```python
import torch

def _softmax(x, axis=-1):
    return torch.softmax(x, dim=axis)

def _gelu(x):
    return torch.nn.functional.gelu(x, approximate='tanh')

def _silu(x):
    return torch.nn.functional.silu(x)

def _sigmoid(x):
    return torch.sigmoid(x)

def _layernorm(x, axis=-1, eps=1e-05):
    m = x.mean(dim=axis, keepdim=True)
    v = x.var(dim=axis, keepdim=True, unbiased=False)
    return (x - m) / torch.sqrt(v + eps)

def _scatter_add(tgt, idx, src, axis=0):
    return tgt.clone().index_add_(axis, idx, src)

def _segment_sum(src, seg, n):
    out = torch.zeros((n,) + src.shape[1:], dtype=src.dtype)
    return out.index_add_(0, seg, src)

def _pad(x, pw):
    flat = tuple((v for pair in reversed(pw) for v in pair))
    return torch.nn.functional.pad(x, flat)
kernel_name = 'adaLN_cond__sliding_local_dilated__glu_gated_glu__prompt'

def setup_inputs():

    _w = lambda a: (lambda t: t.to(torch.bfloat16) if t.is_floating_point() else t)(torch.as_tensor(a))

    def _A_setup():
        B, S, D = (1, 2048, 1024)
        return {'x': _w((lambda *s: torch.randn(*s, dtype=torch.bfloat16) * 0.05)(B, S, D)), 'wqkv': _w((lambda *s: torch.randn(*s, dtype=torch.bfloat16) * 0.05)(D, 3 * D)), 'wo': _w((lambda *s: torch.randn(*s, dtype=torch.bfloat16) * 0.05)(D, D))}
    _A_in = _A_setup()

    def _B_setup():
        B, S, D, F = (1, 2048, 1024, 3584)
        return {'x': _w((lambda *s: torch.randn(*s, dtype=torch.bfloat16) * 0.05)(B, S, D)), 'w_gate': _w((lambda *s: torch.randn(*s, dtype=torch.bfloat16) * 0.05)(D, F)), 'w_up': _w((lambda *s: torch.randn(*s, dtype=torch.bfloat16) * 0.05)(D, F)), 'w_down': _w((lambda *s: torch.randn(*s, dtype=torch.bfloat16) * 0.05)(F, D))}
    _B_in = _B_setup()
    return {'A_x': _A_in['x'], 'A_wqkv': _A_in['wqkv'], 'A_wo': _A_in['wo'], 'B_x': _B_in['x'], 'B_w_gate': _B_in['w_gate'], 'B_w_up': _B_in['w_up'], 'B_w_down': _B_in['w_down'], 'c': _w((lambda *s: torch.randn(*s, dtype=torch.bfloat16) * 0.1)(1, 1024) * 8.0), 'w_mod': _w((lambda *s: torch.randn(*s, dtype=torch.bfloat16) * 0.1)(1024, 6 * 1024) * 1024 ** (-0.5) * 8.0)}

def reference(A_x, A_wqkv, A_wo, B_x, B_w_gate, B_w_up, B_w_down, c, w_mod):

    def _A_ref(x, wqkv, wo):
        B, S, D = x.shape
        H = 32
        Dh = D // H
        W, dil = (8, 2)
        qkv = (lambda x, *d: x.permute(*d))((x @ wqkv).reshape(B, S, 3, H, Dh), 2, 0, 3, 1, 4)
        q, k, v = (qkv[0], qkv[1], qkv[2])
        scale = Dh ** (-0.5)
        pos = torch.arange(S)
        off = torch.arange(W) * dil
        idx = pos[:, None] - off[None, :]
        mask = idx >= 0
        idx_c = torch.where(mask, idx, 0).reshape(-1)
        kg = k[:, :, idx_c, :].reshape(B, H, S, W, Dh)
        vg = v[:, :, idx_c, :].reshape(B, H, S, W, Dh)
        logits = torch.einsum('bhsd,bhswd->bhsw', q, kg) * scale
        logits = torch.where(mask[None, None, :, :], logits, -1000000000.0)
        attn = _softmax(logits, axis=-1)
        o = torch.einsum('bhsw,bhswd->bhsd', attn, vg)
        return (lambda x, *d: x.permute(*d))(o, 0, 2, 1, 3).reshape(B, S, D) @ wo

    def _B_ref(x, w_gate, w_up, w_down):
        g = torch.einsum('bsd,df->bsf', x, w_gate)
        u = torch.einsum('bsd,df->bsf', x, w_up)
        h = _sigmoid(g) * u
        return torch.einsum('bsf,fd->bsd', h, w_down)
    x = A_x
    mod = (_silu(c) @ w_mod).reshape(c.shape[0], 6, 1, -1)
    sa, ca, ga, sb, cb, gb = (mod[:, 0].clone(), mod[:, 1].clone(), mod[:, 2].clone(), mod[:, 3].clone(), mod[:, 4].clone(), mod[:, 5].clone())
    h = _layernorm(x, axis=-1) * (1 + ca) + sa
    x = x + ga * _A_ref(h, A_wqkv, A_wo)
    h = _layernorm(x, axis=-1) * (1 + cb) + sb
    x = x + gb * _B_ref(h, B_w_gate, B_w_up, B_w_down)
    return x
```

```asm
; @launch kernel=k2_kernel grid=(256,1,1) block=(512,1,1) lds=82944
; @launch kernel=k5_kernel grid=(256,1,1) block=(256,1,1) lds=123904
.amdgcn_target "amdgcn-amd-amdhsa--gfx950"
.text
.globl k2_kernel
.p2align 8
.type k2_kernel,@function
k2_kernel:
  s_cmp_ge_u32 s2, 256
  s_cbranch_scc1 L_end_1
  s_load_dwordx4 s[96:99], s[0:1], 0
  s_load_dwordx4 s[92:95], s[0:1], 56
  s_load_dwordx2 s[20:21], s[0:1], 88
  s_load_dwordx2 s[26:27], s[0:1], 16
  s_load_dwordx4 s[60:63], s[0:1], 32
  v_lshrrev_b32 v110, 6, v0
  v_and_b32 v104, 63, v0
  s_nop 0
  v_readfirstlane_b32 s3, v110
  v_lshlrev_b32 v119, 4, v104
  v_mov_b32 v100, 0
  v_mov_b32 v128, v0
  s_lshr_b32 s28, s2, 4
  s_lshl_b32 s28, s28, 3
  s_and_b32 s29, s2, 7
  s_add_u32 s28, s28, s29
  s_bitcmp1_b32 s2, 3
  s_cbranch_scc1 L_lnrole_3
  s_lshr_b32 s30, s28, 2
  s_and_b32 s31, s28, 3
  v_lshrrev_b32 v1, 3, v0
  v_lshlrev_b32 v1, 2, v1
  s_lshl_b32 s33, s31, 8
  v_add_u32 v1, s33, v1
  v_lshlrev_b32 v2, 1, v1
  s_movk_i32 s33, 12288
  v_mul_u32_u24 v1, s33, v1
  v_and_b32 v94, 7, v0
  v_lshl_add_u32 v1, v94, 4, v1
  s_lshl_b32 s35, s30, 7
  s_mul_i32 s34, s31, 24576
  s_lshl_b32 s33, s30, 8
  s_add_u32 s34, s34, s33
  v_lshlrev_b32 v95, 2, v104
  s_waitcnt lgkmcnt(0)
  s_load_dword s100, s[20:21], 0xd2d00
  s_mov_b32 s44, s92
  s_mov_b32 s45, s93
  s_mov_b32 s46, 0x800
  s_mov_b32 s47, 0x20000
  s_mov_b32 s48, s94
  s_mov_b32 s49, s95
  s_mov_b32 s50, 0xc00000
  s_mov_b32 s51, 0x20000
  buffer_load_dwordx2 v[4:5], v2, s[44:47], 0 offen
  buffer_load_dwordx4 v[32:35], v1, s[48:51], s35 offen nt
  s_add_u32 s35, s35, 12288
  buffer_load_dwordx4 v[36:39], v1, s[48:51], s35 offen nt
  s_add_u32 s35, s35, 12288
  buffer_load_dwordx4 v[40:43], v1, s[48:51], s35 offen nt
  s_add_u32 s35, s35, 12288
  buffer_load_dwordx4 v[44:47], v1, s[48:51], s35 offen nt
  s_add_u32 s35, s35, 12288
  s_mov_b32 s12, s20
  s_mov_b32 s13, s21
  s_mov_b32 s14, 0x18000
  s_mov_b32 s15, 0x20000
  s_add_u32 s64, s20, 0xc0000
  s_addc_u32 s65, s21, 0
  s_mov_b32 s66, 0x20000
  s_mov_b32 s67, 0x20000
  s_mov_b32 s52, s98
  s_mov_b32 s53, s99
  s_mov_b32 s54, 0x600000
  s_mov_b32 s55, 0x20000
  v_lshrrev_b32 v90, 4, v104
  s_movk_i32 s33, 6144
  v_mul_u32_u24 v90, s33, v90
  v_and_b32 v91, 15, v104
  v_min_u32 v91, 11, v91
  v_and_b32 v92, 3, v91
  v_lshl_add_u32 v90, v92, 7, v90
  v_lshrrev_b32 v91, 2, v91
  v_lshl_add_u32 v90, v91, 11, v90
  s_lshr_b32 s56, s2, 4
  s_lshl_b32 s33, s3, 4
  s_add_u32 s56, s56, s33
  s_mul_i32 s57, s56, 24576
  s_bfe_u32 s33, s2, 0x20001
  s_lshl_b32 s33, s33, 9
  s_add_u32 s57, s57, s33
  s_mov_b32 s32, 0xbfb8aa3b
  v_and_b32 v96, 3, v104
  v_lshlrev_b32 v96, 3, v96
  s_waitcnt vmcnt(4)
  v_lshlrev_b32 v8, 16, v4
  v_and_b32 v9, 0xffff0000, v4
  v_lshlrev_b32 v10, 16, v5
  v_and_b32 v11, 0xffff0000, v5
  v_mul_f32 v24, s32, v8
  v_mul_f32 v25, s32, v9
  v_mul_f32 v26, s32, v10
  v_mul_f32 v27, s32, v11
  v_exp_f32 v24, v24
  v_exp_f32 v25, v25
  v_exp_f32 v26, v26
  v_exp_f32 v27, v27
  s_nop 0
  v_add_f32 v24, 1.0, v24
  v_add_f32 v25, 1.0, v25
  v_add_f32 v26, 1.0, v26
  v_add_f32 v27, 1.0, v27
  v_rcp_f32 v24, v24
  v_rcp_f32 v25, v25
  v_rcp_f32 v26, v26
  v_rcp_f32 v27, v27
  s_nop 0
  v_mul_f32 v8, v8, v24
  v_mul_f32 v9, v9, v25
  v_mul_f32 v10, v10, v26
  v_mul_f32 v11, v11, v27
  v_cvt_pk_bf16_f32 v24, v8, v9
  v_lshlrev_b32 v8, 16, v24
  v_and_b32 v9, 0xffff0000, v24
  v_cvt_pk_bf16_f32 v25, v10, v11
  v_lshlrev_b32 v10, 16, v25
  v_and_b32 v11, 0xffff0000, v25
  s_waitcnt vmcnt(3)
  v_lshlrev_b32 v24, 16, v32
  v_and_b32 v25, 0xffff0000, v32
  v_lshlrev_b32 v26, 16, v33
  v_and_b32 v27, 0xffff0000, v33
  v_lshlrev_b32 v28, 16, v34
  v_and_b32 v29, 0xffff0000, v34
  v_lshlrev_b32 v30, 16, v35
  v_and_b32 v31, 0xffff0000, v35
  v_mul_f32 v16, v24, v8
  v_mul_f32 v17, v25, v8
  v_mul_f32 v18, v26, v8
  v_mul_f32 v19, v27, v8
  v_mul_f32 v20, v28, v8
  v_mul_f32 v21, v29, v8
  v_mul_f32 v22, v30, v8
  v_mul_f32 v23, v31, v8
  s_waitcnt vmcnt(2)
  v_lshlrev_b32 v24, 16, v36
  v_and_b32 v25, 0xffff0000, v36
  v_lshlrev_b32 v26, 16, v37
  v_and_b32 v27, 0xffff0000, v37
  v_lshlrev_b32 v28, 16, v38
  v_and_b32 v29, 0xffff0000, v38
  v_lshlrev_b32 v30, 16, v39
  v_and_b32 v31, 0xffff0000, v39
  v_fmac_f32 v16, v24, v9
  v_fmac_f32 v17, v25, v9
  v_fmac_f32 v18, v26, v9
  v_fmac_f32 v19, v27, v9
  v_fmac_f32 v20, v28, v9
  v_fmac_f32 v21, v29, v9
  v_fmac_f32 v22, v30, v9
  v_fmac_f32 v23, v31, v9
  s_waitcnt vmcnt(1)
  v_lshlrev_b32 v24, 16, v40
  v_and_b32 v25, 0xffff0000, v40
  v_lshlrev_b32 v26, 16, v41
  v_and_b32 v27, 0xffff0000, v41
  v_lshlrev_b32 v28, 16, v42
  v_and_b32 v29, 0xffff0000, v42
  v_lshlrev_b32 v30, 16, v43
  v_and_b32 v31, 0xffff0000, v43
  v_fmac_f32 v16, v24, v10
  v_fmac_f32 v17, v25, v10
  v_fmac_f32 v18, v26, v10
  v_fmac_f32 v19, v27, v10
  v_fmac_f32 v20, v28, v10
  v_fmac_f32 v21, v29, v10
  v_fmac_f32 v22, v30, v10
  v_fmac_f32 v23, v31, v10
  s_waitcnt vmcnt(0)
  v_lshlrev_b32 v24, 16, v44
  v_and_b32 v25, 0xffff0000, v44
  v_lshlrev_b32 v26, 16, v45
  v_and_b32 v27, 0xffff0000, v45
  v_lshlrev_b32 v28, 16, v46
  v_and_b32 v29, 0xffff0000, v46
  v_lshlrev_b32 v30, 16, v47
  v_and_b32 v31, 0xffff0000, v47
  v_fmac_f32 v16, v24, v11
  v_fmac_f32 v17, v25, v11
  v_fmac_f32 v18, v26, v11
  v_fmac_f32 v19, v27, v11
  v_fmac_f32 v20, v28, v11
  v_fmac_f32 v21, v29, v11
  v_fmac_f32 v22, v30, v11
  v_fmac_f32 v23, v31, v11
  s_nop 1
  v_add_f32_dpp v16, v16, v16 row_ror:8 row_mask:0xf bank_mask:0xf
  v_add_f32_dpp v17, v17, v17 row_ror:8 row_mask:0xf bank_mask:0xf
  v_add_f32_dpp v18, v18, v18 row_ror:8 row_mask:0xf bank_mask:0xf
  v_add_f32_dpp v19, v19, v19 row_ror:8 row_mask:0xf bank_mask:0xf
  v_add_f32_dpp v20, v20, v20 row_ror:8 row_mask:0xf bank_mask:0xf
  v_add_f32_dpp v21, v21, v21 row_ror:8 row_mask:0xf bank_mask:0xf
  v_add_f32_dpp v22, v22, v22 row_ror:8 row_mask:0xf bank_mask:0xf
  v_add_f32_dpp v23, v23, v23 row_ror:8 row_mask:0xf bank_mask:0xf
  v_lshrrev_b32 v93, 4, v0
  v_lshlrev_b32 v93, 8, v93
  v_lshl_add_u32 v93, v94, 5, v93
  ds_write_b128 v93, v[16:19] offset:53248
  ds_write_b128 v93, v[20:23] offset:53264
  s_waitcnt lgkmcnt(0)
  s_barrier
  s_mul_i32 s100, s100, 0x9e3779b1
  s_add_u32 s100, s100, 0x7f4a7c15
  s_cmp_lg_u32 s3, 0
  s_cbranch_scc1 L_pfgo_5
  v_add_u32 v93, 53248, v95
  ds_read2st64_b32 v[32:33], v93 offset0:0 offset1:1
  ds_read2st64_b32 v[34:35], v93 offset0:2 offset1:3
  ds_read2st64_b32 v[36:37], v93 offset0:4 offset1:5
  ds_read2st64_b32 v[38:39], v93 offset0:6 offset1:7
  ds_read2st64_b32 v[40:41], v93 offset0:8 offset1:9
  ds_read2st64_b32 v[42:43], v93 offset0:10 offset1:11
  ds_read2st64_b32 v[44:45], v93 offset0:12 offset1:13
  ds_read2st64_b32 v[46:47], v93 offset0:14 offset1:15
  ds_read2st64_b32 v[48:49], v93 offset0:16 offset1:17
  ds_read2st64_b32 v[50:51], v93 offset0:18 offset1:19
  ds_read2st64_b32 v[52:53], v93 offset0:20 offset1:21
  ds_read2st64_b32 v[54:55], v93 offset0:22 offset1:23
  ds_read2st64_b32 v[56:57], v93 offset0:24 offset1:25
  ds_read2st64_b32 v[58:59], v93 offset0:26 offset1:27
  ds_read2st64_b32 v[60:61], v93 offset0:28 offset1:29
  ds_read2st64_b32 v[62:63], v93 offset0:30 offset1:31
  v_lshrrev_b32 v96, v96, s100
  s_movk_i32 s33, 0xff
  s_waitcnt lgkmcnt(0)
  v_pk_add_f32 v[32:33], v[32:33], v[48:49]
  v_pk_add_f32 v[34:35], v[34:35], v[50:51]
  v_pk_add_f32 v[36:37], v[36:37], v[52:53]
  v_pk_add_f32 v[38:39], v[38:39], v[54:55]
  v_pk_add_f32 v[40:41], v[40:41], v[56:57]
  v_pk_add_f32 v[42:43], v[42:43], v[58:59]
  v_pk_add_f32 v[44:45], v[44:45], v[60:61]
  v_pk_add_f32 v[46:47], v[46:47], v[62:63]
  v_pk_add_f32 v[32:33], v[32:33], v[40:41]
  v_pk_add_f32 v[34:35], v[34:35], v[42:43]
  v_pk_add_f32 v[36:37], v[36:37], v[44:45]
  v_pk_add_f32 v[38:39], v[38:39], v[46:47]
  v_pk_add_f32 v[32:33], v[32:33], v[36:37]
  v_pk_add_f32 v[34:35], v[34:35], v[38:39]
  v_pk_add_f32 v[32:33], v[32:33], v[34:35]
  v_add_f32 v32, v32, v33
  v_bfi_b32 v32, s33, v96, v32
  buffer_store_dword v32, v95, s[12:15], s34 offen sc1
L_pfgo_5:
  s_barrier
  s_getpc_b64 s[58:59]
  L_pc_6:
  s_sub_u32 s58, s58, L_pc_6-k2_kernel
  s_subb_u32 s59, s59, 0
  s_lshl_b32 s33, s56, 13
  v_lshlrev_b32 v86, 7, v104
  v_add_u32 v86, s33, v86
  v_min_u32 v86, L_code_end-k2_kernel-4, v86
  v_mov_b32 v87, s59
  v_add_co_u32 v86, vcc, s58, v86
  s_nop 1
  v_addc_co_u32 v87, vcc, 0, v87, vcc
  global_load_dword v113, v[86:87], off
  s_lshl_b32 s35, s30, 8
  s_add_u32 s35, s35, 4096
  buffer_load_dwordx4 v[32:35], v1, s[48:51], s35 offen offset:0 nt
  buffer_load_dwordx4 v[48:51], v1, s[48:51], s35 offen offset:128 nt
  s_add_u32 s35, s35, 12288
  buffer_load_dwordx4 v[36:39], v1, s[48:51], s35 offen offset:0 nt
  buffer_load_dwordx4 v[52:55], v1, s[48:51], s35 offen offset:128 nt
  s_add_u32 s35, s35, 12288
  buffer_load_dwordx4 v[40:43], v1, s[48:51], s35 offen offset:0 nt
  buffer_load_dwordx4 v[56:59], v1, s[48:51], s35 offen offset:128 nt
  s_add_u32 s35, s35, 12288
  buffer_load_dwordx4 v[44:47], v1, s[48:51], s35 offen offset:0 nt
  buffer_load_dwordx4 v[60:63], v1, s[48:51], s35 offen offset:128 nt
  s_add_u32 s35, s35, 12288
  v_lshrrev_b32 v93, 4, v0
  v_lshlrev_b32 v93, 8, v93
  v_lshl_add_u32 v93, v94, 5, v93
  v_add_u32 v93, 63808, v93
  s_waitcnt vmcnt(0)
  v_lshlrev_b32 v24, 16, v32
  v_and_b32 v25, 0xffff0000, v32
  v_lshlrev_b32 v26, 16, v33
  v_and_b32 v27, 0xffff0000, v33
  v_lshlrev_b32 v28, 16, v34
  v_and_b32 v29, 0xffff0000, v34
  v_lshlrev_b32 v30, 16, v35
  v_and_b32 v31, 0xffff0000, v35
  v_mul_f32 v16, v24, v8
  v_mul_f32 v17, v25, v8
  v_mul_f32 v18, v26, v8
  v_mul_f32 v19, v27, v8
  v_mul_f32 v20, v28, v8
  v_mul_f32 v21, v29, v8
  v_mul_f32 v22, v30, v8
  v_mul_f32 v23, v31, v8
  v_lshlrev_b32 v24, 16, v36
  v_and_b32 v25, 0xffff0000, v36
  v_lshlrev_b32 v26, 16, v37
  v_and_b32 v27, 0xffff0000, v37
  v_lshlrev_b32 v28, 16, v38
  v_and_b32 v29, 0xffff0000, v38
  v_lshlrev_b32 v30, 16, v39
  v_and_b32 v31, 0xffff0000, v39
  v_fmac_f32 v16, v24, v9
  v_fmac_f32 v17, v25, v9
  v_fmac_f32 v18, v26, v9
  v_fmac_f32 v19, v27, v9
  v_fmac_f32 v20, v28, v9
  v_fmac_f32 v21, v29, v9
  v_fmac_f32 v22, v30, v9
  v_fmac_f32 v23, v31, v9
  v_lshlrev_b32 v24, 16, v40
  v_and_b32 v25, 0xffff0000, v40
  v_lshlrev_b32 v26, 16, v41
  v_and_b32 v27, 0xffff0000, v41
  v_lshlrev_b32 v28, 16, v42
  v_and_b32 v29, 0xffff0000, v42
  v_lshlrev_b32 v30, 16, v43
  v_and_b32 v31, 0xffff0000, v43
  v_fmac_f32 v16, v24, v10
  v_fmac_f32 v17, v25, v10
  v_fmac_f32 v18, v26, v10
  v_fmac_f32 v19, v27, v10
  v_fmac_f32 v20, v28, v10
  v_fmac_f32 v21, v29, v10
  v_fmac_f32 v22, v30, v10
  v_fmac_f32 v23, v31, v10
  v_lshlrev_b32 v24, 16, v44
  v_and_b32 v25, 0xffff0000, v44
  v_lshlrev_b32 v26, 16, v45
  v_and_b32 v27, 0xffff0000, v45
  v_lshlrev_b32 v28, 16, v46
  v_and_b32 v29, 0xffff0000, v46
  v_lshlrev_b32 v30, 16, v47
  v_and_b32 v31, 0xffff0000, v47
  v_fmac_f32 v16, v24, v11
  v_fmac_f32 v17, v25, v11
  v_fmac_f32 v18, v26, v11
  v_fmac_f32 v19, v27, v11
  v_fmac_f32 v20, v28, v11
  v_fmac_f32 v21, v29, v11
  v_fmac_f32 v22, v30, v11
  v_fmac_f32 v23, v31, v11
  s_nop 1
  v_add_f32_dpp v16, v16, v16 row_ror:8 row_mask:0xf bank_mask:0xf
  v_add_f32_dpp v17, v17, v17 row_ror:8 row_mask:0xf bank_mask:0xf
  v_add_f32_dpp v18, v18, v18 row_ror:8 row_mask:0xf bank_mask:0xf
  v_add_f32_dpp v19, v19, v19 row_ror:8 row_mask:0xf bank_mask:0xf
  v_add_f32_dpp v20, v20, v20 row_ror:8 row_mask:0xf bank_mask:0xf
  v_add_f32_dpp v21, v21, v21 row_ror:8 row_mask:0xf bank_mask:0xf
  v_add_f32_dpp v22, v22, v22 row_ror:8 row_mask:0xf bank_mask:0xf
  v_add_f32_dpp v23, v23, v23 row_ror:8 row_mask:0xf bank_mask:0xf
  ds_write_b128 v93, v[16:19] offset:0
  ds_write_b128 v93, v[20:23] offset:16
  s_nop 1
  v_lshlrev_b32 v24, 16, v48
  v_and_b32 v25, 0xffff0000, v48
  v_lshlrev_b32 v26, 16, v49
  v_and_b32 v27, 0xffff0000, v49
  v_lshlrev_b32 v28, 16, v50
  v_and_b32 v29, 0xffff0000, v50
  v_lshlrev_b32 v30, 16, v51
  v_and_b32 v31, 0xffff0000, v51
  v_mul_f32 v16, v24, v8
  v_mul_f32 v17, v25, v8
  v_mul_f32 v18, v26, v8
  v_mul_f32 v19, v27, v8
  v_mul_f32 v20, v28, v8
  v_mul_f32 v21, v29, v8
  v_mul_f32 v22, v30, v8
  v_mul_f32 v23, v31, v8
  v_lshlrev_b32 v24, 16, v52
  v_and_b32 v25, 0xffff0000, v52
  v_lshlrev_b32 v26, 16, v53
  v_and_b32 v27, 0xffff0000, v53
  v_lshlrev_b32 v28, 16, v54
  v_and_b32 v29, 0xffff0000, v54
  v_lshlrev_b32 v30, 16, v55
  v_and_b32 v31, 0xffff0000, v55
  v_fmac_f32 v16, v24, v9
  v_fmac_f32 v17, v25, v9
  v_fmac_f32 v18, v26, v9
  v_fmac_f32 v19, v27, v9
  v_fmac_f32 v20, v28, v9
  v_fmac_f32 v21, v29, v9
  v_fmac_f32 v22, v30, v9
  v_fmac_f32 v23, v31, v9
  v_lshlrev_b32 v24, 16, v56
  v_and_b32 v25, 0xffff0000, v56
  v_lshlrev_b32 v26, 16, v57
  v_and_b32 v27, 0xffff0000, v57
  v_lshlrev_b32 v28, 16, v58
  v_and_b32 v29, 0xffff0000, v58
  v_lshlrev_b32 v30, 16, v59
  v_and_b32 v31, 0xffff0000, v59
  v_fmac_f32 v16, v24, v10
  v_fmac_f32 v17, v25, v10
  v_fmac_f32 v18, v26, v10
  v_fmac_f32 v19, v27, v10
  v_fmac_f32 v20, v28, v10
  v_fmac_f32 v21, v29, v10
  v_fmac_f32 v22, v30, v10
  v_fmac_f32 v23, v31, v10
  v_lshlrev_b32 v24, 16, v60
  v_and_b32 v25, 0xffff0000, v60
  v_lshlrev_b32 v26, 16, v61
  v_and_b32 v27, 0xffff0000, v61
  v_lshlrev_b32 v28, 16, v62
  v_and_b32 v29, 0xffff0000, v62
  v_lshlrev_b32 v30, 16, v63
  v_and_b32 v31, 0xffff0000, v63
  v_fmac_f32 v16, v24, v11
  v_fmac_f32 v17, v25, v11
  v_fmac_f32 v18, v26, v11
  v_fmac_f32 v19, v27, v11
  v_fmac_f32 v20, v28, v11
  v_fmac_f32 v21, v29, v11
  v_fmac_f32 v22, v30, v11
  v_fmac_f32 v23, v31, v11
  s_nop 1
  v_add_f32_dpp v16, v16, v16 row_ror:8 row_mask:0xf bank_mask:0xf
  v_add_f32_dpp v17, v17, v17 row_ror:8 row_mask:0xf bank_mask:0xf
  v_add_f32_dpp v18, v18, v18 row_ror:8 row_mask:0xf bank_mask:0xf
  v_add_f32_dpp v19, v19, v19 row_ror:8 row_mask:0xf bank_mask:0xf
  v_add_f32_dpp v20, v20, v20 row_ror:8 row_mask:0xf bank_mask:0xf
  v_add_f32_dpp v21, v21, v21 row_ror:8 row_mask:0xf bank_mask:0xf
  v_add_f32_dpp v22, v22, v22 row_ror:8 row_mask:0xf bank_mask:0xf
  v_add_f32_dpp v23, v23, v23 row_ror:8 row_mask:0xf bank_mask:0xf
  ds_write_b128 v93, v[16:19] offset:8192
  ds_write_b128 v93, v[20:23] offset:8208
  s_nop 1
  s_waitcnt lgkmcnt(0)
  s_barrier
  s_cmp_lt_u32 s3, 6
  s_cbranch_scc1 L_g2d_7
  s_and_b32 s33, s3, 1
  s_lshl_b32 s32, s33, 13
  s_add_u32 s32, s32, 63808
  v_add_u32 v93, s32, v95
  ds_read2st64_b32 v[32:33], v93 offset0:0 offset1:1
  ds_read2st64_b32 v[34:35], v93 offset0:2 offset1:3
  ds_read2st64_b32 v[36:37], v93 offset0:4 offset1:5
  ds_read2st64_b32 v[38:39], v93 offset0:6 offset1:7
  ds_read2st64_b32 v[40:41], v93 offset0:8 offset1:9
  ds_read2st64_b32 v[42:43], v93 offset0:10 offset1:11
  ds_read2st64_b32 v[44:45], v93 offset0:12 offset1:13
  ds_read2st64_b32 v[46:47], v93 offset0:14 offset1:15
  ds_read2st64_b32 v[48:49], v93 offset0:16 offset1:17
  ds_read2st64_b32 v[50:51], v93 offset0:18 offset1:19
  ds_read2st64_b32 v[52:53], v93 offset0:20 offset1:21
  ds_read2st64_b32 v[54:55], v93 offset0:22 offset1:23
  ds_read2st64_b32 v[56:57], v93 offset0:24 offset1:25
  ds_read2st64_b32 v[58:59], v93 offset0:26 offset1:27
  ds_read2st64_b32 v[60:61], v93 offset0:28 offset1:29
  ds_read2st64_b32 v[62:63], v93 offset0:30 offset1:31
  s_mul_i32 s34, s31, 24576
  s_lshl_b32 s32, s30, 9
  s_add_u32 s34, s34, s32
  s_lshl_b32 s32, s33, 8
  s_add_u32 s34, s34, s32
  s_add_u32 s34, s34, 8192
  s_waitcnt lgkmcnt(0)
  v_add_f32 v32, v32, v48
  v_add_f32 v33, v33, v49
  v_add_f32 v34, v34, v50
  v_add_f32 v35, v35, v51
  v_add_f32 v36, v36, v52
  v_add_f32 v37, v37, v53
  v_add_f32 v38, v38, v54
  v_add_f32 v39, v39, v55
  v_add_f32 v40, v40, v56
  v_add_f32 v41, v41, v57
  v_add_f32 v42, v42, v58
  v_add_f32 v43, v43, v59
  v_add_f32 v44, v44, v60
  v_add_f32 v45, v45, v61
  v_add_f32 v46, v46, v62
  v_add_f32 v47, v47, v63
  v_add_f32 v32, v32, v40
  v_add_f32 v33, v33, v41
  v_add_f32 v34, v34, v42
  v_add_f32 v35, v35, v43
  v_add_f32 v36, v36, v44
  v_add_f32 v37, v37, v45
  v_add_f32 v38, v38, v46
  v_add_f32 v39, v39, v47
  v_add_f32 v32, v32, v36
  v_add_f32 v33, v33, v37
  v_add_f32 v34, v34, v38
  v_add_f32 v35, v35, v39
  v_add_f32 v32, v32, v34
  v_add_f32 v33, v33, v35
  v_add_f32 v32, v32, v33
  buffer_store_dword v32, v95, s[12:15], s34 offen sc1
L_g2d_7:
  s_and_b32 s32, s2, 7
  s_lshr_b32 s34, s2, 3
  s_and_b32 s30, s32, 1
  s_lshl_b32 s30, s30, 3
  s_and_b32 s31, s34, 7
  s_add_u32 s30, s30, s31
  s_lshr_b32 s31, s32, 1
  s_lshl_b32 s31, s31, 2
  s_lshr_b32 s34, s34, 3
  s_add_u32 s31, s31, s34
  v_lshrrev_b32 v110, 3, v104
  v_and_b32 v111, 6, v110
  v_and_b32 v112, 7, v104
  v_xor_b32 v111, v111, v112
  s_movk_i32 s33, 6144
  v_mul_u32_u24 v110, s33, v110
  v_lshl_add_u32 v110, v111, 4, v110
  s_mul_i32 s32, s3, 49152
  s_lshl_b32 s33, s31, 7
  s_add_u32 s32, s32, s33
  v_add_u32 v107, s32, v110
  v_add_u32 v108, 1024, v107
  v_add_u32 v109, 2048, v107
  s_mul_i32 s38, s3, 3072
  s_lshl_b32 s39, s3, 8
  s_add_u32 s39, s39, 12288
  s_mov_b32 s16, 0
  s_mov_b32 s17, 0
  s_mov_b32 s19, 0
  s_mov_b32 s8, s98
  s_mov_b32 s9, s99
  s_mov_b32 s10, 0x600000
  s_mov_b32 s11, 0x20000
  s_cmp_ge_u32 s3, 4
  s_cbranch_scc1 L_sk_8
  s_add_u32 m0, s38, 0
  s_nop 0
  buffer_load_dwordx4 v107, s[8:11], s17 offen lds
  buffer_load_dwordx4 v108, s[8:11], s17 offen offset:1024 lds
  buffer_load_dwordx4 v109, s[8:11], s17 offen offset:2048 lds
  s_add_u32 s17, s17, 196608
  s_add_u32 m0, s38, 13312
  s_nop 0
  buffer_load_dwordx4 v107, s[8:11], s17 offen lds
  buffer_load_dwordx4 v108, s[8:11], s17 offen offset:1024 lds
  buffer_load_dwordx4 v109, s[8:11], s17 offen offset:2048 lds
  s_add_u32 s17, s17, 196608
  s_add_u32 m0, s38, 26624
  s_nop 0
  buffer_load_dwordx4 v107, s[8:11], s17 offen lds
  buffer_load_dwordx4 v108, s[8:11], s17 offen offset:1024 lds
  buffer_load_dwordx4 v109, s[8:11], s17 offen offset:2048 lds
  s_add_u32 s17, s17, 196608
L_sk_8:
  s_add_u32 s4, s20, 0x100000
  s_addc_u32 s5, s21, 0
  s_mov_b32 s6, 0x400000
  s_mov_b32 s7, 0x20000
  s_lshl_b32 s33, s30, 3
  s_lshl_b32 s35, s3, 1
  s_add_u32 s35, s35, s33
  s_lshl_b32 s35, s35, 3
  s_max_u32 s33, s33, 1
  s_sub_u32 s33, s33, 1
  s_lshl_b32 s33, s33, 3
  v_and_b32 v110, 7, v104
  v_add_u32 v110, s33, v110
  v_add_u32 v129, s35, v104
  v_cmp_lt_u32 vcc, 15, v104
  s_nop 1
  v_cndmask_b32 v129, v129, v110, vcc
  v_and_b32 v131, -8, v129
  v_lshlrev_b32 v129, 6, v129
  v_lshlrev_b32 v131, 6, v131
  s_lshl_b32 s32, s30, 13
  s_lshl_b32 s33, s3, 11
  s_add_u32 s32, s32, s33
  v_add_u32 v105, s32, v119
  s_lshl_b32 s32, s30, 3
  s_max_u32 s32, s32, 1
  s_sub_u32 s32, s32, 1
  s_lshl_b32 s32, s32, 10
  s_lshl_b32 s33, s3, 8
  s_add_u32 s32, s32, s33
  v_lshlrev_b32 v106, 2, v104
  v_add_u32 v106, s32, v106
  v_lshrrev_b32 v110, 5, v104
  v_mul_u32_u24 v110, 3072, v110
  v_bfe_u32 v111, v104, 2, 3
  v_lshl_add_u32 v110, v111, 7, v110
  v_bfe_u32 v111, v104, 3, 2
  v_lshl_add_u32 v110, v111, 5, v110
  v_and_b32 v111, 3, v104
  v_lshl_add_u32 v114, v111, 3, v110
  v_xor_b32 v115, 32, v114
  v_xor_b32 v116, 64, v114
  v_xor_b32 v117, 96, v114
  s_lshl_b32 s33, s3, 5
  v_xor_b32 v118, s33, v114
  v_and_b32 v110, 14, v104
  v_lshrrev_b32 v111, 4, v104
  v_lshlrev_b32 v111, 2, v111
  v_cmp_le_u32 s[44:45], v111, v110
  v_add_u32 v111, 2, v111
  v_cmp_le_u32 s[46:47], v111, v110
  v_and_b32 v110, 1, v104
  v_cmp_eq_u32 s[48:49], 1, v110
  s_branch L_front_4
L_lnrole_3:
  v_bfe_u32 v66, v104, 4, 1
  v_lshlrev_b32 v3, 5, v66
  v_lshrrev_b32 v66, 5, v104
  v_lshl_add_u32 v3, v66, 4, v3
  v_and_b32 v66, 15, v104
  v_lshl_add_u32 v1, v66, 11, v3
  s_lshl_b32 s35, s28, 15
  s_lshl_b32 s30, s3, 8
  s_add_u32 s35, s35, s30
  s_waitcnt lgkmcnt(0)
  s_load_dword s100, s[20:21], 0xd2d00
  s_mov_b32 s12, s96
  s_mov_b32 s13, s97
  s_mov_b32 s14, 0x400000
  s_mov_b32 s15, 0x20000
  buffer_load_dwordx4 v[8:11], v1, s[12:15], s35 offen offset:0
  buffer_load_dwordx4 v[12:15], v1, s[12:15], s35 offen offset:64
  buffer_load_dwordx4 v[16:19], v1, s[12:15], s35 offen offset:128
  buffer_load_dwordx4 v[20:23], v1, s[12:15], s35 offen offset:192
  s_add_u32 s64, s20, 0xc0000
  s_addc_u32 s65, s21, 0
  s_mov_b32 s66, 0x20000
  s_mov_b32 s67, 0x20000
  s_mov_b32 s12, s20
  s_mov_b32 s13, s21
  s_mov_b32 s14, 0x18000
  s_mov_b32 s15, 0x20000
  s_add_u32 s4, s20, 0x100000
  s_addc_u32 s5, s21, 0
  s_mov_b32 s6, 0x400000
  s_mov_b32 s7, 0x20000
  s_lshl_b32 s30, s3, 9
  v_lshlrev_b32 v3, 1, v3
  v_add_u32 v3, s30, v3
  v_and_b32 v66, 31, v104
  v_lshlrev_b32 v5, 4, v66
  v_add_u32 v5, s30, v5
  v_lshrrev_b32 v66, 5, v104
  s_movk_i32 s33, 24576
  v_mul_u32_u24 v4, s33, v66
  v_add_u32 v4, v5, v4
  s_mov_b32 s22, 0
  s_mov_b32 s23, 49152
  s_mov_b32 s24, 4096
  s_mov_b32 s25, 53248
  s_lshl_b32 s36, s28, 3
  s_add_u32 s36, s36, s3
  s_lshl_b32 s36, s36, 6
  s_mov_b32 s52, s98
  s_mov_b32 s53, s99
  s_mov_b32 s54, 0x600000
  s_mov_b32 s55, 0x20000
  v_lshrrev_b32 v90, 4, v104
  s_movk_i32 s33, 6144
  v_mul_u32_u24 v90, s33, v90
  v_and_b32 v91, 15, v104
  v_min_u32 v91, 11, v91
  v_and_b32 v92, 3, v91
  v_lshl_add_u32 v90, v92, 7, v90
  v_lshrrev_b32 v91, 2, v91
  v_lshl_add_u32 v90, v91, 11, v90
  s_lshr_b32 s56, s2, 4
  s_lshl_b32 s33, s3, 4
  s_add_u32 s56, s56, s33
  s_mul_i32 s57, s56, 24576
  s_bfe_u32 s33, s2, 0x20001
  s_lshl_b32 s33, s33, 9
  s_add_u32 s57, s57, s33
  s_barrier
  buffer_load_dword v89, v90, s[52:55], s57 offen
  s_add_u32 s57, s57, 3145728
  buffer_load_dword v89, v90, s[52:55], s57 offen
  s_waitcnt vmcnt(2)
  v_lshlrev_b32 v24, 16, v8
  v_and_b32 v25, 0xffff0000, v8
  v_lshlrev_b32 v26, 16, v9
  v_and_b32 v27, 0xffff0000, v9
  v_lshlrev_b32 v28, 16, v10
  v_and_b32 v29, 0xffff0000, v10
  v_lshlrev_b32 v30, 16, v11
  v_and_b32 v31, 0xffff0000, v11
  v_lshlrev_b32 v32, 16, v12
  v_and_b32 v33, 0xffff0000, v12
  v_lshlrev_b32 v34, 16, v13
  v_and_b32 v35, 0xffff0000, v13
  v_lshlrev_b32 v36, 16, v14
  v_and_b32 v37, 0xffff0000, v14
  v_lshlrev_b32 v38, 16, v15
  v_and_b32 v39, 0xffff0000, v15
  v_lshlrev_b32 v40, 16, v16
  v_and_b32 v41, 0xffff0000, v16
  v_lshlrev_b32 v42, 16, v17
  v_and_b32 v43, 0xffff0000, v17
  v_lshlrev_b32 v44, 16, v18
  v_and_b32 v45, 0xffff0000, v18
  v_lshlrev_b32 v46, 16, v19
  v_and_b32 v47, 0xffff0000, v19
  v_lshlrev_b32 v48, 16, v20
  v_and_b32 v49, 0xffff0000, v20
  v_lshlrev_b32 v50, 16, v21
  v_and_b32 v51, 0xffff0000, v21
  v_lshlrev_b32 v52, 16, v22
  v_and_b32 v53, 0xffff0000, v22
  v_lshlrev_b32 v54, 16, v23
  v_and_b32 v55, 0xffff0000, v23
  v_pk_add_f32 v[66:67], v[24:25], v[26:27]
  v_pk_add_f32 v[68:69], v[28:29], v[30:31]
  v_pk_add_f32 v[66:67], v[66:67], v[32:33]
  v_pk_add_f32 v[68:69], v[68:69], v[34:35]
  v_pk_add_f32 v[66:67], v[66:67], v[36:37]
  v_pk_add_f32 v[68:69], v[68:69], v[38:39]
  v_pk_add_f32 v[66:67], v[66:67], v[40:41]
  v_pk_add_f32 v[68:69], v[68:69], v[42:43]
  v_pk_add_f32 v[66:67], v[66:67], v[44:45]
  v_pk_add_f32 v[68:69], v[68:69], v[46:47]
  v_pk_add_f32 v[66:67], v[66:67], v[48:49]
  v_pk_add_f32 v[68:69], v[68:69], v[50:51]
  v_pk_add_f32 v[66:67], v[66:67], v[52:53]
  v_pk_add_f32 v[68:69], v[68:69], v[54:55]
  v_pk_add_f32 v[66:67], v[66:67], v[68:69]
  v_add_f32 v66, v66, v67
  v_mov_b32 v67, v66
  s_nop 1
  v_permlane16_swap_b32 v67, v66
  s_nop 1
  v_add_f32 v66, v66, v67
  v_mov_b32 v67, v66
  s_nop 1
  v_permlane32_swap_b32 v67, v66
  s_nop 1
  v_add_f32 v66, v66, v67
  v_mul_f32 v56, 0x3c000000, v66
  v_mov_b32 v57, v56
  v_pk_add_f32 v[60:61], v[24:25], v[56:57] neg_lo:[0,1] neg_hi:[0,1]
  v_pk_mul_f32 v[66:67], v[60:61], v[60:61]
  v_pk_add_f32 v[62:63], v[26:27], v[56:57] neg_lo:[0,1] neg_hi:[0,1]
  v_pk_mul_f32 v[68:69], v[62:63], v[62:63]
  v_pk_add_f32 v[60:61], v[28:29], v[56:57] neg_lo:[0,1] neg_hi:[0,1]
  v_pk_fma_f32 v[66:67], v[60:61], v[60:61], v[66:67]
  v_pk_add_f32 v[62:63], v[30:31], v[56:57] neg_lo:[0,1] neg_hi:[0,1]
  v_pk_fma_f32 v[68:69], v[62:63], v[62:63], v[68:69]
  v_pk_add_f32 v[60:61], v[32:33], v[56:57] neg_lo:[0,1] neg_hi:[0,1]
  v_pk_fma_f32 v[66:67], v[60:61], v[60:61], v[66:67]
  v_pk_add_f32 v[62:63], v[34:35], v[56:57] neg_lo:[0,1] neg_hi:[0,1]
  v_pk_fma_f32 v[68:69], v[62:63], v[62:63], v[68:69]
  v_pk_add_f32 v[60:61], v[36:37], v[56:57] neg_lo:[0,1] neg_hi:[0,1]
  v_pk_fma_f32 v[66:67], v[60:61], v[60:61], v[66:67]
  v_pk_add_f32 v[62:63], v[38:39], v[56:57] neg_lo:[0,1] neg_hi:[0,1]
  v_pk_fma_f32 v[68:69], v[62:63], v[62:63], v[68:69]
  v_pk_add_f32 v[60:61], v[40:41], v[56:57] neg_lo:[0,1] neg_hi:[0,1]
  v_pk_fma_f32 v[66:67], v[60:61], v[60:61], v[66:67]
  v_pk_add_f32 v[62:63], v[42:43], v[56:57] neg_lo:[0,1] neg_hi:[0,1]
  v_pk_fma_f32 v[68:69], v[62:63], v[62:63], v[68:69]
  v_pk_add_f32 v[60:61], v[44:45], v[56:57] neg_lo:[0,1] neg_hi:[0,1]
  v_pk_fma_f32 v[66:67], v[60:61], v[60:61], v[66:67]
  v_pk_add_f32 v[62:63], v[46:47], v[56:57] neg_lo:[0,1] neg_hi:[0,1]
  v_pk_fma_f32 v[68:69], v[62:63], v[62:63], v[68:69]
  v_pk_add_f32 v[60:61], v[48:49], v[56:57] neg_lo:[0,1] neg_hi:[0,1]
  v_pk_fma_f32 v[66:67], v[60:61], v[60:61], v[66:67]
  v_pk_add_f32 v[62:63], v[50:51], v[56:57] neg_lo:[0,1] neg_hi:[0,1]
  v_pk_fma_f32 v[68:69], v[62:63], v[62:63], v[68:69]
  v_pk_add_f32 v[60:61], v[52:53], v[56:57] neg_lo:[0,1] neg_hi:[0,1]
  v_pk_fma_f32 v[66:67], v[60:61], v[60:61], v[66:67]
  v_pk_add_f32 v[62:63], v[54:55], v[56:57] neg_lo:[0,1] neg_hi:[0,1]
  v_pk_fma_f32 v[68:69], v[62:63], v[62:63], v[68:69]
  v_pk_add_f32 v[66:67], v[66:67], v[68:69]
  v_add_f32 v57, v66, v67
  v_mov_b32 v67, v57
  s_nop 1
  v_permlane16_swap_b32 v67, v57
  s_nop 1
  v_add_f32 v57, v57, v67
  v_mov_b32 v67, v57
  s_nop 1
  v_permlane32_swap_b32 v67, v57
  s_nop 1
  v_add_f32 v57, v57, v67
  v_and_b32 v70, 15, v104
  v_mul_u32_u24 v70, 80, v70
  s_lshl_b32 s30, s3, 3
  v_add_u32 v71, s30, v70
  ds_write_b64 v71, v[56:57] offset:62464
  s_waitcnt lgkmcnt(0)
  s_barrier
  s_mul_i32 s100, s100, 0x9e3779b1
  s_add_u32 s100, s100, 0x7f4a7c15
  ds_read_b128 v[132:135], v70 offset:62464
  ds_read_b128 v[136:139], v70 offset:62480
  ds_read_b128 v[140:143], v70 offset:62496
  ds_read_b128 v[144:147], v70 offset:62512
  s_waitcnt lgkmcnt(0)
  v_pk_add_f32 v[66:67], v[132:133], v[134:135]
  v_pk_add_f32 v[68:69], v[136:137], v[138:139]
  v_pk_add_f32 v[66:67], v[66:67], v[140:141]
  v_pk_add_f32 v[68:69], v[68:69], v[142:143]
  v_pk_add_f32 v[66:67], v[66:67], v[144:145]
  v_pk_add_f32 v[68:69], v[68:69], v[146:147]
  v_pk_add_f32 v[66:67], v[66:67], v[68:69]
  v_mul_f32 v56, 0x3e000000, v66
  v_sub_f32 v132, v132, v56
  v_sub_f32 v134, v134, v56
  v_sub_f32 v136, v136, v56
  v_sub_f32 v138, v138, v56
  v_sub_f32 v140, v140, v56
  v_sub_f32 v142, v142, v56
  v_sub_f32 v144, v144, v56
  v_sub_f32 v146, v146, v56
  v_mul_f32 v68, v132, v132
  v_fmac_f32 v68, v134, v134
  v_fmac_f32 v68, v136, v136
  v_fmac_f32 v68, v138, v138
  v_fmac_f32 v68, v140, v140
  v_fmac_f32 v68, v142, v142
  v_fmac_f32 v68, v144, v144
  v_fmac_f32 v68, v146, v146
  v_mul_f32 v60, 0x3a800000, v67
  v_fmac_f32 v60, 0x3e000000, v68
  v_cvt_pk_bf16_f32 v64, v56, v60
  v_lshlrev_b32 v56, 16, v64
  v_and_b32 v60, 0xffff0000, v64
  v_add_f32 v60, 0x3727c5ac, v60
  v_cvt_pk_bf16_f32 v64, v60, v61
  v_lshlrev_b32 v60, 16, v64
  v_and_b32 v61, 0xffff0000, v64
  v_sqrt_f32 v60, v60
  s_nop 0
  v_cvt_pk_bf16_f32 v64, v60, v61
  v_lshlrev_b32 v60, 16, v64
  v_and_b32 v61, 0xffff0000, v64
  v_rcp_f32 v60, v60
  v_mov_b32 v57, v56
  s_nop 0
  v_mov_b32 v61, v60
  s_barrier
  v_pk_add_f32 v[24:25], v[24:25], v[56:57] neg_lo:[0,1] neg_hi:[0,1]
  v_pk_add_f32 v[26:27], v[26:27], v[56:57] neg_lo:[0,1] neg_hi:[0,1]
  v_pk_add_f32 v[28:29], v[28:29], v[56:57] neg_lo:[0,1] neg_hi:[0,1]
  v_pk_add_f32 v[30:31], v[30:31], v[56:57] neg_lo:[0,1] neg_hi:[0,1]
  v_pk_add_f32 v[32:33], v[32:33], v[56:57] neg_lo:[0,1] neg_hi:[0,1]
  v_pk_add_f32 v[34:35], v[34:35], v[56:57] neg_lo:[0,1] neg_hi:[0,1]
  v_pk_add_f32 v[36:37], v[36:37], v[56:57] neg_lo:[0,1] neg_hi:[0,1]
  v_pk_add_f32 v[38:39], v[38:39], v[56:57] neg_lo:[0,1] neg_hi:[0,1]
  v_pk_add_f32 v[40:41], v[40:41], v[56:57] neg_lo:[0,1] neg_hi:[0,1]
  v_pk_add_f32 v[42:43], v[42:43], v[56:57] neg_lo:[0,1] neg_hi:[0,1]
  v_pk_add_f32 v[44:45], v[44:45], v[56:57] neg_lo:[0,1] neg_hi:[0,1]
  v_pk_add_f32 v[46:47], v[46:47], v[56:57] neg_lo:[0,1] neg_hi:[0,1]
  v_pk_add_f32 v[48:49], v[48:49], v[56:57] neg_lo:[0,1] neg_hi:[0,1]
  v_pk_add_f32 v[50:51], v[50:51], v[56:57] neg_lo:[0,1] neg_hi:[0,1]
  v_pk_add_f32 v[52:53], v[52:53], v[56:57] neg_lo:[0,1] neg_hi:[0,1]
  v_pk_add_f32 v[54:55], v[54:55], v[56:57] neg_lo:[0,1] neg_hi:[0,1]
  v_pk_mul_f32 v[24:25], v[24:25], v[60:61]
  v_pk_mul_f32 v[26:27], v[26:27], v[60:61]
  v_pk_mul_f32 v[28:29], v[28:29], v[60:61]
  v_pk_mul_f32 v[30:31], v[30:31], v[60:61]
  v_pk_mul_f32 v[32:33], v[32:33], v[60:61]
  v_pk_mul_f32 v[34:35], v[34:35], v[60:61]
  v_pk_mul_f32 v[36:37], v[36:37], v[60:61]
  v_pk_mul_f32 v[38:39], v[38:39], v[60:61]
  v_pk_mul_f32 v[40:41], v[40:41], v[60:61]
  v_pk_mul_f32 v[42:43], v[42:43], v[60:61]
  v_pk_mul_f32 v[44:45], v[44:45], v[60:61]
  v_pk_mul_f32 v[46:47], v[46:47], v[60:61]
  v_pk_mul_f32 v[48:49], v[48:49], v[60:61]
  v_pk_mul_f32 v[50:51], v[50:51], v[60:61]
  v_pk_mul_f32 v[52:53], v[52:53], v[60:61]
  v_pk_mul_f32 v[54:55], v[54:55], v[60:61]
  s_and_b32 s32, s2, 7
  s_lshr_b32 s34, s2, 3
  s_and_b32 s30, s32, 1
  s_lshl_b32 s30, s30, 3
  s_and_b32 s31, s34, 7
  s_add_u32 s30, s30, s31
  s_lshr_b32 s31, s32, 1
  s_lshl_b32 s31, s31, 2
  s_lshr_b32 s34, s34, 3
  s_add_u32 s31, s31, s34
  v_lshrrev_b32 v110, 3, v104
  v_and_b32 v111, 6, v110
  v_and_b32 v112, 7, v104
  v_xor_b32 v111, v111, v112
  s_movk_i32 s33, 6144
  v_mul_u32_u24 v110, s33, v110
  v_lshl_add_u32 v110, v111, 4, v110
  s_mul_i32 s32, s3, 49152
  s_lshl_b32 s33, s31, 7
  s_add_u32 s32, s32, s33
  v_add_u32 v107, s32, v110
  v_add_u32 v108, 1024, v107
  v_add_u32 v109, 2048, v107
  s_mul_i32 s38, s3, 3072
  s_lshl_b32 s39, s3, 8
  s_add_u32 s39, s39, 12288
  s_mov_b32 s16, 0
  s_mov_b32 s17, 0
  s_mov_b32 s19, 0
  s_mov_b32 s8, s98
  s_mov_b32 s9, s99
  s_mov_b32 s10, 0x600000
  s_mov_b32 s11, 0x20000
  s_cmp_ge_u32 s3, 4
  s_cbranch_scc1 L_sk_9
  s_add_u32 m0, s38, 0
  s_nop 0
  buffer_load_dwordx4 v107, s[8:11], s17 offen lds
  buffer_load_dwordx4 v108, s[8:11], s17 offen offset:1024 lds
  buffer_load_dwordx4 v109, s[8:11], s17 offen offset:2048 lds
  s_add_u32 s17, s17, 196608
  s_add_u32 m0, s38, 13312
  s_nop 0
  buffer_load_dwordx4 v107, s[8:11], s17 offen lds
  buffer_load_dwordx4 v108, s[8:11], s17 offen offset:1024 lds
  buffer_load_dwordx4 v109, s[8:11], s17 offen offset:2048 lds
  s_add_u32 s17, s17, 196608
  s_add_u32 m0, s38, 26624
  s_nop 0
  buffer_load_dwordx4 v107, s[8:11], s17 offen lds
  buffer_load_dwordx4 v108, s[8:11], s17 offen offset:1024 lds
  buffer_load_dwordx4 v109, s[8:11], s17 offen offset:2048 lds
  s_add_u32 s17, s17, 196608
L_sk_9:
  s_add_u32 s4, s20, 0x100000
  s_addc_u32 s5, s21, 0
  s_mov_b32 s6, 0x400000
  s_mov_b32 s7, 0x20000
  s_lshl_b32 s33, s30, 3
  s_lshl_b32 s35, s3, 1
  s_add_u32 s35, s35, s33
  s_lshl_b32 s35, s35, 3
  s_max_u32 s33, s33, 1
  s_sub_u32 s33, s33, 1
  s_lshl_b32 s33, s33, 3
  v_and_b32 v110, 7, v104
  v_add_u32 v110, s33, v110
  v_add_u32 v129, s35, v104
  v_cmp_lt_u32 vcc, 15, v104
  s_nop 1
  v_cndmask_b32 v129, v129, v110, vcc
  v_and_b32 v131, -8, v129
  v_lshlrev_b32 v129, 6, v129
  v_lshlrev_b32 v131, 6, v131
  s_lshl_b32 s32, s30, 13
  s_lshl_b32 s33, s3, 11
  s_add_u32 s32, s32, s33
  v_add_u32 v105, s32, v119
  s_lshl_b32 s32, s30, 3
  s_max_u32 s32, s32, 1
  s_sub_u32 s32, s32, 1
  s_lshl_b32 s32, s32, 10
  s_lshl_b32 s33, s3, 8
  s_add_u32 s32, s32, s33
  v_lshlrev_b32 v106, 2, v104
  v_add_u32 v106, s32, v106
  v_lshrrev_b32 v110, 5, v104
  v_mul_u32_u24 v110, 3072, v110
  v_bfe_u32 v111, v104, 2, 3
  v_lshl_add_u32 v110, v111, 7, v110
  v_bfe_u32 v111, v104, 3, 2
  v_lshl_add_u32 v110, v111, 5, v110
  v_and_b32 v111, 3, v104
  v_lshl_add_u32 v114, v111, 3, v110
  v_xor_b32 v115, 32, v114
  v_xor_b32 v116, 64, v114
  v_xor_b32 v117, 96, v114
  s_lshl_b32 s33, s3, 5
  v_xor_b32 v118, s33, v114
  v_and_b32 v110, 14, v104
  v_lshrrev_b32 v111, 4, v104
  v_lshlrev_b32 v111, 2, v111
  v_cmp_le_u32 s[44:45], v111, v110
  v_add_u32 v111, 2, v111
  v_cmp_le_u32 s[46:47], v111, v110
  v_and_b32 v110, 1, v104
  v_cmp_eq_u32 s[48:49], 1, v110
  s_bfe_u32 s40, s100, 0x80000
  s_bfe_u32 s41, s100, 0x80008
  s_bfe_u32 s42, s100, 0x80010
  s_bfe_u32 s43, s100, 0x80018
  s_mov_b32 s33, 262144
L_mod_10:
  buffer_load_dwordx4 v[72:75], v4, s[12:15], s22 offen sc1
  buffer_load_dwordx4 v[76:79], v4, s[12:15], s23 offen sc1
  buffer_load_dwordx4 v[80:83], v4, s[12:15], s24 offen sc1
  buffer_load_dwordx4 v[84:87], v4, s[12:15], s25 offen sc1
  s_waitcnt vmcnt(3)
  v_xor_b32 v72, s40, v72
  v_xor_b32 v73, s41, v73
  v_xor_b32 v74, s42, v74
  v_xor_b32 v75, s43, v75
  v_or3_b32 v66, v72, v73, v74
  v_or_b32 v66, v66, v75
  s_waitcnt vmcnt(2)
  v_xor_b32 v76, s40, v76
  v_xor_b32 v77, s41, v77
  v_xor_b32 v78, s42, v78
  v_xor_b32 v79, s43, v79
  v_or3_b32 v66, v66, v76, v77
  v_or3_b32 v66, v66, v78, v79
  s_waitcnt vmcnt(1)
  v_xor_b32 v80, s40, v80
  v_xor_b32 v81, s41, v81
  v_xor_b32 v82, s42, v82
  v_xor_b32 v83, s43, v83
  v_or3_b32 v66, v66, v80, v81
  v_or3_b32 v66, v66, v82, v83
  s_waitcnt vmcnt(0)
  v_xor_b32 v84, s40, v84
  v_xor_b32 v85, s41, v85
  v_xor_b32 v86, s42, v86
  v_xor_b32 v87, s43, v87
  v_or3_b32 v66, v66, v84, v85
  v_or3_b32 v66, v66, v86, v87
  v_and_b32 v66, 0xff, v66
  v_cmp_ne_u32 vcc, 0, v66
  s_nop 1
  s_cmp_eq_u64 vcc, 0
  s_cbranch_scc1 L_mok_11
  s_sub_u32 s33, s33, 1
  s_cmp_lg_u32 s33, 0
  s_cbranch_scc1 L_mod_10
L_mok_11:
  v_pk_add_f32 v[72:73], v[72:73], v[76:77]
  v_pk_add_f32 v[74:75], v[74:75], v[78:79]
  v_pk_add_f32 v[76:77], v[80:81], v[84:85]
  v_pk_add_f32 v[78:79], v[82:83], v[86:87]
  v_mov_b32 v80, v72
  v_mov_b32 v81, v73
  v_mov_b32 v82, v74
  v_mov_b32 v83, v75
  v_mov_b32 v84, v76
  v_mov_b32 v85, v77
  v_mov_b32 v86, v78
  v_mov_b32 v87, v79
  s_nop 1
  v_permlane32_swap_b32 v80, v72
  v_permlane32_swap_b32 v81, v73
  v_permlane32_swap_b32 v82, v74
  v_permlane32_swap_b32 v83, v75
  v_permlane32_swap_b32 v84, v76
  v_permlane32_swap_b32 v85, v77
  v_permlane32_swap_b32 v86, v78
  v_permlane32_swap_b32 v87, v79
  s_nop 1
  v_add_f32 v72, v72, v80
  v_add_f32 v73, v73, v81
  v_add_f32 v74, v74, v82
  v_add_f32 v75, v75, v83
  v_add_f32 v76, v76, v84
  v_add_f32 v77, v77, v85
  v_add_f32 v78, v78, v86
  v_add_f32 v79, v79, v87
  v_cvt_pk_bf16_f32 v80, v72, v73
  v_lshlrev_b32 v72, 16, v80
  v_and_b32 v73, 0xffff0000, v80
  v_cvt_pk_bf16_f32 v81, v74, v75
  v_lshlrev_b32 v74, 16, v81
  v_and_b32 v75, 0xffff0000, v81
  v_cvt_pk_bf16_f32 v82, v76, v77
  v_lshlrev_b32 v76, 16, v82
  v_and_b32 v77, 0xffff0000, v82
  v_cvt_pk_bf16_f32 v83, v78, v79
  v_lshlrev_b32 v78, 16, v83
  v_and_b32 v79, 0xffff0000, v83
  v_add_f32 v76, 1.0, v76
  v_add_f32 v77, 1.0, v77
  v_add_f32 v78, 1.0, v78
  v_add_f32 v79, 1.0, v79
  v_cvt_pk_bf16_f32 v80, v76, v77
  v_lshlrev_b32 v76, 16, v80
  v_and_b32 v77, 0xffff0000, v80
  v_cvt_pk_bf16_f32 v81, v78, v79
  v_lshlrev_b32 v78, 16, v81
  v_and_b32 v79, 0xffff0000, v81
  ds_write_b128 v5, v[72:75] offset:53248
  ds_write_b128 v5, v[76:79] offset:57344
  ds_read_b128 v[132:135], v3 offset:53248
  ds_read_b128 v[164:167], v3 offset:57344
  ds_read_b128 v[136:139], v3 offset:53264
  ds_read_b128 v[168:171], v3 offset:57360
  ds_read_b128 v[140:143], v3 offset:53376
  ds_read_b128 v[172:175], v3 offset:57472
  ds_read_b128 v[144:147], v3 offset:53392
  ds_read_b128 v[176:179], v3 offset:57488
  ds_read_b128 v[148:151], v3 offset:53504
  ds_read_b128 v[180:183], v3 offset:57600
  ds_read_b128 v[152:155], v3 offset:53520
  ds_read_b128 v[184:187], v3 offset:57616
  ds_read_b128 v[156:159], v3 offset:53632
  ds_read_b128 v[188:191], v3 offset:57728
  ds_read_b128 v[160:163], v3 offset:53648
  ds_read_b128 v[192:195], v3 offset:57744
  s_lshl_b32 s22, s3, 19
  s_lshl_b32 s33, s28, 10
  s_add_u32 s22, s22, s33
  s_add_u32 s23, s22, 131072
  s_add_u32 s24, s22, 262144
  s_add_u32 s25, s22, 393216
  s_waitcnt lgkmcnt(12)
  v_pk_fma_f32 v[24:25], v[24:25], v[164:165], v[132:133]
  v_pk_fma_f32 v[26:27], v[26:27], v[166:167], v[134:135]
  v_pk_fma_f32 v[28:29], v[28:29], v[168:169], v[136:137]
  v_pk_fma_f32 v[30:31], v[30:31], v[170:171], v[138:139]
  v_cvt_pk_bf16_f32 v8, v24, v25
  v_cvt_pk_bf16_f32 v9, v26, v27
  v_cvt_pk_bf16_f32 v10, v28, v29
  v_cvt_pk_bf16_f32 v11, v30, v31
  s_nop 1
  v_permlane16_swap_b32 v8, v10
  v_permlane16_swap_b32 v9, v11
  s_nop 1
  buffer_store_dwordx4 v[8:11], v119, s[4:7], s22 offen sc1
  s_waitcnt lgkmcnt(8)
  v_pk_fma_f32 v[32:33], v[32:33], v[172:173], v[140:141]
  v_pk_fma_f32 v[34:35], v[34:35], v[174:175], v[142:143]
  v_pk_fma_f32 v[36:37], v[36:37], v[176:177], v[144:145]
  v_pk_fma_f32 v[38:39], v[38:39], v[178:179], v[146:147]
  v_cvt_pk_bf16_f32 v12, v32, v33
  v_cvt_pk_bf16_f32 v13, v34, v35
  v_cvt_pk_bf16_f32 v14, v36, v37
  v_cvt_pk_bf16_f32 v15, v38, v39
  s_nop 1
  v_permlane16_swap_b32 v12, v14
  v_permlane16_swap_b32 v13, v15
  s_nop 1
  buffer_store_dwordx4 v[12:15], v119, s[4:7], s23 offen sc1
  s_waitcnt lgkmcnt(4)
  v_pk_fma_f32 v[40:41], v[40:41], v[180:181], v[148:149]
  v_pk_fma_f32 v[42:43], v[42:43], v[182:183], v[150:151]
  v_pk_fma_f32 v[44:45], v[44:45], v[184:185], v[152:153]
  v_pk_fma_f32 v[46:47], v[46:47], v[186:187], v[154:155]
  v_cvt_pk_bf16_f32 v16, v40, v41
  v_cvt_pk_bf16_f32 v17, v42, v43
  v_cvt_pk_bf16_f32 v18, v44, v45
  v_cvt_pk_bf16_f32 v19, v46, v47
  s_nop 1
  v_permlane16_swap_b32 v16, v18
  v_permlane16_swap_b32 v17, v19
  s_nop 1
  buffer_store_dwordx4 v[16:19], v119, s[4:7], s24 offen sc1
  s_waitcnt lgkmcnt(0)
  v_pk_fma_f32 v[48:49], v[48:49], v[188:189], v[156:157]
  v_pk_fma_f32 v[50:51], v[50:51], v[190:191], v[158:159]
  v_pk_fma_f32 v[52:53], v[52:53], v[192:193], v[160:161]
  v_pk_fma_f32 v[54:55], v[54:55], v[194:195], v[162:163]
  v_cvt_pk_bf16_f32 v20, v48, v49
  v_cvt_pk_bf16_f32 v21, v50, v51
  v_cvt_pk_bf16_f32 v22, v52, v53
  v_cvt_pk_bf16_f32 v23, v54, v55
  s_nop 1
  v_permlane16_swap_b32 v20, v22
  v_permlane16_swap_b32 v21, v23
  s_nop 1
  buffer_store_dwordx4 v[20:23], v119, s[4:7], s25 offen sc1
  v_mov_b32 v7, s100
  s_waitcnt vmcnt(0)
  s_mov_b64 exec, 1
  buffer_store_dword v7, v100, s[64:67], s36 offen sc1
  s_mov_b64 exec, -1
L_front_4:
  s_cmp_ge_u32 s3, 4
  s_cbranch_scc1 L_helper_2
  s_branch L_slow_12
L_back_13:
  s_add_u32 m0, s39, 0
  s_nop 0
  buffer_load_dword v106, s[4:7], s19 offen sc1 lds
  s_add_u32 s19, s19, 131072
  buffer_load_dwordx4 v[212:215], v105, s[4:7], s16 offen sc1
  buffer_load_dwordx4 v[216:219], v105, s[4:7], s16 offen offset:1024 sc1
  s_add_u32 s16, s16, 131072
  s_add_u32 m0, s39, 13312
  s_nop 0
  buffer_load_dword v106, s[4:7], s19 offen sc1 lds
  s_add_u32 s19, s19, 131072
  buffer_load_dwordx4 v[220:223], v105, s[4:7], s16 offen sc1
  buffer_load_dwordx4 v[224:227], v105, s[4:7], s16 offen offset:1024 sc1
  s_add_u32 s16, s16, 131072
  s_add_u32 m0, s39, 26624
  s_nop 0
  buffer_load_dword v106, s[4:7], s19 offen sc1 lds
  s_add_u32 s19, s19, 131072
  s_waitcnt vmcnt(6)
  s_barrier
  ds_read_b64_tr_b16 v[180:181], v118 offset:1024
  ds_read_b64_tr_b16 v[182:183], v118 offset:7168
  ds_read_b128 v[188:191], v119 offset:12288
  ds_read_b64_tr_b16 v[184:185], v118 offset:2048
  ds_read_b64_tr_b16 v[186:187], v118 offset:8192
  ds_read_b64_tr_b16 v[132:133], v114 offset:0
  ds_read_b64_tr_b16 v[134:135], v114 offset:6144
  ds_read_b64_tr_b16 v[136:137], v115 offset:0
  ds_read_b64_tr_b16 v[138:139], v115 offset:6144
  ds_read_b64_tr_b16 v[140:141], v116 offset:0
  ds_read_b64_tr_b16 v[142:143], v116 offset:6144
  ds_read_b64_tr_b16 v[144:145], v117 offset:0
  ds_read_b64_tr_b16 v[146:147], v117 offset:6144
  ds_read_b64_tr_b16 v[148:149], v114 offset:1024
  ds_read_b64_tr_b16 v[150:151], v114 offset:7168
  ds_read_b64_tr_b16 v[152:153], v115 offset:1024
  ds_read_b64_tr_b16 v[154:155], v115 offset:7168
  ds_read_b64_tr_b16 v[156:157], v116 offset:1024
  ds_read_b64_tr_b16 v[158:159], v116 offset:7168
  ds_read_b64_tr_b16 v[160:161], v117 offset:1024
  ds_read_b64_tr_b16 v[162:163], v117 offset:7168
  ds_read_b64_tr_b16 v[164:165], v114 offset:2048
  ds_read_b64_tr_b16 v[166:167], v114 offset:8192
  ds_read_b64_tr_b16 v[168:169], v115 offset:2048
  ds_read_b64_tr_b16 v[170:171], v115 offset:8192
  ds_read_b64_tr_b16 v[172:173], v116 offset:2048
  ds_read_b64_tr_b16 v[174:175], v116 offset:8192
  ds_read_b64_tr_b16 v[176:177], v117 offset:2048
  ds_read_b64_tr_b16 v[178:179], v117 offset:8192
  s_waitcnt vmcnt(3) lgkmcnt(10)
  s_barrier
  buffer_load_dwordx4 v[228:231], v105, s[4:7], s16 offen sc1
  v_mfma_f32_16x16x32_bf16 v[96:99], v[180:183], v[188:191], 0
  ds_read_b64_tr_b16 v[180:181], v118 offset:14336
  v_mfma_f32_16x16x32_bf16 v[100:103], v[188:191], v[184:187], 0
  ds_read_b64_tr_b16 v[182:183], v118 offset:20480
  ds_read_b128 v[188:191], v119 offset:25600
  ds_read_b64_tr_b16 v[184:185], v118 offset:15360
  v_mfma_f32_16x16x32_bf16 v[0:3], v[132:135], v[212:215], 0
  ds_read_b64_tr_b16 v[186:187], v118 offset:21504
  buffer_load_dwordx4 v[232:235], v105, s[4:7], s16 offen offset:1024 sc1
  s_add_u32 s16, s16, 131072
  v_mfma_f32_16x16x32_bf16 v[48:51], v[132:135], v[216:219], 0
  ds_read_b64_tr_b16 v[132:133], v114 offset:13312
  buffer_load_dword v130, v129, s[64:67], 0 offen sc1
  v_mfma_f32_16x16x32_bf16 v[4:7], v[136:139], v[212:215], 0
  ds_read_b64_tr_b16 v[134:135], v114 offset:19456
  v_mfma_f32_16x16x32_bf16 v[52:55], v[136:139], v[216:219], 0
  ds_read_b64_tr_b16 v[136:137], v115 offset:13312
  s_add_u32 m0, s38, 39936
  s_nop 0
  buffer_load_dwordx4 v107, s[8:11], s17 offen lds
  v_mfma_f32_16x16x32_bf16 v[8:11], v[140:143], v[212:215], 0
  ds_read_b64_tr_b16 v[138:139], v115 offset:19456
  v_mfma_f32_16x16x32_bf16 v[56:59], v[140:143], v[216:219], 0
  ds_read_b64_tr_b16 v[140:141], v116 offset:13312
  v_mfma_f32_16x16x32_bf16 v[12:15], v[144:147], v[212:215], 0
  ds_read_b64_tr_b16 v[142:143], v116 offset:19456
  buffer_load_dwordx4 v108, s[8:11], s17 offen offset:1024 lds
  v_mfma_f32_16x16x32_bf16 v[60:63], v[144:147], v[216:219], 0
  ds_read_b64_tr_b16 v[144:145], v117 offset:13312
  v_mfma_f32_16x16x32_bf16 v[16:19], v[148:151], v[212:215], 0
  ds_read_b64_tr_b16 v[146:147], v117 offset:19456
  v_mfma_f32_16x16x32_bf16 v[64:67], v[148:151], v[216:219], 0
  ds_read_b64_tr_b16 v[148:149], v114 offset:14336
  v_mfma_f32_16x16x32_bf16 v[20:23], v[152:155], v[212:215], 0
  ds_read_b64_tr_b16 v[150:151], v114 offset:20480
  buffer_load_dwordx4 v109, s[8:11], s17 offen offset:2048 lds
  s_add_u32 s17, s17, 196608
  v_mfma_f32_16x16x32_bf16 v[68:71], v[152:155], v[216:219], 0
  ds_read_b64_tr_b16 v[152:153], v115 offset:14336
  v_mfma_f32_16x16x32_bf16 v[24:27], v[156:159], v[212:215], 0
  ds_read_b64_tr_b16 v[154:155], v115 offset:20480
  v_mfma_f32_16x16x32_bf16 v[72:75], v[156:159], v[216:219], 0
  ds_read_b64_tr_b16 v[156:157], v116 offset:14336
  s_add_u32 m0, s39, 39936
  s_nop 0
  buffer_load_dword v106, s[4:7], s19 offen sc1 lds
  s_add_u32 s19, s19, 131072
  s_waitcnt lgkmcnt(10)
  v_mfma_f32_16x16x32_bf16 v[28:31], v[160:163], v[212:215], 0
  ds_read_b64_tr_b16 v[158:159], v116 offset:20480
  v_mfma_f32_16x16x32_bf16 v[76:79], v[160:163], v[216:219], 0
  ds_read_b64_tr_b16 v[160:161], v117 offset:14336
  v_mfma_f32_16x16x32_bf16 v[32:35], v[212:215], v[164:167], 0
  ds_read_b64_tr_b16 v[162:163], v117 offset:20480
  buffer_load_dwordx4 v[236:239], v105, s[4:7], s16 offen sc1
  v_mfma_f32_16x16x32_bf16 v[80:83], v[216:219], v[164:167], 0
  ds_read_b64_tr_b16 v[164:165], v114 offset:15360
  v_mfma_f32_16x16x32_bf16 v[36:39], v[212:215], v[168:171], 0
  ds_read_b64_tr_b16 v[166:167], v114 offset:21504
  v_mfma_f32_16x16x32_bf16 v[84:87], v[216:219], v[168:171], 0
  ds_read_b64_tr_b16 v[168:169], v115 offset:15360
  buffer_load_dwordx4 v[240:243], v105, s[4:7], s16 offen offset:1024 sc1
  s_add_u32 s16, s16, 131072
  v_mfma_f32_16x16x32_bf16 v[40:43], v[212:215], v[172:175], 0
  ds_read_b64_tr_b16 v[170:171], v115 offset:21504
  v_mfma_f32_16x16x32_bf16 v[88:91], v[216:219], v[172:175], 0
  ds_read_b64_tr_b16 v[172:173], v116 offset:15360
  v_mfma_f32_16x16x32_bf16 v[44:47], v[212:215], v[176:179], 0
  ds_read_b64_tr_b16 v[174:175], v116 offset:21504
  v_mfma_f32_16x16x32_bf16 v[92:95], v[216:219], v[176:179], 0
  ds_read_b64_tr_b16 v[176:177], v117 offset:15360
  ds_read_b64_tr_b16 v[178:179], v117 offset:21504
  s_waitcnt vmcnt(6) lgkmcnt(10)
  s_barrier
  v_cmp_ne_u32 vcc, s100, v130
  s_nop 1
  s_cmp_lg_u64 vcc, 0
  s_cbranch_scc1 L_slow_14
  L_back_15:
  s_add_u32 m0, s38, 0
  s_nop 0
  buffer_load_dwordx4 v107, s[8:11], s17 offen lds
  v_mfma_f32_16x16x32_bf16 v[96:99], v[180:183], v[188:191], v[96:99]
  ds_read_b64_tr_b16 v[180:181], v118 offset:27648
  v_mfma_f32_16x16x32_bf16 v[100:103], v[188:191], v[184:187], v[100:103]
  ds_read_b64_tr_b16 v[182:183], v118 offset:33792
  ds_read_b128 v[188:191], v119 offset:38912
  ds_read_b64_tr_b16 v[184:185], v118 offset:28672
  v_mfma_f32_16x16x32_bf16 v[0:3], v[132:135], v[220:223], v[0:3]
  ds_read_b64_tr_b16 v[186:187], v118 offset:34816
  v_mfma_f32_16x16x32_bf16 v[48:51], v[132:135], v[224:227], v[48:51]
  ds_read_b64_tr_b16 v[132:133], v114 offset:26624
  buffer_load_dwordx4 v108, s[8:11], s17 offen offset:1024 lds
  v_mfma_f32_16x16x32_bf16 v[4:7], v[136:139], v[220:223], v[4:7]
  ds_read_b64_tr_b16 v[134:135], v114 offset:32768
  v_mfma_f32_16x16x32_bf16 v[52:55], v[136:139], v[224:227], v[52:55]
  ds_read_b64_tr_b16 v[136:137], v115 offset:26624
  v_mfma_f32_16x16x32_bf16 v[8:11], v[140:143], v[220:223], v[8:11]
  ds_read_b64_tr_b16 v[138:139], v115 offset:32768
  v_mfma_f32_16x16x32_bf16 v[56:59], v[140:143], v[224:227], v[56:59]
  ds_read_b64_tr_b16 v[140:141], v116 offset:26624
  buffer_load_dwordx4 v109, s[8:11], s17 offen offset:2048 lds
  s_add_u32 s17, s17, 196608
  v_mfma_f32_16x16x32_bf16 v[12:15], v[144:147], v[220:223], v[12:15]
  ds_read_b64_tr_b16 v[142:143], v116 offset:32768
  v_mfma_f32_16x16x32_bf16 v[60:63], v[144:147], v[224:227], v[60:63]
  ds_read_b64_tr_b16 v[144:145], v117 offset:26624
  v_mfma_f32_16x16x32_bf16 v[16:19], v[148:151], v[220:223], v[16:19]
  ds_read_b64_tr_b16 v[146:147], v117 offset:32768
  v_mfma_f32_16x16x32_bf16 v[64:67], v[148:151], v[224:227], v[64:67]
  ds_read_b64_tr_b16 v[148:149], v114 offset:27648
  v_mfma_f32_16x16x32_bf16 v[20:23], v[152:155], v[220:223], v[20:23]
  ds_read_b64_tr_b16 v[150:151], v114 offset:33792
  s_add_u32 m0, s39, 0
  s_nop 0
  buffer_load_dword v106, s[4:7], s19 offen sc1 lds
  s_add_u32 s19, s19, 131072
  v_mfma_f32_16x16x32_bf16 v[68:71], v[152:155], v[224:227], v[68:71]
  ds_read_b64_tr_b16 v[152:153], v115 offset:27648
  v_mfma_f32_16x16x32_bf16 v[24:27], v[156:159], v[220:223], v[24:27]
  ds_read_b64_tr_b16 v[154:155], v115 offset:33792
  v_mfma_f32_16x16x32_bf16 v[72:75], v[156:159], v[224:227], v[72:75]
  ds_read_b64_tr_b16 v[156:157], v116 offset:27648
  s_waitcnt lgkmcnt(10)
  v_mfma_f32_16x16x32_bf16 v[28:31], v[160:163], v[220:223], v[28:31]
  ds_read_b64_tr_b16 v[158:159], v116 offset:33792
  buffer_load_dwordx4 v[212:215], v105, s[4:7], s16 offen sc1
  v_mfma_f32_16x16x32_bf16 v[76:79], v[160:163], v[224:227], v[76:79]
  ds_read_b64_tr_b16 v[160:161], v117 offset:27648
  v_mfma_f32_16x16x32_bf16 v[32:35], v[220:223], v[164:167], v[32:35]
  ds_read_b64_tr_b16 v[162:163], v117 offset:33792
  v_mfma_f32_16x16x32_bf16 v[80:83], v[224:227], v[164:167], v[80:83]
  ds_read_b64_tr_b16 v[164:165], v114 offset:28672
  v_mfma_f32_16x16x32_bf16 v[36:39], v[220:223], v[168:171], v[36:39]
  ds_read_b64_tr_b16 v[166:167], v114 offset:34816
  buffer_load_dwordx4 v[216:219], v105, s[4:7], s16 offen offset:1024 sc1
  s_add_u32 s16, s16, 131072
  v_mfma_f32_16x16x32_bf16 v[84:87], v[224:227], v[168:171], v[84:87]
  ds_read_b64_tr_b16 v[168:169], v115 offset:28672
  v_mfma_f32_16x16x32_bf16 v[40:43], v[220:223], v[172:175], v[40:43]
  ds_read_b64_tr_b16 v[170:171], v115 offset:34816
  v_mfma_f32_16x16x32_bf16 v[88:91], v[224:227], v[172:175], v[88:91]
  ds_read_b64_tr_b16 v[172:173], v116 offset:28672
  v_mfma_f32_16x16x32_bf16 v[44:47], v[220:223], v[176:179], v[44:47]
  ds_read_b64_tr_b16 v[174:175], v116 offset:34816
  v_mfma_f32_16x16x32_bf16 v[92:95], v[224:227], v[176:179], v[92:95]
  ds_read_b64_tr_b16 v[176:177], v117 offset:28672
  ds_read_b64_tr_b16 v[178:179], v117 offset:34816
  s_mov_b32 s18, 6
  .p2align 6
L_loop_17:
  s_waitcnt vmcnt(8) lgkmcnt(10)
  s_barrier
  s_add_u32 m0, s38, 13312
  s_nop 0
  buffer_load_dwordx4 v107, s[8:11], s17 offen lds
  v_mfma_f32_16x16x32_bf16 v[96:99], v[180:183], v[188:191], v[96:99]
  ds_read_b64_tr_b16 v[180:181], v118 offset:40960
  v_mfma_f32_16x16x32_bf16 v[100:103], v[188:191], v[184:187], v[100:103]
  ds_read_b64_tr_b16 v[182:183], v118 offset:47104
  ds_read_b128 v[188:191], v119 offset:52224
  ds_read_b64_tr_b16 v[184:185], v118 offset:41984
  v_mfma_f32_16x16x32_bf16 v[0:3], v[132:135], v[228:231], v[0:3]
  ds_read_b64_tr_b16 v[186:187], v118 offset:48128
  v_mfma_f32_16x16x32_bf16 v[48:51], v[132:135], v[232:235], v[48:51]
  ds_read_b64_tr_b16 v[132:133], v114 offset:39936
  buffer_load_dwordx4 v108, s[8:11], s17 offen offset:1024 lds
  v_mfma_f32_16x16x32_bf16 v[4:7], v[136:139], v[228:231], v[4:7]
  ds_read_b64_tr_b16 v[134:135], v114 offset:46080
  v_mfma_f32_16x16x32_bf16 v[52:55], v[136:139], v[232:235], v[52:55]
  ds_read_b64_tr_b16 v[136:137], v115 offset:39936
  v_mfma_f32_16x16x32_bf16 v[8:11], v[140:143], v[228:231], v[8:11]
  ds_read_b64_tr_b16 v[138:139], v115 offset:46080
  v_mfma_f32_16x16x32_bf16 v[56:59], v[140:143], v[232:235], v[56:59]
  ds_read_b64_tr_b16 v[140:141], v116 offset:39936
  buffer_load_dwordx4 v109, s[8:11], s17 offen offset:2048 lds
  s_add_u32 s17, s17, 196608
  v_mfma_f32_16x16x32_bf16 v[12:15], v[144:147], v[228:231], v[12:15]
  ds_read_b64_tr_b16 v[142:143], v116 offset:46080
  v_mfma_f32_16x16x32_bf16 v[60:63], v[144:147], v[232:235], v[60:63]
  ds_read_b64_tr_b16 v[144:145], v117 offset:39936
  v_mfma_f32_16x16x32_bf16 v[16:19], v[148:151], v[228:231], v[16:19]
  ds_read_b64_tr_b16 v[146:147], v117 offset:46080
  v_mfma_f32_16x16x32_bf16 v[64:67], v[148:151], v[232:235], v[64:67]
  ds_read_b64_tr_b16 v[148:149], v114 offset:40960
  v_mfma_f32_16x16x32_bf16 v[20:23], v[152:155], v[228:231], v[20:23]
  ds_read_b64_tr_b16 v[150:151], v114 offset:47104
  s_add_u32 m0, s39, 13312
  s_nop 0
  buffer_load_dword v106, s[4:7], s19 offen sc1 lds
  s_add_u32 s19, s19, 131072
  v_mfma_f32_16x16x32_bf16 v[68:71], v[152:155], v[232:235], v[68:71]
  ds_read_b64_tr_b16 v[152:153], v115 offset:40960
  v_mfma_f32_16x16x32_bf16 v[24:27], v[156:159], v[228:231], v[24:27]
  ds_read_b64_tr_b16 v[154:155], v115 offset:47104
  v_mfma_f32_16x16x32_bf16 v[72:75], v[156:159], v[232:235], v[72:75]
  ds_read_b64_tr_b16 v[156:157], v116 offset:40960
  s_waitcnt lgkmcnt(10)
  v_mfma_f32_16x16x32_bf16 v[28:31], v[160:163], v[228:231], v[28:31]
  ds_read_b64_tr_b16 v[158:159], v116 offset:47104
  buffer_load_dwordx4 v[220:223], v105, s[4:7], s16 offen sc1
  v_mfma_f32_16x16x32_bf16 v[76:79], v[160:163], v[232:235], v[76:79]
  ds_read_b64_tr_b16 v[160:161], v117 offset:40960
  v_mfma_f32_16x16x32_bf16 v[32:35], v[228:231], v[164:167], v[32:35]
  ds_read_b64_tr_b16 v[162:163], v117 offset:47104
  v_mfma_f32_16x16x32_bf16 v[80:83], v[232:235], v[164:167], v[80:83]
  ds_read_b64_tr_b16 v[164:165], v114 offset:41984
  v_mfma_f32_16x16x32_bf16 v[36:39], v[228:231], v[168:171], v[36:39]
  ds_read_b64_tr_b16 v[166:167], v114 offset:48128
  buffer_load_dwordx4 v[224:227], v105, s[4:7], s16 offen offset:1024 sc1
  s_add_u32 s16, s16, 131072
  v_mfma_f32_16x16x32_bf16 v[84:87], v[232:235], v[168:171], v[84:87]
  ds_read_b64_tr_b16 v[168:169], v115 offset:41984
  v_mfma_f32_16x16x32_bf16 v[40:43], v[228:231], v[172:175], v[40:43]
  ds_read_b64_tr_b16 v[170:171], v115 offset:48128
  v_mfma_f32_16x16x32_bf16 v[88:91], v[232:235], v[172:175], v[88:91]
  ds_read_b64_tr_b16 v[172:173], v116 offset:41984
  v_mfma_f32_16x16x32_bf16 v[44:47], v[228:231], v[176:179], v[44:47]
  ds_read_b64_tr_b16 v[174:175], v116 offset:48128
  v_mfma_f32_16x16x32_bf16 v[92:95], v[232:235], v[176:179], v[92:95]
  ds_read_b64_tr_b16 v[176:177], v117 offset:41984
  ds_read_b64_tr_b16 v[178:179], v117 offset:48128
  s_waitcnt vmcnt(8) lgkmcnt(10)
  s_barrier
  s_add_u32 m0, s38, 26624
  s_nop 0
  buffer_load_dwordx4 v107, s[8:11], s17 offen lds
  v_mfma_f32_16x16x32_bf16 v[96:99], v[180:183], v[188:191], v[96:99]
  ds_read_b64_tr_b16 v[180:181], v118 offset:1024
  v_mfma_f32_16x16x32_bf16 v[100:103], v[188:191], v[184:187], v[100:103]
  ds_read_b64_tr_b16 v[182:183], v118 offset:7168
  ds_read_b128 v[188:191], v119 offset:12288
  ds_read_b64_tr_b16 v[184:185], v118 offset:2048
  v_mfma_f32_16x16x32_bf16 v[0:3], v[132:135], v[236:239], v[0:3]
  ds_read_b64_tr_b16 v[186:187], v118 offset:8192
  v_mfma_f32_16x16x32_bf16 v[48:51], v[132:135], v[240:243], v[48:51]
  ds_read_b64_tr_b16 v[132:133], v114 offset:0
  buffer_load_dwordx4 v108, s[8:11], s17 offen offset:1024 lds
  v_mfma_f32_16x16x32_bf16 v[4:7], v[136:139], v[236:239], v[4:7]
  ds_read_b64_tr_b16 v[134:135], v114 offset:6144
  v_mfma_f32_16x16x32_bf16 v[52:55], v[136:139], v[240:243], v[52:55]
  ds_read_b64_tr_b16 v[136:137], v115 offset:0
  v_mfma_f32_16x16x32_bf16 v[8:11], v[140:143], v[236:239], v[8:11]
  ds_read_b64_tr_b16 v[138:139], v115 offset:6144
  v_mfma_f32_16x16x32_bf16 v[56:59], v[140:143], v[240:243], v[56:59]
  ds_read_b64_tr_b16 v[140:141], v116 offset:0
  buffer_load_dwordx4 v109, s[8:11], s17 offen offset:2048 lds
  s_add_u32 s17, s17, 196608
  v_mfma_f32_16x16x32_bf16 v[12:15], v[144:147], v[236:239], v[12:15]
  ds_read_b64_tr_b16 v[142:143], v116 offset:6144
  v_mfma_f32_16x16x32_bf16 v[60:63], v[144:147], v[240:243], v[60:63]
  ds_read_b64_tr_b16 v[144:145], v117 offset:0
  v_mfma_f32_16x16x32_bf16 v[16:19], v[148:151], v[236:239], v[16:19]
  ds_read_b64_tr_b16 v[146:147], v117 offset:6144
  v_mfma_f32_16x16x32_bf16 v[64:67], v[148:151], v[240:243], v[64:67]
  ds_read_b64_tr_b16 v[148:149], v114 offset:1024
  v_mfma_f32_16x16x32_bf16 v[20:23], v[152:155], v[236:239], v[20:23]
  ds_read_b64_tr_b16 v[150:151], v114 offset:7168
  s_add_u32 m0, s39, 26624
  s_nop 0
  buffer_load_dword v106, s[4:7], s19 offen sc1 lds
  s_add_u32 s19, s19, 131072
  v_mfma_f32_16x16x32_bf16 v[68:71], v[152:155], v[240:243], v[68:71]
  ds_read_b64_tr_b16 v[152:153], v115 offset:1024
  v_mfma_f32_16x16x32_bf16 v[24:27], v[156:159], v[236:239], v[24:27]
  ds_read_b64_tr_b16 v[154:155], v115 offset:7168
  v_mfma_f32_16x16x32_bf16 v[72:75], v[156:159], v[240:243], v[72:75]
  ds_read_b64_tr_b16 v[156:157], v116 offset:1024
  s_waitcnt lgkmcnt(10)
  v_mfma_f32_16x16x32_bf16 v[28:31], v[160:163], v[236:239], v[28:31]
  ds_read_b64_tr_b16 v[158:159], v116 offset:7168
  buffer_load_dwordx4 v[228:231], v105, s[4:7], s16 offen sc1
  v_mfma_f32_16x16x32_bf16 v[76:79], v[160:163], v[240:243], v[76:79]
  ds_read_b64_tr_b16 v[160:161], v117 offset:1024
  v_mfma_f32_16x16x32_bf16 v[32:35], v[236:239], v[164:167], v[32:35]
  ds_read_b64_tr_b16 v[162:163], v117 offset:7168
  v_mfma_f32_16x16x32_bf16 v[80:83], v[240:243], v[164:167], v[80:83]
  ds_read_b64_tr_b16 v[164:165], v114 offset:2048
  v_mfma_f32_16x16x32_bf16 v[36:39], v[236:239], v[168:171], v[36:39]
  ds_read_b64_tr_b16 v[166:167], v114 offset:8192
  buffer_load_dwordx4 v[232:235], v105, s[4:7], s16 offen offset:1024 sc1
  s_add_u32 s16, s16, 131072
  v_mfma_f32_16x16x32_bf16 v[84:87], v[240:243], v[168:171], v[84:87]
  ds_read_b64_tr_b16 v[168:169], v115 offset:2048
  v_mfma_f32_16x16x32_bf16 v[40:43], v[236:239], v[172:175], v[40:43]
  ds_read_b64_tr_b16 v[170:171], v115 offset:8192
  v_mfma_f32_16x16x32_bf16 v[88:91], v[240:243], v[172:175], v[88:91]
  ds_read_b64_tr_b16 v[172:173], v116 offset:2048
  v_mfma_f32_16x16x32_bf16 v[44:47], v[236:239], v[176:179], v[44:47]
  ds_read_b64_tr_b16 v[174:175], v116 offset:8192
  v_mfma_f32_16x16x32_bf16 v[92:95], v[240:243], v[176:179], v[92:95]
  ds_read_b64_tr_b16 v[176:177], v117 offset:2048
  ds_read_b64_tr_b16 v[178:179], v117 offset:8192
  s_waitcnt vmcnt(8) lgkmcnt(10)
  s_barrier
  s_add_u32 m0, s38, 39936
  s_nop 0
  buffer_load_dwordx4 v107, s[8:11], s17 offen lds
  v_mfma_f32_16x16x32_bf16 v[96:99], v[180:183], v[188:191], v[96:99]
  ds_read_b64_tr_b16 v[180:181], v118 offset:14336
  v_mfma_f32_16x16x32_bf16 v[100:103], v[188:191], v[184:187], v[100:103]
  ds_read_b64_tr_b16 v[182:183], v118 offset:20480
  ds_read_b128 v[188:191], v119 offset:25600
  ds_read_b64_tr_b16 v[184:185], v118 offset:15360
  v_mfma_f32_16x16x32_bf16 v[0:3], v[132:135], v[212:215], v[0:3]
  ds_read_b64_tr_b16 v[186:187], v118 offset:21504
  v_mfma_f32_16x16x32_bf16 v[48:51], v[132:135], v[216:219], v[48:51]
  ds_read_b64_tr_b16 v[132:133], v114 offset:13312
  buffer_load_dwordx4 v108, s[8:11], s17 offen offset:1024 lds
  v_mfma_f32_16x16x32_bf16 v[4:7], v[136:139], v[212:215], v[4:7]
  ds_read_b64_tr_b16 v[134:135], v114 offset:19456
  v_mfma_f32_16x16x32_bf16 v[52:55], v[136:139], v[216:219], v[52:55]
  ds_read_b64_tr_b16 v[136:137], v115 offset:13312
  v_mfma_f32_16x16x32_bf16 v[8:11], v[140:143], v[212:215], v[8:11]
  ds_read_b64_tr_b16 v[138:139], v115 offset:19456
  v_mfma_f32_16x16x32_bf16 v[56:59], v[140:143], v[216:219], v[56:59]
  ds_read_b64_tr_b16 v[140:141], v116 offset:13312
  buffer_load_dwordx4 v109, s[8:11], s17 offen offset:2048 lds
  s_add_u32 s17, s17, 196608
  v_mfma_f32_16x16x32_bf16 v[12:15], v[144:147], v[212:215], v[12:15]
  ds_read_b64_tr_b16 v[142:143], v116 offset:19456
  v_mfma_f32_16x16x32_bf16 v[60:63], v[144:147], v[216:219], v[60:63]
  ds_read_b64_tr_b16 v[144:145], v117 offset:13312
  v_mfma_f32_16x16x32_bf16 v[16:19], v[148:151], v[212:215], v[16:19]
  ds_read_b64_tr_b16 v[146:147], v117 offset:19456
  v_mfma_f32_16x16x32_bf16 v[64:67], v[148:151], v[216:219], v[64:67]
  ds_read_b64_tr_b16 v[148:149], v114 offset:14336
  v_mfma_f32_16x16x32_bf16 v[20:23], v[152:155], v[212:215], v[20:23]
  ds_read_b64_tr_b16 v[150:151], v114 offset:20480
  s_add_u32 m0, s39, 39936
  s_nop 0
  buffer_load_dword v106, s[4:7], s19 offen sc1 lds
  s_add_u32 s19, s19, 131072
  v_mfma_f32_16x16x32_bf16 v[68:71], v[152:155], v[216:219], v[68:71]
  ds_read_b64_tr_b16 v[152:153], v115 offset:14336
  v_mfma_f32_16x16x32_bf16 v[24:27], v[156:159], v[212:215], v[24:27]
  ds_read_b64_tr_b16 v[154:155], v115 offset:20480
  v_mfma_f32_16x16x32_bf16 v[72:75], v[156:159], v[216:219], v[72:75]
  ds_read_b64_tr_b16 v[156:157], v116 offset:14336
  s_waitcnt lgkmcnt(10)
  v_mfma_f32_16x16x32_bf16 v[28:31], v[160:163], v[212:215], v[28:31]
  ds_read_b64_tr_b16 v[158:159], v116 offset:20480
  buffer_load_dwordx4 v[236:239], v105, s[4:7], s16 offen sc1
  v_mfma_f32_16x16x32_bf16 v[76:79], v[160:163], v[216:219], v[76:79]
  ds_read_b64_tr_b16 v[160:161], v117 offset:14336
  v_mfma_f32_16x16x32_bf16 v[32:35], v[212:215], v[164:167], v[32:35]
  ds_read_b64_tr_b16 v[162:163], v117 offset:20480
  v_mfma_f32_16x16x32_bf16 v[80:83], v[216:219], v[164:167], v[80:83]
  ds_read_b64_tr_b16 v[164:165], v114 offset:15360
  v_mfma_f32_16x16x32_bf16 v[36:39], v[212:215], v[168:171], v[36:39]
  ds_read_b64_tr_b16 v[166:167], v114 offset:21504
  buffer_load_dwordx4 v[240:243], v105, s[4:7], s16 offen offset:1024 sc1
  s_add_u32 s16, s16, 131072
  v_mfma_f32_16x16x32_bf16 v[84:87], v[216:219], v[168:171], v[84:87]
  ds_read_b64_tr_b16 v[168:169], v115 offset:15360
  v_mfma_f32_16x16x32_bf16 v[40:43], v[212:215], v[172:175], v[40:43]
  ds_read_b64_tr_b16 v[170:171], v115 offset:21504
  v_mfma_f32_16x16x32_bf16 v[88:91], v[216:219], v[172:175], v[88:91]
  ds_read_b64_tr_b16 v[172:173], v116 offset:15360
  v_mfma_f32_16x16x32_bf16 v[44:47], v[212:215], v[176:179], v[44:47]
  ds_read_b64_tr_b16 v[174:175], v116 offset:21504
  v_mfma_f32_16x16x32_bf16 v[92:95], v[216:219], v[176:179], v[92:95]
  ds_read_b64_tr_b16 v[176:177], v117 offset:15360
  ds_read_b64_tr_b16 v[178:179], v117 offset:21504
  s_waitcnt vmcnt(8) lgkmcnt(10)
  s_barrier
  s_add_u32 m0, s38, 0
  s_nop 0
  buffer_load_dwordx4 v107, s[8:11], s17 offen lds
  v_mfma_f32_16x16x32_bf16 v[96:99], v[180:183], v[188:191], v[96:99]
  ds_read_b64_tr_b16 v[180:181], v118 offset:27648
  v_mfma_f32_16x16x32_bf16 v[100:103], v[188:191], v[184:187], v[100:103]
  ds_read_b64_tr_b16 v[182:183], v118 offset:33792
  ds_read_b128 v[188:191], v119 offset:38912
  ds_read_b64_tr_b16 v[184:185], v118 offset:28672
  v_mfma_f32_16x16x32_bf16 v[0:3], v[132:135], v[220:223], v[0:3]
  ds_read_b64_tr_b16 v[186:187], v118 offset:34816
  v_mfma_f32_16x16x32_bf16 v[48:51], v[132:135], v[224:227], v[48:51]
  ds_read_b64_tr_b16 v[132:133], v114 offset:26624
  buffer_load_dwordx4 v108, s[8:11], s17 offen offset:1024 lds
  v_mfma_f32_16x16x32_bf16 v[4:7], v[136:139], v[220:223], v[4:7]
  ds_read_b64_tr_b16 v[134:135], v114 offset:32768
  v_mfma_f32_16x16x32_bf16 v[52:55], v[136:139], v[224:227], v[52:55]
  ds_read_b64_tr_b16 v[136:137], v115 offset:26624
  v_mfma_f32_16x16x32_bf16 v[8:11], v[140:143], v[220:223], v[8:11]
  ds_read_b64_tr_b16 v[138:139], v115 offset:32768
  v_mfma_f32_16x16x32_bf16 v[56:59], v[140:143], v[224:227], v[56:59]
  ds_read_b64_tr_b16 v[140:141], v116 offset:26624
  buffer_load_dwordx4 v109, s[8:11], s17 offen offset:2048 lds
  s_add_u32 s17, s17, 196608
  v_mfma_f32_16x16x32_bf16 v[12:15], v[144:147], v[220:223], v[12:15]
  ds_read_b64_tr_b16 v[142:143], v116 offset:32768
  v_mfma_f32_16x16x32_bf16 v[60:63], v[144:147], v[224:227], v[60:63]
  ds_read_b64_tr_b16 v[144:145], v117 offset:26624
  v_mfma_f32_16x16x32_bf16 v[16:19], v[148:151], v[220:223], v[16:19]
  ds_read_b64_tr_b16 v[146:147], v117 offset:32768
  v_mfma_f32_16x16x32_bf16 v[64:67], v[148:151], v[224:227], v[64:67]
  ds_read_b64_tr_b16 v[148:149], v114 offset:27648
  v_mfma_f32_16x16x32_bf16 v[20:23], v[152:155], v[220:223], v[20:23]
  ds_read_b64_tr_b16 v[150:151], v114 offset:33792
  s_add_u32 m0, s39, 0
  s_nop 0
  buffer_load_dword v106, s[4:7], s19 offen sc1 lds
  s_add_u32 s19, s19, 131072
  v_mfma_f32_16x16x32_bf16 v[68:71], v[152:155], v[224:227], v[68:71]
  ds_read_b64_tr_b16 v[152:153], v115 offset:27648
  v_mfma_f32_16x16x32_bf16 v[24:27], v[156:159], v[220:223], v[24:27]
  ds_read_b64_tr_b16 v[154:155], v115 offset:33792
  v_mfma_f32_16x16x32_bf16 v[72:75], v[156:159], v[224:227], v[72:75]
  ds_read_b64_tr_b16 v[156:157], v116 offset:27648
  s_waitcnt lgkmcnt(10)
  v_mfma_f32_16x16x32_bf16 v[28:31], v[160:163], v[220:223], v[28:31]
  ds_read_b64_tr_b16 v[158:159], v116 offset:33792
  buffer_load_dwordx4 v[212:215], v105, s[4:7], s16 offen sc1
  v_mfma_f32_16x16x32_bf16 v[76:79], v[160:163], v[224:227], v[76:79]
  ds_read_b64_tr_b16 v[160:161], v117 offset:27648
  v_mfma_f32_16x16x32_bf16 v[32:35], v[220:223], v[164:167], v[32:35]
  ds_read_b64_tr_b16 v[162:163], v117 offset:33792
  v_mfma_f32_16x16x32_bf16 v[80:83], v[224:227], v[164:167], v[80:83]
  ds_read_b64_tr_b16 v[164:165], v114 offset:28672
  v_mfma_f32_16x16x32_bf16 v[36:39], v[220:223], v[168:171], v[36:39]
  ds_read_b64_tr_b16 v[166:167], v114 offset:34816
  buffer_load_dwordx4 v[216:219], v105, s[4:7], s16 offen offset:1024 sc1
  s_add_u32 s16, s16, 131072
  v_mfma_f32_16x16x32_bf16 v[84:87], v[224:227], v[168:171], v[84:87]
  ds_read_b64_tr_b16 v[168:169], v115 offset:28672
  v_mfma_f32_16x16x32_bf16 v[40:43], v[220:223], v[172:175], v[40:43]
  ds_read_b64_tr_b16 v[170:171], v115 offset:34816
  v_mfma_f32_16x16x32_bf16 v[88:91], v[224:227], v[172:175], v[88:91]
  ds_read_b64_tr_b16 v[172:173], v116 offset:28672
  v_mfma_f32_16x16x32_bf16 v[44:47], v[220:223], v[176:179], v[44:47]
  ds_read_b64_tr_b16 v[174:175], v116 offset:34816
  v_mfma_f32_16x16x32_bf16 v[92:95], v[224:227], v[176:179], v[92:95]
  ds_read_b64_tr_b16 v[176:177], v117 offset:28672
  ds_read_b64_tr_b16 v[178:179], v117 offset:34816
  s_sub_u32 s18, s18, 1
  s_cmp_lg_u32 s18, 0
  s_cbranch_scc1 L_loop_17
  s_waitcnt vmcnt(8) lgkmcnt(10)
  s_barrier
  s_add_u32 m0, s38, 13312
  s_nop 0
  buffer_load_dwordx4 v107, s[8:11], s17 offen lds
  v_mfma_f32_16x16x32_bf16 v[96:99], v[180:183], v[188:191], v[96:99]
  ds_read_b64_tr_b16 v[180:181], v118 offset:40960
  v_mfma_f32_16x16x32_bf16 v[100:103], v[188:191], v[184:187], v[100:103]
  ds_read_b64_tr_b16 v[182:183], v118 offset:47104
  ds_read_b128 v[188:191], v119 offset:52224
  ds_read_b64_tr_b16 v[184:185], v118 offset:41984
  v_mfma_f32_16x16x32_bf16 v[0:3], v[132:135], v[228:231], v[0:3]
  ds_read_b64_tr_b16 v[186:187], v118 offset:48128
  v_mfma_f32_16x16x32_bf16 v[48:51], v[132:135], v[232:235], v[48:51]
  ds_read_b64_tr_b16 v[132:133], v114 offset:39936
  buffer_load_dwordx4 v108, s[8:11], s17 offen offset:1024 lds
  v_mfma_f32_16x16x32_bf16 v[4:7], v[136:139], v[228:231], v[4:7]
  ds_read_b64_tr_b16 v[134:135], v114 offset:46080
  v_mfma_f32_16x16x32_bf16 v[52:55], v[136:139], v[232:235], v[52:55]
  ds_read_b64_tr_b16 v[136:137], v115 offset:39936
  v_mfma_f32_16x16x32_bf16 v[8:11], v[140:143], v[228:231], v[8:11]
  ds_read_b64_tr_b16 v[138:139], v115 offset:46080
  v_mfma_f32_16x16x32_bf16 v[56:59], v[140:143], v[232:235], v[56:59]
  ds_read_b64_tr_b16 v[140:141], v116 offset:39936
  buffer_load_dwordx4 v109, s[8:11], s17 offen offset:2048 lds
  s_add_u32 s17, s17, 196608
  v_mfma_f32_16x16x32_bf16 v[12:15], v[144:147], v[228:231], v[12:15]
  ds_read_b64_tr_b16 v[142:143], v116 offset:46080
  v_mfma_f32_16x16x32_bf16 v[60:63], v[144:147], v[232:235], v[60:63]
  ds_read_b64_tr_b16 v[144:145], v117 offset:39936
  v_mfma_f32_16x16x32_bf16 v[16:19], v[148:151], v[228:231], v[16:19]
  ds_read_b64_tr_b16 v[146:147], v117 offset:46080
  v_mfma_f32_16x16x32_bf16 v[64:67], v[148:151], v[232:235], v[64:67]
  ds_read_b64_tr_b16 v[148:149], v114 offset:40960
  v_mfma_f32_16x16x32_bf16 v[20:23], v[152:155], v[228:231], v[20:23]
  ds_read_b64_tr_b16 v[150:151], v114 offset:47104
  s_add_u32 m0, s39, 13312
  s_nop 0
  buffer_load_dword v106, s[4:7], s19 offen sc1 lds
  s_add_u32 s19, s19, 131072
  v_mfma_f32_16x16x32_bf16 v[68:71], v[152:155], v[232:235], v[68:71]
  ds_read_b64_tr_b16 v[152:153], v115 offset:40960
  v_mfma_f32_16x16x32_bf16 v[24:27], v[156:159], v[228:231], v[24:27]
  ds_read_b64_tr_b16 v[154:155], v115 offset:47104
  v_mfma_f32_16x16x32_bf16 v[72:75], v[156:159], v[232:235], v[72:75]
  ds_read_b64_tr_b16 v[156:157], v116 offset:40960
  s_waitcnt lgkmcnt(10)
  v_mfma_f32_16x16x32_bf16 v[28:31], v[160:163], v[228:231], v[28:31]
  ds_read_b64_tr_b16 v[158:159], v116 offset:47104
  buffer_load_dwordx4 v[220:223], v105, s[4:7], s16 offen sc1
  v_mfma_f32_16x16x32_bf16 v[76:79], v[160:163], v[232:235], v[76:79]
  ds_read_b64_tr_b16 v[160:161], v117 offset:40960
  v_mfma_f32_16x16x32_bf16 v[32:35], v[228:231], v[164:167], v[32:35]
  ds_read_b64_tr_b16 v[162:163], v117 offset:47104
  v_mfma_f32_16x16x32_bf16 v[80:83], v[232:235], v[164:167], v[80:83]
  ds_read_b64_tr_b16 v[164:165], v114 offset:41984
  v_mfma_f32_16x16x32_bf16 v[36:39], v[228:231], v[168:171], v[36:39]
  ds_read_b64_tr_b16 v[166:167], v114 offset:48128
  buffer_load_dwordx4 v[224:227], v105, s[4:7], s16 offen offset:1024 sc1
  s_add_u32 s16, s16, 131072
  v_mfma_f32_16x16x32_bf16 v[84:87], v[232:235], v[168:171], v[84:87]
  ds_read_b64_tr_b16 v[168:169], v115 offset:41984
  v_mfma_f32_16x16x32_bf16 v[40:43], v[228:231], v[172:175], v[40:43]
  ds_read_b64_tr_b16 v[170:171], v115 offset:48128
  v_mfma_f32_16x16x32_bf16 v[88:91], v[232:235], v[172:175], v[88:91]
  ds_read_b64_tr_b16 v[172:173], v116 offset:41984
  v_mfma_f32_16x16x32_bf16 v[44:47], v[228:231], v[176:179], v[44:47]
  ds_read_b64_tr_b16 v[174:175], v116 offset:48128
  v_mfma_f32_16x16x32_bf16 v[92:95], v[232:235], v[176:179], v[92:95]
  ds_read_b64_tr_b16 v[176:177], v117 offset:41984
  ds_read_b64_tr_b16 v[178:179], v117 offset:48128
  s_waitcnt vmcnt(8) lgkmcnt(10)
  s_barrier
  s_add_u32 m0, s38, 26624
  s_nop 0
  buffer_load_dwordx4 v107, s[8:11], s17 offen lds
  v_mfma_f32_16x16x32_bf16 v[96:99], v[180:183], v[188:191], v[96:99]
  ds_read_b64_tr_b16 v[180:181], v118 offset:1024
  v_mfma_f32_16x16x32_bf16 v[100:103], v[188:191], v[184:187], v[100:103]
  ds_read_b64_tr_b16 v[182:183], v118 offset:7168
  ds_read_b128 v[188:191], v119 offset:12288
  ds_read_b64_tr_b16 v[184:185], v118 offset:2048
  v_mfma_f32_16x16x32_bf16 v[0:3], v[132:135], v[236:239], v[0:3]
  ds_read_b64_tr_b16 v[186:187], v118 offset:8192
  v_mfma_f32_16x16x32_bf16 v[48:51], v[132:135], v[240:243], v[48:51]
  ds_read_b64_tr_b16 v[132:133], v114 offset:0
  buffer_load_dwordx4 v108, s[8:11], s17 offen offset:1024 lds
  v_mfma_f32_16x16x32_bf16 v[4:7], v[136:139], v[236:239], v[4:7]
  ds_read_b64_tr_b16 v[134:135], v114 offset:6144
  v_mfma_f32_16x16x32_bf16 v[52:55], v[136:139], v[240:243], v[52:55]
  ds_read_b64_tr_b16 v[136:137], v115 offset:0
  v_mfma_f32_16x16x32_bf16 v[8:11], v[140:143], v[236:239], v[8:11]
  ds_read_b64_tr_b16 v[138:139], v115 offset:6144
  v_mfma_f32_16x16x32_bf16 v[56:59], v[140:143], v[240:243], v[56:59]
  ds_read_b64_tr_b16 v[140:141], v116 offset:0
  buffer_load_dwordx4 v109, s[8:11], s17 offen offset:2048 lds
  s_add_u32 s17, s17, 196608
  v_mfma_f32_16x16x32_bf16 v[12:15], v[144:147], v[236:239], v[12:15]
  ds_read_b64_tr_b16 v[142:143], v116 offset:6144
  v_mfma_f32_16x16x32_bf16 v[60:63], v[144:147], v[240:243], v[60:63]
  ds_read_b64_tr_b16 v[144:145], v117 offset:0
  v_mfma_f32_16x16x32_bf16 v[16:19], v[148:151], v[236:239], v[16:19]
  ds_read_b64_tr_b16 v[146:147], v117 offset:6144
  v_mfma_f32_16x16x32_bf16 v[64:67], v[148:151], v[240:243], v[64:67]
  ds_read_b64_tr_b16 v[148:149], v114 offset:1024
  v_mfma_f32_16x16x32_bf16 v[20:23], v[152:155], v[236:239], v[20:23]
  ds_read_b64_tr_b16 v[150:151], v114 offset:7168
  s_add_u32 m0, s39, 26624
  s_nop 0
  buffer_load_dword v106, s[4:7], s19 offen sc1 lds
  s_add_u32 s19, s19, 131072
  v_mfma_f32_16x16x32_bf16 v[68:71], v[152:155], v[240:243], v[68:71]
  ds_read_b64_tr_b16 v[152:153], v115 offset:1024
  v_mfma_f32_16x16x32_bf16 v[24:27], v[156:159], v[236:239], v[24:27]
  ds_read_b64_tr_b16 v[154:155], v115 offset:7168
  v_mfma_f32_16x16x32_bf16 v[72:75], v[156:159], v[240:243], v[72:75]
  ds_read_b64_tr_b16 v[156:157], v116 offset:1024
  s_waitcnt lgkmcnt(10)
  v_mfma_f32_16x16x32_bf16 v[28:31], v[160:163], v[236:239], v[28:31]
  ds_read_b64_tr_b16 v[158:159], v116 offset:7168
  buffer_load_dwordx4 v[228:231], v105, s[4:7], s16 offen sc1
  v_mfma_f32_16x16x32_bf16 v[76:79], v[160:163], v[240:243], v[76:79]
  ds_read_b64_tr_b16 v[160:161], v117 offset:1024
  v_mfma_f32_16x16x32_bf16 v[32:35], v[236:239], v[164:167], v[32:35]
  ds_read_b64_tr_b16 v[162:163], v117 offset:7168
  v_mfma_f32_16x16x32_bf16 v[80:83], v[240:243], v[164:167], v[80:83]
  ds_read_b64_tr_b16 v[164:165], v114 offset:2048
  v_mfma_f32_16x16x32_bf16 v[36:39], v[236:239], v[168:171], v[36:39]
  ds_read_b64_tr_b16 v[166:167], v114 offset:8192
  buffer_load_dwordx4 v[232:235], v105, s[4:7], s16 offen offset:1024 sc1
  s_add_u32 s16, s16, 131072
  v_mfma_f32_16x16x32_bf16 v[84:87], v[240:243], v[168:171], v[84:87]
  ds_read_b64_tr_b16 v[168:169], v115 offset:2048
  v_mfma_f32_16x16x32_bf16 v[40:43], v[236:239], v[172:175], v[40:43]
  ds_read_b64_tr_b16 v[170:171], v115 offset:8192
  v_mfma_f32_16x16x32_bf16 v[88:91], v[240:243], v[172:175], v[88:91]
  ds_read_b64_tr_b16 v[172:173], v116 offset:2048
  v_mfma_f32_16x16x32_bf16 v[44:47], v[236:239], v[176:179], v[44:47]
  ds_read_b64_tr_b16 v[174:175], v116 offset:8192
  v_mfma_f32_16x16x32_bf16 v[92:95], v[240:243], v[176:179], v[92:95]
  ds_read_b64_tr_b16 v[176:177], v117 offset:2048
  ds_read_b64_tr_b16 v[178:179], v117 offset:8192
  s_waitcnt vmcnt(8) lgkmcnt(10)
  s_barrier
  s_add_u32 m0, s38, 39936
  s_nop 0
  buffer_load_dwordx4 v107, s[8:11], s17 offen lds
  v_mfma_f32_16x16x32_bf16 v[96:99], v[180:183], v[188:191], v[96:99]
  ds_read_b64_tr_b16 v[180:181], v118 offset:14336
  v_mfma_f32_16x16x32_bf16 v[100:103], v[188:191], v[184:187], v[100:103]
  ds_read_b64_tr_b16 v[182:183], v118 offset:20480
  ds_read_b128 v[188:191], v119 offset:25600
  ds_read_b64_tr_b16 v[184:185], v118 offset:15360
  v_mfma_f32_16x16x32_bf16 v[0:3], v[132:135], v[212:215], v[0:3]
  ds_read_b64_tr_b16 v[186:187], v118 offset:21504
  buffer_load_dwordx4 v108, s[8:11], s17 offen offset:1024 lds
  v_mfma_f32_16x16x32_bf16 v[48:51], v[132:135], v[216:219], v[48:51]
  ds_read_b64_tr_b16 v[132:133], v114 offset:13312
  v_mfma_f32_16x16x32_bf16 v[4:7], v[136:139], v[212:215], v[4:7]
  ds_read_b64_tr_b16 v[134:135], v114 offset:19456
  v_mfma_f32_16x16x32_bf16 v[52:55], v[136:139], v[216:219], v[52:55]
  ds_read_b64_tr_b16 v[136:137], v115 offset:13312
  buffer_load_dwordx4 v109, s[8:11], s17 offen offset:2048 lds
  s_add_u32 s17, s17, 196608
  v_mfma_f32_16x16x32_bf16 v[8:11], v[140:143], v[212:215], v[8:11]
  ds_read_b64_tr_b16 v[138:139], v115 offset:19456
  v_mfma_f32_16x16x32_bf16 v[56:59], v[140:143], v[216:219], v[56:59]
  ds_read_b64_tr_b16 v[140:141], v116 offset:13312
  v_mfma_f32_16x16x32_bf16 v[12:15], v[144:147], v[212:215], v[12:15]
  ds_read_b64_tr_b16 v[142:143], v116 offset:19456
  s_add_u32 m0, s39, 39936
  s_nop 0
  buffer_load_dword v106, s[4:7], s19 offen sc1 lds
  s_add_u32 s19, s19, 131072
  v_mfma_f32_16x16x32_bf16 v[60:63], v[144:147], v[216:219], v[60:63]
  ds_read_b64_tr_b16 v[144:145], v117 offset:13312
  v_mfma_f32_16x16x32_bf16 v[16:19], v[148:151], v[212:215], v[16:19]
  ds_read_b64_tr_b16 v[146:147], v117 offset:19456
  v_mfma_f32_16x16x32_bf16 v[64:67], v[148:151], v[216:219], v[64:67]
  ds_read_b64_tr_b16 v[148:149], v114 offset:14336
  v_mfma_f32_16x16x32_bf16 v[20:23], v[152:155], v[212:215], v[20:23]
  ds_read_b64_tr_b16 v[150:151], v114 offset:20480
  buffer_load_dwordx4 v[236:239], v105, s[4:7], s16 offen sc1
  v_mfma_f32_16x16x32_bf16 v[68:71], v[152:155], v[216:219], v[68:71]
  ds_read_b64_tr_b16 v[152:153], v115 offset:14336
  v_mfma_f32_16x16x32_bf16 v[24:27], v[156:159], v[212:215], v[24:27]
  ds_read_b64_tr_b16 v[154:155], v115 offset:20480
  v_mfma_f32_16x16x32_bf16 v[72:75], v[156:159], v[216:219], v[72:75]
  ds_read_b64_tr_b16 v[156:157], v116 offset:14336
  buffer_load_dwordx4 v[240:243], v105, s[4:7], s16 offen offset:1024 sc1
  s_add_u32 s16, s16, 131072
  s_waitcnt lgkmcnt(10)
  v_mfma_f32_16x16x32_bf16 v[28:31], v[160:163], v[212:215], v[28:31]
  ds_read_b64_tr_b16 v[158:159], v116 offset:20480
  v_mfma_f32_16x16x32_bf16 v[76:79], v[160:163], v[216:219], v[76:79]
  ds_read_b64_tr_b16 v[160:161], v117 offset:14336
  v_mfma_f32_16x16x32_bf16 v[32:35], v[212:215], v[164:167], v[32:35]
  ds_read_b64_tr_b16 v[162:163], v117 offset:20480
  s_mov_b32 s8, s26
  s_mov_b32 s9, s27
  s_mov_b32 s10, 0x200000
  s_mov_b32 s11, 0x20000
  v_lshrrev_b32 v127, 3, v104
  v_lshlrev_b32 v127, 11, v127
  v_and_b32 v126, 7, v104
  v_lshl_add_u32 v127, v126, 8, v127
  s_lshr_b32 s34, s2, 3
  s_lshl_b32 s34, s34, 2
  s_add_u32 s34, s34, s3
  s_lshl_b32 s34, s34, 14
  s_and_b32 s35, s2, 1
  s_lshl_b32 s35, s35, 7
  s_add_u32 s34, s34, s35
  buffer_load_dword v113, v127, s[8:11], s34 offen
  v_mfma_f32_16x16x32_bf16 v[80:83], v[216:219], v[164:167], v[80:83]
  ds_read_b64_tr_b16 v[164:165], v114 offset:15360
  v_mfma_f32_16x16x32_bf16 v[36:39], v[212:215], v[168:171], v[36:39]
  ds_read_b64_tr_b16 v[166:167], v114 offset:21504
  v_mfma_f32_16x16x32_bf16 v[84:87], v[216:219], v[168:171], v[84:87]
  ds_read_b64_tr_b16 v[168:169], v115 offset:15360
  s_getpc_b64 s[8:9]
  L_pc_16:
  s_add_u32 s8, s8, k5_kernel-L_pc_16
  s_addc_u32 s9, s9, 0
  s_lshr_b32 s34, s2, 3
  s_lshl_b32 s34, s34, 2
  s_add_u32 s34, s34, s3
  s_lshl_b32 s34, s34, 13
  v_lshlrev_b32 v128, 7, v104
  v_add_u32 v128, s34, v128
  v_min_u32 v128, L_k56_seam-k5_kernel-4, v128
  v_mov_b32 v129, s9
  v_add_co_u32 v128, vcc, s8, v128
  s_nop 1
  v_addc_co_u32 v129, vcc, 0, v129, vcc
  global_load_dword v113, v[128:129], off
  v_mfma_f32_16x16x32_bf16 v[40:43], v[212:215], v[172:175], v[40:43]
  ds_read_b64_tr_b16 v[170:171], v115 offset:21504
  v_mfma_f32_16x16x32_bf16 v[88:91], v[216:219], v[172:175], v[88:91]
  ds_read_b64_tr_b16 v[172:173], v116 offset:15360
  v_mfma_f32_16x16x32_bf16 v[44:47], v[212:215], v[176:179], v[44:47]
  ds_read_b64_tr_b16 v[174:175], v116 offset:21504
  v_mfma_f32_16x16x32_bf16 v[92:95], v[216:219], v[176:179], v[92:95]
  ds_read_b64_tr_b16 v[176:177], v117 offset:15360
  ds_read_b64_tr_b16 v[178:179], v117 offset:21504
  s_waitcnt vmcnt(10) lgkmcnt(10)
  s_barrier
  v_mfma_f32_16x16x32_bf16 v[96:99], v[180:183], v[188:191], v[96:99]
  ds_read_b64_tr_b16 v[180:181], v118 offset:27648
  v_mfma_f32_16x16x32_bf16 v[100:103], v[188:191], v[184:187], v[100:103]
  ds_read_b64_tr_b16 v[182:183], v118 offset:33792
  ds_read_b128 v[188:191], v119 offset:38912
  ds_read_b64_tr_b16 v[184:185], v118 offset:28672
  v_mfma_f32_16x16x32_bf16 v[0:3], v[132:135], v[220:223], v[0:3]
  ds_read_b64_tr_b16 v[186:187], v118 offset:34816
  v_mfma_f32_16x16x32_bf16 v[48:51], v[132:135], v[224:227], v[48:51]
  ds_read_b64_tr_b16 v[132:133], v114 offset:26624
  v_mfma_f32_16x16x32_bf16 v[4:7], v[136:139], v[220:223], v[4:7]
  ds_read_b64_tr_b16 v[134:135], v114 offset:32768
  v_mfma_f32_16x16x32_bf16 v[52:55], v[136:139], v[224:227], v[52:55]
  ds_read_b64_tr_b16 v[136:137], v115 offset:26624
  v_mfma_f32_16x16x32_bf16 v[8:11], v[140:143], v[220:223], v[8:11]
  ds_read_b64_tr_b16 v[138:139], v115 offset:32768
  v_mfma_f32_16x16x32_bf16 v[56:59], v[140:143], v[224:227], v[56:59]
  ds_read_b64_tr_b16 v[140:141], v116 offset:26624
  v_mfma_f32_16x16x32_bf16 v[12:15], v[144:147], v[220:223], v[12:15]
  ds_read_b64_tr_b16 v[142:143], v116 offset:32768
  v_mfma_f32_16x16x32_bf16 v[60:63], v[144:147], v[224:227], v[60:63]
  ds_read_b64_tr_b16 v[144:145], v117 offset:26624
  v_mfma_f32_16x16x32_bf16 v[16:19], v[148:151], v[220:223], v[16:19]
  ds_read_b64_tr_b16 v[146:147], v117 offset:32768
  v_mfma_f32_16x16x32_bf16 v[64:67], v[148:151], v[224:227], v[64:67]
  ds_read_b64_tr_b16 v[148:149], v114 offset:27648
  v_mfma_f32_16x16x32_bf16 v[20:23], v[152:155], v[220:223], v[20:23]
  ds_read_b64_tr_b16 v[150:151], v114 offset:33792
  v_mfma_f32_16x16x32_bf16 v[68:71], v[152:155], v[224:227], v[68:71]
  ds_read_b64_tr_b16 v[152:153], v115 offset:27648
  v_mfma_f32_16x16x32_bf16 v[24:27], v[156:159], v[220:223], v[24:27]
  ds_read_b64_tr_b16 v[154:155], v115 offset:33792
  v_mfma_f32_16x16x32_bf16 v[72:75], v[156:159], v[224:227], v[72:75]
  ds_read_b64_tr_b16 v[156:157], v116 offset:27648
  s_waitcnt lgkmcnt(10)
  v_mfma_f32_16x16x32_bf16 v[28:31], v[160:163], v[220:223], v[28:31]
  ds_read_b64_tr_b16 v[158:159], v116 offset:33792
  v_mfma_f32_16x16x32_bf16 v[76:79], v[160:163], v[224:227], v[76:79]
  ds_read_b64_tr_b16 v[160:161], v117 offset:27648
  v_mfma_f32_16x16x32_bf16 v[32:35], v[220:223], v[164:167], v[32:35]
  ds_read_b64_tr_b16 v[162:163], v117 offset:33792
  v_mfma_f32_16x16x32_bf16 v[80:83], v[224:227], v[164:167], v[80:83]
  ds_read_b64_tr_b16 v[164:165], v114 offset:28672
  v_mfma_f32_16x16x32_bf16 v[36:39], v[220:223], v[168:171], v[36:39]
  ds_read_b64_tr_b16 v[166:167], v114 offset:34816
  v_mfma_f32_16x16x32_bf16 v[84:87], v[224:227], v[168:171], v[84:87]
  ds_read_b64_tr_b16 v[168:169], v115 offset:28672
  v_mfma_f32_16x16x32_bf16 v[40:43], v[220:223], v[172:175], v[40:43]
  ds_read_b64_tr_b16 v[170:171], v115 offset:34816
  v_mfma_f32_16x16x32_bf16 v[88:91], v[224:227], v[172:175], v[88:91]
  ds_read_b64_tr_b16 v[172:173], v116 offset:28672
  v_mfma_f32_16x16x32_bf16 v[44:47], v[220:223], v[176:179], v[44:47]
  ds_read_b64_tr_b16 v[174:175], v116 offset:34816
  v_mfma_f32_16x16x32_bf16 v[92:95], v[224:227], v[176:179], v[92:95]
  ds_read_b64_tr_b16 v[176:177], v117 offset:28672
  ds_read_b64_tr_b16 v[178:179], v117 offset:34816
  s_waitcnt vmcnt(4) lgkmcnt(10)
  s_barrier
  v_mfma_f32_16x16x32_bf16 v[96:99], v[180:183], v[188:191], v[96:99]
  ds_read_b64_tr_b16 v[180:181], v118 offset:40960
  v_mfma_f32_16x16x32_bf16 v[100:103], v[188:191], v[184:187], v[100:103]
  ds_read_b64_tr_b16 v[182:183], v118 offset:47104
  ds_read_b128 v[188:191], v119 offset:52224
  ds_read_b64_tr_b16 v[184:185], v118 offset:41984
  v_mfma_f32_16x16x32_bf16 v[0:3], v[132:135], v[228:231], v[0:3]
  ds_read_b64_tr_b16 v[186:187], v118 offset:48128
  v_mfma_f32_16x16x32_bf16 v[48:51], v[132:135], v[232:235], v[48:51]
  ds_read_b64_tr_b16 v[132:133], v114 offset:39936
  v_mfma_f32_16x16x32_bf16 v[4:7], v[136:139], v[228:231], v[4:7]
  ds_read_b64_tr_b16 v[134:135], v114 offset:46080
  v_mfma_f32_16x16x32_bf16 v[52:55], v[136:139], v[232:235], v[52:55]
  ds_read_b64_tr_b16 v[136:137], v115 offset:39936
  v_mfma_f32_16x16x32_bf16 v[8:11], v[140:143], v[228:231], v[8:11]
  ds_read_b64_tr_b16 v[138:139], v115 offset:46080
  v_mfma_f32_16x16x32_bf16 v[56:59], v[140:143], v[232:235], v[56:59]
  ds_read_b64_tr_b16 v[140:141], v116 offset:39936
  v_mfma_f32_16x16x32_bf16 v[12:15], v[144:147], v[228:231], v[12:15]
  ds_read_b64_tr_b16 v[142:143], v116 offset:46080
  v_mfma_f32_16x16x32_bf16 v[60:63], v[144:147], v[232:235], v[60:63]
  ds_read_b64_tr_b16 v[144:145], v117 offset:39936
  v_mfma_f32_16x16x32_bf16 v[16:19], v[148:151], v[228:231], v[16:19]
  ds_read_b64_tr_b16 v[146:147], v117 offset:46080
  v_mfma_f32_16x16x32_bf16 v[64:67], v[148:151], v[232:235], v[64:67]
  ds_read_b64_tr_b16 v[148:149], v114 offset:40960
  v_mfma_f32_16x16x32_bf16 v[20:23], v[152:155], v[228:231], v[20:23]
  ds_read_b64_tr_b16 v[150:151], v114 offset:47104
  v_mfma_f32_16x16x32_bf16 v[68:71], v[152:155], v[232:235], v[68:71]
  ds_read_b64_tr_b16 v[152:153], v115 offset:40960
  v_mfma_f32_16x16x32_bf16 v[24:27], v[156:159], v[228:231], v[24:27]
  ds_read_b64_tr_b16 v[154:155], v115 offset:47104
  v_mfma_f32_16x16x32_bf16 v[72:75], v[156:159], v[232:235], v[72:75]
  ds_read_b64_tr_b16 v[156:157], v116 offset:40960
  s_waitcnt lgkmcnt(10)
  v_mfma_f32_16x16x32_bf16 v[28:31], v[160:163], v[228:231], v[28:31]
  ds_read_b64_tr_b16 v[158:159], v116 offset:47104
  v_mfma_f32_16x16x32_bf16 v[76:79], v[160:163], v[232:235], v[76:79]
  ds_read_b64_tr_b16 v[160:161], v117 offset:40960
  v_mfma_f32_16x16x32_bf16 v[32:35], v[228:231], v[164:167], v[32:35]
  ds_read_b64_tr_b16 v[162:163], v117 offset:47104
  v_mfma_f32_16x16x32_bf16 v[80:83], v[232:235], v[164:167], v[80:83]
  ds_read_b64_tr_b16 v[164:165], v114 offset:41984
  v_mfma_f32_16x16x32_bf16 v[36:39], v[228:231], v[168:171], v[36:39]
  ds_read_b64_tr_b16 v[166:167], v114 offset:48128
  v_mfma_f32_16x16x32_bf16 v[84:87], v[232:235], v[168:171], v[84:87]
  ds_read_b64_tr_b16 v[168:169], v115 offset:41984
  v_mfma_f32_16x16x32_bf16 v[40:43], v[228:231], v[172:175], v[40:43]
  ds_read_b64_tr_b16 v[170:171], v115 offset:48128
  v_mfma_f32_16x16x32_bf16 v[88:91], v[232:235], v[172:175], v[88:91]
  ds_read_b64_tr_b16 v[172:173], v116 offset:41984
  v_mfma_f32_16x16x32_bf16 v[44:47], v[228:231], v[176:179], v[44:47]
  ds_read_b64_tr_b16 v[174:175], v116 offset:48128
  v_mfma_f32_16x16x32_bf16 v[92:95], v[232:235], v[176:179], v[92:95]
  ds_read_b64_tr_b16 v[176:177], v117 offset:41984
  ds_read_b64_tr_b16 v[178:179], v117 offset:48128
  s_waitcnt vmcnt(2) lgkmcnt(10)
  s_barrier
  v_mfma_f32_16x16x32_bf16 v[96:99], v[180:183], v[188:191], v[96:99]
  v_mfma_f32_16x16x32_bf16 v[100:103], v[188:191], v[184:187], v[100:103]
  v_mfma_f32_16x16x32_bf16 v[0:3], v[132:135], v[236:239], v[0:3]
  v_mfma_f32_16x16x32_bf16 v[48:51], v[132:135], v[240:243], v[48:51]
  v_mfma_f32_16x16x32_bf16 v[4:7], v[136:139], v[236:239], v[4:7]
  v_mfma_f32_16x16x32_bf16 v[52:55], v[136:139], v[240:243], v[52:55]
  v_mfma_f32_16x16x32_bf16 v[8:11], v[140:143], v[236:239], v[8:11]
  v_mfma_f32_16x16x32_bf16 v[56:59], v[140:143], v[240:243], v[56:59]
  v_mfma_f32_16x16x32_bf16 v[12:15], v[144:147], v[236:239], v[12:15]
  v_mfma_f32_16x16x32_bf16 v[60:63], v[144:147], v[240:243], v[60:63]
  v_mfma_f32_16x16x32_bf16 v[16:19], v[148:151], v[236:239], v[16:19]
  v_mfma_f32_16x16x32_bf16 v[64:67], v[148:151], v[240:243], v[64:67]
  v_mfma_f32_16x16x32_bf16 v[20:23], v[152:155], v[236:239], v[20:23]
  v_mfma_f32_16x16x32_bf16 v[68:71], v[152:155], v[240:243], v[68:71]
  v_mfma_f32_16x16x32_bf16 v[24:27], v[156:159], v[236:239], v[24:27]
  v_mfma_f32_16x16x32_bf16 v[72:75], v[156:159], v[240:243], v[72:75]
  s_waitcnt lgkmcnt(8)
  v_mfma_f32_16x16x32_bf16 v[28:31], v[160:163], v[236:239], v[28:31]
  v_mfma_f32_16x16x32_bf16 v[76:79], v[160:163], v[240:243], v[76:79]
  s_waitcnt lgkmcnt(6)
  v_mfma_f32_16x16x32_bf16 v[32:35], v[236:239], v[164:167], v[32:35]
  v_mfma_f32_16x16x32_bf16 v[80:83], v[240:243], v[164:167], v[80:83]
  s_waitcnt lgkmcnt(4)
  v_mfma_f32_16x16x32_bf16 v[36:39], v[236:239], v[168:171], v[36:39]
  v_mfma_f32_16x16x32_bf16 v[84:87], v[240:243], v[168:171], v[84:87]
  s_waitcnt lgkmcnt(2)
  v_mfma_f32_16x16x32_bf16 v[40:43], v[236:239], v[172:175], v[40:43]
  v_mfma_f32_16x16x32_bf16 v[88:91], v[240:243], v[172:175], v[88:91]
  s_waitcnt lgkmcnt(0)
  v_mfma_f32_16x16x32_bf16 v[44:47], v[236:239], v[176:179], v[44:47]
  v_mfma_f32_16x16x32_bf16 v[92:95], v[240:243], v[176:179], v[92:95]
  s_nop 7
  s_nop 1
  s_add_u32 s12, s20, 0x500000
  s_addc_u32 s13, s21, 0
  s_mov_b32 s14, 0x400000
  s_mov_b32 s15, 0x20000
  s_lshl_b32 s33, s3, 12
  v_add_u32 v110, s33, v119
  s_lshr_b32 s33, s3, 1
  s_lshl_b32 s33, s33, 10
  s_and_b32 s34, s3, 1
  s_lshl_b32 s34, s34, 3
  s_add_u32 s33, s33, s34
  v_add_u32 v111, s33, v119
  v_cvt_pk_bf16_f32 v196, v96, v97
  v_cvt_pk_bf16_f32 v197, v98, v99
  v_cvt_pk_bf16_f32 v198, v100, v101
  v_cvt_pk_bf16_f32 v199, v102, v103
  v_cvt_pk_bf16_f32 v164, v64, v65
  v_cvt_pk_bf16_f32 v165, v66, v67
  v_cvt_pk_bf16_f32 v176, v80, v81
  v_cvt_pk_bf16_f32 v177, v82, v83
  v_cvt_pk_bf16_f32 v166, v68, v69
  v_cvt_pk_bf16_f32 v167, v70, v71
  v_cvt_pk_bf16_f32 v182, v84, v85
  v_cvt_pk_bf16_f32 v183, v86, v87
  v_cvt_pk_bf16_f32 v168, v72, v73
  v_cvt_pk_bf16_f32 v169, v74, v75
  v_cvt_pk_bf16_f32 v188, v88, v89
  v_cvt_pk_bf16_f32 v189, v90, v91
  v_cvt_pk_bf16_f32 v170, v76, v77
  v_cvt_pk_bf16_f32 v171, v78, v79
  v_cvt_pk_bf16_f32 v194, v92, v93
  v_cvt_pk_bf16_f32 v195, v94, v95
  ds_write_b64 v111, v[196:197] offset:0
  ds_write_b64 v111, v[198:199] offset:2048
  ds_write_b128 v110, v[164:167] offset:4096
  ds_write_b64 v110, v[176:177] offset:6144
  ds_write_b64 v110, v[182:183] offset:6152
  ds_write_b128 v110, v[168:171] offset:5120
  ds_write_b64 v110, v[188:189] offset:7168
  ds_write_b64 v110, v[194:195] offset:7176
  v_cvt_pk_bf16_f32 v132, v0, v1
  v_cvt_pk_bf16_f32 v133, v2, v3
  v_cvt_pk_bf16_f32 v140, v48, v49
  v_cvt_pk_bf16_f32 v141, v50, v51
  v_cvt_pk_bf16_f32 v156, v16, v17
  v_cvt_pk_bf16_f32 v157, v18, v19
  v_cvt_pk_bf16_f32 v174, v32, v33
  v_cvt_pk_bf16_f32 v175, v34, v35
  v_cvt_pk_bf16_f32 v134, v4, v5
  v_cvt_pk_bf16_f32 v135, v6, v7
  v_cvt_pk_bf16_f32 v142, v52, v53
  v_cvt_pk_bf16_f32 v143, v54, v55
  v_cvt_pk_bf16_f32 v158, v20, v21
  v_cvt_pk_bf16_f32 v159, v22, v23
  v_cvt_pk_bf16_f32 v180, v36, v37
  v_cvt_pk_bf16_f32 v181, v38, v39
  v_cvt_pk_bf16_f32 v136, v8, v9
  v_cvt_pk_bf16_f32 v137, v10, v11
  v_cvt_pk_bf16_f32 v144, v56, v57
  v_cvt_pk_bf16_f32 v145, v58, v59
  v_cvt_pk_bf16_f32 v160, v24, v25
  v_cvt_pk_bf16_f32 v161, v26, v27
  v_cvt_pk_bf16_f32 v186, v40, v41
  v_cvt_pk_bf16_f32 v187, v42, v43
  v_cvt_pk_bf16_f32 v138, v12, v13
  v_cvt_pk_bf16_f32 v139, v14, v15
  v_cvt_pk_bf16_f32 v146, v60, v61
  v_cvt_pk_bf16_f32 v147, v62, v63
  v_cvt_pk_bf16_f32 v162, v28, v29
  v_cvt_pk_bf16_f32 v163, v30, v31
  v_cvt_pk_bf16_f32 v192, v44, v45
  v_cvt_pk_bf16_f32 v193, v46, v47
  s_waitcnt lgkmcnt(0)
  s_barrier
  ds_read_b128 v[148:151], v110 offset:0
  ds_read_b64 v[172:173], v110 offset:2048
  ds_read_b64 v[178:179], v110 offset:2056
  ds_read_b128 v[152:155], v110 offset:1024
  ds_read_b64 v[184:185], v110 offset:3072
  ds_read_b64 v[190:191], v110 offset:3080
  v_mfma_f32_16x16x32_bf16 v[200:203], v[156:159], v[140:143], 0
  v_mfma_f32_16x16x32_bf16 v[204:207], v[164:167], v[140:143], 0
  v_mfma_f32_16x16x32_bf16 v[208:211], v[160:163], v[144:147], 0
  v_mfma_f32_16x16x32_bf16 v[212:215], v[168:171], v[144:147], 0
  s_or_b32 s33, s30, s3
  s_cmp_eq_u32 s33, 0
  s_cselect_b32 s33, 0xf149f2ca, 0
  v_mov_b32 v232, s33
  v_cndmask_b32_e64 v120, v232, 0, s[44:45]
  v_cndmask_b32_e64 v121, v232, 0, s[46:47]
  v_and_b32 v122, 1, v104
  v_lshlrev_b32 v122, 4, v122
  s_waitcnt lgkmcnt(0)
  v_mfma_f32_16x16x32_bf16 v[216:219], v[148:151], v[132:135], 0
  v_mfma_f32_16x16x32_bf16 v[220:223], v[156:159], v[132:135], 0
  v_mfma_f32_16x16x32_bf16 v[224:227], v[152:155], v[136:139], 0
  v_mfma_f32_16x16x32_bf16 v[228:231], v[160:163], v[136:139], 0
  s_mov_b32 s40, 0x3e8293ee
  v_cndmask_b32_e64 v200, v200, v201, s[48:49]
  v_cndmask_b32_e64 v202, v202, v203, s[48:49]
  v_cndmask_b32_e64 v204, v204, v205, s[48:49]
  v_cndmask_b32_e64 v206, v206, v207, s[48:49]
  v_cndmask_b32_e64 v208, v208, v209, s[48:49]
  v_cndmask_b32_e64 v210, v210, v211, s[48:49]
  v_cndmask_b32_e64 v212, v212, v213, s[48:49]
  v_cndmask_b32_e64 v214, v214, v215, s[48:49]
  v_cndmask_b32_e64 v216, v216, v217, s[48:49]
  v_cndmask_b32_e64 v218, v218, v219, s[48:49]
  v_cndmask_b32_e64 v220, v220, v221, s[48:49]
  v_cndmask_b32_e64 v222, v222, v223, s[48:49]
  v_cndmask_b32_e64 v224, v224, v225, s[48:49]
  v_cndmask_b32_e64 v226, v226, v227, s[48:49]
  v_cndmask_b32_e64 v228, v228, v229, s[48:49]
  v_cndmask_b32_e64 v230, v230, v231, s[48:49]
  v_cndmask_b32_e64 v200, v200, v204, s[44:45]
  v_cndmask_b32_e64 v201, v202, v206, s[46:47]
  v_cndmask_b32_e64 v208, v208, v212, s[44:45]
  v_cndmask_b32_e64 v209, v210, v214, s[46:47]
  v_cndmask_b32_e64 v216, v216, v220, s[44:45]
  v_cndmask_b32_e64 v217, v218, v222, s[46:47]
  v_cndmask_b32_e64 v224, v224, v228, s[44:45]
  v_cndmask_b32_e64 v225, v226, v230, s[46:47]
  v_mul_f32 v200, s40, v200
  v_mul_f32 v201, s40, v201
  v_mul_f32 v208, s40, v208
  v_mul_f32 v209, s40, v209
  v_fma_f32 v216, v216, s40, v120
  v_fma_f32 v217, v217, s40, v121
  v_fma_f32 v224, v224, s40, v120
  v_fma_f32 v225, v225, s40, v121
  v_max_f32 v232, v200, v201
  v_max_f32 v233, v208, v209
  v_max_f32 v234, v216, v217
  v_max_f32 v235, v224, v225
  v_mov_b32 v236, v232
  v_mov_b32 v237, v233
  v_mov_b32 v238, v234
  v_mov_b32 v239, v235
  s_nop 1
  v_permlane16_swap_b32 v236, v232
  v_permlane16_swap_b32 v237, v233
  v_permlane16_swap_b32 v238, v234
  v_permlane16_swap_b32 v239, v235
  s_nop 1
  v_max_f32 v232, v232, v236
  v_max_f32 v233, v233, v237
  v_max_f32 v234, v234, v238
  v_max_f32 v235, v235, v239
  v_mov_b32 v236, v232
  v_mov_b32 v237, v233
  v_mov_b32 v238, v234
  v_mov_b32 v239, v235
  s_nop 1
  v_permlane32_swap_b32 v236, v232
  v_permlane32_swap_b32 v237, v233
  v_permlane32_swap_b32 v238, v234
  v_permlane32_swap_b32 v239, v235
  s_nop 1
  v_max_f32 v232, v232, v236
  v_max_f32 v233, v233, v237
  v_max_f32 v234, v234, v238
  v_max_f32 v235, v235, v239
  v_sub_f32 v200, v200, v232
  v_sub_f32 v201, v201, v232
  v_sub_f32 v208, v208, v233
  v_sub_f32 v209, v209, v233
  v_sub_f32 v216, v216, v234
  v_sub_f32 v217, v217, v234
  v_sub_f32 v224, v224, v235
  v_sub_f32 v225, v225, v235
  v_exp_f32 v200, v200
  v_exp_f32 v201, v201
  v_exp_f32 v208, v208
  v_exp_f32 v209, v209
  v_exp_f32 v216, v216
  v_exp_f32 v217, v217
  v_exp_f32 v224, v224
  v_exp_f32 v225, v225
  s_nop 0
  v_add_f32 v232, v200, v201
  v_add_f32 v233, v208, v209
  v_add_f32 v234, v216, v217
  v_add_f32 v235, v224, v225
  v_mov_b32 v236, v232
  v_mov_b32 v237, v233
  v_mov_b32 v238, v234
  v_mov_b32 v239, v235
  s_nop 1
  v_permlane16_swap_b32 v236, v232
  v_permlane16_swap_b32 v237, v233
  v_permlane16_swap_b32 v238, v234
  v_permlane16_swap_b32 v239, v235
  s_nop 1
  v_add_f32 v232, v232, v236
  v_add_f32 v233, v233, v237
  v_add_f32 v234, v234, v238
  v_add_f32 v235, v235, v239
  v_mov_b32 v236, v232
  v_mov_b32 v237, v233
  v_mov_b32 v238, v234
  v_mov_b32 v239, v235
  s_nop 1
  v_permlane32_swap_b32 v236, v232
  v_permlane32_swap_b32 v237, v233
  v_permlane32_swap_b32 v238, v234
  v_permlane32_swap_b32 v239, v235
  s_nop 1
  v_add_f32 v232, v232, v236
  v_add_f32 v233, v233, v237
  v_add_f32 v234, v234, v238
  v_add_f32 v235, v235, v239
  v_rcp_f32 v232, v232
  v_rcp_f32 v233, v233
  v_rcp_f32 v234, v234
  v_rcp_f32 v235, v235
  s_nop 0
  v_mul_f32 v200, v200, v232
  v_mul_f32 v201, v201, v232
  v_mul_f32 v208, v208, v233
  v_mul_f32 v209, v209, v233
  v_mul_f32 v216, v216, v234
  v_mul_f32 v217, v217, v234
  v_mul_f32 v224, v224, v235
  v_mul_f32 v225, v225, v235
  v_cvt_pk_bf16_f32 v200, v200, 0
  v_cvt_pk_bf16_f32 v201, v201, 0
  v_cvt_pk_bf16_f32 v208, v208, 0
  v_cvt_pk_bf16_f32 v209, v209, 0
  v_cvt_pk_bf16_f32 v216, v216, 0
  v_cvt_pk_bf16_f32 v217, v217, 0
  v_cvt_pk_bf16_f32 v224, v224, 0
  v_cvt_pk_bf16_f32 v225, v225, 0
  v_lshlrev_b32 v200, v122, v200
  v_lshlrev_b32 v201, v122, v201
  v_lshlrev_b32 v208, v122, v208
  v_lshlrev_b32 v209, v122, v209
  v_lshlrev_b32 v216, v122, v216
  v_lshlrev_b32 v217, v122, v217
  v_lshlrev_b32 v224, v122, v224
  v_lshlrev_b32 v225, v122, v225
  v_cndmask_b32_e64 v132, v200, 0, s[44:45]
  v_cndmask_b32_e64 v134, 0, v200, s[44:45]
  v_cndmask_b32_e64 v133, v201, 0, s[46:47]
  v_cndmask_b32_e64 v135, 0, v201, s[46:47]
  v_cndmask_b32_e64 v136, v208, 0, s[44:45]
  v_cndmask_b32_e64 v138, 0, v208, s[44:45]
  v_cndmask_b32_e64 v137, v209, 0, s[46:47]
  v_cndmask_b32_e64 v139, 0, v209, s[46:47]
  v_cndmask_b32_e64 v140, v216, 0, s[44:45]
  v_cndmask_b32_e64 v142, 0, v216, s[44:45]
  v_cndmask_b32_e64 v141, v217, 0, s[46:47]
  v_cndmask_b32_e64 v143, 0, v217, s[46:47]
  v_cndmask_b32_e64 v144, v224, 0, s[44:45]
  v_cndmask_b32_e64 v146, 0, v224, s[44:45]
  v_cndmask_b32_e64 v145, v225, 0, s[46:47]
  v_cndmask_b32_e64 v147, 0, v225, s[46:47]
  s_nop 1
  v_mfma_f32_16x16x32_bf16 v[200:203], v[174:177], v[132:135], 0
  v_mfma_f32_16x16x32_bf16 v[204:207], v[180:183], v[132:135], 0
  v_mfma_f32_16x16x32_bf16 v[208:211], v[186:189], v[136:139], 0
  v_mfma_f32_16x16x32_bf16 v[212:215], v[192:195], v[136:139], 0
  v_mfma_f32_16x16x32_bf16 v[216:219], v[172:175], v[140:143], 0
  v_mfma_f32_16x16x32_bf16 v[220:223], v[178:181], v[140:143], 0
  v_mfma_f32_16x16x32_bf16 v[224:227], v[184:187], v[144:147], 0
  v_mfma_f32_16x16x32_bf16 v[228:231], v[190:193], v[144:147], 0
  s_lshl_b32 s41, s31, 18
  s_add_u32 s42, s41, 131072
  s_nop 1
  v_cvt_pk_bf16_f32 v148, v200, v201
  v_cvt_pk_bf16_f32 v149, v202, v203
  v_cvt_pk_bf16_f32 v150, v204, v205
  v_cvt_pk_bf16_f32 v151, v206, v207
  buffer_store_dwordx4 v[148:151], v105, s[12:15], s41 offen offset:1024 sc1
  v_cvt_pk_bf16_f32 v152, v208, v209
  v_cvt_pk_bf16_f32 v153, v210, v211
  v_cvt_pk_bf16_f32 v154, v212, v213
  v_cvt_pk_bf16_f32 v155, v214, v215
  buffer_store_dwordx4 v[152:155], v105, s[12:15], s42 offen offset:1024 sc1
  v_cvt_pk_bf16_f32 v156, v216, v217
  v_cvt_pk_bf16_f32 v157, v218, v219
  v_cvt_pk_bf16_f32 v158, v220, v221
  v_cvt_pk_bf16_f32 v159, v222, v223
  buffer_store_dwordx4 v[156:159], v105, s[12:15], s41 offen offset:0 sc1
  s_nop 0
  v_cvt_pk_bf16_f32 v160, v224, v225
  v_cvt_pk_bf16_f32 v161, v226, v227
  v_cvt_pk_bf16_f32 v162, v228, v229
  v_cvt_pk_bf16_f32 v163, v230, v231
  buffer_store_dwordx4 v[160:163], v105, s[12:15], s42 offen offset:0 sc1
  s_endpgm
L_slow_14:
  s_mov_b32 s33, 262144
L_spin_18:
  buffer_load_dword v130, v129, s[64:67], 0 offen sc1
  s_waitcnt vmcnt(0)
  v_cmp_ne_u32 vcc, s100, v130
  s_nop 1
  s_cmp_eq_u64 vcc, 0
  s_cbranch_scc1 L_back_15
  s_sub_u32 s33, s33, 1
  s_cmp_lg_u32 s33, 0
  s_cbranch_scc1 L_spin_18
  s_branch L_back_15
L_slow_12:
  s_mov_b32 s33, 262144
L_spin_19:
  buffer_load_dword v130, v131, s[64:67], 0 offen sc1
  s_waitcnt vmcnt(0)
  v_cmp_ne_u32 vcc, s100, v130
  s_nop 1
  s_cmp_eq_u64 vcc, 0
  s_cbranch_scc1 L_back_13
  s_sub_u32 s33, s33, 1
  s_cmp_lg_u32 s33, 0
  s_cbranch_scc1 L_spin_19
  s_branch L_back_13
L_helper_2:
  s_and_b32 s39, s3, 3
  v_and_b32 v3, 255, v128
  v_mov_b32 v101, 1
  v_mov_b32 v102, 63744
  ds_write_b32 v102, v100 offset:8
  v_mov_b32 v96, -1
  v_mov_b32 v97, -1
  v_mov_b32 v98, -1
  v_mov_b32 v99, -1
  v_lshlrev_b32 v95, 2, v104
  s_mov_b32 s12, s20
  s_mov_b32 s13, s21
  s_mov_b32 s14, 0x18000
  s_mov_b32 s15, 0x20000
  s_mov_b32 s44, s92
  s_mov_b32 s45, s93
  s_mov_b32 s46, 0x800
  s_mov_b32 s47, 0x20000
  s_mov_b32 s48, s94
  s_mov_b32 s49, s95
  s_mov_b32 s50, 0xc00000
  s_mov_b32 s51, 0x20000
  s_add_u32 s52, s20, 0x40000
  s_addc_u32 s53, s21, 0
  s_mov_b32 s54, 0x0
  s_mov_b32 s55, 0x20000
  s_add_u32 s56, s20, 0x80000
  s_addc_u32 s57, s21, 0
  s_mov_b32 s58, 0x0
  s_mov_b32 s59, 0x20000
  s_cmp_eq_u32 s39, 1
  s_cselect_b32 s54, 0x40000, 0
  s_cselect_b32 s58, 262144, 0
  s_lshl_b32 s33, s2, 10
  buffer_store_dwordx4 v[96:99], v119, s[52:55], s33 offen sc1
  v_min_u32 v92, 15, v104
  v_lshlrev_b32 v92, 6, v92
  s_lshl_b32 s33, s2, 10
  buffer_store_dword v96, v92, s[56:59], s33 offen sc1
  s_and_b32 s31, s2, 3
  s_lshr_b32 s30, s2, 2
  s_lshl_b32 s33, s31, 8
  v_add_u32 v2, s33, v3
  v_and_b32 v1, -8, v2
  s_movk_i32 s33, 12288
  v_mul_u32_u24 v1, s33, v1
  v_lshlrev_b32 v2, 1, v2
  v_and_b32 v94, 7, v3
  v_lshl_add_u32 v1, v94, 4, v1
  s_mov_b32 s50, 12582912
  s_mul_i32 s34, s31, 24576
  s_lshl_b32 s33, s30, 8
  s_add_u32 s34, s34, s33
  s_add_u32 s34, s34, 8192
  s_lshl_b32 s35, s30, 7
  s_add_u32 s35, s35, 4096
  s_barrier
  s_barrier
  s_barrier
  s_bitcmp1_b32 s3, 0
  s_cselect_b32 s4, s62, s60
  s_cselect_b32 s5, s63, s61
  s_lshl_b32 s6, s2, 1
  s_bfe_u32 s7, s3, 0x10001
  s_add_u32 s6, s6, s7
  s_lshl_b32 s6, s6, 8
  s_add_u32 s4, s4, s6
  s_addc_u32 s5, s5, 0
  s_add_u32 s56, s20, 0x1800000
  s_addc_u32 s57, s21, 0
  s_mov_b32 s58, 0x800000
  s_mov_b32 s59, 0x20000
  s_lshl_b32 s36, s2, 2
  s_add_u32 s36, s36, s39
  s_lshl_b32 s36, s36, 13
  s_mov_b32 s18, 4
L_hl_20:
  s_load_dword s52, s[4:5], 0
  s_load_dword s53, s[4:5], 64
  s_load_dword s54, s[4:5], 128
  s_load_dword s55, s[4:5], 192
  s_add_u32 s4, s4, 131072
  s_addc_u32 s5, s5, 0
  s_barrier
  s_load_dword s52, s[4:5], 0
  s_load_dword s53, s[4:5], 64
  s_load_dword s54, s[4:5], 128
  s_load_dword s55, s[4:5], 192
  s_add_u32 s4, s4, 131072
  s_addc_u32 s5, s5, 0
  s_barrier
  s_load_dword s52, s[4:5], 0
  s_load_dword s53, s[4:5], 64
  s_load_dword s54, s[4:5], 128
  s_load_dword s55, s[4:5], 192
  s_add_u32 s4, s4, 131072
  s_addc_u32 s5, s5, 0
  s_barrier
  s_load_dword s52, s[4:5], 0
  s_load_dword s53, s[4:5], 64
  s_load_dword s54, s[4:5], 128
  s_load_dword s55, s[4:5], 192
  s_add_u32 s4, s4, 131072
  s_addc_u32 s5, s5, 0
  buffer_store_dwordx4 v[96:99], v119, s[56:59], s36 offen sc1
  s_add_u32 s36, s36, 1024
  s_barrier
  s_sub_u32 s18, s18, 1
  s_cmp_lg_u32 s18, 0
  s_cbranch_scc1 L_hl_20
  s_lshl_b32 s33, s2, 3
  s_add_u32 s33, s33, s3
  s_cmp_eq_u32 s33, 71
  s_cselect_b32 s66, 65536, 0
  v_lshlrev_b32 v92, 6, v104
  s_mov_b32 s33, 0
  buffer_load_dword v64, v92, s[64:67], s33 offen sc1
  s_mov_b32 s33, 4096
  buffer_load_dword v65, v92, s[64:67], s33 offen sc1
  s_mov_b32 s33, 8192
  buffer_load_dword v66, v92, s[64:67], s33 offen sc1
  s_mov_b32 s33, 12288
  buffer_load_dword v67, v92, s[64:67], s33 offen sc1
  s_mov_b32 s33, 16384
  buffer_load_dword v68, v92, s[64:67], s33 offen sc1
  s_mov_b32 s33, 20480
  buffer_load_dword v69, v92, s[64:67], s33 offen sc1
  s_mov_b32 s33, 24576
  buffer_load_dword v70, v92, s[64:67], s33 offen sc1
  s_mov_b32 s33, 28672
  buffer_load_dword v71, v92, s[64:67], s33 offen sc1
  s_mov_b32 s33, 32768
  buffer_load_dword v72, v92, s[64:67], s33 offen sc1
  s_mov_b32 s33, 36864
  buffer_load_dword v73, v92, s[64:67], s33 offen sc1
  s_mov_b32 s33, 40960
  buffer_load_dword v74, v92, s[64:67], s33 offen sc1
  s_mov_b32 s33, 45056
  buffer_load_dword v75, v92, s[64:67], s33 offen sc1
  s_mov_b32 s33, 49152
  buffer_load_dword v76, v92, s[64:67], s33 offen sc1
  s_mov_b32 s33, 53248
  buffer_load_dword v77, v92, s[64:67], s33 offen sc1
  s_mov_b32 s33, 57344
  buffer_load_dword v78, v92, s[64:67], s33 offen sc1
  s_mov_b32 s33, 61440
  buffer_load_dword v79, v92, s[64:67], s33 offen sc1
  s_mov_b32 s18, 5
L_hl_21:
  s_load_dword s52, s[4:5], 0
  s_load_dword s53, s[4:5], 64
  s_load_dword s54, s[4:5], 128
  s_load_dword s55, s[4:5], 192
  s_add_u32 s4, s4, 131072
  s_addc_u32 s5, s5, 0
  s_barrier
  s_sub_u32 s18, s18, 1
  s_cmp_lg_u32 s18, 0
  s_cbranch_scc1 L_hl_21
  s_load_dword s52, s[4:5], 0
  s_load_dword s53, s[4:5], 64
  s_load_dword s54, s[4:5], 128
  s_load_dword s55, s[4:5], 192
  s_add_u32 s4, s4, 131072
  s_addc_u32 s5, s5, 0
  s_barrier
  s_load_dword s52, s[4:5], 0
  s_load_dword s53, s[4:5], 64
  s_load_dword s54, s[4:5], 128
  s_load_dword s55, s[4:5], 192
  s_add_u32 s4, s4, 131072
  s_addc_u32 s5, s5, 0
  s_barrier
  s_load_dword s52, s[4:5], 0
  s_load_dword s53, s[4:5], 64
  s_load_dword s54, s[4:5], 128
  s_load_dword s55, s[4:5], 192
  s_add_u32 s4, s4, 131072
  s_addc_u32 s5, s5, 0
  s_barrier
  s_load_dword s52, s[4:5], 0
  s_load_dword s53, s[4:5], 64
  s_load_dword s54, s[4:5], 128
  s_load_dword s55, s[4:5], 192
  s_add_u32 s4, s4, 131072
  s_addc_u32 s5, s5, 0
  s_barrier
  s_load_dword s52, s[4:5], 0
  s_load_dword s53, s[4:5], 64
  s_load_dword s54, s[4:5], 128
  s_load_dword s55, s[4:5], 192
  s_add_u32 s4, s4, 131072
  s_addc_u32 s5, s5, 0
  s_barrier
  s_load_dword s52, s[4:5], 0
  s_load_dword s53, s[4:5], 64
  s_load_dword s54, s[4:5], 128
  s_load_dword s55, s[4:5], 192
  s_add_u32 s4, s4, 131072
  s_addc_u32 s5, s5, 0
  s_barrier
  s_load_dword s52, s[4:5], 0
  s_load_dword s53, s[4:5], 64
  s_load_dword s54, s[4:5], 128
  s_load_dword s55, s[4:5], 192
  s_add_u32 s4, s4, 131072
  s_addc_u32 s5, s5, 0
  s_barrier
  s_barrier
  s_barrier
  s_barrier
  s_cmp_eq_u32 s66, 0
  s_cbranch_scc1 L_end_1
  s_mov_b32 s35, 262144
L_bl_22:
  s_waitcnt vmcnt(0)
  v_xor_b32 v64, s100, v64
  v_xor_b32 v65, s100, v65
  v_xor_b32 v66, s100, v66
  v_xor_b32 v67, s100, v67
  v_xor_b32 v68, s100, v68
  v_xor_b32 v69, s100, v69
  v_xor_b32 v70, s100, v70
  v_xor_b32 v71, s100, v71
  v_xor_b32 v72, s100, v72
  v_xor_b32 v73, s100, v73
  v_xor_b32 v74, s100, v74
  v_xor_b32 v75, s100, v75
  v_xor_b32 v76, s100, v76
  v_xor_b32 v77, s100, v77
  v_xor_b32 v78, s100, v78
  v_xor_b32 v79, s100, v79
  v_or3_b32 v64, v64, v65, v66
  v_or3_b32 v64, v64, v67, v68
  v_or3_b32 v64, v64, v69, v70
  v_or3_b32 v64, v64, v71, v72
  v_or3_b32 v64, v64, v73, v74
  v_or3_b32 v64, v64, v75, v76
  v_or3_b32 v64, v64, v77, v78
  v_or3_b32 v64, v64, v79, v79
  v_cmp_ne_u32 vcc, 0, v64
  s_nop 1
  s_cmp_eq_u64 vcc, 0
  s_cbranch_scc1 L_bok_23
  s_mov_b32 s33, 0
  buffer_load_dword v64, v92, s[64:67], s33 offen sc1
  s_mov_b32 s33, 4096
  buffer_load_dword v65, v92, s[64:67], s33 offen sc1
  s_mov_b32 s33, 8192
  buffer_load_dword v66, v92, s[64:67], s33 offen sc1
  s_mov_b32 s33, 12288
  buffer_load_dword v67, v92, s[64:67], s33 offen sc1
  s_mov_b32 s33, 16384
  buffer_load_dword v68, v92, s[64:67], s33 offen sc1
  s_mov_b32 s33, 20480
  buffer_load_dword v69, v92, s[64:67], s33 offen sc1
  s_mov_b32 s33, 24576
  buffer_load_dword v70, v92, s[64:67], s33 offen sc1
  s_mov_b32 s33, 28672
  buffer_load_dword v71, v92, s[64:67], s33 offen sc1
  s_mov_b32 s33, 32768
  buffer_load_dword v72, v92, s[64:67], s33 offen sc1
  s_mov_b32 s33, 36864
  buffer_load_dword v73, v92, s[64:67], s33 offen sc1
  s_mov_b32 s33, 40960
  buffer_load_dword v74, v92, s[64:67], s33 offen sc1
  s_mov_b32 s33, 45056
  buffer_load_dword v75, v92, s[64:67], s33 offen sc1
  s_mov_b32 s33, 49152
  buffer_load_dword v76, v92, s[64:67], s33 offen sc1
  s_mov_b32 s33, 53248
  buffer_load_dword v77, v92, s[64:67], s33 offen sc1
  s_mov_b32 s33, 57344
  buffer_load_dword v78, v92, s[64:67], s33 offen sc1
  s_mov_b32 s33, 61440
  buffer_load_dword v79, v92, s[64:67], s33 offen sc1
  s_sub_u32 s35, s35, 1
  s_cmp_lg_u32 s35, 0
  s_cbranch_scc1 L_bl_22
L_bok_23:
  s_add_u32 s64, s20, 0xd2d00
  s_addc_u32 s65, s21, 0
  s_mov_b32 s66, 0x40
  s_mov_b32 s67, 0x20000
  v_mov_b32 v93, s100
  buffer_store_dword v93, v92, s[64:67], 0 offen sc1
L_end_1:
  s_endpgm
.globl k5_kernel
.p2align 8
.type k5_kernel,@function
k5_kernel:
  s_cmp_ge_u32 s2, 256
  s_cbranch_scc1 L_end_24
  s_load_dwordx2 s[20:21], s[0:1], 88
  s_load_dwordx2 s[24:25], s[0:1], 16
  s_load_dwordx2 s[26:27], s[0:1], 0
  s_load_dwordx4 s[60:63], s[0:1], 32
  s_load_dwordx2 s[22:23], s[0:1], 48
  s_load_dwordx2 s[90:91], s[0:1], 72
  v_lshrrev_b32 v232, 6, v0
  v_and_b32 v231, 63, v0
  s_nop 0
  v_readfirstlane_b32 s3, v232
  v_and_b32 v32, 63, v0
  s_and_b32 s28, s2, 1
  s_lshr_b32 s29, s2, 3
  s_bfe_u32 s30, s2, 0x20001
  s_lshl_b32 s30, s30, 2
  s_and_b32 s31, s29, 3
  s_add_u32 s30, s30, s31
  s_lshr_b32 s29, s29, 2
  s_lshl_b32 s31, s29, 1
  s_add_u32 s31, s31, s28
  s_lshl_b32 s32, s30, 13
  s_lshl_b32 s33, s3, 11
  s_add_u32 s32, s32, s33
  v_lshlrev_b32 v33, 4, v32
  v_add_u32 v33, s32, v33
  v_add_u32 v34, 131072, v33
  v_lshrrev_b32 v42, 3, v32
  v_and_b32 v43, 6, v42
  v_and_b32 v44, 7, v32
  v_xor_b32 v43, v43, v44
  v_lshlrev_b32 v42, 11, v42
  v_lshl_add_u32 v42, v43, 4, v42
  s_lshl_b32 s32, s3, 15
  s_lshl_b32 s33, s31, 7
  s_add_u32 s32, s32, s33
  v_add_u32 v35, s32, v42
  v_add_u32 v36, 15360, v35
  s_lshl_b32 s38, s3, 11
  s_add_u32 s38, s38, 57344
  s_mov_b32 s16, 0
  s_mov_b32 s17, 0
  s_waitcnt lgkmcnt(0)
  s_mov_b32 s8, s24
  s_mov_b32 s9, s25
  s_mov_b32 s10, 0x200000
  s_mov_b32 s11, 0x20000
  s_add_u32 s4, s20, 0x500000
  s_addc_u32 s5, s21, 0
  s_mov_b32 s6, 0x400000
  s_mov_b32 s7, 0x20000
  s_add_u32 m0, s38, 0
  s_nop 0
  buffer_load_dwordx4 v35, s[8:11], s17 offen lds
  buffer_load_dwordx4 v36, s[8:11], s17 offen offset:1024 lds
  s_add_u32 s17, s17, 131072
  buffer_load_dwordx4 v[120:123], v33, s[4:7], s16 offen offset:0
  buffer_load_dwordx4 v[124:127], v33, s[4:7], s16 offen offset:1024
  buffer_load_dwordx4 v[128:131], v34, s[4:7], s16 offen offset:0
  buffer_load_dwordx4 v[132:135], v34, s[4:7], s16 offen offset:1024
  s_add_u32 s16, s16, 262144
  s_add_u32 m0, s38, 8192
  s_nop 0
  buffer_load_dwordx4 v35, s[8:11], s17 offen lds
  buffer_load_dwordx4 v36, s[8:11], s17 offen offset:1024 lds
  s_add_u32 s17, s17, 131072
  buffer_load_dwordx4 v[136:139], v33, s[4:7], s16 offen offset:0
  buffer_load_dwordx4 v[140:143], v33, s[4:7], s16 offen offset:1024
  buffer_load_dwordx4 v[144:147], v34, s[4:7], s16 offen offset:0
  buffer_load_dwordx4 v[148:151], v34, s[4:7], s16 offen offset:1024
  s_add_u32 s16, s16, 262144
  s_add_u32 m0, s38, 16384
  s_nop 0
  buffer_load_dwordx4 v35, s[8:11], s17 offen lds
  buffer_load_dwordx4 v36, s[8:11], s17 offen offset:1024 lds
  s_add_u32 s17, s17, 131072
  buffer_load_dwordx4 v[152:155], v33, s[4:7], s16 offen offset:0
  buffer_load_dwordx4 v[156:159], v33, s[4:7], s16 offen offset:1024
  buffer_load_dwordx4 v[160:163], v34, s[4:7], s16 offen offset:0
  buffer_load_dwordx4 v[164:167], v34, s[4:7], s16 offen offset:1024
  s_add_u32 s16, s16, 262144
  v_lshrrev_b32 v80, 2, v32
  v_lshlrev_b32 v80, 7, v80
  v_bfe_u32 v81, v32, 3, 2
  v_lshl_add_u32 v80, v81, 5, v80
  v_and_b32 v81, 3, v32
  v_lshl_add_u32 v80, v81, 3, v80
  v_xor_b32 v37, 0, v80
  v_add_u32 v37, 57344, v37
  v_xor_b32 v38, 32, v80
  v_add_u32 v38, 57344, v38
  v_xor_b32 v39, 64, v80
  v_add_u32 v39, 57344, v39
  v_xor_b32 v40, 96, v80
  v_add_u32 v40, 57344, v40
  s_mov_b32 s92, s30
  s_mov_b32 s93, s31
  s_and_b32 s28, s2, 7
  s_lshr_b32 s29, s2, 3
  s_and_b32 s30, s28, 1
  s_lshl_b32 s30, s30, 2
  s_and_b32 s31, s29, 3
  s_add_u32 s30, s30, s31
  s_lshr_b32 s31, s28, 1
  s_lshl_b32 s31, s31, 3
  s_lshr_b32 s29, s29, 2
  s_add_u32 s31, s31, s29
  s_lshl_b32 s32, s30, 14
  s_lshl_b32 s33, s3, 12
  s_add_u32 s32, s32, s33
  v_lshlrev_b32 v224, 4, v231
  v_add_u32 v224, s32, v224
  s_and_b32 s33, s3, 1
  s_mul_i32 s34, s33, 114688
  s_mul_i32 s35, s31, 224
  s_add_u32 s34, s34, s35
  s_movk_i32 s36, 4682
  s_movk_i32 s37, 7168
  s_and_b32 s39, s31, 1
  s_lshl_b32 s39, s39, 1
  v_add_u32 v234, 0, v231
  v_mul_u32_u24 v235, s36, v234
  v_lshrrev_b32 v235, 16, v235
  v_mul_u32_u24 v236, 14, v235
  v_sub_u32 v236, v234, v236
  v_add_u32 v236, s39, v236
  v_subrev_u32 v237, 14, v236
  v_min_u32 v236, v236, v237
  v_mul_u32_u24 v235, s37, v235
  v_lshl_add_u32 v235, v236, 4, v235
  v_add_u32 v235, s34, v235
  v_subrev_u32 v225, 0, v235
  v_add_u32 v234, 64, v231
  v_mul_u32_u24 v235, s36, v234
  v_lshrrev_b32 v235, 16, v235
  v_mul_u32_u24 v236, 14, v235
  v_sub_u32 v236, v234, v236
  v_add_u32 v236, s39, v236
  v_subrev_u32 v237, 14, v236
  v_min_u32 v236, v236, v237
  v_mul_u32_u24 v235, s37, v235
  v_lshl_add_u32 v235, v236, 4, v235
  v_add_u32 v235, s34, v235
  v_subrev_u32 v226, 1024, v235
  v_add_u32 v234, 128, v231
  v_mul_u32_u24 v235, s36, v234
  v_lshrrev_b32 v235, 16, v235
  v_mul_u32_u24 v236, 14, v235
  v_sub_u32 v236, v234, v236
  v_add_u32 v236, s39, v236
  v_subrev_u32 v237, 14, v236
  v_min_u32 v236, v236, v237
  v_mul_u32_u24 v235, s37, v235
  v_lshl_add_u32 v235, v236, 4, v235
  v_add_u32 v235, s34, v235
  v_subrev_u32 v227, 2048, v235
  v_add_u32 v234, 192, v231
  v_mul_u32_u24 v235, s36, v234
  v_lshrrev_b32 v235, 16, v235
  v_mul_u32_u24 v236, 14, v235
  v_sub_u32 v236, v234, v236
  v_add_u32 v236, s39, v236
  v_subrev_u32 v237, 14, v236
  v_min_u32 v236, v236, v237
  v_mul_u32_u24 v235, s37, v235
  v_lshl_add_u32 v235, v236, 4, v235
  v_add_u32 v235, s34, v235
  v_subrev_u32 v228, 3072, v235
  s_mov_b32 s94, s30
  s_mov_b32 s95, s31
  s_mov_b32 s30, s92
  s_mov_b32 s31, s93
  v_and_b32 v42, 15, v32
  v_lshlrev_b32 v41, 11, v42
  v_bfe_u32 v44, v32, 4, 1
  v_lshl_add_u32 v41, v44, 5, v41
  v_lshrrev_b32 v44, 5, v32
  v_lshl_add_u32 v41, v44, 4, v41
  s_lshl_b32 s32, s30, 18
  s_lshl_b32 s33, s3, 16
  s_add_u32 s32, s32, s33
  s_lshl_b32 s33, s31, 7
  s_add_u32 s32, s32, s33
  v_add_u32 v41, s32, v41
  v_mov_b32 v252, v41
  s_lshl_b32 s41, s31, 18
  s_add_u32 s42, s41, 131072
  s_mov_b32 s43, 0x8000
  s_mov_b32 s44, s26
  s_mov_b32 s45, s27
  s_mov_b32 s46, 0x400000
  s_mov_b32 s47, 0x20000
  s_mov_b32 s48, s20
  s_mov_b32 s49, s21
  s_mov_b32 s50, 0x18000
  s_mov_b32 s51, 0x20000
  v_lshrrev_b32 v45, 4, v32
  s_movk_i32 s33, 24576
  v_mul_u32_u24 v45, s33, v45
  v_and_b32 v42, 15, v32
  v_lshl_add_u32 v45, v42, 4, v45
  s_lshl_b32 s34, s31, 8
  s_lshl_b32 s33, s3, 12
  s_add_u32 s34, s34, s33
  s_add_u32 s34, s34, 8192
  s_waitcnt vmcnt(16)
  s_barrier
  ds_read_b64_tr_b16 v[88:89], v37 offset:0
  ds_read_b64_tr_b16 v[90:91], v37 offset:2048
  ds_read_b64_tr_b16 v[92:93], v38 offset:0
  ds_read_b64_tr_b16 v[94:95], v38 offset:2048
  ds_read_b64_tr_b16 v[96:97], v39 offset:0
  ds_read_b64_tr_b16 v[98:99], v39 offset:2048
  ds_read_b64_tr_b16 v[100:101], v40 offset:0
  ds_read_b64_tr_b16 v[102:103], v40 offset:2048
  ds_read_b64_tr_b16 v[104:105], v37 offset:4096
  ds_read_b64_tr_b16 v[106:107], v37 offset:6144
  ds_read_b64_tr_b16 v[108:109], v38 offset:4096
  ds_read_b64_tr_b16 v[110:111], v38 offset:6144
  ds_read_b64_tr_b16 v[112:113], v39 offset:4096
  ds_read_b64_tr_b16 v[114:115], v39 offset:6144
  ds_read_b64_tr_b16 v[116:117], v40 offset:4096
  ds_read_b64_tr_b16 v[118:119], v40 offset:6144
  s_waitcnt vmcnt(10) lgkmcnt(10)
  s_barrier
  s_add_u32 m0, s38, 24576
  s_nop 0
  buffer_load_dwordx4 v35, s[8:11], s17 offen lds
  v_mfma_f32_16x16x32_bf16 v[0:3], v[88:91], v[120:123], 0
  v_mfma_f32_16x16x32_bf16 v[16:19], v[88:91], v[124:127], 0
  ds_read_b64_tr_b16 v[88:89], v37 offset:8192
  v_mfma_f32_16x16x32_bf16 v[4:7], v[92:95], v[120:123], 0
  ds_read_b64_tr_b16 v[90:91], v37 offset:10240
  buffer_load_dwordx4 v36, s[8:11], s17 offen offset:1024 lds
  s_add_u32 s17, s17, 131072
  v_mfma_f32_16x16x32_bf16 v[20:23], v[92:95], v[124:127], 0
  ds_read_b64_tr_b16 v[92:93], v38 offset:8192
  v_mfma_f32_16x16x32_bf16 v[8:11], v[96:99], v[120:123], 0
  ds_read_b64_tr_b16 v[94:95], v38 offset:10240
  buffer_load_dwordx4 v[168:171], v33, s[4:7], s16 offen offset:0
  v_mfma_f32_16x16x32_bf16 v[24:27], v[96:99], v[124:127], 0
  ds_read_b64_tr_b16 v[96:97], v39 offset:8192
  s_waitcnt lgkmcnt(10)
  v_mfma_f32_16x16x32_bf16 v[12:15], v[100:103], v[120:123], 0
  ds_read_b64_tr_b16 v[98:99], v39 offset:10240
  v_mfma_f32_16x16x32_bf16 v[28:31], v[100:103], v[124:127], 0
  ds_read_b64_tr_b16 v[100:101], v40 offset:8192
  buffer_load_dwordx4 v[172:175], v33, s[4:7], s16 offen offset:1024
  v_mfma_f32_16x16x32_bf16 v[0:3], v[104:107], v[128:131], v[0:3]
  ds_read_b64_tr_b16 v[102:103], v40 offset:10240
  v_mfma_f32_16x16x32_bf16 v[16:19], v[104:107], v[132:135], v[16:19]
  ds_read_b64_tr_b16 v[104:105], v37 offset:12288
  buffer_load_dwordx4 v[176:179], v34, s[4:7], s16 offen offset:0
  s_waitcnt lgkmcnt(10)
  v_mfma_f32_16x16x32_bf16 v[4:7], v[108:111], v[128:131], v[4:7]
  ds_read_b64_tr_b16 v[106:107], v37 offset:14336
  v_mfma_f32_16x16x32_bf16 v[20:23], v[108:111], v[132:135], v[20:23]
  ds_read_b64_tr_b16 v[108:109], v38 offset:12288
  v_mfma_f32_16x16x32_bf16 v[8:11], v[112:115], v[128:131], v[8:11]
  ds_read_b64_tr_b16 v[110:111], v38 offset:14336
  buffer_load_dwordx4 v[180:183], v34, s[4:7], s16 offen offset:1024
  s_add_u32 s16, s16, 262144
  v_mfma_f32_16x16x32_bf16 v[24:27], v[112:115], v[132:135], v[24:27]
  ds_read_b64_tr_b16 v[112:113], v39 offset:12288
  s_waitcnt lgkmcnt(10)
  v_mfma_f32_16x16x32_bf16 v[12:15], v[116:119], v[128:131], v[12:15]
  ds_read_b64_tr_b16 v[114:115], v39 offset:14336
  v_mfma_f32_16x16x32_bf16 v[28:31], v[116:119], v[132:135], v[28:31]
  ds_read_b64_tr_b16 v[116:117], v40 offset:12288
  ds_read_b64_tr_b16 v[118:119], v40 offset:14336
  s_waitcnt vmcnt(10) lgkmcnt(10)
  s_barrier
  s_add_u32 m0, s38, 0
  s_nop 0
  buffer_load_dwordx4 v35, s[8:11], s17 offen lds
  v_mfma_f32_16x16x32_bf16 v[0:3], v[88:91], v[136:139], v[0:3]
  v_mfma_f32_16x16x32_bf16 v[16:19], v[88:91], v[140:143], v[16:19]
  ds_read_b64_tr_b16 v[88:89], v37 offset:16384
  v_mfma_f32_16x16x32_bf16 v[4:7], v[92:95], v[136:139], v[4:7]
  ds_read_b64_tr_b16 v[90:91], v37 offset:18432
  buffer_load_dwordx4 v36, s[8:11], s17 offen offset:1024 lds
  s_add_u32 s17, s17, 131072
  v_mfma_f32_16x16x32_bf16 v[20:23], v[92:95], v[140:143], v[20:23]
  ds_read_b64_tr_b16 v[92:93], v38 offset:16384
  v_mfma_f32_16x16x32_bf16 v[8:11], v[96:99], v[136:139], v[8:11]
  ds_read_b64_tr_b16 v[94:95], v38 offset:18432
  buffer_load_dwordx4 v[120:123], v33, s[4:7], s16 offen offset:0
  v_mfma_f32_16x16x32_bf16 v[24:27], v[96:99], v[140:143], v[24:27]
  ds_read_b64_tr_b16 v[96:97], v39 offset:16384
  s_waitcnt lgkmcnt(10)
  v_mfma_f32_16x16x32_bf16 v[12:15], v[100:103], v[136:139], v[12:15]
  ds_read_b64_tr_b16 v[98:99], v39 offset:18432
  v_mfma_f32_16x16x32_bf16 v[28:31], v[100:103], v[140:143], v[28:31]
  ds_read_b64_tr_b16 v[100:101], v40 offset:16384
  buffer_load_dwordx4 v[124:127], v33, s[4:7], s16 offen offset:1024
  v_mfma_f32_16x16x32_bf16 v[0:3], v[104:107], v[144:147], v[0:3]
  ds_read_b64_tr_b16 v[102:103], v40 offset:18432
  v_mfma_f32_16x16x32_bf16 v[16:19], v[104:107], v[148:151], v[16:19]
  ds_read_b64_tr_b16 v[104:105], v37 offset:20480
  buffer_load_dwordx4 v[128:131], v34, s[4:7], s16 offen offset:0
  s_waitcnt lgkmcnt(10)
  v_mfma_f32_16x16x32_bf16 v[4:7], v[108:111], v[144:147], v[4:7]
  ds_read_b64_tr_b16 v[106:107], v37 offset:22528
  v_mfma_f32_16x16x32_bf16 v[20:23], v[108:111], v[148:151], v[20:23]
  ds_read_b64_tr_b16 v[108:109], v38 offset:20480
  v_mfma_f32_16x16x32_bf16 v[8:11], v[112:115], v[144:147], v[8:11]
  ds_read_b64_tr_b16 v[110:111], v38 offset:22528
  buffer_load_dwordx4 v[132:135], v34, s[4:7], s16 offen offset:1024
  s_add_u32 s16, s16, 262144
  v_mfma_f32_16x16x32_bf16 v[24:27], v[112:115], v[148:151], v[24:27]
  ds_read_b64_tr_b16 v[112:113], v39 offset:20480
  s_waitcnt lgkmcnt(10)
  v_mfma_f32_16x16x32_bf16 v[12:15], v[116:119], v[144:147], v[12:15]
  ds_read_b64_tr_b16 v[114:115], v39 offset:22528
  v_mfma_f32_16x16x32_bf16 v[28:31], v[116:119], v[148:151], v[28:31]
  ds_read_b64_tr_b16 v[116:117], v40 offset:20480
  ds_read_b64_tr_b16 v[118:119], v40 offset:22528
  s_waitcnt vmcnt(10) lgkmcnt(10)
  s_barrier
  s_add_u32 m0, s38, 8192
  s_nop 0
  buffer_load_dwordx4 v35, s[8:11], s17 offen lds
  v_mfma_f32_16x16x32_bf16 v[0:3], v[88:91], v[152:155], v[0:3]
  v_mfma_f32_16x16x32_bf16 v[16:19], v[88:91], v[156:159], v[16:19]
  ds_read_b64_tr_b16 v[88:89], v37 offset:24576
  buffer_load_dwordx4 v36, s[8:11], s17 offen offset:1024 lds
  s_add_u32 s17, s17, 131072
  v_mfma_f32_16x16x32_bf16 v[4:7], v[92:95], v[152:155], v[4:7]
  ds_read_b64_tr_b16 v[90:91], v37 offset:26624
  v_mfma_f32_16x16x32_bf16 v[20:23], v[92:95], v[156:159], v[20:23]
  ds_read_b64_tr_b16 v[92:93], v38 offset:24576
  buffer_load_dwordx4 v[136:139], v33, s[4:7], s16 offen offset:0
  v_mfma_f32_16x16x32_bf16 v[8:11], v[96:99], v[152:155], v[8:11]
  ds_read_b64_tr_b16 v[94:95], v38 offset:26624
  v_mfma_f32_16x16x32_bf16 v[24:27], v[96:99], v[156:159], v[24:27]
  ds_read_b64_tr_b16 v[96:97], v39 offset:24576
  buffer_load_dwordx4 v[140:143], v33, s[4:7], s16 offen offset:1024
  s_waitcnt lgkmcnt(10)
  v_mfma_f32_16x16x32_bf16 v[12:15], v[100:103], v[152:155], v[12:15]
  ds_read_b64_tr_b16 v[98:99], v39 offset:26624
  v_mfma_f32_16x16x32_bf16 v[28:31], v[100:103], v[156:159], v[28:31]
  ds_read_b64_tr_b16 v[100:101], v40 offset:24576
  v_mfma_f32_16x16x32_bf16 v[0:3], v[104:107], v[160:163], v[0:3]
  ds_read_b64_tr_b16 v[102:103], v40 offset:26624
  buffer_load_dwordx4 v[144:147], v34, s[4:7], s16 offen offset:0
  v_mfma_f32_16x16x32_bf16 v[16:19], v[104:107], v[164:167], v[16:19]
  ds_read_b64_tr_b16 v[104:105], v37 offset:28672
  s_waitcnt lgkmcnt(10)
  v_mfma_f32_16x16x32_bf16 v[4:7], v[108:111], v[160:163], v[4:7]
  ds_read_b64_tr_b16 v[106:107], v37 offset:30720
  buffer_load_dwordx4 v[148:151], v34, s[4:7], s16 offen offset:1024
  s_add_u32 s16, s16, 262144
  v_mfma_f32_16x16x32_bf16 v[20:23], v[108:111], v[164:167], v[20:23]
  ds_read_b64_tr_b16 v[108:109], v38 offset:28672
  v_mfma_f32_16x16x32_bf16 v[8:11], v[112:115], v[160:163], v[8:11]
  ds_read_b64_tr_b16 v[110:111], v38 offset:30720
  buffer_load_dwordx4 v[184:187], v45, s[48:51], s34 offen
  v_mfma_f32_16x16x32_bf16 v[24:27], v[112:115], v[164:167], v[24:27]
  ds_read_b64_tr_b16 v[112:113], v39 offset:28672
  s_waitcnt lgkmcnt(10)
  v_mfma_f32_16x16x32_bf16 v[12:15], v[116:119], v[160:163], v[12:15]
  ds_read_b64_tr_b16 v[114:115], v39 offset:30720
  v_mfma_f32_16x16x32_bf16 v[28:31], v[116:119], v[164:167], v[28:31]
  ds_read_b64_tr_b16 v[116:117], v40 offset:28672
  ds_read_b64_tr_b16 v[118:119], v40 offset:30720
  s_waitcnt vmcnt(11) lgkmcnt(10)
  s_barrier
  s_add_u32 m0, s38, 16384
  s_nop 0
  buffer_load_dwordx4 v35, s[8:11], s17 offen lds
  v_mfma_f32_16x16x32_bf16 v[0:3], v[88:91], v[168:171], v[0:3]
  v_mfma_f32_16x16x32_bf16 v[16:19], v[88:91], v[172:175], v[16:19]
  ds_read_b64_tr_b16 v[88:89], v37 offset:0
  v_mfma_f32_16x16x32_bf16 v[4:7], v[92:95], v[168:171], v[4:7]
  ds_read_b64_tr_b16 v[90:91], v37 offset:2048
  buffer_load_dwordx4 v36, s[8:11], s17 offen offset:1024 lds
  s_add_u32 s17, s17, 131072
  v_mfma_f32_16x16x32_bf16 v[20:23], v[92:95], v[172:175], v[20:23]
  ds_read_b64_tr_b16 v[92:93], v38 offset:0
  v_mfma_f32_16x16x32_bf16 v[8:11], v[96:99], v[168:171], v[8:11]
  ds_read_b64_tr_b16 v[94:95], v38 offset:2048
  buffer_load_dwordx4 v[152:155], v33, s[4:7], s16 offen offset:0
  v_mfma_f32_16x16x32_bf16 v[24:27], v[96:99], v[172:175], v[24:27]
  ds_read_b64_tr_b16 v[96:97], v39 offset:0
  s_waitcnt lgkmcnt(10)
  v_mfma_f32_16x16x32_bf16 v[12:15], v[100:103], v[168:171], v[12:15]
  ds_read_b64_tr_b16 v[98:99], v39 offset:2048
  v_mfma_f32_16x16x32_bf16 v[28:31], v[100:103], v[172:175], v[28:31]
  ds_read_b64_tr_b16 v[100:101], v40 offset:0
  buffer_load_dwordx4 v[156:159], v33, s[4:7], s16 offen offset:1024
  v_mfma_f32_16x16x32_bf16 v[0:3], v[104:107], v[176:179], v[0:3]
  ds_read_b64_tr_b16 v[102:103], v40 offset:2048
  v_mfma_f32_16x16x32_bf16 v[16:19], v[104:107], v[180:183], v[16:19]
  ds_read_b64_tr_b16 v[104:105], v37 offset:4096
  buffer_load_dwordx4 v[160:163], v34, s[4:7], s16 offen offset:0
  s_waitcnt lgkmcnt(10)
  v_mfma_f32_16x16x32_bf16 v[4:7], v[108:111], v[176:179], v[4:7]
  ds_read_b64_tr_b16 v[106:107], v37 offset:6144
  v_mfma_f32_16x16x32_bf16 v[20:23], v[108:111], v[180:183], v[20:23]
  ds_read_b64_tr_b16 v[108:109], v38 offset:4096
  v_mfma_f32_16x16x32_bf16 v[8:11], v[112:115], v[176:179], v[8:11]
  ds_read_b64_tr_b16 v[110:111], v38 offset:6144
  buffer_load_dwordx4 v[164:167], v34, s[4:7], s16 offen offset:1024
  s_add_u32 s16, s16, 262144
  v_mfma_f32_16x16x32_bf16 v[24:27], v[112:115], v[180:183], v[24:27]
  ds_read_b64_tr_b16 v[112:113], v39 offset:4096
  s_waitcnt lgkmcnt(10)
  v_mfma_f32_16x16x32_bf16 v[12:15], v[116:119], v[176:179], v[12:15]
  ds_read_b64_tr_b16 v[114:115], v39 offset:6144
  v_mfma_f32_16x16x32_bf16 v[28:31], v[116:119], v[180:183], v[28:31]
  ds_read_b64_tr_b16 v[116:117], v40 offset:4096
  ds_read_b64_tr_b16 v[118:119], v40 offset:6144
  s_waitcnt vmcnt(11) lgkmcnt(10)
  s_barrier
  s_add_u32 m0, s38, 24576
  s_nop 0
  buffer_load_dwordx4 v35, s[8:11], s17 offen lds
  v_mfma_f32_16x16x32_bf16 v[0:3], v[88:91], v[120:123], v[0:3]
  v_mfma_f32_16x16x32_bf16 v[16:19], v[88:91], v[124:127], v[16:19]
  ds_read_b64_tr_b16 v[88:89], v37 offset:8192
  v_mfma_f32_16x16x32_bf16 v[4:7], v[92:95], v[120:123], v[4:7]
  ds_read_b64_tr_b16 v[90:91], v37 offset:10240
  buffer_load_dwordx4 v36, s[8:11], s17 offen offset:1024 lds
  s_add_u32 s17, s17, 131072
  v_mfma_f32_16x16x32_bf16 v[20:23], v[92:95], v[124:127], v[20:23]
  ds_read_b64_tr_b16 v[92:93], v38 offset:8192
  v_mfma_f32_16x16x32_bf16 v[8:11], v[96:99], v[120:123], v[8:11]
  ds_read_b64_tr_b16 v[94:95], v38 offset:10240
  buffer_load_dwordx4 v[168:171], v33, s[4:7], s16 offen offset:0
  v_mfma_f32_16x16x32_bf16 v[24:27], v[96:99], v[124:127], v[24:27]
  ds_read_b64_tr_b16 v[96:97], v39 offset:8192
  s_waitcnt lgkmcnt(10)
  v_mfma_f32_16x16x32_bf16 v[12:15], v[100:103], v[120:123], v[12:15]
  ds_read_b64_tr_b16 v[98:99], v39 offset:10240
  v_mfma_f32_16x16x32_bf16 v[28:31], v[100:103], v[124:127], v[28:31]
  ds_read_b64_tr_b16 v[100:101], v40 offset:8192
  buffer_load_dwordx4 v[172:175], v33, s[4:7], s16 offen offset:1024
  v_mfma_f32_16x16x32_bf16 v[0:3], v[104:107], v[128:131], v[0:3]
  ds_read_b64_tr_b16 v[102:103], v40 offset:10240
  v_mfma_f32_16x16x32_bf16 v[16:19], v[104:107], v[132:135], v[16:19]
  ds_read_b64_tr_b16 v[104:105], v37 offset:12288
  buffer_load_dwordx4 v[176:179], v34, s[4:7], s16 offen offset:0
  s_waitcnt lgkmcnt(10)
  v_mfma_f32_16x16x32_bf16 v[4:7], v[108:111], v[128:131], v[4:7]
  ds_read_b64_tr_b16 v[106:107], v37 offset:14336
  v_mfma_f32_16x16x32_bf16 v[20:23], v[108:111], v[132:135], v[20:23]
  ds_read_b64_tr_b16 v[108:109], v38 offset:12288
  v_mfma_f32_16x16x32_bf16 v[8:11], v[112:115], v[128:131], v[8:11]
  ds_read_b64_tr_b16 v[110:111], v38 offset:14336
  buffer_load_dwordx4 v[180:183], v34, s[4:7], s16 offen offset:1024
  s_add_u32 s16, s16, 262144
  v_mfma_f32_16x16x32_bf16 v[24:27], v[112:115], v[132:135], v[24:27]
  ds_read_b64_tr_b16 v[112:113], v39 offset:12288
  s_waitcnt lgkmcnt(10)
  v_mfma_f32_16x16x32_bf16 v[12:15], v[116:119], v[128:131], v[12:15]
  ds_read_b64_tr_b16 v[114:115], v39 offset:14336
  v_mfma_f32_16x16x32_bf16 v[28:31], v[116:119], v[132:135], v[28:31]
  ds_read_b64_tr_b16 v[116:117], v40 offset:12288
  ds_read_b64_tr_b16 v[118:119], v40 offset:14336
  s_waitcnt vmcnt(10) lgkmcnt(10)
  s_barrier
  s_add_u32 m0, s38, 0
  s_nop 0
  buffer_load_dwordx4 v35, s[8:11], s17 offen lds
  v_mfma_f32_16x16x32_bf16 v[0:3], v[88:91], v[136:139], v[0:3]
  v_mfma_f32_16x16x32_bf16 v[16:19], v[88:91], v[140:143], v[16:19]
  ds_read_b64_tr_b16 v[88:89], v37 offset:16384
  v_mov_b32 v188, v184
  v_mov_b32 v189, v185
  v_mov_b32 v190, v186
  v_mov_b32 v191, v187
  s_nop 1
  v_permlane16_swap_b32 v188, v184
  v_permlane16_swap_b32 v189, v185
  v_permlane16_swap_b32 v190, v186
  v_permlane16_swap_b32 v191, v187
  s_nop 1
  v_add_f32 v184, v184, v188
  v_add_f32 v185, v185, v189
  v_add_f32 v186, v186, v190
  v_add_f32 v187, v187, v191
  v_mov_b32 v188, v184
  v_mov_b32 v189, v185
  v_mov_b32 v190, v186
  v_mov_b32 v191, v187
  s_nop 1
  v_permlane32_swap_b32 v188, v184
  v_permlane32_swap_b32 v189, v185
  v_permlane32_swap_b32 v190, v186
  v_permlane32_swap_b32 v191, v187
  s_nop 1
  v_add_f32 v184, v184, v188
  v_add_f32 v185, v185, v189
  v_add_f32 v186, v186, v190
  v_add_f32 v187, v187, v191
  v_cvt_pk_bf16_f32 v188, v184, v185
  v_lshlrev_b32 v184, 16, v188
  v_and_b32 v185, 0xffff0000, v188
  v_cvt_pk_bf16_f32 v189, v186, v187
  v_lshlrev_b32 v186, 16, v189
  v_and_b32 v187, 0xffff0000, v189
  s_cmp_eq_u32 s3, 2
  s_cselect_b32 s33, 1.0, 0
  v_add_f32 v184, s33, v184
  v_add_f32 v185, s33, v185
  v_add_f32 v186, s33, v186
  v_add_f32 v187, s33, v187
  v_cvt_pk_bf16_f32 v188, v184, v185
  v_lshlrev_b32 v184, 16, v188
  v_and_b32 v185, 0xffff0000, v188
  v_cvt_pk_bf16_f32 v189, v186, v187
  v_lshlrev_b32 v186, 16, v189
  v_and_b32 v187, 0xffff0000, v189
  v_and_b32 v188, 15, v32
  v_lshlrev_b32 v188, 4, v188
  s_lshl_b32 s33, s3, 8
  s_add_u32 s33, s33, 122880
  v_add_u32 v188, s33, v188
  ds_write_b128 v188, v[184:187]
  v_mfma_f32_16x16x32_bf16 v[4:7], v[92:95], v[136:139], v[4:7]
  ds_read_b64_tr_b16 v[90:91], v37 offset:18432
  buffer_load_dwordx4 v36, s[8:11], s17 offen offset:1024 lds
  s_add_u32 s17, s17, 131072
  v_mfma_f32_16x16x32_bf16 v[20:23], v[92:95], v[140:143], v[20:23]
  ds_read_b64_tr_b16 v[92:93], v38 offset:16384
  v_mfma_f32_16x16x32_bf16 v[8:11], v[96:99], v[136:139], v[8:11]
  ds_read_b64_tr_b16 v[94:95], v38 offset:18432
  buffer_load_dwordx4 v[120:123], v33, s[4:7], s16 offen offset:0
  v_mfma_f32_16x16x32_bf16 v[24:27], v[96:99], v[140:143], v[24:27]
  ds_read_b64_tr_b16 v[96:97], v39 offset:16384
  s_waitcnt lgkmcnt(10)
  v_mfma_f32_16x16x32_bf16 v[12:15], v[100:103], v[136:139], v[12:15]
  ds_read_b64_tr_b16 v[98:99], v39 offset:18432
  v_mfma_f32_16x16x32_bf16 v[28:31], v[100:103], v[140:143], v[28:31]
  ds_read_b64_tr_b16 v[100:101], v40 offset:16384
  buffer_load_dwordx4 v[124:127], v33, s[4:7], s16 offen offset:1024
  v_mfma_f32_16x16x32_bf16 v[0:3], v[104:107], v[144:147], v[0:3]
  ds_read_b64_tr_b16 v[102:103], v40 offset:18432
  v_mfma_f32_16x16x32_bf16 v[16:19], v[104:107], v[148:151], v[16:19]
  ds_read_b64_tr_b16 v[104:105], v37 offset:20480
  buffer_load_dwordx4 v[128:131], v34, s[4:7], s16 offen offset:0
  v_mfma_f32_16x16x32_bf16 v[4:7], v[108:111], v[144:147], v[4:7]
  ds_read_b64_tr_b16 v[106:107], v37 offset:22528
  v_mfma_f32_16x16x32_bf16 v[20:23], v[108:111], v[148:151], v[20:23]
  ds_read_b64_tr_b16 v[108:109], v38 offset:20480
  s_waitcnt lgkmcnt(10)
  v_mfma_f32_16x16x32_bf16 v[8:11], v[112:115], v[144:147], v[8:11]
  ds_read_b64_tr_b16 v[110:111], v38 offset:22528
  buffer_load_dwordx4 v[132:135], v34, s[4:7], s16 offen offset:1024
  s_add_u32 s16, s16, 262144
  v_mfma_f32_16x16x32_bf16 v[24:27], v[112:115], v[148:151], v[24:27]
  ds_read_b64_tr_b16 v[112:113], v39 offset:20480
  v_mfma_f32_16x16x32_bf16 v[12:15], v[116:119], v[144:147], v[12:15]
  ds_read_b64_tr_b16 v[114:115], v39 offset:22528
  v_mfma_f32_16x16x32_bf16 v[28:31], v[116:119], v[148:151], v[28:31]
  ds_read_b64_tr_b16 v[116:117], v40 offset:20480
  ds_read_b64_tr_b16 v[118:119], v40 offset:22528
  s_waitcnt vmcnt(10) lgkmcnt(10)
  s_barrier
  s_add_u32 m0, s38, 8192
  s_nop 0
  buffer_load_dwordx4 v35, s[8:11], s17 offen lds
  v_mfma_f32_16x16x32_bf16 v[0:3], v[88:91], v[152:155], v[0:3]
  v_mfma_f32_16x16x32_bf16 v[16:19], v[88:91], v[156:159], v[16:19]
  ds_read_b64_tr_b16 v[88:89], v37 offset:24576
  v_lshrrev_b32 v45, 4, v32
  v_lshlrev_b32 v45, 4, v45
  v_add_u32 v45, 122880, v45
  v_mov_b32 v253, v45
  buffer_load_dwordx4 v36, s[8:11], s17 offen offset:1024 lds
  s_add_u32 s17, s17, 131072
  v_mfma_f32_16x16x32_bf16 v[4:7], v[92:95], v[152:155], v[4:7]
  ds_read_b64_tr_b16 v[90:91], v37 offset:26624
  v_mfma_f32_16x16x32_bf16 v[20:23], v[92:95], v[156:159], v[20:23]
  ds_read_b64_tr_b16 v[92:93], v38 offset:24576
  buffer_load_dwordx4 v[136:139], v33, s[4:7], s16 offen offset:0
  v_mfma_f32_16x16x32_bf16 v[8:11], v[96:99], v[152:155], v[8:11]
  ds_read_b64_tr_b16 v[94:95], v38 offset:26624
  v_mfma_f32_16x16x32_bf16 v[24:27], v[96:99], v[156:159], v[24:27]
  ds_read_b64_tr_b16 v[96:97], v39 offset:24576
  buffer_load_dwordx4 v[140:143], v33, s[4:7], s16 offen offset:1024
  s_waitcnt lgkmcnt(10)
  v_mfma_f32_16x16x32_bf16 v[12:15], v[100:103], v[152:155], v[12:15]
  ds_read_b64_tr_b16 v[98:99], v39 offset:26624
  v_mfma_f32_16x16x32_bf16 v[28:31], v[100:103], v[156:159], v[28:31]
  ds_read_b64_tr_b16 v[100:101], v40 offset:24576
  v_mfma_f32_16x16x32_bf16 v[0:3], v[104:107], v[160:163], v[0:3]
  ds_read_b64_tr_b16 v[102:103], v40 offset:26624
  buffer_load_dwordx4 v[144:147], v34, s[4:7], s16 offen offset:0
  v_mfma_f32_16x16x32_bf16 v[16:19], v[104:107], v[164:167], v[16:19]
  ds_read_b64_tr_b16 v[104:105], v37 offset:28672
  s_waitcnt lgkmcnt(10)
  v_mfma_f32_16x16x32_bf16 v[4:7], v[108:111], v[160:163], v[4:7]
  ds_read_b64_tr_b16 v[106:107], v37 offset:30720
  buffer_load_dwordx4 v[148:151], v34, s[4:7], s16 offen offset:1024
  s_add_u32 s16, s16, 262144
  v_mfma_f32_16x16x32_bf16 v[20:23], v[108:111], v[164:167], v[20:23]
  ds_read_b64_tr_b16 v[108:109], v38 offset:28672
  v_mfma_f32_16x16x32_bf16 v[8:11], v[112:115], v[160:163], v[8:11]
  ds_read_b64_tr_b16 v[110:111], v38 offset:30720
  buffer_load_dwordx4 v[48:51], v41, s[44:47], 0 offen offset:0
  buffer_load_dwordx4 v[52:55], v41, s[44:47], 0 offen offset:64
  v_mfma_f32_16x16x32_bf16 v[24:27], v[112:115], v[164:167], v[24:27]
  ds_read_b64_tr_b16 v[112:113], v39 offset:28672
  s_waitcnt lgkmcnt(10)
  v_mfma_f32_16x16x32_bf16 v[12:15], v[116:119], v[160:163], v[12:15]
  ds_read_b64_tr_b16 v[114:115], v39 offset:30720
  v_mfma_f32_16x16x32_bf16 v[28:31], v[116:119], v[164:167], v[28:31]
  ds_read_b64_tr_b16 v[116:117], v40 offset:28672
  ds_read_b64_tr_b16 v[118:119], v40 offset:30720
  s_waitcnt vmcnt(12) lgkmcnt(10)
  s_barrier
  s_add_u32 m0, s38, 16384
  s_nop 0
  buffer_load_dwordx4 v35, s[8:11], s17 offen lds
  v_mfma_f32_16x16x32_bf16 v[0:3], v[88:91], v[168:171], v[0:3]
  v_mfma_f32_16x16x32_bf16 v[16:19], v[88:91], v[172:175], v[16:19]
  ds_read_b64_tr_b16 v[88:89], v37 offset:0
  buffer_load_dwordx4 v36, s[8:11], s17 offen offset:1024 lds
  s_add_u32 s17, s17, 131072
  v_mfma_f32_16x16x32_bf16 v[4:7], v[92:95], v[168:171], v[4:7]
  ds_read_b64_tr_b16 v[90:91], v37 offset:2048
  v_mfma_f32_16x16x32_bf16 v[20:23], v[92:95], v[172:175], v[20:23]
  ds_read_b64_tr_b16 v[92:93], v38 offset:0
  buffer_load_dwordx4 v[152:155], v33, s[4:7], s16 offen offset:0
  v_mfma_f32_16x16x32_bf16 v[8:11], v[96:99], v[168:171], v[8:11]
  ds_read_b64_tr_b16 v[94:95], v38 offset:2048
  v_mfma_f32_16x16x32_bf16 v[24:27], v[96:99], v[172:175], v[24:27]
  ds_read_b64_tr_b16 v[96:97], v39 offset:0
  buffer_load_dwordx4 v[156:159], v33, s[4:7], s16 offen offset:1024
  s_waitcnt lgkmcnt(10)
  v_mfma_f32_16x16x32_bf16 v[12:15], v[100:103], v[168:171], v[12:15]
  ds_read_b64_tr_b16 v[98:99], v39 offset:2048
  v_mfma_f32_16x16x32_bf16 v[28:31], v[100:103], v[172:175], v[28:31]
  ds_read_b64_tr_b16 v[100:101], v40 offset:0
  v_mfma_f32_16x16x32_bf16 v[0:3], v[104:107], v[176:179], v[0:3]
  ds_read_b64_tr_b16 v[102:103], v40 offset:2048
  buffer_load_dwordx4 v[160:163], v34, s[4:7], s16 offen offset:0
  v_mfma_f32_16x16x32_bf16 v[16:19], v[104:107], v[180:183], v[16:19]
  ds_read_b64_tr_b16 v[104:105], v37 offset:4096
  s_waitcnt lgkmcnt(10)
  v_mfma_f32_16x16x32_bf16 v[4:7], v[108:111], v[176:179], v[4:7]
  ds_read_b64_tr_b16 v[106:107], v37 offset:6144
  buffer_load_dwordx4 v[164:167], v34, s[4:7], s16 offen offset:1024
  s_add_u32 s16, s16, 262144
  v_mfma_f32_16x16x32_bf16 v[20:23], v[108:111], v[180:183], v[20:23]
  ds_read_b64_tr_b16 v[108:109], v38 offset:4096
  v_mfma_f32_16x16x32_bf16 v[8:11], v[112:115], v[176:179], v[8:11]
  ds_read_b64_tr_b16 v[110:111], v38 offset:6144
  buffer_load_dwordx4 v[56:59], v41, s[44:47], s43 offen offset:0
  buffer_load_dwordx4 v[60:63], v41, s[44:47], s43 offen offset:64
  v_mfma_f32_16x16x32_bf16 v[24:27], v[112:115], v[180:183], v[24:27]
  ds_read_b64_tr_b16 v[112:113], v39 offset:4096
  s_waitcnt lgkmcnt(10)
  v_mfma_f32_16x16x32_bf16 v[12:15], v[116:119], v[176:179], v[12:15]
  ds_read_b64_tr_b16 v[114:115], v39 offset:6144
  v_mfma_f32_16x16x32_bf16 v[28:31], v[116:119], v[180:183], v[28:31]
  ds_read_b64_tr_b16 v[116:117], v40 offset:4096
  ds_read_b64_tr_b16 v[118:119], v40 offset:6144
  s_waitcnt vmcnt(14) lgkmcnt(10)
  s_barrier
  s_add_u32 m0, s38, 24576
  s_nop 0
  buffer_load_dwordx4 v35, s[8:11], s17 offen lds
  v_mfma_f32_16x16x32_bf16 v[0:3], v[88:91], v[120:123], v[0:3]
  v_mfma_f32_16x16x32_bf16 v[16:19], v[88:91], v[124:127], v[16:19]
  ds_read_b64_tr_b16 v[88:89], v37 offset:8192
  v_mfma_f32_16x16x32_bf16 v[4:7], v[92:95], v[120:123], v[4:7]
  ds_read_b64_tr_b16 v[90:91], v37 offset:10240
  ds_read_b128 v[64:67], v45 offset:0
  buffer_load_dwordx4 v36, s[8:11], s17 offen offset:1024 lds
  s_add_u32 s17, s17, 131072
  v_mfma_f32_16x16x32_bf16 v[20:23], v[92:95], v[124:127], v[20:23]
  ds_read_b64_tr_b16 v[92:93], v38 offset:8192
  v_mfma_f32_16x16x32_bf16 v[8:11], v[96:99], v[120:123], v[8:11]
  ds_read_b64_tr_b16 v[94:95], v38 offset:10240
  buffer_load_dwordx4 v[168:171], v33, s[4:7], s16 offen offset:0
  v_mfma_f32_16x16x32_bf16 v[24:27], v[96:99], v[124:127], v[24:27]
  ds_read_b64_tr_b16 v[96:97], v39 offset:8192
  ds_read_b128 v[68:71], v45 offset:64
  s_waitcnt lgkmcnt(10)
  v_mfma_f32_16x16x32_bf16 v[12:15], v[100:103], v[120:123], v[12:15]
  ds_read_b64_tr_b16 v[98:99], v39 offset:10240
  v_mfma_f32_16x16x32_bf16 v[28:31], v[100:103], v[124:127], v[28:31]
  ds_read_b64_tr_b16 v[100:101], v40 offset:8192
  buffer_load_dwordx4 v[172:175], v33, s[4:7], s16 offen offset:1024
  v_mfma_f32_16x16x32_bf16 v[0:3], v[104:107], v[128:131], v[0:3]
  ds_read_b64_tr_b16 v[102:103], v40 offset:10240
  ds_read_b128 v[72:75], v45 offset:128
  v_mfma_f32_16x16x32_bf16 v[16:19], v[104:107], v[132:135], v[16:19]
  ds_read_b64_tr_b16 v[104:105], v37 offset:12288
  buffer_load_dwordx4 v[176:179], v34, s[4:7], s16 offen offset:0
  v_mfma_f32_16x16x32_bf16 v[4:7], v[108:111], v[128:131], v[4:7]
  ds_read_b64_tr_b16 v[106:107], v37 offset:14336
  v_mfma_f32_16x16x32_bf16 v[20:23], v[108:111], v[132:135], v[20:23]
  ds_read_b64_tr_b16 v[108:109], v38 offset:12288
  ds_read_b128 v[76:79], v45 offset:192
  s_waitcnt lgkmcnt(10)
  v_mfma_f32_16x16x32_bf16 v[8:11], v[112:115], v[128:131], v[8:11]
  ds_read_b64_tr_b16 v[110:111], v38 offset:14336
  buffer_load_dwordx4 v[180:183], v34, s[4:7], s16 offen offset:1024
  s_add_u32 s16, s16, 262144
  v_mfma_f32_16x16x32_bf16 v[24:27], v[112:115], v[132:135], v[24:27]
  ds_read_b64_tr_b16 v[112:113], v39 offset:12288
  v_mfma_f32_16x16x32_bf16 v[12:15], v[116:119], v[128:131], v[12:15]
  ds_read_b64_tr_b16 v[114:115], v39 offset:14336
  v_mfma_f32_16x16x32_bf16 v[28:31], v[116:119], v[132:135], v[28:31]
  ds_read_b64_tr_b16 v[116:117], v40 offset:12288
  ds_read_b64_tr_b16 v[118:119], v40 offset:14336
  s_waitcnt vmcnt(12) lgkmcnt(10)
  s_barrier
  s_add_u32 m0, s38, 0
  s_nop 0
  buffer_load_dwordx4 v35, s[8:11], s17 offen lds
  v_mfma_f32_16x16x32_bf16 v[0:3], v[88:91], v[136:139], v[0:3]
  v_mfma_f32_16x16x32_bf16 v[16:19], v[88:91], v[140:143], v[16:19]
  ds_read_b64_tr_b16 v[88:89], v37 offset:16384
  v_mfma_f32_16x16x32_bf16 v[4:7], v[92:95], v[136:139], v[4:7]
  ds_read_b64_tr_b16 v[90:91], v37 offset:18432
  ds_read_b128 v[184:187], v45 offset:256
  buffer_load_dwordx4 v36, s[8:11], s17 offen offset:1024 lds
  s_add_u32 s17, s17, 131072
  v_mfma_f32_16x16x32_bf16 v[20:23], v[92:95], v[140:143], v[20:23]
  ds_read_b64_tr_b16 v[92:93], v38 offset:16384
  v_mfma_f32_16x16x32_bf16 v[8:11], v[96:99], v[136:139], v[8:11]
  ds_read_b64_tr_b16 v[94:95], v38 offset:18432
  buffer_load_dwordx4 v[120:123], v33, s[4:7], s16 offen offset:0
  v_mfma_f32_16x16x32_bf16 v[24:27], v[96:99], v[140:143], v[24:27]
  ds_read_b64_tr_b16 v[96:97], v39 offset:16384
  ds_read_b128 v[188:191], v45 offset:320
  v_mfma_f32_16x16x32_bf16 v[12:15], v[100:103], v[136:139], v[12:15]
  ds_read_b64_tr_b16 v[98:99], v39 offset:18432
  v_mfma_f32_16x16x32_bf16 v[28:31], v[100:103], v[140:143], v[28:31]
  ds_read_b64_tr_b16 v[100:101], v40 offset:16384
  buffer_load_dwordx4 v[124:127], v33, s[4:7], s16 offen offset:1024
  s_waitcnt lgkmcnt(10)
  v_mfma_f32_16x16x32_bf16 v[0:3], v[104:107], v[144:147], v[0:3]
  ds_read_b64_tr_b16 v[102:103], v40 offset:18432
  ds_read_b128 v[192:195], v45 offset:384
  v_mfma_f32_16x16x32_bf16 v[16:19], v[104:107], v[148:151], v[16:19]
  ds_read_b64_tr_b16 v[104:105], v37 offset:20480
  buffer_load_dwordx4 v[128:131], v34, s[4:7], s16 offen offset:0
  v_mfma_f32_16x16x32_bf16 v[4:7], v[108:111], v[144:147], v[4:7]
  ds_read_b64_tr_b16 v[106:107], v37 offset:22528
  v_mfma_f32_16x16x32_bf16 v[20:23], v[108:111], v[148:151], v[20:23]
  ds_read_b64_tr_b16 v[108:109], v38 offset:20480
  ds_read_b128 v[196:199], v45 offset:448
  v_mfma_f32_16x16x32_bf16 v[8:11], v[112:115], v[144:147], v[8:11]
  ds_read_b64_tr_b16 v[110:111], v38 offset:22528
  buffer_load_dwordx4 v[132:135], v34, s[4:7], s16 offen offset:1024
  s_add_u32 s16, s16, 262144
  v_mfma_f32_16x16x32_bf16 v[24:27], v[112:115], v[148:151], v[24:27]
  ds_read_b64_tr_b16 v[112:113], v39 offset:20480
  s_waitcnt lgkmcnt(10)
  v_mfma_f32_16x16x32_bf16 v[12:15], v[116:119], v[144:147], v[12:15]
  ds_read_b64_tr_b16 v[114:115], v39 offset:22528
  v_mfma_f32_16x16x32_bf16 v[28:31], v[116:119], v[148:151], v[28:31]
  ds_read_b64_tr_b16 v[116:117], v40 offset:20480
  ds_read_b64_tr_b16 v[118:119], v40 offset:22528
  s_waitcnt vmcnt(10) lgkmcnt(10)
  s_barrier
  s_add_u32 m0, s38, 8192
  s_nop 0
  buffer_load_dwordx4 v35, s[8:11], s17 offen lds
  v_mfma_f32_16x16x32_bf16 v[0:3], v[88:91], v[152:155], v[0:3]
  v_mfma_f32_16x16x32_bf16 v[16:19], v[88:91], v[156:159], v[16:19]
  ds_read_b64_tr_b16 v[88:89], v37 offset:24576
  v_mfma_f32_16x16x32_bf16 v[4:7], v[92:95], v[152:155], v[4:7]
  ds_read_b64_tr_b16 v[90:91], v37 offset:26624
  ds_read_b128 v[200:203], v45 offset:512
  buffer_load_dwordx4 v36, s[8:11], s17 offen offset:1024 lds
  s_add_u32 s17, s17, 131072
  v_mfma_f32_16x16x32_bf16 v[20:23], v[92:95], v[156:159], v[20:23]
  ds_read_b64_tr_b16 v[92:93], v38 offset:24576
  v_mfma_f32_16x16x32_bf16 v[8:11], v[96:99], v[152:155], v[8:11]
  ds_read_b64_tr_b16 v[94:95], v38 offset:26624
  buffer_load_dwordx4 v[136:139], v33, s[4:7], s16 offen offset:0
  v_mfma_f32_16x16x32_bf16 v[24:27], v[96:99], v[156:159], v[24:27]
  ds_read_b64_tr_b16 v[96:97], v39 offset:24576
  ds_read_b128 v[204:207], v45 offset:576
  v_mfma_f32_16x16x32_bf16 v[12:15], v[100:103], v[152:155], v[12:15]
  ds_read_b64_tr_b16 v[98:99], v39 offset:26624
  v_mfma_f32_16x16x32_bf16 v[28:31], v[100:103], v[156:159], v[28:31]
  ds_read_b64_tr_b16 v[100:101], v40 offset:24576
  buffer_load_dwordx4 v[140:143], v33, s[4:7], s16 offen offset:1024
  s_waitcnt lgkmcnt(10)
  v_mfma_f32_16x16x32_bf16 v[0:3], v[104:107], v[160:163], v[0:3]
  ds_read_b64_tr_b16 v[102:103], v40 offset:26624
  ds_read_b128 v[208:211], v45 offset:640
  v_mfma_f32_16x16x32_bf16 v[16:19], v[104:107], v[164:167], v[16:19]
  ds_read_b64_tr_b16 v[104:105], v37 offset:28672
  buffer_load_dwordx4 v[144:147], v34, s[4:7], s16 offen offset:0
  v_mfma_f32_16x16x32_bf16 v[4:7], v[108:111], v[160:163], v[4:7]
  ds_read_b64_tr_b16 v[106:107], v37 offset:30720
  v_mfma_f32_16x16x32_bf16 v[20:23], v[108:111], v[164:167], v[20:23]
  ds_read_b64_tr_b16 v[108:109], v38 offset:28672
  ds_read_b128 v[212:215], v45 offset:704
  v_mfma_f32_16x16x32_bf16 v[8:11], v[112:115], v[160:163], v[8:11]
  ds_read_b64_tr_b16 v[110:111], v38 offset:30720
  buffer_load_dwordx4 v[148:151], v34, s[4:7], s16 offen offset:1024
  s_add_u32 s16, s16, 262144
  v_mfma_f32_16x16x32_bf16 v[24:27], v[112:115], v[164:167], v[24:27]
  ds_read_b64_tr_b16 v[112:113], v39 offset:28672
  s_waitcnt lgkmcnt(10)
  v_mfma_f32_16x16x32_bf16 v[12:15], v[116:119], v[160:163], v[12:15]
  ds_read_b64_tr_b16 v[114:115], v39 offset:30720
  v_mfma_f32_16x16x32_bf16 v[28:31], v[116:119], v[164:167], v[28:31]
  ds_read_b64_tr_b16 v[116:117], v40 offset:28672
  ds_read_b64_tr_b16 v[118:119], v40 offset:30720
  s_waitcnt vmcnt(10) lgkmcnt(10)
  s_barrier
  s_add_u32 m0, s38, 16384
  s_nop 0
  buffer_load_dwordx4 v35, s[8:11], s17 offen lds
  v_mfma_f32_16x16x32_bf16 v[0:3], v[88:91], v[168:171], v[0:3]
  v_mfma_f32_16x16x32_bf16 v[16:19], v[88:91], v[172:175], v[16:19]
  ds_read_b64_tr_b16 v[88:89], v37 offset:0
  v_permlane16_swap_b32 v48, v50
  v_permlane16_swap_b32 v49, v51
  v_permlane16_swap_b32 v52, v54
  v_permlane16_swap_b32 v53, v55
  v_permlane16_swap_b32 v56, v58
  v_permlane16_swap_b32 v57, v59
  v_permlane16_swap_b32 v60, v62
  v_permlane16_swap_b32 v61, v63
  v_mfma_f32_16x16x32_bf16 v[4:7], v[92:95], v[168:171], v[4:7]
  ds_read_b64_tr_b16 v[90:91], v37 offset:2048
  buffer_load_dwordx4 v36, s[8:11], s17 offen offset:1024 lds
  s_add_u32 s17, s17, 131072
  v_mfma_f32_16x16x32_bf16 v[20:23], v[92:95], v[172:175], v[20:23]
  ds_read_b64_tr_b16 v[92:93], v38 offset:0
  v_mfma_f32_16x16x32_bf16 v[8:11], v[96:99], v[168:171], v[8:11]
  ds_read_b64_tr_b16 v[94:95], v38 offset:2048
  buffer_load_dwordx4 v[152:155], v33, s[4:7], s16 offen offset:0
  v_mfma_f32_16x16x32_bf16 v[24:27], v[96:99], v[172:175], v[24:27]
  ds_read_b64_tr_b16 v[96:97], v39 offset:0
  v_mfma_f32_16x16x32_bf16 v[12:15], v[100:103], v[168:171], v[12:15]
  ds_read_b64_tr_b16 v[98:99], v39 offset:2048
  v_mfma_f32_16x16x32_bf16 v[28:31], v[100:103], v[172:175], v[28:31]
  ds_read_b64_tr_b16 v[100:101], v40 offset:0
  buffer_load_dwordx4 v[156:159], v33, s[4:7], s16 offen offset:1024
  s_waitcnt lgkmcnt(10)
  v_mfma_f32_16x16x32_bf16 v[0:3], v[104:107], v[176:179], v[0:3]
  ds_read_b64_tr_b16 v[102:103], v40 offset:2048
  v_mfma_f32_16x16x32_bf16 v[16:19], v[104:107], v[180:183], v[16:19]
  ds_read_b64_tr_b16 v[104:105], v37 offset:4096
  buffer_load_dwordx4 v[160:163], v34, s[4:7], s16 offen offset:0
  v_mfma_f32_16x16x32_bf16 v[4:7], v[108:111], v[176:179], v[4:7]
  ds_read_b64_tr_b16 v[106:107], v37 offset:6144
  v_mfma_f32_16x16x32_bf16 v[20:23], v[108:111], v[180:183], v[20:23]
  ds_read_b64_tr_b16 v[108:109], v38 offset:4096
  s_waitcnt lgkmcnt(10)
  v_mfma_f32_16x16x32_bf16 v[8:11], v[112:115], v[176:179], v[8:11]
  ds_read_b64_tr_b16 v[110:111], v38 offset:6144
  buffer_load_dwordx4 v[164:167], v34, s[4:7], s16 offen offset:1024
  s_add_u32 s16, s16, 262144
  v_mfma_f32_16x16x32_bf16 v[24:27], v[112:115], v[180:183], v[24:27]
  ds_read_b64_tr_b16 v[112:113], v39 offset:4096
  v_mfma_f32_16x16x32_bf16 v[12:15], v[116:119], v[176:179], v[12:15]
  ds_read_b64_tr_b16 v[114:115], v39 offset:6144
  v_mfma_f32_16x16x32_bf16 v[28:31], v[116:119], v[180:183], v[28:31]
  ds_read_b64_tr_b16 v[116:117], v40 offset:4096
  ds_read_b64_tr_b16 v[118:119], v40 offset:6144
  s_waitcnt vmcnt(10) lgkmcnt(10)
  s_barrier
  s_add_u32 m0, s38, 24576
  s_nop 0
  buffer_load_dwordx4 v35, s[8:11], s17 offen lds
  v_mfma_f32_16x16x32_bf16 v[0:3], v[88:91], v[120:123], v[0:3]
  v_mfma_f32_16x16x32_bf16 v[16:19], v[88:91], v[124:127], v[16:19]
  ds_read_b64_tr_b16 v[88:89], v37 offset:8192
  v_mfma_f32_16x16x32_bf16 v[4:7], v[92:95], v[120:123], v[4:7]
  ds_read_b64_tr_b16 v[90:91], v37 offset:10240
  buffer_load_dwordx4 v36, s[8:11], s17 offen offset:1024 lds
  s_add_u32 s17, s17, 131072
  v_mfma_f32_16x16x32_bf16 v[20:23], v[92:95], v[124:127], v[20:23]
  ds_read_b64_tr_b16 v[92:93], v38 offset:8192
  v_mfma_f32_16x16x32_bf16 v[8:11], v[96:99], v[120:123], v[8:11]
  ds_read_b64_tr_b16 v[94:95], v38 offset:10240
  buffer_load_dwordx4 v[168:171], v33, s[4:7], s16 offen offset:0
  v_mfma_f32_16x16x32_bf16 v[24:27], v[96:99], v[124:127], v[24:27]
  ds_read_b64_tr_b16 v[96:97], v39 offset:8192
  s_waitcnt lgkmcnt(10)
  v_mfma_f32_16x16x32_bf16 v[12:15], v[100:103], v[120:123], v[12:15]
  ds_read_b64_tr_b16 v[98:99], v39 offset:10240
  v_mfma_f32_16x16x32_bf16 v[28:31], v[100:103], v[124:127], v[28:31]
  ds_read_b64_tr_b16 v[100:101], v40 offset:8192
  buffer_load_dwordx4 v[172:175], v33, s[4:7], s16 offen offset:1024
  v_mfma_f32_16x16x32_bf16 v[0:3], v[104:107], v[128:131], v[0:3]
  ds_read_b64_tr_b16 v[102:103], v40 offset:10240
  v_mfma_f32_16x16x32_bf16 v[16:19], v[104:107], v[132:135], v[16:19]
  ds_read_b64_tr_b16 v[104:105], v37 offset:12288
  buffer_load_dwordx4 v[176:179], v34, s[4:7], s16 offen offset:0
  s_waitcnt lgkmcnt(10)
  v_mfma_f32_16x16x32_bf16 v[4:7], v[108:111], v[128:131], v[4:7]
  ds_read_b64_tr_b16 v[106:107], v37 offset:14336
  v_mfma_f32_16x16x32_bf16 v[20:23], v[108:111], v[132:135], v[20:23]
  ds_read_b64_tr_b16 v[108:109], v38 offset:12288
  v_mfma_f32_16x16x32_bf16 v[8:11], v[112:115], v[128:131], v[8:11]
  ds_read_b64_tr_b16 v[110:111], v38 offset:14336
  buffer_load_dwordx4 v[180:183], v34, s[4:7], s16 offen offset:1024
  s_add_u32 s16, s16, 262144
  v_mfma_f32_16x16x32_bf16 v[24:27], v[112:115], v[132:135], v[24:27]
  ds_read_b64_tr_b16 v[112:113], v39 offset:12288
  s_waitcnt lgkmcnt(10)
  v_mfma_f32_16x16x32_bf16 v[12:15], v[116:119], v[128:131], v[12:15]
  ds_read_b64_tr_b16 v[114:115], v39 offset:14336
  v_mfma_f32_16x16x32_bf16 v[28:31], v[116:119], v[132:135], v[28:31]
  ds_read_b64_tr_b16 v[116:117], v40 offset:12288
  ds_read_b64_tr_b16 v[118:119], v40 offset:14336
  s_waitcnt vmcnt(10) lgkmcnt(10)
  s_barrier
  v_mfma_f32_16x16x32_bf16 v[0:3], v[88:91], v[136:139], v[0:3]
  v_mfma_f32_16x16x32_bf16 v[16:19], v[88:91], v[140:143], v[16:19]
  ds_read_b64_tr_b16 v[88:89], v37 offset:16384
  v_mfma_f32_16x16x32_bf16 v[4:7], v[92:95], v[136:139], v[4:7]
  ds_read_b64_tr_b16 v[90:91], v37 offset:18432
  v_mfma_f32_16x16x32_bf16 v[20:23], v[92:95], v[140:143], v[20:23]
  ds_read_b64_tr_b16 v[92:93], v38 offset:16384
  v_mfma_f32_16x16x32_bf16 v[8:11], v[96:99], v[136:139], v[8:11]
  ds_read_b64_tr_b16 v[94:95], v38 offset:18432
  v_mfma_f32_16x16x32_bf16 v[24:27], v[96:99], v[140:143], v[24:27]
  ds_read_b64_tr_b16 v[96:97], v39 offset:16384
  s_waitcnt lgkmcnt(10)
  v_mfma_f32_16x16x32_bf16 v[12:15], v[100:103], v[136:139], v[12:15]
  ds_read_b64_tr_b16 v[98:99], v39 offset:18432
  v_mfma_f32_16x16x32_bf16 v[28:31], v[100:103], v[140:143], v[28:31]
  ds_read_b64_tr_b16 v[100:101], v40 offset:16384
  s_add_u32 s52, s20, 0x40000
  s_addc_u32 s53, s21, 0
  s_mov_b32 s54, 0x40000
  s_mov_b32 s55, 0x20000
  v_lshlrev_b32 v80, 3, v32
  s_lshl_b32 s56, s30, 14
  s_lshl_b32 s57, s3, 8
  s_add_u32 s56, s56, s57
  s_lshl_b32 s57, s31, 10
  s_add_u32 s57, s57, s56
  v_lshrrev_b32 v81, 4, v32
  v_lshlrev_b32 v81, 12, v81
  v_and_b32 v82, 15, v32
  v_lshl_add_u32 v81, v82, 3, v81
  v_cmp_gt_u32 s[34:35], 16, v32
  v_mfma_f32_16x16x32_bf16 v[0:3], v[104:107], v[144:147], v[0:3]
  ds_read_b64_tr_b16 v[102:103], v40 offset:18432
  v_mfma_f32_16x16x32_bf16 v[16:19], v[104:107], v[148:151], v[16:19]
  ds_read_b64_tr_b16 v[104:105], v37 offset:20480
  s_waitcnt lgkmcnt(10)
  v_mfma_f32_16x16x32_bf16 v[4:7], v[108:111], v[144:147], v[4:7]
  ds_read_b64_tr_b16 v[106:107], v37 offset:22528
  v_mfma_f32_16x16x32_bf16 v[20:23], v[108:111], v[148:151], v[20:23]
  ds_read_b64_tr_b16 v[108:109], v38 offset:20480
  v_mfma_f32_16x16x32_bf16 v[8:11], v[112:115], v[144:147], v[8:11]
  ds_read_b64_tr_b16 v[110:111], v38 offset:22528
  v_mfma_f32_16x16x32_bf16 v[24:27], v[112:115], v[148:151], v[24:27]
  ds_read_b64_tr_b16 v[112:113], v39 offset:20480
  s_waitcnt lgkmcnt(10)
  v_mfma_f32_16x16x32_bf16 v[12:15], v[116:119], v[144:147], v[12:15]
  ds_read_b64_tr_b16 v[114:115], v39 offset:22528
  v_mfma_f32_16x16x32_bf16 v[28:31], v[116:119], v[148:151], v[28:31]
  ds_read_b64_tr_b16 v[116:117], v40 offset:20480
  ds_read_b64_tr_b16 v[118:119], v40 offset:22528
  s_waitcnt vmcnt(4) lgkmcnt(10)
  s_barrier
  v_lshlrev_b32 v120, 16, v48
  v_mfma_f32_16x16x32_bf16 v[0:3], v[88:91], v[152:155], v[0:3]
  v_and_b32 v121, 0xffff0000, v48
  v_mfma_f32_16x16x32_bf16 v[16:19], v[88:91], v[156:159], v[16:19]
  ds_read_b64_tr_b16 v[88:89], v37 offset:24576
  v_lshlrev_b32 v122, 16, v49
  v_mfma_f32_16x16x32_bf16 v[4:7], v[92:95], v[152:155], v[4:7]
  ds_read_b64_tr_b16 v[90:91], v37 offset:26624
  v_and_b32 v123, 0xffff0000, v49
  v_mfma_f32_16x16x32_bf16 v[20:23], v[92:95], v[156:159], v[20:23]
  ds_read_b64_tr_b16 v[92:93], v38 offset:24576
  v_lshlrev_b32 v124, 16, v50
  v_mfma_f32_16x16x32_bf16 v[8:11], v[96:99], v[152:155], v[8:11]
  ds_read_b64_tr_b16 v[94:95], v38 offset:26624
  v_and_b32 v125, 0xffff0000, v50
  v_mfma_f32_16x16x32_bf16 v[24:27], v[96:99], v[156:159], v[24:27]
  ds_read_b64_tr_b16 v[96:97], v39 offset:24576
  v_lshlrev_b32 v126, 16, v51
  s_waitcnt lgkmcnt(10)
  v_mfma_f32_16x16x32_bf16 v[12:15], v[100:103], v[152:155], v[12:15]
  ds_read_b64_tr_b16 v[98:99], v39 offset:26624
  v_and_b32 v127, 0xffff0000, v51
  v_mfma_f32_16x16x32_bf16 v[28:31], v[100:103], v[156:159], v[28:31]
  ds_read_b64_tr_b16 v[100:101], v40 offset:24576
  v_lshlrev_b32 v128, 16, v52
  v_mfma_f32_16x16x32_bf16 v[0:3], v[104:107], v[160:163], v[0:3]
  ds_read_b64_tr_b16 v[102:103], v40 offset:26624
  v_and_b32 v129, 0xffff0000, v52
  v_mfma_f32_16x16x32_bf16 v[16:19], v[104:107], v[164:167], v[16:19]
  ds_read_b64_tr_b16 v[104:105], v37 offset:28672
  v_lshlrev_b32 v130, 16, v53
  s_waitcnt lgkmcnt(10)
  v_mfma_f32_16x16x32_bf16 v[4:7], v[108:111], v[160:163], v[4:7]
  ds_read_b64_tr_b16 v[106:107], v37 offset:30720
  v_and_b32 v131, 0xffff0000, v53
  v_mfma_f32_16x16x32_bf16 v[20:23], v[108:111], v[164:167], v[20:23]
  ds_read_b64_tr_b16 v[108:109], v38 offset:28672
  v_lshlrev_b32 v132, 16, v54
  v_mfma_f32_16x16x32_bf16 v[8:11], v[112:115], v[160:163], v[8:11]
  ds_read_b64_tr_b16 v[110:111], v38 offset:30720
  v_and_b32 v133, 0xffff0000, v54
  v_mfma_f32_16x16x32_bf16 v[24:27], v[112:115], v[164:167], v[24:27]
  ds_read_b64_tr_b16 v[112:113], v39 offset:28672
  v_lshlrev_b32 v134, 16, v55
  s_waitcnt lgkmcnt(10)
  v_mfma_f32_16x16x32_bf16 v[12:15], v[116:119], v[160:163], v[12:15]
  ds_read_b64_tr_b16 v[114:115], v39 offset:30720
  v_and_b32 v135, 0xffff0000, v55
  v_mfma_f32_16x16x32_bf16 v[28:31], v[116:119], v[164:167], v[28:31]
  ds_read_b64_tr_b16 v[116:117], v40 offset:28672
  ds_read_b64_tr_b16 v[118:119], v40 offset:30720
  s_waitcnt vmcnt(0) lgkmcnt(10)
  s_barrier
  v_lshlrev_b32 v136, 16, v56
  v_mfma_f32_16x16x32_bf16 v[0:3], v[88:91], v[168:171], v[0:3]
  v_and_b32 v137, 0xffff0000, v56
  v_mfma_f32_16x16x32_bf16 v[16:19], v[88:91], v[172:175], v[16:19]
  v_lshlrev_b32 v138, 16, v57
  v_mfma_f32_16x16x32_bf16 v[4:7], v[92:95], v[168:171], v[4:7]
  v_and_b32 v139, 0xffff0000, v57
  v_mfma_f32_16x16x32_bf16 v[20:23], v[92:95], v[172:175], v[20:23]
  v_lshlrev_b32 v140, 16, v58
  v_mfma_f32_16x16x32_bf16 v[8:11], v[96:99], v[168:171], v[8:11]
  v_and_b32 v141, 0xffff0000, v58
  v_mfma_f32_16x16x32_bf16 v[24:27], v[96:99], v[172:175], v[24:27]
  v_lshlrev_b32 v142, 16, v59
  s_waitcnt lgkmcnt(8)
  v_mfma_f32_16x16x32_bf16 v[12:15], v[100:103], v[168:171], v[12:15]
  v_and_b32 v143, 0xffff0000, v59
  v_mfma_f32_16x16x32_bf16 v[28:31], v[100:103], v[172:175], v[28:31]
  v_lshlrev_b32 v144, 16, v60
  s_waitcnt lgkmcnt(6)
  v_mfma_f32_16x16x32_bf16 v[0:3], v[104:107], v[176:179], v[0:3]
  v_and_b32 v145, 0xffff0000, v60
  v_mfma_f32_16x16x32_bf16 v[16:19], v[104:107], v[180:183], v[16:19]
  v_lshlrev_b32 v146, 16, v61
  s_waitcnt lgkmcnt(4)
  v_mfma_f32_16x16x32_bf16 v[4:7], v[108:111], v[176:179], v[4:7]
  v_and_b32 v147, 0xffff0000, v61
  v_mfma_f32_16x16x32_bf16 v[20:23], v[108:111], v[180:183], v[20:23]
  v_lshlrev_b32 v148, 16, v62
  s_waitcnt lgkmcnt(2)
  v_mfma_f32_16x16x32_bf16 v[8:11], v[112:115], v[176:179], v[8:11]
  v_and_b32 v149, 0xffff0000, v62
  v_mfma_f32_16x16x32_bf16 v[24:27], v[112:115], v[180:183], v[24:27]
  v_lshlrev_b32 v150, 16, v63
  s_waitcnt lgkmcnt(0)
  v_mfma_f32_16x16x32_bf16 v[12:15], v[116:119], v[176:179], v[12:15]
  v_and_b32 v151, 0xffff0000, v63
  v_mfma_f32_16x16x32_bf16 v[28:31], v[116:119], v[180:183], v[28:31]
  s_nop 7
  s_nop 1
  v_pk_fma_f32 v[120:121], v[0:1], v[64:65], v[120:121]
  v_pk_fma_f32 v[122:123], v[2:3], v[66:67], v[122:123]
  v_pk_fma_f32 v[124:125], v[4:5], v[68:69], v[124:125]
  v_pk_fma_f32 v[126:127], v[6:7], v[70:71], v[126:127]
  v_pk_fma_f32 v[128:129], v[8:9], v[72:73], v[128:129]
  v_pk_fma_f32 v[130:131], v[10:11], v[74:75], v[130:131]
  v_pk_fma_f32 v[132:133], v[12:13], v[76:77], v[132:133]
  v_pk_fma_f32 v[134:135], v[14:15], v[78:79], v[134:135]
  v_pk_fma_f32 v[136:137], v[16:17], v[64:65], v[136:137]
  v_pk_fma_f32 v[138:139], v[18:19], v[66:67], v[138:139]
  v_pk_fma_f32 v[140:141], v[20:21], v[68:69], v[140:141]
  v_pk_fma_f32 v[142:143], v[22:23], v[70:71], v[142:143]
  v_pk_fma_f32 v[144:145], v[24:25], v[72:73], v[144:145]
  v_pk_fma_f32 v[146:147], v[26:27], v[74:75], v[146:147]
  v_pk_fma_f32 v[148:149], v[28:29], v[76:77], v[148:149]
  v_pk_fma_f32 v[150:151], v[30:31], v[78:79], v[150:151]
  v_pk_mul_f32 v[156:157], v[120:121], v[120:121]
  v_pk_mul_f32 v[158:159], v[136:137], v[136:137]
  v_pk_fma_f32 v[156:157], v[122:123], v[122:123], v[156:157]
  v_pk_add_f32 v[152:153], v[120:121], v[122:123]
  v_pk_fma_f32 v[158:159], v[138:139], v[138:139], v[158:159]
  v_pk_add_f32 v[154:155], v[136:137], v[138:139]
  v_pk_fma_f32 v[156:157], v[124:125], v[124:125], v[156:157]
  v_pk_add_f32 v[152:153], v[152:153], v[124:125]
  v_pk_fma_f32 v[158:159], v[140:141], v[140:141], v[158:159]
  v_pk_add_f32 v[154:155], v[154:155], v[140:141]
  v_pk_fma_f32 v[156:157], v[126:127], v[126:127], v[156:157]
  v_pk_add_f32 v[152:153], v[152:153], v[126:127]
  v_pk_fma_f32 v[158:159], v[142:143], v[142:143], v[158:159]
  v_pk_add_f32 v[154:155], v[154:155], v[142:143]
  v_pk_fma_f32 v[156:157], v[128:129], v[128:129], v[156:157]
  v_pk_add_f32 v[152:153], v[152:153], v[128:129]
  v_pk_fma_f32 v[158:159], v[144:145], v[144:145], v[158:159]
  v_pk_add_f32 v[154:155], v[154:155], v[144:145]
  v_pk_fma_f32 v[156:157], v[130:131], v[130:131], v[156:157]
  v_pk_add_f32 v[152:153], v[152:153], v[130:131]
  v_pk_fma_f32 v[158:159], v[146:147], v[146:147], v[158:159]
  v_pk_add_f32 v[154:155], v[154:155], v[146:147]
  v_pk_fma_f32 v[156:157], v[132:133], v[132:133], v[156:157]
  v_pk_add_f32 v[152:153], v[152:153], v[132:133]
  v_pk_fma_f32 v[158:159], v[148:149], v[148:149], v[158:159]
  v_pk_add_f32 v[154:155], v[154:155], v[148:149]
  v_pk_fma_f32 v[156:157], v[134:135], v[134:135], v[156:157]
  v_pk_add_f32 v[152:153], v[152:153], v[134:135]
  v_pk_fma_f32 v[158:159], v[150:151], v[150:151], v[158:159]
  v_pk_add_f32 v[154:155], v[154:155], v[150:151]
  v_add_f32 v152, v152, v153
  v_add_f32 v153, v156, v157
  v_add_f32 v154, v154, v155
  v_add_f32 v155, v158, v159
  v_mov_b32 v156, v152
  v_mov_b32 v157, v153
  v_mov_b32 v158, v154
  v_mov_b32 v159, v155
  s_nop 1
  v_permlane16_swap_b32 v156, v152
  v_permlane16_swap_b32 v157, v153
  v_permlane16_swap_b32 v158, v154
  v_permlane16_swap_b32 v159, v155
  s_nop 1
  v_add_f32 v152, v152, v156
  v_add_f32 v153, v153, v157
  v_add_f32 v154, v154, v158
  v_add_f32 v155, v155, v159
  v_mov_b32 v156, v152
  v_mov_b32 v157, v153
  v_mov_b32 v158, v154
  v_mov_b32 v159, v155
  s_nop 1
  v_permlane32_swap_b32 v156, v152
  v_permlane32_swap_b32 v157, v153
  v_permlane32_swap_b32 v158, v154
  v_permlane32_swap_b32 v159, v155
  s_nop 1
  v_add_f32 v152, v152, v156
  v_add_f32 v153, v153, v157
  v_add_f32 v154, v154, v158
  v_add_f32 v155, v155, v159
  v_cndmask_b32_e64 v156, v154, v152, s[34:35]
  v_cndmask_b32_e64 v157, v155, v153, s[34:35]
  v_and_b32 v156, -2, v156
  v_and_b32 v157, 0x7fffffff, v157
  s_mov_b32 exec_hi, 0
  buffer_store_dwordx2 v[156:157], v80, s[52:55], s57 offen sc1
  s_mov_b64 exec, -1
  s_mul_i32 s38, s3, 3584
  s_mov_b32 s17, 0
  s_cmp_lt_u32 s3, 2
  s_cselect_b32 s8, s60, s62
  s_cselect_b32 s9, s61, s63
  s_mov_b32 s10, 7340032
  s_mov_b32 s11, 0x20000
  s_add_u32 m0, s38, 0
  s_nop 0
  buffer_load_dwordx4 v225, s[8:11], s17 offen lds
  buffer_load_dwordx4 v226, s[8:11], s17 offen offset:1024 lds
  buffer_load_dwordx4 v227, s[8:11], s17 offen offset:2048 lds
  s_mov_b32 exec_hi, 0
  buffer_load_dwordx4 v228, s[8:11], s17 offen offset:3072 lds
  s_mov_b32 exec_hi, -1
  s_add_u32 s17, s17, 229376
  s_add_u32 m0, s38, 14336
  s_nop 0
  buffer_load_dwordx4 v225, s[8:11], s17 offen lds
  buffer_load_dwordx4 v226, s[8:11], s17 offen offset:1024 lds
  buffer_load_dwordx4 v227, s[8:11], s17 offen offset:2048 lds
  s_mov_b32 exec_hi, 0
  buffer_load_dwordx4 v228, s[8:11], s17 offen offset:3072 lds
  s_mov_b32 exec_hi, -1
  s_add_u32 s17, s17, 229376
  s_add_u32 m0, s38, 28672
  s_nop 0
  buffer_load_dwordx4 v225, s[8:11], s17 offen lds
  buffer_load_dwordx4 v226, s[8:11], s17 offen offset:1024 lds
  buffer_load_dwordx4 v227, s[8:11], s17 offen offset:2048 lds
  s_mov_b32 exec_hi, 0
  buffer_load_dwordx4 v228, s[8:11], s17 offen offset:3072 lds
  s_mov_b32 exec_hi, -1
  s_add_u32 s17, s17, 229376
  v_cvt_pk_bf16_f32 v48, v120, v121
  v_cvt_pk_bf16_f32 v49, v122, v123
  v_cvt_pk_bf16_f32 v50, v124, v125
  v_cvt_pk_bf16_f32 v51, v126, v127
  v_cvt_pk_bf16_f32 v52, v128, v129
  v_cvt_pk_bf16_f32 v53, v130, v131
  v_cvt_pk_bf16_f32 v54, v132, v133
  v_cvt_pk_bf16_f32 v55, v134, v135
  v_cvt_pk_bf16_f32 v56, v136, v137
  v_cvt_pk_bf16_f32 v57, v138, v139
  v_cvt_pk_bf16_f32 v58, v140, v141
  v_cvt_pk_bf16_f32 v59, v142, v143
  v_cvt_pk_bf16_f32 v60, v144, v145
  v_cvt_pk_bf16_f32 v61, v146, v147
  v_cvt_pk_bf16_f32 v62, v148, v149
  v_cvt_pk_bf16_f32 v63, v150, v151
  v_accvgpr_write_b32 a128, v48
  v_lshlrev_b32 v0, 16, v48
  v_and_b32 v1, 0xffff0000, v48
  v_accvgpr_write_b32 a129, v49
  v_lshlrev_b32 v2, 16, v49
  v_and_b32 v3, 0xffff0000, v49
  v_accvgpr_write_b32 a130, v50
  v_lshlrev_b32 v4, 16, v50
  v_and_b32 v5, 0xffff0000, v50
  v_accvgpr_write_b32 a131, v51
  v_lshlrev_b32 v6, 16, v51
  v_and_b32 v7, 0xffff0000, v51
  v_accvgpr_write_b32 a132, v52
  v_lshlrev_b32 v8, 16, v52
  v_and_b32 v9, 0xffff0000, v52
  v_accvgpr_write_b32 a133, v53
  v_lshlrev_b32 v10, 16, v53
  v_and_b32 v11, 0xffff0000, v53
  v_accvgpr_write_b32 a134, v54
  v_lshlrev_b32 v12, 16, v54
  v_and_b32 v13, 0xffff0000, v54
  v_accvgpr_write_b32 a135, v55
  v_lshlrev_b32 v14, 16, v55
  v_and_b32 v15, 0xffff0000, v55
  v_accvgpr_write_b32 a136, v56
  v_lshlrev_b32 v16, 16, v56
  v_and_b32 v17, 0xffff0000, v56
  v_accvgpr_write_b32 a137, v57
  v_lshlrev_b32 v18, 16, v57
  v_and_b32 v19, 0xffff0000, v57
  v_accvgpr_write_b32 a138, v58
  v_lshlrev_b32 v20, 16, v58
  v_and_b32 v21, 0xffff0000, v58
  v_accvgpr_write_b32 a139, v59
  v_lshlrev_b32 v22, 16, v59
  v_and_b32 v23, 0xffff0000, v59
  v_accvgpr_write_b32 a140, v60
  v_lshlrev_b32 v24, 16, v60
  v_and_b32 v25, 0xffff0000, v60
  v_accvgpr_write_b32 a141, v61
  v_lshlrev_b32 v26, 16, v61
  v_and_b32 v27, 0xffff0000, v61
  v_accvgpr_write_b32 a142, v62
  v_lshlrev_b32 v28, 16, v62
  v_and_b32 v29, 0xffff0000, v62
  v_accvgpr_write_b32 a143, v63
  v_lshlrev_b32 v30, 16, v63
  v_and_b32 v31, 0xffff0000, v63
  s_add_u32 s48, s20, 0x1300000
  s_addc_u32 s49, s21, 0
  s_mov_b32 s50, 0x400000
  s_mov_b32 s51, 0x20000
  s_mov_b32 s58, 262144
L_poll_25:
  buffer_load_dwordx2 v[168:169], v81, s[52:55], s56 offen offset:0 sc1
  buffer_load_dwordx2 v[170:171], v81, s[52:55], s56 offen offset:1024 sc1
  buffer_load_dwordx2 v[172:173], v81, s[52:55], s56 offen offset:2048 sc1
  buffer_load_dwordx2 v[174:175], v81, s[52:55], s56 offen offset:3072 sc1
  buffer_load_dwordx2 v[176:177], v81, s[52:55], s56 offen offset:128 sc1
  buffer_load_dwordx2 v[178:179], v81, s[52:55], s56 offen offset:1152 sc1
  buffer_load_dwordx2 v[180:181], v81, s[52:55], s56 offen offset:2176 sc1
  buffer_load_dwordx2 v[182:183], v81, s[52:55], s56 offen offset:3200 sc1
  s_waitcnt vmcnt(0)
  v_max3_u32 v160, v168, v169, v170
  v_max3_u32 v160, v160, v171, v172
  v_max3_u32 v160, v160, v173, v174
  v_max3_u32 v160, v160, v175, v176
  v_max3_u32 v160, v160, v177, v178
  v_max3_u32 v160, v160, v179, v180
  v_max3_u32 v160, v160, v181, v182
  v_max_u32 v160, v160, v183
  v_cmp_eq_u32 vcc, -1, v160
  s_nop 1
  s_cmp_eq_u64 vcc, 0
  s_cbranch_scc1 L_ready_26
  s_sub_u32 s58, s58, 1
  s_cmp_lg_u32 s58, 0
  s_cbranch_scc1 L_poll_25
L_ready_26:
  v_pk_add_f32 v[152:153], v[168:169], v[170:171]
  v_pk_add_f32 v[156:157], v[172:173], v[174:175]
  v_pk_add_f32 v[154:155], v[176:177], v[178:179]
  v_pk_add_f32 v[158:159], v[180:181], v[182:183]
  v_pk_add_f32 v[152:153], v[152:153], v[156:157]
  v_pk_add_f32 v[154:155], v[154:155], v[158:159]
  v_mov_b32 v156, v152
  v_mov_b32 v157, v153
  v_mov_b32 v158, v154
  v_mov_b32 v159, v155
  s_nop 1
  v_permlane16_swap_b32 v156, v152
  v_permlane16_swap_b32 v157, v153
  v_permlane16_swap_b32 v158, v154
  v_permlane16_swap_b32 v159, v155
  s_nop 1
  v_add_f32 v152, v152, v156
  v_add_f32 v153, v153, v157
  v_add_f32 v154, v154, v158
  v_add_f32 v155, v155, v159
  v_mov_b32 v156, v152
  v_mov_b32 v157, v153
  v_mov_b32 v158, v154
  v_mov_b32 v159, v155
  s_nop 1
  v_permlane32_swap_b32 v156, v152
  v_permlane32_swap_b32 v157, v153
  v_permlane32_swap_b32 v158, v154
  v_permlane32_swap_b32 v159, v155
  s_nop 1
  v_add_f32 v152, v152, v156
  v_add_f32 v153, v153, v157
  v_add_f32 v154, v154, v158
  v_add_f32 v155, v155, v159
  v_mul_f32 v120, 0x3a800000, v152
  v_mul_f32 v124, 0x3a800000, v153
  v_mul_f32 v132, 0x3a800000, v154
  v_mul_f32 v136, 0x3a800000, v155
  v_fma_f32 v124, -v120, v120, v124
  v_fma_f32 v136, -v132, v132, v136
  v_max_f32 v124, 0, v124
  v_max_f32 v136, 0, v136
  v_cvt_pk_bf16_f32 v128, v120, v124
  v_lshlrev_b32 v120, 16, v128
  v_and_b32 v124, 0xffff0000, v128
  v_add_f32 v124, 0x3727c5ac, v124
  v_cvt_pk_bf16_f32 v128, v124, v125
  v_lshlrev_b32 v124, 16, v128
  v_and_b32 v125, 0xffff0000, v128
  v_sqrt_f32 v124, v124
  s_nop 0
  v_cvt_pk_bf16_f32 v128, v124, v125
  v_lshlrev_b32 v124, 16, v128
  v_and_b32 v125, 0xffff0000, v128
  v_rcp_f32 v124, v124
  v_mov_b32 v121, v120
  s_nop 0
  v_mov_b32 v125, v124
  v_cvt_pk_bf16_f32 v140, v132, v136
  v_lshlrev_b32 v132, 16, v140
  v_and_b32 v136, 0xffff0000, v140
  v_add_f32 v136, 0x3727c5ac, v136
  v_cvt_pk_bf16_f32 v140, v136, v137
  v_lshlrev_b32 v136, 16, v140
  v_and_b32 v137, 0xffff0000, v140
  v_sqrt_f32 v136, v136
  s_nop 0
  v_cvt_pk_bf16_f32 v140, v136, v137
  v_lshlrev_b32 v136, 16, v140
  v_and_b32 v137, 0xffff0000, v140
  v_rcp_f32 v136, v136
  v_mov_b32 v133, v132
  s_nop 0
  v_mov_b32 v137, v136
  v_pk_add_f32 v[0:1], v[0:1], v[120:121] neg_lo:[0,1] neg_hi:[0,1]
  v_pk_add_f32 v[2:3], v[2:3], v[120:121] neg_lo:[0,1] neg_hi:[0,1]
  v_pk_add_f32 v[4:5], v[4:5], v[120:121] neg_lo:[0,1] neg_hi:[0,1]
  v_pk_add_f32 v[6:7], v[6:7], v[120:121] neg_lo:[0,1] neg_hi:[0,1]
  v_pk_add_f32 v[8:9], v[8:9], v[120:121] neg_lo:[0,1] neg_hi:[0,1]
  v_pk_add_f32 v[10:11], v[10:11], v[120:121] neg_lo:[0,1] neg_hi:[0,1]
  v_pk_add_f32 v[12:13], v[12:13], v[120:121] neg_lo:[0,1] neg_hi:[0,1]
  v_pk_add_f32 v[14:15], v[14:15], v[120:121] neg_lo:[0,1] neg_hi:[0,1]
  v_pk_mul_f32 v[0:1], v[0:1], v[124:125]
  v_pk_mul_f32 v[2:3], v[2:3], v[124:125]
  v_pk_mul_f32 v[4:5], v[4:5], v[124:125]
  v_pk_mul_f32 v[6:7], v[6:7], v[124:125]
  v_pk_mul_f32 v[8:9], v[8:9], v[124:125]
  v_pk_mul_f32 v[10:11], v[10:11], v[124:125]
  v_pk_mul_f32 v[12:13], v[12:13], v[124:125]
  v_pk_mul_f32 v[14:15], v[14:15], v[124:125]
  v_pk_fma_f32 v[0:1], v[0:1], v[200:201], v[184:185]
  v_pk_fma_f32 v[2:3], v[2:3], v[202:203], v[186:187]
  v_pk_fma_f32 v[4:5], v[4:5], v[204:205], v[188:189]
  v_pk_fma_f32 v[6:7], v[6:7], v[206:207], v[190:191]
  v_pk_fma_f32 v[8:9], v[8:9], v[208:209], v[192:193]
  v_pk_fma_f32 v[10:11], v[10:11], v[210:211], v[194:195]
  v_pk_fma_f32 v[12:13], v[12:13], v[212:213], v[196:197]
  v_pk_fma_f32 v[14:15], v[14:15], v[214:215], v[198:199]
  v_cvt_pk_bf16_f32 v168, v0, v1
  v_cvt_pk_bf16_f32 v169, v2, v3
  v_cvt_pk_bf16_f32 v170, v4, v5
  v_cvt_pk_bf16_f32 v171, v6, v7
  v_cvt_pk_bf16_f32 v172, v8, v9
  v_cvt_pk_bf16_f32 v173, v10, v11
  v_cvt_pk_bf16_f32 v174, v12, v13
  v_cvt_pk_bf16_f32 v175, v14, v15
  buffer_store_dwordx4 v[168:171], v33, s[48:51], s41 offen offset:0 sc1
  buffer_store_dwordx4 v[172:175], v33, s[48:51], s42 offen offset:0 sc1
  v_pk_add_f32 v[16:17], v[16:17], v[132:133] neg_lo:[0,1] neg_hi:[0,1]
  v_pk_add_f32 v[18:19], v[18:19], v[132:133] neg_lo:[0,1] neg_hi:[0,1]
  v_pk_add_f32 v[20:21], v[20:21], v[132:133] neg_lo:[0,1] neg_hi:[0,1]
  v_pk_add_f32 v[22:23], v[22:23], v[132:133] neg_lo:[0,1] neg_hi:[0,1]
  v_pk_add_f32 v[24:25], v[24:25], v[132:133] neg_lo:[0,1] neg_hi:[0,1]
  v_pk_add_f32 v[26:27], v[26:27], v[132:133] neg_lo:[0,1] neg_hi:[0,1]
  v_pk_add_f32 v[28:29], v[28:29], v[132:133] neg_lo:[0,1] neg_hi:[0,1]
  v_pk_add_f32 v[30:31], v[30:31], v[132:133] neg_lo:[0,1] neg_hi:[0,1]
  v_pk_mul_f32 v[16:17], v[16:17], v[136:137]
  v_pk_mul_f32 v[18:19], v[18:19], v[136:137]
  v_pk_mul_f32 v[20:21], v[20:21], v[136:137]
  v_pk_mul_f32 v[22:23], v[22:23], v[136:137]
  v_pk_mul_f32 v[24:25], v[24:25], v[136:137]
  v_pk_mul_f32 v[26:27], v[26:27], v[136:137]
  v_pk_mul_f32 v[28:29], v[28:29], v[136:137]
  v_pk_mul_f32 v[30:31], v[30:31], v[136:137]
  v_pk_fma_f32 v[16:17], v[16:17], v[200:201], v[184:185]
  v_pk_fma_f32 v[18:19], v[18:19], v[202:203], v[186:187]
  v_pk_fma_f32 v[20:21], v[20:21], v[204:205], v[188:189]
  v_pk_fma_f32 v[22:23], v[22:23], v[206:207], v[190:191]
  v_pk_fma_f32 v[24:25], v[24:25], v[208:209], v[192:193]
  v_pk_fma_f32 v[26:27], v[26:27], v[210:211], v[194:195]
  v_pk_fma_f32 v[28:29], v[28:29], v[212:213], v[196:197]
  v_pk_fma_f32 v[30:31], v[30:31], v[214:215], v[198:199]
  v_cvt_pk_bf16_f32 v176, v16, v17
  v_cvt_pk_bf16_f32 v177, v18, v19
  v_cvt_pk_bf16_f32 v178, v20, v21
  v_cvt_pk_bf16_f32 v179, v22, v23
  v_cvt_pk_bf16_f32 v180, v24, v25
  v_cvt_pk_bf16_f32 v181, v26, v27
  v_cvt_pk_bf16_f32 v182, v28, v29
  v_cvt_pk_bf16_f32 v183, v30, v31
  buffer_store_dwordx4 v[176:179], v33, s[48:51], s41 offen offset:1024 sc1
  buffer_store_dwordx4 v[180:183], v33, s[48:51], s42 offen offset:1024 sc1
  s_add_u32 s64, s20, 0xb0000
  s_addc_u32 s65, s21, 0
  s_mov_b32 s66, 0x10000
  s_mov_b32 s67, 0x20000
  s_lshl_b32 s32, s30, 2
  s_add_u32 s32, s32, s3
  s_lshl_b32 s32, s32, 4
  s_add_u32 s32, s32, s31
  s_lshl_b32 s32, s32, 6
  s_mov_b32 s30, s94
  s_mov_b32 s31, s95
  s_lshl_b32 s33, s30, 2
  s_add_u32 s33, s33, s3
  s_lshl_b32 s68, s33, 11
  v_mov_b32 v250, 0
  v_mov_b32 v248, 1
  v_and_b32 v246, 31, v231
  v_and_b32 v245, 17, v246
  v_lshlrev_b32 v245, 6, v245
  v_lshlrev_b32 v246, 6, v246
  s_mov_b64 s[24:25], s[60:61]
  s_mov_b64 s[26:27], s[62:63]
  s_add_u32 s4, s20, 0x1300000
  s_addc_u32 s5, s21, 0
  s_mov_b32 s6, 0x400000
  s_mov_b32 s7, 0x20000
  s_mov_b32 s16, 0
  s_waitcnt vmcnt(0)
  s_mov_b64 exec, 1
  buffer_store_dword v248, v250, s[64:67], s32 offen sc1
  s_mov_b64 exec, -1
  s_mov_b32 s34, 0x40000
L_spin_27:
  buffer_load_dword v247, v245, s[64:67], s68 offen sc1
  s_waitcnt vmcnt(0)
  v_cmp_ne_u32 vcc, 1, v247
  s_nop 1
  s_cmp_eq_u64 vcc, 0
  s_cbranch_scc1 L_rdy_28
  s_sub_u32 s34, s34, 1
  s_cmp_lg_u32 s34, 0
  s_cbranch_scc1 L_spin_27
L_rdy_28:
  buffer_load_dwordx4 a[0:3], v224, s[4:7], s16 offen offset:0 sc1
  buffer_load_dwordx4 a[4:7], v224, s[4:7], s16 offen offset:1024 sc1
  buffer_load_dwordx4 a[8:11], v224, s[4:7], s16 offen offset:2048 sc1
  buffer_load_dwordx4 a[12:15], v224, s[4:7], s16 offen offset:3072 sc1
  s_add_u32 s16, s16, 131072
  buffer_load_dwordx4 a[16:19], v224, s[4:7], s16 offen offset:0 sc1
  buffer_load_dwordx4 a[20:23], v224, s[4:7], s16 offen offset:1024 sc1
  buffer_load_dwordx4 a[24:27], v224, s[4:7], s16 offen offset:2048 sc1
  buffer_load_dwordx4 a[28:31], v224, s[4:7], s16 offen offset:3072 sc1
  s_add_u32 s16, s16, 131072
  s_bitcmp1_b32 s3, 0
  s_cselect_b32 s52, s26, s24
  s_cselect_b32 s53, s27, s25
  s_cselect_b32 s60, 3670016, 0
  s_mov_b32 s54, 7340032
  s_mov_b32 s55, 0x20000
  s_lshl_b32 s56, s2, 1
  s_lshr_b32 s59, s3, 1
  s_add_u32 s56, s56, s59
  s_lshl_b32 s56, s56, 10
  s_add_u32 s60, s60, s56
  s_add_u32 s56, s56, 3670016
  s_mov_b32 s59, 0
  v_lshrrev_b32 v249, 3, v231
  v_lshlrev_b32 v249, 7, v249
  s_add_u32 s12, s20, 0x100000
  s_addc_u32 s13, s21, 0
  s_mov_b32 s14, 0xe00000
  s_mov_b32 s15, 0x20000
  v_lshrrev_b32 v234, 2, v231
  v_mul_u32_u24 v234, 224, v234
  v_and_b32 v235, 3, v231
  v_lshl_add_u32 v229, v235, 3, v234
  v_add_u32 v230, 57344, v229
  s_waitcnt vmcnt(16)
  s_barrier
  ds_read_b64_tr_b16 a[64:65], v229 offset:0
  ds_read_b64_tr_b16 a[66:67], v229 offset:3584
  ds_read_b64_tr_b16 a[68:69], v229 offset:32
  ds_read_b64_tr_b16 a[70:71], v229 offset:3616
  ds_read_b64_tr_b16 a[72:73], v229 offset:64
  ds_read_b64_tr_b16 a[74:75], v229 offset:3648
  ds_read_b64_tr_b16 a[76:77], v229 offset:96
  ds_read_b64_tr_b16 a[78:79], v229 offset:3680
  ds_read_b64_tr_b16 a[80:81], v229 offset:128
  ds_read_b64_tr_b16 a[82:83], v229 offset:3712
  ds_read_b64_tr_b16 a[84:85], v229 offset:160
  ds_read_b64_tr_b16 a[86:87], v229 offset:3744
  ds_read_b64_tr_b16 a[88:89], v229 offset:192
  ds_read_b64_tr_b16 a[90:91], v229 offset:3776
  ds_read_b64_tr_b16 a[92:93], v229 offset:7168
  ds_read_b64_tr_b16 a[94:95], v229 offset:10752
  ds_read_b64_tr_b16 a[96:97], v229 offset:7200
  ds_read_b64_tr_b16 a[98:99], v229 offset:10784
  ds_read_b64_tr_b16 a[100:101], v229 offset:7232
  ds_read_b64_tr_b16 a[102:103], v229 offset:10816
  ds_read_b64_tr_b16 a[104:105], v229 offset:7264
  ds_read_b64_tr_b16 a[106:107], v229 offset:10848
  ds_read_b64_tr_b16 a[108:109], v229 offset:7296
  ds_read_b64_tr_b16 a[110:111], v229 offset:10880
  ds_read_b64_tr_b16 a[112:113], v229 offset:7328
  ds_read_b64_tr_b16 a[114:115], v229 offset:10912
  ds_read_b64_tr_b16 a[116:117], v229 offset:7360
  ds_read_b64_tr_b16 a[118:119], v229 offset:10944
  s_waitcnt vmcnt(4) lgkmcnt(10)
  s_barrier
  buffer_load_dword v247, v246, s[64:67], s68 offen sc1
  buffer_load_dwordx4 a[32:35], v224, s[4:7], s16 offen offset:0 sc1
  v_mfma_f32_16x16x32_bf16 v[0:3], a[64:67], a[0:3], 0
  v_mfma_f32_16x16x32_bf16 v[56:59], a[64:67], a[4:7], 0
  v_mfma_f32_16x16x32_bf16 v[112:115], a[64:67], a[8:11], 0
  v_mfma_f32_16x16x32_bf16 v[168:171], a[64:67], a[12:15], 0
  ds_read_b64_tr_b16 a[64:65], v229 offset:14336
  buffer_load_dwordx4 a[36:39], v224, s[4:7], s16 offen offset:1024 sc1
  v_mfma_f32_16x16x32_bf16 v[4:7], a[68:71], a[0:3], 0
  ds_read_b64_tr_b16 a[66:67], v229 offset:17920
  v_mfma_f32_16x16x32_bf16 v[60:63], a[68:71], a[4:7], 0
  v_mfma_f32_16x16x32_bf16 v[116:119], a[68:71], a[8:11], 0
  v_mfma_f32_16x16x32_bf16 v[172:175], a[68:71], a[12:15], 0
  ds_read_b64_tr_b16 a[68:69], v229 offset:14368
  buffer_load_dwordx4 a[40:43], v224, s[4:7], s16 offen offset:2048 sc1
  v_mfma_f32_16x16x32_bf16 v[8:11], a[72:75], a[0:3], 0
  ds_read_b64_tr_b16 a[70:71], v229 offset:17952
  v_mfma_f32_16x16x32_bf16 v[64:67], a[72:75], a[4:7], 0
  v_mfma_f32_16x16x32_bf16 v[120:123], a[72:75], a[8:11], 0
  v_mfma_f32_16x16x32_bf16 v[176:179], a[72:75], a[12:15], 0
  ds_read_b64_tr_b16 a[72:73], v229 offset:14400
  v_mfma_f32_16x16x32_bf16 v[12:15], a[76:79], a[0:3], 0
  ds_read_b64_tr_b16 a[74:75], v229 offset:17984
  buffer_load_dwordx4 a[44:47], v224, s[4:7], s16 offen offset:3072 sc1
  s_add_u32 s16, s16, 131072
  v_mfma_f32_16x16x32_bf16 v[68:71], a[76:79], a[4:7], 0
  v_mfma_f32_16x16x32_bf16 v[124:127], a[76:79], a[8:11], 0
  v_mfma_f32_16x16x32_bf16 v[180:183], a[76:79], a[12:15], 0
  ds_read_b64_tr_b16 a[76:77], v229 offset:14432
  v_mfma_f32_16x16x32_bf16 v[16:19], a[80:83], a[0:3], 0
  ds_read_b64_tr_b16 a[78:79], v229 offset:18016
  s_add_u32 m0, s38, 43008
  s_nop 0
  buffer_load_dwordx4 v225, s[8:11], s17 offen lds
  v_mfma_f32_16x16x32_bf16 v[72:75], a[80:83], a[4:7], 0
  v_mfma_f32_16x16x32_bf16 v[128:131], a[80:83], a[8:11], 0
  v_mfma_f32_16x16x32_bf16 v[184:187], a[80:83], a[12:15], 0
  ds_read_b64_tr_b16 a[80:81], v229 offset:14464
  v_mfma_f32_16x16x32_bf16 v[20:23], a[84:87], a[0:3], 0
  ds_read_b64_tr_b16 a[82:83], v229 offset:18048
  buffer_load_dwordx4 v226, s[8:11], s17 offen offset:1024 lds
  v_mfma_f32_16x16x32_bf16 v[76:79], a[84:87], a[4:7], 0
  v_mfma_f32_16x16x32_bf16 v[132:135], a[84:87], a[8:11], 0
  v_mfma_f32_16x16x32_bf16 v[188:191], a[84:87], a[12:15], 0
  ds_read_b64_tr_b16 a[84:85], v229 offset:14496
  v_mfma_f32_16x16x32_bf16 v[24:27], a[88:91], a[0:3], 0
  ds_read_b64_tr_b16 a[86:87], v229 offset:18080
  buffer_load_dwordx4 v227, s[8:11], s17 offen offset:2048 lds
  v_mfma_f32_16x16x32_bf16 v[80:83], a[88:91], a[4:7], 0
  v_mfma_f32_16x16x32_bf16 v[136:139], a[88:91], a[8:11], 0
  v_mfma_f32_16x16x32_bf16 v[192:195], a[88:91], a[12:15], 0
  ds_read_b64_tr_b16 a[88:89], v229 offset:14528
  v_mfma_f32_16x16x32_bf16 v[28:31], a[92:95], a[0:3], 0
  ds_read_b64_tr_b16 a[90:91], v229 offset:18112
  v_mfma_f32_16x16x32_bf16 v[84:87], a[92:95], a[4:7], 0
  s_mov_b32 exec_hi, 0
  buffer_load_dwordx4 v228, s[8:11], s17 offen offset:3072 lds
  s_mov_b32 exec_hi, -1
  s_add_u32 s17, s17, 229376
  v_mfma_f32_16x16x32_bf16 v[140:143], a[92:95], a[8:11], 0
  v_mfma_f32_16x16x32_bf16 v[196:199], a[92:95], a[12:15], 0
  ds_read_b64_tr_b16 a[92:93], v229 offset:21504
  v_mfma_f32_16x16x32_bf16 v[32:35], a[96:99], a[0:3], 0
  ds_read_b64_tr_b16 a[94:95], v229 offset:25088
  v_mfma_f32_16x16x32_bf16 v[88:91], a[96:99], a[4:7], 0
  buffer_load_dwordx4 a[48:51], v224, s[4:7], s16 offen offset:0 sc1
  v_mfma_f32_16x16x32_bf16 v[144:147], a[96:99], a[8:11], 0
  v_mfma_f32_16x16x32_bf16 v[200:203], a[96:99], a[12:15], 0
  ds_read_b64_tr_b16 a[96:97], v229 offset:21536
  s_waitcnt lgkmcnt(10)
  v_mfma_f32_16x16x32_bf16 v[36:39], a[100:103], a[0:3], 0
  ds_read_b64_tr_b16 a[98:99], v229 offset:25120
  v_mfma_f32_16x16x32_bf16 v[92:95], a[100:103], a[4:7], 0
  buffer_load_dwordx4 a[52:55], v224, s[4:7], s16 offen offset:1024 sc1
  v_mfma_f32_16x16x32_bf16 v[148:151], a[100:103], a[8:11], 0
  v_mfma_f32_16x16x32_bf16 v[204:207], a[100:103], a[12:15], 0
  ds_read_b64_tr_b16 a[100:101], v229 offset:21568
  v_mfma_f32_16x16x32_bf16 v[40:43], a[104:107], a[0:3], 0
  ds_read_b64_tr_b16 a[102:103], v229 offset:25152
  v_mfma_f32_16x16x32_bf16 v[96:99], a[104:107], a[4:7], 0
  buffer_load_dwordx4 a[56:59], v224, s[4:7], s16 offen offset:2048 sc1
  v_mfma_f32_16x16x32_bf16 v[152:155], a[104:107], a[8:11], 0
  v_mfma_f32_16x16x32_bf16 v[208:211], a[104:107], a[12:15], 0
  ds_read_b64_tr_b16 a[104:105], v229 offset:21600
  v_mfma_f32_16x16x32_bf16 v[44:47], a[108:111], a[0:3], 0
  ds_read_b64_tr_b16 a[106:107], v229 offset:25184
  v_mfma_f32_16x16x32_bf16 v[100:103], a[108:111], a[4:7], 0
  v_mfma_f32_16x16x32_bf16 v[156:159], a[108:111], a[8:11], 0
  buffer_load_dwordx4 a[60:63], v224, s[4:7], s16 offen offset:3072 sc1
  s_add_u32 s16, s16, 131072
  v_mfma_f32_16x16x32_bf16 v[212:215], a[108:111], a[12:15], 0
  ds_read_b64_tr_b16 a[108:109], v229 offset:21632
  v_mfma_f32_16x16x32_bf16 v[48:51], a[112:115], a[0:3], 0
  ds_read_b64_tr_b16 a[110:111], v229 offset:25216
  v_mfma_f32_16x16x32_bf16 v[104:107], a[112:115], a[4:7], 0
  v_mfma_f32_16x16x32_bf16 v[160:163], a[112:115], a[8:11], 0
  buffer_load_dword v251, v249, s[52:55], s56 offen
  s_add_u32 s56, s56, 0x80000
  s_add_u32 s59, s59, 1
  s_cmp_eq_u32 s59, 7
  s_cselect_b32 s52, s22, s52
  s_cselect_b32 s53, s23, s53
  s_cselect_b32 s56, s60, s56
  v_mfma_f32_16x16x32_bf16 v[216:219], a[112:115], a[12:15], 0
  ds_read_b64_tr_b16 a[112:113], v229 offset:21664
  v_mfma_f32_16x16x32_bf16 v[52:55], a[116:119], a[0:3], 0
  ds_read_b64_tr_b16 a[114:115], v229 offset:25248
  v_mfma_f32_16x16x32_bf16 v[108:111], a[116:119], a[4:7], 0
  v_mfma_f32_16x16x32_bf16 v[164:167], a[116:119], a[8:11], 0
  v_mfma_f32_16x16x32_bf16 v[220:223], a[116:119], a[12:15], 0
  ds_read_b64_tr_b16 a[116:117], v229 offset:21696
  ds_read_b64_tr_b16 a[118:119], v229 offset:25280
  s_waitcnt vmcnt(13) lgkmcnt(10)
  s_barrier
  v_cmp_ne_u32 vcc, 1, v247
  s_nop 1
  s_cmp_lg_u64 vcc, 0
  s_cbranch_scc1 L_slow_29
  L_back_30:
  s_add_u32 m0, s38, 0
  s_nop 0
  buffer_load_dwordx4 v225, s[8:11], s17 offen lds
  v_mfma_f32_16x16x32_bf16 v[0:3], a[64:67], a[16:19], v[0:3]
  v_mfma_f32_16x16x32_bf16 v[56:59], a[64:67], a[20:23], v[56:59]
  v_mfma_f32_16x16x32_bf16 v[112:115], a[64:67], a[24:27], v[112:115]
  v_mfma_f32_16x16x32_bf16 v[168:171], a[64:67], a[28:31], v[168:171]
  ds_read_b64_tr_b16 a[64:65], v229 offset:28672
  v_mfma_f32_16x16x32_bf16 v[4:7], a[68:71], a[16:19], v[4:7]
  ds_read_b64_tr_b16 a[66:67], v229 offset:32256
  v_mfma_f32_16x16x32_bf16 v[60:63], a[68:71], a[20:23], v[60:63]
  buffer_load_dwordx4 v226, s[8:11], s17 offen offset:1024 lds
  v_mfma_f32_16x16x32_bf16 v[116:119], a[68:71], a[24:27], v[116:119]
  v_mfma_f32_16x16x32_bf16 v[172:175], a[68:71], a[28:31], v[172:175]
  ds_read_b64_tr_b16 a[68:69], v229 offset:28704
  v_mfma_f32_16x16x32_bf16 v[8:11], a[72:75], a[16:19], v[8:11]
  ds_read_b64_tr_b16 a[70:71], v229 offset:32288
  v_mfma_f32_16x16x32_bf16 v[64:67], a[72:75], a[20:23], v[64:67]
  v_mfma_f32_16x16x32_bf16 v[120:123], a[72:75], a[24:27], v[120:123]
  v_mfma_f32_16x16x32_bf16 v[176:179], a[72:75], a[28:31], v[176:179]
  ds_read_b64_tr_b16 a[72:73], v229 offset:28736
  buffer_load_dwordx4 v227, s[8:11], s17 offen offset:2048 lds
  v_mfma_f32_16x16x32_bf16 v[12:15], a[76:79], a[16:19], v[12:15]
  ds_read_b64_tr_b16 a[74:75], v229 offset:32320
  v_mfma_f32_16x16x32_bf16 v[68:71], a[76:79], a[20:23], v[68:71]
  v_mfma_f32_16x16x32_bf16 v[124:127], a[76:79], a[24:27], v[124:127]
  v_mfma_f32_16x16x32_bf16 v[180:183], a[76:79], a[28:31], v[180:183]
  ds_read_b64_tr_b16 a[76:77], v229 offset:28768
  v_mfma_f32_16x16x32_bf16 v[16:19], a[80:83], a[16:19], v[16:19]
  ds_read_b64_tr_b16 a[78:79], v229 offset:32352
  v_mfma_f32_16x16x32_bf16 v[72:75], a[80:83], a[20:23], v[72:75]
  s_mov_b32 exec_hi, 0
  buffer_load_dwordx4 v228, s[8:11], s17 offen offset:3072 lds
  s_mov_b32 exec_hi, -1
  s_add_u32 s17, s17, 229376
  v_mfma_f32_16x16x32_bf16 v[128:131], a[80:83], a[24:27], v[128:131]
  v_mfma_f32_16x16x32_bf16 v[184:187], a[80:83], a[28:31], v[184:187]
  ds_read_b64_tr_b16 a[80:81], v229 offset:28800
  v_mfma_f32_16x16x32_bf16 v[20:23], a[84:87], a[16:19], v[20:23]
  ds_read_b64_tr_b16 a[82:83], v229 offset:32384
  v_mfma_f32_16x16x32_bf16 v[76:79], a[84:87], a[20:23], v[76:79]
  v_mfma_f32_16x16x32_bf16 v[132:135], a[84:87], a[24:27], v[132:135]
  v_mfma_f32_16x16x32_bf16 v[188:191], a[84:87], a[28:31], v[188:191]
  ds_read_b64_tr_b16 a[84:85], v229 offset:28832
  buffer_load_dwordx4 a[0:3], v224, s[4:7], s16 offen offset:0 sc1
  v_mfma_f32_16x16x32_bf16 v[24:27], a[88:91], a[16:19], v[24:27]
  ds_read_b64_tr_b16 a[86:87], v229 offset:32416
  v_mfma_f32_16x16x32_bf16 v[80:83], a[88:91], a[20:23], v[80:83]
  v_mfma_f32_16x16x32_bf16 v[136:139], a[88:91], a[24:27], v[136:139]
  v_mfma_f32_16x16x32_bf16 v[192:195], a[88:91], a[28:31], v[192:195]
  ds_read_b64_tr_b16 a[88:89], v229 offset:28864
  v_mfma_f32_16x16x32_bf16 v[28:31], a[92:95], a[16:19], v[28:31]
  ds_read_b64_tr_b16 a[90:91], v229 offset:32448
  v_mfma_f32_16x16x32_bf16 v[84:87], a[92:95], a[20:23], v[84:87]
  v_mfma_f32_16x16x32_bf16 v[140:143], a[92:95], a[24:27], v[140:143]
  buffer_load_dwordx4 a[4:7], v224, s[4:7], s16 offen offset:1024 sc1
  v_mfma_f32_16x16x32_bf16 v[196:199], a[92:95], a[28:31], v[196:199]
  ds_read_b64_tr_b16 a[92:93], v229 offset:35840
  v_mfma_f32_16x16x32_bf16 v[32:35], a[96:99], a[16:19], v[32:35]
  ds_read_b64_tr_b16 a[94:95], v229 offset:39424
  v_mfma_f32_16x16x32_bf16 v[88:91], a[96:99], a[20:23], v[88:91]
  v_mfma_f32_16x16x32_bf16 v[144:147], a[96:99], a[24:27], v[144:147]
  v_mfma_f32_16x16x32_bf16 v[200:203], a[96:99], a[28:31], v[200:203]
  ds_read_b64_tr_b16 a[96:97], v229 offset:35872
  s_waitcnt lgkmcnt(10)
  v_mfma_f32_16x16x32_bf16 v[36:39], a[100:103], a[16:19], v[36:39]
  ds_read_b64_tr_b16 a[98:99], v229 offset:39456
  buffer_load_dwordx4 a[8:11], v224, s[4:7], s16 offen offset:2048 sc1
  v_mfma_f32_16x16x32_bf16 v[92:95], a[100:103], a[20:23], v[92:95]
  v_mfma_f32_16x16x32_bf16 v[148:151], a[100:103], a[24:27], v[148:151]
  v_mfma_f32_16x16x32_bf16 v[204:207], a[100:103], a[28:31], v[204:207]
  ds_read_b64_tr_b16 a[100:101], v229 offset:35904
  v_mfma_f32_16x16x32_bf16 v[40:43], a[104:107], a[16:19], v[40:43]
  ds_read_b64_tr_b16 a[102:103], v229 offset:39488
  v_mfma_f32_16x16x32_bf16 v[96:99], a[104:107], a[20:23], v[96:99]
  v_mfma_f32_16x16x32_bf16 v[152:155], a[104:107], a[24:27], v[152:155]
  buffer_load_dwordx4 a[12:15], v224, s[4:7], s16 offen offset:3072 sc1
  s_add_u32 s16, s16, 131072
  v_mfma_f32_16x16x32_bf16 v[208:211], a[104:107], a[28:31], v[208:211]
  ds_read_b64_tr_b16 a[104:105], v229 offset:35936
  v_mfma_f32_16x16x32_bf16 v[44:47], a[108:111], a[16:19], v[44:47]
  ds_read_b64_tr_b16 a[106:107], v229 offset:39520
  v_mfma_f32_16x16x32_bf16 v[100:103], a[108:111], a[20:23], v[100:103]
  v_mfma_f32_16x16x32_bf16 v[156:159], a[108:111], a[24:27], v[156:159]
  v_mfma_f32_16x16x32_bf16 v[212:215], a[108:111], a[28:31], v[212:215]
  ds_read_b64_tr_b16 a[108:109], v229 offset:35968
  v_mfma_f32_16x16x32_bf16 v[48:51], a[112:115], a[16:19], v[48:51]
  ds_read_b64_tr_b16 a[110:111], v229 offset:39552
  buffer_load_dword v251, v249, s[52:55], s56 offen
  s_add_u32 s56, s56, 0x80000
  s_add_u32 s59, s59, 1
  s_cmp_eq_u32 s59, 7
  s_cselect_b32 s52, s22, s52
  s_cselect_b32 s53, s23, s53
  s_cselect_b32 s56, s60, s56
  v_mfma_f32_16x16x32_bf16 v[104:107], a[112:115], a[20:23], v[104:107]
  v_mfma_f32_16x16x32_bf16 v[160:163], a[112:115], a[24:27], v[160:163]
  v_mfma_f32_16x16x32_bf16 v[216:219], a[112:115], a[28:31], v[216:219]
  ds_read_b64_tr_b16 a[112:113], v229 offset:36000
  v_mfma_f32_16x16x32_bf16 v[52:55], a[116:119], a[16:19], v[52:55]
  ds_read_b64_tr_b16 a[114:115], v229 offset:39584
  v_mfma_f32_16x16x32_bf16 v[108:111], a[116:119], a[20:23], v[108:111]
  v_mfma_f32_16x16x32_bf16 v[164:167], a[116:119], a[24:27], v[164:167]
  v_mfma_f32_16x16x32_bf16 v[220:223], a[116:119], a[28:31], v[220:223]
  ds_read_b64_tr_b16 a[116:117], v229 offset:36032
  ds_read_b64_tr_b16 a[118:119], v229 offset:39616
  s_waitcnt vmcnt(14) lgkmcnt(10)
  s_barrier
  s_add_u32 m0, s38, 14336
  s_nop 0
  buffer_load_dwordx4 v225, s[8:11], s17 offen lds
  v_mfma_f32_16x16x32_bf16 v[0:3], a[64:67], a[32:35], v[0:3]
  v_mfma_f32_16x16x32_bf16 v[56:59], a[64:67], a[36:39], v[56:59]
  v_mfma_f32_16x16x32_bf16 v[112:115], a[64:67], a[40:43], v[112:115]
  v_mfma_f32_16x16x32_bf16 v[168:171], a[64:67], a[44:47], v[168:171]
  ds_read_b64_tr_b16 a[64:65], v229 offset:43008
  v_mfma_f32_16x16x32_bf16 v[4:7], a[68:71], a[32:35], v[4:7]
  ds_read_b64_tr_b16 a[66:67], v229 offset:46592
  v_mfma_f32_16x16x32_bf16 v[60:63], a[68:71], a[36:39], v[60:63]
  buffer_load_dwordx4 v226, s[8:11], s17 offen offset:1024 lds
  v_mfma_f32_16x16x32_bf16 v[116:119], a[68:71], a[40:43], v[116:119]
  v_mfma_f32_16x16x32_bf16 v[172:175], a[68:71], a[44:47], v[172:175]
  ds_read_b64_tr_b16 a[68:69], v229 offset:43040
  v_mfma_f32_16x16x32_bf16 v[8:11], a[72:75], a[32:35], v[8:11]
  ds_read_b64_tr_b16 a[70:71], v229 offset:46624
  v_mfma_f32_16x16x32_bf16 v[64:67], a[72:75], a[36:39], v[64:67]
  v_mfma_f32_16x16x32_bf16 v[120:123], a[72:75], a[40:43], v[120:123]
  v_mfma_f32_16x16x32_bf16 v[176:179], a[72:75], a[44:47], v[176:179]
  ds_read_b64_tr_b16 a[72:73], v229 offset:43072
  buffer_load_dwordx4 v227, s[8:11], s17 offen offset:2048 lds
  v_mfma_f32_16x16x32_bf16 v[12:15], a[76:79], a[32:35], v[12:15]
  ds_read_b64_tr_b16 a[74:75], v229 offset:46656
  v_mfma_f32_16x16x32_bf16 v[68:71], a[76:79], a[36:39], v[68:71]
  v_mfma_f32_16x16x32_bf16 v[124:127], a[76:79], a[40:43], v[124:127]
  v_mfma_f32_16x16x32_bf16 v[180:183], a[76:79], a[44:47], v[180:183]
  ds_read_b64_tr_b16 a[76:77], v229 offset:43104
  v_mfma_f32_16x16x32_bf16 v[16:19], a[80:83], a[32:35], v[16:19]
  ds_read_b64_tr_b16 a[78:79], v229 offset:46688
  v_mfma_f32_16x16x32_bf16 v[72:75], a[80:83], a[36:39], v[72:75]
  s_mov_b32 exec_hi, 0
  buffer_load_dwordx4 v228, s[8:11], s17 offen offset:3072 lds
  s_mov_b32 exec_hi, -1
  s_add_u32 s17, s17, 229376
  v_mfma_f32_16x16x32_bf16 v[128:131], a[80:83], a[40:43], v[128:131]
  v_mfma_f32_16x16x32_bf16 v[184:187], a[80:83], a[44:47], v[184:187]
  ds_read_b64_tr_b16 a[80:81], v229 offset:43136
  v_mfma_f32_16x16x32_bf16 v[20:23], a[84:87], a[32:35], v[20:23]
  ds_read_b64_tr_b16 a[82:83], v229 offset:46720
  v_mfma_f32_16x16x32_bf16 v[76:79], a[84:87], a[36:39], v[76:79]
  v_mfma_f32_16x16x32_bf16 v[132:135], a[84:87], a[40:43], v[132:135]
  v_mfma_f32_16x16x32_bf16 v[188:191], a[84:87], a[44:47], v[188:191]
  ds_read_b64_tr_b16 a[84:85], v229 offset:43168
  buffer_load_dwordx4 a[16:19], v224, s[4:7], s16 offen offset:0 sc1
  v_mfma_f32_16x16x32_bf16 v[24:27], a[88:91], a[32:35], v[24:27]
  ds_read_b64_tr_b16 a[86:87], v229 offset:46752
  v_mfma_f32_16x16x32_bf16 v[80:83], a[88:91], a[36:39], v[80:83]
  v_mfma_f32_16x16x32_bf16 v[136:139], a[88:91], a[40:43], v[136:139]
  v_mfma_f32_16x16x32_bf16 v[192:195], a[88:91], a[44:47], v[192:195]
  ds_read_b64_tr_b16 a[88:89], v229 offset:43200
  v_mfma_f32_16x16x32_bf16 v[28:31], a[92:95], a[32:35], v[28:31]
  ds_read_b64_tr_b16 a[90:91], v229 offset:46784
  v_mfma_f32_16x16x32_bf16 v[84:87], a[92:95], a[36:39], v[84:87]
  v_mfma_f32_16x16x32_bf16 v[140:143], a[92:95], a[40:43], v[140:143]
  buffer_load_dwordx4 a[20:23], v224, s[4:7], s16 offen offset:1024 sc1
  v_mfma_f32_16x16x32_bf16 v[196:199], a[92:95], a[44:47], v[196:199]
  ds_read_b64_tr_b16 a[92:93], v229 offset:50176
  v_mfma_f32_16x16x32_bf16 v[32:35], a[96:99], a[32:35], v[32:35]
  ds_read_b64_tr_b16 a[94:95], v229 offset:53760
  v_mfma_f32_16x16x32_bf16 v[88:91], a[96:99], a[36:39], v[88:91]
  v_mfma_f32_16x16x32_bf16 v[144:147], a[96:99], a[40:43], v[144:147]
  v_mfma_f32_16x16x32_bf16 v[200:203], a[96:99], a[44:47], v[200:203]
  ds_read_b64_tr_b16 a[96:97], v229 offset:50208
  s_waitcnt lgkmcnt(10)
  v_mfma_f32_16x16x32_bf16 v[36:39], a[100:103], a[32:35], v[36:39]
  ds_read_b64_tr_b16 a[98:99], v229 offset:53792
  buffer_load_dwordx4 a[24:27], v224, s[4:7], s16 offen offset:2048 sc1
  v_mfma_f32_16x16x32_bf16 v[92:95], a[100:103], a[36:39], v[92:95]
  v_mfma_f32_16x16x32_bf16 v[148:151], a[100:103], a[40:43], v[148:151]
  v_mfma_f32_16x16x32_bf16 v[204:207], a[100:103], a[44:47], v[204:207]
  ds_read_b64_tr_b16 a[100:101], v229 offset:50240
  v_mfma_f32_16x16x32_bf16 v[40:43], a[104:107], a[32:35], v[40:43]
  ds_read_b64_tr_b16 a[102:103], v229 offset:53824
  v_mfma_f32_16x16x32_bf16 v[96:99], a[104:107], a[36:39], v[96:99]
  v_mfma_f32_16x16x32_bf16 v[152:155], a[104:107], a[40:43], v[152:155]
  buffer_load_dwordx4 a[28:31], v224, s[4:7], s16 offen offset:3072 sc1
  s_add_u32 s16, s16, 131072
  v_mfma_f32_16x16x32_bf16 v[208:211], a[104:107], a[44:47], v[208:211]
  ds_read_b64_tr_b16 a[104:105], v229 offset:50272
  v_mfma_f32_16x16x32_bf16 v[44:47], a[108:111], a[32:35], v[44:47]
  ds_read_b64_tr_b16 a[106:107], v229 offset:53856
  v_mfma_f32_16x16x32_bf16 v[100:103], a[108:111], a[36:39], v[100:103]
  v_mfma_f32_16x16x32_bf16 v[156:159], a[108:111], a[40:43], v[156:159]
  v_mfma_f32_16x16x32_bf16 v[212:215], a[108:111], a[44:47], v[212:215]
  ds_read_b64_tr_b16 a[108:109], v229 offset:50304
  v_mfma_f32_16x16x32_bf16 v[48:51], a[112:115], a[32:35], v[48:51]
  ds_read_b64_tr_b16 a[110:111], v229 offset:53888
  buffer_load_dword v251, v249, s[52:55], s56 offen
  s_add_u32 s56, s56, 0x80000
  s_add_u32 s59, s59, 1
  s_cmp_eq_u32 s59, 7
  s_cselect_b32 s52, s22, s52
  s_cselect_b32 s53, s23, s53
  s_cselect_b32 s56, s60, s56
  v_mfma_f32_16x16x32_bf16 v[104:107], a[112:115], a[36:39], v[104:107]
  v_mfma_f32_16x16x32_bf16 v[160:163], a[112:115], a[40:43], v[160:163]
  v_mfma_f32_16x16x32_bf16 v[216:219], a[112:115], a[44:47], v[216:219]
  ds_read_b64_tr_b16 a[112:113], v229 offset:50336
  v_mfma_f32_16x16x32_bf16 v[52:55], a[116:119], a[32:35], v[52:55]
  ds_read_b64_tr_b16 a[114:115], v229 offset:53920
  v_mfma_f32_16x16x32_bf16 v[108:111], a[116:119], a[36:39], v[108:111]
  v_mfma_f32_16x16x32_bf16 v[164:167], a[116:119], a[40:43], v[164:167]
  v_mfma_f32_16x16x32_bf16 v[220:223], a[116:119], a[44:47], v[220:223]
  ds_read_b64_tr_b16 a[116:117], v229 offset:50368
  ds_read_b64_tr_b16 a[118:119], v229 offset:53952
  s_waitcnt vmcnt(14) lgkmcnt(10)
  s_barrier
  s_add_u32 m0, s38, 28672
  s_nop 0
  buffer_load_dwordx4 v225, s[8:11], s17 offen lds
  v_mfma_f32_16x16x32_bf16 v[0:3], a[64:67], a[48:51], v[0:3]
  v_mfma_f32_16x16x32_bf16 v[56:59], a[64:67], a[52:55], v[56:59]
  v_mfma_f32_16x16x32_bf16 v[112:115], a[64:67], a[56:59], v[112:115]
  v_mfma_f32_16x16x32_bf16 v[168:171], a[64:67], a[60:63], v[168:171]
  ds_read_b64_tr_b16 a[64:65], v229 offset:0
  v_mfma_f32_16x16x32_bf16 v[4:7], a[68:71], a[48:51], v[4:7]
  ds_read_b64_tr_b16 a[66:67], v229 offset:3584
  v_mfma_f32_16x16x32_bf16 v[60:63], a[68:71], a[52:55], v[60:63]
  v_mfma_f32_16x16x32_bf16 v[116:119], a[68:71], a[56:59], v[116:119]
  buffer_load_dwordx4 v226, s[8:11], s17 offen offset:1024 lds
  v_mfma_f32_16x16x32_bf16 v[172:175], a[68:71], a[60:63], v[172:175]
  ds_read_b64_tr_b16 a[68:69], v229 offset:32
  v_mfma_f32_16x16x32_bf16 v[8:11], a[72:75], a[48:51], v[8:11]
  ds_read_b64_tr_b16 a[70:71], v229 offset:3616
  v_mfma_f32_16x16x32_bf16 v[64:67], a[72:75], a[52:55], v[64:67]
  v_mfma_f32_16x16x32_bf16 v[120:123], a[72:75], a[56:59], v[120:123]
  v_mfma_f32_16x16x32_bf16 v[176:179], a[72:75], a[60:63], v[176:179]
  ds_read_b64_tr_b16 a[72:73], v229 offset:64
  v_mfma_f32_16x16x32_bf16 v[12:15], a[76:79], a[48:51], v[12:15]
  ds_read_b64_tr_b16 a[74:75], v229 offset:3648
  v_mfma_f32_16x16x32_bf16 v[68:71], a[76:79], a[52:55], v[68:71]
  buffer_load_dwordx4 v227, s[8:11], s17 offen offset:2048 lds
  v_mfma_f32_16x16x32_bf16 v[124:127], a[76:79], a[56:59], v[124:127]
  v_mfma_f32_16x16x32_bf16 v[180:183], a[76:79], a[60:63], v[180:183]
  ds_read_b64_tr_b16 a[76:77], v229 offset:96
  v_mfma_f32_16x16x32_bf16 v[16:19], a[80:83], a[48:51], v[16:19]
  ds_read_b64_tr_b16 a[78:79], v229 offset:3680
  v_mfma_f32_16x16x32_bf16 v[72:75], a[80:83], a[52:55], v[72:75]
  v_mfma_f32_16x16x32_bf16 v[128:131], a[80:83], a[56:59], v[128:131]
  v_mfma_f32_16x16x32_bf16 v[184:187], a[80:83], a[60:63], v[184:187]
  ds_read_b64_tr_b16 a[80:81], v229 offset:128
  v_mfma_f32_16x16x32_bf16 v[20:23], a[84:87], a[48:51], v[20:23]
  ds_read_b64_tr_b16 a[82:83], v229 offset:3712
  s_mov_b32 exec_hi, 0
  buffer_load_dwordx4 v228, s[8:11], s17 offen offset:3072 lds
  s_mov_b32 exec_hi, -1
  s_add_u32 s17, s17, 229376
  v_mfma_f32_16x16x32_bf16 v[76:79], a[84:87], a[52:55], v[76:79]
  v_mfma_f32_16x16x32_bf16 v[132:135], a[84:87], a[56:59], v[132:135]
  v_mfma_f32_16x16x32_bf16 v[188:191], a[84:87], a[60:63], v[188:191]
  ds_read_b64_tr_b16 a[84:85], v229 offset:160
  v_mfma_f32_16x16x32_bf16 v[24:27], a[88:91], a[48:51], v[24:27]
  ds_read_b64_tr_b16 a[86:87], v229 offset:3744
  v_mfma_f32_16x16x32_bf16 v[80:83], a[88:91], a[52:55], v[80:83]
  v_mfma_f32_16x16x32_bf16 v[136:139], a[88:91], a[56:59], v[136:139]
  v_mfma_f32_16x16x32_bf16 v[192:195], a[88:91], a[60:63], v[192:195]
  ds_read_b64_tr_b16 a[88:89], v229 offset:192
  buffer_load_dwordx4 a[32:35], v224, s[4:7], s16 offen offset:0 sc1
  v_mfma_f32_16x16x32_bf16 v[28:31], a[92:95], a[48:51], v[28:31]
  ds_read_b64_tr_b16 a[90:91], v229 offset:3776
  v_mfma_f32_16x16x32_bf16 v[84:87], a[92:95], a[52:55], v[84:87]
  v_mfma_f32_16x16x32_bf16 v[140:143], a[92:95], a[56:59], v[140:143]
  v_mfma_f32_16x16x32_bf16 v[196:199], a[92:95], a[60:63], v[196:199]
  ds_read_b64_tr_b16 a[92:93], v229 offset:7168
  v_mfma_f32_16x16x32_bf16 v[32:35], a[96:99], a[48:51], v[32:35]
  ds_read_b64_tr_b16 a[94:95], v229 offset:10752
  v_mfma_f32_16x16x32_bf16 v[88:91], a[96:99], a[52:55], v[88:91]
  buffer_load_dwordx4 a[36:39], v224, s[4:7], s16 offen offset:1024 sc1
  v_mfma_f32_16x16x32_bf16 v[144:147], a[96:99], a[56:59], v[144:147]
  v_mfma_f32_16x16x32_bf16 v[200:203], a[96:99], a[60:63], v[200:203]
  ds_read_b64_tr_b16 a[96:97], v229 offset:7200
  s_waitcnt lgkmcnt(10)
  v_mfma_f32_16x16x32_bf16 v[36:39], a[100:103], a[48:51], v[36:39]
  ds_read_b64_tr_b16 a[98:99], v229 offset:10784
  v_mfma_f32_16x16x32_bf16 v[92:95], a[100:103], a[52:55], v[92:95]
  v_mfma_f32_16x16x32_bf16 v[148:151], a[100:103], a[56:59], v[148:151]
  v_mfma_f32_16x16x32_bf16 v[204:207], a[100:103], a[60:63], v[204:207]
  ds_read_b64_tr_b16 a[100:101], v229 offset:7232
  v_mfma_f32_16x16x32_bf16 v[40:43], a[104:107], a[48:51], v[40:43]
  ds_read_b64_tr_b16 a[102:103], v229 offset:10816
  buffer_load_dwordx4 a[40:43], v224, s[4:7], s16 offen offset:2048 sc1
  v_mfma_f32_16x16x32_bf16 v[96:99], a[104:107], a[52:55], v[96:99]
  v_mfma_f32_16x16x32_bf16 v[152:155], a[104:107], a[56:59], v[152:155]
  v_mfma_f32_16x16x32_bf16 v[208:211], a[104:107], a[60:63], v[208:211]
  ds_read_b64_tr_b16 a[104:105], v229 offset:7264
  v_mfma_f32_16x16x32_bf16 v[44:47], a[108:111], a[48:51], v[44:47]
  ds_read_b64_tr_b16 a[106:107], v229 offset:10848
  v_mfma_f32_16x16x32_bf16 v[100:103], a[108:111], a[52:55], v[100:103]
  v_mfma_f32_16x16x32_bf16 v[156:159], a[108:111], a[56:59], v[156:159]
  v_mfma_f32_16x16x32_bf16 v[212:215], a[108:111], a[60:63], v[212:215]
  ds_read_b64_tr_b16 a[108:109], v229 offset:7296
  buffer_load_dwordx4 a[44:47], v224, s[4:7], s16 offen offset:3072 sc1
  s_add_u32 s16, s16, 131072
  v_mfma_f32_16x16x32_bf16 v[48:51], a[112:115], a[48:51], v[48:51]
  ds_read_b64_tr_b16 a[110:111], v229 offset:10880
  v_mfma_f32_16x16x32_bf16 v[104:107], a[112:115], a[52:55], v[104:107]
  v_mfma_f32_16x16x32_bf16 v[160:163], a[112:115], a[56:59], v[160:163]
  v_mfma_f32_16x16x32_bf16 v[216:219], a[112:115], a[60:63], v[216:219]
  ds_read_b64_tr_b16 a[112:113], v229 offset:7328
  v_mfma_f32_16x16x32_bf16 v[52:55], a[116:119], a[48:51], v[52:55]
  ds_read_b64_tr_b16 a[114:115], v229 offset:10912
  v_mfma_f32_16x16x32_bf16 v[108:111], a[116:119], a[52:55], v[108:111]
  v_mfma_f32_16x16x32_bf16 v[164:167], a[116:119], a[56:59], v[164:167]
  v_mfma_f32_16x16x32_bf16 v[220:223], a[116:119], a[60:63], v[220:223]
  ds_read_b64_tr_b16 a[116:117], v229 offset:7360
  ds_read_b64_tr_b16 a[118:119], v229 offset:10944
  s_mov_b32 s18, 5
  .p2align 6
L_loop_32:
  s_waitcnt vmcnt(13) lgkmcnt(10)
  s_barrier
  s_add_u32 m0, s38, 43008
  s_nop 0
  buffer_load_dwordx4 v225, s[8:11], s17 offen lds
  v_mfma_f32_16x16x32_bf16 v[0:3], a[64:67], a[0:3], v[0:3]
  v_mfma_f32_16x16x32_bf16 v[56:59], a[64:67], a[4:7], v[56:59]
  v_mfma_f32_16x16x32_bf16 v[112:115], a[64:67], a[8:11], v[112:115]
  v_mfma_f32_16x16x32_bf16 v[168:171], a[64:67], a[12:15], v[168:171]
  ds_read_b64_tr_b16 a[64:65], v229 offset:14336
  v_mfma_f32_16x16x32_bf16 v[4:7], a[68:71], a[0:3], v[4:7]
  ds_read_b64_tr_b16 a[66:67], v229 offset:17920
  v_mfma_f32_16x16x32_bf16 v[60:63], a[68:71], a[4:7], v[60:63]
  buffer_load_dwordx4 v226, s[8:11], s17 offen offset:1024 lds
  v_mfma_f32_16x16x32_bf16 v[116:119], a[68:71], a[8:11], v[116:119]
  v_mfma_f32_16x16x32_bf16 v[172:175], a[68:71], a[12:15], v[172:175]
  ds_read_b64_tr_b16 a[68:69], v229 offset:14368
  v_mfma_f32_16x16x32_bf16 v[8:11], a[72:75], a[0:3], v[8:11]
  ds_read_b64_tr_b16 a[70:71], v229 offset:17952
  v_mfma_f32_16x16x32_bf16 v[64:67], a[72:75], a[4:7], v[64:67]
  v_mfma_f32_16x16x32_bf16 v[120:123], a[72:75], a[8:11], v[120:123]
  v_mfma_f32_16x16x32_bf16 v[176:179], a[72:75], a[12:15], v[176:179]
  ds_read_b64_tr_b16 a[72:73], v229 offset:14400
  buffer_load_dwordx4 v227, s[8:11], s17 offen offset:2048 lds
  v_mfma_f32_16x16x32_bf16 v[12:15], a[76:79], a[0:3], v[12:15]
  ds_read_b64_tr_b16 a[74:75], v229 offset:17984
  v_mfma_f32_16x16x32_bf16 v[68:71], a[76:79], a[4:7], v[68:71]
  v_mfma_f32_16x16x32_bf16 v[124:127], a[76:79], a[8:11], v[124:127]
  v_mfma_f32_16x16x32_bf16 v[180:183], a[76:79], a[12:15], v[180:183]
  ds_read_b64_tr_b16 a[76:77], v229 offset:14432
  v_mfma_f32_16x16x32_bf16 v[16:19], a[80:83], a[0:3], v[16:19]
  ds_read_b64_tr_b16 a[78:79], v229 offset:18016
  v_mfma_f32_16x16x32_bf16 v[72:75], a[80:83], a[4:7], v[72:75]
  s_mov_b32 exec_hi, 0
  buffer_load_dwordx4 v228, s[8:11], s17 offen offset:3072 lds
  s_mov_b32 exec_hi, -1
  s_add_u32 s17, s17, 229376
  v_mfma_f32_16x16x32_bf16 v[128:131], a[80:83], a[8:11], v[128:131]
  v_mfma_f32_16x16x32_bf16 v[184:187], a[80:83], a[12:15], v[184:187]
  ds_read_b64_tr_b16 a[80:81], v229 offset:14464
  v_mfma_f32_16x16x32_bf16 v[20:23], a[84:87], a[0:3], v[20:23]
  ds_read_b64_tr_b16 a[82:83], v229 offset:18048
  v_mfma_f32_16x16x32_bf16 v[76:79], a[84:87], a[4:7], v[76:79]
  v_mfma_f32_16x16x32_bf16 v[132:135], a[84:87], a[8:11], v[132:135]
  v_mfma_f32_16x16x32_bf16 v[188:191], a[84:87], a[12:15], v[188:191]
  ds_read_b64_tr_b16 a[84:85], v229 offset:14496
  buffer_load_dwordx4 a[48:51], v224, s[4:7], s16 offen offset:0 sc1
  v_mfma_f32_16x16x32_bf16 v[24:27], a[88:91], a[0:3], v[24:27]
  ds_read_b64_tr_b16 a[86:87], v229 offset:18080
  v_mfma_f32_16x16x32_bf16 v[80:83], a[88:91], a[4:7], v[80:83]
  v_mfma_f32_16x16x32_bf16 v[136:139], a[88:91], a[8:11], v[136:139]
  v_mfma_f32_16x16x32_bf16 v[192:195], a[88:91], a[12:15], v[192:195]
  ds_read_b64_tr_b16 a[88:89], v229 offset:14528
  v_mfma_f32_16x16x32_bf16 v[28:31], a[92:95], a[0:3], v[28:31]
  ds_read_b64_tr_b16 a[90:91], v229 offset:18112
  v_mfma_f32_16x16x32_bf16 v[84:87], a[92:95], a[4:7], v[84:87]
  v_mfma_f32_16x16x32_bf16 v[140:143], a[92:95], a[8:11], v[140:143]
  buffer_load_dwordx4 a[52:55], v224, s[4:7], s16 offen offset:1024 sc1
  v_mfma_f32_16x16x32_bf16 v[196:199], a[92:95], a[12:15], v[196:199]
  ds_read_b64_tr_b16 a[92:93], v229 offset:21504
  v_mfma_f32_16x16x32_bf16 v[32:35], a[96:99], a[0:3], v[32:35]
  ds_read_b64_tr_b16 a[94:95], v229 offset:25088
  v_mfma_f32_16x16x32_bf16 v[88:91], a[96:99], a[4:7], v[88:91]
  v_mfma_f32_16x16x32_bf16 v[144:147], a[96:99], a[8:11], v[144:147]
  v_mfma_f32_16x16x32_bf16 v[200:203], a[96:99], a[12:15], v[200:203]
  ds_read_b64_tr_b16 a[96:97], v229 offset:21536
  s_waitcnt lgkmcnt(10)
  v_mfma_f32_16x16x32_bf16 v[36:39], a[100:103], a[0:3], v[36:39]
  ds_read_b64_tr_b16 a[98:99], v229 offset:25120
  buffer_load_dwordx4 a[56:59], v224, s[4:7], s16 offen offset:2048 sc1
  v_mfma_f32_16x16x32_bf16 v[92:95], a[100:103], a[4:7], v[92:95]
  v_mfma_f32_16x16x32_bf16 v[148:151], a[100:103], a[8:11], v[148:151]
  v_mfma_f32_16x16x32_bf16 v[204:207], a[100:103], a[12:15], v[204:207]
  ds_read_b64_tr_b16 a[100:101], v229 offset:21568
  v_mfma_f32_16x16x32_bf16 v[40:43], a[104:107], a[0:3], v[40:43]
  ds_read_b64_tr_b16 a[102:103], v229 offset:25152
  v_mfma_f32_16x16x32_bf16 v[96:99], a[104:107], a[4:7], v[96:99]
  v_mfma_f32_16x16x32_bf16 v[152:155], a[104:107], a[8:11], v[152:155]
  buffer_load_dwordx4 a[60:63], v224, s[4:7], s16 offen offset:3072 sc1
  s_add_u32 s16, s16, 131072
  v_mfma_f32_16x16x32_bf16 v[208:211], a[104:107], a[12:15], v[208:211]
  ds_read_b64_tr_b16 a[104:105], v229 offset:21600
  v_mfma_f32_16x16x32_bf16 v[44:47], a[108:111], a[0:3], v[44:47]
  ds_read_b64_tr_b16 a[106:107], v229 offset:25184
  v_mfma_f32_16x16x32_bf16 v[100:103], a[108:111], a[4:7], v[100:103]
  v_mfma_f32_16x16x32_bf16 v[156:159], a[108:111], a[8:11], v[156:159]
  v_mfma_f32_16x16x32_bf16 v[212:215], a[108:111], a[12:15], v[212:215]
  ds_read_b64_tr_b16 a[108:109], v229 offset:21632
  v_mfma_f32_16x16x32_bf16 v[48:51], a[112:115], a[0:3], v[48:51]
  ds_read_b64_tr_b16 a[110:111], v229 offset:25216
  buffer_load_dword v251, v249, s[52:55], s56 offen
  s_add_u32 s56, s56, 0x80000
  s_add_u32 s59, s59, 1
  s_cmp_eq_u32 s59, 7
  s_cselect_b32 s52, s22, s52
  s_cselect_b32 s53, s23, s53
  s_cselect_b32 s56, s60, s56
  v_mfma_f32_16x16x32_bf16 v[104:107], a[112:115], a[4:7], v[104:107]
  v_mfma_f32_16x16x32_bf16 v[160:163], a[112:115], a[8:11], v[160:163]
  v_mfma_f32_16x16x32_bf16 v[216:219], a[112:115], a[12:15], v[216:219]
  ds_read_b64_tr_b16 a[112:113], v229 offset:21664
  v_mfma_f32_16x16x32_bf16 v[52:55], a[116:119], a[0:3], v[52:55]
  ds_read_b64_tr_b16 a[114:115], v229 offset:25248
  v_mfma_f32_16x16x32_bf16 v[108:111], a[116:119], a[4:7], v[108:111]
  v_mfma_f32_16x16x32_bf16 v[164:167], a[116:119], a[8:11], v[164:167]
  v_mfma_f32_16x16x32_bf16 v[220:223], a[116:119], a[12:15], v[220:223]
  ds_read_b64_tr_b16 a[116:117], v229 offset:21696
  ds_read_b64_tr_b16 a[118:119], v229 offset:25280
  s_waitcnt vmcnt(13) lgkmcnt(10)
  s_barrier
  s_add_u32 m0, s38, 0
  s_nop 0
  buffer_load_dwordx4 v225, s[8:11], s17 offen lds
  v_mfma_f32_16x16x32_bf16 v[0:3], a[64:67], a[16:19], v[0:3]
  v_mfma_f32_16x16x32_bf16 v[56:59], a[64:67], a[20:23], v[56:59]
  v_mfma_f32_16x16x32_bf16 v[112:115], a[64:67], a[24:27], v[112:115]
  v_mfma_f32_16x16x32_bf16 v[168:171], a[64:67], a[28:31], v[168:171]
  ds_read_b64_tr_b16 a[64:65], v229 offset:28672
  v_mfma_f32_16x16x32_bf16 v[4:7], a[68:71], a[16:19], v[4:7]
  ds_read_b64_tr_b16 a[66:67], v229 offset:32256
  v_mfma_f32_16x16x32_bf16 v[60:63], a[68:71], a[20:23], v[60:63]
  v_mfma_f32_16x16x32_bf16 v[116:119], a[68:71], a[24:27], v[116:119]
  buffer_load_dwordx4 v226, s[8:11], s17 offen offset:1024 lds
  v_mfma_f32_16x16x32_bf16 v[172:175], a[68:71], a[28:31], v[172:175]
  ds_read_b64_tr_b16 a[68:69], v229 offset:28704
  v_mfma_f32_16x16x32_bf16 v[8:11], a[72:75], a[16:19], v[8:11]
  ds_read_b64_tr_b16 a[70:71], v229 offset:32288
  v_mfma_f32_16x16x32_bf16 v[64:67], a[72:75], a[20:23], v[64:67]
  v_mfma_f32_16x16x32_bf16 v[120:123], a[72:75], a[24:27], v[120:123]
  v_mfma_f32_16x16x32_bf16 v[176:179], a[72:75], a[28:31], v[176:179]
  ds_read_b64_tr_b16 a[72:73], v229 offset:28736
  v_mfma_f32_16x16x32_bf16 v[12:15], a[76:79], a[16:19], v[12:15]
  ds_read_b64_tr_b16 a[74:75], v229 offset:32320
  v_mfma_f32_16x16x32_bf16 v[68:71], a[76:79], a[20:23], v[68:71]
  buffer_load_dwordx4 v227, s[8:11], s17 offen offset:2048 lds
  v_mfma_f32_16x16x32_bf16 v[124:127], a[76:79], a[24:27], v[124:127]
  v_mfma_f32_16x16x32_bf16 v[180:183], a[76:79], a[28:31], v[180:183]
  ds_read_b64_tr_b16 a[76:77], v229 offset:28768
  v_mfma_f32_16x16x32_bf16 v[16:19], a[80:83], a[16:19], v[16:19]
  ds_read_b64_tr_b16 a[78:79], v229 offset:32352
  v_mfma_f32_16x16x32_bf16 v[72:75], a[80:83], a[20:23], v[72:75]
  v_mfma_f32_16x16x32_bf16 v[128:131], a[80:83], a[24:27], v[128:131]
  v_mfma_f32_16x16x32_bf16 v[184:187], a[80:83], a[28:31], v[184:187]
  ds_read_b64_tr_b16 a[80:81], v229 offset:28800
  v_mfma_f32_16x16x32_bf16 v[20:23], a[84:87], a[16:19], v[20:23]
  ds_read_b64_tr_b16 a[82:83], v229 offset:32384
  s_mov_b32 exec_hi, 0
  buffer_load_dwordx4 v228, s[8:11], s17 offen offset:3072 lds
  s_mov_b32 exec_hi, -1
  s_add_u32 s17, s17, 229376
  v_mfma_f32_16x16x32_bf16 v[76:79], a[84:87], a[20:23], v[76:79]
  v_mfma_f32_16x16x32_bf16 v[132:135], a[84:87], a[24:27], v[132:135]
  v_mfma_f32_16x16x32_bf16 v[188:191], a[84:87], a[28:31], v[188:191]
  ds_read_b64_tr_b16 a[84:85], v229 offset:28832
  v_mfma_f32_16x16x32_bf16 v[24:27], a[88:91], a[16:19], v[24:27]
  ds_read_b64_tr_b16 a[86:87], v229 offset:32416
  v_mfma_f32_16x16x32_bf16 v[80:83], a[88:91], a[20:23], v[80:83]
  v_mfma_f32_16x16x32_bf16 v[136:139], a[88:91], a[24:27], v[136:139]
  v_mfma_f32_16x16x32_bf16 v[192:195], a[88:91], a[28:31], v[192:195]
  ds_read_b64_tr_b16 a[88:89], v229 offset:28864
  buffer_load_dwordx4 a[0:3], v224, s[4:7], s16 offen offset:0 sc1
  v_mfma_f32_16x16x32_bf16 v[28:31], a[92:95], a[16:19], v[28:31]
  ds_read_b64_tr_b16 a[90:91], v229 offset:32448
  v_mfma_f32_16x16x32_bf16 v[84:87], a[92:95], a[20:23], v[84:87]
  v_mfma_f32_16x16x32_bf16 v[140:143], a[92:95], a[24:27], v[140:143]
  v_mfma_f32_16x16x32_bf16 v[196:199], a[92:95], a[28:31], v[196:199]
  ds_read_b64_tr_b16 a[92:93], v229 offset:35840
  v_mfma_f32_16x16x32_bf16 v[32:35], a[96:99], a[16:19], v[32:35]
  ds_read_b64_tr_b16 a[94:95], v229 offset:39424
  v_mfma_f32_16x16x32_bf16 v[88:91], a[96:99], a[20:23], v[88:91]
  buffer_load_dwordx4 a[4:7], v224, s[4:7], s16 offen offset:1024 sc1
  v_mfma_f32_16x16x32_bf16 v[144:147], a[96:99], a[24:27], v[144:147]
  v_mfma_f32_16x16x32_bf16 v[200:203], a[96:99], a[28:31], v[200:203]
  ds_read_b64_tr_b16 a[96:97], v229 offset:35872
  s_waitcnt lgkmcnt(10)
  v_mfma_f32_16x16x32_bf16 v[36:39], a[100:103], a[16:19], v[36:39]
  ds_read_b64_tr_b16 a[98:99], v229 offset:39456
  v_mfma_f32_16x16x32_bf16 v[92:95], a[100:103], a[20:23], v[92:95]
  v_mfma_f32_16x16x32_bf16 v[148:151], a[100:103], a[24:27], v[148:151]
  v_mfma_f32_16x16x32_bf16 v[204:207], a[100:103], a[28:31], v[204:207]
  ds_read_b64_tr_b16 a[100:101], v229 offset:35904
  v_mfma_f32_16x16x32_bf16 v[40:43], a[104:107], a[16:19], v[40:43]
  ds_read_b64_tr_b16 a[102:103], v229 offset:39488
  buffer_load_dwordx4 a[8:11], v224, s[4:7], s16 offen offset:2048 sc1
  v_mfma_f32_16x16x32_bf16 v[96:99], a[104:107], a[20:23], v[96:99]
  v_mfma_f32_16x16x32_bf16 v[152:155], a[104:107], a[24:27], v[152:155]
  v_mfma_f32_16x16x32_bf16 v[208:211], a[104:107], a[28:31], v[208:211]
  ds_read_b64_tr_b16 a[104:105], v229 offset:35936
  v_mfma_f32_16x16x32_bf16 v[44:47], a[108:111], a[16:19], v[44:47]
  ds_read_b64_tr_b16 a[106:107], v229 offset:39520
  v_mfma_f32_16x16x32_bf16 v[100:103], a[108:111], a[20:23], v[100:103]
  v_mfma_f32_16x16x32_bf16 v[156:159], a[108:111], a[24:27], v[156:159]
  v_mfma_f32_16x16x32_bf16 v[212:215], a[108:111], a[28:31], v[212:215]
  ds_read_b64_tr_b16 a[108:109], v229 offset:35968
  buffer_load_dwordx4 a[12:15], v224, s[4:7], s16 offen offset:3072 sc1
  s_add_u32 s16, s16, 131072
  v_mfma_f32_16x16x32_bf16 v[48:51], a[112:115], a[16:19], v[48:51]
  ds_read_b64_tr_b16 a[110:111], v229 offset:39552
  v_mfma_f32_16x16x32_bf16 v[104:107], a[112:115], a[20:23], v[104:107]
  v_mfma_f32_16x16x32_bf16 v[160:163], a[112:115], a[24:27], v[160:163]
  v_mfma_f32_16x16x32_bf16 v[216:219], a[112:115], a[28:31], v[216:219]
  ds_read_b64_tr_b16 a[112:113], v229 offset:36000
  v_mfma_f32_16x16x32_bf16 v[52:55], a[116:119], a[16:19], v[52:55]
  ds_read_b64_tr_b16 a[114:115], v229 offset:39584
  v_mfma_f32_16x16x32_bf16 v[108:111], a[116:119], a[20:23], v[108:111]
  v_mfma_f32_16x16x32_bf16 v[164:167], a[116:119], a[24:27], v[164:167]
  v_mfma_f32_16x16x32_bf16 v[220:223], a[116:119], a[28:31], v[220:223]
  ds_read_b64_tr_b16 a[116:117], v229 offset:36032
  ds_read_b64_tr_b16 a[118:119], v229 offset:39616
  s_waitcnt vmcnt(13) lgkmcnt(10)
  s_barrier
  s_add_u32 m0, s38, 14336
  s_nop 0
  buffer_load_dwordx4 v225, s[8:11], s17 offen lds
  v_mfma_f32_16x16x32_bf16 v[0:3], a[64:67], a[32:35], v[0:3]
  v_mfma_f32_16x16x32_bf16 v[56:59], a[64:67], a[36:39], v[56:59]
  v_mfma_f32_16x16x32_bf16 v[112:115], a[64:67], a[40:43], v[112:115]
  v_mfma_f32_16x16x32_bf16 v[168:171], a[64:67], a[44:47], v[168:171]
  ds_read_b64_tr_b16 a[64:65], v229 offset:43008
  v_mfma_f32_16x16x32_bf16 v[4:7], a[68:71], a[32:35], v[4:7]
  ds_read_b64_tr_b16 a[66:67], v229 offset:46592
  v_mfma_f32_16x16x32_bf16 v[60:63], a[68:71], a[36:39], v[60:63]
  buffer_load_dwordx4 v226, s[8:11], s17 offen offset:1024 lds
  v_mfma_f32_16x16x32_bf16 v[116:119], a[68:71], a[40:43], v[116:119]
  v_mfma_f32_16x16x32_bf16 v[172:175], a[68:71], a[44:47], v[172:175]
  ds_read_b64_tr_b16 a[68:69], v229 offset:43040
  v_mfma_f32_16x16x32_bf16 v[8:11], a[72:75], a[32:35], v[8:11]
  ds_read_b64_tr_b16 a[70:71], v229 offset:46624
  v_mfma_f32_16x16x32_bf16 v[64:67], a[72:75], a[36:39], v[64:67]
  v_mfma_f32_16x16x32_bf16 v[120:123], a[72:75], a[40:43], v[120:123]
  v_mfma_f32_16x16x32_bf16 v[176:179], a[72:75], a[44:47], v[176:179]
  ds_read_b64_tr_b16 a[72:73], v229 offset:43072
  buffer_load_dwordx4 v227, s[8:11], s17 offen offset:2048 lds
  v_mfma_f32_16x16x32_bf16 v[12:15], a[76:79], a[32:35], v[12:15]
  ds_read_b64_tr_b16 a[74:75], v229 offset:46656
  v_mfma_f32_16x16x32_bf16 v[68:71], a[76:79], a[36:39], v[68:71]
  v_mfma_f32_16x16x32_bf16 v[124:127], a[76:79], a[40:43], v[124:127]
  v_mfma_f32_16x16x32_bf16 v[180:183], a[76:79], a[44:47], v[180:183]
  ds_read_b64_tr_b16 a[76:77], v229 offset:43104
  v_mfma_f32_16x16x32_bf16 v[16:19], a[80:83], a[32:35], v[16:19]
  ds_read_b64_tr_b16 a[78:79], v229 offset:46688
  v_mfma_f32_16x16x32_bf16 v[72:75], a[80:83], a[36:39], v[72:75]
  s_mov_b32 exec_hi, 0
  buffer_load_dwordx4 v228, s[8:11], s17 offen offset:3072 lds
  s_mov_b32 exec_hi, -1
  s_add_u32 s17, s17, 229376
  v_mfma_f32_16x16x32_bf16 v[128:131], a[80:83], a[40:43], v[128:131]
  v_mfma_f32_16x16x32_bf16 v[184:187], a[80:83], a[44:47], v[184:187]
  ds_read_b64_tr_b16 a[80:81], v229 offset:43136
  v_mfma_f32_16x16x32_bf16 v[20:23], a[84:87], a[32:35], v[20:23]
  ds_read_b64_tr_b16 a[82:83], v229 offset:46720
  v_mfma_f32_16x16x32_bf16 v[76:79], a[84:87], a[36:39], v[76:79]
  v_mfma_f32_16x16x32_bf16 v[132:135], a[84:87], a[40:43], v[132:135]
  v_mfma_f32_16x16x32_bf16 v[188:191], a[84:87], a[44:47], v[188:191]
  ds_read_b64_tr_b16 a[84:85], v229 offset:43168
  buffer_load_dwordx4 a[16:19], v224, s[4:7], s16 offen offset:0 sc1
  v_mfma_f32_16x16x32_bf16 v[24:27], a[88:91], a[32:35], v[24:27]
  ds_read_b64_tr_b16 a[86:87], v229 offset:46752
  v_mfma_f32_16x16x32_bf16 v[80:83], a[88:91], a[36:39], v[80:83]
  v_mfma_f32_16x16x32_bf16 v[136:139], a[88:91], a[40:43], v[136:139]
  v_mfma_f32_16x16x32_bf16 v[192:195], a[88:91], a[44:47], v[192:195]
  ds_read_b64_tr_b16 a[88:89], v229 offset:43200
  v_mfma_f32_16x16x32_bf16 v[28:31], a[92:95], a[32:35], v[28:31]
  ds_read_b64_tr_b16 a[90:91], v229 offset:46784
  v_mfma_f32_16x16x32_bf16 v[84:87], a[92:95], a[36:39], v[84:87]
  v_mfma_f32_16x16x32_bf16 v[140:143], a[92:95], a[40:43], v[140:143]
  buffer_load_dwordx4 a[20:23], v224, s[4:7], s16 offen offset:1024 sc1
  v_mfma_f32_16x16x32_bf16 v[196:199], a[92:95], a[44:47], v[196:199]
  ds_read_b64_tr_b16 a[92:93], v229 offset:50176
  v_mfma_f32_16x16x32_bf16 v[32:35], a[96:99], a[32:35], v[32:35]
  ds_read_b64_tr_b16 a[94:95], v229 offset:53760
  v_mfma_f32_16x16x32_bf16 v[88:91], a[96:99], a[36:39], v[88:91]
  v_mfma_f32_16x16x32_bf16 v[144:147], a[96:99], a[40:43], v[144:147]
  v_mfma_f32_16x16x32_bf16 v[200:203], a[96:99], a[44:47], v[200:203]
  ds_read_b64_tr_b16 a[96:97], v229 offset:50208
  s_waitcnt lgkmcnt(10)
  v_mfma_f32_16x16x32_bf16 v[36:39], a[100:103], a[32:35], v[36:39]
  ds_read_b64_tr_b16 a[98:99], v229 offset:53792
  buffer_load_dwordx4 a[24:27], v224, s[4:7], s16 offen offset:2048 sc1
  v_mfma_f32_16x16x32_bf16 v[92:95], a[100:103], a[36:39], v[92:95]
  v_mfma_f32_16x16x32_bf16 v[148:151], a[100:103], a[40:43], v[148:151]
  v_mfma_f32_16x16x32_bf16 v[204:207], a[100:103], a[44:47], v[204:207]
  ds_read_b64_tr_b16 a[100:101], v229 offset:50240
  v_mfma_f32_16x16x32_bf16 v[40:43], a[104:107], a[32:35], v[40:43]
  ds_read_b64_tr_b16 a[102:103], v229 offset:53824
  v_mfma_f32_16x16x32_bf16 v[96:99], a[104:107], a[36:39], v[96:99]
  v_mfma_f32_16x16x32_bf16 v[152:155], a[104:107], a[40:43], v[152:155]
  buffer_load_dwordx4 a[28:31], v224, s[4:7], s16 offen offset:3072 sc1
  s_add_u32 s16, s16, 131072
  v_mfma_f32_16x16x32_bf16 v[208:211], a[104:107], a[44:47], v[208:211]
  ds_read_b64_tr_b16 a[104:105], v229 offset:50272
  v_mfma_f32_16x16x32_bf16 v[44:47], a[108:111], a[32:35], v[44:47]
  ds_read_b64_tr_b16 a[106:107], v229 offset:53856
  v_mfma_f32_16x16x32_bf16 v[100:103], a[108:111], a[36:39], v[100:103]
  v_mfma_f32_16x16x32_bf16 v[156:159], a[108:111], a[40:43], v[156:159]
  v_mfma_f32_16x16x32_bf16 v[212:215], a[108:111], a[44:47], v[212:215]
  ds_read_b64_tr_b16 a[108:109], v229 offset:50304
  v_mfma_f32_16x16x32_bf16 v[48:51], a[112:115], a[32:35], v[48:51]
  ds_read_b64_tr_b16 a[110:111], v229 offset:53888
  buffer_load_dword v251, v249, s[52:55], s56 offen
  s_add_u32 s56, s56, 0x80000
  s_add_u32 s59, s59, 1
  s_cmp_eq_u32 s59, 7
  s_cselect_b32 s52, s22, s52
  s_cselect_b32 s53, s23, s53
  s_cselect_b32 s56, s60, s56
  v_mfma_f32_16x16x32_bf16 v[104:107], a[112:115], a[36:39], v[104:107]
  v_mfma_f32_16x16x32_bf16 v[160:163], a[112:115], a[40:43], v[160:163]
  v_mfma_f32_16x16x32_bf16 v[216:219], a[112:115], a[44:47], v[216:219]
  ds_read_b64_tr_b16 a[112:113], v229 offset:50336
  v_mfma_f32_16x16x32_bf16 v[52:55], a[116:119], a[32:35], v[52:55]
  ds_read_b64_tr_b16 a[114:115], v229 offset:53920
  v_mfma_f32_16x16x32_bf16 v[108:111], a[116:119], a[36:39], v[108:111]
  v_mfma_f32_16x16x32_bf16 v[164:167], a[116:119], a[40:43], v[164:167]
  v_mfma_f32_16x16x32_bf16 v[220:223], a[116:119], a[44:47], v[220:223]
  ds_read_b64_tr_b16 a[116:117], v229 offset:50368
  ds_read_b64_tr_b16 a[118:119], v229 offset:53952
  s_waitcnt vmcnt(13) lgkmcnt(10)
  s_barrier
  s_add_u32 m0, s38, 28672
  s_nop 0
  buffer_load_dwordx4 v225, s[8:11], s17 offen lds
  v_mfma_f32_16x16x32_bf16 v[0:3], a[64:67], a[48:51], v[0:3]
  v_mfma_f32_16x16x32_bf16 v[56:59], a[64:67], a[52:55], v[56:59]
  v_mfma_f32_16x16x32_bf16 v[112:115], a[64:67], a[56:59], v[112:115]
  v_mfma_f32_16x16x32_bf16 v[168:171], a[64:67], a[60:63], v[168:171]
  ds_read_b64_tr_b16 a[64:65], v229 offset:0
  v_mfma_f32_16x16x32_bf16 v[4:7], a[68:71], a[48:51], v[4:7]
  ds_read_b64_tr_b16 a[66:67], v229 offset:3584
  v_mfma_f32_16x16x32_bf16 v[60:63], a[68:71], a[52:55], v[60:63]
  v_mfma_f32_16x16x32_bf16 v[116:119], a[68:71], a[56:59], v[116:119]
  buffer_load_dwordx4 v226, s[8:11], s17 offen offset:1024 lds
  v_mfma_f32_16x16x32_bf16 v[172:175], a[68:71], a[60:63], v[172:175]
  ds_read_b64_tr_b16 a[68:69], v229 offset:32
  v_mfma_f32_16x16x32_bf16 v[8:11], a[72:75], a[48:51], v[8:11]
  ds_read_b64_tr_b16 a[70:71], v229 offset:3616
  v_mfma_f32_16x16x32_bf16 v[64:67], a[72:75], a[52:55], v[64:67]
  v_mfma_f32_16x16x32_bf16 v[120:123], a[72:75], a[56:59], v[120:123]
  v_mfma_f32_16x16x32_bf16 v[176:179], a[72:75], a[60:63], v[176:179]
  ds_read_b64_tr_b16 a[72:73], v229 offset:64
  v_mfma_f32_16x16x32_bf16 v[12:15], a[76:79], a[48:51], v[12:15]
  ds_read_b64_tr_b16 a[74:75], v229 offset:3648
  v_mfma_f32_16x16x32_bf16 v[68:71], a[76:79], a[52:55], v[68:71]
  buffer_load_dwordx4 v227, s[8:11], s17 offen offset:2048 lds
  v_mfma_f32_16x16x32_bf16 v[124:127], a[76:79], a[56:59], v[124:127]
  v_mfma_f32_16x16x32_bf16 v[180:183], a[76:79], a[60:63], v[180:183]
  ds_read_b64_tr_b16 a[76:77], v229 offset:96
  v_mfma_f32_16x16x32_bf16 v[16:19], a[80:83], a[48:51], v[16:19]
  ds_read_b64_tr_b16 a[78:79], v229 offset:3680
  v_mfma_f32_16x16x32_bf16 v[72:75], a[80:83], a[52:55], v[72:75]
  v_mfma_f32_16x16x32_bf16 v[128:131], a[80:83], a[56:59], v[128:131]
  v_mfma_f32_16x16x32_bf16 v[184:187], a[80:83], a[60:63], v[184:187]
  ds_read_b64_tr_b16 a[80:81], v229 offset:128
  v_mfma_f32_16x16x32_bf16 v[20:23], a[84:87], a[48:51], v[20:23]
  ds_read_b64_tr_b16 a[82:83], v229 offset:3712
  s_mov_b32 exec_hi, 0
  buffer_load_dwordx4 v228, s[8:11], s17 offen offset:3072 lds
  s_mov_b32 exec_hi, -1
  s_add_u32 s17, s17, 229376
  v_mfma_f32_16x16x32_bf16 v[76:79], a[84:87], a[52:55], v[76:79]
  v_mfma_f32_16x16x32_bf16 v[132:135], a[84:87], a[56:59], v[132:135]
  v_mfma_f32_16x16x32_bf16 v[188:191], a[84:87], a[60:63], v[188:191]
  ds_read_b64_tr_b16 a[84:85], v229 offset:160
  v_mfma_f32_16x16x32_bf16 v[24:27], a[88:91], a[48:51], v[24:27]
  ds_read_b64_tr_b16 a[86:87], v229 offset:3744
  v_mfma_f32_16x16x32_bf16 v[80:83], a[88:91], a[52:55], v[80:83]
  v_mfma_f32_16x16x32_bf16 v[136:139], a[88:91], a[56:59], v[136:139]
  v_mfma_f32_16x16x32_bf16 v[192:195], a[88:91], a[60:63], v[192:195]
  ds_read_b64_tr_b16 a[88:89], v229 offset:192
  buffer_load_dwordx4 a[32:35], v224, s[4:7], s16 offen offset:0 sc1
  v_mfma_f32_16x16x32_bf16 v[28:31], a[92:95], a[48:51], v[28:31]
  ds_read_b64_tr_b16 a[90:91], v229 offset:3776
  v_mfma_f32_16x16x32_bf16 v[84:87], a[92:95], a[52:55], v[84:87]
  v_mfma_f32_16x16x32_bf16 v[140:143], a[92:95], a[56:59], v[140:143]
  v_mfma_f32_16x16x32_bf16 v[196:199], a[92:95], a[60:63], v[196:199]
  ds_read_b64_tr_b16 a[92:93], v229 offset:7168
  v_mfma_f32_16x16x32_bf16 v[32:35], a[96:99], a[48:51], v[32:35]
  ds_read_b64_tr_b16 a[94:95], v229 offset:10752
  v_mfma_f32_16x16x32_bf16 v[88:91], a[96:99], a[52:55], v[88:91]
  buffer_load_dwordx4 a[36:39], v224, s[4:7], s16 offen offset:1024 sc1
  v_mfma_f32_16x16x32_bf16 v[144:147], a[96:99], a[56:59], v[144:147]
  v_mfma_f32_16x16x32_bf16 v[200:203], a[96:99], a[60:63], v[200:203]
  ds_read_b64_tr_b16 a[96:97], v229 offset:7200
  s_waitcnt lgkmcnt(10)
  v_mfma_f32_16x16x32_bf16 v[36:39], a[100:103], a[48:51], v[36:39]
  ds_read_b64_tr_b16 a[98:99], v229 offset:10784
  v_mfma_f32_16x16x32_bf16 v[92:95], a[100:103], a[52:55], v[92:95]
  v_mfma_f32_16x16x32_bf16 v[148:151], a[100:103], a[56:59], v[148:151]
  v_mfma_f32_16x16x32_bf16 v[204:207], a[100:103], a[60:63], v[204:207]
  ds_read_b64_tr_b16 a[100:101], v229 offset:7232
  v_mfma_f32_16x16x32_bf16 v[40:43], a[104:107], a[48:51], v[40:43]
  ds_read_b64_tr_b16 a[102:103], v229 offset:10816
  buffer_load_dwordx4 a[40:43], v224, s[4:7], s16 offen offset:2048 sc1
  v_mfma_f32_16x16x32_bf16 v[96:99], a[104:107], a[52:55], v[96:99]
  v_mfma_f32_16x16x32_bf16 v[152:155], a[104:107], a[56:59], v[152:155]
  v_mfma_f32_16x16x32_bf16 v[208:211], a[104:107], a[60:63], v[208:211]
  ds_read_b64_tr_b16 a[104:105], v229 offset:7264
  v_mfma_f32_16x16x32_bf16 v[44:47], a[108:111], a[48:51], v[44:47]
  ds_read_b64_tr_b16 a[106:107], v229 offset:10848
  v_mfma_f32_16x16x32_bf16 v[100:103], a[108:111], a[52:55], v[100:103]
  v_mfma_f32_16x16x32_bf16 v[156:159], a[108:111], a[56:59], v[156:159]
  v_mfma_f32_16x16x32_bf16 v[212:215], a[108:111], a[60:63], v[212:215]
  ds_read_b64_tr_b16 a[108:109], v229 offset:7296
  buffer_load_dwordx4 a[44:47], v224, s[4:7], s16 offen offset:3072 sc1
  s_add_u32 s16, s16, 131072
  v_mfma_f32_16x16x32_bf16 v[48:51], a[112:115], a[48:51], v[48:51]
  ds_read_b64_tr_b16 a[110:111], v229 offset:10880
  v_mfma_f32_16x16x32_bf16 v[104:107], a[112:115], a[52:55], v[104:107]
  v_mfma_f32_16x16x32_bf16 v[160:163], a[112:115], a[56:59], v[160:163]
  v_mfma_f32_16x16x32_bf16 v[216:219], a[112:115], a[60:63], v[216:219]
  ds_read_b64_tr_b16 a[112:113], v229 offset:7328
  v_mfma_f32_16x16x32_bf16 v[52:55], a[116:119], a[48:51], v[52:55]
  ds_read_b64_tr_b16 a[114:115], v229 offset:10912
  v_mfma_f32_16x16x32_bf16 v[108:111], a[116:119], a[52:55], v[108:111]
  v_mfma_f32_16x16x32_bf16 v[164:167], a[116:119], a[56:59], v[164:167]
  v_mfma_f32_16x16x32_bf16 v[220:223], a[116:119], a[60:63], v[220:223]
  ds_read_b64_tr_b16 a[116:117], v229 offset:7360
  ds_read_b64_tr_b16 a[118:119], v229 offset:10944
  s_sub_u32 s18, s18, 1
  s_cmp_lg_u32 s18, 0
  s_cbranch_scc1 L_loop_32
  s_waitcnt vmcnt(13) lgkmcnt(10)
  s_barrier
  s_add_u32 m0, s38, 43008
  s_nop 0
  buffer_load_dwordx4 v225, s[8:11], s17 offen lds
  v_mfma_f32_16x16x32_bf16 v[0:3], a[64:67], a[0:3], v[0:3]
  v_mfma_f32_16x16x32_bf16 v[56:59], a[64:67], a[4:7], v[56:59]
  v_mfma_f32_16x16x32_bf16 v[112:115], a[64:67], a[8:11], v[112:115]
  v_mfma_f32_16x16x32_bf16 v[168:171], a[64:67], a[12:15], v[168:171]
  ds_read_b64_tr_b16 a[64:65], v229 offset:14336
  v_mfma_f32_16x16x32_bf16 v[4:7], a[68:71], a[0:3], v[4:7]
  ds_read_b64_tr_b16 a[66:67], v229 offset:17920
  v_mfma_f32_16x16x32_bf16 v[60:63], a[68:71], a[4:7], v[60:63]
  buffer_load_dwordx4 v226, s[8:11], s17 offen offset:1024 lds
  v_mfma_f32_16x16x32_bf16 v[116:119], a[68:71], a[8:11], v[116:119]
  v_mfma_f32_16x16x32_bf16 v[172:175], a[68:71], a[12:15], v[172:175]
  ds_read_b64_tr_b16 a[68:69], v229 offset:14368
  v_mfma_f32_16x16x32_bf16 v[8:11], a[72:75], a[0:3], v[8:11]
  ds_read_b64_tr_b16 a[70:71], v229 offset:17952
  v_mfma_f32_16x16x32_bf16 v[64:67], a[72:75], a[4:7], v[64:67]
  v_mfma_f32_16x16x32_bf16 v[120:123], a[72:75], a[8:11], v[120:123]
  v_mfma_f32_16x16x32_bf16 v[176:179], a[72:75], a[12:15], v[176:179]
  ds_read_b64_tr_b16 a[72:73], v229 offset:14400
  buffer_load_dwordx4 v227, s[8:11], s17 offen offset:2048 lds
  v_mfma_f32_16x16x32_bf16 v[12:15], a[76:79], a[0:3], v[12:15]
  ds_read_b64_tr_b16 a[74:75], v229 offset:17984
  v_mfma_f32_16x16x32_bf16 v[68:71], a[76:79], a[4:7], v[68:71]
  v_mfma_f32_16x16x32_bf16 v[124:127], a[76:79], a[8:11], v[124:127]
  v_mfma_f32_16x16x32_bf16 v[180:183], a[76:79], a[12:15], v[180:183]
  ds_read_b64_tr_b16 a[76:77], v229 offset:14432
  v_mfma_f32_16x16x32_bf16 v[16:19], a[80:83], a[0:3], v[16:19]
  ds_read_b64_tr_b16 a[78:79], v229 offset:18016
  v_mfma_f32_16x16x32_bf16 v[72:75], a[80:83], a[4:7], v[72:75]
  s_mov_b32 exec_hi, 0
  buffer_load_dwordx4 v228, s[8:11], s17 offen offset:3072 lds
  s_mov_b32 exec_hi, -1
  s_add_u32 s17, s17, 229376
  v_mfma_f32_16x16x32_bf16 v[128:131], a[80:83], a[8:11], v[128:131]
  v_mfma_f32_16x16x32_bf16 v[184:187], a[80:83], a[12:15], v[184:187]
  ds_read_b64_tr_b16 a[80:81], v229 offset:14464
  v_mfma_f32_16x16x32_bf16 v[20:23], a[84:87], a[0:3], v[20:23]
  ds_read_b64_tr_b16 a[82:83], v229 offset:18048
  v_mfma_f32_16x16x32_bf16 v[76:79], a[84:87], a[4:7], v[76:79]
  v_mfma_f32_16x16x32_bf16 v[132:135], a[84:87], a[8:11], v[132:135]
  v_mfma_f32_16x16x32_bf16 v[188:191], a[84:87], a[12:15], v[188:191]
  ds_read_b64_tr_b16 a[84:85], v229 offset:14496
  buffer_load_dwordx4 a[48:51], v224, s[4:7], s16 offen offset:0 sc1
  v_mfma_f32_16x16x32_bf16 v[24:27], a[88:91], a[0:3], v[24:27]
  ds_read_b64_tr_b16 a[86:87], v229 offset:18080
  v_mfma_f32_16x16x32_bf16 v[80:83], a[88:91], a[4:7], v[80:83]
  v_mfma_f32_16x16x32_bf16 v[136:139], a[88:91], a[8:11], v[136:139]
  v_mfma_f32_16x16x32_bf16 v[192:195], a[88:91], a[12:15], v[192:195]
  ds_read_b64_tr_b16 a[88:89], v229 offset:14528
  v_mfma_f32_16x16x32_bf16 v[28:31], a[92:95], a[0:3], v[28:31]
  ds_read_b64_tr_b16 a[90:91], v229 offset:18112
  v_mfma_f32_16x16x32_bf16 v[84:87], a[92:95], a[4:7], v[84:87]
  v_mfma_f32_16x16x32_bf16 v[140:143], a[92:95], a[8:11], v[140:143]
  buffer_load_dwordx4 a[52:55], v224, s[4:7], s16 offen offset:1024 sc1
  v_mfma_f32_16x16x32_bf16 v[196:199], a[92:95], a[12:15], v[196:199]
  ds_read_b64_tr_b16 a[92:93], v229 offset:21504
  v_mfma_f32_16x16x32_bf16 v[32:35], a[96:99], a[0:3], v[32:35]
  ds_read_b64_tr_b16 a[94:95], v229 offset:25088
  v_mfma_f32_16x16x32_bf16 v[88:91], a[96:99], a[4:7], v[88:91]
  v_mfma_f32_16x16x32_bf16 v[144:147], a[96:99], a[8:11], v[144:147]
  v_mfma_f32_16x16x32_bf16 v[200:203], a[96:99], a[12:15], v[200:203]
  ds_read_b64_tr_b16 a[96:97], v229 offset:21536
  s_waitcnt lgkmcnt(10)
  v_mfma_f32_16x16x32_bf16 v[36:39], a[100:103], a[0:3], v[36:39]
  ds_read_b64_tr_b16 a[98:99], v229 offset:25120
  buffer_load_dwordx4 a[56:59], v224, s[4:7], s16 offen offset:2048 sc1
  v_mfma_f32_16x16x32_bf16 v[92:95], a[100:103], a[4:7], v[92:95]
  v_mfma_f32_16x16x32_bf16 v[148:151], a[100:103], a[8:11], v[148:151]
  v_mfma_f32_16x16x32_bf16 v[204:207], a[100:103], a[12:15], v[204:207]
  ds_read_b64_tr_b16 a[100:101], v229 offset:21568
  v_mfma_f32_16x16x32_bf16 v[40:43], a[104:107], a[0:3], v[40:43]
  ds_read_b64_tr_b16 a[102:103], v229 offset:25152
  v_mfma_f32_16x16x32_bf16 v[96:99], a[104:107], a[4:7], v[96:99]
  v_mfma_f32_16x16x32_bf16 v[152:155], a[104:107], a[8:11], v[152:155]
  buffer_load_dwordx4 a[60:63], v224, s[4:7], s16 offen offset:3072 sc1
  s_add_u32 s16, s16, 131072
  v_mfma_f32_16x16x32_bf16 v[208:211], a[104:107], a[12:15], v[208:211]
  ds_read_b64_tr_b16 a[104:105], v229 offset:21600
  v_mfma_f32_16x16x32_bf16 v[44:47], a[108:111], a[0:3], v[44:47]
  ds_read_b64_tr_b16 a[106:107], v229 offset:25184
  v_mfma_f32_16x16x32_bf16 v[100:103], a[108:111], a[4:7], v[100:103]
  v_mfma_f32_16x16x32_bf16 v[156:159], a[108:111], a[8:11], v[156:159]
  v_mfma_f32_16x16x32_bf16 v[212:215], a[108:111], a[12:15], v[212:215]
  ds_read_b64_tr_b16 a[108:109], v229 offset:21632
  v_mfma_f32_16x16x32_bf16 v[48:51], a[112:115], a[0:3], v[48:51]
  ds_read_b64_tr_b16 a[110:111], v229 offset:25216
  buffer_load_dword v251, v249, s[52:55], s56 offen
  s_add_u32 s56, s56, 0x80000
  s_add_u32 s59, s59, 1
  s_cmp_eq_u32 s59, 7
  s_cselect_b32 s52, s22, s52
  s_cselect_b32 s53, s23, s53
  s_cselect_b32 s56, s60, s56
  v_mfma_f32_16x16x32_bf16 v[104:107], a[112:115], a[4:7], v[104:107]
  v_mfma_f32_16x16x32_bf16 v[160:163], a[112:115], a[8:11], v[160:163]
  v_mfma_f32_16x16x32_bf16 v[216:219], a[112:115], a[12:15], v[216:219]
  ds_read_b64_tr_b16 a[112:113], v229 offset:21664
  v_mfma_f32_16x16x32_bf16 v[52:55], a[116:119], a[0:3], v[52:55]
  ds_read_b64_tr_b16 a[114:115], v229 offset:25248
  v_mfma_f32_16x16x32_bf16 v[108:111], a[116:119], a[4:7], v[108:111]
  v_mfma_f32_16x16x32_bf16 v[164:167], a[116:119], a[8:11], v[164:167]
  v_mfma_f32_16x16x32_bf16 v[220:223], a[116:119], a[12:15], v[220:223]
  ds_read_b64_tr_b16 a[116:117], v229 offset:21696
  ds_read_b64_tr_b16 a[118:119], v229 offset:25280
  s_waitcnt vmcnt(13) lgkmcnt(10)
  s_barrier
  s_add_u32 m0, s38, 0
  s_nop 0
  buffer_load_dwordx4 v225, s[8:11], s17 offen lds
  v_mfma_f32_16x16x32_bf16 v[0:3], a[64:67], a[16:19], v[0:3]
  v_mfma_f32_16x16x32_bf16 v[56:59], a[64:67], a[20:23], v[56:59]
  v_mfma_f32_16x16x32_bf16 v[112:115], a[64:67], a[24:27], v[112:115]
  v_mfma_f32_16x16x32_bf16 v[168:171], a[64:67], a[28:31], v[168:171]
  ds_read_b64_tr_b16 a[64:65], v229 offset:28672
  v_mfma_f32_16x16x32_bf16 v[4:7], a[68:71], a[16:19], v[4:7]
  ds_read_b64_tr_b16 a[66:67], v229 offset:32256
  v_mfma_f32_16x16x32_bf16 v[60:63], a[68:71], a[20:23], v[60:63]
  v_mfma_f32_16x16x32_bf16 v[116:119], a[68:71], a[24:27], v[116:119]
  buffer_load_dwordx4 v226, s[8:11], s17 offen offset:1024 lds
  v_mfma_f32_16x16x32_bf16 v[172:175], a[68:71], a[28:31], v[172:175]
  ds_read_b64_tr_b16 a[68:69], v229 offset:28704
  v_mfma_f32_16x16x32_bf16 v[8:11], a[72:75], a[16:19], v[8:11]
  ds_read_b64_tr_b16 a[70:71], v229 offset:32288
  v_mfma_f32_16x16x32_bf16 v[64:67], a[72:75], a[20:23], v[64:67]
  v_mfma_f32_16x16x32_bf16 v[120:123], a[72:75], a[24:27], v[120:123]
  v_mfma_f32_16x16x32_bf16 v[176:179], a[72:75], a[28:31], v[176:179]
  ds_read_b64_tr_b16 a[72:73], v229 offset:28736
  v_mfma_f32_16x16x32_bf16 v[12:15], a[76:79], a[16:19], v[12:15]
  ds_read_b64_tr_b16 a[74:75], v229 offset:32320
  v_mfma_f32_16x16x32_bf16 v[68:71], a[76:79], a[20:23], v[68:71]
  buffer_load_dwordx4 v227, s[8:11], s17 offen offset:2048 lds
  v_mfma_f32_16x16x32_bf16 v[124:127], a[76:79], a[24:27], v[124:127]
  v_mfma_f32_16x16x32_bf16 v[180:183], a[76:79], a[28:31], v[180:183]
  ds_read_b64_tr_b16 a[76:77], v229 offset:28768
  v_mfma_f32_16x16x32_bf16 v[16:19], a[80:83], a[16:19], v[16:19]
  ds_read_b64_tr_b16 a[78:79], v229 offset:32352
  v_mfma_f32_16x16x32_bf16 v[72:75], a[80:83], a[20:23], v[72:75]
  v_mfma_f32_16x16x32_bf16 v[128:131], a[80:83], a[24:27], v[128:131]
  v_mfma_f32_16x16x32_bf16 v[184:187], a[80:83], a[28:31], v[184:187]
  ds_read_b64_tr_b16 a[80:81], v229 offset:28800
  v_mfma_f32_16x16x32_bf16 v[20:23], a[84:87], a[16:19], v[20:23]
  ds_read_b64_tr_b16 a[82:83], v229 offset:32384
  s_mov_b32 exec_hi, 0
  buffer_load_dwordx4 v228, s[8:11], s17 offen offset:3072 lds
  s_mov_b32 exec_hi, -1
  s_add_u32 s17, s17, 229376
  v_mfma_f32_16x16x32_bf16 v[76:79], a[84:87], a[20:23], v[76:79]
  v_mfma_f32_16x16x32_bf16 v[132:135], a[84:87], a[24:27], v[132:135]
  v_mfma_f32_16x16x32_bf16 v[188:191], a[84:87], a[28:31], v[188:191]
  ds_read_b64_tr_b16 a[84:85], v229 offset:28832
  v_mfma_f32_16x16x32_bf16 v[24:27], a[88:91], a[16:19], v[24:27]
  ds_read_b64_tr_b16 a[86:87], v229 offset:32416
  v_mfma_f32_16x16x32_bf16 v[80:83], a[88:91], a[20:23], v[80:83]
  v_mfma_f32_16x16x32_bf16 v[136:139], a[88:91], a[24:27], v[136:139]
  v_mfma_f32_16x16x32_bf16 v[192:195], a[88:91], a[28:31], v[192:195]
  ds_read_b64_tr_b16 a[88:89], v229 offset:28864
  buffer_load_dwordx4 a[0:3], v224, s[4:7], s16 offen offset:0 sc1
  v_mfma_f32_16x16x32_bf16 v[28:31], a[92:95], a[16:19], v[28:31]
  ds_read_b64_tr_b16 a[90:91], v229 offset:32448
  v_mfma_f32_16x16x32_bf16 v[84:87], a[92:95], a[20:23], v[84:87]
  v_mfma_f32_16x16x32_bf16 v[140:143], a[92:95], a[24:27], v[140:143]
  v_mfma_f32_16x16x32_bf16 v[196:199], a[92:95], a[28:31], v[196:199]
  ds_read_b64_tr_b16 a[92:93], v229 offset:35840
  v_mfma_f32_16x16x32_bf16 v[32:35], a[96:99], a[16:19], v[32:35]
  ds_read_b64_tr_b16 a[94:95], v229 offset:39424
  v_mfma_f32_16x16x32_bf16 v[88:91], a[96:99], a[20:23], v[88:91]
  buffer_load_dwordx4 a[4:7], v224, s[4:7], s16 offen offset:1024 sc1
  v_mfma_f32_16x16x32_bf16 v[144:147], a[96:99], a[24:27], v[144:147]
  v_mfma_f32_16x16x32_bf16 v[200:203], a[96:99], a[28:31], v[200:203]
  ds_read_b64_tr_b16 a[96:97], v229 offset:35872
  s_waitcnt lgkmcnt(10)
  v_mfma_f32_16x16x32_bf16 v[36:39], a[100:103], a[16:19], v[36:39]
  ds_read_b64_tr_b16 a[98:99], v229 offset:39456
  v_mfma_f32_16x16x32_bf16 v[92:95], a[100:103], a[20:23], v[92:95]
  v_mfma_f32_16x16x32_bf16 v[148:151], a[100:103], a[24:27], v[148:151]
  v_mfma_f32_16x16x32_bf16 v[204:207], a[100:103], a[28:31], v[204:207]
  ds_read_b64_tr_b16 a[100:101], v229 offset:35904
  v_mfma_f32_16x16x32_bf16 v[40:43], a[104:107], a[16:19], v[40:43]
  ds_read_b64_tr_b16 a[102:103], v229 offset:39488
  buffer_load_dwordx4 a[8:11], v224, s[4:7], s16 offen offset:2048 sc1
  v_mfma_f32_16x16x32_bf16 v[96:99], a[104:107], a[20:23], v[96:99]
  v_mfma_f32_16x16x32_bf16 v[152:155], a[104:107], a[24:27], v[152:155]
  v_mfma_f32_16x16x32_bf16 v[208:211], a[104:107], a[28:31], v[208:211]
  ds_read_b64_tr_b16 a[104:105], v229 offset:35936
  v_mfma_f32_16x16x32_bf16 v[44:47], a[108:111], a[16:19], v[44:47]
  ds_read_b64_tr_b16 a[106:107], v229 offset:39520
  v_mfma_f32_16x16x32_bf16 v[100:103], a[108:111], a[20:23], v[100:103]
  v_mfma_f32_16x16x32_bf16 v[156:159], a[108:111], a[24:27], v[156:159]
  v_mfma_f32_16x16x32_bf16 v[212:215], a[108:111], a[28:31], v[212:215]
  ds_read_b64_tr_b16 a[108:109], v229 offset:35968
  buffer_load_dwordx4 a[12:15], v224, s[4:7], s16 offen offset:3072 sc1
  s_add_u32 s16, s16, 131072
  v_mfma_f32_16x16x32_bf16 v[48:51], a[112:115], a[16:19], v[48:51]
  ds_read_b64_tr_b16 a[110:111], v229 offset:39552
  v_mfma_f32_16x16x32_bf16 v[104:107], a[112:115], a[20:23], v[104:107]
  v_mfma_f32_16x16x32_bf16 v[160:163], a[112:115], a[24:27], v[160:163]
  v_mfma_f32_16x16x32_bf16 v[216:219], a[112:115], a[28:31], v[216:219]
  ds_read_b64_tr_b16 a[112:113], v229 offset:36000
  v_mfma_f32_16x16x32_bf16 v[52:55], a[116:119], a[16:19], v[52:55]
  ds_read_b64_tr_b16 a[114:115], v229 offset:39584
  v_mfma_f32_16x16x32_bf16 v[108:111], a[116:119], a[20:23], v[108:111]
  v_mfma_f32_16x16x32_bf16 v[164:167], a[116:119], a[24:27], v[164:167]
  v_mfma_f32_16x16x32_bf16 v[220:223], a[116:119], a[28:31], v[220:223]
  ds_read_b64_tr_b16 a[116:117], v229 offset:36032
  ds_read_b64_tr_b16 a[118:119], v229 offset:39616
  s_waitcnt vmcnt(13) lgkmcnt(10)
  s_barrier
  s_add_u32 m0, s38, 14336
  s_nop 0
  buffer_load_dwordx4 v225, s[8:11], s17 offen lds
  v_mfma_f32_16x16x32_bf16 v[0:3], a[64:67], a[32:35], v[0:3]
  v_mfma_f32_16x16x32_bf16 v[56:59], a[64:67], a[36:39], v[56:59]
  v_mfma_f32_16x16x32_bf16 v[112:115], a[64:67], a[40:43], v[112:115]
  v_mfma_f32_16x16x32_bf16 v[168:171], a[64:67], a[44:47], v[168:171]
  ds_read_b64_tr_b16 a[64:65], v229 offset:43008
  v_mfma_f32_16x16x32_bf16 v[4:7], a[68:71], a[32:35], v[4:7]
  ds_read_b64_tr_b16 a[66:67], v229 offset:46592
  v_mfma_f32_16x16x32_bf16 v[60:63], a[68:71], a[36:39], v[60:63]
  v_mfma_f32_16x16x32_bf16 v[116:119], a[68:71], a[40:43], v[116:119]
  buffer_load_dwordx4 v226, s[8:11], s17 offen offset:1024 lds
  v_mfma_f32_16x16x32_bf16 v[172:175], a[68:71], a[44:47], v[172:175]
  ds_read_b64_tr_b16 a[68:69], v229 offset:43040
  v_mfma_f32_16x16x32_bf16 v[8:11], a[72:75], a[32:35], v[8:11]
  ds_read_b64_tr_b16 a[70:71], v229 offset:46624
  v_mfma_f32_16x16x32_bf16 v[64:67], a[72:75], a[36:39], v[64:67]
  v_mfma_f32_16x16x32_bf16 v[120:123], a[72:75], a[40:43], v[120:123]
  v_mfma_f32_16x16x32_bf16 v[176:179], a[72:75], a[44:47], v[176:179]
  ds_read_b64_tr_b16 a[72:73], v229 offset:43072
  v_mfma_f32_16x16x32_bf16 v[12:15], a[76:79], a[32:35], v[12:15]
  ds_read_b64_tr_b16 a[74:75], v229 offset:46656
  v_mfma_f32_16x16x32_bf16 v[68:71], a[76:79], a[36:39], v[68:71]
  buffer_load_dwordx4 v227, s[8:11], s17 offen offset:2048 lds
  v_mfma_f32_16x16x32_bf16 v[124:127], a[76:79], a[40:43], v[124:127]
  v_mfma_f32_16x16x32_bf16 v[180:183], a[76:79], a[44:47], v[180:183]
  ds_read_b64_tr_b16 a[76:77], v229 offset:43104
  v_mfma_f32_16x16x32_bf16 v[16:19], a[80:83], a[32:35], v[16:19]
  ds_read_b64_tr_b16 a[78:79], v229 offset:46688
  v_mfma_f32_16x16x32_bf16 v[72:75], a[80:83], a[36:39], v[72:75]
  v_mfma_f32_16x16x32_bf16 v[128:131], a[80:83], a[40:43], v[128:131]
  v_mfma_f32_16x16x32_bf16 v[184:187], a[80:83], a[44:47], v[184:187]
  ds_read_b64_tr_b16 a[80:81], v229 offset:43136
  v_mfma_f32_16x16x32_bf16 v[20:23], a[84:87], a[32:35], v[20:23]
  ds_read_b64_tr_b16 a[82:83], v229 offset:46720
  s_mov_b32 exec_hi, 0
  buffer_load_dwordx4 v228, s[8:11], s17 offen offset:3072 lds
  s_mov_b32 exec_hi, -1
  s_add_u32 s17, s17, 229376
  v_mfma_f32_16x16x32_bf16 v[76:79], a[84:87], a[36:39], v[76:79]
  v_mfma_f32_16x16x32_bf16 v[132:135], a[84:87], a[40:43], v[132:135]
  v_mfma_f32_16x16x32_bf16 v[188:191], a[84:87], a[44:47], v[188:191]
  ds_read_b64_tr_b16 a[84:85], v229 offset:43168
  v_mfma_f32_16x16x32_bf16 v[24:27], a[88:91], a[32:35], v[24:27]
  ds_read_b64_tr_b16 a[86:87], v229 offset:46752
  v_mfma_f32_16x16x32_bf16 v[80:83], a[88:91], a[36:39], v[80:83]
  v_mfma_f32_16x16x32_bf16 v[136:139], a[88:91], a[40:43], v[136:139]
  v_mfma_f32_16x16x32_bf16 v[192:195], a[88:91], a[44:47], v[192:195]
  ds_read_b64_tr_b16 a[88:89], v229 offset:43200
  buffer_load_dwordx4 a[16:19], v224, s[4:7], s16 offen offset:0 sc1
  v_mfma_f32_16x16x32_bf16 v[28:31], a[92:95], a[32:35], v[28:31]
  ds_read_b64_tr_b16 a[90:91], v229 offset:46784
  v_mfma_f32_16x16x32_bf16 v[84:87], a[92:95], a[36:39], v[84:87]
  v_mfma_f32_16x16x32_bf16 v[140:143], a[92:95], a[40:43], v[140:143]
  v_mfma_f32_16x16x32_bf16 v[196:199], a[92:95], a[44:47], v[196:199]
  ds_read_b64_tr_b16 a[92:93], v229 offset:50176
  v_mfma_f32_16x16x32_bf16 v[32:35], a[96:99], a[32:35], v[32:35]
  ds_read_b64_tr_b16 a[94:95], v229 offset:53760
  v_mfma_f32_16x16x32_bf16 v[88:91], a[96:99], a[36:39], v[88:91]
  buffer_load_dwordx4 a[20:23], v224, s[4:7], s16 offen offset:1024 sc1
  v_mfma_f32_16x16x32_bf16 v[144:147], a[96:99], a[40:43], v[144:147]
  v_mfma_f32_16x16x32_bf16 v[200:203], a[96:99], a[44:47], v[200:203]
  ds_read_b64_tr_b16 a[96:97], v229 offset:50208
  s_waitcnt lgkmcnt(10)
  v_mfma_f32_16x16x32_bf16 v[36:39], a[100:103], a[32:35], v[36:39]
  ds_read_b64_tr_b16 a[98:99], v229 offset:53792
  v_mfma_f32_16x16x32_bf16 v[92:95], a[100:103], a[36:39], v[92:95]
  v_mfma_f32_16x16x32_bf16 v[148:151], a[100:103], a[40:43], v[148:151]
  v_mfma_f32_16x16x32_bf16 v[204:207], a[100:103], a[44:47], v[204:207]
  ds_read_b64_tr_b16 a[100:101], v229 offset:50240
  v_mfma_f32_16x16x32_bf16 v[40:43], a[104:107], a[32:35], v[40:43]
  ds_read_b64_tr_b16 a[102:103], v229 offset:53824
  buffer_load_dwordx4 a[24:27], v224, s[4:7], s16 offen offset:2048 sc1
  v_mfma_f32_16x16x32_bf16 v[96:99], a[104:107], a[36:39], v[96:99]
  v_mfma_f32_16x16x32_bf16 v[152:155], a[104:107], a[40:43], v[152:155]
  v_mfma_f32_16x16x32_bf16 v[208:211], a[104:107], a[44:47], v[208:211]
  ds_read_b64_tr_b16 a[104:105], v229 offset:50272
  v_mfma_f32_16x16x32_bf16 v[44:47], a[108:111], a[32:35], v[44:47]
  ds_read_b64_tr_b16 a[106:107], v229 offset:53856
  v_mfma_f32_16x16x32_bf16 v[100:103], a[108:111], a[36:39], v[100:103]
  v_mfma_f32_16x16x32_bf16 v[156:159], a[108:111], a[40:43], v[156:159]
  v_mfma_f32_16x16x32_bf16 v[212:215], a[108:111], a[44:47], v[212:215]
  ds_read_b64_tr_b16 a[108:109], v229 offset:50304
  buffer_load_dwordx4 a[28:31], v224, s[4:7], s16 offen offset:3072 sc1
  s_add_u32 s16, s16, 131072
  v_mfma_f32_16x16x32_bf16 v[48:51], a[112:115], a[32:35], v[48:51]
  ds_read_b64_tr_b16 a[110:111], v229 offset:53888
  v_mfma_f32_16x16x32_bf16 v[104:107], a[112:115], a[36:39], v[104:107]
  v_mfma_f32_16x16x32_bf16 v[160:163], a[112:115], a[40:43], v[160:163]
  v_mfma_f32_16x16x32_bf16 v[216:219], a[112:115], a[44:47], v[216:219]
  ds_read_b64_tr_b16 a[112:113], v229 offset:50336
  v_mfma_f32_16x16x32_bf16 v[52:55], a[116:119], a[32:35], v[52:55]
  ds_read_b64_tr_b16 a[114:115], v229 offset:53920
  v_mfma_f32_16x16x32_bf16 v[108:111], a[116:119], a[36:39], v[108:111]
  v_mfma_f32_16x16x32_bf16 v[164:167], a[116:119], a[40:43], v[164:167]
  v_mfma_f32_16x16x32_bf16 v[220:223], a[116:119], a[44:47], v[220:223]
  ds_read_b64_tr_b16 a[116:117], v229 offset:50368
  ds_read_b64_tr_b16 a[118:119], v229 offset:53952
  s_waitcnt vmcnt(12) lgkmcnt(10)
  s_barrier
  s_add_u32 m0, s38, 28672
  s_nop 0
  buffer_load_dwordx4 v225, s[8:11], s17 offen lds
  v_mfma_f32_16x16x32_bf16 v[0:3], a[64:67], a[48:51], v[0:3]
  v_mfma_f32_16x16x32_bf16 v[56:59], a[64:67], a[52:55], v[56:59]
  v_mfma_f32_16x16x32_bf16 v[112:115], a[64:67], a[56:59], v[112:115]
  v_mfma_f32_16x16x32_bf16 v[168:171], a[64:67], a[60:63], v[168:171]
  ds_read_b64_tr_b16 a[64:65], v229 offset:0
  v_mfma_f32_16x16x32_bf16 v[4:7], a[68:71], a[48:51], v[4:7]
  ds_read_b64_tr_b16 a[66:67], v229 offset:3584
  v_mfma_f32_16x16x32_bf16 v[60:63], a[68:71], a[52:55], v[60:63]
  v_mfma_f32_16x16x32_bf16 v[116:119], a[68:71], a[56:59], v[116:119]
  buffer_load_dwordx4 v226, s[8:11], s17 offen offset:1024 lds
  v_mfma_f32_16x16x32_bf16 v[172:175], a[68:71], a[60:63], v[172:175]
  ds_read_b64_tr_b16 a[68:69], v229 offset:32
  v_mfma_f32_16x16x32_bf16 v[8:11], a[72:75], a[48:51], v[8:11]
  ds_read_b64_tr_b16 a[70:71], v229 offset:3616
  v_mfma_f32_16x16x32_bf16 v[64:67], a[72:75], a[52:55], v[64:67]
  v_mfma_f32_16x16x32_bf16 v[120:123], a[72:75], a[56:59], v[120:123]
  v_mfma_f32_16x16x32_bf16 v[176:179], a[72:75], a[60:63], v[176:179]
  ds_read_b64_tr_b16 a[72:73], v229 offset:64
  v_mfma_f32_16x16x32_bf16 v[12:15], a[76:79], a[48:51], v[12:15]
  ds_read_b64_tr_b16 a[74:75], v229 offset:3648
  v_mfma_f32_16x16x32_bf16 v[68:71], a[76:79], a[52:55], v[68:71]
  buffer_load_dwordx4 v227, s[8:11], s17 offen offset:2048 lds
  v_mfma_f32_16x16x32_bf16 v[124:127], a[76:79], a[56:59], v[124:127]
  v_mfma_f32_16x16x32_bf16 v[180:183], a[76:79], a[60:63], v[180:183]
  ds_read_b64_tr_b16 a[76:77], v229 offset:96
  v_mfma_f32_16x16x32_bf16 v[16:19], a[80:83], a[48:51], v[16:19]
  ds_read_b64_tr_b16 a[78:79], v229 offset:3680
  v_mfma_f32_16x16x32_bf16 v[72:75], a[80:83], a[52:55], v[72:75]
  v_mfma_f32_16x16x32_bf16 v[128:131], a[80:83], a[56:59], v[128:131]
  v_mfma_f32_16x16x32_bf16 v[184:187], a[80:83], a[60:63], v[184:187]
  ds_read_b64_tr_b16 a[80:81], v229 offset:128
  v_mfma_f32_16x16x32_bf16 v[20:23], a[84:87], a[48:51], v[20:23]
  ds_read_b64_tr_b16 a[82:83], v229 offset:3712
  s_mov_b32 exec_hi, 0
  buffer_load_dwordx4 v228, s[8:11], s17 offen offset:3072 lds
  s_mov_b32 exec_hi, -1
  s_add_u32 s17, s17, 229376
  v_mfma_f32_16x16x32_bf16 v[76:79], a[84:87], a[52:55], v[76:79]
  v_mfma_f32_16x16x32_bf16 v[132:135], a[84:87], a[56:59], v[132:135]
  v_mfma_f32_16x16x32_bf16 v[188:191], a[84:87], a[60:63], v[188:191]
  ds_read_b64_tr_b16 a[84:85], v229 offset:160
  v_mfma_f32_16x16x32_bf16 v[24:27], a[88:91], a[48:51], v[24:27]
  ds_read_b64_tr_b16 a[86:87], v229 offset:3744
  v_mfma_f32_16x16x32_bf16 v[80:83], a[88:91], a[52:55], v[80:83]
  v_mfma_f32_16x16x32_bf16 v[136:139], a[88:91], a[56:59], v[136:139]
  v_mfma_f32_16x16x32_bf16 v[192:195], a[88:91], a[60:63], v[192:195]
  ds_read_b64_tr_b16 a[88:89], v229 offset:192
  buffer_load_dwordx4 a[32:35], v224, s[4:7], s16 offen offset:0 sc1
  v_mfma_f32_16x16x32_bf16 v[28:31], a[92:95], a[48:51], v[28:31]
  ds_read_b64_tr_b16 a[90:91], v229 offset:3776
  v_mfma_f32_16x16x32_bf16 v[84:87], a[92:95], a[52:55], v[84:87]
  v_mfma_f32_16x16x32_bf16 v[140:143], a[92:95], a[56:59], v[140:143]
  v_mfma_f32_16x16x32_bf16 v[196:199], a[92:95], a[60:63], v[196:199]
  ds_read_b64_tr_b16 a[92:93], v229 offset:7168
  v_mfma_f32_16x16x32_bf16 v[32:35], a[96:99], a[48:51], v[32:35]
  ds_read_b64_tr_b16 a[94:95], v229 offset:10752
  v_mfma_f32_16x16x32_bf16 v[88:91], a[96:99], a[52:55], v[88:91]
  buffer_load_dwordx4 a[36:39], v224, s[4:7], s16 offen offset:1024 sc1
  v_mfma_f32_16x16x32_bf16 v[144:147], a[96:99], a[56:59], v[144:147]
  v_mfma_f32_16x16x32_bf16 v[200:203], a[96:99], a[60:63], v[200:203]
  ds_read_b64_tr_b16 a[96:97], v229 offset:7200
  s_waitcnt lgkmcnt(10)
  v_mfma_f32_16x16x32_bf16 v[36:39], a[100:103], a[48:51], v[36:39]
  ds_read_b64_tr_b16 a[98:99], v229 offset:10784
  v_mfma_f32_16x16x32_bf16 v[92:95], a[100:103], a[52:55], v[92:95]
  v_mfma_f32_16x16x32_bf16 v[148:151], a[100:103], a[56:59], v[148:151]
  v_mfma_f32_16x16x32_bf16 v[204:207], a[100:103], a[60:63], v[204:207]
  ds_read_b64_tr_b16 a[100:101], v229 offset:7232
  v_mfma_f32_16x16x32_bf16 v[40:43], a[104:107], a[48:51], v[40:43]
  ds_read_b64_tr_b16 a[102:103], v229 offset:10816
  buffer_load_dwordx4 a[40:43], v224, s[4:7], s16 offen offset:2048 sc1
  v_mfma_f32_16x16x32_bf16 v[96:99], a[104:107], a[52:55], v[96:99]
  v_mfma_f32_16x16x32_bf16 v[152:155], a[104:107], a[56:59], v[152:155]
  v_mfma_f32_16x16x32_bf16 v[208:211], a[104:107], a[60:63], v[208:211]
  ds_read_b64_tr_b16 a[104:105], v229 offset:7264
  v_mfma_f32_16x16x32_bf16 v[44:47], a[108:111], a[48:51], v[44:47]
  ds_read_b64_tr_b16 a[106:107], v229 offset:10848
  v_mfma_f32_16x16x32_bf16 v[100:103], a[108:111], a[52:55], v[100:103]
  v_mfma_f32_16x16x32_bf16 v[156:159], a[108:111], a[56:59], v[156:159]
  v_mfma_f32_16x16x32_bf16 v[212:215], a[108:111], a[60:63], v[212:215]
  ds_read_b64_tr_b16 a[108:109], v229 offset:7296
  buffer_load_dwordx4 a[44:47], v224, s[4:7], s16 offen offset:3072 sc1
  s_add_u32 s16, s16, 131072
  v_mfma_f32_16x16x32_bf16 v[48:51], a[112:115], a[48:51], v[48:51]
  ds_read_b64_tr_b16 a[110:111], v229 offset:10880
  v_mfma_f32_16x16x32_bf16 v[104:107], a[112:115], a[52:55], v[104:107]
  v_mfma_f32_16x16x32_bf16 v[160:163], a[112:115], a[56:59], v[160:163]
  v_mfma_f32_16x16x32_bf16 v[216:219], a[112:115], a[60:63], v[216:219]
  ds_read_b64_tr_b16 a[112:113], v229 offset:7328
  v_mfma_f32_16x16x32_bf16 v[52:55], a[116:119], a[48:51], v[52:55]
  ds_read_b64_tr_b16 a[114:115], v229 offset:10912
  v_mfma_f32_16x16x32_bf16 v[108:111], a[116:119], a[52:55], v[108:111]
  v_mfma_f32_16x16x32_bf16 v[164:167], a[116:119], a[56:59], v[164:167]
  v_mfma_f32_16x16x32_bf16 v[220:223], a[116:119], a[60:63], v[220:223]
  ds_read_b64_tr_b16 a[116:117], v229 offset:7360
  ds_read_b64_tr_b16 a[118:119], v229 offset:10944
  s_waitcnt vmcnt(12) lgkmcnt(10)
  s_barrier
  s_add_u32 m0, s38, 43008
  s_nop 0
  buffer_load_dwordx4 v225, s[8:11], s17 offen lds
  v_mfma_f32_16x16x32_bf16 v[0:3], a[64:67], a[0:3], v[0:3]
  v_mfma_f32_16x16x32_bf16 v[56:59], a[64:67], a[4:7], v[56:59]
  v_mfma_f32_16x16x32_bf16 v[112:115], a[64:67], a[8:11], v[112:115]
  v_mfma_f32_16x16x32_bf16 v[168:171], a[64:67], a[12:15], v[168:171]
  ds_read_b64_tr_b16 a[64:65], v229 offset:14336
  v_mfma_f32_16x16x32_bf16 v[4:7], a[68:71], a[0:3], v[4:7]
  ds_read_b64_tr_b16 a[66:67], v229 offset:17920
  v_mfma_f32_16x16x32_bf16 v[60:63], a[68:71], a[4:7], v[60:63]
  buffer_load_dwordx4 v226, s[8:11], s17 offen offset:1024 lds
  v_mfma_f32_16x16x32_bf16 v[116:119], a[68:71], a[8:11], v[116:119]
  v_mfma_f32_16x16x32_bf16 v[172:175], a[68:71], a[12:15], v[172:175]
  ds_read_b64_tr_b16 a[68:69], v229 offset:14368
  v_mfma_f32_16x16x32_bf16 v[8:11], a[72:75], a[0:3], v[8:11]
  ds_read_b64_tr_b16 a[70:71], v229 offset:17952
  v_mfma_f32_16x16x32_bf16 v[64:67], a[72:75], a[4:7], v[64:67]
  v_mfma_f32_16x16x32_bf16 v[120:123], a[72:75], a[8:11], v[120:123]
  v_mfma_f32_16x16x32_bf16 v[176:179], a[72:75], a[12:15], v[176:179]
  ds_read_b64_tr_b16 a[72:73], v229 offset:14400
  buffer_load_dwordx4 v227, s[8:11], s17 offen offset:2048 lds
  v_mfma_f32_16x16x32_bf16 v[12:15], a[76:79], a[0:3], v[12:15]
  ds_read_b64_tr_b16 a[74:75], v229 offset:17984
  v_mfma_f32_16x16x32_bf16 v[68:71], a[76:79], a[4:7], v[68:71]
  v_mfma_f32_16x16x32_bf16 v[124:127], a[76:79], a[8:11], v[124:127]
  v_mfma_f32_16x16x32_bf16 v[180:183], a[76:79], a[12:15], v[180:183]
  ds_read_b64_tr_b16 a[76:77], v229 offset:14432
  v_mfma_f32_16x16x32_bf16 v[16:19], a[80:83], a[0:3], v[16:19]
  ds_read_b64_tr_b16 a[78:79], v229 offset:18016
  v_mfma_f32_16x16x32_bf16 v[72:75], a[80:83], a[4:7], v[72:75]
  s_mov_b32 exec_hi, 0
  buffer_load_dwordx4 v228, s[8:11], s17 offen offset:3072 lds
  s_mov_b32 exec_hi, -1
  s_add_u32 s17, s17, 229376
  v_mfma_f32_16x16x32_bf16 v[128:131], a[80:83], a[8:11], v[128:131]
  v_mfma_f32_16x16x32_bf16 v[184:187], a[80:83], a[12:15], v[184:187]
  ds_read_b64_tr_b16 a[80:81], v229 offset:14464
  v_mfma_f32_16x16x32_bf16 v[20:23], a[84:87], a[0:3], v[20:23]
  ds_read_b64_tr_b16 a[82:83], v229 offset:18048
  v_mfma_f32_16x16x32_bf16 v[76:79], a[84:87], a[4:7], v[76:79]
  v_mfma_f32_16x16x32_bf16 v[132:135], a[84:87], a[8:11], v[132:135]
  v_mfma_f32_16x16x32_bf16 v[188:191], a[84:87], a[12:15], v[188:191]
  ds_read_b64_tr_b16 a[84:85], v229 offset:14496
  buffer_load_dwordx4 a[48:51], v224, s[4:7], s16 offen offset:0 sc1
  v_mfma_f32_16x16x32_bf16 v[24:27], a[88:91], a[0:3], v[24:27]
  ds_read_b64_tr_b16 a[86:87], v229 offset:18080
  v_mfma_f32_16x16x32_bf16 v[80:83], a[88:91], a[4:7], v[80:83]
  v_mfma_f32_16x16x32_bf16 v[136:139], a[88:91], a[8:11], v[136:139]
  v_mfma_f32_16x16x32_bf16 v[192:195], a[88:91], a[12:15], v[192:195]
  ds_read_b64_tr_b16 a[88:89], v229 offset:14528
  v_mfma_f32_16x16x32_bf16 v[28:31], a[92:95], a[0:3], v[28:31]
  ds_read_b64_tr_b16 a[90:91], v229 offset:18112
  v_mfma_f32_16x16x32_bf16 v[84:87], a[92:95], a[4:7], v[84:87]
  v_mfma_f32_16x16x32_bf16 v[140:143], a[92:95], a[8:11], v[140:143]
  buffer_load_dwordx4 a[52:55], v224, s[4:7], s16 offen offset:1024 sc1
  v_mfma_f32_16x16x32_bf16 v[196:199], a[92:95], a[12:15], v[196:199]
  ds_read_b64_tr_b16 a[92:93], v229 offset:21504
  v_mfma_f32_16x16x32_bf16 v[32:35], a[96:99], a[0:3], v[32:35]
  ds_read_b64_tr_b16 a[94:95], v229 offset:25088
  v_mfma_f32_16x16x32_bf16 v[88:91], a[96:99], a[4:7], v[88:91]
  v_mfma_f32_16x16x32_bf16 v[144:147], a[96:99], a[8:11], v[144:147]
  v_mfma_f32_16x16x32_bf16 v[200:203], a[96:99], a[12:15], v[200:203]
  ds_read_b64_tr_b16 a[96:97], v229 offset:21536
  s_waitcnt lgkmcnt(10)
  v_mfma_f32_16x16x32_bf16 v[36:39], a[100:103], a[0:3], v[36:39]
  ds_read_b64_tr_b16 a[98:99], v229 offset:25120
  buffer_load_dwordx4 a[56:59], v224, s[4:7], s16 offen offset:2048 sc1
  v_mfma_f32_16x16x32_bf16 v[92:95], a[100:103], a[4:7], v[92:95]
  v_mfma_f32_16x16x32_bf16 v[148:151], a[100:103], a[8:11], v[148:151]
  v_mfma_f32_16x16x32_bf16 v[204:207], a[100:103], a[12:15], v[204:207]
  ds_read_b64_tr_b16 a[100:101], v229 offset:21568
  v_mfma_f32_16x16x32_bf16 v[40:43], a[104:107], a[0:3], v[40:43]
  ds_read_b64_tr_b16 a[102:103], v229 offset:25152
  v_mfma_f32_16x16x32_bf16 v[96:99], a[104:107], a[4:7], v[96:99]
  v_mfma_f32_16x16x32_bf16 v[152:155], a[104:107], a[8:11], v[152:155]
  buffer_load_dwordx4 a[60:63], v224, s[4:7], s16 offen offset:3072 sc1
  s_add_u32 s16, s16, 131072
  v_mfma_f32_16x16x32_bf16 v[208:211], a[104:107], a[12:15], v[208:211]
  ds_read_b64_tr_b16 a[104:105], v229 offset:21600
  v_mfma_f32_16x16x32_bf16 v[44:47], a[108:111], a[0:3], v[44:47]
  ds_read_b64_tr_b16 a[106:107], v229 offset:25184
  v_mfma_f32_16x16x32_bf16 v[100:103], a[108:111], a[4:7], v[100:103]
  v_mfma_f32_16x16x32_bf16 v[156:159], a[108:111], a[8:11], v[156:159]
  v_mfma_f32_16x16x32_bf16 v[212:215], a[108:111], a[12:15], v[212:215]
  ds_read_b64_tr_b16 a[108:109], v229 offset:21632
  v_mfma_f32_16x16x32_bf16 v[48:51], a[112:115], a[0:3], v[48:51]
  ds_read_b64_tr_b16 a[110:111], v229 offset:25216
  s_getpc_b64 s[52:53]
  L_pc_31:
  s_add_u32 s52, s52, L_k56_seam-L_pc_31
  s_addc_u32 s53, s53, 0
  s_lshr_b32 s56, s2, 3
  s_lshl_b32 s56, s56, 2
  s_add_u32 s56, s56, s3
  s_lshl_b32 s56, s56, 13
  v_lshlrev_b32 v254, 7, v231
  v_add_u32 v254, s56, v254
  v_min_u32 v254, L_code_end-L_k56_seam-4, v254
  v_mov_b32 v255, s53
  v_add_co_u32 v254, vcc, s52, v254
  s_nop 1
  v_addc_co_u32 v255, vcc, 0, v255, vcc
  global_load_dword v251, v[254:255], off
  v_mfma_f32_16x16x32_bf16 v[104:107], a[112:115], a[4:7], v[104:107]
  v_mfma_f32_16x16x32_bf16 v[160:163], a[112:115], a[8:11], v[160:163]
  v_mfma_f32_16x16x32_bf16 v[216:219], a[112:115], a[12:15], v[216:219]
  ds_read_b64_tr_b16 a[112:113], v229 offset:21664
  v_mfma_f32_16x16x32_bf16 v[52:55], a[116:119], a[0:3], v[52:55]
  ds_read_b64_tr_b16 a[114:115], v229 offset:25248
  v_mfma_f32_16x16x32_bf16 v[108:111], a[116:119], a[4:7], v[108:111]
  v_mfma_f32_16x16x32_bf16 v[164:167], a[116:119], a[8:11], v[164:167]
  v_mfma_f32_16x16x32_bf16 v[220:223], a[116:119], a[12:15], v[220:223]
  ds_read_b64_tr_b16 a[116:117], v229 offset:21696
  ds_read_b64_tr_b16 a[118:119], v229 offset:25280
  s_waitcnt vmcnt(13) lgkmcnt(10)
  s_barrier
  s_lshr_b32 s32, s31, 4
  s_mul_i32 s32, s32, 56
  s_and_b32 s33, s31, 15
  v_mfma_f32_16x16x32_bf16 v[0:3], a[64:67], a[16:19], v[0:3]
  s_add_u32 s34, s33, s32
  s_lshl_b32 s98, s34, 17
  v_mfma_f32_16x16x32_bf16 v[56:59], a[64:67], a[20:23], v[56:59]
  s_add_u32 s99, s98, 2097152
  s_add_u32 s100, s98, 4194304
  v_mfma_f32_16x16x32_bf16 v[112:115], a[64:67], a[24:27], v[112:115]
  s_lshr_b32 s34, s33, 1
  s_add_u32 s34, s34, s32
  v_mfma_f32_16x16x32_bf16 v[168:171], a[64:67], a[28:31], v[168:171]
  ds_read_b64_tr_b16 a[64:65], v229 offset:28672
  s_add_u32 s34, s34, 48
  s_lshl_b32 s101, s34, 17
  v_mfma_f32_16x16x32_bf16 v[4:7], a[68:71], a[16:19], v[4:7]
  ds_read_b64_tr_b16 a[66:67], v229 offset:32256
  s_and_b32 s35, s31, 1
  s_lshl_b32 s35, s35, 10
  v_mfma_f32_16x16x32_bf16 v[60:63], a[68:71], a[20:23], v[60:63]
  s_add_u32 s101, s101, s35
  s_lshl_b32 s92, s30, 2
  v_mfma_f32_16x16x32_bf16 v[116:119], a[68:71], a[24:27], v[116:119]
  s_add_u32 s92, s92, s3
  s_lshl_b32 s92, s92, 5
  v_mfma_f32_16x16x32_bf16 v[172:175], a[68:71], a[28:31], v[172:175]
  ds_read_b64_tr_b16 a[68:69], v229 offset:28704
  s_add_u32 s92, s92, s31
  s_lshl_b32 s92, s92, 6
  v_mfma_f32_16x16x32_bf16 v[8:11], a[72:75], a[16:19], v[8:11]
  ds_read_b64_tr_b16 a[70:71], v229 offset:32288
  s_add_u32 s56, s20, 0x80000
  s_addc_u32 s57, s21, 0
  v_mfma_f32_16x16x32_bf16 v[64:67], a[72:75], a[20:23], v[64:67]
  s_mov_b32 s58, 0x30000
  s_mov_b32 s59, 0x20000
  v_mfma_f32_16x16x32_bf16 v[120:123], a[72:75], a[24:27], v[120:123]
  s_and_b32 s28, s2, 1
  s_lshr_b32 s29, s2, 3
  v_mfma_f32_16x16x32_bf16 v[176:179], a[72:75], a[28:31], v[176:179]
  ds_read_b64_tr_b16 a[72:73], v229 offset:28736
  s_bfe_u32 s30, s2, 0x20001
  s_lshl_b32 s30, s30, 2
  v_mfma_f32_16x16x32_bf16 v[12:15], a[76:79], a[16:19], v[12:15]
  ds_read_b64_tr_b16 a[74:75], v229 offset:32320
  s_and_b32 s31, s29, 3
  s_add_u32 s30, s30, s31
  v_mfma_f32_16x16x32_bf16 v[68:71], a[76:79], a[20:23], v[68:71]
  s_lshr_b32 s29, s29, 2
  s_lshl_b32 s31, s29, 1
  v_mfma_f32_16x16x32_bf16 v[124:127], a[76:79], a[24:27], v[124:127]
  s_add_u32 s31, s31, s28
  s_lshl_b32 s94, s30, 1
  v_mfma_f32_16x16x32_bf16 v[180:183], a[76:79], a[28:31], v[180:183]
  ds_read_b64_tr_b16 a[76:77], v229 offset:28768
  s_lshr_b32 s33, s3, 1
  s_add_u32 s94, s94, s33
  v_mfma_f32_16x16x32_bf16 v[16:19], a[80:83], a[16:19], v[16:19]
  ds_read_b64_tr_b16 a[78:79], v229 offset:32352
  s_lshl_b32 s94, s94, 11
  s_lshl_b32 s33, s28, 10
  v_mfma_f32_16x16x32_bf16 v[72:75], a[80:83], a[20:23], v[72:75]
  s_add_u32 s94, s94, s33
  v_and_b32 v246, 15, v231
  v_mfma_f32_16x16x32_bf16 v[128:131], a[80:83], a[24:27], v[128:131]
  v_min_u32 v254, 15, v246
  v_lshlrev_b32 v254, 6, v254
  v_mfma_f32_16x16x32_bf16 v[184:187], a[80:83], a[28:31], v[184:187]
  ds_read_b64_tr_b16 a[80:81], v229 offset:28800
  v_lshlrev_b32 v246, 6, v246
  v_mov_b32 v248, 1
  v_mfma_f32_16x16x32_bf16 v[20:23], a[84:87], a[16:19], v[20:23]
  ds_read_b64_tr_b16 a[82:83], v229 offset:32384
  v_mov_b32 v250, 0
  s_lshl_b32 s32, s30, 13
  v_mfma_f32_16x16x32_bf16 v[76:79], a[84:87], a[20:23], v[76:79]
  s_lshl_b32 s33, s3, 11
  s_add_u32 s32, s32, s33
  v_mfma_f32_16x16x32_bf16 v[132:135], a[84:87], a[24:27], v[132:135]
  v_lshlrev_b32 v240, 4, v231
  v_add_u32 v240, s32, v240
  v_mfma_f32_16x16x32_bf16 v[188:191], a[84:87], a[28:31], v[188:191]
  ds_read_b64_tr_b16 a[84:85], v229 offset:28832
  v_add_u32 v241, 131072, v240
  v_lshrrev_b32 v232, 3, v231
  v_mfma_f32_16x16x32_bf16 v[24:27], a[88:91], a[16:19], v[24:27]
  ds_read_b64_tr_b16 a[86:87], v229 offset:32416
  v_and_b32 v233, 6, v232
  v_and_b32 v234, 7, v231
  v_mfma_f32_16x16x32_bf16 v[80:83], a[88:91], a[20:23], v[80:83]
  v_xor_b32 v233, v233, v234
  v_lshlrev_b32 v232, 11, v232
  v_mfma_f32_16x16x32_bf16 v[136:139], a[88:91], a[24:27], v[136:139]
  v_lshl_add_u32 v232, v233, 4, v232
  s_lshl_b32 s32, s3, 15
  s_add_u32 s32, s32, 4096
  v_mfma_f32_16x16x32_bf16 v[192:195], a[88:91], a[28:31], v[192:195]
  ds_read_b64_tr_b16 a[88:89], v229 offset:28864
  s_lshl_b32 s33, s31, 7
  s_add_u32 s34, s32, s33
  v_mfma_f32_16x16x32_bf16 v[28:31], a[92:95], a[16:19], v[28:31]
  ds_read_b64_tr_b16 a[90:91], v229 offset:32448
  s_xor_b32 s33, s33, 128
  s_add_u32 s35, s32, s33
  v_mfma_f32_16x16x32_bf16 v[84:87], a[92:95], a[20:23], v[84:87]
  v_add_u32 v225, s34, v232
  v_add_u32 v226, 15360, v225
  v_mfma_f32_16x16x32_bf16 v[140:143], a[92:95], a[24:27], v[140:143]
  v_add_u32 v227, s35, v232
  v_add_u32 v228, 13312, v227
  v_mfma_f32_16x16x32_bf16 v[196:199], a[92:95], a[28:31], v[196:199]
  ds_read_b64_tr_b16 a[92:93], v229 offset:35840
  v_subrev_u32 v227, 2048, v227
  s_lshl_b32 s38, s3, 12
  v_mfma_f32_16x16x32_bf16 v[32:35], a[96:99], a[16:19], v[32:35]
  ds_read_b64_tr_b16 a[94:95], v229 offset:39424
  s_add_u32 s38, s38, 57344
  s_mul_i32 s16, s28, 7340032
  v_mfma_f32_16x16x32_bf16 v[88:91], a[96:99], a[20:23], v[88:91]
  s_mul_i32 s17, s28, 3670016
  s_lshr_b32 s33, s3, 1
  v_mfma_f32_16x16x32_bf16 v[144:147], a[96:99], a[24:27], v[144:147]
  s_mul_i32 s33, s33, 196608
  s_add_u32 s17, s17, s33
  v_mfma_f32_16x16x32_bf16 v[200:203], a[96:99], a[28:31], v[200:203]
  ds_read_b64_tr_b16 a[96:97], v229 offset:35872
  s_add_u32 s97, s17, s33
  s_add_u32 s97, s97, 196608
  s_waitcnt lgkmcnt(10)
  v_mfma_f32_16x16x32_bf16 v[36:39], a[100:103], a[16:19], v[36:39]
  ds_read_b64_tr_b16 a[98:99], v229 offset:39456
  s_add_u32 s96, s17, 1376256
  s_lshr_b32 s33, s2, 3
  v_mfma_f32_16x16x32_bf16 v[92:95], a[100:103], a[20:23], v[92:95]
  s_lshl_b32 s33, s33, 11
  s_lshr_b32 s34, s3, 1
  v_mfma_f32_16x16x32_bf16 v[148:151], a[100:103], a[24:27], v[148:151]
  s_lshl_b32 s34, s34, 16
  s_add_u32 s33, s33, s34
  v_mfma_f32_16x16x32_bf16 v[204:207], a[100:103], a[28:31], v[204:207]
  ds_read_b64_tr_b16 a[100:101], v229 offset:35904
  s_and_b32 s34, s3, 1
  s_lshl_b32 s34, s34, 10
  v_mfma_f32_16x16x32_bf16 v[40:43], a[104:107], a[16:19], v[40:43]
  ds_read_b64_tr_b16 a[102:103], v229 offset:39488
  s_add_u32 s33, s33, s34
  s_add_u32 s33, s33, 4352
  v_mfma_f32_16x16x32_bf16 v[96:99], a[104:107], a[20:23], v[96:99]
  v_and_b32 v255, 1, v231
  v_lshlrev_b32 v255, 7, v255
  v_mfma_f32_16x16x32_bf16 v[152:155], a[104:107], a[24:27], v[152:155]
  v_add_u32 v255, s33, v255
  s_sub_u32 s8, s22, 4096
  v_mfma_f32_16x16x32_bf16 v[208:211], a[104:107], a[28:31], v[208:211]
  ds_read_b64_tr_b16 a[104:105], v229 offset:35936
  s_subb_u32 s9, s23, 0
  s_mov_b32 s10, 7344128
  v_mfma_f32_16x16x32_bf16 v[44:47], a[108:111], a[16:19], v[44:47]
  ds_read_b64_tr_b16 a[106:107], v229 offset:39520
  s_add_u32 s4, s20, 0x100000
  s_addc_u32 s5, s21, 0
  v_mfma_f32_16x16x32_bf16 v[100:103], a[108:111], a[20:23], v[100:103]
  s_mov_b32 s6, 0xe00000
  s_mov_b32 s7, 0x20000
  v_mfma_f32_16x16x32_bf16 v[156:159], a[108:111], a[24:27], v[156:159]
  v_lshrrev_b32 v232, 2, v231
  v_lshlrev_b32 v232, 7, v232
  v_mfma_f32_16x16x32_bf16 v[212:215], a[108:111], a[28:31], v[212:215]
  ds_read_b64_tr_b16 a[108:109], v229 offset:35968
  v_bfe_u32 v233, v231, 3, 2
  v_lshl_add_u32 v232, v233, 5, v232
  v_mfma_f32_16x16x32_bf16 v[48:51], a[112:115], a[16:19], v[48:51]
  ds_read_b64_tr_b16 a[110:111], v229 offset:39552
  v_and_b32 v233, 3, v231
  v_lshl_add_u32 v232, v233, 3, v232
  v_mfma_f32_16x16x32_bf16 v[104:107], a[112:115], a[20:23], v[104:107]
  v_xor_b32 v242, 0, v232
  v_add_u32 v242, 57344, v242
  v_mfma_f32_16x16x32_bf16 v[160:163], a[112:115], a[24:27], v[160:163]
  v_xor_b32 v243, 32, v232
  v_add_u32 v243, 57344, v243
  v_mfma_f32_16x16x32_bf16 v[216:219], a[112:115], a[28:31], v[216:219]
  ds_read_b64_tr_b16 a[112:113], v229 offset:36000
  v_xor_b32 v244, 64, v232
  v_add_u32 v244, 57344, v244
  v_mfma_f32_16x16x32_bf16 v[52:55], a[116:119], a[16:19], v[52:55]
  ds_read_b64_tr_b16 a[114:115], v229 offset:39584
  v_xor_b32 v245, 96, v232
  v_add_u32 v245, 57344, v245
  v_mfma_f32_16x16x32_bf16 v[108:111], a[116:119], a[20:23], v[108:111]
  s_mov_b32 s42, 0xbfb8aa3b
  s_mov_b32 s43, 0x42780000
  v_mfma_f32_16x16x32_bf16 v[164:167], a[116:119], a[24:27], v[164:167]
  v_mfma_f32_16x16x32_bf16 v[220:223], a[116:119], a[28:31], v[220:223]
  ds_read_b64_tr_b16 a[116:117], v229 offset:36032
  ds_read_b64_tr_b16 a[118:119], v229 offset:39616
  s_waitcnt vmcnt(5) lgkmcnt(10)
  s_barrier
  v_mfma_f32_16x16x32_bf16 v[0:3], a[64:67], a[32:35], v[0:3]
  v_mfma_f32_16x16x32_bf16 v[56:59], a[64:67], a[36:39], v[56:59]
  s_add_u32 m0, s38, 0
  s_nop 0
  buffer_load_dwordx4 v225, s[8:11], s17 offen lds
  v_mfma_f32_16x16x32_bf16 v[112:115], a[64:67], a[40:43], v[112:115]
  v_mfma_f32_16x16x32_bf16 v[168:171], a[64:67], a[44:47], v[168:171]
  ds_read_b64_tr_b16 a[64:65], v229 offset:43008
  v_mfma_f32_16x16x32_bf16 v[4:7], a[68:71], a[32:35], v[4:7]
  ds_read_b64_tr_b16 a[66:67], v229 offset:46592
  buffer_load_dwordx4 v226, s[8:11], s17 offen offset:1024 lds
  v_mfma_f32_16x16x32_bf16 v[60:63], a[68:71], a[36:39], v[60:63]
  v_mfma_f32_16x16x32_bf16 v[116:119], a[68:71], a[40:43], v[116:119]
  v_mfma_f32_16x16x32_bf16 v[172:175], a[68:71], a[44:47], v[172:175]
  ds_read_b64_tr_b16 a[68:69], v229 offset:43040
  buffer_load_dwordx4 v227, s[8:11], s17 offen offset:2048 lds
  v_mfma_f32_16x16x32_bf16 v[8:11], a[72:75], a[32:35], v[8:11]
  ds_read_b64_tr_b16 a[70:71], v229 offset:46624
  v_mfma_f32_16x16x32_bf16 v[64:67], a[72:75], a[36:39], v[64:67]
  v_mfma_f32_16x16x32_bf16 v[120:123], a[72:75], a[40:43], v[120:123]
  buffer_load_dwordx4 v228, s[8:11], s17 offen offset:3072 lds
  s_add_u32 s17, s17, 458752
  v_mfma_f32_16x16x32_bf16 v[176:179], a[72:75], a[44:47], v[176:179]
  ds_read_b64_tr_b16 a[72:73], v229 offset:50176
  v_mfma_f32_16x16x32_bf16 v[12:15], a[76:79], a[32:35], v[12:15]
  ds_read_b64_tr_b16 a[74:75], v229 offset:53760
  v_mfma_f32_16x16x32_bf16 v[68:71], a[76:79], a[36:39], v[68:71]
  buffer_load_dword v251, v255, s[8:11], s96 offen
  s_add_u32 s96, s96, 458752
  v_mfma_f32_16x16x32_bf16 v[124:127], a[76:79], a[40:43], v[124:127]
  v_mfma_f32_16x16x32_bf16 v[180:183], a[76:79], a[44:47], v[180:183]
  ds_read_b64_tr_b16 a[76:77], v229 offset:50208
  v_mfma_f32_16x16x32_bf16 v[16:19], a[80:83], a[32:35], v[16:19]
  ds_read_b64_tr_b16 a[78:79], v229 offset:53792
  s_add_u32 m0, s38, 16384
  s_nop 0
  buffer_load_dwordx4 v225, s[8:11], s17 offen lds
  v_mfma_f32_16x16x32_bf16 v[72:75], a[80:83], a[36:39], v[72:75]
  v_mfma_f32_16x16x32_bf16 v[128:131], a[80:83], a[40:43], v[128:131]
  v_mfma_f32_16x16x32_bf16 v[184:187], a[80:83], a[44:47], v[184:187]
  ds_read_b64_tr_b16 a[80:81], v229 offset:43072
  buffer_load_dwordx4 v226, s[8:11], s17 offen offset:1024 lds
  v_mfma_f32_16x16x32_bf16 v[20:23], a[84:87], a[32:35], v[20:23]
  ds_read_b64_tr_b16 a[82:83], v229 offset:46656
  v_mfma_f32_16x16x32_bf16 v[76:79], a[84:87], a[36:39], v[76:79]
  v_mfma_f32_16x16x32_bf16 v[132:135], a[84:87], a[40:43], v[132:135]
  buffer_load_dwordx4 v227, s[8:11], s17 offen offset:2048 lds
  v_mfma_f32_16x16x32_bf16 v[188:191], a[84:87], a[44:47], v[188:191]
  ds_read_b64_tr_b16 a[84:85], v229 offset:43104
  v_mfma_f32_16x16x32_bf16 v[24:27], a[88:91], a[32:35], v[24:27]
  ds_read_b64_tr_b16 a[86:87], v229 offset:46688
  v_mfma_f32_16x16x32_bf16 v[80:83], a[88:91], a[36:39], v[80:83]
  buffer_load_dwordx4 v228, s[8:11], s17 offen offset:3072 lds
  s_add_u32 s17, s17, 458752
  v_mfma_f32_16x16x32_bf16 v[136:139], a[88:91], a[40:43], v[136:139]
  v_mfma_f32_16x16x32_bf16 v[192:195], a[88:91], a[44:47], v[192:195]
  ds_read_b64_tr_b16 a[88:89], v229 offset:50240
  v_mfma_f32_16x16x32_bf16 v[28:31], a[92:95], a[32:35], v[28:31]
  ds_read_b64_tr_b16 a[90:91], v229 offset:53824
  buffer_load_dword v251, v255, s[8:11], s96 offen
  s_add_u32 s96, s96, 458752
  v_mfma_f32_16x16x32_bf16 v[84:87], a[92:95], a[36:39], v[84:87]
  v_mfma_f32_16x16x32_bf16 v[140:143], a[92:95], a[40:43], v[140:143]
  v_mfma_f32_16x16x32_bf16 v[196:199], a[92:95], a[44:47], v[196:199]
  ds_read_b64_tr_b16 a[92:93], v229 offset:50272
  s_add_u32 m0, s38, 32768
  s_nop 0
  buffer_load_dwordx4 v225, s[8:11], s17 offen lds
  v_mfma_f32_16x16x32_bf16 v[32:35], a[96:99], a[32:35], v[32:35]
  ds_read_b64_tr_b16 a[94:95], v229 offset:53856
  v_mfma_f32_16x16x32_bf16 v[88:91], a[96:99], a[36:39], v[88:91]
  v_mfma_f32_16x16x32_bf16 v[144:147], a[96:99], a[40:43], v[144:147]
  buffer_load_dwordx4 v226, s[8:11], s17 offen offset:1024 lds
  v_mfma_f32_16x16x32_bf16 v[200:203], a[96:99], a[44:47], v[200:203]
  ds_read_b64_tr_b16 a[96:97], v229 offset:43136
  s_waitcnt lgkmcnt(10)
  v_mfma_f32_16x16x32_bf16 v[36:39], a[100:103], a[32:35], v[36:39]
  ds_read_b64_tr_b16 a[98:99], v229 offset:46720
  v_mfma_f32_16x16x32_bf16 v[92:95], a[100:103], a[36:39], v[92:95]
  buffer_load_dwordx4 v227, s[8:11], s17 offen offset:2048 lds
  v_mfma_f32_16x16x32_bf16 v[148:151], a[100:103], a[40:43], v[148:151]
  v_mfma_f32_16x16x32_bf16 v[204:207], a[100:103], a[44:47], v[204:207]
  ds_read_b64_tr_b16 a[100:101], v229 offset:43168
  v_mfma_f32_16x16x32_bf16 v[40:43], a[104:107], a[32:35], v[40:43]
  ds_read_b64_tr_b16 a[102:103], v229 offset:46752
  buffer_load_dwordx4 v228, s[8:11], s17 offen offset:3072 lds
  s_add_u32 s17, s17, 458752
  v_mfma_f32_16x16x32_bf16 v[96:99], a[104:107], a[36:39], v[96:99]
  v_mfma_f32_16x16x32_bf16 v[152:155], a[104:107], a[40:43], v[152:155]
  v_mfma_f32_16x16x32_bf16 v[208:211], a[104:107], a[44:47], v[208:211]
  ds_read_b64_tr_b16 a[104:105], v229 offset:43200
  buffer_load_dword v251, v255, s[8:11], s96 offen
  s_add_u32 s96, s96, 458752
  v_mfma_f32_16x16x32_bf16 v[44:47], a[108:111], a[32:35], v[44:47]
  ds_read_b64_tr_b16 a[106:107], v229 offset:46784
  v_mfma_f32_16x16x32_bf16 v[100:103], a[108:111], a[36:39], v[100:103]
  v_mfma_f32_16x16x32_bf16 v[156:159], a[108:111], a[40:43], v[156:159]
  v_mfma_f32_16x16x32_bf16 v[212:215], a[108:111], a[44:47], v[212:215]
  ds_read_b64_tr_b16 a[108:109], v229 offset:50304
  v_mfma_f32_16x16x32_bf16 v[48:51], a[112:115], a[32:35], v[48:51]
  ds_read_b64_tr_b16 a[110:111], v229 offset:53888
  v_mfma_f32_16x16x32_bf16 v[104:107], a[112:115], a[36:39], v[104:107]
  v_mfma_f32_16x16x32_bf16 v[160:163], a[112:115], a[40:43], v[160:163]
  v_mfma_f32_16x16x32_bf16 v[216:219], a[112:115], a[44:47], v[216:219]
  ds_read_b64_tr_b16 a[112:113], v229 offset:50336
  v_mfma_f32_16x16x32_bf16 v[52:55], a[116:119], a[32:35], v[52:55]
  ds_read_b64_tr_b16 a[114:115], v229 offset:53920
  v_mfma_f32_16x16x32_bf16 v[108:111], a[116:119], a[36:39], v[108:111]
  v_mfma_f32_16x16x32_bf16 v[164:167], a[116:119], a[40:43], v[164:167]
  v_mfma_f32_16x16x32_bf16 v[220:223], a[116:119], a[44:47], v[220:223]
  ds_read_b64_tr_b16 a[116:117], v229 offset:50368
  ds_read_b64_tr_b16 a[118:119], v229 offset:53952
  s_waitcnt vmcnt(16) lgkmcnt(10)
  s_barrier
  v_mfma_f32_16x16x32_bf16 v[0:3], a[64:67], a[48:51], v[0:3]
  v_mfma_f32_16x16x32_bf16 v[56:59], a[64:67], a[52:55], v[56:59]
  v_mfma_f32_16x16x32_bf16 v[112:115], a[64:67], a[56:59], v[112:115]
  v_mfma_f32_16x16x32_bf16 v[168:171], a[64:67], a[60:63], v[168:171]
  v_mfma_f32_16x16x32_bf16 v[4:7], a[68:71], a[48:51], v[4:7]
  v_mfma_f32_16x16x32_bf16 v[60:63], a[68:71], a[52:55], v[60:63]
  v_mfma_f32_16x16x32_bf16 v[116:119], a[68:71], a[56:59], v[116:119]
  v_mfma_f32_16x16x32_bf16 v[172:175], a[68:71], a[60:63], v[172:175]
  v_mfma_f32_16x16x32_bf16 v[28:31], a[72:75], a[48:51], v[28:31]
  v_mfma_f32_16x16x32_bf16 v[84:87], a[72:75], a[52:55], v[84:87]
  v_mfma_f32_16x16x32_bf16 v[140:143], a[72:75], a[56:59], v[140:143]
  v_mfma_f32_16x16x32_bf16 v[196:199], a[72:75], a[60:63], v[196:199]
  v_mfma_f32_16x16x32_bf16 v[32:35], a[76:79], a[48:51], v[32:35]
  v_mfma_f32_16x16x32_bf16 v[88:91], a[76:79], a[52:55], v[88:91]
  v_mfma_f32_16x16x32_bf16 v[144:147], a[76:79], a[56:59], v[144:147]
  v_mfma_f32_16x16x32_bf16 v[200:203], a[76:79], a[60:63], v[200:203]
  v_mfma_f32_16x16x32_bf16 v[8:11], a[80:83], a[48:51], v[8:11]
  v_mfma_f32_16x16x32_bf16 v[64:67], a[80:83], a[52:55], v[64:67]
  v_mfma_f32_16x16x32_bf16 v[120:123], a[80:83], a[56:59], v[120:123]
  v_mfma_f32_16x16x32_bf16 v[176:179], a[80:83], a[60:63], v[176:179]
  v_mfma_f32_16x16x32_bf16 v[12:15], a[84:87], a[48:51], v[12:15]
  v_mfma_f32_16x16x32_bf16 v[68:71], a[84:87], a[52:55], v[68:71]
  v_mfma_f32_16x16x32_bf16 v[124:127], a[84:87], a[56:59], v[124:127]
  v_mfma_f32_16x16x32_bf16 v[180:183], a[84:87], a[60:63], v[180:183]
  v_mfma_f32_16x16x32_bf16 v[36:39], a[88:91], a[48:51], v[36:39]
  v_mfma_f32_16x16x32_bf16 v[92:95], a[88:91], a[52:55], v[92:95]
  v_mfma_f32_16x16x32_bf16 v[148:151], a[88:91], a[56:59], v[148:151]
  v_mfma_f32_16x16x32_bf16 v[204:207], a[88:91], a[60:63], v[204:207]
  v_mfma_f32_16x16x32_bf16 v[40:43], a[92:95], a[48:51], v[40:43]
  v_mfma_f32_16x16x32_bf16 v[96:99], a[92:95], a[52:55], v[96:99]
  v_mfma_f32_16x16x32_bf16 v[152:155], a[92:95], a[56:59], v[152:155]
  v_mfma_f32_16x16x32_bf16 v[208:211], a[92:95], a[60:63], v[208:211]
  v_mfma_f32_16x16x32_bf16 v[16:19], a[96:99], a[48:51], v[16:19]
  v_mfma_f32_16x16x32_bf16 v[72:75], a[96:99], a[52:55], v[72:75]
  v_mfma_f32_16x16x32_bf16 v[128:131], a[96:99], a[56:59], v[128:131]
  v_mfma_f32_16x16x32_bf16 v[184:187], a[96:99], a[60:63], v[184:187]
  s_waitcnt lgkmcnt(8)
  v_mfma_f32_16x16x32_bf16 v[20:23], a[100:103], a[48:51], v[20:23]
  v_mfma_f32_16x16x32_bf16 v[76:79], a[100:103], a[52:55], v[76:79]
  v_mfma_f32_16x16x32_bf16 v[132:135], a[100:103], a[56:59], v[132:135]
  v_mfma_f32_16x16x32_bf16 v[188:191], a[100:103], a[60:63], v[188:191]
  s_waitcnt lgkmcnt(6)
  v_mfma_f32_16x16x32_bf16 v[24:27], a[104:107], a[48:51], v[24:27]
  v_mfma_f32_16x16x32_bf16 v[80:83], a[104:107], a[52:55], v[80:83]
  v_mfma_f32_16x16x32_bf16 v[136:139], a[104:107], a[56:59], v[136:139]
  v_mfma_f32_16x16x32_bf16 v[192:195], a[104:107], a[60:63], v[192:195]
  s_waitcnt lgkmcnt(4)
  v_mfma_f32_16x16x32_bf16 v[44:47], a[108:111], a[48:51], v[44:47]
  v_mfma_f32_16x16x32_bf16 v[100:103], a[108:111], a[52:55], v[100:103]
  v_mfma_f32_16x16x32_bf16 v[156:159], a[108:111], a[56:59], v[156:159]
  v_mfma_f32_16x16x32_bf16 v[212:215], a[108:111], a[60:63], v[212:215]
  s_waitcnt lgkmcnt(2)
  v_mfma_f32_16x16x32_bf16 v[48:51], a[112:115], a[48:51], v[48:51]
  v_mfma_f32_16x16x32_bf16 v[104:107], a[112:115], a[52:55], v[104:107]
  v_mfma_f32_16x16x32_bf16 v[160:163], a[112:115], a[56:59], v[160:163]
  v_mfma_f32_16x16x32_bf16 v[216:219], a[112:115], a[60:63], v[216:219]
  s_waitcnt lgkmcnt(0)
  v_mfma_f32_16x16x32_bf16 v[52:55], a[116:119], a[48:51], v[52:55]
  v_mfma_f32_16x16x32_bf16 v[108:111], a[116:119], a[52:55], v[108:111]
  v_mfma_f32_16x16x32_bf16 v[164:167], a[116:119], a[56:59], v[164:167]
  v_mfma_f32_16x16x32_bf16 v[220:223], a[116:119], a[60:63], v[220:223]
  s_nop 7
  s_nop 1
L_k56_seam:
  v_mul_f32 v232, s42, v0
  v_mul_f32 v233, s42, v1
  v_mul_f32 v234, s42, v2
  v_mul_f32 v235, s42, v3
  v_exp_f32 v232, v232
  v_exp_f32 v233, v233
  v_exp_f32 v234, v234
  v_exp_f32 v235, v235
  v_add_f32 v232, 1.0, v232
  v_add_f32 v233, 1.0, v233
  v_add_f32 v234, 1.0, v234
  v_add_f32 v235, 1.0, v235
  v_rcp_f32 v232, v232
  v_rcp_f32 v233, v233
  v_rcp_f32 v234, v234
  v_rcp_f32 v235, v235
  v_mul_f32 v232, v232, v28
  v_mul_f32 v233, v233, v29
  v_mul_f32 v234, v234, v30
  v_mul_f32 v235, v235, v31
  v_cvt_pk_bf16_f32 v0, v232, v233
  v_cvt_pk_bf16_f32 v1, v234, v235
  v_mul_f32 v236, s42, v4
  v_mul_f32 v237, s42, v5
  v_mul_f32 v238, s42, v6
  v_mul_f32 v239, s42, v7
  v_exp_f32 v236, v236
  v_exp_f32 v237, v237
  v_exp_f32 v238, v238
  v_exp_f32 v239, v239
  v_add_f32 v236, 1.0, v236
  v_add_f32 v237, 1.0, v237
  v_add_f32 v238, 1.0, v238
  v_add_f32 v239, 1.0, v239
  v_rcp_f32 v236, v236
  v_rcp_f32 v237, v237
  v_rcp_f32 v238, v238
  v_rcp_f32 v239, v239
  v_mul_f32 v236, v236, v32
  v_mul_f32 v237, v237, v33
  v_mul_f32 v238, v238, v34
  v_mul_f32 v239, v239, v35
  v_cvt_pk_bf16_f32 v2, v236, v237
  v_cvt_pk_bf16_f32 v3, v238, v239
  buffer_store_dwordx4 v[0:3], v224, s[12:15], s98 offen offset:0 sc1
  v_mul_f32 v232, s42, v56
  v_mul_f32 v233, s42, v57
  v_mul_f32 v234, s42, v58
  v_mul_f32 v235, s42, v59
  v_exp_f32 v232, v232
  v_exp_f32 v233, v233
  v_exp_f32 v234, v234
  v_exp_f32 v235, v235
  v_add_f32 v232, 1.0, v232
  v_add_f32 v233, 1.0, v233
  v_add_f32 v234, 1.0, v234
  v_add_f32 v235, 1.0, v235
  v_rcp_f32 v232, v232
  v_rcp_f32 v233, v233
  v_rcp_f32 v234, v234
  v_rcp_f32 v235, v235
  v_mul_f32 v232, v232, v84
  v_mul_f32 v233, v233, v85
  v_mul_f32 v234, v234, v86
  v_mul_f32 v235, v235, v87
  v_cvt_pk_bf16_f32 v56, v232, v233
  v_cvt_pk_bf16_f32 v57, v234, v235
  v_mul_f32 v236, s42, v60
  v_mul_f32 v237, s42, v61
  v_mul_f32 v238, s42, v62
  v_mul_f32 v239, s42, v63
  v_exp_f32 v236, v236
  v_exp_f32 v237, v237
  v_exp_f32 v238, v238
  v_exp_f32 v239, v239
  v_add_f32 v236, 1.0, v236
  v_add_f32 v237, 1.0, v237
  v_add_f32 v238, 1.0, v238
  v_add_f32 v239, 1.0, v239
  v_rcp_f32 v236, v236
  v_rcp_f32 v237, v237
  v_rcp_f32 v238, v238
  v_rcp_f32 v239, v239
  v_mul_f32 v236, v236, v88
  v_mul_f32 v237, v237, v89
  v_mul_f32 v238, v238, v90
  v_mul_f32 v239, v239, v91
  v_cvt_pk_bf16_f32 v58, v236, v237
  v_cvt_pk_bf16_f32 v59, v238, v239
  buffer_store_dwordx4 v[56:59], v224, s[12:15], s98 offen offset:1024 sc1
  v_mul_f32 v232, s42, v112
  v_mul_f32 v233, s42, v113
  v_mul_f32 v234, s42, v114
  v_mul_f32 v235, s42, v115
  v_exp_f32 v232, v232
  v_exp_f32 v233, v233
  v_exp_f32 v234, v234
  v_exp_f32 v235, v235
  v_add_f32 v232, 1.0, v232
  v_add_f32 v233, 1.0, v233
  v_add_f32 v234, 1.0, v234
  v_add_f32 v235, 1.0, v235
  v_rcp_f32 v232, v232
  v_rcp_f32 v233, v233
  v_rcp_f32 v234, v234
  v_rcp_f32 v235, v235
  v_mul_f32 v232, v232, v140
  v_mul_f32 v233, v233, v141
  v_mul_f32 v234, v234, v142
  v_mul_f32 v235, v235, v143
  v_cvt_pk_bf16_f32 v112, v232, v233
  v_cvt_pk_bf16_f32 v113, v234, v235
  v_mul_f32 v236, s42, v116
  v_mul_f32 v237, s42, v117
  v_mul_f32 v238, s42, v118
  v_mul_f32 v239, s42, v119
  v_exp_f32 v236, v236
  v_exp_f32 v237, v237
  v_exp_f32 v238, v238
  v_exp_f32 v239, v239
  v_add_f32 v236, 1.0, v236
  v_add_f32 v237, 1.0, v237
  v_add_f32 v238, 1.0, v238
  v_add_f32 v239, 1.0, v239
  v_rcp_f32 v236, v236
  v_rcp_f32 v237, v237
  v_rcp_f32 v238, v238
  v_rcp_f32 v239, v239
  v_mul_f32 v236, v236, v144
  v_mul_f32 v237, v237, v145
  v_mul_f32 v238, v238, v146
  v_mul_f32 v239, v239, v147
  v_cvt_pk_bf16_f32 v114, v236, v237
  v_cvt_pk_bf16_f32 v115, v238, v239
  buffer_store_dwordx4 v[112:115], v224, s[12:15], s98 offen offset:2048 sc1
  v_mul_f32 v232, s42, v168
  v_mul_f32 v233, s42, v169
  v_mul_f32 v234, s42, v170
  v_mul_f32 v235, s42, v171
  v_exp_f32 v232, v232
  v_exp_f32 v233, v233
  v_exp_f32 v234, v234
  v_exp_f32 v235, v235
  v_add_f32 v232, 1.0, v232
  v_add_f32 v233, 1.0, v233
  v_add_f32 v234, 1.0, v234
  v_add_f32 v235, 1.0, v235
  v_rcp_f32 v232, v232
  v_rcp_f32 v233, v233
  v_rcp_f32 v234, v234
  v_rcp_f32 v235, v235
  v_mul_f32 v232, v232, v196
  v_mul_f32 v233, v233, v197
  v_mul_f32 v234, v234, v198
  v_mul_f32 v235, v235, v199
  v_cvt_pk_bf16_f32 v168, v232, v233
  v_cvt_pk_bf16_f32 v169, v234, v235
  v_mul_f32 v236, s42, v172
  v_mul_f32 v237, s42, v173
  v_mul_f32 v238, s42, v174
  v_mul_f32 v239, s42, v175
  v_exp_f32 v236, v236
  v_exp_f32 v237, v237
  v_exp_f32 v238, v238
  v_exp_f32 v239, v239
  v_add_f32 v236, 1.0, v236
  v_add_f32 v237, 1.0, v237
  v_add_f32 v238, 1.0, v238
  v_add_f32 v239, 1.0, v239
  v_rcp_f32 v236, v236
  v_rcp_f32 v237, v237
  v_rcp_f32 v238, v238
  v_rcp_f32 v239, v239
  v_mul_f32 v236, v236, v200
  v_mul_f32 v237, v237, v201
  v_mul_f32 v238, v238, v202
  v_mul_f32 v239, v239, v203
  v_cvt_pk_bf16_f32 v170, v236, v237
  v_cvt_pk_bf16_f32 v171, v238, v239
  buffer_store_dwordx4 v[168:171], v224, s[12:15], s98 offen offset:3072 sc1
  v_mul_f32 v232, s42, v8
  v_mul_f32 v233, s42, v9
  v_mul_f32 v234, s42, v10
  v_mul_f32 v235, s42, v11
  v_exp_f32 v232, v232
  v_exp_f32 v233, v233
  v_exp_f32 v234, v234
  v_exp_f32 v235, v235
  v_add_f32 v232, 1.0, v232
  v_add_f32 v233, 1.0, v233
  v_add_f32 v234, 1.0, v234
  v_add_f32 v235, 1.0, v235
  v_rcp_f32 v232, v232
  v_rcp_f32 v233, v233
  v_rcp_f32 v234, v234
  v_rcp_f32 v235, v235
  v_mul_f32 v232, v232, v36
  v_mul_f32 v233, v233, v37
  v_mul_f32 v234, v234, v38
  v_mul_f32 v235, v235, v39
  v_cvt_pk_bf16_f32 v4, v232, v233
  v_cvt_pk_bf16_f32 v5, v234, v235
  v_mul_f32 v236, s42, v12
  v_mul_f32 v237, s42, v13
  v_mul_f32 v238, s42, v14
  v_mul_f32 v239, s42, v15
  v_exp_f32 v236, v236
  v_exp_f32 v237, v237
  v_exp_f32 v238, v238
  v_exp_f32 v239, v239
  v_add_f32 v236, 1.0, v236
  v_add_f32 v237, 1.0, v237
  v_add_f32 v238, 1.0, v238
  v_add_f32 v239, 1.0, v239
  v_rcp_f32 v236, v236
  v_rcp_f32 v237, v237
  v_rcp_f32 v238, v238
  v_rcp_f32 v239, v239
  v_mul_f32 v236, v236, v40
  v_mul_f32 v237, v237, v41
  v_mul_f32 v238, v238, v42
  v_mul_f32 v239, v239, v43
  v_cvt_pk_bf16_f32 v6, v236, v237
  v_cvt_pk_bf16_f32 v7, v238, v239
  v_mul_f32 v232, s42, v64
  v_mul_f32 v233, s42, v65
  v_mul_f32 v234, s42, v66
  v_mul_f32 v235, s42, v67
  v_exp_f32 v232, v232
  v_exp_f32 v233, v233
  v_exp_f32 v234, v234
  v_exp_f32 v235, v235
  v_add_f32 v232, 1.0, v232
  v_add_f32 v233, 1.0, v233
  v_add_f32 v234, 1.0, v234
  v_add_f32 v235, 1.0, v235
  v_rcp_f32 v232, v232
  v_rcp_f32 v233, v233
  v_rcp_f32 v234, v234
  v_rcp_f32 v235, v235
  v_mul_f32 v232, v232, v92
  v_mul_f32 v233, v233, v93
  v_mul_f32 v234, v234, v94
  v_mul_f32 v235, v235, v95
  v_cvt_pk_bf16_f32 v60, v232, v233
  v_cvt_pk_bf16_f32 v61, v234, v235
  v_mul_f32 v236, s42, v68
  v_mul_f32 v237, s42, v69
  v_mul_f32 v238, s42, v70
  v_mul_f32 v239, s42, v71
  v_exp_f32 v236, v236
  v_exp_f32 v237, v237
  v_exp_f32 v238, v238
  v_exp_f32 v239, v239
  v_add_f32 v236, 1.0, v236
  v_add_f32 v237, 1.0, v237
  v_add_f32 v238, 1.0, v238
  v_add_f32 v239, 1.0, v239
  v_rcp_f32 v236, v236
  v_rcp_f32 v237, v237
  v_rcp_f32 v238, v238
  v_rcp_f32 v239, v239
  v_mul_f32 v236, v236, v96
  v_mul_f32 v237, v237, v97
  v_mul_f32 v238, v238, v98
  v_mul_f32 v239, v239, v99
  v_cvt_pk_bf16_f32 v62, v236, v237
  v_cvt_pk_bf16_f32 v63, v238, v239
  v_mul_f32 v232, s42, v120
  v_mul_f32 v233, s42, v121
  v_mul_f32 v234, s42, v122
  v_mul_f32 v235, s42, v123
  v_exp_f32 v232, v232
  v_exp_f32 v233, v233
  v_exp_f32 v234, v234
  v_exp_f32 v235, v235
  v_add_f32 v232, 1.0, v232
  v_add_f32 v233, 1.0, v233
  v_add_f32 v234, 1.0, v234
  v_add_f32 v235, 1.0, v235
  v_rcp_f32 v232, v232
  v_rcp_f32 v233, v233
  v_rcp_f32 v234, v234
  v_rcp_f32 v235, v235
  v_mul_f32 v232, v232, v148
  v_mul_f32 v233, v233, v149
  v_mul_f32 v234, v234, v150
  v_mul_f32 v235, v235, v151
  v_cvt_pk_bf16_f32 v116, v232, v233
  v_cvt_pk_bf16_f32 v117, v234, v235
  v_mul_f32 v236, s42, v124
  v_mul_f32 v237, s42, v125
  v_mul_f32 v238, s42, v126
  v_mul_f32 v239, s42, v127
  v_exp_f32 v236, v236
  v_exp_f32 v237, v237
  v_exp_f32 v238, v238
  v_exp_f32 v239, v239
  v_add_f32 v236, 1.0, v236
  v_add_f32 v237, 1.0, v237
  v_add_f32 v238, 1.0, v238
  v_add_f32 v239, 1.0, v239
  v_rcp_f32 v236, v236
  v_rcp_f32 v237, v237
  v_rcp_f32 v238, v238
  v_rcp_f32 v239, v239
  v_mul_f32 v236, v236, v152
  v_mul_f32 v237, v237, v153
  v_mul_f32 v238, v238, v154
  v_mul_f32 v239, v239, v155
  v_cvt_pk_bf16_f32 v118, v236, v237
  v_cvt_pk_bf16_f32 v119, v238, v239
  s_waitcnt vmcnt(0)
  s_mov_b64 exec, 1
  buffer_store_dword v248, v250, s[56:59], s92 offen sc1
  s_mov_b64 exec, -1
  s_add_u32 s92, s92, 65536
  v_mul_f32 v232, s42, v176
  v_mul_f32 v233, s42, v177
  v_mul_f32 v234, s42, v178
  v_mul_f32 v235, s42, v179
  v_exp_f32 v232, v232
  v_exp_f32 v233, v233
  v_exp_f32 v234, v234
  v_exp_f32 v235, v235
  v_add_f32 v232, 1.0, v232
  v_add_f32 v233, 1.0, v233
  v_add_f32 v234, 1.0, v234
  v_add_f32 v235, 1.0, v235
  v_rcp_f32 v232, v232
  v_rcp_f32 v233, v233
  v_rcp_f32 v234, v234
  v_rcp_f32 v235, v235
  v_mul_f32 v232, v232, v204
  v_mul_f32 v233, v233, v205
  v_mul_f32 v234, v234, v206
  v_mul_f32 v235, v235, v207
  v_cvt_pk_bf16_f32 v172, v232, v233
  v_cvt_pk_bf16_f32 v173, v234, v235
  v_mul_f32 v236, s42, v180
  v_mul_f32 v237, s42, v181
  v_mul_f32 v238, s42, v182
  v_mul_f32 v239, s42, v183
  v_exp_f32 v236, v236
  v_exp_f32 v237, v237
  v_exp_f32 v238, v238
  v_exp_f32 v239, v239
  v_add_f32 v236, 1.0, v236
  v_add_f32 v237, 1.0, v237
  v_add_f32 v238, 1.0, v238
  v_add_f32 v239, 1.0, v239
  v_rcp_f32 v236, v236
  v_rcp_f32 v237, v237
  v_rcp_f32 v238, v238
  v_rcp_f32 v239, v239
  v_mul_f32 v236, v236, v208
  v_mul_f32 v237, v237, v209
  v_mul_f32 v238, v238, v210
  v_mul_f32 v239, v239, v211
  v_cvt_pk_bf16_f32 v174, v236, v237
  v_cvt_pk_bf16_f32 v175, v238, v239
  v_mul_f32 v232, s42, v16
  v_mul_f32 v233, s42, v17
  v_mul_f32 v234, s42, v18
  v_mul_f32 v235, s42, v19
  v_exp_f32 v232, v232
  v_exp_f32 v233, v233
  v_exp_f32 v234, v234
  v_exp_f32 v235, v235
  v_add_f32 v232, 1.0, v232
  v_add_f32 v233, 1.0, v233
  v_add_f32 v234, 1.0, v234
  v_add_f32 v235, 1.0, v235
  v_rcp_f32 v232, v232
  v_rcp_f32 v233, v233
  v_rcp_f32 v234, v234
  v_rcp_f32 v235, v235
  v_mul_f32 v232, v232, v44
  v_mul_f32 v233, v233, v45
  v_mul_f32 v234, v234, v46
  v_mul_f32 v235, v235, v47
  v_cvt_pk_bf16_f32 v8, v232, v233
  v_cvt_pk_bf16_f32 v9, v234, v235
  v_mul_f32 v236, s42, v20
  v_mul_f32 v237, s42, v21
  v_mul_f32 v238, s42, v22
  v_mul_f32 v239, s42, v23
  v_exp_f32 v236, v236
  v_exp_f32 v237, v237
  v_exp_f32 v238, v238
  v_exp_f32 v239, v239
  v_add_f32 v236, 1.0, v236
  v_add_f32 v237, 1.0, v237
  v_add_f32 v238, 1.0, v238
  v_add_f32 v239, 1.0, v239
  v_rcp_f32 v236, v236
  v_rcp_f32 v237, v237
  v_rcp_f32 v238, v238
  v_rcp_f32 v239, v239
  v_mul_f32 v236, v236, v48
  v_mul_f32 v237, v237, v49
  v_mul_f32 v238, v238, v50
  v_mul_f32 v239, v239, v51
  v_cvt_pk_bf16_f32 v10, v236, v237
  v_cvt_pk_bf16_f32 v11, v238, v239
  v_mul_f32 v232, s42, v72
  v_mul_f32 v233, s42, v73
  v_mul_f32 v234, s42, v74
  v_mul_f32 v235, s42, v75
  v_exp_f32 v232, v232
  v_exp_f32 v233, v233
  v_exp_f32 v234, v234
  v_exp_f32 v235, v235
  v_add_f32 v232, 1.0, v232
  v_add_f32 v233, 1.0, v233
  v_add_f32 v234, 1.0, v234
  v_add_f32 v235, 1.0, v235
  v_rcp_f32 v232, v232
  v_rcp_f32 v233, v233
  v_rcp_f32 v234, v234
  v_rcp_f32 v235, v235
  v_mul_f32 v232, v232, v100
  v_mul_f32 v233, v233, v101
  v_mul_f32 v234, v234, v102
  v_mul_f32 v235, v235, v103
  v_cvt_pk_bf16_f32 v64, v232, v233
  v_cvt_pk_bf16_f32 v65, v234, v235
  v_mul_f32 v236, s42, v76
  v_mul_f32 v237, s42, v77
  v_mul_f32 v238, s42, v78
  v_mul_f32 v239, s42, v79
  v_exp_f32 v236, v236
  v_exp_f32 v237, v237
  v_exp_f32 v238, v238
  v_exp_f32 v239, v239
  v_add_f32 v236, 1.0, v236
  v_add_f32 v237, 1.0, v237
  v_add_f32 v238, 1.0, v238
  v_add_f32 v239, 1.0, v239
  v_rcp_f32 v236, v236
  v_rcp_f32 v237, v237
  v_rcp_f32 v238, v238
  v_rcp_f32 v239, v239
  v_mul_f32 v236, v236, v104
  v_mul_f32 v237, v237, v105
  v_mul_f32 v238, v238, v106
  v_mul_f32 v239, v239, v107
  v_cvt_pk_bf16_f32 v66, v236, v237
  v_cvt_pk_bf16_f32 v67, v238, v239
  v_mul_f32 v232, s42, v128
  v_mul_f32 v233, s42, v129
  v_mul_f32 v234, s42, v130
  v_mul_f32 v235, s42, v131
  v_exp_f32 v232, v232
  v_exp_f32 v233, v233
  v_exp_f32 v234, v234
  v_exp_f32 v235, v235
  v_add_f32 v232, 1.0, v232
  v_add_f32 v233, 1.0, v233
  v_add_f32 v234, 1.0, v234
  v_add_f32 v235, 1.0, v235
  v_rcp_f32 v232, v232
  v_rcp_f32 v233, v233
  v_rcp_f32 v234, v234
  v_rcp_f32 v235, v235
  v_mul_f32 v232, v232, v156
  v_mul_f32 v233, v233, v157
  v_mul_f32 v234, v234, v158
  v_mul_f32 v235, v235, v159
  v_cvt_pk_bf16_f32 v120, v232, v233
  v_cvt_pk_bf16_f32 v121, v234, v235
  v_mul_f32 v236, s42, v132
  v_mul_f32 v237, s42, v133
  v_mul_f32 v238, s42, v134
  v_mul_f32 v239, s42, v135
  v_exp_f32 v236, v236
  v_exp_f32 v237, v237
  v_exp_f32 v238, v238
  v_exp_f32 v239, v239
  v_add_f32 v236, 1.0, v236
  v_add_f32 v237, 1.0, v237
  v_add_f32 v238, 1.0, v238
  v_add_f32 v239, 1.0, v239
  v_rcp_f32 v236, v236
  v_rcp_f32 v237, v237
  v_rcp_f32 v238, v238
  v_rcp_f32 v239, v239
  v_mul_f32 v236, v236, v160
  v_mul_f32 v237, v237, v161
  v_mul_f32 v238, v238, v162
  v_mul_f32 v239, v239, v163
  v_cvt_pk_bf16_f32 v122, v236, v237
  v_cvt_pk_bf16_f32 v123, v238, v239
  v_mul_f32 v232, s42, v184
  v_mul_f32 v233, s42, v185
  v_mul_f32 v234, s42, v186
  v_mul_f32 v235, s42, v187
  v_exp_f32 v232, v232
  v_exp_f32 v233, v233
  v_exp_f32 v234, v234
  v_exp_f32 v235, v235
  v_add_f32 v232, 1.0, v232
  v_add_f32 v233, 1.0, v233
  v_add_f32 v234, 1.0, v234
  v_add_f32 v235, 1.0, v235
  v_rcp_f32 v232, v232
  v_rcp_f32 v233, v233
  v_rcp_f32 v234, v234
  v_rcp_f32 v235, v235
  v_mul_f32 v232, v232, v212
  v_mul_f32 v233, v233, v213
  v_mul_f32 v234, v234, v214
  v_mul_f32 v235, v235, v215
  v_cvt_pk_bf16_f32 v176, v232, v233
  v_cvt_pk_bf16_f32 v177, v234, v235
  v_mul_f32 v236, s42, v188
  v_mul_f32 v237, s42, v189
  v_mul_f32 v238, s42, v190
  v_mul_f32 v239, s42, v191
  v_exp_f32 v236, v236
  v_exp_f32 v237, v237
  v_exp_f32 v238, v238
  v_exp_f32 v239, v239
  v_add_f32 v236, 1.0, v236
  v_add_f32 v237, 1.0, v237
  v_add_f32 v238, 1.0, v238
  v_add_f32 v239, 1.0, v239
  v_rcp_f32 v236, v236
  v_rcp_f32 v237, v237
  v_rcp_f32 v238, v238
  v_rcp_f32 v239, v239
  v_mul_f32 v236, v236, v216
  v_mul_f32 v237, v237, v217
  v_mul_f32 v238, v238, v218
  v_mul_f32 v239, v239, v219
  v_cvt_pk_bf16_f32 v178, v236, v237
  v_cvt_pk_bf16_f32 v179, v238, v239
  buffer_load_dword v247, v246, s[56:59], s94 offen sc1
  buffer_store_dwordx4 v[4:7], v224, s[12:15], s99 offen offset:0 sc1
  buffer_store_dwordx4 v[60:63], v224, s[12:15], s99 offen offset:1024 sc1
  buffer_store_dwordx4 v[116:119], v224, s[12:15], s99 offen offset:2048 sc1
  buffer_store_dwordx4 v[172:175], v224, s[12:15], s99 offen offset:3072 sc1
  v_mul_f32 v232, s42, v24
  v_mul_f32 v233, s42, v25
  v_mul_f32 v234, s42, v26
  v_mul_f32 v235, s42, v27
  v_exp_f32 v232, v232
  v_exp_f32 v233, v233
  v_exp_f32 v234, v234
  v_exp_f32 v235, v235
  v_add_f32 v232, 1.0, v232
  v_add_f32 v233, 1.0, v233
  v_add_f32 v234, 1.0, v234
  v_add_f32 v235, 1.0, v235
  v_rcp_f32 v232, v232
  v_rcp_f32 v233, v233
  v_rcp_f32 v234, v234
  v_rcp_f32 v235, v235
  v_mul_f32 v232, v232, v52
  v_mul_f32 v233, v233, v53
  v_mul_f32 v234, v234, v54
  v_mul_f32 v235, v235, v55
  v_cvt_pk_bf16_f32 v12, v232, v233
  v_cvt_pk_bf16_f32 v13, v234, v235
  v_mul_f32 v236, s42, v80
  v_mul_f32 v237, s42, v81
  v_mul_f32 v238, s42, v82
  v_mul_f32 v239, s42, v83
  v_exp_f32 v236, v236
  v_exp_f32 v237, v237
  v_exp_f32 v238, v238
  v_exp_f32 v239, v239
  v_add_f32 v236, 1.0, v236
  v_add_f32 v237, 1.0, v237
  v_add_f32 v238, 1.0, v238
  v_add_f32 v239, 1.0, v239
  v_rcp_f32 v236, v236
  v_rcp_f32 v237, v237
  v_rcp_f32 v238, v238
  v_rcp_f32 v239, v239
  v_mul_f32 v236, v236, v108
  v_mul_f32 v237, v237, v109
  v_mul_f32 v238, v238, v110
  v_mul_f32 v239, v239, v111
  v_cvt_pk_bf16_f32 v14, v236, v237
  v_cvt_pk_bf16_f32 v15, v238, v239
  v_mul_f32 v232, s42, v136
  v_mul_f32 v233, s42, v137
  v_mul_f32 v234, s42, v138
  v_mul_f32 v235, s42, v139
  v_exp_f32 v232, v232
  v_exp_f32 v233, v233
  v_exp_f32 v234, v234
  v_exp_f32 v235, v235
  v_add_f32 v232, 1.0, v232
  v_add_f32 v233, 1.0, v233
  v_add_f32 v234, 1.0, v234
  v_add_f32 v235, 1.0, v235
  v_rcp_f32 v232, v232
  v_rcp_f32 v233, v233
  v_rcp_f32 v234, v234
  v_rcp_f32 v235, v235
  v_mul_f32 v232, v232, v164
  v_mul_f32 v233, v233, v165
  v_mul_f32 v234, v234, v166
  v_mul_f32 v235, v235, v167
  v_cvt_pk_bf16_f32 v124, v232, v233
  v_cvt_pk_bf16_f32 v125, v234, v235
  v_mul_f32 v236, s42, v192
  v_mul_f32 v237, s42, v193
  v_mul_f32 v238, s42, v194
  v_mul_f32 v239, s42, v195
  v_exp_f32 v236, v236
  v_exp_f32 v237, v237
  v_exp_f32 v238, v238
  v_exp_f32 v239, v239
  v_add_f32 v236, 1.0, v236
  v_add_f32 v237, 1.0, v237
  v_add_f32 v238, 1.0, v238
  v_add_f32 v239, 1.0, v239
  v_rcp_f32 v236, v236
  v_rcp_f32 v237, v237
  v_rcp_f32 v238, v238
  v_rcp_f32 v239, v239
  v_mul_f32 v236, v236, v220
  v_mul_f32 v237, v237, v221
  v_mul_f32 v238, v238, v222
  v_mul_f32 v239, v239, v223
  v_cvt_pk_bf16_f32 v126, v236, v237
  v_cvt_pk_bf16_f32 v127, v238, v239
  s_waitcnt vmcnt(4)
  v_cmp_ne_u32 vcc, 1, v247
  s_nop 1
  s_cmp_lg_u64 vcc, 0
  s_cbranch_scc1 L_slow_33
  L_back_34:
  s_add_u32 s94, s94, 65536
  buffer_load_dwordx4 a[0:3], v240, s[4:7], s16 offen offset:0 sc1
  buffer_load_dwordx4 a[4:7], v240, s[4:7], s16 offen offset:1024 sc1
  buffer_load_dwordx4 a[8:11], v241, s[4:7], s16 offen offset:0 sc1
  buffer_load_dwordx4 a[12:15], v241, s[4:7], s16 offen offset:1024 sc1
  s_add_u32 s16, s16, 262144
  buffer_load_dwordx4 a[16:19], v240, s[4:7], s16 offen offset:0 sc1
  buffer_load_dwordx4 a[20:23], v240, s[4:7], s16 offen offset:1024 sc1
  buffer_load_dwordx4 a[24:27], v241, s[4:7], s16 offen offset:0 sc1
  buffer_load_dwordx4 a[28:31], v241, s[4:7], s16 offen offset:1024 sc1
  s_add_u32 s16, s16, 262144
  buffer_load_dwordx4 a[32:35], v240, s[4:7], s16 offen offset:0 sc1
  buffer_load_dwordx4 a[36:39], v240, s[4:7], s16 offen offset:1024 sc1
  buffer_load_dwordx4 a[40:43], v241, s[4:7], s16 offen offset:0 sc1
  buffer_load_dwordx4 a[44:47], v241, s[4:7], s16 offen offset:1024 sc1
  s_add_u32 s16, s16, 262144
  v_add_u32 v104, 65536, v242
  v_add_u32 v105, 65536, v243
  v_add_u32 v106, 65536, v244
  v_add_u32 v107, 65536, v245
  s_waitcnt vmcnt(32)
  s_barrier
  ds_read_b64_tr_b16 a[80:81], v242 offset:2048
  ds_read_b64_tr_b16 a[82:83], v242 offset:6144
  ds_read_b64_tr_b16 a[84:85], v243 offset:2048
  ds_read_b64_tr_b16 a[86:87], v243 offset:6144
  ds_read_b64_tr_b16 a[88:89], v244 offset:2048
  ds_read_b64_tr_b16 a[90:91], v244 offset:6144
  ds_read_b64_tr_b16 a[92:93], v245 offset:2048
  ds_read_b64_tr_b16 a[94:95], v245 offset:6144
  ds_read_b64_tr_b16 a[112:113], v242 offset:10240
  ds_read_b64_tr_b16 a[114:115], v242 offset:14336
  ds_read_b64_tr_b16 a[116:117], v243 offset:10240
  ds_read_b64_tr_b16 a[118:119], v243 offset:14336
  ds_read_b64_tr_b16 a[120:121], v244 offset:10240
  ds_read_b64_tr_b16 a[122:123], v244 offset:14336
  ds_read_b64_tr_b16 a[124:125], v245 offset:10240
  ds_read_b64_tr_b16 a[126:127], v245 offset:14336
  ds_read_b64_tr_b16 a[64:65], v242 offset:0
  ds_read_b64_tr_b16 a[66:67], v242 offset:4096
  ds_read_b64_tr_b16 a[68:69], v243 offset:0
  ds_read_b64_tr_b16 a[70:71], v243 offset:4096
  ds_read_b64_tr_b16 a[72:73], v244 offset:0
  ds_read_b64_tr_b16 a[74:75], v244 offset:4096
  ds_read_b64_tr_b16 a[76:77], v245 offset:0
  ds_read_b64_tr_b16 a[78:79], v245 offset:4096
  ds_read_b64_tr_b16 a[96:97], v242 offset:8192
  ds_read_b64_tr_b16 a[98:99], v242 offset:12288
  ds_read_b64_tr_b16 a[100:101], v243 offset:8192
  ds_read_b64_tr_b16 a[102:103], v243 offset:12288
  ds_read_b64_tr_b16 a[104:105], v244 offset:8192
  ds_read_b64_tr_b16 a[106:107], v244 offset:12288
  ds_read_b64_tr_b16 a[108:109], v245 offset:8192
  ds_read_b64_tr_b16 a[110:111], v245 offset:12288
  s_waitcnt vmcnt(8) lgkmcnt(10)
  s_barrier
  s_mov_b64 exec, 1
  buffer_store_dword v248, v250, s[56:59], s92 offen sc1
  s_mov_b64 exec, -1
  s_add_u32 s92, s92, 65536
  s_add_u32 m0, s38, 49152
  s_nop 0
  buffer_load_dwordx4 v225, s[8:11], s17 offen lds
  v_mfma_f32_16x16x32_bf16 v[72:75], a[80:83], a[0:3], 0
  v_mfma_f32_16x16x32_bf16 v[88:91], a[80:83], a[4:7], 0
  ds_read_b64_tr_b16 a[80:81], v242 offset:18432
  v_mfma_f32_16x16x32_bf16 v[76:79], a[84:87], a[0:3], 0
  ds_read_b64_tr_b16 a[82:83], v242 offset:22528
  buffer_load_dwordx4 v226, s[8:11], s17 offen offset:1024 lds
  v_mfma_f32_16x16x32_bf16 v[92:95], a[84:87], a[4:7], 0
  ds_read_b64_tr_b16 a[84:85], v243 offset:18432
  v_mfma_f32_16x16x32_bf16 v[80:83], a[88:91], a[0:3], 0
  ds_read_b64_tr_b16 a[86:87], v243 offset:22528
  v_mfma_f32_16x16x32_bf16 v[96:99], a[88:91], a[4:7], 0
  ds_read_b64_tr_b16 a[88:89], v244 offset:18432
  buffer_load_dwordx4 v227, s[8:11], s17 offen offset:2048 lds
  v_mfma_f32_16x16x32_bf16 v[84:87], a[92:95], a[0:3], 0
  ds_read_b64_tr_b16 a[90:91], v244 offset:22528
  v_mfma_f32_16x16x32_bf16 v[100:103], a[92:95], a[4:7], 0
  ds_read_b64_tr_b16 a[92:93], v245 offset:18432
  buffer_load_dwordx4 v228, s[8:11], s17 offen offset:3072 lds
  s_add_u32 s17, s17, 458752
  v_mfma_f32_16x16x32_bf16 v[72:75], a[112:115], a[8:11], v[72:75]
  ds_read_b64_tr_b16 a[94:95], v245 offset:22528
  v_mfma_f32_16x16x32_bf16 v[88:91], a[112:115], a[12:15], v[88:91]
  ds_read_b64_tr_b16 a[112:113], v242 offset:26624
  v_mfma_f32_16x16x32_bf16 v[76:79], a[116:119], a[8:11], v[76:79]
  ds_read_b64_tr_b16 a[114:115], v242 offset:30720
  buffer_load_dword v251, v255, s[8:11], s96 offen
  s_add_u32 s96, s96, 458752
  v_mfma_f32_16x16x32_bf16 v[92:95], a[116:119], a[12:15], v[92:95]
  ds_read_b64_tr_b16 a[116:117], v243 offset:26624
  v_mfma_f32_16x16x32_bf16 v[80:83], a[120:123], a[8:11], v[80:83]
  ds_read_b64_tr_b16 a[118:119], v243 offset:30720
  v_mfma_f32_16x16x32_bf16 v[96:99], a[120:123], a[12:15], v[96:99]
  ds_read_b64_tr_b16 a[120:121], v244 offset:26624
  buffer_load_dwordx4 a[48:51], v240, s[4:7], s16 offen offset:0 sc1
  v_mfma_f32_16x16x32_bf16 v[84:87], a[124:127], a[8:11], v[84:87]
  ds_read_b64_tr_b16 a[122:123], v244 offset:30720
  v_mfma_f32_16x16x32_bf16 v[100:103], a[124:127], a[12:15], v[100:103]
  ds_read_b64_tr_b16 a[124:125], v245 offset:26624
  v_mfma_f32_16x16x32_bf16 v[16:19], a[64:67], a[0:3], 0
  ds_read_b64_tr_b16 a[126:127], v245 offset:30720
  buffer_load_dwordx4 a[52:55], v240, s[4:7], s16 offen offset:1024 sc1
  v_mfma_f32_16x16x32_bf16 v[32:35], a[64:67], a[4:7], 0
  ds_read_b64_tr_b16 a[64:65], v242 offset:16384
  v_mfma_f32_16x16x32_bf16 v[20:23], a[68:71], a[0:3], 0
  ds_read_b64_tr_b16 a[66:67], v242 offset:20480
  v_mfma_f32_16x16x32_bf16 v[36:39], a[68:71], a[4:7], 0
  ds_read_b64_tr_b16 a[68:69], v243 offset:16384
  buffer_load_dwordx4 a[56:59], v241, s[4:7], s16 offen offset:0 sc1
  v_mfma_f32_16x16x32_bf16 v[24:27], a[72:75], a[0:3], 0
  ds_read_b64_tr_b16 a[70:71], v243 offset:20480
  v_mfma_f32_16x16x32_bf16 v[40:43], a[72:75], a[4:7], 0
  ds_read_b64_tr_b16 a[72:73], v244 offset:16384
  s_waitcnt lgkmcnt(10)
  v_mfma_f32_16x16x32_bf16 v[28:31], a[76:79], a[0:3], 0
  ds_read_b64_tr_b16 a[74:75], v244 offset:20480
  buffer_load_dwordx4 a[60:63], v241, s[4:7], s16 offen offset:1024 sc1
  s_add_u32 s16, s16, 262144
  v_mfma_f32_16x16x32_bf16 v[44:47], a[76:79], a[4:7], 0
  ds_read_b64_tr_b16 a[76:77], v245 offset:16384
  v_mfma_f32_16x16x32_bf16 v[16:19], a[96:99], a[8:11], v[16:19]
  ds_read_b64_tr_b16 a[78:79], v245 offset:20480
  buffer_store_dwordx4 v[8:11], v224, s[12:15], s100 offen offset:0 sc1
  v_mfma_f32_16x16x32_bf16 v[32:35], a[96:99], a[12:15], v[32:35]
  ds_read_b64_tr_b16 a[96:97], v242 offset:24576
  v_mfma_f32_16x16x32_bf16 v[20:23], a[100:103], a[8:11], v[20:23]
  ds_read_b64_tr_b16 a[98:99], v242 offset:28672
  v_mfma_f32_16x16x32_bf16 v[36:39], a[100:103], a[12:15], v[36:39]
  ds_read_b64_tr_b16 a[100:101], v243 offset:24576
  buffer_store_dwordx4 v[64:67], v224, s[12:15], s100 offen offset:1024 sc1
  v_mfma_f32_16x16x32_bf16 v[24:27], a[104:107], a[8:11], v[24:27]
  ds_read_b64_tr_b16 a[102:103], v243 offset:28672
  v_mfma_f32_16x16x32_bf16 v[40:43], a[104:107], a[12:15], v[40:43]
  ds_read_b64_tr_b16 a[104:105], v244 offset:24576
  v_mfma_f32_16x16x32_bf16 v[28:31], a[108:111], a[8:11], v[28:31]
  ds_read_b64_tr_b16 a[106:107], v244 offset:28672
  v_mfma_f32_16x16x32_bf16 v[44:47], a[108:111], a[12:15], v[44:47]
  ds_read_b64_tr_b16 a[108:109], v245 offset:24576
  ds_read_b64_tr_b16 a[110:111], v245 offset:28672
  s_waitcnt vmcnt(16) lgkmcnt(10)
  s_barrier
  s_add_u32 m0, s38, 0
  s_nop 0
  buffer_load_dwordx4 v225, s[8:11], s17 offen lds
  v_mfma_f32_16x16x32_bf16 v[72:75], a[80:83], a[16:19], v[72:75]
  v_mfma_f32_16x16x32_bf16 v[88:91], a[80:83], a[20:23], v[88:91]
  ds_read_b64_tr_b16 a[80:81], v242 offset:34816
  v_mfma_f32_16x16x32_bf16 v[76:79], a[84:87], a[16:19], v[76:79]
  ds_read_b64_tr_b16 a[82:83], v242 offset:38912
  buffer_load_dwordx4 v226, s[8:11], s17 offen offset:1024 lds
  v_mfma_f32_16x16x32_bf16 v[92:95], a[84:87], a[20:23], v[92:95]
  ds_read_b64_tr_b16 a[84:85], v243 offset:34816
  v_mfma_f32_16x16x32_bf16 v[80:83], a[88:91], a[16:19], v[80:83]
  ds_read_b64_tr_b16 a[86:87], v243 offset:38912
  v_mfma_f32_16x16x32_bf16 v[96:99], a[88:91], a[20:23], v[96:99]
  ds_read_b64_tr_b16 a[88:89], v244 offset:34816
  buffer_load_dwordx4 v227, s[8:11], s17 offen offset:2048 lds
  v_mfma_f32_16x16x32_bf16 v[84:87], a[92:95], a[16:19], v[84:87]
  ds_read_b64_tr_b16 a[90:91], v244 offset:38912
  v_mfma_f32_16x16x32_bf16 v[100:103], a[92:95], a[20:23], v[100:103]
  ds_read_b64_tr_b16 a[92:93], v245 offset:34816
  buffer_load_dwordx4 v228, s[8:11], s17 offen offset:3072 lds
  s_add_u32 s17, s17, 458752
  v_mfma_f32_16x16x32_bf16 v[72:75], a[112:115], a[24:27], v[72:75]
  ds_read_b64_tr_b16 a[94:95], v245 offset:38912
  v_mfma_f32_16x16x32_bf16 v[88:91], a[112:115], a[28:31], v[88:91]
  ds_read_b64_tr_b16 a[112:113], v242 offset:43008
  v_mfma_f32_16x16x32_bf16 v[76:79], a[116:119], a[24:27], v[76:79]
  ds_read_b64_tr_b16 a[114:115], v242 offset:47104
  buffer_load_dword v251, v255, s[8:11], s96 offen
  s_sub_u32 s96, s96, 3145728
  v_mfma_f32_16x16x32_bf16 v[92:95], a[116:119], a[28:31], v[92:95]
  ds_read_b64_tr_b16 a[116:117], v243 offset:43008
  v_mfma_f32_16x16x32_bf16 v[80:83], a[120:123], a[24:27], v[80:83]
  ds_read_b64_tr_b16 a[118:119], v243 offset:47104
  v_mfma_f32_16x16x32_bf16 v[96:99], a[120:123], a[28:31], v[96:99]
  ds_read_b64_tr_b16 a[120:121], v244 offset:43008
  buffer_load_dwordx4 a[0:3], v240, s[4:7], s16 offen offset:0 sc1
  v_mfma_f32_16x16x32_bf16 v[84:87], a[124:127], a[24:27], v[84:87]
  ds_read_b64_tr_b16 a[122:123], v244 offset:47104
  v_mfma_f32_16x16x32_bf16 v[100:103], a[124:127], a[28:31], v[100:103]
  ds_read_b64_tr_b16 a[124:125], v245 offset:43008
  v_mfma_f32_16x16x32_bf16 v[16:19], a[64:67], a[16:19], v[16:19]
  ds_read_b64_tr_b16 a[126:127], v245 offset:47104
  buffer_load_dwordx4 a[4:7], v240, s[4:7], s16 offen offset:1024 sc1
  v_mfma_f32_16x16x32_bf16 v[32:35], a[64:67], a[20:23], v[32:35]
  ds_read_b64_tr_b16 a[64:65], v242 offset:32768
  v_mfma_f32_16x16x32_bf16 v[20:23], a[68:71], a[16:19], v[20:23]
  ds_read_b64_tr_b16 a[66:67], v242 offset:36864
  v_mfma_f32_16x16x32_bf16 v[36:39], a[68:71], a[20:23], v[36:39]
  ds_read_b64_tr_b16 a[68:69], v243 offset:32768
  buffer_load_dwordx4 a[8:11], v241, s[4:7], s16 offen offset:0 sc1
  v_mfma_f32_16x16x32_bf16 v[24:27], a[72:75], a[16:19], v[24:27]
  ds_read_b64_tr_b16 a[70:71], v243 offset:36864
  v_mfma_f32_16x16x32_bf16 v[40:43], a[72:75], a[20:23], v[40:43]
  ds_read_b64_tr_b16 a[72:73], v244 offset:32768
  s_waitcnt lgkmcnt(10)
  v_mfma_f32_16x16x32_bf16 v[28:31], a[76:79], a[16:19], v[28:31]
  ds_read_b64_tr_b16 a[74:75], v244 offset:36864
  buffer_load_dwordx4 a[12:15], v241, s[4:7], s16 offen offset:1024 sc1
  s_add_u32 s16, s16, 262144
  v_mfma_f32_16x16x32_bf16 v[44:47], a[76:79], a[20:23], v[44:47]
  ds_read_b64_tr_b16 a[76:77], v245 offset:32768
  v_mfma_f32_16x16x32_bf16 v[16:19], a[96:99], a[24:27], v[16:19]
  ds_read_b64_tr_b16 a[78:79], v245 offset:36864
  buffer_store_dwordx4 v[120:123], v224, s[12:15], s100 offen offset:2048 sc1
  v_mfma_f32_16x16x32_bf16 v[32:35], a[96:99], a[28:31], v[32:35]
  ds_read_b64_tr_b16 a[96:97], v242 offset:40960
  v_mfma_f32_16x16x32_bf16 v[20:23], a[100:103], a[24:27], v[20:23]
  ds_read_b64_tr_b16 a[98:99], v242 offset:45056
  v_mfma_f32_16x16x32_bf16 v[36:39], a[100:103], a[28:31], v[36:39]
  ds_read_b64_tr_b16 a[100:101], v243 offset:40960
  buffer_store_dwordx4 v[176:179], v224, s[12:15], s100 offen offset:3072 sc1
  v_mfma_f32_16x16x32_bf16 v[24:27], a[104:107], a[24:27], v[24:27]
  ds_read_b64_tr_b16 a[102:103], v243 offset:45056
  v_mfma_f32_16x16x32_bf16 v[40:43], a[104:107], a[28:31], v[40:43]
  ds_read_b64_tr_b16 a[104:105], v244 offset:40960
  v_mfma_f32_16x16x32_bf16 v[28:31], a[108:111], a[24:27], v[28:31]
  ds_read_b64_tr_b16 a[106:107], v244 offset:45056
  v_mfma_f32_16x16x32_bf16 v[44:47], a[108:111], a[28:31], v[44:47]
  ds_read_b64_tr_b16 a[108:109], v245 offset:40960
  ds_read_b64_tr_b16 a[110:111], v245 offset:45056
  s_waitcnt vmcnt(17) lgkmcnt(10)
  s_barrier
  s_add_u32 m0, s38, 16384
  s_nop 0
  buffer_load_dwordx4 v225, s[8:11], s17 offen lds
  v_mfma_f32_16x16x32_bf16 v[72:75], a[80:83], a[32:35], v[72:75]
  v_mfma_f32_16x16x32_bf16 v[88:91], a[80:83], a[36:39], v[88:91]
  ds_read_b64_tr_b16 a[80:81], v242 offset:51200
  v_mfma_f32_16x16x32_bf16 v[76:79], a[84:87], a[32:35], v[76:79]
  ds_read_b64_tr_b16 a[82:83], v242 offset:55296
  buffer_load_dwordx4 v226, s[8:11], s17 offen offset:1024 lds
  v_mfma_f32_16x16x32_bf16 v[92:95], a[84:87], a[36:39], v[92:95]
  ds_read_b64_tr_b16 a[84:85], v243 offset:51200
  v_mfma_f32_16x16x32_bf16 v[80:83], a[88:91], a[32:35], v[80:83]
  ds_read_b64_tr_b16 a[86:87], v243 offset:55296
  v_mfma_f32_16x16x32_bf16 v[96:99], a[88:91], a[36:39], v[96:99]
  ds_read_b64_tr_b16 a[88:89], v244 offset:51200
  buffer_load_dwordx4 v227, s[8:11], s17 offen offset:2048 lds
  v_mfma_f32_16x16x32_bf16 v[84:87], a[92:95], a[32:35], v[84:87]
  ds_read_b64_tr_b16 a[90:91], v244 offset:55296
  v_mfma_f32_16x16x32_bf16 v[100:103], a[92:95], a[36:39], v[100:103]
  ds_read_b64_tr_b16 a[92:93], v245 offset:51200
  buffer_load_dwordx4 v228, s[8:11], s17 offen offset:3072 lds
  s_add_u32 s17, s17, 458752
  v_mfma_f32_16x16x32_bf16 v[72:75], a[112:115], a[40:43], v[72:75]
  ds_read_b64_tr_b16 a[94:95], v245 offset:55296
  v_mfma_f32_16x16x32_bf16 v[88:91], a[112:115], a[44:47], v[88:91]
  ds_read_b64_tr_b16 a[112:113], v242 offset:59392
  v_mfma_f32_16x16x32_bf16 v[76:79], a[116:119], a[40:43], v[76:79]
  ds_read_b64_tr_b16 a[114:115], v242 offset:63488
  buffer_load_dword v251, v255, s[8:11], s96 offen
  s_add_u32 s96, s96, 458752
  v_mfma_f32_16x16x32_bf16 v[92:95], a[116:119], a[44:47], v[92:95]
  ds_read_b64_tr_b16 a[116:117], v243 offset:59392
  v_mfma_f32_16x16x32_bf16 v[80:83], a[120:123], a[40:43], v[80:83]
  ds_read_b64_tr_b16 a[118:119], v243 offset:63488
  v_mfma_f32_16x16x32_bf16 v[96:99], a[120:123], a[44:47], v[96:99]
  ds_read_b64_tr_b16 a[120:121], v244 offset:59392
  buffer_load_dwordx4 a[16:19], v240, s[4:7], s16 offen offset:0 sc1
  v_mfma_f32_16x16x32_bf16 v[84:87], a[124:127], a[40:43], v[84:87]
  ds_read_b64_tr_b16 a[122:123], v244 offset:63488
  v_mfma_f32_16x16x32_bf16 v[100:103], a[124:127], a[44:47], v[100:103]
  ds_read_b64_tr_b16 a[124:125], v245 offset:59392
  v_mfma_f32_16x16x32_bf16 v[16:19], a[64:67], a[32:35], v[16:19]
  ds_read_b64_tr_b16 a[126:127], v245 offset:63488
  buffer_load_dwordx4 a[20:23], v240, s[4:7], s16 offen offset:1024 sc1
  v_mfma_f32_16x16x32_bf16 v[32:35], a[64:67], a[36:39], v[32:35]
  ds_read_b64_tr_b16 a[64:65], v242 offset:49152
  v_mfma_f32_16x16x32_bf16 v[20:23], a[68:71], a[32:35], v[20:23]
  ds_read_b64_tr_b16 a[66:67], v242 offset:53248
  v_mfma_f32_16x16x32_bf16 v[36:39], a[68:71], a[36:39], v[36:39]
  ds_read_b64_tr_b16 a[68:69], v243 offset:49152
  buffer_load_dwordx4 a[24:27], v241, s[4:7], s16 offen offset:0 sc1
  v_mfma_f32_16x16x32_bf16 v[24:27], a[72:75], a[32:35], v[24:27]
  ds_read_b64_tr_b16 a[70:71], v243 offset:53248
  v_mfma_f32_16x16x32_bf16 v[40:43], a[72:75], a[36:39], v[40:43]
  ds_read_b64_tr_b16 a[72:73], v244 offset:49152
  s_waitcnt lgkmcnt(10)
  v_mfma_f32_16x16x32_bf16 v[28:31], a[76:79], a[32:35], v[28:31]
  ds_read_b64_tr_b16 a[74:75], v244 offset:53248
  buffer_load_dwordx4 a[28:31], v241, s[4:7], s16 offen offset:1024 sc1
  s_add_u32 s16, s16, 262144
  v_mfma_f32_16x16x32_bf16 v[44:47], a[76:79], a[36:39], v[44:47]
  ds_read_b64_tr_b16 a[76:77], v245 offset:49152
  v_mfma_f32_16x16x32_bf16 v[16:19], a[96:99], a[40:43], v[16:19]
  ds_read_b64_tr_b16 a[78:79], v245 offset:53248
  buffer_store_dwordx4 v[12:15], v224, s[12:15], s101 offen offset:0 sc1
  v_mfma_f32_16x16x32_bf16 v[32:35], a[96:99], a[44:47], v[32:35]
  ds_read_b64_tr_b16 a[96:97], v242 offset:57344
  v_mfma_f32_16x16x32_bf16 v[20:23], a[100:103], a[40:43], v[20:23]
  ds_read_b64_tr_b16 a[98:99], v242 offset:61440
  v_mfma_f32_16x16x32_bf16 v[36:39], a[100:103], a[44:47], v[36:39]
  ds_read_b64_tr_b16 a[100:101], v243 offset:57344
  buffer_store_dwordx4 v[124:127], v224, s[12:15], s101 offen offset:2048 sc1
  v_mfma_f32_16x16x32_bf16 v[24:27], a[104:107], a[40:43], v[24:27]
  ds_read_b64_tr_b16 a[102:103], v243 offset:61440
  v_mfma_f32_16x16x32_bf16 v[40:43], a[104:107], a[44:47], v[40:43]
  ds_read_b64_tr_b16 a[104:105], v244 offset:57344
  v_mfma_f32_16x16x32_bf16 v[28:31], a[108:111], a[40:43], v[28:31]
  ds_read_b64_tr_b16 a[106:107], v244 offset:61440
  v_mfma_f32_16x16x32_bf16 v[44:47], a[108:111], a[44:47], v[44:47]
  ds_read_b64_tr_b16 a[108:109], v245 offset:57344
  ds_read_b64_tr_b16 a[110:111], v245 offset:61440
  s_waitcnt vmcnt(17) lgkmcnt(10)
  s_barrier
  s_add_u32 m0, s38, 32768
  s_nop 0
  buffer_load_dwordx4 v225, s[8:11], s17 offen lds
  v_mfma_f32_16x16x32_bf16 v[72:75], a[80:83], a[48:51], v[72:75]
  v_mfma_f32_16x16x32_bf16 v[88:91], a[80:83], a[52:55], v[88:91]
  ds_read_b64_tr_b16 a[80:81], v242 offset:2048
  v_mfma_f32_16x16x32_bf16 v[76:79], a[84:87], a[48:51], v[76:79]
  ds_read_b64_tr_b16 a[82:83], v242 offset:6144
  buffer_load_dwordx4 v226, s[8:11], s17 offen offset:1024 lds
  v_mfma_f32_16x16x32_bf16 v[92:95], a[84:87], a[52:55], v[92:95]
  ds_read_b64_tr_b16 a[84:85], v243 offset:2048
  v_mfma_f32_16x16x32_bf16 v[80:83], a[88:91], a[48:51], v[80:83]
  ds_read_b64_tr_b16 a[86:87], v243 offset:6144
  v_mfma_f32_16x16x32_bf16 v[96:99], a[88:91], a[52:55], v[96:99]
  ds_read_b64_tr_b16 a[88:89], v244 offset:2048
  v_mfma_f32_16x16x32_bf16 v[84:87], a[92:95], a[48:51], v[84:87]
  ds_read_b64_tr_b16 a[90:91], v244 offset:6144
  buffer_load_dwordx4 v227, s[8:11], s17 offen offset:2048 lds
  v_mfma_f32_16x16x32_bf16 v[100:103], a[92:95], a[52:55], v[100:103]
  ds_read_b64_tr_b16 a[92:93], v245 offset:2048
  v_mfma_f32_16x16x32_bf16 v[72:75], a[112:115], a[56:59], v[72:75]
  ds_read_b64_tr_b16 a[94:95], v245 offset:6144
  v_mfma_f32_16x16x32_bf16 v[88:91], a[112:115], a[60:63], v[88:91]
  ds_read_b64_tr_b16 a[112:113], v242 offset:10240
  buffer_load_dwordx4 v228, s[8:11], s17 offen offset:3072 lds
  s_add_u32 s17, s17, 458752
  v_mfma_f32_16x16x32_bf16 v[76:79], a[116:119], a[56:59], v[76:79]
  ds_read_b64_tr_b16 a[114:115], v242 offset:14336
  v_mfma_f32_16x16x32_bf16 v[92:95], a[116:119], a[60:63], v[92:95]
  ds_read_b64_tr_b16 a[116:117], v243 offset:10240
  v_mfma_f32_16x16x32_bf16 v[80:83], a[120:123], a[56:59], v[80:83]
  ds_read_b64_tr_b16 a[118:119], v243 offset:14336
  v_mfma_f32_16x16x32_bf16 v[96:99], a[120:123], a[60:63], v[96:99]
  ds_read_b64_tr_b16 a[120:121], v244 offset:10240
  buffer_load_dword v251, v255, s[8:11], s96 offen
  s_add_u32 s96, s96, 458752
  v_mfma_f32_16x16x32_bf16 v[84:87], a[124:127], a[56:59], v[84:87]
  ds_read_b64_tr_b16 a[122:123], v244 offset:14336
  v_mfma_f32_16x16x32_bf16 v[100:103], a[124:127], a[60:63], v[100:103]
  ds_read_b64_tr_b16 a[124:125], v245 offset:10240
  buffer_load_dword v247, v246, s[56:59], s94 offen sc1
  v_mfma_f32_16x16x32_bf16 v[16:19], a[64:67], a[48:51], v[16:19]
  ds_read_b64_tr_b16 a[126:127], v245 offset:14336
  buffer_load_dwordx4 a[32:35], v240, s[4:7], s16 offen offset:0 sc1
  v_mfma_f32_16x16x32_bf16 v[32:35], a[64:67], a[52:55], v[32:35]
  ds_read_b64_tr_b16 a[64:65], v242 offset:0
  v_mfma_f32_16x16x32_bf16 v[20:23], a[68:71], a[48:51], v[20:23]
  ds_read_b64_tr_b16 a[66:67], v242 offset:4096
  v_mfma_f32_16x16x32_bf16 v[36:39], a[68:71], a[52:55], v[36:39]
  ds_read_b64_tr_b16 a[68:69], v243 offset:0
  v_mfma_f32_16x16x32_bf16 v[24:27], a[72:75], a[48:51], v[24:27]
  ds_read_b64_tr_b16 a[70:71], v243 offset:4096
  buffer_load_dwordx4 a[36:39], v240, s[4:7], s16 offen offset:1024 sc1
  v_mfma_f32_16x16x32_bf16 v[40:43], a[72:75], a[52:55], v[40:43]
  ds_read_b64_tr_b16 a[72:73], v244 offset:0
  s_waitcnt lgkmcnt(10)
  v_mfma_f32_16x16x32_bf16 v[28:31], a[76:79], a[48:51], v[28:31]
  ds_read_b64_tr_b16 a[74:75], v244 offset:4096
  v_mfma_f32_16x16x32_bf16 v[44:47], a[76:79], a[52:55], v[44:47]
  ds_read_b64_tr_b16 a[76:77], v245 offset:0
  buffer_load_dwordx4 a[40:43], v241, s[4:7], s16 offen offset:0 sc1
  v_mfma_f32_16x16x32_bf16 v[16:19], a[96:99], a[56:59], v[16:19]
  ds_read_b64_tr_b16 a[78:79], v245 offset:4096
  v_mfma_f32_16x16x32_bf16 v[32:35], a[96:99], a[60:63], v[32:35]
  ds_read_b64_tr_b16 a[96:97], v242 offset:8192
  v_mfma_f32_16x16x32_bf16 v[20:23], a[100:103], a[56:59], v[20:23]
  ds_read_b64_tr_b16 a[98:99], v242 offset:12288
  v_mfma_f32_16x16x32_bf16 v[36:39], a[100:103], a[60:63], v[36:39]
  ds_read_b64_tr_b16 a[100:101], v243 offset:8192
  buffer_load_dwordx4 a[44:47], v241, s[4:7], s16 offen offset:1024 sc1
  s_add_u32 s16, s16, 262144
  v_mfma_f32_16x16x32_bf16 v[24:27], a[104:107], a[56:59], v[24:27]
  ds_read_b64_tr_b16 a[102:103], v243 offset:12288
  v_mfma_f32_16x16x32_bf16 v[40:43], a[104:107], a[60:63], v[40:43]
  ds_read_b64_tr_b16 a[104:105], v244 offset:8192
  v_mfma_f32_16x16x32_bf16 v[28:31], a[108:111], a[56:59], v[28:31]
  ds_read_b64_tr_b16 a[106:107], v244 offset:12288
  v_mfma_f32_16x16x32_bf16 v[44:47], a[108:111], a[60:63], v[44:47]
  ds_read_b64_tr_b16 a[108:109], v245 offset:8192
  ds_read_b64_tr_b16 a[110:111], v245 offset:12288
  s_waitcnt vmcnt(16) lgkmcnt(10)
  s_barrier
  s_add_u32 m0, s38, 49152
  s_nop 0
  buffer_load_dwordx4 v225, s[8:11], s17 offen lds
  v_mfma_f32_16x16x32_bf16 v[72:75], a[80:83], a[0:3], v[72:75]
  v_mfma_f32_16x16x32_bf16 v[88:91], a[80:83], a[4:7], v[88:91]
  ds_read_b64_tr_b16 a[80:81], v242 offset:18432
  v_mfma_f32_16x16x32_bf16 v[76:79], a[84:87], a[0:3], v[76:79]
  ds_read_b64_tr_b16 a[82:83], v242 offset:22528
  buffer_load_dwordx4 v226, s[8:11], s17 offen offset:1024 lds
  v_mfma_f32_16x16x32_bf16 v[92:95], a[84:87], a[4:7], v[92:95]
  ds_read_b64_tr_b16 a[84:85], v243 offset:18432
  v_mfma_f32_16x16x32_bf16 v[80:83], a[88:91], a[0:3], v[80:83]
  ds_read_b64_tr_b16 a[86:87], v243 offset:22528
  v_mfma_f32_16x16x32_bf16 v[96:99], a[88:91], a[4:7], v[96:99]
  ds_read_b64_tr_b16 a[88:89], v244 offset:18432
  v_mfma_f32_16x16x32_bf16 v[84:87], a[92:95], a[0:3], v[84:87]
  ds_read_b64_tr_b16 a[90:91], v244 offset:22528
  buffer_load_dwordx4 v227, s[8:11], s17 offen offset:2048 lds
  v_mfma_f32_16x16x32_bf16 v[100:103], a[92:95], a[4:7], v[100:103]
  ds_read_b64_tr_b16 a[92:93], v245 offset:18432
  v_mfma_f32_16x16x32_bf16 v[72:75], a[112:115], a[8:11], v[72:75]
  ds_read_b64_tr_b16 a[94:95], v245 offset:22528
  v_mfma_f32_16x16x32_bf16 v[88:91], a[112:115], a[12:15], v[88:91]
  ds_read_b64_tr_b16 a[112:113], v242 offset:26624
  buffer_load_dwordx4 v228, s[8:11], s17 offen offset:3072 lds
  s_sub_u32 s17, s17, 3145728
  v_mfma_f32_16x16x32_bf16 v[76:79], a[116:119], a[8:11], v[76:79]
  ds_read_b64_tr_b16 a[114:115], v242 offset:30720
  v_mfma_f32_16x16x32_bf16 v[92:95], a[116:119], a[12:15], v[92:95]
  ds_read_b64_tr_b16 a[116:117], v243 offset:26624
  v_mfma_f32_16x16x32_bf16 v[80:83], a[120:123], a[8:11], v[80:83]
  ds_read_b64_tr_b16 a[118:119], v243 offset:30720
  v_mfma_f32_16x16x32_bf16 v[96:99], a[120:123], a[12:15], v[96:99]
  ds_read_b64_tr_b16 a[120:121], v244 offset:26624
  buffer_load_dword v251, v255, s[8:11], s96 offen
  s_add_u32 s96, s96, 458752
  v_mfma_f32_16x16x32_bf16 v[84:87], a[124:127], a[8:11], v[84:87]
  ds_read_b64_tr_b16 a[122:123], v244 offset:30720
  v_mfma_f32_16x16x32_bf16 v[100:103], a[124:127], a[12:15], v[100:103]
  ds_read_b64_tr_b16 a[124:125], v245 offset:26624
  v_mfma_f32_16x16x32_bf16 v[16:19], a[64:67], a[0:3], v[16:19]
  ds_read_b64_tr_b16 a[126:127], v245 offset:30720
  buffer_load_dwordx4 a[48:51], v240, s[4:7], s16 offen offset:0 sc1
  v_mfma_f32_16x16x32_bf16 v[32:35], a[64:67], a[4:7], v[32:35]
  ds_read_b64_tr_b16 a[64:65], v242 offset:16384
  v_mfma_f32_16x16x32_bf16 v[20:23], a[68:71], a[0:3], v[20:23]
  ds_read_b64_tr_b16 a[66:67], v242 offset:20480
  v_mfma_f32_16x16x32_bf16 v[36:39], a[68:71], a[4:7], v[36:39]
  ds_read_b64_tr_b16 a[68:69], v243 offset:16384
  v_mfma_f32_16x16x32_bf16 v[24:27], a[72:75], a[0:3], v[24:27]
  ds_read_b64_tr_b16 a[70:71], v243 offset:20480
  buffer_load_dwordx4 a[52:55], v240, s[4:7], s16 offen offset:1024 sc1
  v_mfma_f32_16x16x32_bf16 v[40:43], a[72:75], a[4:7], v[40:43]
  ds_read_b64_tr_b16 a[72:73], v244 offset:16384
  s_waitcnt lgkmcnt(10)
  v_mfma_f32_16x16x32_bf16 v[28:31], a[76:79], a[0:3], v[28:31]
  ds_read_b64_tr_b16 a[74:75], v244 offset:20480
  v_mfma_f32_16x16x32_bf16 v[44:47], a[76:79], a[4:7], v[44:47]
  ds_read_b64_tr_b16 a[76:77], v245 offset:16384
  buffer_load_dwordx4 a[56:59], v241, s[4:7], s16 offen offset:0 sc1
  v_mfma_f32_16x16x32_bf16 v[16:19], a[96:99], a[8:11], v[16:19]
  ds_read_b64_tr_b16 a[78:79], v245 offset:20480
  v_mfma_f32_16x16x32_bf16 v[32:35], a[96:99], a[12:15], v[32:35]
  ds_read_b64_tr_b16 a[96:97], v242 offset:24576
  v_mfma_f32_16x16x32_bf16 v[20:23], a[100:103], a[8:11], v[20:23]
  ds_read_b64_tr_b16 a[98:99], v242 offset:28672
  v_mfma_f32_16x16x32_bf16 v[36:39], a[100:103], a[12:15], v[36:39]
  ds_read_b64_tr_b16 a[100:101], v243 offset:24576
  buffer_load_dwordx4 a[60:63], v241, s[4:7], s16 offen offset:1024 sc1
  s_add_u32 s16, s16, 262144
  v_mfma_f32_16x16x32_bf16 v[24:27], a[104:107], a[8:11], v[24:27]
  ds_read_b64_tr_b16 a[102:103], v243 offset:28672
  v_mfma_f32_16x16x32_bf16 v[40:43], a[104:107], a[12:15], v[40:43]
  ds_read_b64_tr_b16 a[104:105], v244 offset:24576
  v_mfma_f32_16x16x32_bf16 v[28:31], a[108:111], a[8:11], v[28:31]
  ds_read_b64_tr_b16 a[106:107], v244 offset:28672
  v_mfma_f32_16x16x32_bf16 v[44:47], a[108:111], a[12:15], v[44:47]
  ds_read_b64_tr_b16 a[108:109], v245 offset:24576
  ds_read_b64_tr_b16 a[110:111], v245 offset:28672
  s_waitcnt vmcnt(13) lgkmcnt(10)
  s_barrier
  v_cmp_ne_u32 vcc, 1, v247
  s_nop 1
  s_cmp_lg_u64 vcc, 0
  s_cbranch_scc1 L_slow_35
  L_back_36:
  s_add_u32 s94, s94, 65536
  s_add_u32 m0, s38, 0
  s_nop 0
  buffer_load_dwordx4 v225, s[8:11], s17 offen lds
  v_mfma_f32_16x16x32_bf16 v[72:75], a[80:83], a[16:19], v[72:75]
  v_mfma_f32_16x16x32_bf16 v[88:91], a[80:83], a[20:23], v[88:91]
  ds_read_b64_tr_b16 a[80:81], v242 offset:34816
  v_mfma_f32_16x16x32_bf16 v[76:79], a[84:87], a[16:19], v[76:79]
  ds_read_b64_tr_b16 a[82:83], v242 offset:38912
  buffer_load_dwordx4 v226, s[8:11], s17 offen offset:1024 lds
  v_mfma_f32_16x16x32_bf16 v[92:95], a[84:87], a[20:23], v[92:95]
  ds_read_b64_tr_b16 a[84:85], v243 offset:34816
  v_mfma_f32_16x16x32_bf16 v[80:83], a[88:91], a[16:19], v[80:83]
  ds_read_b64_tr_b16 a[86:87], v243 offset:38912
  v_mfma_f32_16x16x32_bf16 v[96:99], a[88:91], a[20:23], v[96:99]
  ds_read_b64_tr_b16 a[88:89], v244 offset:34816
  v_mfma_f32_16x16x32_bf16 v[84:87], a[92:95], a[16:19], v[84:87]
  ds_read_b64_tr_b16 a[90:91], v244 offset:38912
  buffer_load_dwordx4 v227, s[8:11], s17 offen offset:2048 lds
  v_mfma_f32_16x16x32_bf16 v[100:103], a[92:95], a[20:23], v[100:103]
  ds_read_b64_tr_b16 a[92:93], v245 offset:34816
  v_mfma_f32_16x16x32_bf16 v[72:75], a[112:115], a[24:27], v[72:75]
  ds_read_b64_tr_b16 a[94:95], v245 offset:38912
  v_mfma_f32_16x16x32_bf16 v[88:91], a[112:115], a[28:31], v[88:91]
  ds_read_b64_tr_b16 a[112:113], v242 offset:43008
  buffer_load_dwordx4 v228, s[8:11], s17 offen offset:3072 lds
  s_add_u32 s17, s17, 458752
  v_mfma_f32_16x16x32_bf16 v[76:79], a[116:119], a[24:27], v[76:79]
  ds_read_b64_tr_b16 a[114:115], v242 offset:47104
  v_mfma_f32_16x16x32_bf16 v[92:95], a[116:119], a[28:31], v[92:95]
  ds_read_b64_tr_b16 a[116:117], v243 offset:43008
  v_mfma_f32_16x16x32_bf16 v[80:83], a[120:123], a[24:27], v[80:83]
  ds_read_b64_tr_b16 a[118:119], v243 offset:47104
  v_mfma_f32_16x16x32_bf16 v[96:99], a[120:123], a[28:31], v[96:99]
  ds_read_b64_tr_b16 a[120:121], v244 offset:43008
  buffer_load_dword v251, v255, s[8:11], s96 offen
  s_add_u32 s96, s96, 458752
  v_mfma_f32_16x16x32_bf16 v[84:87], a[124:127], a[24:27], v[84:87]
  ds_read_b64_tr_b16 a[122:123], v244 offset:47104
  v_mfma_f32_16x16x32_bf16 v[100:103], a[124:127], a[28:31], v[100:103]
  ds_read_b64_tr_b16 a[124:125], v245 offset:43008
  v_mfma_f32_16x16x32_bf16 v[16:19], a[64:67], a[16:19], v[16:19]
  ds_read_b64_tr_b16 a[126:127], v245 offset:47104
  buffer_load_dwordx4 a[0:3], v240, s[4:7], s16 offen offset:0 sc1
  v_mfma_f32_16x16x32_bf16 v[32:35], a[64:67], a[20:23], v[32:35]
  ds_read_b64_tr_b16 a[64:65], v242 offset:32768
  v_mfma_f32_16x16x32_bf16 v[20:23], a[68:71], a[16:19], v[20:23]
  ds_read_b64_tr_b16 a[66:67], v242 offset:36864
  v_mfma_f32_16x16x32_bf16 v[36:39], a[68:71], a[20:23], v[36:39]
  ds_read_b64_tr_b16 a[68:69], v243 offset:32768
  v_mfma_f32_16x16x32_bf16 v[24:27], a[72:75], a[16:19], v[24:27]
  ds_read_b64_tr_b16 a[70:71], v243 offset:36864
  buffer_load_dwordx4 a[4:7], v240, s[4:7], s16 offen offset:1024 sc1
  v_mfma_f32_16x16x32_bf16 v[40:43], a[72:75], a[20:23], v[40:43]
  ds_read_b64_tr_b16 a[72:73], v244 offset:32768
  s_waitcnt lgkmcnt(10)
  v_mfma_f32_16x16x32_bf16 v[28:31], a[76:79], a[16:19], v[28:31]
  ds_read_b64_tr_b16 a[74:75], v244 offset:36864
  v_mfma_f32_16x16x32_bf16 v[44:47], a[76:79], a[20:23], v[44:47]
  ds_read_b64_tr_b16 a[76:77], v245 offset:32768
  buffer_load_dwordx4 a[8:11], v241, s[4:7], s16 offen offset:0 sc1
  v_mfma_f32_16x16x32_bf16 v[16:19], a[96:99], a[24:27], v[16:19]
  ds_read_b64_tr_b16 a[78:79], v245 offset:36864
  v_mfma_f32_16x16x32_bf16 v[32:35], a[96:99], a[28:31], v[32:35]
  ds_read_b64_tr_b16 a[96:97], v242 offset:40960
  v_mfma_f32_16x16x32_bf16 v[20:23], a[100:103], a[24:27], v[20:23]
  ds_read_b64_tr_b16 a[98:99], v242 offset:45056
  v_mfma_f32_16x16x32_bf16 v[36:39], a[100:103], a[28:31], v[36:39]
  ds_read_b64_tr_b16 a[100:101], v243 offset:40960
  buffer_load_dwordx4 a[12:15], v241, s[4:7], s16 offen offset:1024 sc1
  s_add_u32 s16, s16, 262144
  v_mfma_f32_16x16x32_bf16 v[24:27], a[104:107], a[24:27], v[24:27]
  ds_read_b64_tr_b16 a[102:103], v243 offset:45056
  v_mfma_f32_16x16x32_bf16 v[40:43], a[104:107], a[28:31], v[40:43]
  ds_read_b64_tr_b16 a[104:105], v244 offset:40960
  v_mfma_f32_16x16x32_bf16 v[28:31], a[108:111], a[24:27], v[28:31]
  ds_read_b64_tr_b16 a[106:107], v244 offset:45056
  v_mfma_f32_16x16x32_bf16 v[44:47], a[108:111], a[28:31], v[44:47]
  ds_read_b64_tr_b16 a[108:109], v245 offset:40960
  ds_read_b64_tr_b16 a[110:111], v245 offset:45056
  s_waitcnt vmcnt(13) lgkmcnt(10)
  s_barrier
  s_mov_b64 exec, 1
  buffer_store_dword v248, v250, s[56:59], s92 offen sc1
  s_mov_b64 exec, -1
  s_add_u32 s92, s92, 65536
  s_add_u32 m0, s38, 16384
  s_nop 0
  buffer_load_dwordx4 v225, s[8:11], s17 offen lds
  v_mfma_f32_16x16x32_bf16 v[72:75], a[80:83], a[32:35], v[72:75]
  v_mfma_f32_16x16x32_bf16 v[88:91], a[80:83], a[36:39], v[88:91]
  ds_read_b64_tr_b16 a[80:81], v242 offset:51200
  v_mfma_f32_16x16x32_bf16 v[76:79], a[84:87], a[32:35], v[76:79]
  ds_read_b64_tr_b16 a[82:83], v242 offset:55296
  buffer_load_dwordx4 v226, s[8:11], s17 offen offset:1024 lds
  v_mfma_f32_16x16x32_bf16 v[92:95], a[84:87], a[36:39], v[92:95]
  ds_read_b64_tr_b16 a[84:85], v243 offset:51200
  v_mfma_f32_16x16x32_bf16 v[80:83], a[88:91], a[32:35], v[80:83]
  ds_read_b64_tr_b16 a[86:87], v243 offset:55296
  v_mfma_f32_16x16x32_bf16 v[96:99], a[88:91], a[36:39], v[96:99]
  ds_read_b64_tr_b16 a[88:89], v244 offset:51200
  v_mfma_f32_16x16x32_bf16 v[84:87], a[92:95], a[32:35], v[84:87]
  ds_read_b64_tr_b16 a[90:91], v244 offset:55296
  buffer_load_dwordx4 v227, s[8:11], s17 offen offset:2048 lds
  v_mfma_f32_16x16x32_bf16 v[100:103], a[92:95], a[36:39], v[100:103]
  ds_read_b64_tr_b16 a[92:93], v245 offset:51200
  v_mfma_f32_16x16x32_bf16 v[72:75], a[112:115], a[40:43], v[72:75]
  ds_read_b64_tr_b16 a[94:95], v245 offset:55296
  v_mfma_f32_16x16x32_bf16 v[88:91], a[112:115], a[44:47], v[88:91]
  ds_read_b64_tr_b16 a[112:113], v242 offset:59392
  buffer_load_dwordx4 v228, s[8:11], s17 offen offset:3072 lds
  s_add_u32 s17, s17, 458752
  v_mfma_f32_16x16x32_bf16 v[76:79], a[116:119], a[40:43], v[76:79]
  ds_read_b64_tr_b16 a[114:115], v242 offset:63488
  v_mfma_f32_16x16x32_bf16 v[92:95], a[116:119], a[44:47], v[92:95]
  ds_read_b64_tr_b16 a[116:117], v243 offset:59392
  v_mfma_f32_16x16x32_bf16 v[80:83], a[120:123], a[40:43], v[80:83]
  ds_read_b64_tr_b16 a[118:119], v243 offset:63488
  v_mfma_f32_16x16x32_bf16 v[96:99], a[120:123], a[44:47], v[96:99]
  ds_read_b64_tr_b16 a[120:121], v244 offset:59392
  buffer_load_dword v251, v255, s[8:11], s96 offen
  s_add_u32 s96, s96, 458752
  v_mfma_f32_16x16x32_bf16 v[84:87], a[124:127], a[40:43], v[84:87]
  ds_read_b64_tr_b16 a[122:123], v244 offset:63488
  v_mfma_f32_16x16x32_bf16 v[100:103], a[124:127], a[44:47], v[100:103]
  ds_read_b64_tr_b16 a[124:125], v245 offset:59392
  v_mfma_f32_16x16x32_bf16 v[16:19], a[64:67], a[32:35], v[16:19]
  ds_read_b64_tr_b16 a[126:127], v245 offset:63488
  buffer_load_dwordx4 a[16:19], v240, s[4:7], s16 offen offset:0 sc1
  v_mfma_f32_16x16x32_bf16 v[32:35], a[64:67], a[36:39], v[32:35]
  ds_read_b64_tr_b16 a[64:65], v242 offset:49152
  v_mfma_f32_16x16x32_bf16 v[20:23], a[68:71], a[32:35], v[20:23]
  ds_read_b64_tr_b16 a[66:67], v242 offset:53248
  v_mfma_f32_16x16x32_bf16 v[36:39], a[68:71], a[36:39], v[36:39]
  ds_read_b64_tr_b16 a[68:69], v243 offset:49152
  v_mfma_f32_16x16x32_bf16 v[24:27], a[72:75], a[32:35], v[24:27]
  ds_read_b64_tr_b16 a[70:71], v243 offset:53248
  buffer_load_dwordx4 a[20:23], v240, s[4:7], s16 offen offset:1024 sc1
  v_mfma_f32_16x16x32_bf16 v[40:43], a[72:75], a[36:39], v[40:43]
  ds_read_b64_tr_b16 a[72:73], v244 offset:49152
  s_waitcnt lgkmcnt(10)
  v_mfma_f32_16x16x32_bf16 v[28:31], a[76:79], a[32:35], v[28:31]
  ds_read_b64_tr_b16 a[74:75], v244 offset:53248
  v_mfma_f32_16x16x32_bf16 v[44:47], a[76:79], a[36:39], v[44:47]
  ds_read_b64_tr_b16 a[76:77], v245 offset:49152
  buffer_load_dwordx4 a[24:27], v241, s[4:7], s16 offen offset:0 sc1
  v_mfma_f32_16x16x32_bf16 v[16:19], a[96:99], a[40:43], v[16:19]
  ds_read_b64_tr_b16 a[78:79], v245 offset:53248
  v_mfma_f32_16x16x32_bf16 v[32:35], a[96:99], a[44:47], v[32:35]
  ds_read_b64_tr_b16 a[96:97], v242 offset:57344
  v_mfma_f32_16x16x32_bf16 v[20:23], a[100:103], a[40:43], v[20:23]
  ds_read_b64_tr_b16 a[98:99], v242 offset:61440
  v_mfma_f32_16x16x32_bf16 v[36:39], a[100:103], a[44:47], v[36:39]
  ds_read_b64_tr_b16 a[100:101], v243 offset:57344
  buffer_load_dwordx4 a[28:31], v241, s[4:7], s16 offen offset:1024 sc1
  s_add_u32 s16, s16, 262144
  v_mfma_f32_16x16x32_bf16 v[24:27], a[104:107], a[40:43], v[24:27]
  ds_read_b64_tr_b16 a[102:103], v243 offset:61440
  v_mfma_f32_16x16x32_bf16 v[40:43], a[104:107], a[44:47], v[40:43]
  ds_read_b64_tr_b16 a[104:105], v244 offset:57344
  v_mfma_f32_16x16x32_bf16 v[28:31], a[108:111], a[40:43], v[28:31]
  ds_read_b64_tr_b16 a[106:107], v244 offset:61440
  v_mfma_f32_16x16x32_bf16 v[44:47], a[108:111], a[44:47], v[44:47]
  ds_read_b64_tr_b16 a[108:109], v245 offset:57344
  ds_read_b64_tr_b16 a[110:111], v245 offset:61440
  s_waitcnt vmcnt(14) lgkmcnt(10)
  s_barrier
  s_add_u32 m0, s38, 32768
  s_nop 0
  buffer_load_dwordx4 v225, s[8:11], s17 offen lds
  v_mfma_f32_16x16x32_bf16 v[72:75], a[80:83], a[48:51], v[72:75]
  v_mfma_f32_16x16x32_bf16 v[88:91], a[80:83], a[52:55], v[88:91]
  ds_read_b64_tr_b16 a[80:81], v242 offset:2048
  v_mfma_f32_16x16x32_bf16 v[76:79], a[84:87], a[48:51], v[76:79]
  ds_read_b64_tr_b16 a[82:83], v242 offset:6144
  buffer_load_dwordx4 v226, s[8:11], s17 offen offset:1024 lds
  v_mfma_f32_16x16x32_bf16 v[92:95], a[84:87], a[52:55], v[92:95]
  ds_read_b64_tr_b16 a[84:85], v243 offset:2048
  v_mfma_f32_16x16x32_bf16 v[80:83], a[88:91], a[48:51], v[80:83]
  ds_read_b64_tr_b16 a[86:87], v243 offset:6144
  v_mfma_f32_16x16x32_bf16 v[96:99], a[88:91], a[52:55], v[96:99]
  ds_read_b64_tr_b16 a[88:89], v244 offset:2048
  v_mfma_f32_16x16x32_bf16 v[84:87], a[92:95], a[48:51], v[84:87]
  ds_read_b64_tr_b16 a[90:91], v244 offset:6144
  buffer_load_dwordx4 v227, s[8:11], s17 offen offset:2048 lds
  v_mfma_f32_16x16x32_bf16 v[100:103], a[92:95], a[52:55], v[100:103]
  ds_read_b64_tr_b16 a[92:93], v245 offset:2048
  v_mfma_f32_16x16x32_bf16 v[72:75], a[112:115], a[56:59], v[72:75]
  ds_read_b64_tr_b16 a[94:95], v245 offset:6144
  v_mfma_f32_16x16x32_bf16 v[88:91], a[112:115], a[60:63], v[88:91]
  ds_read_b64_tr_b16 a[112:113], v242 offset:10240
  buffer_load_dwordx4 v228, s[8:11], s17 offen offset:3072 lds
  s_add_u32 s17, s17, 458752
  v_mfma_f32_16x16x32_bf16 v[76:79], a[116:119], a[56:59], v[76:79]
  ds_read_b64_tr_b16 a[114:115], v242 offset:14336
  v_mfma_f32_16x16x32_bf16 v[92:95], a[116:119], a[60:63], v[92:95]
  ds_read_b64_tr_b16 a[116:117], v243 offset:10240
  v_mfma_f32_16x16x32_bf16 v[80:83], a[120:123], a[56:59], v[80:83]
  ds_read_b64_tr_b16 a[118:119], v243 offset:14336
  v_mfma_f32_16x16x32_bf16 v[96:99], a[120:123], a[60:63], v[96:99]
  ds_read_b64_tr_b16 a[120:121], v244 offset:10240
  buffer_load_dword v251, v255, s[8:11], s96 offen
  s_add_u32 s96, s96, 458752
  v_mfma_f32_16x16x32_bf16 v[84:87], a[124:127], a[56:59], v[84:87]
  ds_read_b64_tr_b16 a[122:123], v244 offset:14336
  v_mfma_f32_16x16x32_bf16 v[100:103], a[124:127], a[60:63], v[100:103]
  ds_read_b64_tr_b16 a[124:125], v245 offset:10240
  v_mfma_f32_16x16x32_bf16 v[16:19], a[64:67], a[48:51], v[16:19]
  ds_read_b64_tr_b16 a[126:127], v245 offset:14336
  buffer_load_dwordx4 a[32:35], v240, s[4:7], s16 offen offset:0 sc1
  v_mfma_f32_16x16x32_bf16 v[32:35], a[64:67], a[52:55], v[32:35]
  ds_read_b64_tr_b16 a[64:65], v242 offset:0
  v_mfma_f32_16x16x32_bf16 v[20:23], a[68:71], a[48:51], v[20:23]
  ds_read_b64_tr_b16 a[66:67], v242 offset:4096
  v_mfma_f32_16x16x32_bf16 v[36:39], a[68:71], a[52:55], v[36:39]
  ds_read_b64_tr_b16 a[68:69], v243 offset:0
  v_mfma_f32_16x16x32_bf16 v[24:27], a[72:75], a[48:51], v[24:27]
  ds_read_b64_tr_b16 a[70:71], v243 offset:4096
  buffer_load_dwordx4 a[36:39], v240, s[4:7], s16 offen offset:1024 sc1
  v_mfma_f32_16x16x32_bf16 v[40:43], a[72:75], a[52:55], v[40:43]
  ds_read_b64_tr_b16 a[72:73], v244 offset:0
  s_waitcnt lgkmcnt(10)
  v_mfma_f32_16x16x32_bf16 v[28:31], a[76:79], a[48:51], v[28:31]
  ds_read_b64_tr_b16 a[74:75], v244 offset:4096
  v_mfma_f32_16x16x32_bf16 v[44:47], a[76:79], a[52:55], v[44:47]
  ds_read_b64_tr_b16 a[76:77], v245 offset:0
  buffer_load_dwordx4 a[40:43], v241, s[4:7], s16 offen offset:0 sc1
  v_mfma_f32_16x16x32_bf16 v[16:19], a[96:99], a[56:59], v[16:19]
  ds_read_b64_tr_b16 a[78:79], v245 offset:4096
  v_mfma_f32_16x16x32_bf16 v[32:35], a[96:99], a[60:63], v[32:35]
  ds_read_b64_tr_b16 a[96:97], v242 offset:8192
  v_mfma_f32_16x16x32_bf16 v[20:23], a[100:103], a[56:59], v[20:23]
  ds_read_b64_tr_b16 a[98:99], v242 offset:12288
  v_mfma_f32_16x16x32_bf16 v[36:39], a[100:103], a[60:63], v[36:39]
  ds_read_b64_tr_b16 a[100:101], v243 offset:8192
  buffer_load_dwordx4 a[44:47], v241, s[4:7], s16 offen offset:1024 sc1
  s_add_u32 s16, s16, 262144
  v_mfma_f32_16x16x32_bf16 v[24:27], a[104:107], a[56:59], v[24:27]
  ds_read_b64_tr_b16 a[102:103], v243 offset:12288
  v_mfma_f32_16x16x32_bf16 v[40:43], a[104:107], a[60:63], v[40:43]
  ds_read_b64_tr_b16 a[104:105], v244 offset:8192
  v_mfma_f32_16x16x32_bf16 v[28:31], a[108:111], a[56:59], v[28:31]
  ds_read_b64_tr_b16 a[106:107], v244 offset:12288
  v_mfma_f32_16x16x32_bf16 v[44:47], a[108:111], a[60:63], v[44:47]
  ds_read_b64_tr_b16 a[108:109], v245 offset:8192
  ds_read_b64_tr_b16 a[110:111], v245 offset:12288
  s_waitcnt vmcnt(13) lgkmcnt(10)
  s_barrier
  s_add_u32 m0, s38, 49152
  s_nop 0
  buffer_load_dwordx4 v225, s[8:11], s17 offen lds
  v_mfma_f32_16x16x32_bf16 v[72:75], a[80:83], a[0:3], v[72:75]
  v_mfma_f32_16x16x32_bf16 v[88:91], a[80:83], a[4:7], v[88:91]
  ds_read_b64_tr_b16 a[80:81], v242 offset:18432
  v_mfma_f32_16x16x32_bf16 v[76:79], a[84:87], a[0:3], v[76:79]
  ds_read_b64_tr_b16 a[82:83], v242 offset:22528
  buffer_load_dwordx4 v226, s[8:11], s17 offen offset:1024 lds
  v_mfma_f32_16x16x32_bf16 v[92:95], a[84:87], a[4:7], v[92:95]
  ds_read_b64_tr_b16 a[84:85], v243 offset:18432
  v_mfma_f32_16x16x32_bf16 v[80:83], a[88:91], a[0:3], v[80:83]
  ds_read_b64_tr_b16 a[86:87], v243 offset:22528
  v_mfma_f32_16x16x32_bf16 v[96:99], a[88:91], a[4:7], v[96:99]
  ds_read_b64_tr_b16 a[88:89], v244 offset:18432
  v_mfma_f32_16x16x32_bf16 v[84:87], a[92:95], a[0:3], v[84:87]
  ds_read_b64_tr_b16 a[90:91], v244 offset:22528
  buffer_load_dwordx4 v227, s[8:11], s17 offen offset:2048 lds
  v_mfma_f32_16x16x32_bf16 v[100:103], a[92:95], a[4:7], v[100:103]
  ds_read_b64_tr_b16 a[92:93], v245 offset:18432
  v_mfma_f32_16x16x32_bf16 v[72:75], a[112:115], a[8:11], v[72:75]
  ds_read_b64_tr_b16 a[94:95], v245 offset:22528
  v_mfma_f32_16x16x32_bf16 v[88:91], a[112:115], a[12:15], v[88:91]
  ds_read_b64_tr_b16 a[112:113], v242 offset:26624
  buffer_load_dwordx4 v228, s[8:11], s17 offen offset:3072 lds
  s_add_u32 s17, s17, 458752
  v_mfma_f32_16x16x32_bf16 v[76:79], a[116:119], a[8:11], v[76:79]
  ds_read_b64_tr_b16 a[114:115], v242 offset:30720
  v_mfma_f32_16x16x32_bf16 v[92:95], a[116:119], a[12:15], v[92:95]
  ds_read_b64_tr_b16 a[116:117], v243 offset:26624
  v_mfma_f32_16x16x32_bf16 v[80:83], a[120:123], a[8:11], v[80:83]
  ds_read_b64_tr_b16 a[118:119], v243 offset:30720
  v_mfma_f32_16x16x32_bf16 v[96:99], a[120:123], a[12:15], v[96:99]
  ds_read_b64_tr_b16 a[120:121], v244 offset:26624
  buffer_load_dword v251, v255, s[8:11], s96 offen
  s_add_u32 s96, s96, 458752
  v_mfma_f32_16x16x32_bf16 v[84:87], a[124:127], a[8:11], v[84:87]
  ds_read_b64_tr_b16 a[122:123], v244 offset:30720
  v_mfma_f32_16x16x32_bf16 v[100:103], a[124:127], a[12:15], v[100:103]
  ds_read_b64_tr_b16 a[124:125], v245 offset:26624
  v_mfma_f32_16x16x32_bf16 v[16:19], a[64:67], a[0:3], v[16:19]
  ds_read_b64_tr_b16 a[126:127], v245 offset:30720
  buffer_load_dwordx4 a[48:51], v240, s[4:7], s16 offen offset:0 sc1
  v_mfma_f32_16x16x32_bf16 v[32:35], a[64:67], a[4:7], v[32:35]
  ds_read_b64_tr_b16 a[64:65], v242 offset:16384
  v_mfma_f32_16x16x32_bf16 v[20:23], a[68:71], a[0:3], v[20:23]
  ds_read_b64_tr_b16 a[66:67], v242 offset:20480
  v_mfma_f32_16x16x32_bf16 v[36:39], a[68:71], a[4:7], v[36:39]
  ds_read_b64_tr_b16 a[68:69], v243 offset:16384
  v_mfma_f32_16x16x32_bf16 v[24:27], a[72:75], a[0:3], v[24:27]
  ds_read_b64_tr_b16 a[70:71], v243 offset:20480
  buffer_load_dwordx4 a[52:55], v240, s[4:7], s16 offen offset:1024 sc1
  v_mfma_f32_16x16x32_bf16 v[40:43], a[72:75], a[4:7], v[40:43]
  ds_read_b64_tr_b16 a[72:73], v244 offset:16384
  s_waitcnt lgkmcnt(10)
  v_mfma_f32_16x16x32_bf16 v[28:31], a[76:79], a[0:3], v[28:31]
  ds_read_b64_tr_b16 a[74:75], v244 offset:20480
  v_mfma_f32_16x16x32_bf16 v[44:47], a[76:79], a[4:7], v[44:47]
  ds_read_b64_tr_b16 a[76:77], v245 offset:16384
  buffer_load_dwordx4 a[56:59], v241, s[4:7], s16 offen offset:0 sc1
  v_mfma_f32_16x16x32_bf16 v[16:19], a[96:99], a[8:11], v[16:19]
  ds_read_b64_tr_b16 a[78:79], v245 offset:20480
  v_mfma_f32_16x16x32_bf16 v[32:35], a[96:99], a[12:15], v[32:35]
  ds_read_b64_tr_b16 a[96:97], v242 offset:24576
  v_mfma_f32_16x16x32_bf16 v[20:23], a[100:103], a[8:11], v[20:23]
  ds_read_b64_tr_b16 a[98:99], v242 offset:28672
  v_mfma_f32_16x16x32_bf16 v[36:39], a[100:103], a[12:15], v[36:39]
  ds_read_b64_tr_b16 a[100:101], v243 offset:24576
  buffer_load_dwordx4 a[60:63], v241, s[4:7], s16 offen offset:1024 sc1
  s_add_u32 s16, s16, 262144
  v_mfma_f32_16x16x32_bf16 v[24:27], a[104:107], a[8:11], v[24:27]
  ds_read_b64_tr_b16 a[102:103], v243 offset:28672
  v_mfma_f32_16x16x32_bf16 v[40:43], a[104:107], a[12:15], v[40:43]
  ds_read_b64_tr_b16 a[104:105], v244 offset:24576
  v_mfma_f32_16x16x32_bf16 v[28:31], a[108:111], a[8:11], v[28:31]
  ds_read_b64_tr_b16 a[106:107], v244 offset:28672
  v_mfma_f32_16x16x32_bf16 v[44:47], a[108:111], a[12:15], v[44:47]
  ds_read_b64_tr_b16 a[108:109], v245 offset:24576
  ds_read_b64_tr_b16 a[110:111], v245 offset:28672
  s_waitcnt vmcnt(13) lgkmcnt(10)
  s_barrier
  s_add_u32 m0, s38, 0
  s_nop 0
  buffer_load_dwordx4 v225, s[8:11], s17 offen lds
  v_mfma_f32_16x16x32_bf16 v[72:75], a[80:83], a[16:19], v[72:75]
  v_mfma_f32_16x16x32_bf16 v[88:91], a[80:83], a[20:23], v[88:91]
  ds_read_b64_tr_b16 a[80:81], v242 offset:34816
  v_mfma_f32_16x16x32_bf16 v[76:79], a[84:87], a[16:19], v[76:79]
  ds_read_b64_tr_b16 a[82:83], v242 offset:38912
  buffer_load_dwordx4 v226, s[8:11], s17 offen offset:1024 lds
  v_mfma_f32_16x16x32_bf16 v[92:95], a[84:87], a[20:23], v[92:95]
  ds_read_b64_tr_b16 a[84:85], v243 offset:34816
  v_mfma_f32_16x16x32_bf16 v[80:83], a[88:91], a[16:19], v[80:83]
  ds_read_b64_tr_b16 a[86:87], v243 offset:38912
  v_mfma_f32_16x16x32_bf16 v[96:99], a[88:91], a[20:23], v[96:99]
  ds_read_b64_tr_b16 a[88:89], v244 offset:34816
  v_mfma_f32_16x16x32_bf16 v[84:87], a[92:95], a[16:19], v[84:87]
  ds_read_b64_tr_b16 a[90:91], v244 offset:38912
  buffer_load_dwordx4 v227, s[8:11], s17 offen offset:2048 lds
  v_mfma_f32_16x16x32_bf16 v[100:103], a[92:95], a[20:23], v[100:103]
  ds_read_b64_tr_b16 a[92:93], v245 offset:34816
  v_mfma_f32_16x16x32_bf16 v[72:75], a[112:115], a[24:27], v[72:75]
  ds_read_b64_tr_b16 a[94:95], v245 offset:38912
  v_mfma_f32_16x16x32_bf16 v[88:91], a[112:115], a[28:31], v[88:91]
  ds_read_b64_tr_b16 a[112:113], v242 offset:43008
  buffer_load_dwordx4 v228, s[8:11], s17 offen offset:3072 lds
  s_add_u32 s17, s17, 458752
  v_mfma_f32_16x16x32_bf16 v[76:79], a[116:119], a[24:27], v[76:79]
  ds_read_b64_tr_b16 a[114:115], v242 offset:47104
  v_mfma_f32_16x16x32_bf16 v[92:95], a[116:119], a[28:31], v[92:95]
  ds_read_b64_tr_b16 a[116:117], v243 offset:43008
  v_mfma_f32_16x16x32_bf16 v[80:83], a[120:123], a[24:27], v[80:83]
  ds_read_b64_tr_b16 a[118:119], v243 offset:47104
  v_mfma_f32_16x16x32_bf16 v[96:99], a[120:123], a[28:31], v[96:99]
  ds_read_b64_tr_b16 a[120:121], v244 offset:43008
  buffer_load_dword v251, v255, s[8:11], s96 offen
  s_sub_u32 s96, s96, 3145728
  v_mfma_f32_16x16x32_bf16 v[84:87], a[124:127], a[24:27], v[84:87]
  ds_read_b64_tr_b16 a[122:123], v244 offset:47104
  v_mfma_f32_16x16x32_bf16 v[100:103], a[124:127], a[28:31], v[100:103]
  ds_read_b64_tr_b16 a[124:125], v245 offset:43008
  v_mfma_f32_16x16x32_bf16 v[16:19], a[64:67], a[16:19], v[16:19]
  ds_read_b64_tr_b16 a[126:127], v245 offset:47104
  buffer_load_dwordx4 a[0:3], v240, s[4:7], s16 offen offset:0 sc1
  v_mfma_f32_16x16x32_bf16 v[32:35], a[64:67], a[20:23], v[32:35]
  ds_read_b64_tr_b16 a[64:65], v242 offset:32768
  v_mfma_f32_16x16x32_bf16 v[20:23], a[68:71], a[16:19], v[20:23]
  ds_read_b64_tr_b16 a[66:67], v242 offset:36864
  v_mfma_f32_16x16x32_bf16 v[36:39], a[68:71], a[20:23], v[36:39]
  ds_read_b64_tr_b16 a[68:69], v243 offset:32768
  v_mfma_f32_16x16x32_bf16 v[24:27], a[72:75], a[16:19], v[24:27]
  ds_read_b64_tr_b16 a[70:71], v243 offset:36864
  buffer_load_dwordx4 a[4:7], v240, s[4:7], s16 offen offset:1024 sc1
  v_mfma_f32_16x16x32_bf16 v[40:43], a[72:75], a[20:23], v[40:43]
  ds_read_b64_tr_b16 a[72:73], v244 offset:32768
  s_waitcnt lgkmcnt(10)
  v_mfma_f32_16x16x32_bf16 v[28:31], a[76:79], a[16:19], v[28:31]
  ds_read_b64_tr_b16 a[74:75], v244 offset:36864
  v_mfma_f32_16x16x32_bf16 v[44:47], a[76:79], a[20:23], v[44:47]
  ds_read_b64_tr_b16 a[76:77], v245 offset:32768
  buffer_load_dwordx4 a[8:11], v241, s[4:7], s16 offen offset:0 sc1
  v_mfma_f32_16x16x32_bf16 v[16:19], a[96:99], a[24:27], v[16:19]
  ds_read_b64_tr_b16 a[78:79], v245 offset:36864
  v_mfma_f32_16x16x32_bf16 v[32:35], a[96:99], a[28:31], v[32:35]
  ds_read_b64_tr_b16 a[96:97], v242 offset:40960
  v_mfma_f32_16x16x32_bf16 v[20:23], a[100:103], a[24:27], v[20:23]
  ds_read_b64_tr_b16 a[98:99], v242 offset:45056
  v_mfma_f32_16x16x32_bf16 v[36:39], a[100:103], a[28:31], v[36:39]
  ds_read_b64_tr_b16 a[100:101], v243 offset:40960
  buffer_load_dwordx4 a[12:15], v241, s[4:7], s16 offen offset:1024 sc1
  s_add_u32 s16, s16, 262144
  v_mfma_f32_16x16x32_bf16 v[24:27], a[104:107], a[24:27], v[24:27]
  ds_read_b64_tr_b16 a[102:103], v243 offset:45056
  v_mfma_f32_16x16x32_bf16 v[40:43], a[104:107], a[28:31], v[40:43]
  ds_read_b64_tr_b16 a[104:105], v244 offset:40960
  v_mfma_f32_16x16x32_bf16 v[28:31], a[108:111], a[24:27], v[28:31]
  ds_read_b64_tr_b16 a[106:107], v244 offset:45056
  v_mfma_f32_16x16x32_bf16 v[44:47], a[108:111], a[28:31], v[44:47]
  ds_read_b64_tr_b16 a[108:109], v245 offset:40960
  ds_read_b64_tr_b16 a[110:111], v245 offset:45056
  s_waitcnt vmcnt(13) lgkmcnt(10)
  s_barrier
  s_add_u32 m0, s38, 16384
  s_nop 0
  buffer_load_dwordx4 v225, s[8:11], s17 offen lds
  v_mfma_f32_16x16x32_bf16 v[72:75], a[80:83], a[32:35], v[72:75]
  v_mfma_f32_16x16x32_bf16 v[88:91], a[80:83], a[36:39], v[88:91]
  ds_read_b64_tr_b16 a[80:81], v242 offset:51200
  v_mfma_f32_16x16x32_bf16 v[76:79], a[84:87], a[32:35], v[76:79]
  ds_read_b64_tr_b16 a[82:83], v242 offset:55296
  buffer_load_dwordx4 v226, s[8:11], s17 offen offset:1024 lds
  v_mfma_f32_16x16x32_bf16 v[92:95], a[84:87], a[36:39], v[92:95]
  ds_read_b64_tr_b16 a[84:85], v243 offset:51200
  v_mfma_f32_16x16x32_bf16 v[80:83], a[88:91], a[32:35], v[80:83]
  ds_read_b64_tr_b16 a[86:87], v243 offset:55296
  v_mfma_f32_16x16x32_bf16 v[96:99], a[88:91], a[36:39], v[96:99]
  ds_read_b64_tr_b16 a[88:89], v244 offset:51200
  v_mfma_f32_16x16x32_bf16 v[84:87], a[92:95], a[32:35], v[84:87]
  ds_read_b64_tr_b16 a[90:91], v244 offset:55296
  buffer_load_dwordx4 v227, s[8:11], s17 offen offset:2048 lds
  v_mfma_f32_16x16x32_bf16 v[100:103], a[92:95], a[36:39], v[100:103]
  ds_read_b64_tr_b16 a[92:93], v245 offset:51200
  v_mfma_f32_16x16x32_bf16 v[72:75], a[112:115], a[40:43], v[72:75]
  ds_read_b64_tr_b16 a[94:95], v245 offset:55296
  v_mfma_f32_16x16x32_bf16 v[88:91], a[112:115], a[44:47], v[88:91]
  ds_read_b64_tr_b16 a[112:113], v242 offset:59392
  buffer_load_dwordx4 v228, s[8:11], s17 offen offset:3072 lds
  s_add_u32 s17, s17, 458752
  v_mfma_f32_16x16x32_bf16 v[76:79], a[116:119], a[40:43], v[76:79]
  ds_read_b64_tr_b16 a[114:115], v242 offset:63488
  v_mfma_f32_16x16x32_bf16 v[92:95], a[116:119], a[44:47], v[92:95]
  ds_read_b64_tr_b16 a[116:117], v243 offset:59392
  v_mfma_f32_16x16x32_bf16 v[80:83], a[120:123], a[40:43], v[80:83]
  ds_read_b64_tr_b16 a[118:119], v243 offset:63488
  v_mfma_f32_16x16x32_bf16 v[96:99], a[120:123], a[44:47], v[96:99]
  ds_read_b64_tr_b16 a[120:121], v244 offset:59392
  buffer_load_dword v251, v255, s[8:11], s96 offen
  s_add_u32 s96, s96, 458752
  v_mfma_f32_16x16x32_bf16 v[84:87], a[124:127], a[40:43], v[84:87]
  ds_read_b64_tr_b16 a[122:123], v244 offset:63488
  v_mfma_f32_16x16x32_bf16 v[100:103], a[124:127], a[44:47], v[100:103]
  ds_read_b64_tr_b16 a[124:125], v245 offset:59392
  v_mfma_f32_16x16x32_bf16 v[16:19], a[64:67], a[32:35], v[16:19]
  ds_read_b64_tr_b16 a[126:127], v245 offset:63488
  buffer_load_dwordx4 a[16:19], v240, s[4:7], s16 offen offset:0 sc1
  v_mfma_f32_16x16x32_bf16 v[32:35], a[64:67], a[36:39], v[32:35]
  ds_read_b64_tr_b16 a[64:65], v242 offset:49152
  v_mfma_f32_16x16x32_bf16 v[20:23], a[68:71], a[32:35], v[20:23]
  ds_read_b64_tr_b16 a[66:67], v242 offset:53248
  v_mfma_f32_16x16x32_bf16 v[36:39], a[68:71], a[36:39], v[36:39]
  ds_read_b64_tr_b16 a[68:69], v243 offset:49152
  v_mfma_f32_16x16x32_bf16 v[24:27], a[72:75], a[32:35], v[24:27]
  ds_read_b64_tr_b16 a[70:71], v243 offset:53248
  buffer_load_dwordx4 a[20:23], v240, s[4:7], s16 offen offset:1024 sc1
  v_mfma_f32_16x16x32_bf16 v[40:43], a[72:75], a[36:39], v[40:43]
  ds_read_b64_tr_b16 a[72:73], v244 offset:49152
  s_waitcnt lgkmcnt(10)
  v_mfma_f32_16x16x32_bf16 v[28:31], a[76:79], a[32:35], v[28:31]
  ds_read_b64_tr_b16 a[74:75], v244 offset:53248
  v_mfma_f32_16x16x32_bf16 v[44:47], a[76:79], a[36:39], v[44:47]
  ds_read_b64_tr_b16 a[76:77], v245 offset:49152
  buffer_load_dwordx4 a[24:27], v241, s[4:7], s16 offen offset:0 sc1
  v_mfma_f32_16x16x32_bf16 v[16:19], a[96:99], a[40:43], v[16:19]
  ds_read_b64_tr_b16 a[78:79], v245 offset:53248
  v_mfma_f32_16x16x32_bf16 v[32:35], a[96:99], a[44:47], v[32:35]
  ds_read_b64_tr_b16 a[96:97], v242 offset:57344
  v_mfma_f32_16x16x32_bf16 v[20:23], a[100:103], a[40:43], v[20:23]
  ds_read_b64_tr_b16 a[98:99], v242 offset:61440
  v_mfma_f32_16x16x32_bf16 v[36:39], a[100:103], a[44:47], v[36:39]
  ds_read_b64_tr_b16 a[100:101], v243 offset:57344
  buffer_load_dwordx4 a[28:31], v241, s[4:7], s16 offen offset:1024 sc1
  s_add_u32 s16, s16, 262144
  v_mfma_f32_16x16x32_bf16 v[24:27], a[104:107], a[40:43], v[24:27]
  ds_read_b64_tr_b16 a[102:103], v243 offset:61440
  v_mfma_f32_16x16x32_bf16 v[40:43], a[104:107], a[44:47], v[40:43]
  ds_read_b64_tr_b16 a[104:105], v244 offset:57344
  v_mfma_f32_16x16x32_bf16 v[28:31], a[108:111], a[40:43], v[28:31]
  ds_read_b64_tr_b16 a[106:107], v244 offset:61440
  v_mfma_f32_16x16x32_bf16 v[44:47], a[108:111], a[44:47], v[44:47]
  ds_read_b64_tr_b16 a[108:109], v245 offset:57344
  ds_read_b64_tr_b16 a[110:111], v245 offset:61440
  s_waitcnt vmcnt(13) lgkmcnt(10)
  s_barrier
  s_add_u32 m0, s38, 32768
  s_nop 0
  buffer_load_dwordx4 v225, s[8:11], s17 offen lds
  v_mfma_f32_16x16x32_bf16 v[72:75], a[80:83], a[48:51], v[72:75]
  v_mfma_f32_16x16x32_bf16 v[88:91], a[80:83], a[52:55], v[88:91]
  ds_read_b64_tr_b16 a[80:81], v242 offset:2048
  v_mfma_f32_16x16x32_bf16 v[76:79], a[84:87], a[48:51], v[76:79]
  ds_read_b64_tr_b16 a[82:83], v242 offset:6144
  buffer_load_dwordx4 v226, s[8:11], s17 offen offset:1024 lds
  v_mfma_f32_16x16x32_bf16 v[92:95], a[84:87], a[52:55], v[92:95]
  ds_read_b64_tr_b16 a[84:85], v243 offset:2048
  v_mfma_f32_16x16x32_bf16 v[80:83], a[88:91], a[48:51], v[80:83]
  ds_read_b64_tr_b16 a[86:87], v243 offset:6144
  v_mfma_f32_16x16x32_bf16 v[96:99], a[88:91], a[52:55], v[96:99]
  ds_read_b64_tr_b16 a[88:89], v244 offset:2048
  v_mfma_f32_16x16x32_bf16 v[84:87], a[92:95], a[48:51], v[84:87]
  ds_read_b64_tr_b16 a[90:91], v244 offset:6144
  buffer_load_dwordx4 v227, s[8:11], s17 offen offset:2048 lds
  v_mfma_f32_16x16x32_bf16 v[100:103], a[92:95], a[52:55], v[100:103]
  ds_read_b64_tr_b16 a[92:93], v245 offset:2048
  v_mfma_f32_16x16x32_bf16 v[72:75], a[112:115], a[56:59], v[72:75]
  ds_read_b64_tr_b16 a[94:95], v245 offset:6144
  v_mfma_f32_16x16x32_bf16 v[88:91], a[112:115], a[60:63], v[88:91]
  ds_read_b64_tr_b16 a[112:113], v242 offset:10240
  buffer_load_dwordx4 v228, s[8:11], s17 offen offset:3072 lds
  s_add_u32 s17, s17, 458752
  v_mfma_f32_16x16x32_bf16 v[76:79], a[116:119], a[56:59], v[76:79]
  ds_read_b64_tr_b16 a[114:115], v242 offset:14336
  v_mfma_f32_16x16x32_bf16 v[92:95], a[116:119], a[60:63], v[92:95]
  ds_read_b64_tr_b16 a[116:117], v243 offset:10240
  v_mfma_f32_16x16x32_bf16 v[80:83], a[120:123], a[56:59], v[80:83]
  ds_read_b64_tr_b16 a[118:119], v243 offset:14336
  v_mfma_f32_16x16x32_bf16 v[96:99], a[120:123], a[60:63], v[96:99]
  ds_read_b64_tr_b16 a[120:121], v244 offset:10240
  buffer_load_dword v251, v255, s[8:11], s96 offen
  s_add_u32 s96, s96, 458752
  v_mfma_f32_16x16x32_bf16 v[84:87], a[124:127], a[56:59], v[84:87]
  ds_read_b64_tr_b16 a[122:123], v244 offset:14336
  v_mfma_f32_16x16x32_bf16 v[100:103], a[124:127], a[60:63], v[100:103]
  ds_read_b64_tr_b16 a[124:125], v245 offset:10240
  buffer_load_dword v247, v246, s[56:59], s94 offen sc1
  v_mfma_f32_16x16x32_bf16 v[16:19], a[64:67], a[48:51], v[16:19]
  ds_read_b64_tr_b16 a[126:127], v245 offset:14336
  buffer_load_dwordx4 a[32:35], v240, s[4:7], s16 offen offset:0 sc1
  v_mfma_f32_16x16x32_bf16 v[32:35], a[64:67], a[52:55], v[32:35]
  ds_read_b64_tr_b16 a[64:65], v242 offset:0
  v_mfma_f32_16x16x32_bf16 v[20:23], a[68:71], a[48:51], v[20:23]
  ds_read_b64_tr_b16 a[66:67], v242 offset:4096
  v_mfma_f32_16x16x32_bf16 v[36:39], a[68:71], a[52:55], v[36:39]
  ds_read_b64_tr_b16 a[68:69], v243 offset:0
  v_mfma_f32_16x16x32_bf16 v[24:27], a[72:75], a[48:51], v[24:27]
  ds_read_b64_tr_b16 a[70:71], v243 offset:4096
  buffer_load_dwordx4 a[36:39], v240, s[4:7], s16 offen offset:1024 sc1
  v_mfma_f32_16x16x32_bf16 v[40:43], a[72:75], a[52:55], v[40:43]
  ds_read_b64_tr_b16 a[72:73], v244 offset:0
  s_waitcnt lgkmcnt(10)
  v_mfma_f32_16x16x32_bf16 v[28:31], a[76:79], a[48:51], v[28:31]
  ds_read_b64_tr_b16 a[74:75], v244 offset:4096
  v_mfma_f32_16x16x32_bf16 v[44:47], a[76:79], a[52:55], v[44:47]
  ds_read_b64_tr_b16 a[76:77], v245 offset:0
  buffer_load_dwordx4 a[40:43], v241, s[4:7], s16 offen offset:0 sc1
  v_mfma_f32_16x16x32_bf16 v[16:19], a[96:99], a[56:59], v[16:19]
  ds_read_b64_tr_b16 a[78:79], v245 offset:4096
  v_mfma_f32_16x16x32_bf16 v[32:35], a[96:99], a[60:63], v[32:35]
  ds_read_b64_tr_b16 a[96:97], v242 offset:8192
  v_mfma_f32_16x16x32_bf16 v[20:23], a[100:103], a[56:59], v[20:23]
  ds_read_b64_tr_b16 a[98:99], v242 offset:12288
  v_mfma_f32_16x16x32_bf16 v[36:39], a[100:103], a[60:63], v[36:39]
  ds_read_b64_tr_b16 a[100:101], v243 offset:8192
  buffer_load_dwordx4 a[44:47], v241, s[4:7], s16 offen offset:1024 sc1
  s_add_u32 s16, s16, 262144
  v_mfma_f32_16x16x32_bf16 v[24:27], a[104:107], a[56:59], v[24:27]
  ds_read_b64_tr_b16 a[102:103], v243 offset:12288
  v_mfma_f32_16x16x32_bf16 v[40:43], a[104:107], a[60:63], v[40:43]
  ds_read_b64_tr_b16 a[104:105], v244 offset:8192
  v_mfma_f32_16x16x32_bf16 v[28:31], a[108:111], a[56:59], v[28:31]
  ds_read_b64_tr_b16 a[106:107], v244 offset:12288
  v_mfma_f32_16x16x32_bf16 v[44:47], a[108:111], a[60:63], v[44:47]
  ds_read_b64_tr_b16 a[108:109], v245 offset:8192
  ds_read_b64_tr_b16 a[110:111], v245 offset:12288
  s_waitcnt vmcnt(14) lgkmcnt(10)
  s_barrier
  s_add_u32 m0, s38, 49152
  s_nop 0
  buffer_load_dwordx4 v225, s[8:11], s17 offen lds
  v_mfma_f32_16x16x32_bf16 v[72:75], a[80:83], a[0:3], v[72:75]
  v_mfma_f32_16x16x32_bf16 v[88:91], a[80:83], a[4:7], v[88:91]
  ds_read_b64_tr_b16 a[80:81], v242 offset:18432
  v_mfma_f32_16x16x32_bf16 v[76:79], a[84:87], a[0:3], v[76:79]
  ds_read_b64_tr_b16 a[82:83], v242 offset:22528
  buffer_load_dwordx4 v226, s[8:11], s17 offen offset:1024 lds
  v_mfma_f32_16x16x32_bf16 v[92:95], a[84:87], a[4:7], v[92:95]
  ds_read_b64_tr_b16 a[84:85], v243 offset:18432
  v_mfma_f32_16x16x32_bf16 v[80:83], a[88:91], a[0:3], v[80:83]
  ds_read_b64_tr_b16 a[86:87], v243 offset:22528
  v_mfma_f32_16x16x32_bf16 v[96:99], a[88:91], a[4:7], v[96:99]
  ds_read_b64_tr_b16 a[88:89], v244 offset:18432
  v_mfma_f32_16x16x32_bf16 v[84:87], a[92:95], a[0:3], v[84:87]
  ds_read_b64_tr_b16 a[90:91], v244 offset:22528
  buffer_load_dwordx4 v227, s[8:11], s17 offen offset:2048 lds
  v_mfma_f32_16x16x32_bf16 v[100:103], a[92:95], a[4:7], v[100:103]
  ds_read_b64_tr_b16 a[92:93], v245 offset:18432
  v_mfma_f32_16x16x32_bf16 v[72:75], a[112:115], a[8:11], v[72:75]
  ds_read_b64_tr_b16 a[94:95], v245 offset:22528
  v_mfma_f32_16x16x32_bf16 v[88:91], a[112:115], a[12:15], v[88:91]
  ds_read_b64_tr_b16 a[112:113], v242 offset:26624
  buffer_load_dwordx4 v228, s[8:11], s17 offen offset:3072 lds
  s_sub_u32 s17, s17, 3145728
  v_mfma_f32_16x16x32_bf16 v[76:79], a[116:119], a[8:11], v[76:79]
  ds_read_b64_tr_b16 a[114:115], v242 offset:30720
  v_mfma_f32_16x16x32_bf16 v[92:95], a[116:119], a[12:15], v[92:95]
  ds_read_b64_tr_b16 a[116:117], v243 offset:26624
  v_mfma_f32_16x16x32_bf16 v[80:83], a[120:123], a[8:11], v[80:83]
  ds_read_b64_tr_b16 a[118:119], v243 offset:30720
  v_mfma_f32_16x16x32_bf16 v[96:99], a[120:123], a[12:15], v[96:99]
  ds_read_b64_tr_b16 a[120:121], v244 offset:26624
  buffer_load_dword v251, v255, s[8:11], s96 offen
  s_add_u32 s96, s96, 458752
  v_mfma_f32_16x16x32_bf16 v[84:87], a[124:127], a[8:11], v[84:87]
  ds_read_b64_tr_b16 a[122:123], v244 offset:30720
  v_mfma_f32_16x16x32_bf16 v[100:103], a[124:127], a[12:15], v[100:103]
  ds_read_b64_tr_b16 a[124:125], v245 offset:26624
  v_mfma_f32_16x16x32_bf16 v[16:19], a[64:67], a[0:3], v[16:19]
  ds_read_b64_tr_b16 a[126:127], v245 offset:30720
  buffer_load_dwordx4 a[48:51], v240, s[4:7], s16 offen offset:0 sc1
  v_mfma_f32_16x16x32_bf16 v[32:35], a[64:67], a[4:7], v[32:35]
  ds_read_b64_tr_b16 a[64:65], v242 offset:16384
  v_mfma_f32_16x16x32_bf16 v[20:23], a[68:71], a[0:3], v[20:23]
  ds_read_b64_tr_b16 a[66:67], v242 offset:20480
  v_mfma_f32_16x16x32_bf16 v[36:39], a[68:71], a[4:7], v[36:39]
  ds_read_b64_tr_b16 a[68:69], v243 offset:16384
  v_mfma_f32_16x16x32_bf16 v[24:27], a[72:75], a[0:3], v[24:27]
  ds_read_b64_tr_b16 a[70:71], v243 offset:20480
  buffer_load_dwordx4 a[52:55], v240, s[4:7], s16 offen offset:1024 sc1
  v_mfma_f32_16x16x32_bf16 v[40:43], a[72:75], a[4:7], v[40:43]
  ds_read_b64_tr_b16 a[72:73], v244 offset:16384
  s_waitcnt lgkmcnt(10)
  v_mfma_f32_16x16x32_bf16 v[28:31], a[76:79], a[0:3], v[28:31]
  ds_read_b64_tr_b16 a[74:75], v244 offset:20480
  v_mfma_f32_16x16x32_bf16 v[44:47], a[76:79], a[4:7], v[44:47]
  ds_read_b64_tr_b16 a[76:77], v245 offset:16384
  buffer_load_dwordx4 a[56:59], v241, s[4:7], s16 offen offset:0 sc1
  v_mfma_f32_16x16x32_bf16 v[16:19], a[96:99], a[8:11], v[16:19]
  ds_read_b64_tr_b16 a[78:79], v245 offset:20480
  v_mfma_f32_16x16x32_bf16 v[32:35], a[96:99], a[12:15], v[32:35]
  ds_read_b64_tr_b16 a[96:97], v242 offset:24576
  v_mfma_f32_16x16x32_bf16 v[20:23], a[100:103], a[8:11], v[20:23]
  ds_read_b64_tr_b16 a[98:99], v242 offset:28672
  v_mfma_f32_16x16x32_bf16 v[36:39], a[100:103], a[12:15], v[36:39]
  ds_read_b64_tr_b16 a[100:101], v243 offset:24576
  buffer_load_dwordx4 a[60:63], v241, s[4:7], s16 offen offset:1024 sc1
  s_add_u32 s16, s16, 262144
  v_mfma_f32_16x16x32_bf16 v[24:27], a[104:107], a[8:11], v[24:27]
  ds_read_b64_tr_b16 a[102:103], v243 offset:28672
  v_mfma_f32_16x16x32_bf16 v[40:43], a[104:107], a[12:15], v[40:43]
  ds_read_b64_tr_b16 a[104:105], v244 offset:24576
  v_mfma_f32_16x16x32_bf16 v[28:31], a[108:111], a[8:11], v[28:31]
  ds_read_b64_tr_b16 a[106:107], v244 offset:28672
  v_mfma_f32_16x16x32_bf16 v[44:47], a[108:111], a[12:15], v[44:47]
  ds_read_b64_tr_b16 a[108:109], v245 offset:24576
  ds_read_b64_tr_b16 a[110:111], v245 offset:28672
  s_waitcnt vmcnt(13) lgkmcnt(10)
  s_barrier
  v_cmp_ne_u32 vcc, 1, v247
  s_nop 1
  s_cmp_lg_u64 vcc, 0
  s_cbranch_scc1 L_slow_37
  L_back_38:
  s_add_u32 s94, s94, 65536
  s_add_u32 m0, s38, 0
  s_nop 0
  buffer_load_dwordx4 v225, s[8:11], s17 offen lds
  v_mfma_f32_16x16x32_bf16 v[72:75], a[80:83], a[16:19], v[72:75]
  v_mfma_f32_16x16x32_bf16 v[88:91], a[80:83], a[20:23], v[88:91]
  ds_read_b64_tr_b16 a[80:81], v242 offset:34816
  v_mfma_f32_16x16x32_bf16 v[76:79], a[84:87], a[16:19], v[76:79]
  ds_read_b64_tr_b16 a[82:83], v242 offset:38912
  buffer_load_dwordx4 v226, s[8:11], s17 offen offset:1024 lds
  v_mfma_f32_16x16x32_bf16 v[92:95], a[84:87], a[20:23], v[92:95]
  ds_read_b64_tr_b16 a[84:85], v243 offset:34816
  v_mfma_f32_16x16x32_bf16 v[80:83], a[88:91], a[16:19], v[80:83]
  ds_read_b64_tr_b16 a[86:87], v243 offset:38912
  v_mfma_f32_16x16x32_bf16 v[96:99], a[88:91], a[20:23], v[96:99]
  ds_read_b64_tr_b16 a[88:89], v244 offset:34816
  v_mfma_f32_16x16x32_bf16 v[84:87], a[92:95], a[16:19], v[84:87]
  ds_read_b64_tr_b16 a[90:91], v244 offset:38912
  buffer_load_dwordx4 v227, s[8:11], s17 offen offset:2048 lds
  v_mfma_f32_16x16x32_bf16 v[100:103], a[92:95], a[20:23], v[100:103]
  ds_read_b64_tr_b16 a[92:93], v245 offset:34816
  v_mfma_f32_16x16x32_bf16 v[72:75], a[112:115], a[24:27], v[72:75]
  ds_read_b64_tr_b16 a[94:95], v245 offset:38912
  v_mfma_f32_16x16x32_bf16 v[88:91], a[112:115], a[28:31], v[88:91]
  ds_read_b64_tr_b16 a[112:113], v242 offset:43008
  buffer_load_dwordx4 v228, s[8:11], s17 offen offset:3072 lds
  s_add_u32 s17, s17, 458752
  v_mfma_f32_16x16x32_bf16 v[76:79], a[116:119], a[24:27], v[76:79]
  ds_read_b64_tr_b16 a[114:115], v242 offset:47104
  v_mfma_f32_16x16x32_bf16 v[92:95], a[116:119], a[28:31], v[92:95]
  ds_read_b64_tr_b16 a[116:117], v243 offset:43008
  v_mfma_f32_16x16x32_bf16 v[80:83], a[120:123], a[24:27], v[80:83]
  ds_read_b64_tr_b16 a[118:119], v243 offset:47104
  v_mfma_f32_16x16x32_bf16 v[96:99], a[120:123], a[28:31], v[96:99]
  ds_read_b64_tr_b16 a[120:121], v244 offset:43008
  buffer_load_dword v251, v255, s[8:11], s96 offen
  s_add_u32 s96, s96, 458752
  v_mfma_f32_16x16x32_bf16 v[84:87], a[124:127], a[24:27], v[84:87]
  ds_read_b64_tr_b16 a[122:123], v244 offset:47104
  v_mfma_f32_16x16x32_bf16 v[100:103], a[124:127], a[28:31], v[100:103]
  ds_read_b64_tr_b16 a[124:125], v245 offset:43008
  v_mfma_f32_16x16x32_bf16 v[16:19], a[64:67], a[16:19], v[16:19]
  ds_read_b64_tr_b16 a[126:127], v245 offset:47104
  buffer_load_dwordx4 a[0:3], v240, s[4:7], s16 offen offset:0 sc1
  v_mfma_f32_16x16x32_bf16 v[32:35], a[64:67], a[20:23], v[32:35]
  ds_read_b64_tr_b16 a[64:65], v242 offset:32768
  v_mfma_f32_16x16x32_bf16 v[20:23], a[68:71], a[16:19], v[20:23]
  ds_read_b64_tr_b16 a[66:67], v242 offset:36864
  v_mfma_f32_16x16x32_bf16 v[36:39], a[68:71], a[20:23], v[36:39]
  ds_read_b64_tr_b16 a[68:69], v243 offset:32768
  v_mfma_f32_16x16x32_bf16 v[24:27], a[72:75], a[16:19], v[24:27]
  ds_read_b64_tr_b16 a[70:71], v243 offset:36864
  buffer_load_dwordx4 a[4:7], v240, s[4:7], s16 offen offset:1024 sc1
  v_mfma_f32_16x16x32_bf16 v[40:43], a[72:75], a[20:23], v[40:43]
  ds_read_b64_tr_b16 a[72:73], v244 offset:32768
  s_waitcnt lgkmcnt(10)
  v_mfma_f32_16x16x32_bf16 v[28:31], a[76:79], a[16:19], v[28:31]
  ds_read_b64_tr_b16 a[74:75], v244 offset:36864
  v_mfma_f32_16x16x32_bf16 v[44:47], a[76:79], a[20:23], v[44:47]
  ds_read_b64_tr_b16 a[76:77], v245 offset:32768
  buffer_load_dwordx4 a[8:11], v241, s[4:7], s16 offen offset:0 sc1
  v_mfma_f32_16x16x32_bf16 v[16:19], a[96:99], a[24:27], v[16:19]
  ds_read_b64_tr_b16 a[78:79], v245 offset:36864
  v_mfma_f32_16x16x32_bf16 v[32:35], a[96:99], a[28:31], v[32:35]
  ds_read_b64_tr_b16 a[96:97], v242 offset:40960
  v_mfma_f32_16x16x32_bf16 v[20:23], a[100:103], a[24:27], v[20:23]
  ds_read_b64_tr_b16 a[98:99], v242 offset:45056
  v_mfma_f32_16x16x32_bf16 v[36:39], a[100:103], a[28:31], v[36:39]
  ds_read_b64_tr_b16 a[100:101], v243 offset:40960
  buffer_load_dwordx4 a[12:15], v241, s[4:7], s16 offen offset:1024 sc1
  s_add_u32 s16, s16, 262144
  v_mfma_f32_16x16x32_bf16 v[24:27], a[104:107], a[24:27], v[24:27]
  ds_read_b64_tr_b16 a[102:103], v243 offset:45056
  v_mfma_f32_16x16x32_bf16 v[40:43], a[104:107], a[28:31], v[40:43]
  ds_read_b64_tr_b16 a[104:105], v244 offset:40960
  v_mfma_f32_16x16x32_bf16 v[28:31], a[108:111], a[24:27], v[28:31]
  ds_read_b64_tr_b16 a[106:107], v244 offset:45056
  v_mfma_f32_16x16x32_bf16 v[44:47], a[108:111], a[28:31], v[44:47]
  ds_read_b64_tr_b16 a[108:109], v245 offset:40960
  ds_read_b64_tr_b16 a[110:111], v245 offset:45056
  s_waitcnt vmcnt(13) lgkmcnt(10)
  s_barrier
  s_add_u32 m0, s38, 16384
  s_nop 0
  buffer_load_dwordx4 v225, s[8:11], s17 offen lds
  v_mfma_f32_16x16x32_bf16 v[72:75], a[80:83], a[32:35], v[72:75]
  v_mfma_f32_16x16x32_bf16 v[88:91], a[80:83], a[36:39], v[88:91]
  ds_read_b64_tr_b16 a[80:81], v242 offset:51200
  v_mfma_f32_16x16x32_bf16 v[76:79], a[84:87], a[32:35], v[76:79]
  ds_read_b64_tr_b16 a[82:83], v242 offset:55296
  buffer_load_dwordx4 v226, s[8:11], s17 offen offset:1024 lds
  v_mfma_f32_16x16x32_bf16 v[92:95], a[84:87], a[36:39], v[92:95]
  ds_read_b64_tr_b16 a[84:85], v243 offset:51200
  v_mfma_f32_16x16x32_bf16 v[80:83], a[88:91], a[32:35], v[80:83]
  ds_read_b64_tr_b16 a[86:87], v243 offset:55296
  v_mfma_f32_16x16x32_bf16 v[96:99], a[88:91], a[36:39], v[96:99]
  ds_read_b64_tr_b16 a[88:89], v244 offset:51200
  v_mfma_f32_16x16x32_bf16 v[84:87], a[92:95], a[32:35], v[84:87]
  ds_read_b64_tr_b16 a[90:91], v244 offset:55296
  buffer_load_dwordx4 v227, s[8:11], s17 offen offset:2048 lds
  v_mfma_f32_16x16x32_bf16 v[100:103], a[92:95], a[36:39], v[100:103]
  ds_read_b64_tr_b16 a[92:93], v245 offset:51200
  v_mfma_f32_16x16x32_bf16 v[72:75], a[112:115], a[40:43], v[72:75]
  ds_read_b64_tr_b16 a[94:95], v245 offset:55296
  v_mfma_f32_16x16x32_bf16 v[88:91], a[112:115], a[44:47], v[88:91]
  ds_read_b64_tr_b16 a[112:113], v242 offset:59392
  buffer_load_dwordx4 v228, s[8:11], s17 offen offset:3072 lds
  s_add_u32 s17, s17, 458752
  v_mfma_f32_16x16x32_bf16 v[76:79], a[116:119], a[40:43], v[76:79]
  ds_read_b64_tr_b16 a[114:115], v242 offset:63488
  v_mfma_f32_16x16x32_bf16 v[92:95], a[116:119], a[44:47], v[92:95]
  ds_read_b64_tr_b16 a[116:117], v243 offset:59392
  v_mfma_f32_16x16x32_bf16 v[80:83], a[120:123], a[40:43], v[80:83]
  ds_read_b64_tr_b16 a[118:119], v243 offset:63488
  v_mfma_f32_16x16x32_bf16 v[96:99], a[120:123], a[44:47], v[96:99]
  ds_read_b64_tr_b16 a[120:121], v244 offset:59392
  buffer_load_dword v251, v255, s[8:11], s96 offen
  s_add_u32 s96, s96, 458752
  v_mfma_f32_16x16x32_bf16 v[84:87], a[124:127], a[40:43], v[84:87]
  ds_read_b64_tr_b16 a[122:123], v244 offset:63488
  v_mfma_f32_16x16x32_bf16 v[100:103], a[124:127], a[44:47], v[100:103]
  ds_read_b64_tr_b16 a[124:125], v245 offset:59392
  v_mfma_f32_16x16x32_bf16 v[16:19], a[64:67], a[32:35], v[16:19]
  ds_read_b64_tr_b16 a[126:127], v245 offset:63488
  buffer_load_dwordx4 a[16:19], v240, s[4:7], s16 offen offset:0 sc1
  v_mfma_f32_16x16x32_bf16 v[32:35], a[64:67], a[36:39], v[32:35]
  ds_read_b64_tr_b16 a[64:65], v242 offset:49152
  v_mfma_f32_16x16x32_bf16 v[20:23], a[68:71], a[32:35], v[20:23]
  ds_read_b64_tr_b16 a[66:67], v242 offset:53248
  v_mfma_f32_16x16x32_bf16 v[36:39], a[68:71], a[36:39], v[36:39]
  ds_read_b64_tr_b16 a[68:69], v243 offset:49152
  v_mfma_f32_16x16x32_bf16 v[24:27], a[72:75], a[32:35], v[24:27]
  ds_read_b64_tr_b16 a[70:71], v243 offset:53248
  buffer_load_dwordx4 a[20:23], v240, s[4:7], s16 offen offset:1024 sc1
  v_mfma_f32_16x16x32_bf16 v[40:43], a[72:75], a[36:39], v[40:43]
  ds_read_b64_tr_b16 a[72:73], v244 offset:49152
  s_waitcnt lgkmcnt(10)
  v_mfma_f32_16x16x32_bf16 v[28:31], a[76:79], a[32:35], v[28:31]
  ds_read_b64_tr_b16 a[74:75], v244 offset:53248
  v_mfma_f32_16x16x32_bf16 v[44:47], a[76:79], a[36:39], v[44:47]
  ds_read_b64_tr_b16 a[76:77], v245 offset:49152
  buffer_load_dwordx4 a[24:27], v241, s[4:7], s16 offen offset:0 sc1
  v_mfma_f32_16x16x32_bf16 v[16:19], a[96:99], a[40:43], v[16:19]
  ds_read_b64_tr_b16 a[78:79], v245 offset:53248
  v_mfma_f32_16x16x32_bf16 v[32:35], a[96:99], a[44:47], v[32:35]
  ds_read_b64_tr_b16 a[96:97], v242 offset:57344
  v_mfma_f32_16x16x32_bf16 v[20:23], a[100:103], a[40:43], v[20:23]
  ds_read_b64_tr_b16 a[98:99], v242 offset:61440
  v_mfma_f32_16x16x32_bf16 v[36:39], a[100:103], a[44:47], v[36:39]
  ds_read_b64_tr_b16 a[100:101], v243 offset:57344
  buffer_load_dwordx4 a[28:31], v241, s[4:7], s16 offen offset:1024 sc1
  s_add_u32 s16, s16, 262144
  v_mfma_f32_16x16x32_bf16 v[24:27], a[104:107], a[40:43], v[24:27]
  ds_read_b64_tr_b16 a[102:103], v243 offset:61440
  v_mfma_f32_16x16x32_bf16 v[40:43], a[104:107], a[44:47], v[40:43]
  ds_read_b64_tr_b16 a[104:105], v244 offset:57344
  v_mfma_f32_16x16x32_bf16 v[28:31], a[108:111], a[40:43], v[28:31]
  ds_read_b64_tr_b16 a[106:107], v244 offset:61440
  v_mfma_f32_16x16x32_bf16 v[44:47], a[108:111], a[44:47], v[44:47]
  ds_read_b64_tr_b16 a[108:109], v245 offset:57344
  ds_read_b64_tr_b16 a[110:111], v245 offset:61440
  s_waitcnt vmcnt(13) lgkmcnt(10)
  s_barrier
  s_add_u32 m0, s38, 32768
  s_nop 0
  buffer_load_dwordx4 v225, s[8:11], s17 offen lds
  v_mfma_f32_16x16x32_bf16 v[72:75], a[80:83], a[48:51], v[72:75]
  v_mfma_f32_16x16x32_bf16 v[88:91], a[80:83], a[52:55], v[88:91]
  ds_read_b64_tr_b16 a[80:81], v242 offset:2048
  v_mfma_f32_16x16x32_bf16 v[76:79], a[84:87], a[48:51], v[76:79]
  ds_read_b64_tr_b16 a[82:83], v242 offset:6144
  buffer_load_dwordx4 v226, s[8:11], s17 offen offset:1024 lds
  v_mfma_f32_16x16x32_bf16 v[92:95], a[84:87], a[52:55], v[92:95]
  ds_read_b64_tr_b16 a[84:85], v243 offset:2048
  v_mfma_f32_16x16x32_bf16 v[80:83], a[88:91], a[48:51], v[80:83]
  ds_read_b64_tr_b16 a[86:87], v243 offset:6144
  v_mfma_f32_16x16x32_bf16 v[96:99], a[88:91], a[52:55], v[96:99]
  ds_read_b64_tr_b16 a[88:89], v244 offset:2048
  v_mfma_f32_16x16x32_bf16 v[84:87], a[92:95], a[48:51], v[84:87]
  ds_read_b64_tr_b16 a[90:91], v244 offset:6144
  buffer_load_dwordx4 v227, s[8:11], s17 offen offset:2048 lds
  v_mfma_f32_16x16x32_bf16 v[100:103], a[92:95], a[52:55], v[100:103]
  ds_read_b64_tr_b16 a[92:93], v245 offset:2048
  v_mfma_f32_16x16x32_bf16 v[72:75], a[112:115], a[56:59], v[72:75]
  ds_read_b64_tr_b16 a[94:95], v245 offset:6144
  v_mfma_f32_16x16x32_bf16 v[88:91], a[112:115], a[60:63], v[88:91]
  ds_read_b64_tr_b16 a[112:113], v242 offset:10240
  buffer_load_dwordx4 v228, s[8:11], s17 offen offset:3072 lds
  s_add_u32 s17, s17, 458752
  v_mfma_f32_16x16x32_bf16 v[76:79], a[116:119], a[56:59], v[76:79]
  ds_read_b64_tr_b16 a[114:115], v242 offset:14336
  v_mfma_f32_16x16x32_bf16 v[92:95], a[116:119], a[60:63], v[92:95]
  ds_read_b64_tr_b16 a[116:117], v243 offset:10240
  v_mfma_f32_16x16x32_bf16 v[80:83], a[120:123], a[56:59], v[80:83]
  ds_read_b64_tr_b16 a[118:119], v243 offset:14336
  v_mfma_f32_16x16x32_bf16 v[96:99], a[120:123], a[60:63], v[96:99]
  ds_read_b64_tr_b16 a[120:121], v244 offset:10240
  buffer_load_dword v251, v255, s[8:11], s96 offen
  s_add_u32 s96, s96, 458752
  v_mfma_f32_16x16x32_bf16 v[84:87], a[124:127], a[56:59], v[84:87]
  ds_read_b64_tr_b16 a[122:123], v244 offset:14336
  v_mfma_f32_16x16x32_bf16 v[100:103], a[124:127], a[60:63], v[100:103]
  ds_read_b64_tr_b16 a[124:125], v245 offset:10240
  v_mfma_f32_16x16x32_bf16 v[16:19], a[64:67], a[48:51], v[16:19]
  ds_read_b64_tr_b16 a[126:127], v245 offset:14336
  buffer_load_dwordx4 a[32:35], v240, s[4:7], s16 offen offset:0 sc1
  v_mfma_f32_16x16x32_bf16 v[32:35], a[64:67], a[52:55], v[32:35]
  ds_read_b64_tr_b16 a[64:65], v242 offset:0
  v_mfma_f32_16x16x32_bf16 v[20:23], a[68:71], a[48:51], v[20:23]
  ds_read_b64_tr_b16 a[66:67], v242 offset:4096
  v_mfma_f32_16x16x32_bf16 v[36:39], a[68:71], a[52:55], v[36:39]
  ds_read_b64_tr_b16 a[68:69], v243 offset:0
  v_mfma_f32_16x16x32_bf16 v[24:27], a[72:75], a[48:51], v[24:27]
  ds_read_b64_tr_b16 a[70:71], v243 offset:4096
  buffer_load_dwordx4 a[36:39], v240, s[4:7], s16 offen offset:1024 sc1
  v_mfma_f32_16x16x32_bf16 v[40:43], a[72:75], a[52:55], v[40:43]
  ds_read_b64_tr_b16 a[72:73], v244 offset:0
  s_waitcnt lgkmcnt(10)
  v_mfma_f32_16x16x32_bf16 v[28:31], a[76:79], a[48:51], v[28:31]
  ds_read_b64_tr_b16 a[74:75], v244 offset:4096
  v_mfma_f32_16x16x32_bf16 v[44:47], a[76:79], a[52:55], v[44:47]
  ds_read_b64_tr_b16 a[76:77], v245 offset:0
  buffer_load_dwordx4 a[40:43], v241, s[4:7], s16 offen offset:0 sc1
  v_mfma_f32_16x16x32_bf16 v[16:19], a[96:99], a[56:59], v[16:19]
  ds_read_b64_tr_b16 a[78:79], v245 offset:4096
  v_mfma_f32_16x16x32_bf16 v[32:35], a[96:99], a[60:63], v[32:35]
  ds_read_b64_tr_b16 a[96:97], v242 offset:8192
  v_mfma_f32_16x16x32_bf16 v[20:23], a[100:103], a[56:59], v[20:23]
  ds_read_b64_tr_b16 a[98:99], v242 offset:12288
  v_mfma_f32_16x16x32_bf16 v[36:39], a[100:103], a[60:63], v[36:39]
  ds_read_b64_tr_b16 a[100:101], v243 offset:8192
  buffer_load_dwordx4 a[44:47], v241, s[4:7], s16 offen offset:1024 sc1
  s_add_u32 s16, s16, 262144
  v_mfma_f32_16x16x32_bf16 v[24:27], a[104:107], a[56:59], v[24:27]
  ds_read_b64_tr_b16 a[102:103], v243 offset:12288
  v_mfma_f32_16x16x32_bf16 v[40:43], a[104:107], a[60:63], v[40:43]
  ds_read_b64_tr_b16 a[104:105], v244 offset:8192
  v_mfma_f32_16x16x32_bf16 v[28:31], a[108:111], a[56:59], v[28:31]
  ds_read_b64_tr_b16 a[106:107], v244 offset:12288
  v_mfma_f32_16x16x32_bf16 v[44:47], a[108:111], a[60:63], v[44:47]
  ds_read_b64_tr_b16 a[108:109], v245 offset:8192
  ds_read_b64_tr_b16 a[110:111], v245 offset:12288
  s_waitcnt vmcnt(13) lgkmcnt(10)
  s_barrier
  s_add_u32 m0, s38, 49152
  s_nop 0
  buffer_load_dwordx4 v225, s[8:11], s17 offen lds
  v_mfma_f32_16x16x32_bf16 v[72:75], a[80:83], a[0:3], v[72:75]
  v_mfma_f32_16x16x32_bf16 v[88:91], a[80:83], a[4:7], v[88:91]
  ds_read_b64_tr_b16 a[80:81], v242 offset:18432
  v_mfma_f32_16x16x32_bf16 v[76:79], a[84:87], a[0:3], v[76:79]
  ds_read_b64_tr_b16 a[82:83], v242 offset:22528
  buffer_load_dwordx4 v226, s[8:11], s17 offen offset:1024 lds
  v_mfma_f32_16x16x32_bf16 v[92:95], a[84:87], a[4:7], v[92:95]
  ds_read_b64_tr_b16 a[84:85], v243 offset:18432
  v_mfma_f32_16x16x32_bf16 v[80:83], a[88:91], a[0:3], v[80:83]
  ds_read_b64_tr_b16 a[86:87], v243 offset:22528
  v_mfma_f32_16x16x32_bf16 v[96:99], a[88:91], a[4:7], v[96:99]
  ds_read_b64_tr_b16 a[88:89], v244 offset:18432
  v_mfma_f32_16x16x32_bf16 v[84:87], a[92:95], a[0:3], v[84:87]
  ds_read_b64_tr_b16 a[90:91], v244 offset:22528
  buffer_load_dwordx4 v227, s[8:11], s17 offen offset:2048 lds
  v_mfma_f32_16x16x32_bf16 v[100:103], a[92:95], a[4:7], v[100:103]
  ds_read_b64_tr_b16 a[92:93], v245 offset:18432
  v_mfma_f32_16x16x32_bf16 v[72:75], a[112:115], a[8:11], v[72:75]
  ds_read_b64_tr_b16 a[94:95], v245 offset:22528
  v_mfma_f32_16x16x32_bf16 v[88:91], a[112:115], a[12:15], v[88:91]
  ds_read_b64_tr_b16 a[112:113], v242 offset:26624
  buffer_load_dwordx4 v228, s[8:11], s17 offen offset:3072 lds
  s_add_u32 s17, s17, 458752
  v_mfma_f32_16x16x32_bf16 v[76:79], a[116:119], a[8:11], v[76:79]
  ds_read_b64_tr_b16 a[114:115], v242 offset:30720
  v_mfma_f32_16x16x32_bf16 v[92:95], a[116:119], a[12:15], v[92:95]
  ds_read_b64_tr_b16 a[116:117], v243 offset:26624
  v_mfma_f32_16x16x32_bf16 v[80:83], a[120:123], a[8:11], v[80:83]
  ds_read_b64_tr_b16 a[118:119], v243 offset:30720
  v_mfma_f32_16x16x32_bf16 v[96:99], a[120:123], a[12:15], v[96:99]
  ds_read_b64_tr_b16 a[120:121], v244 offset:26624
  buffer_load_dword v251, v255, s[8:11], s96 offen
  s_add_u32 s96, s96, 458752
  v_mfma_f32_16x16x32_bf16 v[84:87], a[124:127], a[8:11], v[84:87]
  ds_read_b64_tr_b16 a[122:123], v244 offset:30720
  v_mfma_f32_16x16x32_bf16 v[100:103], a[124:127], a[12:15], v[100:103]
  ds_read_b64_tr_b16 a[124:125], v245 offset:26624
  v_mfma_f32_16x16x32_bf16 v[16:19], a[64:67], a[0:3], v[16:19]
  ds_read_b64_tr_b16 a[126:127], v245 offset:30720
  buffer_load_dwordx4 a[48:51], v240, s[4:7], s16 offen offset:0 sc1
  v_mfma_f32_16x16x32_bf16 v[32:35], a[64:67], a[4:7], v[32:35]
  ds_read_b64_tr_b16 a[64:65], v242 offset:16384
  v_mfma_f32_16x16x32_bf16 v[20:23], a[68:71], a[0:3], v[20:23]
  ds_read_b64_tr_b16 a[66:67], v242 offset:20480
  v_mfma_f32_16x16x32_bf16 v[36:39], a[68:71], a[4:7], v[36:39]
  ds_read_b64_tr_b16 a[68:69], v243 offset:16384
  v_mfma_f32_16x16x32_bf16 v[24:27], a[72:75], a[0:3], v[24:27]
  ds_read_b64_tr_b16 a[70:71], v243 offset:20480
  buffer_load_dwordx4 a[52:55], v240, s[4:7], s16 offen offset:1024 sc1
  v_mfma_f32_16x16x32_bf16 v[40:43], a[72:75], a[4:7], v[40:43]
  ds_read_b64_tr_b16 a[72:73], v244 offset:16384
  s_waitcnt lgkmcnt(10)
  v_mfma_f32_16x16x32_bf16 v[28:31], a[76:79], a[0:3], v[28:31]
  ds_read_b64_tr_b16 a[74:75], v244 offset:20480
  v_mfma_f32_16x16x32_bf16 v[44:47], a[76:79], a[4:7], v[44:47]
  ds_read_b64_tr_b16 a[76:77], v245 offset:16384
  buffer_load_dwordx4 a[56:59], v241, s[4:7], s16 offen offset:0 sc1
  v_mfma_f32_16x16x32_bf16 v[16:19], a[96:99], a[8:11], v[16:19]
  ds_read_b64_tr_b16 a[78:79], v245 offset:20480
  v_mfma_f32_16x16x32_bf16 v[32:35], a[96:99], a[12:15], v[32:35]
  ds_read_b64_tr_b16 a[96:97], v242 offset:24576
  v_mfma_f32_16x16x32_bf16 v[20:23], a[100:103], a[8:11], v[20:23]
  ds_read_b64_tr_b16 a[98:99], v242 offset:28672
  v_mfma_f32_16x16x32_bf16 v[36:39], a[100:103], a[12:15], v[36:39]
  ds_read_b64_tr_b16 a[100:101], v243 offset:24576
  buffer_load_dwordx4 a[60:63], v241, s[4:7], s16 offen offset:1024 sc1
  s_add_u32 s16, s16, 262144
  v_mfma_f32_16x16x32_bf16 v[24:27], a[104:107], a[8:11], v[24:27]
  ds_read_b64_tr_b16 a[102:103], v243 offset:28672
  v_mfma_f32_16x16x32_bf16 v[40:43], a[104:107], a[12:15], v[40:43]
  ds_read_b64_tr_b16 a[104:105], v244 offset:24576
  v_mfma_f32_16x16x32_bf16 v[28:31], a[108:111], a[8:11], v[28:31]
  ds_read_b64_tr_b16 a[106:107], v244 offset:28672
  v_mfma_f32_16x16x32_bf16 v[44:47], a[108:111], a[12:15], v[44:47]
  ds_read_b64_tr_b16 a[108:109], v245 offset:24576
  ds_read_b64_tr_b16 a[110:111], v245 offset:28672
  s_waitcnt vmcnt(13) lgkmcnt(10)
  s_barrier
  s_add_u32 m0, s38, 0
  s_nop 0
  buffer_load_dwordx4 v225, s[8:11], s17 offen lds
  v_mfma_f32_16x16x32_bf16 v[72:75], a[80:83], a[16:19], v[72:75]
  v_mfma_f32_16x16x32_bf16 v[88:91], a[80:83], a[20:23], v[88:91]
  ds_read_b64_tr_b16 a[80:81], v242 offset:34816
  v_mfma_f32_16x16x32_bf16 v[76:79], a[84:87], a[16:19], v[76:79]
  ds_read_b64_tr_b16 a[82:83], v242 offset:38912
  buffer_load_dwordx4 v226, s[8:11], s17 offen offset:1024 lds
  v_mfma_f32_16x16x32_bf16 v[92:95], a[84:87], a[20:23], v[92:95]
  ds_read_b64_tr_b16 a[84:85], v243 offset:34816
  v_mfma_f32_16x16x32_bf16 v[80:83], a[88:91], a[16:19], v[80:83]
  ds_read_b64_tr_b16 a[86:87], v243 offset:38912
  v_mfma_f32_16x16x32_bf16 v[96:99], a[88:91], a[20:23], v[96:99]
  ds_read_b64_tr_b16 a[88:89], v244 offset:34816
  v_mfma_f32_16x16x32_bf16 v[84:87], a[92:95], a[16:19], v[84:87]
  ds_read_b64_tr_b16 a[90:91], v244 offset:38912
  buffer_load_dwordx4 v227, s[8:11], s17 offen offset:2048 lds
  v_mfma_f32_16x16x32_bf16 v[100:103], a[92:95], a[20:23], v[100:103]
  ds_read_b64_tr_b16 a[92:93], v245 offset:34816
  v_mfma_f32_16x16x32_bf16 v[72:75], a[112:115], a[24:27], v[72:75]
  ds_read_b64_tr_b16 a[94:95], v245 offset:38912
  v_mfma_f32_16x16x32_bf16 v[88:91], a[112:115], a[28:31], v[88:91]
  ds_read_b64_tr_b16 a[112:113], v242 offset:43008
  buffer_load_dwordx4 v228, s[8:11], s17 offen offset:3072 lds
  s_add_u32 s17, s17, 458752
  v_mfma_f32_16x16x32_bf16 v[76:79], a[116:119], a[24:27], v[76:79]
  ds_read_b64_tr_b16 a[114:115], v242 offset:47104
  v_mfma_f32_16x16x32_bf16 v[92:95], a[116:119], a[28:31], v[92:95]
  ds_read_b64_tr_b16 a[116:117], v243 offset:43008
  v_mfma_f32_16x16x32_bf16 v[80:83], a[120:123], a[24:27], v[80:83]
  ds_read_b64_tr_b16 a[118:119], v243 offset:47104
  v_mfma_f32_16x16x32_bf16 v[96:99], a[120:123], a[28:31], v[96:99]
  ds_read_b64_tr_b16 a[120:121], v244 offset:43008
  buffer_load_dword v251, v255, s[8:11], s96 offen
  s_mov_b32 s96, s97
  v_mfma_f32_16x16x32_bf16 v[84:87], a[124:127], a[24:27], v[84:87]
  ds_read_b64_tr_b16 a[122:123], v244 offset:47104
  v_mfma_f32_16x16x32_bf16 v[100:103], a[124:127], a[28:31], v[100:103]
  ds_read_b64_tr_b16 a[124:125], v245 offset:43008
  v_mfma_f32_16x16x32_bf16 v[16:19], a[64:67], a[16:19], v[16:19]
  ds_read_b64_tr_b16 a[126:127], v245 offset:47104
  buffer_load_dwordx4 a[0:3], v240, s[4:7], s16 offen offset:0 sc1
  v_mfma_f32_16x16x32_bf16 v[32:35], a[64:67], a[20:23], v[32:35]
  ds_read_b64_tr_b16 a[64:65], v242 offset:32768
  v_mfma_f32_16x16x32_bf16 v[20:23], a[68:71], a[16:19], v[20:23]
  ds_read_b64_tr_b16 a[66:67], v242 offset:36864
  v_mfma_f32_16x16x32_bf16 v[36:39], a[68:71], a[20:23], v[36:39]
  ds_read_b64_tr_b16 a[68:69], v243 offset:32768
  v_mfma_f32_16x16x32_bf16 v[24:27], a[72:75], a[16:19], v[24:27]
  ds_read_b64_tr_b16 a[70:71], v243 offset:36864
  buffer_load_dwordx4 a[4:7], v240, s[4:7], s16 offen offset:1024 sc1
  v_mfma_f32_16x16x32_bf16 v[40:43], a[72:75], a[20:23], v[40:43]
  ds_read_b64_tr_b16 a[72:73], v244 offset:32768
  s_waitcnt lgkmcnt(10)
  v_mfma_f32_16x16x32_bf16 v[28:31], a[76:79], a[16:19], v[28:31]
  ds_read_b64_tr_b16 a[74:75], v244 offset:36864
  v_mfma_f32_16x16x32_bf16 v[44:47], a[76:79], a[20:23], v[44:47]
  ds_read_b64_tr_b16 a[76:77], v245 offset:32768
  buffer_load_dwordx4 a[8:11], v241, s[4:7], s16 offen offset:0 sc1
  v_mfma_f32_16x16x32_bf16 v[16:19], a[96:99], a[24:27], v[16:19]
  ds_read_b64_tr_b16 a[78:79], v245 offset:36864
  v_mfma_f32_16x16x32_bf16 v[32:35], a[96:99], a[28:31], v[32:35]
  ds_read_b64_tr_b16 a[96:97], v242 offset:40960
  v_mfma_f32_16x16x32_bf16 v[20:23], a[100:103], a[24:27], v[20:23]
  ds_read_b64_tr_b16 a[98:99], v242 offset:45056
  v_mfma_f32_16x16x32_bf16 v[36:39], a[100:103], a[28:31], v[36:39]
  ds_read_b64_tr_b16 a[100:101], v243 offset:40960
  buffer_load_dwordx4 a[12:15], v241, s[4:7], s16 offen offset:1024 sc1
  s_add_u32 s16, s16, 262144
  v_mfma_f32_16x16x32_bf16 v[24:27], a[104:107], a[24:27], v[24:27]
  ds_read_b64_tr_b16 a[102:103], v243 offset:45056
  v_mfma_f32_16x16x32_bf16 v[40:43], a[104:107], a[28:31], v[40:43]
  ds_read_b64_tr_b16 a[104:105], v244 offset:40960
  v_mfma_f32_16x16x32_bf16 v[28:31], a[108:111], a[24:27], v[28:31]
  ds_read_b64_tr_b16 a[106:107], v244 offset:45056
  v_mfma_f32_16x16x32_bf16 v[44:47], a[108:111], a[28:31], v[44:47]
  ds_read_b64_tr_b16 a[108:109], v245 offset:40960
  ds_read_b64_tr_b16 a[110:111], v245 offset:45056
  s_waitcnt vmcnt(13) lgkmcnt(10)
  s_barrier
  s_add_u32 m0, s38, 16384
  s_nop 0
  buffer_load_dwordx4 v225, s[8:11], s17 offen lds
  v_mfma_f32_16x16x32_bf16 v[72:75], a[80:83], a[32:35], v[72:75]
  v_mfma_f32_16x16x32_bf16 v[88:91], a[80:83], a[36:39], v[88:91]
  ds_read_b64_tr_b16 a[80:81], v242 offset:51200
  v_mfma_f32_16x16x32_bf16 v[76:79], a[84:87], a[32:35], v[76:79]
  ds_read_b64_tr_b16 a[82:83], v242 offset:55296
  buffer_load_dwordx4 v226, s[8:11], s17 offen offset:1024 lds
  v_mfma_f32_16x16x32_bf16 v[92:95], a[84:87], a[36:39], v[92:95]
  ds_read_b64_tr_b16 a[84:85], v243 offset:51200
  v_mfma_f32_16x16x32_bf16 v[80:83], a[88:91], a[32:35], v[80:83]
  ds_read_b64_tr_b16 a[86:87], v243 offset:55296
  v_mfma_f32_16x16x32_bf16 v[96:99], a[88:91], a[36:39], v[96:99]
  ds_read_b64_tr_b16 a[88:89], v244 offset:51200
  v_mfma_f32_16x16x32_bf16 v[84:87], a[92:95], a[32:35], v[84:87]
  ds_read_b64_tr_b16 a[90:91], v244 offset:55296
  buffer_load_dwordx4 v227, s[8:11], s17 offen offset:2048 lds
  v_mfma_f32_16x16x32_bf16 v[100:103], a[92:95], a[36:39], v[100:103]
  ds_read_b64_tr_b16 a[92:93], v245 offset:51200
  v_mfma_f32_16x16x32_bf16 v[72:75], a[112:115], a[40:43], v[72:75]
  ds_read_b64_tr_b16 a[94:95], v245 offset:55296
  v_mfma_f32_16x16x32_bf16 v[88:91], a[112:115], a[44:47], v[88:91]
  ds_read_b64_tr_b16 a[112:113], v242 offset:59392
  buffer_load_dwordx4 v228, s[8:11], s17 offen offset:3072 lds
  s_add_u32 s17, s17, 458752
  v_mfma_f32_16x16x32_bf16 v[76:79], a[116:119], a[40:43], v[76:79]
  ds_read_b64_tr_b16 a[114:115], v242 offset:63488
  v_mfma_f32_16x16x32_bf16 v[92:95], a[116:119], a[44:47], v[92:95]
  ds_read_b64_tr_b16 a[116:117], v243 offset:59392
  v_mfma_f32_16x16x32_bf16 v[80:83], a[120:123], a[40:43], v[80:83]
  ds_read_b64_tr_b16 a[118:119], v243 offset:63488
  v_mfma_f32_16x16x32_bf16 v[96:99], a[120:123], a[44:47], v[96:99]
  ds_read_b64_tr_b16 a[120:121], v244 offset:59392
  buffer_load_dword v251, v255, s[8:11], s96 offen
  s_add_u32 s96, s96, 917504
  v_mfma_f32_16x16x32_bf16 v[84:87], a[124:127], a[40:43], v[84:87]
  ds_read_b64_tr_b16 a[122:123], v244 offset:63488
  v_mfma_f32_16x16x32_bf16 v[100:103], a[124:127], a[44:47], v[100:103]
  ds_read_b64_tr_b16 a[124:125], v245 offset:59392
  v_mfma_f32_16x16x32_bf16 v[16:19], a[64:67], a[32:35], v[16:19]
  ds_read_b64_tr_b16 a[126:127], v245 offset:63488
  buffer_load_dwordx4 a[16:19], v240, s[4:7], s16 offen offset:0 sc1
  v_mfma_f32_16x16x32_bf16 v[32:35], a[64:67], a[36:39], v[32:35]
  ds_read_b64_tr_b16 a[64:65], v242 offset:49152
  v_mfma_f32_16x16x32_bf16 v[20:23], a[68:71], a[32:35], v[20:23]
  ds_read_b64_tr_b16 a[66:67], v242 offset:53248
  v_mfma_f32_16x16x32_bf16 v[36:39], a[68:71], a[36:39], v[36:39]
  ds_read_b64_tr_b16 a[68:69], v243 offset:49152
  v_mfma_f32_16x16x32_bf16 v[24:27], a[72:75], a[32:35], v[24:27]
  ds_read_b64_tr_b16 a[70:71], v243 offset:53248
  buffer_load_dwordx4 a[20:23], v240, s[4:7], s16 offen offset:1024 sc1
  v_mfma_f32_16x16x32_bf16 v[40:43], a[72:75], a[36:39], v[40:43]
  ds_read_b64_tr_b16 a[72:73], v244 offset:49152
  s_waitcnt lgkmcnt(10)
  v_mfma_f32_16x16x32_bf16 v[28:31], a[76:79], a[32:35], v[28:31]
  ds_read_b64_tr_b16 a[74:75], v244 offset:53248
  v_mfma_f32_16x16x32_bf16 v[44:47], a[76:79], a[36:39], v[44:47]
  ds_read_b64_tr_b16 a[76:77], v245 offset:49152
  buffer_load_dwordx4 a[24:27], v241, s[4:7], s16 offen offset:0 sc1
  v_mfma_f32_16x16x32_bf16 v[16:19], a[96:99], a[40:43], v[16:19]
  ds_read_b64_tr_b16 a[78:79], v245 offset:53248
  v_mfma_f32_16x16x32_bf16 v[32:35], a[96:99], a[44:47], v[32:35]
  ds_read_b64_tr_b16 a[96:97], v242 offset:57344
  v_mfma_f32_16x16x32_bf16 v[20:23], a[100:103], a[40:43], v[20:23]
  ds_read_b64_tr_b16 a[98:99], v242 offset:61440
  v_mfma_f32_16x16x32_bf16 v[36:39], a[100:103], a[44:47], v[36:39]
  ds_read_b64_tr_b16 a[100:101], v243 offset:57344
  buffer_load_dwordx4 a[28:31], v241, s[4:7], s16 offen offset:1024 sc1
  s_add_u32 s16, s16, 262144
  v_mfma_f32_16x16x32_bf16 v[24:27], a[104:107], a[40:43], v[24:27]
  ds_read_b64_tr_b16 a[102:103], v243 offset:61440
  v_mfma_f32_16x16x32_bf16 v[40:43], a[104:107], a[44:47], v[40:43]
  ds_read_b64_tr_b16 a[104:105], v244 offset:57344
  v_mfma_f32_16x16x32_bf16 v[28:31], a[108:111], a[40:43], v[28:31]
  ds_read_b64_tr_b16 a[106:107], v244 offset:61440
  v_mfma_f32_16x16x32_bf16 v[44:47], a[108:111], a[44:47], v[44:47]
  ds_read_b64_tr_b16 a[108:109], v245 offset:57344
  ds_read_b64_tr_b16 a[110:111], v245 offset:61440
  s_waitcnt vmcnt(13) lgkmcnt(10)
  s_barrier
  s_add_u32 m0, s38, 32768
  s_nop 0
  buffer_load_dwordx4 v225, s[8:11], s17 offen lds
  v_mfma_f32_16x16x32_bf16 v[72:75], a[80:83], a[48:51], v[72:75]
  v_mfma_f32_16x16x32_bf16 v[88:91], a[80:83], a[52:55], v[88:91]
  ds_read_b64_tr_b16 a[80:81], v242 offset:2048
  v_mfma_f32_16x16x32_bf16 v[76:79], a[84:87], a[48:51], v[76:79]
  ds_read_b64_tr_b16 a[82:83], v242 offset:6144
  buffer_load_dwordx4 v226, s[8:11], s17 offen offset:1024 lds
  v_mfma_f32_16x16x32_bf16 v[92:95], a[84:87], a[52:55], v[92:95]
  ds_read_b64_tr_b16 a[84:85], v243 offset:2048
  v_mfma_f32_16x16x32_bf16 v[80:83], a[88:91], a[48:51], v[80:83]
  ds_read_b64_tr_b16 a[86:87], v243 offset:6144
  v_mfma_f32_16x16x32_bf16 v[96:99], a[88:91], a[52:55], v[96:99]
  ds_read_b64_tr_b16 a[88:89], v244 offset:2048
  v_mfma_f32_16x16x32_bf16 v[84:87], a[92:95], a[48:51], v[84:87]
  ds_read_b64_tr_b16 a[90:91], v244 offset:6144
  buffer_load_dwordx4 v227, s[8:11], s17 offen offset:2048 lds
  v_mfma_f32_16x16x32_bf16 v[100:103], a[92:95], a[52:55], v[100:103]
  ds_read_b64_tr_b16 a[92:93], v245 offset:2048
  v_mfma_f32_16x16x32_bf16 v[72:75], a[112:115], a[56:59], v[72:75]
  ds_read_b64_tr_b16 a[94:95], v245 offset:6144
  v_mfma_f32_16x16x32_bf16 v[88:91], a[112:115], a[60:63], v[88:91]
  ds_read_b64_tr_b16 a[112:113], v242 offset:10240
  buffer_load_dwordx4 v228, s[8:11], s17 offen offset:3072 lds
  s_add_u32 s17, s17, 458752
  v_mfma_f32_16x16x32_bf16 v[76:79], a[116:119], a[56:59], v[76:79]
  ds_read_b64_tr_b16 a[114:115], v242 offset:14336
  v_mfma_f32_16x16x32_bf16 v[92:95], a[116:119], a[60:63], v[92:95]
  ds_read_b64_tr_b16 a[116:117], v243 offset:10240
  v_mfma_f32_16x16x32_bf16 v[80:83], a[120:123], a[56:59], v[80:83]
  ds_read_b64_tr_b16 a[118:119], v243 offset:14336
  v_mfma_f32_16x16x32_bf16 v[96:99], a[120:123], a[60:63], v[96:99]
  ds_read_b64_tr_b16 a[120:121], v244 offset:10240
  buffer_load_dword v251, v255, s[8:11], s96 offen
  s_add_u32 s96, s96, 917504
  v_mfma_f32_16x16x32_bf16 v[84:87], a[124:127], a[56:59], v[84:87]
  ds_read_b64_tr_b16 a[122:123], v244 offset:14336
  v_mfma_f32_16x16x32_bf16 v[100:103], a[124:127], a[60:63], v[100:103]
  ds_read_b64_tr_b16 a[124:125], v245 offset:10240
  v_mfma_f32_16x16x32_bf16 v[16:19], a[64:67], a[48:51], v[16:19]
  ds_read_b64_tr_b16 a[126:127], v245 offset:14336
  buffer_load_dwordx4 a[32:35], v240, s[4:7], s16 offen offset:0 sc1
  v_mfma_f32_16x16x32_bf16 v[32:35], a[64:67], a[52:55], v[32:35]
  ds_read_b64_tr_b16 a[64:65], v242 offset:0
  v_mfma_f32_16x16x32_bf16 v[20:23], a[68:71], a[48:51], v[20:23]
  ds_read_b64_tr_b16 a[66:67], v242 offset:4096
  v_mfma_f32_16x16x32_bf16 v[36:39], a[68:71], a[52:55], v[36:39]
  ds_read_b64_tr_b16 a[68:69], v243 offset:0
  v_mfma_f32_16x16x32_bf16 v[24:27], a[72:75], a[48:51], v[24:27]
  ds_read_b64_tr_b16 a[70:71], v243 offset:4096
  buffer_load_dwordx4 a[36:39], v240, s[4:7], s16 offen offset:1024 sc1
  v_mfma_f32_16x16x32_bf16 v[40:43], a[72:75], a[52:55], v[40:43]
  ds_read_b64_tr_b16 a[72:73], v244 offset:0
  s_waitcnt lgkmcnt(10)
  v_mfma_f32_16x16x32_bf16 v[28:31], a[76:79], a[48:51], v[28:31]
  ds_read_b64_tr_b16 a[74:75], v244 offset:4096
  v_mfma_f32_16x16x32_bf16 v[44:47], a[76:79], a[52:55], v[44:47]
  ds_read_b64_tr_b16 a[76:77], v245 offset:0
  buffer_load_dwordx4 a[40:43], v241, s[4:7], s16 offen offset:0 sc1
  v_mfma_f32_16x16x32_bf16 v[16:19], a[96:99], a[56:59], v[16:19]
  ds_read_b64_tr_b16 a[78:79], v245 offset:4096
  v_mfma_f32_16x16x32_bf16 v[32:35], a[96:99], a[60:63], v[32:35]
  ds_read_b64_tr_b16 a[96:97], v242 offset:8192
  v_mfma_f32_16x16x32_bf16 v[20:23], a[100:103], a[56:59], v[20:23]
  ds_read_b64_tr_b16 a[98:99], v242 offset:12288
  v_mfma_f32_16x16x32_bf16 v[36:39], a[100:103], a[60:63], v[36:39]
  ds_read_b64_tr_b16 a[100:101], v243 offset:8192
  buffer_load_dwordx4 a[44:47], v241, s[4:7], s16 offen offset:1024 sc1
  s_add_u32 s16, s16, 262144
  v_mfma_f32_16x16x32_bf16 v[24:27], a[104:107], a[56:59], v[24:27]
  ds_read_b64_tr_b16 a[102:103], v243 offset:12288
  v_mfma_f32_16x16x32_bf16 v[40:43], a[104:107], a[60:63], v[40:43]
  ds_read_b64_tr_b16 a[104:105], v244 offset:8192
  v_mfma_f32_16x16x32_bf16 v[28:31], a[108:111], a[56:59], v[28:31]
  ds_read_b64_tr_b16 a[106:107], v244 offset:12288
  v_mfma_f32_16x16x32_bf16 v[44:47], a[108:111], a[60:63], v[44:47]
  ds_read_b64_tr_b16 a[108:109], v245 offset:8192
  ds_read_b64_tr_b16 a[110:111], v245 offset:12288
  s_waitcnt vmcnt(13) lgkmcnt(10)
  s_barrier
  s_add_u32 m0, s38, 49152
  s_nop 0
  buffer_load_dwordx4 v225, s[8:11], s17 offen lds
  v_mfma_f32_16x16x32_bf16 v[72:75], a[80:83], a[0:3], v[72:75]
  v_mfma_f32_16x16x32_bf16 v[88:91], a[80:83], a[4:7], v[88:91]
  ds_read_b64_tr_b16 a[80:81], v242 offset:18432
  v_mfma_f32_16x16x32_bf16 v[76:79], a[84:87], a[0:3], v[76:79]
  ds_read_b64_tr_b16 a[82:83], v242 offset:22528
  buffer_load_dwordx4 v226, s[8:11], s17 offen offset:1024 lds
  v_mfma_f32_16x16x32_bf16 v[92:95], a[84:87], a[4:7], v[92:95]
  ds_read_b64_tr_b16 a[84:85], v243 offset:18432
  v_mfma_f32_16x16x32_bf16 v[80:83], a[88:91], a[0:3], v[80:83]
  ds_read_b64_tr_b16 a[86:87], v243 offset:22528
  v_mfma_f32_16x16x32_bf16 v[96:99], a[88:91], a[4:7], v[96:99]
  ds_read_b64_tr_b16 a[88:89], v244 offset:18432
  v_mfma_f32_16x16x32_bf16 v[84:87], a[92:95], a[0:3], v[84:87]
  ds_read_b64_tr_b16 a[90:91], v244 offset:22528
  buffer_load_dwordx4 v227, s[8:11], s17 offen offset:2048 lds
  v_mfma_f32_16x16x32_bf16 v[100:103], a[92:95], a[4:7], v[100:103]
  ds_read_b64_tr_b16 a[92:93], v245 offset:18432
  v_mfma_f32_16x16x32_bf16 v[72:75], a[112:115], a[8:11], v[72:75]
  ds_read_b64_tr_b16 a[94:95], v245 offset:22528
  v_mfma_f32_16x16x32_bf16 v[88:91], a[112:115], a[12:15], v[88:91]
  ds_read_b64_tr_b16 a[112:113], v242 offset:26624
  buffer_load_dwordx4 v228, s[8:11], s17 offen offset:3072 lds
  s_mov_b32 s17, s97
  v_mfma_f32_16x16x32_bf16 v[76:79], a[116:119], a[8:11], v[76:79]
  ds_read_b64_tr_b16 a[114:115], v242 offset:30720
  v_mfma_f32_16x16x32_bf16 v[92:95], a[116:119], a[12:15], v[92:95]
  ds_read_b64_tr_b16 a[116:117], v243 offset:26624
  v_mfma_f32_16x16x32_bf16 v[80:83], a[120:123], a[8:11], v[80:83]
  ds_read_b64_tr_b16 a[118:119], v243 offset:30720
  v_mfma_f32_16x16x32_bf16 v[96:99], a[120:123], a[12:15], v[96:99]
  ds_read_b64_tr_b16 a[120:121], v244 offset:26624
  buffer_load_dword v251, v255, s[8:11], s96 offen
  s_add_u32 s96, s96, 917504
  v_mfma_f32_16x16x32_bf16 v[84:87], a[124:127], a[8:11], v[84:87]
  ds_read_b64_tr_b16 a[122:123], v244 offset:30720
  v_mfma_f32_16x16x32_bf16 v[100:103], a[124:127], a[12:15], v[100:103]
  ds_read_b64_tr_b16 a[124:125], v245 offset:26624
  v_mfma_f32_16x16x32_bf16 v[16:19], a[64:67], a[0:3], v[16:19]
  ds_read_b64_tr_b16 a[126:127], v245 offset:30720
  buffer_load_dwordx4 a[48:51], v240, s[4:7], s16 offen offset:0 sc1
  v_mfma_f32_16x16x32_bf16 v[32:35], a[64:67], a[4:7], v[32:35]
  ds_read_b64_tr_b16 a[64:65], v242 offset:16384
  v_mfma_f32_16x16x32_bf16 v[20:23], a[68:71], a[0:3], v[20:23]
  ds_read_b64_tr_b16 a[66:67], v242 offset:20480
  v_mfma_f32_16x16x32_bf16 v[36:39], a[68:71], a[4:7], v[36:39]
  ds_read_b64_tr_b16 a[68:69], v243 offset:16384
  v_mfma_f32_16x16x32_bf16 v[24:27], a[72:75], a[0:3], v[24:27]
  ds_read_b64_tr_b16 a[70:71], v243 offset:20480
  buffer_load_dwordx4 a[52:55], v240, s[4:7], s16 offen offset:1024 sc1
  v_mfma_f32_16x16x32_bf16 v[40:43], a[72:75], a[4:7], v[40:43]
  ds_read_b64_tr_b16 a[72:73], v244 offset:16384
  s_waitcnt lgkmcnt(10)
  v_mfma_f32_16x16x32_bf16 v[28:31], a[76:79], a[0:3], v[28:31]
  ds_read_b64_tr_b16 a[74:75], v244 offset:20480
  v_mfma_f32_16x16x32_bf16 v[44:47], a[76:79], a[4:7], v[44:47]
  ds_read_b64_tr_b16 a[76:77], v245 offset:16384
  buffer_load_dwordx4 a[56:59], v241, s[4:7], s16 offen offset:0 sc1
  v_mfma_f32_16x16x32_bf16 v[16:19], a[96:99], a[8:11], v[16:19]
  ds_read_b64_tr_b16 a[78:79], v245 offset:20480
  v_mfma_f32_16x16x32_bf16 v[32:35], a[96:99], a[12:15], v[32:35]
  ds_read_b64_tr_b16 a[96:97], v242 offset:24576
  v_mfma_f32_16x16x32_bf16 v[20:23], a[100:103], a[8:11], v[20:23]
  ds_read_b64_tr_b16 a[98:99], v242 offset:28672
  v_mfma_f32_16x16x32_bf16 v[36:39], a[100:103], a[12:15], v[36:39]
  ds_read_b64_tr_b16 a[100:101], v243 offset:24576
  buffer_load_dwordx4 a[60:63], v241, s[4:7], s16 offen offset:1024 sc1
  s_add_u32 s16, s16, 262144
  v_mfma_f32_16x16x32_bf16 v[24:27], a[104:107], a[8:11], v[24:27]
  ds_read_b64_tr_b16 a[102:103], v243 offset:28672
  v_mfma_f32_16x16x32_bf16 v[40:43], a[104:107], a[12:15], v[40:43]
  ds_read_b64_tr_b16 a[104:105], v244 offset:24576
  v_mfma_f32_16x16x32_bf16 v[28:31], a[108:111], a[8:11], v[28:31]
  ds_read_b64_tr_b16 a[106:107], v244 offset:28672
  v_mfma_f32_16x16x32_bf16 v[44:47], a[108:111], a[12:15], v[44:47]
  ds_read_b64_tr_b16 a[108:109], v245 offset:24576
  ds_read_b64_tr_b16 a[110:111], v245 offset:28672
  s_waitcnt vmcnt(13) lgkmcnt(10)
  s_barrier
  s_add_u32 m0, s38, 0
  s_nop 0
  buffer_load_dwordx4 v227, s[8:11], s17 offen offset:2048 lds
  v_mfma_f32_16x16x32_bf16 v[72:75], a[80:83], a[16:19], v[72:75]
  v_mfma_f32_16x16x32_bf16 v[88:91], a[80:83], a[20:23], v[88:91]
  ds_read_b64_tr_b16 a[80:81], v242 offset:34816
  v_mfma_f32_16x16x32_bf16 v[76:79], a[84:87], a[16:19], v[76:79]
  ds_read_b64_tr_b16 a[82:83], v242 offset:38912
  buffer_load_dwordx4 v228, s[8:11], s17 offen offset:3072 lds
  s_add_u32 s17, s17, 917504
  v_mfma_f32_16x16x32_bf16 v[92:95], a[84:87], a[20:23], v[92:95]
  ds_read_b64_tr_b16 a[84:85], v243 offset:34816
  v_mfma_f32_16x16x32_bf16 v[80:83], a[88:91], a[16:19], v[80:83]
  ds_read_b64_tr_b16 a[86:87], v243 offset:38912
  s_add_u32 m0, s38, -2048
  s_nop 0
  buffer_load_dwordx4 v227, s[8:11], s17 offen offset:2048 lds
  v_mfma_f32_16x16x32_bf16 v[96:99], a[88:91], a[20:23], v[96:99]
  ds_read_b64_tr_b16 a[88:89], v244 offset:34816
  v_mfma_f32_16x16x32_bf16 v[84:87], a[92:95], a[16:19], v[84:87]
  ds_read_b64_tr_b16 a[90:91], v244 offset:38912
  v_mfma_f32_16x16x32_bf16 v[100:103], a[92:95], a[20:23], v[100:103]
  ds_read_b64_tr_b16 a[92:93], v245 offset:34816
  buffer_load_dwordx4 v228, s[8:11], s17 offen offset:3072 lds
  s_add_u32 s17, s17, 917504
  v_mfma_f32_16x16x32_bf16 v[72:75], a[112:115], a[24:27], v[72:75]
  ds_read_b64_tr_b16 a[94:95], v245 offset:38912
  v_mfma_f32_16x16x32_bf16 v[88:91], a[112:115], a[28:31], v[88:91]
  ds_read_b64_tr_b16 a[112:113], v242 offset:43008
  buffer_load_dwordx4 v[128:131], v240, s[4:7], s16 offen offset:0 sc1
  v_mfma_f32_16x16x32_bf16 v[76:79], a[116:119], a[24:27], v[76:79]
  ds_read_b64_tr_b16 a[114:115], v242 offset:47104
  v_mfma_f32_16x16x32_bf16 v[92:95], a[116:119], a[28:31], v[92:95]
  ds_read_b64_tr_b16 a[116:117], v243 offset:43008
  v_mfma_f32_16x16x32_bf16 v[80:83], a[120:123], a[24:27], v[80:83]
  ds_read_b64_tr_b16 a[118:119], v243 offset:47104
  buffer_load_dwordx4 v[132:135], v240, s[4:7], s16 offen offset:1024 sc1
  v_mfma_f32_16x16x32_bf16 v[96:99], a[120:123], a[28:31], v[96:99]
  ds_read_b64_tr_b16 a[120:121], v244 offset:43008
  v_mfma_f32_16x16x32_bf16 v[84:87], a[124:127], a[24:27], v[84:87]
  ds_read_b64_tr_b16 a[122:123], v244 offset:47104
  v_mfma_f32_16x16x32_bf16 v[100:103], a[124:127], a[28:31], v[100:103]
  ds_read_b64_tr_b16 a[124:125], v245 offset:43008
  buffer_load_dwordx4 v[136:139], v241, s[4:7], s16 offen offset:0 sc1
  v_mfma_f32_16x16x32_bf16 v[16:19], a[64:67], a[16:19], v[16:19]
  ds_read_b64_tr_b16 a[126:127], v245 offset:47104
  v_mfma_f32_16x16x32_bf16 v[32:35], a[64:67], a[20:23], v[32:35]
  ds_read_b64_tr_b16 a[64:65], v242 offset:32768
  buffer_load_dwordx4 v[140:143], v241, s[4:7], s16 offen offset:1024 sc1
  s_add_u32 s16, s16, 262144
  v_mfma_f32_16x16x32_bf16 v[20:23], a[68:71], a[16:19], v[20:23]
  ds_read_b64_tr_b16 a[66:67], v242 offset:36864
  v_mfma_f32_16x16x32_bf16 v[36:39], a[68:71], a[20:23], v[36:39]
  ds_read_b64_tr_b16 a[68:69], v243 offset:32768
  v_mfma_f32_16x16x32_bf16 v[24:27], a[72:75], a[16:19], v[24:27]
  ds_read_b64_tr_b16 a[70:71], v243 offset:36864
  buffer_load_dwordx4 v[144:147], v240, s[4:7], s16 offen offset:0 sc1
  v_mfma_f32_16x16x32_bf16 v[40:43], a[72:75], a[20:23], v[40:43]
  ds_read_b64_tr_b16 a[72:73], v244 offset:32768
  s_waitcnt lgkmcnt(10)
  v_mfma_f32_16x16x32_bf16 v[28:31], a[76:79], a[16:19], v[28:31]
  ds_read_b64_tr_b16 a[74:75], v244 offset:36864
  buffer_load_dwordx4 v[148:151], v240, s[4:7], s16 offen offset:1024 sc1
  v_mfma_f32_16x16x32_bf16 v[44:47], a[76:79], a[20:23], v[44:47]
  ds_read_b64_tr_b16 a[76:77], v245 offset:32768
  v_mfma_f32_16x16x32_bf16 v[16:19], a[96:99], a[24:27], v[16:19]
  ds_read_b64_tr_b16 a[78:79], v245 offset:36864
  v_mfma_f32_16x16x32_bf16 v[32:35], a[96:99], a[28:31], v[32:35]
  ds_read_b64_tr_b16 a[96:97], v242 offset:40960
  buffer_load_dwordx4 v[152:155], v241, s[4:7], s16 offen offset:0 sc1
  v_mfma_f32_16x16x32_bf16 v[20:23], a[100:103], a[24:27], v[20:23]
  ds_read_b64_tr_b16 a[98:99], v242 offset:45056
  v_mfma_f32_16x16x32_bf16 v[36:39], a[100:103], a[28:31], v[36:39]
  ds_read_b64_tr_b16 a[100:101], v243 offset:40960
  buffer_load_dwordx4 v[156:159], v241, s[4:7], s16 offen offset:1024 sc1
  s_add_u32 s16, s16, 262144
  v_mfma_f32_16x16x32_bf16 v[24:27], a[104:107], a[24:27], v[24:27]
  ds_read_b64_tr_b16 a[102:103], v243 offset:45056
  v_mfma_f32_16x16x32_bf16 v[40:43], a[104:107], a[28:31], v[40:43]
  ds_read_b64_tr_b16 a[104:105], v244 offset:40960
  v_mfma_f32_16x16x32_bf16 v[28:31], a[108:111], a[24:27], v[28:31]
  ds_read_b64_tr_b16 a[106:107], v244 offset:45056
  v_mfma_f32_16x16x32_bf16 v[44:47], a[108:111], a[28:31], v[44:47]
  ds_read_b64_tr_b16 a[108:109], v245 offset:40960
  ds_read_b64_tr_b16 a[110:111], v245 offset:45056
  s_waitcnt vmcnt(16) lgkmcnt(10)
  s_barrier
  s_add_u32 m0, s38, 16384
  s_nop 0
  buffer_load_dwordx4 v227, s[8:11], s17 offen offset:2048 lds
  v_mfma_f32_16x16x32_bf16 v[72:75], a[80:83], a[32:35], v[72:75]
  v_mfma_f32_16x16x32_bf16 v[88:91], a[80:83], a[36:39], v[88:91]
  ds_read_b64_tr_b16 a[80:81], v242 offset:51200
  v_mfma_f32_16x16x32_bf16 v[76:79], a[84:87], a[32:35], v[76:79]
  ds_read_b64_tr_b16 a[82:83], v242 offset:55296
  buffer_load_dwordx4 v228, s[8:11], s17 offen offset:3072 lds
  s_add_u32 s17, s17, 917504
  v_mfma_f32_16x16x32_bf16 v[92:95], a[84:87], a[36:39], v[92:95]
  ds_read_b64_tr_b16 a[84:85], v243 offset:51200
  v_mfma_f32_16x16x32_bf16 v[80:83], a[88:91], a[32:35], v[80:83]
  ds_read_b64_tr_b16 a[86:87], v243 offset:55296
  s_add_u32 m0, s38, 14336
  s_nop 0
  buffer_load_dwordx4 v227, s[8:11], s17 offen offset:2048 lds
  v_mfma_f32_16x16x32_bf16 v[96:99], a[88:91], a[36:39], v[96:99]
  ds_read_b64_tr_b16 a[88:89], v244 offset:51200
  v_mfma_f32_16x16x32_bf16 v[84:87], a[92:95], a[32:35], v[84:87]
  ds_read_b64_tr_b16 a[90:91], v244 offset:55296
  v_mfma_f32_16x16x32_bf16 v[100:103], a[92:95], a[36:39], v[100:103]
  ds_read_b64_tr_b16 a[92:93], v245 offset:51200
  buffer_load_dwordx4 v228, s[8:11], s17 offen offset:3072 lds
  s_mov_b32 s17, s97
  v_mfma_f32_16x16x32_bf16 v[72:75], a[112:115], a[40:43], v[72:75]
  ds_read_b64_tr_b16 a[94:95], v245 offset:55296
  v_mfma_f32_16x16x32_bf16 v[88:91], a[112:115], a[44:47], v[88:91]
  ds_read_b64_tr_b16 a[112:113], v242 offset:59392
  buffer_load_dwordx4 v[160:163], v240, s[4:7], s16 offen offset:0 sc1
  v_mfma_f32_16x16x32_bf16 v[76:79], a[116:119], a[40:43], v[76:79]
  ds_read_b64_tr_b16 a[114:115], v242 offset:63488
  v_mfma_f32_16x16x32_bf16 v[92:95], a[116:119], a[44:47], v[92:95]
  ds_read_b64_tr_b16 a[116:117], v243 offset:59392
  v_mfma_f32_16x16x32_bf16 v[80:83], a[120:123], a[40:43], v[80:83]
  ds_read_b64_tr_b16 a[118:119], v243 offset:63488
  buffer_load_dwordx4 v[164:167], v240, s[4:7], s16 offen offset:1024 sc1
  v_mfma_f32_16x16x32_bf16 v[96:99], a[120:123], a[44:47], v[96:99]
  ds_read_b64_tr_b16 a[120:121], v244 offset:59392
  v_mfma_f32_16x16x32_bf16 v[84:87], a[124:127], a[40:43], v[84:87]
  ds_read_b64_tr_b16 a[122:123], v244 offset:63488
  v_mfma_f32_16x16x32_bf16 v[100:103], a[124:127], a[44:47], v[100:103]
  ds_read_b64_tr_b16 a[124:125], v245 offset:59392
  buffer_load_dwordx4 v[168:171], v241, s[4:7], s16 offen offset:0 sc1
  v_mfma_f32_16x16x32_bf16 v[16:19], a[64:67], a[32:35], v[16:19]
  ds_read_b64_tr_b16 a[126:127], v245 offset:63488
  v_mfma_f32_16x16x32_bf16 v[32:35], a[64:67], a[36:39], v[32:35]
  ds_read_b64_tr_b16 a[64:65], v242 offset:49152
  buffer_load_dwordx4 v[172:175], v241, s[4:7], s16 offen offset:1024 sc1
  s_add_u32 s16, s16, 262144
  v_mfma_f32_16x16x32_bf16 v[20:23], a[68:71], a[32:35], v[20:23]
  ds_read_b64_tr_b16 a[66:67], v242 offset:53248
  v_mfma_f32_16x16x32_bf16 v[36:39], a[68:71], a[36:39], v[36:39]
  ds_read_b64_tr_b16 a[68:69], v243 offset:49152
  v_mfma_f32_16x16x32_bf16 v[24:27], a[72:75], a[32:35], v[24:27]
  ds_read_b64_tr_b16 a[70:71], v243 offset:53248
  buffer_load_dwordx4 v[176:179], v240, s[4:7], s16 offen offset:0 sc1
  v_mfma_f32_16x16x32_bf16 v[40:43], a[72:75], a[36:39], v[40:43]
  ds_read_b64_tr_b16 a[72:73], v244 offset:49152
  s_waitcnt lgkmcnt(10)
  v_mfma_f32_16x16x32_bf16 v[28:31], a[76:79], a[32:35], v[28:31]
  ds_read_b64_tr_b16 a[74:75], v244 offset:53248
  buffer_load_dwordx4 v[180:183], v240, s[4:7], s16 offen offset:1024 sc1
  v_mfma_f32_16x16x32_bf16 v[44:47], a[76:79], a[36:39], v[44:47]
  ds_read_b64_tr_b16 a[76:77], v245 offset:49152
  v_mfma_f32_16x16x32_bf16 v[16:19], a[96:99], a[40:43], v[16:19]
  ds_read_b64_tr_b16 a[78:79], v245 offset:53248
  v_mfma_f32_16x16x32_bf16 v[32:35], a[96:99], a[44:47], v[32:35]
  ds_read_b64_tr_b16 a[96:97], v242 offset:57344
  buffer_load_dwordx4 v[184:187], v241, s[4:7], s16 offen offset:0 sc1
  v_mfma_f32_16x16x32_bf16 v[20:23], a[100:103], a[40:43], v[20:23]
  ds_read_b64_tr_b16 a[98:99], v242 offset:61440
  v_mfma_f32_16x16x32_bf16 v[36:39], a[100:103], a[44:47], v[36:39]
  ds_read_b64_tr_b16 a[100:101], v243 offset:57344
  buffer_load_dwordx4 v[188:191], v241, s[4:7], s16 offen offset:1024 sc1
  s_add_u32 s16, s16, 262144
  v_mfma_f32_16x16x32_bf16 v[24:27], a[104:107], a[40:43], v[24:27]
  ds_read_b64_tr_b16 a[102:103], v243 offset:61440
  v_mfma_f32_16x16x32_bf16 v[40:43], a[104:107], a[44:47], v[40:43]
  ds_read_b64_tr_b16 a[104:105], v244 offset:57344
  v_mfma_f32_16x16x32_bf16 v[28:31], a[108:111], a[40:43], v[28:31]
  ds_read_b64_tr_b16 a[106:107], v244 offset:61440
  v_mfma_f32_16x16x32_bf16 v[44:47], a[108:111], a[44:47], v[44:47]
  ds_read_b64_tr_b16 a[108:109], v245 offset:57344
  ds_read_b64_tr_b16 a[110:111], v245 offset:61440
  s_waitcnt vmcnt(20) lgkmcnt(10)
  s_barrier
  s_add_u32 m0, s38, 34816
  s_nop 0
  buffer_load_dwordx4 v225, s[8:11], s17 offen offset:0 lds
  v_mfma_f32_16x16x32_bf16 v[72:75], a[80:83], a[48:51], v[72:75]
  v_mfma_f32_16x16x32_bf16 v[88:91], a[80:83], a[52:55], v[88:91]
  ds_read_b64_tr_b16 a[80:81], v242 offset:2048
  v_mfma_f32_16x16x32_bf16 v[76:79], a[84:87], a[48:51], v[76:79]
  ds_read_b64_tr_b16 a[82:83], v242 offset:6144
  v_mfma_f32_16x16x32_bf16 v[92:95], a[84:87], a[52:55], v[92:95]
  ds_read_b64_tr_b16 a[84:85], v243 offset:2048
  v_mfma_f32_16x16x32_bf16 v[80:83], a[88:91], a[48:51], v[80:83]
  ds_read_b64_tr_b16 a[86:87], v243 offset:6144
  v_mfma_f32_16x16x32_bf16 v[96:99], a[88:91], a[52:55], v[96:99]
  ds_read_b64_tr_b16 a[88:89], v244 offset:2048
  v_mfma_f32_16x16x32_bf16 v[84:87], a[92:95], a[48:51], v[84:87]
  ds_read_b64_tr_b16 a[90:91], v244 offset:6144
  v_mfma_f32_16x16x32_bf16 v[100:103], a[92:95], a[52:55], v[100:103]
  ds_read_b64_tr_b16 a[92:93], v245 offset:2048
  buffer_load_dwordx4 v226, s[8:11], s17 offen offset:1024 lds
  s_add_u32 s17, s17, 917504
  v_mfma_f32_16x16x32_bf16 v[72:75], a[112:115], a[56:59], v[72:75]
  ds_read_b64_tr_b16 a[94:95], v245 offset:6144
  v_mfma_f32_16x16x32_bf16 v[88:91], a[112:115], a[60:63], v[88:91]
  ds_read_b64_tr_b16 a[112:113], v242 offset:10240
  v_mfma_f32_16x16x32_bf16 v[76:79], a[116:119], a[56:59], v[76:79]
  ds_read_b64_tr_b16 a[114:115], v242 offset:14336
  v_mfma_f32_16x16x32_bf16 v[92:95], a[116:119], a[60:63], v[92:95]
  ds_read_b64_tr_b16 a[116:117], v243 offset:10240
  v_mfma_f32_16x16x32_bf16 v[80:83], a[120:123], a[56:59], v[80:83]
  ds_read_b64_tr_b16 a[118:119], v243 offset:14336
  v_mfma_f32_16x16x32_bf16 v[96:99], a[120:123], a[60:63], v[96:99]
  ds_read_b64_tr_b16 a[120:121], v244 offset:10240
  v_mfma_f32_16x16x32_bf16 v[84:87], a[124:127], a[56:59], v[84:87]
  ds_read_b64_tr_b16 a[122:123], v244 offset:14336
  v_mfma_f32_16x16x32_bf16 v[100:103], a[124:127], a[60:63], v[100:103]
  ds_read_b64_tr_b16 a[124:125], v245 offset:10240
  s_add_u32 m0, s38, 32768
  s_nop 0
  buffer_load_dwordx4 v225, s[8:11], s17 offen offset:0 lds
  v_mfma_f32_16x16x32_bf16 v[16:19], a[64:67], a[48:51], v[16:19]
  ds_read_b64_tr_b16 a[126:127], v245 offset:14336
  v_mfma_f32_16x16x32_bf16 v[32:35], a[64:67], a[52:55], v[32:35]
  ds_read_b64_tr_b16 a[64:65], v242 offset:0
  v_mfma_f32_16x16x32_bf16 v[20:23], a[68:71], a[48:51], v[20:23]
  ds_read_b64_tr_b16 a[66:67], v242 offset:4096
  v_mfma_f32_16x16x32_bf16 v[36:39], a[68:71], a[52:55], v[36:39]
  ds_read_b64_tr_b16 a[68:69], v243 offset:0
  v_mfma_f32_16x16x32_bf16 v[24:27], a[72:75], a[48:51], v[24:27]
  ds_read_b64_tr_b16 a[70:71], v243 offset:4096
  v_mfma_f32_16x16x32_bf16 v[40:43], a[72:75], a[52:55], v[40:43]
  ds_read_b64_tr_b16 a[72:73], v244 offset:0
  s_waitcnt lgkmcnt(10)
  v_mfma_f32_16x16x32_bf16 v[28:31], a[76:79], a[48:51], v[28:31]
  ds_read_b64_tr_b16 a[74:75], v244 offset:4096
  buffer_load_dwordx4 v226, s[8:11], s17 offen offset:1024 lds
  s_add_u32 s17, s17, 917504
  v_mfma_f32_16x16x32_bf16 v[44:47], a[76:79], a[52:55], v[44:47]
  ds_read_b64_tr_b16 a[76:77], v245 offset:0
  v_mfma_f32_16x16x32_bf16 v[16:19], a[96:99], a[56:59], v[16:19]
  ds_read_b64_tr_b16 a[78:79], v245 offset:4096
  v_mfma_f32_16x16x32_bf16 v[32:35], a[96:99], a[60:63], v[32:35]
  ds_read_b64_tr_b16 a[96:97], v242 offset:8192
  v_mfma_f32_16x16x32_bf16 v[20:23], a[100:103], a[56:59], v[20:23]
  ds_read_b64_tr_b16 a[98:99], v242 offset:12288
  v_mfma_f32_16x16x32_bf16 v[36:39], a[100:103], a[60:63], v[36:39]
  ds_read_b64_tr_b16 a[100:101], v243 offset:8192
  v_mfma_f32_16x16x32_bf16 v[24:27], a[104:107], a[56:59], v[24:27]
  ds_read_b64_tr_b16 a[102:103], v243 offset:12288
  v_mfma_f32_16x16x32_bf16 v[40:43], a[104:107], a[60:63], v[40:43]
  ds_read_b64_tr_b16 a[104:105], v244 offset:8192
  v_mfma_f32_16x16x32_bf16 v[28:31], a[108:111], a[56:59], v[28:31]
  ds_read_b64_tr_b16 a[106:107], v244 offset:12288
  v_mfma_f32_16x16x32_bf16 v[44:47], a[108:111], a[60:63], v[44:47]
  ds_read_b64_tr_b16 a[108:109], v245 offset:8192
  ds_read_b64_tr_b16 a[110:111], v245 offset:12288
  s_waitcnt vmcnt(12) lgkmcnt(10)
  s_barrier
  v_swap_b32 v130, v132
  v_swap_b32 v131, v133
  v_swap_b32 v138, v140
  v_swap_b32 v139, v141
  v_swap_b32 v146, v148
  v_swap_b32 v147, v149
  v_swap_b32 v154, v156
  v_swap_b32 v155, v157
  s_nop 1
  s_add_u32 m0, s38, 51200
  s_nop 0
  buffer_load_dwordx4 v225, s[8:11], s17 offen offset:0 lds
  v_mfma_f32_16x16x32_bf16 v[72:75], a[80:83], v[128:131], v[72:75]
  v_mfma_f32_16x16x32_bf16 v[88:91], a[80:83], v[132:135], v[88:91]
  ds_read_b64_tr_b16 a[80:81], v242 offset:18432
  v_mfma_f32_16x16x32_bf16 v[76:79], a[84:87], v[128:131], v[76:79]
  ds_read_b64_tr_b16 a[82:83], v242 offset:22528
  v_mfma_f32_16x16x32_bf16 v[92:95], a[84:87], v[132:135], v[92:95]
  ds_read_b64_tr_b16 a[84:85], v243 offset:18432
  v_mfma_f32_16x16x32_bf16 v[80:83], a[88:91], v[128:131], v[80:83]
  ds_read_b64_tr_b16 a[86:87], v243 offset:22528
  v_mfma_f32_16x16x32_bf16 v[96:99], a[88:91], v[132:135], v[96:99]
  ds_read_b64_tr_b16 a[88:89], v244 offset:18432
  buffer_load_dwordx4 v226, s[8:11], s17 offen offset:1024 lds
  s_add_u32 s17, s17, 917504
  v_mfma_f32_16x16x32_bf16 v[84:87], a[92:95], v[128:131], v[84:87]
  ds_read_b64_tr_b16 a[90:91], v244 offset:22528
  v_mfma_f32_16x16x32_bf16 v[100:103], a[92:95], v[132:135], v[100:103]
  ds_read_b64_tr_b16 a[92:93], v245 offset:18432
  v_mfma_f32_16x16x32_bf16 v[72:75], a[112:115], v[136:139], v[72:75]
  ds_read_b64_tr_b16 a[94:95], v245 offset:22528
  v_mfma_f32_16x16x32_bf16 v[88:91], a[112:115], v[140:143], v[88:91]
  ds_read_b64_tr_b16 a[112:113], v242 offset:26624
  v_mfma_f32_16x16x32_bf16 v[76:79], a[116:119], v[136:139], v[76:79]
  ds_read_b64_tr_b16 a[114:115], v242 offset:30720
  v_mfma_f32_16x16x32_bf16 v[92:95], a[116:119], v[140:143], v[92:95]
  ds_read_b64_tr_b16 a[116:117], v243 offset:26624
  s_add_u32 m0, s38, 49152
  s_nop 0
  buffer_load_dwordx4 v225, s[8:11], s17 offen offset:0 lds
  v_mfma_f32_16x16x32_bf16 v[80:83], a[120:123], v[136:139], v[80:83]
  ds_read_b64_tr_b16 a[118:119], v243 offset:30720
  v_mfma_f32_16x16x32_bf16 v[96:99], a[120:123], v[140:143], v[96:99]
  ds_read_b64_tr_b16 a[120:121], v244 offset:26624
  v_mfma_f32_16x16x32_bf16 v[84:87], a[124:127], v[136:139], v[84:87]
  ds_read_b64_tr_b16 a[122:123], v244 offset:30720
  v_mfma_f32_16x16x32_bf16 v[100:103], a[124:127], v[140:143], v[100:103]
  ds_read_b64_tr_b16 a[124:125], v245 offset:26624
  v_mfma_f32_16x16x32_bf16 v[72:75], a[64:67], v[144:147], v[72:75]
  ds_read_b64_tr_b16 a[126:127], v245 offset:30720
  v_mfma_f32_16x16x32_bf16 v[88:91], a[64:67], v[148:151], v[88:91]
  ds_read_b64_tr_b16 a[64:65], v242 offset:16384
  v_mfma_f32_16x16x32_bf16 v[76:79], a[68:71], v[144:147], v[76:79]
  ds_read_b64_tr_b16 a[66:67], v242 offset:20480
  buffer_load_dwordx4 v226, s[8:11], s17 offen offset:1024 lds
  s_add_u32 s17, s17, 917504
  v_mfma_f32_16x16x32_bf16 v[92:95], a[68:71], v[148:151], v[92:95]
  ds_read_b64_tr_b16 a[68:69], v243 offset:16384
  v_mfma_f32_16x16x32_bf16 v[80:83], a[72:75], v[144:147], v[80:83]
  ds_read_b64_tr_b16 a[70:71], v243 offset:20480
  v_mfma_f32_16x16x32_bf16 v[96:99], a[72:75], v[148:151], v[96:99]
  ds_read_b64_tr_b16 a[72:73], v244 offset:16384
  s_waitcnt lgkmcnt(10)
  v_mfma_f32_16x16x32_bf16 v[84:87], a[76:79], v[144:147], v[84:87]
  ds_read_b64_tr_b16 a[74:75], v244 offset:20480
  v_mfma_f32_16x16x32_bf16 v[100:103], a[76:79], v[148:151], v[100:103]
  ds_read_b64_tr_b16 a[76:77], v245 offset:16384
  v_mfma_f32_16x16x32_bf16 v[72:75], a[96:99], v[152:155], v[72:75]
  ds_read_b64_tr_b16 a[78:79], v245 offset:20480
  s_add_u32 s52, s20, 0x1800000
  s_addc_u32 s53, s21, 0
  s_mov_b32 s54, 0x800000
  s_mov_b32 s55, 0x20000
  v_lshlrev_b32 v50, 4, v231
  s_lshl_b32 s36, s2, 2
  s_add_u32 s36, s36, s3
  s_xor_b32 s37, s36, 4
  s_lshl_b32 s39, s37, 13
  s_add_u32 s40, s39, 4096
  s_lshl_b32 s36, s36, 13
  s_add_u32 s37, s36, 4096
  s_mov_b32 s43, 0x8000
  s_mov_b32 s44, s90
  s_mov_b32 s45, s91
  s_mov_b32 s46, 0x400000
  s_mov_b32 s47, 0x20000
  v_mfma_f32_16x16x32_bf16 v[88:91], a[96:99], v[156:159], v[88:91]
  ds_read_b64_tr_b16 a[96:97], v242 offset:24576
  v_mfma_f32_16x16x32_bf16 v[76:79], a[100:103], v[152:155], v[76:79]
  ds_read_b64_tr_b16 a[98:99], v242 offset:28672
  v_mfma_f32_16x16x32_bf16 v[92:95], a[100:103], v[156:159], v[92:95]
  ds_read_b64_tr_b16 a[100:101], v243 offset:24576
  v_mfma_f32_16x16x32_bf16 v[80:83], a[104:107], v[152:155], v[80:83]
  ds_read_b64_tr_b16 a[102:103], v243 offset:28672
  v_mfma_f32_16x16x32_bf16 v[96:99], a[104:107], v[156:159], v[96:99]
  ds_read_b64_tr_b16 a[104:105], v244 offset:24576
  v_mfma_f32_16x16x32_bf16 v[84:87], a[108:111], v[152:155], v[84:87]
  ds_read_b64_tr_b16 a[106:107], v244 offset:28672
  v_mfma_f32_16x16x32_bf16 v[100:103], a[108:111], v[156:159], v[100:103]
  ds_read_b64_tr_b16 a[108:109], v245 offset:24576
  ds_read_b64_tr_b16 a[110:111], v245 offset:28672
  s_waitcnt vmcnt(4) lgkmcnt(10)
  s_barrier
  v_swap_b32 v162, v164
  v_swap_b32 v163, v165
  v_swap_b32 v170, v172
  v_swap_b32 v171, v173
  v_swap_b32 v178, v180
  v_swap_b32 v179, v181
  v_swap_b32 v186, v188
  v_swap_b32 v187, v189
  s_nop 1
  v_mfma_f32_16x16x32_bf16 v[72:75], a[80:83], v[160:163], v[72:75]
  v_mfma_f32_16x16x32_bf16 v[88:91], a[80:83], v[164:167], v[88:91]
  ds_read_b64_tr_b16 a[80:81], v242 offset:34816
  v_mfma_f32_16x16x32_bf16 v[76:79], a[84:87], v[160:163], v[76:79]
  ds_read_b64_tr_b16 a[82:83], v242 offset:38912
  v_mfma_f32_16x16x32_bf16 v[92:95], a[84:87], v[164:167], v[92:95]
  ds_read_b64_tr_b16 a[84:85], v243 offset:34816
  v_mfma_f32_16x16x32_bf16 v[80:83], a[88:91], v[160:163], v[80:83]
  ds_read_b64_tr_b16 a[86:87], v243 offset:38912
  v_mfma_f32_16x16x32_bf16 v[96:99], a[88:91], v[164:167], v[96:99]
  ds_read_b64_tr_b16 a[88:89], v244 offset:34816
  v_mfma_f32_16x16x32_bf16 v[84:87], a[92:95], v[160:163], v[84:87]
  ds_read_b64_tr_b16 a[90:91], v244 offset:38912
  v_mfma_f32_16x16x32_bf16 v[100:103], a[92:95], v[164:167], v[100:103]
  ds_read_b64_tr_b16 a[92:93], v245 offset:34816
  v_mfma_f32_16x16x32_bf16 v[72:75], a[112:115], v[168:171], v[72:75]
  ds_read_b64_tr_b16 a[94:95], v245 offset:38912
  v_mfma_f32_16x16x32_bf16 v[88:91], a[112:115], v[172:175], v[88:91]
  ds_read_b64_tr_b16 a[112:113], v242 offset:43008
  v_mfma_f32_16x16x32_bf16 v[76:79], a[116:119], v[168:171], v[76:79]
  ds_read_b64_tr_b16 a[114:115], v242 offset:47104
  v_mfma_f32_16x16x32_bf16 v[92:95], a[116:119], v[172:175], v[92:95]
  ds_read_b64_tr_b16 a[116:117], v243 offset:43008
  v_mfma_f32_16x16x32_bf16 v[80:83], a[120:123], v[168:171], v[80:83]
  ds_read_b64_tr_b16 a[118:119], v243 offset:47104
  v_mfma_f32_16x16x32_bf16 v[96:99], a[120:123], v[172:175], v[96:99]
  ds_read_b64_tr_b16 a[120:121], v244 offset:43008
  v_mfma_f32_16x16x32_bf16 v[84:87], a[124:127], v[168:171], v[84:87]
  ds_read_b64_tr_b16 a[122:123], v244 offset:47104
  v_mfma_f32_16x16x32_bf16 v[100:103], a[124:127], v[172:175], v[100:103]
  ds_read_b64_tr_b16 a[124:125], v245 offset:43008
  v_mfma_f32_16x16x32_bf16 v[72:75], a[64:67], v[176:179], v[72:75]
  ds_read_b64_tr_b16 a[126:127], v245 offset:47104
  v_mfma_f32_16x16x32_bf16 v[88:91], a[64:67], v[180:183], v[88:91]
  ds_read_b64_tr_b16 a[64:65], v242 offset:32768
  v_mfma_f32_16x16x32_bf16 v[76:79], a[68:71], v[176:179], v[76:79]
  ds_read_b64_tr_b16 a[66:67], v242 offset:36864
  v_mfma_f32_16x16x32_bf16 v[92:95], a[68:71], v[180:183], v[92:95]
  ds_read_b64_tr_b16 a[68:69], v243 offset:32768
  v_mfma_f32_16x16x32_bf16 v[80:83], a[72:75], v[176:179], v[80:83]
  ds_read_b64_tr_b16 a[70:71], v243 offset:36864
  v_mfma_f32_16x16x32_bf16 v[96:99], a[72:75], v[180:183], v[96:99]
  ds_read_b64_tr_b16 a[72:73], v244 offset:32768
  s_waitcnt lgkmcnt(10)
  v_mfma_f32_16x16x32_bf16 v[84:87], a[76:79], v[176:179], v[84:87]
  ds_read_b64_tr_b16 a[74:75], v244 offset:36864
  v_mfma_f32_16x16x32_bf16 v[100:103], a[76:79], v[180:183], v[100:103]
  ds_read_b64_tr_b16 a[76:77], v245 offset:32768
  v_mfma_f32_16x16x32_bf16 v[72:75], a[96:99], v[184:187], v[72:75]
  ds_read_b64_tr_b16 a[78:79], v245 offset:36864
  v_mfma_f32_16x16x32_bf16 v[88:91], a[96:99], v[188:191], v[88:91]
  ds_read_b64_tr_b16 a[96:97], v242 offset:40960
  v_mfma_f32_16x16x32_bf16 v[76:79], a[100:103], v[184:187], v[76:79]
  ds_read_b64_tr_b16 a[98:99], v242 offset:45056
  v_mfma_f32_16x16x32_bf16 v[92:95], a[100:103], v[188:191], v[92:95]
  ds_read_b64_tr_b16 a[100:101], v243 offset:40960
  v_mfma_f32_16x16x32_bf16 v[80:83], a[104:107], v[184:187], v[80:83]
  ds_read_b64_tr_b16 a[102:103], v243 offset:45056
  v_mfma_f32_16x16x32_bf16 v[96:99], a[104:107], v[188:191], v[96:99]
  ds_read_b64_tr_b16 a[104:105], v244 offset:40960
  v_mfma_f32_16x16x32_bf16 v[84:87], a[108:111], v[184:187], v[84:87]
  ds_read_b64_tr_b16 a[106:107], v244 offset:45056
  v_mfma_f32_16x16x32_bf16 v[100:103], a[108:111], v[188:191], v[100:103]
  ds_read_b64_tr_b16 a[108:109], v245 offset:40960
  ds_read_b64_tr_b16 a[110:111], v245 offset:45056
  s_waitcnt vmcnt(0) lgkmcnt(10)
  s_barrier
  v_mfma_f32_16x16x32_bf16 v[16:19], a[80:83], v[128:131], v[16:19]
  v_mfma_f32_16x16x32_bf16 v[32:35], a[80:83], v[132:135], v[32:35]
  ds_read_b64_tr_b16 a[80:81], v242 offset:51200
  v_mfma_f32_16x16x32_bf16 v[20:23], a[84:87], v[128:131], v[20:23]
  ds_read_b64_tr_b16 a[82:83], v242 offset:55296
  v_mfma_f32_16x16x32_bf16 v[36:39], a[84:87], v[132:135], v[36:39]
  ds_read_b64_tr_b16 a[84:85], v243 offset:51200
  v_cvt_pk_bf16_f32 v108, v72, v73
  v_cvt_pk_bf16_f32 v109, v74, v75
  v_cvt_pk_bf16_f32 v110, v76, v77
  v_cvt_pk_bf16_f32 v111, v78, v79
  buffer_store_dwordx4 v[108:111], v50, s[52:55], s39 offen offset:0 sc1
  v_mfma_f32_16x16x32_bf16 v[24:27], a[88:91], v[128:131], v[24:27]
  ds_read_b64_tr_b16 a[86:87], v243 offset:55296
  v_cvt_pk_bf16_f32 v116, v88, v89
  v_cvt_pk_bf16_f32 v117, v90, v91
  v_cvt_pk_bf16_f32 v118, v92, v93
  v_cvt_pk_bf16_f32 v119, v94, v95
  buffer_store_dwordx4 v[116:119], v50, s[52:55], s39 offen offset:2048 sc1
  v_mfma_f32_16x16x32_bf16 v[40:43], a[88:91], v[132:135], v[40:43]
  ds_read_b64_tr_b16 a[88:89], v244 offset:51200
  v_mfma_f32_16x16x32_bf16 v[28:31], a[92:95], v[128:131], v[28:31]
  ds_read_b64_tr_b16 a[90:91], v244 offset:55296
  v_mfma_f32_16x16x32_bf16 v[44:47], a[92:95], v[132:135], v[44:47]
  ds_read_b64_tr_b16 a[92:93], v245 offset:51200
  v_cvt_pk_bf16_f32 v112, v80, v81
  v_cvt_pk_bf16_f32 v113, v82, v83
  v_cvt_pk_bf16_f32 v114, v84, v85
  v_cvt_pk_bf16_f32 v115, v86, v87
  buffer_store_dwordx4 v[112:115], v50, s[52:55], s39 offen offset:1024 sc1
  v_mfma_f32_16x16x32_bf16 v[16:19], a[112:115], v[136:139], v[16:19]
  ds_read_b64_tr_b16 a[94:95], v245 offset:55296
  v_cvt_pk_bf16_f32 v120, v96, v97
  v_cvt_pk_bf16_f32 v121, v98, v99
  v_cvt_pk_bf16_f32 v122, v100, v101
  v_cvt_pk_bf16_f32 v123, v102, v103
  buffer_store_dwordx4 v[120:123], v50, s[52:55], s39 offen offset:3072 sc1
  v_mfma_f32_16x16x32_bf16 v[32:35], a[112:115], v[140:143], v[32:35]
  ds_read_b64_tr_b16 a[112:113], v242 offset:59392
  v_mfma_f32_16x16x32_bf16 v[20:23], a[116:119], v[136:139], v[20:23]
  ds_read_b64_tr_b16 a[114:115], v242 offset:63488
  v_mfma_f32_16x16x32_bf16 v[36:39], a[116:119], v[140:143], v[36:39]
  ds_read_b64_tr_b16 a[116:117], v243 offset:59392
  v_mfma_f32_16x16x32_bf16 v[24:27], a[120:123], v[136:139], v[24:27]
  ds_read_b64_tr_b16 a[118:119], v243 offset:63488
  v_mfma_f32_16x16x32_bf16 v[40:43], a[120:123], v[140:143], v[40:43]
  ds_read_b64_tr_b16 a[120:121], v244 offset:59392
  v_mfma_f32_16x16x32_bf16 v[28:31], a[124:127], v[136:139], v[28:31]
  ds_read_b64_tr_b16 a[122:123], v244 offset:63488
  v_mfma_f32_16x16x32_bf16 v[44:47], a[124:127], v[140:143], v[44:47]
  ds_read_b64_tr_b16 a[124:125], v245 offset:59392
  v_mfma_f32_16x16x32_bf16 v[16:19], a[64:67], v[144:147], v[16:19]
  ds_read_b64_tr_b16 a[126:127], v245 offset:63488
  v_mfma_f32_16x16x32_bf16 v[32:35], a[64:67], v[148:151], v[32:35]
  ds_read_b64_tr_b16 a[64:65], v242 offset:49152
  v_mfma_f32_16x16x32_bf16 v[20:23], a[68:71], v[144:147], v[20:23]
  ds_read_b64_tr_b16 a[66:67], v242 offset:53248
  v_mfma_f32_16x16x32_bf16 v[36:39], a[68:71], v[148:151], v[36:39]
  ds_read_b64_tr_b16 a[68:69], v243 offset:49152
  v_mfma_f32_16x16x32_bf16 v[24:27], a[72:75], v[144:147], v[24:27]
  ds_read_b64_tr_b16 a[70:71], v243 offset:53248
  v_mfma_f32_16x16x32_bf16 v[40:43], a[72:75], v[148:151], v[40:43]
  ds_read_b64_tr_b16 a[72:73], v244 offset:49152
  s_waitcnt lgkmcnt(10)
  v_mfma_f32_16x16x32_bf16 v[28:31], a[76:79], v[144:147], v[28:31]
  ds_read_b64_tr_b16 a[74:75], v244 offset:53248
  v_mfma_f32_16x16x32_bf16 v[44:47], a[76:79], v[148:151], v[44:47]
  ds_read_b64_tr_b16 a[76:77], v245 offset:49152
  v_mfma_f32_16x16x32_bf16 v[16:19], a[96:99], v[152:155], v[16:19]
  ds_read_b64_tr_b16 a[78:79], v245 offset:53248
  v_mfma_f32_16x16x32_bf16 v[32:35], a[96:99], v[156:159], v[32:35]
  ds_read_b64_tr_b16 a[96:97], v242 offset:57344
  v_mfma_f32_16x16x32_bf16 v[20:23], a[100:103], v[152:155], v[20:23]
  ds_read_b64_tr_b16 a[98:99], v242 offset:61440
  v_mfma_f32_16x16x32_bf16 v[36:39], a[100:103], v[156:159], v[36:39]
  ds_read_b64_tr_b16 a[100:101], v243 offset:57344
  v_mfma_f32_16x16x32_bf16 v[24:27], a[104:107], v[152:155], v[24:27]
  ds_read_b64_tr_b16 a[102:103], v243 offset:61440
  v_mfma_f32_16x16x32_bf16 v[40:43], a[104:107], v[156:159], v[40:43]
  ds_read_b64_tr_b16 a[104:105], v244 offset:57344
  v_mfma_f32_16x16x32_bf16 v[28:31], a[108:111], v[152:155], v[28:31]
  ds_read_b64_tr_b16 a[106:107], v244 offset:61440
  v_mfma_f32_16x16x32_bf16 v[44:47], a[108:111], v[156:159], v[44:47]
  ds_read_b64_tr_b16 a[108:109], v245 offset:57344
  ds_read_b64_tr_b16 a[110:111], v245 offset:61440
  s_waitcnt vmcnt(63) lgkmcnt(10)
  s_barrier
  v_accvgpr_read_b32 v0, a128
  v_accvgpr_read_b32 v1, a129
  v_mfma_f32_16x16x32_bf16 v[16:19], a[80:83], v[160:163], v[16:19]
  v_accvgpr_read_b32 v2, a130
  v_accvgpr_read_b32 v3, a131
  v_mfma_f32_16x16x32_bf16 v[32:35], a[80:83], v[164:167], v[32:35]
  v_accvgpr_read_b32 v4, a132
  v_mfma_f32_16x16x32_bf16 v[20:23], a[84:87], v[160:163], v[20:23]
  v_accvgpr_read_b32 v5, a133
  v_accvgpr_read_b32 v6, a134
  v_mfma_f32_16x16x32_bf16 v[36:39], a[84:87], v[164:167], v[36:39]
  v_accvgpr_read_b32 v7, a135
  v_mfma_f32_16x16x32_bf16 v[24:27], a[88:91], v[160:163], v[24:27]
  v_accvgpr_read_b32 v8, a136
  v_accvgpr_read_b32 v9, a137
  v_mfma_f32_16x16x32_bf16 v[40:43], a[88:91], v[164:167], v[40:43]
  v_accvgpr_read_b32 v10, a138
  v_accvgpr_read_b32 v11, a139
  v_mfma_f32_16x16x32_bf16 v[28:31], a[92:95], v[160:163], v[28:31]
  v_accvgpr_read_b32 v12, a140
  v_mfma_f32_16x16x32_bf16 v[44:47], a[92:95], v[164:167], v[44:47]
  v_accvgpr_read_b32 v13, a141
  v_accvgpr_read_b32 v14, a142
  v_mfma_f32_16x16x32_bf16 v[16:19], a[112:115], v[168:171], v[16:19]
  v_accvgpr_read_b32 v15, a143
  v_mfma_f32_16x16x32_bf16 v[32:35], a[112:115], v[172:175], v[32:35]
  v_lshlrev_b32 v192, 16, v0
  v_and_b32 v193, 0xffff0000, v0
  v_mfma_f32_16x16x32_bf16 v[20:23], a[116:119], v[168:171], v[20:23]
  v_lshlrev_b32 v194, 16, v1
  v_and_b32 v195, 0xffff0000, v1
  v_mfma_f32_16x16x32_bf16 v[36:39], a[116:119], v[172:175], v[36:39]
  v_lshlrev_b32 v196, 16, v2
  v_mfma_f32_16x16x32_bf16 v[24:27], a[120:123], v[168:171], v[24:27]
  v_and_b32 v197, 0xffff0000, v2
  v_lshlrev_b32 v198, 16, v3
  v_mfma_f32_16x16x32_bf16 v[40:43], a[120:123], v[172:175], v[40:43]
  v_and_b32 v199, 0xffff0000, v3
  v_mfma_f32_16x16x32_bf16 v[28:31], a[124:127], v[168:171], v[28:31]
  v_lshlrev_b32 v200, 16, v4
  v_and_b32 v201, 0xffff0000, v4
  v_mfma_f32_16x16x32_bf16 v[44:47], a[124:127], v[172:175], v[44:47]
  v_lshlrev_b32 v202, 16, v5
  v_and_b32 v203, 0xffff0000, v5
  v_mfma_f32_16x16x32_bf16 v[16:19], a[64:67], v[176:179], v[16:19]
  v_lshlrev_b32 v204, 16, v6
  v_mfma_f32_16x16x32_bf16 v[32:35], a[64:67], v[180:183], v[32:35]
  v_and_b32 v205, 0xffff0000, v6
  v_lshlrev_b32 v206, 16, v7
  v_mfma_f32_16x16x32_bf16 v[20:23], a[68:71], v[176:179], v[20:23]
  v_and_b32 v207, 0xffff0000, v7
  v_mfma_f32_16x16x32_bf16 v[36:39], a[68:71], v[180:183], v[36:39]
  v_lshlrev_b32 v208, 16, v8
  v_and_b32 v209, 0xffff0000, v8
  ds_read_b128 v[56:59], v253 offset:768
  buffer_load_dwordx4 v[108:111], v50, s[52:55], s36 offen offset:0 sc1
  v_mfma_f32_16x16x32_bf16 v[24:27], a[72:75], v[176:179], v[24:27]
  v_lshlrev_b32 v210, 16, v9
  v_and_b32 v211, 0xffff0000, v9
  ds_read_b128 v[60:63], v253 offset:832
  buffer_load_dwordx4 v[112:115], v50, s[52:55], s36 offen offset:1024 sc1
  v_mfma_f32_16x16x32_bf16 v[40:43], a[72:75], v[180:183], v[40:43]
  v_lshlrev_b32 v212, 16, v10
  ds_read_b128 v[64:67], v253 offset:896
  buffer_load_dwordx4 v[116:119], v50, s[52:55], s36 offen offset:2048 sc1
  s_waitcnt lgkmcnt(10)
  v_mfma_f32_16x16x32_bf16 v[28:31], a[76:79], v[176:179], v[28:31]
  v_and_b32 v213, 0xffff0000, v10
  v_lshlrev_b32 v214, 16, v11
  ds_read_b128 v[68:71], v253 offset:960
  buffer_load_dwordx4 v[120:123], v50, s[52:55], s36 offen offset:3072 sc1
  v_mfma_f32_16x16x32_bf16 v[44:47], a[76:79], v[180:183], v[44:47]
  v_and_b32 v215, 0xffff0000, v11
  s_waitcnt lgkmcnt(10)
  v_mfma_f32_16x16x32_bf16 v[16:19], a[96:99], v[184:187], v[16:19]
  v_lshlrev_b32 v216, 16, v12
  v_and_b32 v217, 0xffff0000, v12
  v_mfma_f32_16x16x32_bf16 v[32:35], a[96:99], v[188:191], v[32:35]
  v_lshlrev_b32 v218, 16, v13
  v_and_b32 v219, 0xffff0000, v13
  s_waitcnt lgkmcnt(8)
  v_mfma_f32_16x16x32_bf16 v[20:23], a[100:103], v[184:187], v[20:23]
  v_lshlrev_b32 v220, 16, v14
  v_mfma_f32_16x16x32_bf16 v[36:39], a[100:103], v[188:191], v[36:39]
  v_and_b32 v221, 0xffff0000, v14
  v_lshlrev_b32 v222, 16, v15
  s_waitcnt lgkmcnt(6)
  v_mfma_f32_16x16x32_bf16 v[24:27], a[104:107], v[184:187], v[24:27]
  v_and_b32 v223, 0xffff0000, v15
  v_mfma_f32_16x16x32_bf16 v[40:43], a[104:107], v[188:191], v[40:43]
  s_waitcnt lgkmcnt(4)
  v_mfma_f32_16x16x32_bf16 v[28:31], a[108:111], v[184:187], v[28:31]
  v_mfma_f32_16x16x32_bf16 v[44:47], a[108:111], v[188:191], v[44:47]
  s_nop 7
  s_nop 1
  s_waitcnt lgkmcnt(0)
  v_pk_fma_f32 v[192:193], v[16:17], v[56:57], v[192:193]
  v_pk_fma_f32 v[194:195], v[18:19], v[58:59], v[194:195]
  v_pk_fma_f32 v[196:197], v[20:21], v[60:61], v[196:197]
  v_pk_fma_f32 v[198:199], v[22:23], v[62:63], v[198:199]
  v_pk_fma_f32 v[200:201], v[24:25], v[64:65], v[200:201]
  v_pk_fma_f32 v[202:203], v[26:27], v[66:67], v[202:203]
  v_pk_fma_f32 v[204:205], v[28:29], v[68:69], v[204:205]
  v_pk_fma_f32 v[206:207], v[30:31], v[70:71], v[206:207]
  v_pk_fma_f32 v[208:209], v[32:33], v[56:57], v[208:209]
  v_pk_fma_f32 v[210:211], v[34:35], v[58:59], v[210:211]
  v_pk_fma_f32 v[212:213], v[36:37], v[60:61], v[212:213]
  v_pk_fma_f32 v[214:215], v[38:39], v[62:63], v[214:215]
  v_pk_fma_f32 v[216:217], v[40:41], v[64:65], v[216:217]
  v_pk_fma_f32 v[218:219], v[42:43], v[66:67], v[218:219]
  v_pk_fma_f32 v[220:221], v[44:45], v[68:69], v[220:221]
  v_pk_fma_f32 v[222:223], v[46:47], v[70:71], v[222:223]
  s_mov_b32 s60, 0x40000
  s_branch L_chk_41
L_poll_39:
  buffer_load_dwordx4 v[108:111], v50, s[52:55], s36 offen offset:0 sc1
  buffer_load_dwordx4 v[112:115], v50, s[52:55], s36 offen offset:1024 sc1
  buffer_load_dwordx4 v[116:119], v50, s[52:55], s36 offen offset:2048 sc1
  buffer_load_dwordx4 v[120:123], v50, s[52:55], s36 offen offset:3072 sc1
L_chk_41:
  s_waitcnt vmcnt(3)
  v_max3_u32 v51, v108, v109, v110
  v_max_u32 v51, v51, v111
  s_waitcnt vmcnt(2)
  v_max3_u32 v51, v51, v112, v113
  v_max3_u32 v51, v51, v114, v115
  s_waitcnt vmcnt(1)
  v_max3_u32 v51, v51, v116, v117
  v_max3_u32 v51, v51, v118, v119
  s_waitcnt vmcnt(0)
  v_max3_u32 v51, v51, v120, v121
  v_max3_u32 v51, v51, v122, v123
  v_cmp_eq_u32 vcc, -1, v51
  s_nop 1
  s_cmp_eq_u64 vcc, 0
  s_cbranch_scc1 L_ready_40
  s_sub_u32 s60, s60, 1
  s_cmp_lg_u32 s60, 0
  s_cbranch_scc1 L_poll_39
L_ready_40:
  v_lshlrev_b32 v72, 16, v108
  v_and_b32 v73, 0xffff0000, v108
  v_lshlrev_b32 v74, 16, v109
  v_and_b32 v75, 0xffff0000, v109
  v_pk_fma_f32 v[192:193], v[72:73], v[56:57], v[192:193]
  v_pk_fma_f32 v[194:195], v[74:75], v[58:59], v[194:195]
  v_cvt_pk_bf16_f32 v0, v192, v193
  v_cvt_pk_bf16_f32 v1, v194, v195
  v_lshlrev_b32 v76, 16, v110
  v_and_b32 v77, 0xffff0000, v110
  v_lshlrev_b32 v78, 16, v111
  v_and_b32 v79, 0xffff0000, v111
  v_pk_fma_f32 v[196:197], v[76:77], v[60:61], v[196:197]
  v_pk_fma_f32 v[198:199], v[78:79], v[62:63], v[198:199]
  v_cvt_pk_bf16_f32 v2, v196, v197
  v_cvt_pk_bf16_f32 v3, v198, v199
  s_nop 1
  v_permlane16_swap_b32 v0, v2
  v_permlane16_swap_b32 v1, v3
  s_nop 1
  buffer_store_dwordx4 v[0:3], v252, s[44:47], 0 offen offset:0 sc1
  v_lshlrev_b32 v80, 16, v112
  v_and_b32 v81, 0xffff0000, v112
  v_lshlrev_b32 v82, 16, v113
  v_and_b32 v83, 0xffff0000, v113
  v_pk_fma_f32 v[200:201], v[80:81], v[64:65], v[200:201]
  v_pk_fma_f32 v[202:203], v[82:83], v[66:67], v[202:203]
  v_cvt_pk_bf16_f32 v4, v200, v201
  v_cvt_pk_bf16_f32 v5, v202, v203
  v_lshlrev_b32 v84, 16, v114
  v_and_b32 v85, 0xffff0000, v114
  v_lshlrev_b32 v86, 16, v115
  v_and_b32 v87, 0xffff0000, v115
  v_pk_fma_f32 v[204:205], v[84:85], v[68:69], v[204:205]
  v_pk_fma_f32 v[206:207], v[86:87], v[70:71], v[206:207]
  v_cvt_pk_bf16_f32 v6, v204, v205
  v_cvt_pk_bf16_f32 v7, v206, v207
  s_nop 1
  v_permlane16_swap_b32 v4, v6
  v_permlane16_swap_b32 v5, v7
  s_nop 1
  buffer_store_dwordx4 v[4:7], v252, s[44:47], 0 offen offset:64 sc1
  v_lshlrev_b32 v88, 16, v116
  v_and_b32 v89, 0xffff0000, v116
  v_lshlrev_b32 v90, 16, v117
  v_and_b32 v91, 0xffff0000, v117
  v_pk_fma_f32 v[208:209], v[88:89], v[56:57], v[208:209]
  v_pk_fma_f32 v[210:211], v[90:91], v[58:59], v[210:211]
  v_cvt_pk_bf16_f32 v8, v208, v209
  v_cvt_pk_bf16_f32 v9, v210, v211
  v_lshlrev_b32 v92, 16, v118
  v_and_b32 v93, 0xffff0000, v118
  v_lshlrev_b32 v94, 16, v119
  v_and_b32 v95, 0xffff0000, v119
  v_pk_fma_f32 v[212:213], v[92:93], v[60:61], v[212:213]
  v_pk_fma_f32 v[214:215], v[94:95], v[62:63], v[214:215]
  v_cvt_pk_bf16_f32 v10, v212, v213
  v_cvt_pk_bf16_f32 v11, v214, v215
  s_nop 1
  v_permlane16_swap_b32 v8, v10
  v_permlane16_swap_b32 v9, v11
  s_nop 1
  buffer_store_dwordx4 v[8:11], v252, s[44:47], s43 offen offset:0 sc1
  v_lshlrev_b32 v96, 16, v120
  v_and_b32 v97, 0xffff0000, v120
  v_lshlrev_b32 v98, 16, v121
  v_and_b32 v99, 0xffff0000, v121
  v_pk_fma_f32 v[216:217], v[96:97], v[64:65], v[216:217]
  v_pk_fma_f32 v[218:219], v[98:99], v[66:67], v[218:219]
  v_cvt_pk_bf16_f32 v12, v216, v217
  v_cvt_pk_bf16_f32 v13, v218, v219
  v_lshlrev_b32 v100, 16, v122
  v_and_b32 v101, 0xffff0000, v122
  v_lshlrev_b32 v102, 16, v123
  v_and_b32 v103, 0xffff0000, v123
  v_pk_fma_f32 v[220:221], v[100:101], v[68:69], v[220:221]
  v_pk_fma_f32 v[222:223], v[102:103], v[70:71], v[222:223]
  v_cvt_pk_bf16_f32 v14, v220, v221
  v_cvt_pk_bf16_f32 v15, v222, v223
  s_nop 1
  v_permlane16_swap_b32 v12, v14
  v_permlane16_swap_b32 v13, v15
  s_nop 1
  buffer_store_dwordx4 v[12:15], v252, s[44:47], s43 offen offset:64 sc1
  s_endpgm
L_slow_29:
  s_mov_b32 s69, 262144
L_spin_42:
  buffer_load_dword v247, v246, s[64:67], s68 offen sc1
  s_waitcnt vmcnt(0)
  v_cmp_ne_u32 vcc, 1, v247
  s_nop 1
  s_cmp_eq_u64 vcc, 0
  s_cbranch_scc1 L_back_30
  s_sub_u32 s69, s69, 1
  s_cmp_lg_u32 s69, 0
  s_cbranch_scc1 L_spin_42
  s_branch L_back_30
L_slow_33:
  s_mov_b32 s60, 0x40000
L_spin_43:
  buffer_load_dword v247, v246, s[56:59], s94 offen sc1
  s_waitcnt vmcnt(0)
  v_cmp_ne_u32 vcc, 1, v247
  s_nop 1
  s_cmp_eq_u64 vcc, 0
  s_cbranch_scc1 L_back_34
  s_sub_u32 s60, s60, 1
  s_cmp_lg_u32 s60, 0
  s_cbranch_scc1 L_spin_43
  s_branch L_back_34
L_slow_35:
  s_mov_b32 s60, 0x40000
L_spin_44:
  buffer_load_dword v247, v246, s[56:59], s94 offen sc1
  s_waitcnt vmcnt(0)
  v_cmp_ne_u32 vcc, 1, v247
  s_nop 1
  s_cmp_eq_u64 vcc, 0
  s_cbranch_scc1 L_back_36
  s_sub_u32 s60, s60, 1
  s_cmp_lg_u32 s60, 0
  s_cbranch_scc1 L_spin_44
  s_branch L_back_36
L_slow_37:
  s_mov_b32 s60, 0x40000
L_spin_45:
  buffer_load_dword v247, v246, s[56:59], s94 offen sc1
  s_waitcnt vmcnt(0)
  v_cmp_ne_u32 vcc, 1, v247
  s_nop 1
  s_cmp_eq_u64 vcc, 0
  s_cbranch_scc1 L_back_38
  s_sub_u32 s60, s60, 1
  s_cmp_lg_u32 s60, 0
  s_cbranch_scc1 L_spin_45
  s_branch L_back_38
L_end_24:
  s_endpgm
L_code_end:
  s_endpgm
.section .rodata,"a"
.p2align 6
.amdhsa_kernel k2_kernel
  .amdhsa_next_free_vgpr 256
  .amdhsa_next_free_sgpr 102
  .amdhsa_accum_offset 256
  .amdhsa_group_segment_fixed_size 0
  .amdhsa_kernarg_size 96
  .amdhsa_user_sgpr_count 2
  .amdhsa_user_sgpr_kernarg_segment_ptr 1
  .amdhsa_system_sgpr_workgroup_id_x 1
  .amdhsa_float_denorm_mode_32 3
.end_amdhsa_kernel
.p2align 6
.amdhsa_kernel k5_kernel
  .amdhsa_next_free_vgpr 400
  .amdhsa_next_free_sgpr 102
  .amdhsa_accum_offset 256
  .amdhsa_group_segment_fixed_size 0
  .amdhsa_kernarg_size 96
  .amdhsa_user_sgpr_count 2
  .amdhsa_user_sgpr_kernarg_segment_ptr 1
  .amdhsa_system_sgpr_workgroup_id_x 1
  .amdhsa_float_denorm_mode_32 3
.end_amdhsa_kernel
```

```asm
; @launch grid=(256,1,1) block=(256,1,1) lds=163840
.amdgcn_target "amdgcn-amd-amdhsa--gfx950"
.text
.globl adaLN_cond__sliding_local_dilated__glu_gated_glu__prompt_kernel
.p2align 8
.type adaLN_cond__sliding_local_dilated__glu_gated_glu__prompt_kernel,@function
adaLN_cond__sliding_local_dilated__glu_gated_glu__prompt_kernel:
  s_cmp_ge_u32 s2, 256
  s_cbranch_scc1 L_end_1
  s_load_dwordx2 s[44:45], s[0:1], 56
  s_load_dwordx2 s[52:53], s[0:1], 64
  s_load_dwordx2 s[12:13], s[0:1], 0
  s_load_dwordx2 s[20:21], s[0:1], 88
  s_load_dwordx2 s[8:9], s[0:1], 8
  s_getpc_b64 s[58:59]
  v_and_b32 v86, 31, v0
  v_lshlrev_b32 v86, 7, v86
  global_load_dword v131, v86, s[58:59] offset:128
  v_lshrrev_b32 v110, 6, v0
  v_and_b32 v104, 63, v0
  s_nop 0
  v_readfirstlane_b32 s3, v110
  s_and_b32 s29, s2, 3
  s_and_b32 s28, s2, 4
  s_lshl_b32 s28, s28, 3
  s_lshr_b32 s31, s2, 3
  s_or_b32 s28, s28, s31
  v_lshrrev_b32 v1, 2, v104
  v_mul_u32_u24 v1, 12288, v1
  v_and_b32 v66, 3, v104
  v_lshl_add_u32 v1, v66, 4, v1
  v_lshlrev_b32 v2, 1, v0
  s_lshl2_add_u32 s30, s29, s3
  s_mul_i32 s50, s30, 786432
  s_lshl_b32 s31, s28, 6
  s_add_u32 s35, s50, s31
  s_lshl_b32 s34, s29, 9
  s_lshl_b32 s31, s3, 12
  s_add_u32 m0, s31, 79872
  v_and_b32 v66, 7, v104
  v_lshlrev_b32 v3, 11, v66
  v_lshrrev_b32 v67, 3, v104
  v_lshl_add_u32 v3, v67, 4, v3
  s_lshl_b32 s36, s2, 14
  s_lshl_b32 s31, s3, 9
  s_add_u32 s36, s36, s31
  s_movk_i32 s46, 2048
  s_mov_b32 s47, 0x20000
  s_mov_b32 s54, 12582912
  s_mov_b32 s55, 0x20000
  s_mov_b32 s14, 4194304
  s_mov_b32 s15, 0x20000
  s_waitcnt lgkmcnt(0)
  s_load_dword s19, s[20:21], 0x40000
  buffer_load_ushort v4, v2, s[44:47], s34 offen
  buffer_load_dwordx4 v1, s[52:55], s35 offen offset:0 lds
  s_add_u32 s35, s35, 195584
  buffer_load_dwordx4 v1, s[52:55], s35 offen offset:1024 lds
  s_add_u32 s35, s35, 195584
  buffer_load_dwordx4 v1, s[52:55], s35 offen offset:2048 lds
  s_add_u32 s35, s35, 195584
  buffer_load_dwordx4 v1, s[52:55], s35 offen offset:3072 lds
  s_barrier
  buffer_load_dwordx4 v[8:11], v3, s[12:15], s36 offen offset:0
  buffer_load_dwordx4 v[12:15], v3, s[12:15], s36 offen offset:128
  buffer_load_dwordx4 v[16:19], v3, s[12:15], s36 offen offset:256
  buffer_load_dwordx4 v[20:23], v3, s[12:15], s36 offen offset:384
  s_load_dwordx2 s[24:25], s[0:1], 16
  s_load_dwordx4 s[60:63], s[0:1], 32
  s_load_dwordx2 s[22:23], s[0:1], 48
  s_load_dwordx2 s[90:91], s[0:1], 72
  s_mov_b64 s[26:27], s[12:13]
  s_and_b32 s30, s2, 1
  s_lshl_b32 s30, s30, 3
  s_bfe_u32 s31, s2, 0x30003
  s_add_u32 s30, s30, s31
  s_bfe_u32 s31, s2, 0x20001
  s_lshl_b32 s31, s31, 2
  s_lshr_b32 s34, s2, 6
  s_add_u32 s31, s31, s34
  v_and_b32 v111, 2, v67
  v_xor_b32 v111, v111, v66
  v_mul_u32_u24 v129, 12288, v67
  v_lshl_add_u32 v129, v111, 4, v129
  s_and_b32 s33, s3, 1
  s_lshl_b32 s33, s33, 2
  v_xor_b32 v111, s33, v111
  v_mul_u32_u24 v110, 6144, v67
  v_lshl_add_u32 v110, v111, 4, v110
  s_mul_i32 s32, s3, 49152
  s_lshl_b32 s33, s31, 7
  s_add_u32 s32, s32, s33
  v_add_u32 v107, s32, v110
  v_add_u32 v108, 1024, v107
  v_add_u32 v109, 2048, v107
  s_mul_i32 s38, s3, 3072
  s_and_b32 s33, s30, 7
  s_mul_i32 s16, s33, 131072
  s_mul_i32 s17, s33, 196608
  s_mov_b32 s10, 1572864
  s_mov_b32 s11, 0x20000
  s_barrier
  s_getpc_b64 s[100:101]
  L_pc_2:
  s_add_u32 s100, s100, L_gemm_a-L_pc_2
  s_addc_u32 s101, s101, 0
  s_lshr_b32 s33, s2, 3
  s_lshl_b32 s33, s33, 2
  s_add_u32 s33, s33, s3
  s_lshl_b32 s33, s33, 13
  v_lshlrev_b32 v200, 7, v104
  v_add_u32 v200, s33, v200
  v_min_u32 v200, L_code_end-L_gemm_a-4, v200
  v_mov_b32 v201, s101
  v_add_co_u32 v200, vcc, s100, v200
  s_nop 1
  v_addc_co_u32 v201, vcc, 0, v201, vcc
  global_load_dword v131, v[200:201], off
  v_lshrrev_b32 v68, 4, v104
  v_bfe_u32 v69, v104, 2, 2
  v_lshl_add_u32 v69, v68, 3, v69
  v_and_b32 v70, 3, v104
  v_lshlrev_b32 v70, 3, v70
  s_lshl_b32 s33, s3, 5
  s_add_u32 s33, s33, 106496
  v_add_u32 v70, s33, v70
  v_lshl_add_u32 v5, v69, 6, v70
  v_subrev_u32 v5, 26624, v5
  v_lshl_add_u32 v196, v69, 7, v70
  v_and_b32 v70, 8, v104
  v_lshlrev_b32 v70, 2, v70
  v_xor_b32 v196, v196, v70
  v_lshlrev_b32 v255, 4, v68
  v_add_u32 v197, 147456, v255
  v_and_b32 v70, 15, v104
  v_lshl_or_b32 v255, v70, 24, v255
  v_mov_b32 v198, 0xffffff00
  v_add_u32 v2, 147456, v2
  s_mov_b32 s12, s20
  s_mov_b32 s13, s21
  s_mov_b32 s14, 0x18000
  s_mov_b32 s15, 0x20000
  s_mul_i32 s96, s29, 24576
  s_lshl_b32 s33, s3, 6
  s_add_u32 s96, s96, s33
  s_lshl_b32 s33, s28, 7
  s_add_u32 s34, s96, s33
  s_add_u32 s96, s34, s33
  s_add_u32 s96, s96, 8192
  s_add_u32 s50, s50, s33
  s_add_u32 s50, s50, 4096
  s_lshl_b32 s51, s3, 13
  s_add_u32 s51, s51, 106496
  s_waitcnt vmcnt(9)
  v_lshlrev_b32 v4, 16, v4
  v_mul_f32 v6, 0xbfb8aa3b, v4
  v_exp_f32 v6, v6
  s_nop 0
  v_add_f32 v6, 1.0, v6
  v_rcp_f32 v6, v6
  s_nop 0
  v_mul_f32 v4, v4, v6
  v_cvt_pk_bf16_f32 v4, v4, v4
  ds_write_b16 v2, v4
  s_waitcnt vmcnt(5) lgkmcnt(0)
  s_barrier
  s_mul_i32 s19, s19, 0x9e3779b1
  s_add_u32 s19, s19, 0x7f4a7c15
  s_bfe_u32 s40, s19, 0x80000
  s_bfe_u32 s41, s19, 0x80008
  s_bfe_u32 s42, s19, 0x80010
  s_bfe_u32 s43, s19, 0x80018
  s_cmp_ge_u32 s3, 2
  s_cbranch_scc1 L_nog_3
  ds_read_b64_tr_b16 a[64:65], v5 offset:0
  ds_read_b64_tr_b16 a[66:67], v5 offset:256
  ds_read_b128 a[68:71], v197 offset:0
  ds_read_b64_tr_b16 a[72:73], v5 offset:2048
  ds_read_b64_tr_b16 a[74:75], v5 offset:2304
  ds_read_b128 a[76:79], v197 offset:64
  ds_read_b64_tr_b16 a[80:81], v5 offset:4096
  ds_read_b64_tr_b16 a[82:83], v5 offset:4352
  ds_read_b128 a[84:87], v197 offset:128
  ds_read_b64_tr_b16 a[88:89], v5 offset:6144
  ds_read_b64_tr_b16 a[90:91], v5 offset:6400
  ds_read_b128 a[92:95], v197 offset:192
  ds_read_b64_tr_b16 a[96:97], v5 offset:8192
  ds_read_b64_tr_b16 a[98:99], v5 offset:8448
  ds_read_b128 a[100:103], v197 offset:256
  s_waitcnt lgkmcnt(12)
  v_mfma_f32_16x16x32_bf16 v[192:195], a[64:67], a[68:71], 0
  ds_read_b64_tr_b16 a[104:105], v5 offset:10240
  ds_read_b64_tr_b16 a[106:107], v5 offset:10496
  ds_read_b128 a[108:111], v197 offset:320
  s_waitcnt lgkmcnt(12)
  v_mfma_f32_16x16x32_bf16 v[192:195], a[72:75], a[76:79], v[192:195]
  ds_read_b64_tr_b16 a[112:113], v5 offset:12288
  ds_read_b64_tr_b16 a[114:115], v5 offset:12544
  ds_read_b128 a[116:119], v197 offset:384
  s_waitcnt lgkmcnt(12)
  v_mfma_f32_16x16x32_bf16 v[192:195], a[80:83], a[84:87], v[192:195]
  ds_read_b64_tr_b16 a[120:121], v5 offset:14336
  ds_read_b64_tr_b16 a[122:123], v5 offset:14592
  ds_read_b128 a[124:127], v197 offset:448
  s_waitcnt lgkmcnt(12)
  v_mfma_f32_16x16x32_bf16 v[192:195], a[88:91], a[92:95], v[192:195]
  s_waitcnt lgkmcnt(9)
  v_mfma_f32_16x16x32_bf16 v[192:195], a[96:99], a[100:103], v[192:195]
  s_waitcnt lgkmcnt(6)
  v_mfma_f32_16x16x32_bf16 v[192:195], a[104:107], a[108:111], v[192:195]
  s_waitcnt lgkmcnt(3)
  v_mfma_f32_16x16x32_bf16 v[192:195], a[112:115], a[116:119], v[192:195]
  s_waitcnt lgkmcnt(0)
  v_mfma_f32_16x16x32_bf16 v[192:195], a[120:123], a[124:127], v[192:195]
  s_nop 7
  v_and_or_b32 v192, v192, v198, s40
  v_and_or_b32 v193, v193, v198, s41
  v_and_or_b32 v194, v194, v198, s42
  v_and_or_b32 v195, v195, v198, s43
  buffer_store_dwordx4 v[192:195], v255, s[12:15], s34 offen sc1
L_nog_3:
  s_waitcnt vmcnt(1)
  v_lshlrev_b32 v24, 16, v8
  v_and_b32 v25, 0xffff0000, v8
  v_lshlrev_b32 v26, 16, v9
  v_and_b32 v27, 0xffff0000, v9
  v_lshlrev_b32 v28, 16, v10
  v_and_b32 v29, 0xffff0000, v10
  v_lshlrev_b32 v30, 16, v11
  v_and_b32 v31, 0xffff0000, v11
  v_lshlrev_b32 v32, 16, v12
  v_and_b32 v33, 0xffff0000, v12
  v_lshlrev_b32 v34, 16, v13
  v_and_b32 v35, 0xffff0000, v13
  v_lshlrev_b32 v36, 16, v14
  v_and_b32 v37, 0xffff0000, v14
  v_lshlrev_b32 v38, 16, v15
  v_and_b32 v39, 0xffff0000, v15
  v_lshlrev_b32 v40, 16, v16
  v_and_b32 v41, 0xffff0000, v16
  v_lshlrev_b32 v42, 16, v17
  v_and_b32 v43, 0xffff0000, v17
  v_lshlrev_b32 v44, 16, v18
  v_and_b32 v45, 0xffff0000, v18
  v_lshlrev_b32 v46, 16, v19
  v_and_b32 v47, 0xffff0000, v19
  v_lshlrev_b32 v48, 16, v20
  v_and_b32 v49, 0xffff0000, v20
  v_lshlrev_b32 v50, 16, v21
  v_and_b32 v51, 0xffff0000, v21
  v_lshlrev_b32 v52, 16, v22
  v_and_b32 v53, 0xffff0000, v22
  v_lshlrev_b32 v54, 16, v23
  v_and_b32 v55, 0xffff0000, v23
  v_pk_add_f32 v[56:57], v[24:25], v[26:27]
  v_pk_mul_f32 v[58:59], v[24:25], v[24:25]
  v_pk_mul_f32 v[60:61], v[26:27], v[26:27]
  v_pk_add_f32 v[56:57], v[56:57], v[28:29]
  v_pk_fma_f32 v[58:59], v[28:29], v[28:29], v[58:59]
  v_pk_add_f32 v[56:57], v[56:57], v[30:31]
  v_pk_fma_f32 v[60:61], v[30:31], v[30:31], v[60:61]
  v_pk_add_f32 v[56:57], v[56:57], v[32:33]
  v_pk_fma_f32 v[58:59], v[32:33], v[32:33], v[58:59]
  v_pk_add_f32 v[56:57], v[56:57], v[34:35]
  v_pk_fma_f32 v[60:61], v[34:35], v[34:35], v[60:61]
  v_pk_add_f32 v[56:57], v[56:57], v[36:37]
  v_pk_fma_f32 v[58:59], v[36:37], v[36:37], v[58:59]
  v_pk_add_f32 v[56:57], v[56:57], v[38:39]
  v_pk_fma_f32 v[60:61], v[38:39], v[38:39], v[60:61]
  v_pk_add_f32 v[56:57], v[56:57], v[40:41]
  v_pk_fma_f32 v[58:59], v[40:41], v[40:41], v[58:59]
  v_pk_add_f32 v[56:57], v[56:57], v[42:43]
  v_pk_fma_f32 v[60:61], v[42:43], v[42:43], v[60:61]
  v_pk_add_f32 v[56:57], v[56:57], v[44:45]
  v_pk_fma_f32 v[58:59], v[44:45], v[44:45], v[58:59]
  v_pk_add_f32 v[56:57], v[56:57], v[46:47]
  v_pk_fma_f32 v[60:61], v[46:47], v[46:47], v[60:61]
  v_pk_add_f32 v[56:57], v[56:57], v[48:49]
  v_pk_fma_f32 v[58:59], v[48:49], v[48:49], v[58:59]
  v_pk_add_f32 v[56:57], v[56:57], v[50:51]
  v_pk_fma_f32 v[60:61], v[50:51], v[50:51], v[60:61]
  v_pk_add_f32 v[56:57], v[56:57], v[52:53]
  v_pk_fma_f32 v[58:59], v[52:53], v[52:53], v[58:59]
  v_pk_add_f32 v[56:57], v[56:57], v[54:55]
  v_pk_fma_f32 v[60:61], v[54:55], v[54:55], v[60:61]
  v_pk_add_f32 v[58:59], v[58:59], v[60:61]
  v_add_f32 v56, v56, v57
  v_add_f32 v57, v58, v59
  s_nop 1
  v_add_f32_dpp v56, v56, v56 row_ror:8 row_mask:0xf bank_mask:0xf
  v_add_f32_dpp v57, v57, v57 row_ror:8 row_mask:0xf bank_mask:0xf
  v_mov_b32 v58, v56
  v_mov_b32 v59, v57
  s_nop 1
  v_permlane16_swap_b32 v58, v56
  v_permlane16_swap_b32 v59, v57
  s_nop 1
  v_add_f32 v56, v56, v58
  v_add_f32 v57, v57, v59
  v_mov_b32 v58, v56
  v_mov_b32 v59, v57
  s_nop 1
  v_permlane32_swap_b32 v58, v56
  v_permlane32_swap_b32 v59, v57
  s_nop 1
  v_add_f32 v56, v56, v58
  v_add_f32 v57, v57, v59
  v_lshlrev_b32 v68, 5, v66
  v_add_u32 v68, 147968, v68
  s_lshl_b32 s33, s3, 3
  v_add_u32 v69, s33, v68
  ds_write_b64 v69, v[56:57]
  v_lshlrev_b32 v119, 4, v104
  s_lshl_b32 s33, s3, 10
  v_add_u32 v1, s33, v119
  v_add_u32 v2, 4096, v1
  s_lshl_b32 s33, s3, 11
  s_add_u32 s33, s33, 139264
  v_add_u32 v3, s33, v119
  v_lshlrev_b32 v4, 5, v67
  v_add_u32 v4, s33, v4
  v_lshrrev_b32 v5, 5, v104
  v_lshlrev_b32 v5, 17, v5
  v_and_b32 v70, 3, v67
  v_lshl_add_u32 v5, v70, 8, v5
  v_lshl_add_u32 v5, v66, 4, v5
  s_waitcnt lgkmcnt(0)
  s_barrier
  ds_read_b128 v[132:135], v68 offset:0
  ds_read_b128 v[136:139], v68 offset:16
  s_add_u32 m0, s38, 0
  s_nop 0
  buffer_load_dwordx4 v107, s[8:11], s17 offen lds
  buffer_load_dwordx4 v108, s[8:11], s17 offen offset:1024 lds
  buffer_load_dwordx4 v109, s[8:11], s17 offen offset:2048 lds
  s_add_u32 s17, s17, 196608
  s_cmp_eq_u32 s17, s10
  s_cselect_b32 s17, 0, s17
  s_mov_b32 s32, 24576
  s_mov_b32 s35, 49152
  s_mov_b32 s36, 73728
  s_add_u32 s4, s20, 0x200000
  s_addc_u32 s5, s21, 0
  s_mov_b32 s6, 0x400000
  s_mov_b32 s7, 0x20000
  s_add_u32 s64, s20, 0xc0000
  s_addc_u32 s65, s21, 0
  s_mov_b32 s66, 0x20000
  s_mov_b32 s67, 0x20000
  s_waitcnt lgkmcnt(0)
  v_pk_add_f32 v[132:133], v[132:133], v[134:135]
  v_pk_add_f32 v[136:137], v[136:137], v[138:139]
  v_pk_add_f32 v[132:133], v[132:133], v[136:137]
  v_mul_f32 v56, 0x3a800000, v132
  v_mul_f32 v60, 0x3a800000, v133
  v_fma_f32 v60, -v56, v56, v60
  v_max_f32 v60, 0, v60
  buffer_load_dwordx4 v[72:75], v1, s[12:15], 0 offen sc1
  buffer_load_dwordx4 v[76:79], v1, s[12:15], s32 offen sc1
  buffer_load_dwordx4 v[80:83], v1, s[12:15], s35 offen sc1
  buffer_load_dwordx4 v[84:87], v1, s[12:15], s36 offen sc1
  buffer_load_dwordx4 v[88:91], v2, s[12:15], 0 offen sc1
  buffer_load_dwordx4 v[92:95], v2, s[12:15], s32 offen sc1
  buffer_load_dwordx4 v[96:99], v2, s[12:15], s35 offen sc1
  buffer_load_dwordx4 v[100:103], v2, s[12:15], s36 offen sc1
  v_cvt_pk_bf16_f32 v64, v56, v60
  v_lshlrev_b32 v56, 16, v64
  v_and_b32 v60, 0xffff0000, v64
  v_add_f32 v60, 0x3727c5ac, v60
  v_cvt_pk_bf16_f32 v64, v60, v61
  v_lshlrev_b32 v60, 16, v64
  v_and_b32 v61, 0xffff0000, v64
  v_sqrt_f32 v60, v60
  s_nop 0
  v_cvt_pk_bf16_f32 v64, v60, v61
  v_lshlrev_b32 v60, 16, v64
  v_and_b32 v61, 0xffff0000, v64
  v_rcp_f32 v60, v60
  v_mov_b32 v57, v56
  s_nop 0
  v_mov_b32 v61, v60
  v_pk_add_f32 v[24:25], v[24:25], v[56:57] neg_lo:[0,1] neg_hi:[0,1]
  v_pk_add_f32 v[26:27], v[26:27], v[56:57] neg_lo:[0,1] neg_hi:[0,1]
  v_pk_add_f32 v[28:29], v[28:29], v[56:57] neg_lo:[0,1] neg_hi:[0,1]
  v_pk_add_f32 v[30:31], v[30:31], v[56:57] neg_lo:[0,1] neg_hi:[0,1]
  v_pk_add_f32 v[32:33], v[32:33], v[56:57] neg_lo:[0,1] neg_hi:[0,1]
  v_pk_add_f32 v[34:35], v[34:35], v[56:57] neg_lo:[0,1] neg_hi:[0,1]
  v_pk_add_f32 v[36:37], v[36:37], v[56:57] neg_lo:[0,1] neg_hi:[0,1]
  v_pk_add_f32 v[38:39], v[38:39], v[56:57] neg_lo:[0,1] neg_hi:[0,1]
  v_pk_add_f32 v[40:41], v[40:41], v[56:57] neg_lo:[0,1] neg_hi:[0,1]
  v_pk_add_f32 v[42:43], v[42:43], v[56:57] neg_lo:[0,1] neg_hi:[0,1]
  v_pk_add_f32 v[44:45], v[44:45], v[56:57] neg_lo:[0,1] neg_hi:[0,1]
  v_pk_add_f32 v[46:47], v[46:47], v[56:57] neg_lo:[0,1] neg_hi:[0,1]
  v_pk_add_f32 v[48:49], v[48:49], v[56:57] neg_lo:[0,1] neg_hi:[0,1]
  v_pk_add_f32 v[50:51], v[50:51], v[56:57] neg_lo:[0,1] neg_hi:[0,1]
  v_pk_add_f32 v[52:53], v[52:53], v[56:57] neg_lo:[0,1] neg_hi:[0,1]
  v_pk_add_f32 v[54:55], v[54:55], v[56:57] neg_lo:[0,1] neg_hi:[0,1]
  v_pk_mul_f32 v[24:25], v[24:25], v[60:61]
  v_pk_mul_f32 v[26:27], v[26:27], v[60:61]
  v_pk_mul_f32 v[28:29], v[28:29], v[60:61]
  v_pk_mul_f32 v[30:31], v[30:31], v[60:61]
  v_pk_mul_f32 v[32:33], v[32:33], v[60:61]
  v_pk_mul_f32 v[34:35], v[34:35], v[60:61]
  v_pk_mul_f32 v[36:37], v[36:37], v[60:61]
  v_pk_mul_f32 v[38:39], v[38:39], v[60:61]
  v_pk_mul_f32 v[40:41], v[40:41], v[60:61]
  v_pk_mul_f32 v[42:43], v[42:43], v[60:61]
  v_pk_mul_f32 v[44:45], v[44:45], v[60:61]
  v_pk_mul_f32 v[46:47], v[46:47], v[60:61]
  v_pk_mul_f32 v[48:49], v[48:49], v[60:61]
  v_pk_mul_f32 v[50:51], v[50:51], v[60:61]
  v_pk_mul_f32 v[52:53], v[52:53], v[60:61]
  v_pk_mul_f32 v[54:55], v[54:55], v[60:61]
  s_lshl_b32 s39, s3, 8
  s_add_u32 s39, s39, 12288
  s_lshl_b32 s33, s30, 6
  s_lshl_b32 s34, s3, 4
  s_add_u32 s34, s34, s33
  s_max_u32 s33, s33, 8
  s_sub_u32 s33, s33, 8
  v_add_u32 v110, s33, v66
  v_add_u32 v126, s34, v104
  v_cmp_lt_u32 vcc, 15, v104
  s_nop 1
  v_cndmask_b32 v126, v126, v110, vcc
  s_mov_b32 s33, 0
  v_and_b32 v128, 0, v126
  v_add_u32 v128, s33, v128
  v_and_b32 v128, 3, v128
  v_and_or_b32 v128, v126, -4, v128
  v_lshlrev_b32 v126, 6, v126
  v_lshlrev_b32 v128, 6, v128
  s_lshl_b32 s34, s30, 13
  s_lshl_b32 s33, s3, 11
  s_add_u32 s34, s34, s33
  v_add_u32 v105, s34, v119
  s_lshl_b32 s34, s30, 3
  s_max_u32 s34, s34, 1
  s_sub_u32 s34, s34, 1
  s_lshl_b32 s34, s34, 10
  s_lshl_b32 s33, s3, 8
  s_add_u32 s34, s34, s33
  v_lshlrev_b32 v106, 2, v104
  v_add_u32 v106, s34, v106
  v_lshrrev_b32 v110, 4, v104
  v_mul_u32_u24 v110, 3072, v110
  v_bfe_u32 v111, v104, 2, 2
  v_lshl_add_u32 v110, v111, 7, v110
  v_bfe_u32 v111, v104, 3, 2
  v_lshl_add_u32 v110, v111, 5, v110
  v_and_b32 v111, 3, v104
  v_lshl_add_u32 v114, v111, 3, v110
  v_xor_b32 v115, 32, v114
  v_xor_b32 v116, 64, v114
  v_xor_b32 v117, 96, v114
  s_lshl_b32 s33, s3, 5
  v_xor_b32 v118, s33, v114
  v_add_u32 v120, 53248, v114
  v_add_u32 v121, 53248, v115
  v_add_u32 v122, 53248, v116
  v_add_u32 v123, 53248, v117
  v_add_u32 v124, 53248, v118
  v_add_u32 v125, 53248, v119
  v_and_b32 v110, 14, v104
  v_lshrrev_b32 v111, 4, v104
  v_lshlrev_b32 v111, 2, v111
  v_cmp_le_u32 s[44:45], v111, v110
  v_add_u32 v111, 2, v111
  v_cmp_le_u32 s[46:47], v111, v110
  v_and_b32 v110, 1, v104
  v_cmp_eq_u32 s[48:49], 1, v110
  s_lshl_b32 s56, s3, 20
  s_lshr_b32 s33, s2, 1
  s_lshl_b32 s33, s33, 10
  s_add_u32 s56, s56, s33
  s_and_b32 s33, s2, 1
  s_lshl_b32 s33, s33, 7
  s_add_u32 s56, s56, s33
  s_add_u32 s57, s56, 262144
  s_add_u32 s58, s56, 524288
  s_add_u32 s59, s56, 786432
  s_lshl_b32 s37, s2, 2
  s_add_u32 s37, s37, s3
  s_lshl_b32 s37, s37, 6
  s_mov_b32 s33, 262144
L_mod_4:
  s_waitcnt vmcnt(7)
  v_xor_b32 v72, s40, v72
  v_xor_b32 v73, s41, v73
  v_xor_b32 v74, s42, v74
  v_xor_b32 v75, s43, v75
  v_or3_b32 v66, v72, v73, v74
  v_or_b32 v66, v66, v75
  s_waitcnt vmcnt(6)
  v_xor_b32 v76, s40, v76
  v_xor_b32 v77, s41, v77
  v_xor_b32 v78, s42, v78
  v_xor_b32 v79, s43, v79
  v_or3_b32 v66, v66, v76, v77
  v_or3_b32 v66, v66, v78, v79
  s_waitcnt vmcnt(5)
  v_xor_b32 v80, s40, v80
  v_xor_b32 v81, s41, v81
  v_xor_b32 v82, s42, v82
  v_xor_b32 v83, s43, v83
  v_or3_b32 v66, v66, v80, v81
  v_or3_b32 v66, v66, v82, v83
  s_waitcnt vmcnt(4)
  v_xor_b32 v84, s40, v84
  v_xor_b32 v85, s41, v85
  v_xor_b32 v86, s42, v86
  v_xor_b32 v87, s43, v87
  v_or3_b32 v66, v66, v84, v85
  v_or3_b32 v66, v66, v86, v87
  s_waitcnt vmcnt(3)
  v_xor_b32 v88, s40, v88
  v_xor_b32 v89, s41, v89
  v_xor_b32 v90, s42, v90
  v_xor_b32 v91, s43, v91
  v_or3_b32 v66, v66, v88, v89
  v_or3_b32 v66, v66, v90, v91
  s_waitcnt vmcnt(2)
  v_xor_b32 v92, s40, v92
  v_xor_b32 v93, s41, v93
  v_xor_b32 v94, s42, v94
  v_xor_b32 v95, s43, v95
  v_or3_b32 v66, v66, v92, v93
  v_or3_b32 v66, v66, v94, v95
  s_waitcnt vmcnt(1)
  v_xor_b32 v96, s40, v96
  v_xor_b32 v97, s41, v97
  v_xor_b32 v98, s42, v98
  v_xor_b32 v99, s43, v99
  v_or3_b32 v66, v66, v96, v97
  v_or3_b32 v66, v66, v98, v99
  s_waitcnt vmcnt(0)
  v_xor_b32 v100, s40, v100
  v_xor_b32 v101, s41, v101
  v_xor_b32 v102, s42, v102
  v_xor_b32 v103, s43, v103
  v_or3_b32 v66, v66, v100, v101
  v_or3_b32 v66, v66, v102, v103
  v_and_b32 v66, 0xff, v66
  v_cmp_ne_u32 vcc, 0, v66
  s_nop 1
  s_cmp_eq_u64 vcc, 0
  s_cbranch_scc1 L_mok_5
  s_mov_b64 exec, vcc
  buffer_load_dwordx4 v[72:75], v1, s[12:15], 0 offen sc1
  buffer_load_dwordx4 v[76:79], v1, s[12:15], s32 offen sc1
  buffer_load_dwordx4 v[80:83], v1, s[12:15], s35 offen sc1
  buffer_load_dwordx4 v[84:87], v1, s[12:15], s36 offen sc1
  buffer_load_dwordx4 v[88:91], v2, s[12:15], 0 offen sc1
  buffer_load_dwordx4 v[92:95], v2, s[12:15], s32 offen sc1
  buffer_load_dwordx4 v[96:99], v2, s[12:15], s35 offen sc1
  buffer_load_dwordx4 v[100:103], v2, s[12:15], s36 offen sc1
  s_sub_u32 s33, s33, 1
  s_cmp_lg_u32 s33, 0
  s_cbranch_scc1 L_mod_4
  s_waitcnt vmcnt(0)
L_mok_5:
  s_mov_b64 exec, -1
  v_pk_add_f32 v[72:73], v[72:73], v[80:81]
  v_pk_add_f32 v[74:75], v[74:75], v[82:83]
  v_pk_add_f32 v[76:77], v[76:77], v[84:85]
  v_pk_add_f32 v[78:79], v[78:79], v[86:87]
  v_pk_add_f32 v[88:89], v[88:89], v[96:97]
  v_pk_add_f32 v[90:91], v[90:91], v[98:99]
  v_pk_add_f32 v[92:93], v[92:93], v[100:101]
  v_pk_add_f32 v[94:95], v[94:95], v[102:103]
  v_pk_add_f32 v[72:73], v[72:73], v[76:77]
  v_pk_add_f32 v[74:75], v[74:75], v[78:79]
  v_pk_add_f32 v[88:89], v[88:89], v[92:93]
  v_pk_add_f32 v[90:91], v[90:91], v[94:95]
  v_cvt_pk_bf16_f32 v80, v72, v73
  v_lshlrev_b32 v72, 16, v80
  v_and_b32 v73, 0xffff0000, v80
  v_cvt_pk_bf16_f32 v81, v74, v75
  v_lshlrev_b32 v74, 16, v81
  v_and_b32 v75, 0xffff0000, v81
  v_cvt_pk_bf16_f32 v82, v88, v89
  v_lshlrev_b32 v88, 16, v82
  v_and_b32 v89, 0xffff0000, v82
  v_cvt_pk_bf16_f32 v83, v90, v91
  v_lshlrev_b32 v90, 16, v83
  v_and_b32 v91, 0xffff0000, v83
  ds_write_b128 v3, v[72:75]
  v_add_f32 v88, 1.0, v88
  v_add_f32 v89, 1.0, v89
  v_add_f32 v90, 1.0, v90
  v_add_f32 v91, 1.0, v91
  v_cvt_pk_bf16_f32 v80, v88, v89
  v_lshlrev_b32 v88, 16, v80
  v_and_b32 v89, 0xffff0000, v80
  v_cvt_pk_bf16_f32 v81, v90, v91
  v_lshlrev_b32 v90, 16, v81
  v_and_b32 v91, 0xffff0000, v81
  ds_write_b128 v3, v[88:91] offset:1024
  ds_read_b128 v[132:135], v4 offset:0
  ds_read_b128 v[164:167], v4 offset:1024
  ds_read_b128 v[136:139], v4 offset:16
  ds_read_b128 v[168:171], v4 offset:1040
  ds_read_b128 v[140:143], v4 offset:256
  ds_read_b128 v[172:175], v4 offset:1280
  ds_read_b128 v[144:147], v4 offset:272
  ds_read_b128 v[176:179], v4 offset:1296
  ds_read_b128 v[148:151], v4 offset:512
  ds_read_b128 v[180:183], v4 offset:1536
  ds_read_b128 v[152:155], v4 offset:528
  ds_read_b128 v[184:187], v4 offset:1552
  s_waitcnt lgkmcnt(8)
  ds_read_b128 v[156:159], v4 offset:768
  ds_read_b128 v[188:191], v4 offset:1792
  ds_read_b128 v[160:163], v4 offset:784
  ds_read_b128 v[192:195], v4 offset:1808
  s_waitcnt lgkmcnt(12)
  v_pk_fma_f32 v[24:25], v[24:25], v[164:165], v[132:133]
  v_pk_fma_f32 v[26:27], v[26:27], v[166:167], v[134:135]
  v_pk_fma_f32 v[28:29], v[28:29], v[168:169], v[136:137]
  v_pk_fma_f32 v[30:31], v[30:31], v[170:171], v[138:139]
  v_cvt_pk_bf16_f32 v8, v24, v25
  v_cvt_pk_bf16_f32 v9, v26, v27
  v_cvt_pk_bf16_f32 v10, v28, v29
  v_cvt_pk_bf16_f32 v11, v30, v31
  buffer_store_dwordx4 v[8:11], v5, s[4:7], s56 offen sc1
  s_waitcnt lgkmcnt(8)
  v_pk_fma_f32 v[32:33], v[32:33], v[172:173], v[140:141]
  v_pk_fma_f32 v[34:35], v[34:35], v[174:175], v[142:143]
  v_pk_fma_f32 v[36:37], v[36:37], v[176:177], v[144:145]
  v_pk_fma_f32 v[38:39], v[38:39], v[178:179], v[146:147]
  v_cvt_pk_bf16_f32 v12, v32, v33
  v_cvt_pk_bf16_f32 v13, v34, v35
  v_cvt_pk_bf16_f32 v14, v36, v37
  v_cvt_pk_bf16_f32 v15, v38, v39
  buffer_store_dwordx4 v[12:15], v5, s[4:7], s57 offen sc1
  s_waitcnt lgkmcnt(4)
  v_pk_fma_f32 v[40:41], v[40:41], v[180:181], v[148:149]
  v_pk_fma_f32 v[42:43], v[42:43], v[182:183], v[150:151]
  v_pk_fma_f32 v[44:45], v[44:45], v[184:185], v[152:153]
  v_pk_fma_f32 v[46:47], v[46:47], v[186:187], v[154:155]
  v_cvt_pk_bf16_f32 v16, v40, v41
  v_cvt_pk_bf16_f32 v17, v42, v43
  v_cvt_pk_bf16_f32 v18, v44, v45
  v_cvt_pk_bf16_f32 v19, v46, v47
  buffer_store_dwordx4 v[16:19], v5, s[4:7], s58 offen sc1
  s_waitcnt lgkmcnt(0)
  v_pk_fma_f32 v[48:49], v[48:49], v[188:189], v[156:157]
  v_pk_fma_f32 v[50:51], v[50:51], v[190:191], v[158:159]
  v_pk_fma_f32 v[52:53], v[52:53], v[192:193], v[160:161]
  v_pk_fma_f32 v[54:55], v[54:55], v[194:195], v[162:163]
  v_cvt_pk_bf16_f32 v20, v48, v49
  v_cvt_pk_bf16_f32 v21, v50, v51
  v_cvt_pk_bf16_f32 v22, v52, v53
  v_cvt_pk_bf16_f32 v23, v54, v55
  buffer_store_dwordx4 v[20:23], v5, s[4:7], s59 offen sc1
  v_mov_b32 v7, s19
  v_lshlrev_b32 v6, 2, v104
  s_waitcnt vmcnt(0)
  s_mov_b64 exec, 1
  buffer_store_dword v7, v6, s[64:67], s37 offen sc1
  s_mov_b64 exec, -1
  s_barrier
  s_add_u32 m0, s38, 13312
  s_nop 0
  buffer_load_dwordx4 v107, s[8:11], s17 offen lds
  buffer_load_dwordx4 v108, s[8:11], s17 offen offset:1024 lds
  buffer_load_dwordx4 v109, s[8:11], s17 offen offset:2048 lds
  s_add_u32 s17, s17, 196608
  s_cmp_eq_u32 s17, s10
  s_cselect_b32 s17, 0, s17
  s_add_u32 m0, s38, 26624
  s_nop 0
  buffer_load_dwordx4 v107, s[8:11], s17 offen lds
  buffer_load_dwordx4 v108, s[8:11], s17 offen offset:1024 lds
  buffer_load_dwordx4 v109, s[8:11], s17 offen offset:2048 lds
  s_add_u32 s17, s17, 196608
  s_cmp_eq_u32 s17, s10
  s_cselect_b32 s17, 0, s17
  s_add_u32 m0, s38, 39936
  s_nop 0
  buffer_load_dwordx4 v107, s[8:11], s17 offen lds
  buffer_load_dwordx4 v108, s[8:11], s17 offen offset:1024 lds
  buffer_load_dwordx4 v109, s[8:11], s17 offen offset:2048 lds
  s_add_u32 s17, s17, 196608
  s_cmp_eq_u32 s17, s10
  s_cselect_b32 s17, 0, s17
L_slow_6:
  s_mov_b32 s33, 262144
L_spin_8:
  buffer_load_dword v127, v128, s[64:67], 0 offen sc1
  s_waitcnt vmcnt(0)
  v_cmp_ne_u32 vcc, s19, v127
  s_nop 1
  s_cmp_eq_u64 vcc, 0
  s_cbranch_scc1 L_back_7
  s_sub_u32 s33, s33, 1
  s_cmp_lg_u32 s33, 0
  s_cbranch_scc1 L_spin_8
  s_branch L_back_7
L_back_7:
L_gemm_a:
  s_mov_b32 s6, 1048576
  s_add_u32 m0, s39, 0
  s_nop 0
  buffer_load_dword v106, s[4:7], s16 offen sc1 lds
  buffer_load_dwordx4 a[0:3], v105, s[4:7], s16 offen sc1
  buffer_load_dwordx4 a[4:7], v105, s[4:7], s16 offen offset:1024 sc1
  s_add_u32 s16, s16, 131072
  s_bitset0_b32 s16, 20
  s_add_u32 m0, s39, 13312
  s_nop 0
  buffer_load_dword v106, s[4:7], s16 offen sc1 lds
  buffer_load_dwordx4 a[8:11], v105, s[4:7], s16 offen sc1
  buffer_load_dwordx4 a[12:15], v105, s[4:7], s16 offen offset:1024 sc1
  s_add_u32 s16, s16, 131072
  s_bitset0_b32 s16, 20
  s_add_u32 m0, s39, 26624
  s_nop 0
  buffer_load_dword v106, s[4:7], s16 offen sc1 lds
  buffer_load_dwordx4 a[16:19], v105, s[4:7], s16 offen sc1
  buffer_load_dwordx4 a[20:23], v105, s[4:7], s16 offen offset:1024 sc1
  s_add_u32 s16, s16, 131072
  s_bitset0_b32 s16, 20
  s_bitcmp1_b32 s3, 0
  s_cselect_b32 s56, s62, s60
  s_cselect_b32 s57, s63, s61
  s_mov_b32 s58, 7340032
  s_mov_b32 s59, 0x20000
  s_lshl_b32 s97, s2, 1
  s_lshr_b32 s33, s3, 1
  s_add_u32 s97, s97, s33
  s_lshl_b32 s97, s97, 10
  v_lshrrev_b32 v110, 3, v104
  v_min_u32 v130, 6, v110
  v_lshlrev_b32 v130, 19, v130
  v_and_b32 v112, 7, v104
  v_lshl_add_u32 v130, v112, 7, v130
  s_bfe_u32 s36, s2, 0x20001
  s_lshl_b32 s36, s36, 2
  s_bfe_u32 s33, s2, 0x20003
  s_add_u32 s36, s36, s33
  s_lshr_b32 s37, s2, 5
  s_lshl_b32 s37, s37, 1
  s_and_b32 s33, s2, 1
  s_add_u32 s37, s37, s33
  s_mov_b32 s98, 0
  v_and_b32 v111, 6, v110
  v_and_b32 v112, 7, v104
  v_xor_b32 v111, v111, v112
  v_lshlrev_b32 v110, 11, v110
  v_lshl_add_u32 v110, v111, 4, v110
  s_lshl_b32 s32, s3, 15
  s_lshl_b32 s33, s37, 7
  s_add_u32 s32, s32, s33
  v_add_u32 v248, s32, v110
  v_add_u32 v249, 15360, v248
  v_mov_b32 v244, -1
  v_mov_b32 v245, -1
  v_mov_b32 v246, -1
  v_mov_b32 v247, -1
  s_add_u32 s92, s20, 0xe00000
  s_addc_u32 s93, s21, 0
  s_mov_b32 s94, 0x800000
  s_mov_b32 s95, 0x20000
  s_lshl_b32 s35, s2, 2
  s_add_u32 s35, s35, s3
  s_lshl_b32 s35, s35, 13
  v_lshrrev_b32 v254, 4, v104
  s_movk_i32 s33, 24576
  v_mul_u32_u24 v254, s33, v254
  v_and_b32 v110, 15, v104
  v_lshl_add_u32 v254, v110, 4, v254
  v_and_b32 v110, 15, v104
  v_lshlrev_b32 v128, 11, v110
  v_bfe_u32 v112, v104, 4, 1
  v_lshl_add_u32 v128, v112, 5, v128
  v_lshrrev_b32 v112, 5, v104
  v_lshl_add_u32 v128, v112, 4, v128
  s_lshl_b32 s32, s36, 18
  s_lshl_b32 s33, s3, 16
  s_add_u32 s32, s32, s33
  s_lshl_b32 s33, s37, 7
  s_add_u32 s32, s32, s33
  v_add_u32 v128, s32, v128
  s_waitcnt vmcnt(6)
  s_barrier
  ds_read_b64_tr_b16 v[180:181], v118 offset:1024
  ds_read_b64_tr_b16 v[182:183], v118 offset:1536
  ds_read_b128 v[188:191], v119 offset:12288
  ds_read_b64_tr_b16 v[184:185], v118 offset:2048
  ds_read_b64_tr_b16 v[186:187], v118 offset:2560
  ds_read_b64_tr_b16 v[132:133], v114 offset:0
  ds_read_b64_tr_b16 v[134:135], v114 offset:512
  ds_read_b64_tr_b16 v[136:137], v115 offset:0
  ds_read_b64_tr_b16 v[138:139], v115 offset:512
  ds_read_b64_tr_b16 v[140:141], v116 offset:0
  ds_read_b64_tr_b16 v[142:143], v116 offset:512
  ds_read_b64_tr_b16 v[144:145], v117 offset:0
  ds_read_b64_tr_b16 v[146:147], v117 offset:512
  ds_read_b64_tr_b16 v[148:149], v114 offset:1024
  ds_read_b64_tr_b16 v[150:151], v114 offset:1536
  ds_read_b64_tr_b16 v[152:153], v115 offset:1024
  ds_read_b64_tr_b16 v[154:155], v115 offset:1536
  ds_read_b64_tr_b16 v[156:157], v116 offset:1024
  ds_read_b64_tr_b16 v[158:159], v116 offset:1536
  ds_read_b64_tr_b16 v[160:161], v117 offset:1024
  ds_read_b64_tr_b16 v[162:163], v117 offset:1536
  ds_read_b64_tr_b16 v[164:165], v114 offset:2048
  ds_read_b64_tr_b16 v[166:167], v114 offset:2560
  ds_read_b64_tr_b16 v[168:169], v115 offset:2048
  ds_read_b64_tr_b16 v[170:171], v115 offset:2560
  ds_read_b64_tr_b16 v[172:173], v116 offset:2048
  ds_read_b64_tr_b16 v[174:175], v116 offset:2560
  ds_read_b64_tr_b16 v[176:177], v117 offset:2048
  ds_read_b64_tr_b16 v[178:179], v117 offset:2560
  s_waitcnt vmcnt(3) lgkmcnt(10)
  s_barrier
  v_mfma_f32_16x16x32_bf16 v[96:99], v[180:183], v[188:191], 0
  s_add_u32 m0, s39, 39936
  s_nop 0
  buffer_load_dword v106, s[4:7], s16 offen sc1 lds
  v_mfma_f32_16x16x32_bf16 v[100:103], v[188:191], v[184:187], 0
  buffer_load_dwordx4 a[24:27], v105, s[4:7], s16 offen sc1
  v_mfma_f32_16x16x32_bf16 v[0:3], v[132:135], a[0:3], 0
  buffer_load_dwordx4 a[28:31], v105, s[4:7], s16 offen offset:1024 sc1
  v_mfma_f32_16x16x32_bf16 v[48:51], v[132:135], a[4:7], 0
  ds_read_b64_tr_b16 v[180:181], v118 offset:14336
  ds_read_b64_tr_b16 v[182:183], v118 offset:14848
  s_add_u32 s16, s16, 131072
  v_mfma_f32_16x16x32_bf16 v[4:7], v[136:139], a[0:3], 0
  ds_read_b128 v[188:191], v119 offset:25600
  ds_read_b64_tr_b16 v[184:185], v118 offset:15360
  ds_read_b64_tr_b16 v[186:187], v118 offset:15872
  s_bitset0_b32 s16, 20
  v_mfma_f32_16x16x32_bf16 v[52:55], v[136:139], a[4:7], 0
  ds_read_b64_tr_b16 v[132:133], v114 offset:13312
  s_add_u32 m0, s38, 53248
  v_mfma_f32_16x16x32_bf16 v[8:11], v[140:143], a[0:3], 0
  ds_read_b64_tr_b16 v[134:135], v114 offset:13824
  buffer_load_dwordx4 v107, s[8:11], s17 offen lds
  v_mfma_f32_16x16x32_bf16 v[56:59], v[140:143], a[4:7], 0
  buffer_load_dwordx4 v108, s[8:11], s17 offen offset:1024 lds
  v_mfma_f32_16x16x32_bf16 v[12:15], v[144:147], a[0:3], 0
  ds_read_b64_tr_b16 v[136:137], v115 offset:13312
  ds_read_b64_tr_b16 v[138:139], v115 offset:13824
  buffer_load_dwordx4 v109, s[8:11], s17 offen offset:2048 lds
  v_mfma_f32_16x16x32_bf16 v[60:63], v[144:147], a[4:7], 0
  ds_read_b64_tr_b16 v[140:141], v116 offset:13312
  s_add_u32 s17, s17, 196608
  v_mfma_f32_16x16x32_bf16 v[16:19], v[148:151], a[0:3], 0
  ds_read_b64_tr_b16 v[142:143], v116 offset:13824
  s_cmp_eq_u32 s17, s10
  v_mfma_f32_16x16x32_bf16 v[64:67], v[148:151], a[4:7], 0
  ds_read_b64_tr_b16 v[144:145], v117 offset:13312
  s_cselect_b32 s17, 0, s17
  v_mfma_f32_16x16x32_bf16 v[20:23], v[152:155], a[0:3], 0
  ds_read_b64_tr_b16 v[146:147], v117 offset:13824
  s_add_u32 m0, s39, 53248
  v_mfma_f32_16x16x32_bf16 v[68:71], v[152:155], a[4:7], 0
  buffer_load_dword v106, s[4:7], s16 offen sc1 lds
  v_mfma_f32_16x16x32_bf16 v[24:27], v[156:159], a[0:3], 0
  ds_read_b64_tr_b16 v[148:149], v114 offset:14336
  ds_read_b64_tr_b16 v[150:151], v114 offset:14848
  buffer_load_dwordx4 a[32:35], v105, s[4:7], s16 offen sc1
  v_mfma_f32_16x16x32_bf16 v[72:75], v[156:159], a[4:7], 0
  buffer_load_dwordx4 a[36:39], v105, s[4:7], s16 offen offset:1024 sc1
  s_waitcnt lgkmcnt(10)
  v_mfma_f32_16x16x32_bf16 v[28:31], v[160:163], a[0:3], 0
  ds_read_b64_tr_b16 v[152:153], v115 offset:14336
  ds_read_b64_tr_b16 v[154:155], v115 offset:14848
  s_add_u32 s16, s16, 131072
  v_mfma_f32_16x16x32_bf16 v[76:79], v[160:163], a[4:7], 0
  ds_read_b64_tr_b16 v[156:157], v116 offset:14336
  s_bitset0_b32 s16, 20
  v_mfma_f32_16x16x32_bf16 v[32:35], a[0:3], v[164:167], 0
  ds_read_b64_tr_b16 v[158:159], v116 offset:14848
  s_add_u32 m0, s38, 66560
  v_mfma_f32_16x16x32_bf16 v[80:83], a[4:7], v[164:167], 0
  buffer_load_dwordx4 v107, s[8:11], s17 offen lds
  v_mfma_f32_16x16x32_bf16 v[36:39], a[0:3], v[168:171], 0
  ds_read_b64_tr_b16 v[160:161], v117 offset:14336
  ds_read_b64_tr_b16 v[162:163], v117 offset:14848
  buffer_load_dwordx4 v108, s[8:11], s17 offen offset:1024 lds
  v_mfma_f32_16x16x32_bf16 v[84:87], a[4:7], v[168:171], 0
  buffer_load_dwordx4 v109, s[8:11], s17 offen offset:2048 lds
  v_mfma_f32_16x16x32_bf16 v[40:43], a[0:3], v[172:175], 0
  ds_read_b64_tr_b16 v[164:165], v114 offset:15360
  ds_read_b64_tr_b16 v[166:167], v114 offset:15872
  s_add_u32 s17, s17, 196608
  v_mfma_f32_16x16x32_bf16 v[88:91], a[4:7], v[172:175], 0
  ds_read_b64_tr_b16 v[168:169], v115 offset:15360
  s_cmp_eq_u32 s17, s10
  v_mfma_f32_16x16x32_bf16 v[44:47], a[0:3], v[176:179], 0
  ds_read_b64_tr_b16 v[170:171], v115 offset:15872
  s_cselect_b32 s17, 0, s17
  v_mfma_f32_16x16x32_bf16 v[92:95], a[4:7], v[176:179], 0
  s_waitcnt vmcnt(12) lgkmcnt(10)
  s_barrier
  v_mfma_f32_16x16x32_bf16 v[96:99], v[180:183], v[188:191], v[96:99]
  ds_read_b64_tr_b16 v[172:173], v116 offset:15360
  ds_read_b64_tr_b16 v[174:175], v116 offset:15872
  s_add_u32 m0, s39, 66560
  v_mfma_f32_16x16x32_bf16 v[100:103], v[188:191], v[184:187], v[100:103]
  buffer_load_dword v106, s[4:7], s16 offen sc1 lds
  v_mfma_f32_16x16x32_bf16 v[0:3], v[132:135], a[8:11], v[0:3]
  ds_read_b64_tr_b16 v[176:177], v117 offset:15360
  ds_read_b64_tr_b16 v[178:179], v117 offset:15872
  buffer_load_dwordx4 a[40:43], v105, s[4:7], s16 offen sc1
  v_mfma_f32_16x16x32_bf16 v[48:51], v[132:135], a[12:15], v[48:51]
  ds_read_b64_tr_b16 v[180:181], v118 offset:27648
  ds_read_b64_tr_b16 v[182:183], v118 offset:28160
  buffer_load_dword v127, v126, s[64:67], 0 offen sc1
  buffer_load_dwordx4 a[44:47], v105, s[4:7], s16 offen offset:1024 sc1
  v_mfma_f32_16x16x32_bf16 v[4:7], v[136:139], a[8:11], v[4:7]
  ds_read_b128 v[188:191], v119 offset:38912
  ds_read_b64_tr_b16 v[184:185], v118 offset:28672
  ds_read_b64_tr_b16 v[186:187], v118 offset:29184
  s_add_u32 s16, s16, 131072
  v_mfma_f32_16x16x32_bf16 v[52:55], v[136:139], a[12:15], v[52:55]
  ds_read_b64_tr_b16 v[132:133], v114 offset:26624
  s_bitset0_b32 s16, 20
  v_mfma_f32_16x16x32_bf16 v[8:11], v[140:143], a[8:11], v[8:11]
  ds_read_b64_tr_b16 v[134:135], v114 offset:27136
  s_add_u32 m0, s38, 79872
  v_mfma_f32_16x16x32_bf16 v[56:59], v[140:143], a[12:15], v[56:59]
  buffer_load_dwordx4 v107, s[8:11], s17 offen lds
  v_mfma_f32_16x16x32_bf16 v[12:15], v[144:147], a[8:11], v[12:15]
  ds_read_b64_tr_b16 v[136:137], v115 offset:26624
  ds_read_b64_tr_b16 v[138:139], v115 offset:27136
  buffer_load_dwordx4 v108, s[8:11], s17 offen offset:1024 lds
  v_mfma_f32_16x16x32_bf16 v[60:63], v[144:147], a[12:15], v[60:63]
  buffer_load_dwordx4 v109, s[8:11], s17 offen offset:2048 lds
  v_mfma_f32_16x16x32_bf16 v[16:19], v[148:151], a[8:11], v[16:19]
  ds_read_b64_tr_b16 v[140:141], v116 offset:26624
  ds_read_b64_tr_b16 v[142:143], v116 offset:27136
  s_add_u32 s17, s17, 196608
  v_mfma_f32_16x16x32_bf16 v[64:67], v[148:151], a[12:15], v[64:67]
  s_cmp_eq_u32 s17, s10
  s_cselect_b32 s17, 0, s17
  s_waitcnt lgkmcnt(10)
  v_mfma_f32_16x16x32_bf16 v[20:23], v[152:155], a[8:11], v[20:23]
  ds_read_b64_tr_b16 v[144:145], v117 offset:26624
  ds_read_b64_tr_b16 v[146:147], v117 offset:27136
  s_add_u32 m0, s39, 79872
  v_mfma_f32_16x16x32_bf16 v[68:71], v[152:155], a[12:15], v[68:71]
  s_add_u32 s40, s20, 0x40000
  s_addc_u32 s41, s21, 0
  s_mov_b32 s42, 0x0
  s_mov_b32 s43, 0x20000
  s_or_b32 s33, s2, s3
  s_cmp_eq_u32 s33, 0
  s_cselect_b32 s42, 4, 0
  v_mov_b32 v192, s19
  buffer_store_dword v192, v119, s[40:43], 0 offen sc1
  buffer_load_dword v106, s[4:7], s16 offen sc1 lds
  v_mfma_f32_16x16x32_bf16 v[24:27], v[156:159], a[8:11], v[24:27]
  ds_read_b64_tr_b16 v[148:149], v114 offset:27648
  ds_read_b64_tr_b16 v[150:151], v114 offset:28160
  buffer_load_dwordx4 a[48:51], v105, s[4:7], s16 offen sc1
  v_mfma_f32_16x16x32_bf16 v[72:75], v[156:159], a[12:15], v[72:75]
  buffer_load_dwordx4 a[52:55], v105, s[4:7], s16 offen offset:1024 sc1
  v_mfma_f32_16x16x32_bf16 v[28:31], v[160:163], a[8:11], v[28:31]
  ds_read_b64_tr_b16 v[152:153], v115 offset:27648
  ds_read_b64_tr_b16 v[154:155], v115 offset:28160
  s_add_u32 s16, s16, 131072
  v_mfma_f32_16x16x32_bf16 v[76:79], v[160:163], a[12:15], v[76:79]
  ds_read_b64_tr_b16 v[156:157], v116 offset:27648
  s_bitset0_b32 s16, 20
  v_mfma_f32_16x16x32_bf16 v[32:35], a[8:11], v[164:167], v[32:35]
  ds_read_b64_tr_b16 v[158:159], v116 offset:28160
  s_add_u32 m0, s38, 93184
  v_mfma_f32_16x16x32_bf16 v[80:83], a[12:15], v[164:167], v[80:83]
  buffer_load_dwordx4 v107, s[8:11], s17 offen lds
  v_mfma_f32_16x16x32_bf16 v[36:39], a[8:11], v[168:171], v[36:39]
  ds_read_b64_tr_b16 v[160:161], v117 offset:27648
  ds_read_b64_tr_b16 v[162:163], v117 offset:28160
  buffer_load_dwordx4 v108, s[8:11], s17 offen offset:1024 lds
  v_mfma_f32_16x16x32_bf16 v[84:87], a[12:15], v[168:171], v[84:87]
  buffer_load_dwordx4 v109, s[8:11], s17 offen offset:2048 lds
  v_mfma_f32_16x16x32_bf16 v[40:43], a[8:11], v[172:175], v[40:43]
  ds_read_b64_tr_b16 v[164:165], v114 offset:28672
  ds_read_b64_tr_b16 v[166:167], v114 offset:29184
  s_add_u32 s17, s17, 196608
  v_mfma_f32_16x16x32_bf16 v[88:91], a[12:15], v[172:175], v[88:91]
  s_cmp_eq_u32 s17, s10
  s_cselect_b32 s17, 0, s17
  v_mfma_f32_16x16x32_bf16 v[44:47], a[8:11], v[176:179], v[44:47]
  ds_read_b64_tr_b16 v[168:169], v115 offset:28672
  ds_read_b64_tr_b16 v[170:171], v115 offset:29184
  s_add_u32 s8, s8, s10
  s_addc_u32 s9, s9, 0
  v_mfma_f32_16x16x32_bf16 v[92:95], a[12:15], v[176:179], v[92:95]
  s_waitcnt vmcnt(11) lgkmcnt(10)
  s_barrier
  v_cmp_ne_u32 vcc, s19, v127
  s_nop 1
  s_cmp_lg_u64 vcc, 0
  s_cbranch_scc1 L_slow_9
  L_back_10:
  v_mfma_f32_16x16x32_bf16 v[96:99], v[180:183], v[188:191], v[96:99]
  ds_read_b64_tr_b16 v[172:173], v116 offset:28672
  ds_read_b64_tr_b16 v[174:175], v116 offset:29184
  s_add_u32 m0, s39, 93184
  s_nop 0
  buffer_load_dword v106, s[4:7], s16 offen sc1 lds
  v_mfma_f32_16x16x32_bf16 v[100:103], v[188:191], v[184:187], v[100:103]
  buffer_load_dwordx4 a[56:59], v105, s[4:7], s16 offen sc1
  v_mfma_f32_16x16x32_bf16 v[0:3], v[132:135], a[16:19], v[0:3]
  ds_read_b64_tr_b16 v[176:177], v117 offset:28672
  ds_read_b64_tr_b16 v[178:179], v117 offset:29184
  buffer_load_dwordx4 a[60:63], v105, s[4:7], s16 offen offset:1024 sc1
  v_mfma_f32_16x16x32_bf16 v[48:51], v[132:135], a[20:23], v[48:51]
  ds_read_b64_tr_b16 v[180:181], v118 offset:40960
  ds_read_b64_tr_b16 v[182:183], v118 offset:41472
  s_add_u32 s16, s16, 131072
  v_mfma_f32_16x16x32_bf16 v[4:7], v[136:139], a[16:19], v[4:7]
  ds_read_b128 v[188:191], v119 offset:52224
  ds_read_b64_tr_b16 v[184:185], v118 offset:41984
  ds_read_b64_tr_b16 v[186:187], v118 offset:42496
  s_bitset0_b32 s16, 20
  v_mfma_f32_16x16x32_bf16 v[52:55], v[136:139], a[20:23], v[52:55]
  s_add_u32 s4, s4, s6
  s_addc_u32 s5, s5, 0
  v_mfma_f32_16x16x32_bf16 v[8:11], v[140:143], a[16:19], v[8:11]
  ds_read_b64_tr_b16 v[132:133], v114 offset:39936
  ds_read_b64_tr_b16 v[134:135], v114 offset:40448
  s_add_u32 m0, s38, 0
  v_mfma_f32_16x16x32_bf16 v[56:59], v[140:143], a[20:23], v[56:59]
  buffer_load_dwordx4 v107, s[8:11], s17 offen lds
  v_mfma_f32_16x16x32_bf16 v[12:15], v[144:147], a[16:19], v[12:15]
  ds_read_b64_tr_b16 v[136:137], v115 offset:39936
  ds_read_b64_tr_b16 v[138:139], v115 offset:40448
  buffer_load_dwordx4 v108, s[8:11], s17 offen offset:1024 lds
  v_mfma_f32_16x16x32_bf16 v[60:63], v[144:147], a[20:23], v[60:63]
  buffer_load_dwordx4 v109, s[8:11], s17 offen offset:2048 lds
  v_mfma_f32_16x16x32_bf16 v[16:19], v[148:151], a[16:19], v[16:19]
  ds_read_b64_tr_b16 v[140:141], v116 offset:39936
  ds_read_b64_tr_b16 v[142:143], v116 offset:40448
  s_add_u32 s17, s17, 196608
  v_mfma_f32_16x16x32_bf16 v[64:67], v[148:151], a[20:23], v[64:67]
  ds_read_b64_tr_b16 v[144:145], v117 offset:39936
  s_cmp_eq_u32 s17, s10
  s_waitcnt lgkmcnt(10)
  v_mfma_f32_16x16x32_bf16 v[20:23], v[152:155], a[16:19], v[20:23]
  ds_read_b64_tr_b16 v[146:147], v117 offset:40448
  s_cselect_b32 s17, 0, s17
  s_add_u32 m0, s39, 0
  v_mfma_f32_16x16x32_bf16 v[68:71], v[152:155], a[20:23], v[68:71]
  buffer_load_dword v106, s[4:7], s16 offen sc1 lds
  v_mfma_f32_16x16x32_bf16 v[24:27], v[156:159], a[16:19], v[24:27]
  ds_read_b64_tr_b16 v[148:149], v114 offset:40960
  ds_read_b64_tr_b16 v[150:151], v114 offset:41472
  buffer_load_dwordx4 a[0:3], v105, s[4:7], s16 offen sc1
  v_mfma_f32_16x16x32_bf16 v[72:75], v[156:159], a[20:23], v[72:75]
  buffer_load_dwordx4 a[4:7], v105, s[4:7], s16 offen offset:1024 sc1
  v_mfma_f32_16x16x32_bf16 v[28:31], v[160:163], a[16:19], v[28:31]
  ds_read_b64_tr_b16 v[152:153], v115 offset:40960
  ds_read_b64_tr_b16 v[154:155], v115 offset:41472
  s_add_u32 s16, s16, 131072
  v_mfma_f32_16x16x32_bf16 v[76:79], v[160:163], a[20:23], v[76:79]
  ds_read_b64_tr_b16 v[156:157], v116 offset:40960
  s_bitset0_b32 s16, 20
  v_mfma_f32_16x16x32_bf16 v[32:35], a[16:19], v[164:167], v[32:35]
  ds_read_b64_tr_b16 v[158:159], v116 offset:41472
  s_add_u32 m0, s38, 13312
  v_mfma_f32_16x16x32_bf16 v[80:83], a[20:23], v[164:167], v[80:83]
  buffer_load_dwordx4 v107, s[8:11], s17 offen lds
  v_mfma_f32_16x16x32_bf16 v[36:39], a[16:19], v[168:171], v[36:39]
  ds_read_b64_tr_b16 v[160:161], v117 offset:40960
  ds_read_b64_tr_b16 v[162:163], v117 offset:41472
  buffer_load_dwordx4 v108, s[8:11], s17 offen offset:1024 lds
  v_mfma_f32_16x16x32_bf16 v[84:87], a[20:23], v[168:171], v[84:87]
  buffer_load_dwordx4 v109, s[8:11], s17 offen offset:2048 lds
  v_mfma_f32_16x16x32_bf16 v[40:43], a[16:19], v[172:175], v[40:43]
  ds_read_b64_tr_b16 v[164:165], v114 offset:41984
  ds_read_b64_tr_b16 v[166:167], v114 offset:42496
  s_add_u32 s17, s17, 196608
  v_mfma_f32_16x16x32_bf16 v[88:91], a[20:23], v[172:175], v[88:91]
  ds_read_b64_tr_b16 v[168:169], v115 offset:41984
  s_cmp_eq_u32 s17, s10
  v_mfma_f32_16x16x32_bf16 v[44:47], a[16:19], v[176:179], v[44:47]
  ds_read_b64_tr_b16 v[170:171], v115 offset:42496
  s_cselect_b32 s17, 0, s17
  v_mfma_f32_16x16x32_bf16 v[92:95], a[20:23], v[176:179], v[92:95]
  s_waitcnt vmcnt(29) lgkmcnt(10)
  s_barrier
  v_mfma_f32_16x16x32_bf16 v[96:99], v[180:183], v[188:191], v[96:99]
  ds_read_b64_tr_b16 v[172:173], v116 offset:41984
  ds_read_b64_tr_b16 v[174:175], v116 offset:42496
  s_add_u32 m0, s39, 13312
  v_mfma_f32_16x16x32_bf16 v[100:103], v[188:191], v[184:187], v[100:103]
  buffer_load_dword v106, s[4:7], s16 offen sc1 lds
  v_mfma_f32_16x16x32_bf16 v[0:3], v[132:135], a[24:27], v[0:3]
  ds_read_b64_tr_b16 v[176:177], v117 offset:41984
  ds_read_b64_tr_b16 v[178:179], v117 offset:42496
  buffer_load_dwordx4 a[8:11], v105, s[4:7], s16 offen sc1
  v_mfma_f32_16x16x32_bf16 v[48:51], v[132:135], a[28:31], v[48:51]
  ds_read_b64_tr_b16 v[180:181], v124 offset:1024
  ds_read_b64_tr_b16 v[182:183], v124 offset:1536
  buffer_load_dwordx4 a[12:15], v105, s[4:7], s16 offen offset:1024 sc1
  v_mfma_f32_16x16x32_bf16 v[4:7], v[136:139], a[24:27], v[4:7]
  ds_read_b128 v[188:191], v125 offset:12288
  ds_read_b64_tr_b16 v[184:185], v124 offset:2048
  ds_read_b64_tr_b16 v[186:187], v124 offset:2560
  v_mfma_f32_16x16x32_bf16 v[52:55], v[136:139], a[28:31], v[52:55]
  ds_read_b64_tr_b16 v[132:133], v120 offset:0
  s_add_u32 s16, s16, 131072
  v_mfma_f32_16x16x32_bf16 v[8:11], v[140:143], a[24:27], v[8:11]
  ds_read_b64_tr_b16 v[134:135], v120 offset:512
  s_bitset0_b32 s16, 20
  v_mfma_f32_16x16x32_bf16 v[56:59], v[140:143], a[28:31], v[56:59]
  ds_read_b64_tr_b16 v[136:137], v121 offset:0
  s_add_u32 m0, s38, 26624
  v_mfma_f32_16x16x32_bf16 v[12:15], v[144:147], a[24:27], v[12:15]
  ds_read_b64_tr_b16 v[138:139], v121 offset:512
  ds_read_b64_tr_b16 v[140:141], v122 offset:0
  v_mfma_f32_16x16x32_bf16 v[60:63], v[144:147], a[28:31], v[60:63]
  buffer_load_dwordx4 v107, s[8:11], s17 offen lds
  v_mfma_f32_16x16x32_bf16 v[16:19], v[148:151], a[24:27], v[16:19]
  ds_read_b64_tr_b16 v[142:143], v122 offset:512
  buffer_load_dwordx4 v108, s[8:11], s17 offen offset:1024 lds
  v_mfma_f32_16x16x32_bf16 v[64:67], v[148:151], a[28:31], v[64:67]
  buffer_load_dwordx4 v109, s[8:11], s17 offen offset:2048 lds
  s_waitcnt lgkmcnt(10)
  v_mfma_f32_16x16x32_bf16 v[20:23], v[152:155], a[24:27], v[20:23]
  ds_read_b64_tr_b16 v[144:145], v123 offset:0
  ds_read_b64_tr_b16 v[146:147], v123 offset:512
  v_mfma_f32_16x16x32_bf16 v[68:71], v[152:155], a[28:31], v[68:71]
  ds_read_b64_tr_b16 v[148:149], v120 offset:1024
  s_add_u32 s17, s17, 196608
  v_mfma_f32_16x16x32_bf16 v[24:27], v[156:159], a[24:27], v[24:27]
  ds_read_b64_tr_b16 v[150:151], v120 offset:1536
  s_cmp_eq_u32 s17, s10
  v_mfma_f32_16x16x32_bf16 v[72:75], v[156:159], a[28:31], v[72:75]
  ds_read_b64_tr_b16 v[152:153], v121 offset:1024
  s_cselect_b32 s17, 0, s17
  v_mfma_f32_16x16x32_bf16 v[28:31], v[160:163], a[24:27], v[28:31]
  ds_read_b64_tr_b16 v[154:155], v121 offset:1536
  ds_read_b64_tr_b16 v[156:157], v122 offset:1024
  v_mfma_f32_16x16x32_bf16 v[76:79], v[160:163], a[28:31], v[76:79]
  ds_read_b64_tr_b16 v[158:159], v122 offset:1536
  s_add_u32 m0, s39, 26624
  v_mfma_f32_16x16x32_bf16 v[32:35], a[24:27], v[164:167], v[32:35]
  buffer_load_dword v106, s[4:7], s16 offen sc1 lds
  v_mfma_f32_16x16x32_bf16 v[80:83], a[28:31], v[164:167], v[80:83]
  buffer_load_dwordx4 a[16:19], v105, s[4:7], s16 offen sc1
  v_mfma_f32_16x16x32_bf16 v[36:39], a[24:27], v[168:171], v[36:39]
  ds_read_b64_tr_b16 v[160:161], v123 offset:1024
  ds_read_b64_tr_b16 v[162:163], v123 offset:1536
  v_mfma_f32_16x16x32_bf16 v[84:87], a[28:31], v[168:171], v[84:87]
  buffer_load_dwordx4 a[20:23], v105, s[4:7], s16 offen offset:1024 sc1
  v_mfma_f32_16x16x32_bf16 v[40:43], a[24:27], v[172:175], v[40:43]
  ds_read_b64_tr_b16 v[164:165], v120 offset:2048
  ds_read_b64_tr_b16 v[166:167], v120 offset:2560
  s_add_u32 s16, s16, 131072
  v_mfma_f32_16x16x32_bf16 v[88:91], a[28:31], v[172:175], v[88:91]
  ds_read_b64_tr_b16 v[168:169], v121 offset:2048
  s_bitset0_b32 s16, 20
  v_mfma_f32_16x16x32_bf16 v[44:47], a[24:27], v[176:179], v[44:47]
  ds_read_b64_tr_b16 v[170:171], v121 offset:2560
  ds_read_b64_tr_b16 v[172:173], v122 offset:2048
  v_mfma_f32_16x16x32_bf16 v[92:95], a[28:31], v[176:179], v[92:95]
  s_waitcnt vmcnt(31) lgkmcnt(10)
  s_barrier
  v_mfma_f32_16x16x32_bf16 v[96:99], v[180:183], v[188:191], v[96:99]
  ds_read_b64_tr_b16 v[174:175], v122 offset:2560
  s_add_u32 m0, s38, 39936
  v_mfma_f32_16x16x32_bf16 v[100:103], v[188:191], v[184:187], v[100:103]
  buffer_load_dwordx4 v107, s[8:11], s17 offen lds
  v_mfma_f32_16x16x32_bf16 v[0:3], v[132:135], a[32:35], v[0:3]
  ds_read_b64_tr_b16 v[176:177], v123 offset:2048
  ds_read_b64_tr_b16 v[178:179], v123 offset:2560
  buffer_load_dwordx4 v108, s[8:11], s17 offen offset:1024 lds
  v_mfma_f32_16x16x32_bf16 v[48:51], v[132:135], a[36:39], v[48:51]
  ds_read_b64_tr_b16 v[180:181], v124 offset:14336
  ds_read_b64_tr_b16 v[182:183], v124 offset:14848
  buffer_load_dwordx4 v109, s[8:11], s17 offen offset:2048 lds
  v_mfma_f32_16x16x32_bf16 v[4:7], v[136:139], a[32:35], v[4:7]
  ds_read_b128 v[188:191], v125 offset:25600
  ds_read_b64_tr_b16 v[184:185], v124 offset:15360
  ds_read_b64_tr_b16 v[186:187], v124 offset:15872
  s_add_u32 s17, s17, 196608
  v_mfma_f32_16x16x32_bf16 v[52:55], v[136:139], a[36:39], v[52:55]
  ds_read_b64_tr_b16 v[132:133], v120 offset:13312
  s_cmp_eq_u32 s17, s10
  v_mfma_f32_16x16x32_bf16 v[8:11], v[140:143], a[32:35], v[8:11]
  ds_read_b64_tr_b16 v[134:135], v120 offset:13824
  s_cselect_b32 s17, 0, s17
  v_mfma_f32_16x16x32_bf16 v[56:59], v[140:143], a[36:39], v[56:59]
  ds_read_b64_tr_b16 v[136:137], v121 offset:13312
  s_add_u32 m0, s39, 39936
  v_mfma_f32_16x16x32_bf16 v[12:15], v[144:147], a[32:35], v[12:15]
  ds_read_b64_tr_b16 v[138:139], v121 offset:13824
  ds_read_b64_tr_b16 v[140:141], v122 offset:13312
  v_mfma_f32_16x16x32_bf16 v[60:63], v[144:147], a[36:39], v[60:63]
  buffer_load_dword v106, s[4:7], s16 offen sc1 lds
  v_mfma_f32_16x16x32_bf16 v[16:19], v[148:151], a[32:35], v[16:19]
  ds_read_b64_tr_b16 v[142:143], v122 offset:13824
  buffer_load_dwordx4 a[24:27], v105, s[4:7], s16 offen sc1
  v_mfma_f32_16x16x32_bf16 v[64:67], v[148:151], a[36:39], v[64:67]
  buffer_load_dwordx4 a[28:31], v105, s[4:7], s16 offen offset:1024 sc1
  s_waitcnt lgkmcnt(10)
  v_mfma_f32_16x16x32_bf16 v[20:23], v[152:155], a[32:35], v[20:23]
  ds_read_b64_tr_b16 v[144:145], v123 offset:13312
  ds_read_b64_tr_b16 v[146:147], v123 offset:13824
  s_add_u32 s16, s16, 131072
  v_mfma_f32_16x16x32_bf16 v[68:71], v[152:155], a[36:39], v[68:71]
  ds_read_b64_tr_b16 v[148:149], v120 offset:14336
  s_bitset0_b32 s16, 20
  v_mfma_f32_16x16x32_bf16 v[24:27], v[156:159], a[32:35], v[24:27]
  ds_read_b64_tr_b16 v[150:151], v120 offset:14848
  s_mov_b32 m0, s51
  v_mfma_f32_16x16x32_bf16 v[72:75], v[156:159], a[36:39], v[72:75]
  ds_read_b64_tr_b16 v[152:153], v121 offset:14336
  s_add_u32 s51, s51, 1024
  v_mfma_f32_16x16x32_bf16 v[28:31], v[160:163], a[32:35], v[28:31]
  ds_read_b64_tr_b16 v[154:155], v121 offset:14848
  ds_read_b64_tr_b16 v[156:157], v122 offset:14336
  v_mfma_f32_16x16x32_bf16 v[76:79], v[160:163], a[36:39], v[76:79]
  buffer_load_dwordx4 v129, s[52:55], s50 offen nt lds
  v_mfma_f32_16x16x32_bf16 v[32:35], a[32:35], v[164:167], v[32:35]
  ds_read_b64_tr_b16 v[158:159], v122 offset:14848
  s_add_u32 s50, s50, 98304
  v_mfma_f32_16x16x32_bf16 v[80:83], a[36:39], v[164:167], v[80:83]
  ds_read_b64_tr_b16 v[160:161], v123 offset:14336
  s_mov_b32 m0, s51
  v_mfma_f32_16x16x32_bf16 v[36:39], a[32:35], v[168:171], v[36:39]
  ds_read_b64_tr_b16 v[162:163], v123 offset:14848
  s_add_u32 s51, s51, 1024
  v_mfma_f32_16x16x32_bf16 v[84:87], a[36:39], v[168:171], v[84:87]
  buffer_load_dwordx4 v129, s[52:55], s50 offen nt lds
  v_mfma_f32_16x16x32_bf16 v[40:43], a[32:35], v[172:175], v[40:43]
  ds_read_b64_tr_b16 v[164:165], v120 offset:15360
  ds_read_b64_tr_b16 v[166:167], v120 offset:15872
  s_add_u32 s50, s50, 98304
  v_mfma_f32_16x16x32_bf16 v[88:91], a[36:39], v[172:175], v[88:91]
  buffer_store_dwordx4 v[244:247], v119, s[92:95], s35 offen offset:0 sc1
  v_mfma_f32_16x16x32_bf16 v[44:47], a[32:35], v[176:179], v[44:47]
  ds_read_b64_tr_b16 v[168:169], v121 offset:15360
  ds_read_b64_tr_b16 v[170:171], v121 offset:15872
  v_mfma_f32_16x16x32_bf16 v[92:95], a[36:39], v[176:179], v[92:95]
  s_waitcnt vmcnt(33) lgkmcnt(10)
  s_barrier
  v_mfma_f32_16x16x32_bf16 v[96:99], v[180:183], v[188:191], v[96:99]
  ds_read_b64_tr_b16 v[172:173], v122 offset:15360
  ds_read_b64_tr_b16 v[174:175], v122 offset:15872
  s_add_u32 m0, s38, 53248
  v_mfma_f32_16x16x32_bf16 v[100:103], v[188:191], v[184:187], v[100:103]
  buffer_load_dwordx4 v107, s[8:11], s17 offen lds
  v_mfma_f32_16x16x32_bf16 v[0:3], v[132:135], a[40:43], v[0:3]
  ds_read_b64_tr_b16 v[176:177], v123 offset:15360
  ds_read_b64_tr_b16 v[178:179], v123 offset:15872
  v_mfma_f32_16x16x32_bf16 v[48:51], v[132:135], a[44:47], v[48:51]
  ds_read_b64_tr_b16 v[180:181], v124 offset:27648
  ds_read_b64_tr_b16 v[182:183], v124 offset:28160
  buffer_load_dwordx4 v108, s[8:11], s17 offen offset:1024 lds
  v_mfma_f32_16x16x32_bf16 v[4:7], v[136:139], a[40:43], v[4:7]
  ds_read_b128 v[188:191], v125 offset:38912
  ds_read_b64_tr_b16 v[184:185], v124 offset:28672
  ds_read_b64_tr_b16 v[186:187], v124 offset:29184
  v_mfma_f32_16x16x32_bf16 v[52:55], v[136:139], a[44:47], v[52:55]
  buffer_load_dwordx4 v109, s[8:11], s17 offen offset:2048 lds
  v_mfma_f32_16x16x32_bf16 v[8:11], v[140:143], a[40:43], v[8:11]
  ds_read_b64_tr_b16 v[132:133], v120 offset:26624
  ds_read_b64_tr_b16 v[134:135], v120 offset:27136
  v_mfma_f32_16x16x32_bf16 v[56:59], v[140:143], a[44:47], v[56:59]
  ds_read_b64_tr_b16 v[136:137], v121 offset:26624
  s_add_u32 s17, s17, 196608
  v_mfma_f32_16x16x32_bf16 v[12:15], v[144:147], a[40:43], v[12:15]
  ds_read_b64_tr_b16 v[138:139], v121 offset:27136
  ds_read_b64_tr_b16 v[140:141], v122 offset:26624
  v_mfma_f32_16x16x32_bf16 v[60:63], v[144:147], a[44:47], v[60:63]
  ds_read_b64_tr_b16 v[142:143], v122 offset:27136
  s_cmp_eq_u32 s17, s10
  v_mfma_f32_16x16x32_bf16 v[16:19], v[148:151], a[40:43], v[16:19]
  ds_read_b64_tr_b16 v[144:145], v123 offset:26624
  ds_read_b64_tr_b16 v[146:147], v123 offset:27136
  v_mfma_f32_16x16x32_bf16 v[64:67], v[148:151], a[44:47], v[64:67]
  ds_read_b64_tr_b16 v[148:149], v120 offset:27648
  s_cselect_b32 s17, 0, s17
  s_waitcnt lgkmcnt(10)
  v_mfma_f32_16x16x32_bf16 v[20:23], v[152:155], a[40:43], v[20:23]
  ds_read_b64_tr_b16 v[150:151], v120 offset:28160
  v_mfma_f32_16x16x32_bf16 v[68:71], v[152:155], a[44:47], v[68:71]
  ds_read_b64_tr_b16 v[152:153], v121 offset:27648
  s_add_u32 m0, s39, 53248
  v_mfma_f32_16x16x32_bf16 v[24:27], v[156:159], a[40:43], v[24:27]
  ds_read_b64_tr_b16 v[154:155], v121 offset:28160
  v_mfma_f32_16x16x32_bf16 v[72:75], v[156:159], a[44:47], v[72:75]
  buffer_load_dword v106, s[4:7], s16 offen sc1 lds
  v_mfma_f32_16x16x32_bf16 v[28:31], v[160:163], a[40:43], v[28:31]
  ds_read_b64_tr_b16 v[156:157], v122 offset:27648
  ds_read_b64_tr_b16 v[158:159], v122 offset:28160
  v_mfma_f32_16x16x32_bf16 v[76:79], v[160:163], a[44:47], v[76:79]
  buffer_load_dwordx4 a[32:35], v105, s[4:7], s16 offen sc1
  v_mfma_f32_16x16x32_bf16 v[32:35], a[40:43], v[164:167], v[32:35]
  ds_read_b64_tr_b16 v[160:161], v123 offset:27648
  ds_read_b64_tr_b16 v[162:163], v123 offset:28160
  v_mfma_f32_16x16x32_bf16 v[80:83], a[44:47], v[164:167], v[80:83]
  buffer_load_dwordx4 a[36:39], v105, s[4:7], s16 offen offset:1024 sc1
  v_mfma_f32_16x16x32_bf16 v[36:39], a[40:43], v[168:171], v[36:39]
  ds_read_b64_tr_b16 v[164:165], v120 offset:28672
  ds_read_b64_tr_b16 v[166:167], v120 offset:29184
  v_mfma_f32_16x16x32_bf16 v[84:87], a[44:47], v[168:171], v[84:87]
  ds_read_b64_tr_b16 v[168:169], v121 offset:28672
  s_add_u32 s16, s16, 131072
  v_mfma_f32_16x16x32_bf16 v[40:43], a[40:43], v[172:175], v[40:43]
  ds_read_b64_tr_b16 v[170:171], v121 offset:29184
  v_mfma_f32_16x16x32_bf16 v[88:91], a[44:47], v[172:175], v[88:91]
  ds_read_b64_tr_b16 v[172:173], v122 offset:28672
  s_bitset0_b32 s16, 20
  v_mfma_f32_16x16x32_bf16 v[44:47], a[40:43], v[176:179], v[44:47]
  ds_read_b64_tr_b16 v[174:175], v122 offset:29184
  v_mfma_f32_16x16x32_bf16 v[92:95], a[44:47], v[176:179], v[92:95]
  s_waitcnt vmcnt(33) lgkmcnt(10)
  s_barrier
  v_mfma_f32_16x16x32_bf16 v[96:99], v[180:183], v[188:191], v[96:99]
  ds_read_b64_tr_b16 v[176:177], v123 offset:28672
  s_add_u32 m0, s38, 66560
  v_mfma_f32_16x16x32_bf16 v[100:103], v[188:191], v[184:187], v[100:103]
  buffer_load_dwordx4 v107, s[8:11], s17 offen lds
  v_mfma_f32_16x16x32_bf16 v[0:3], v[132:135], a[48:51], v[0:3]
  ds_read_b64_tr_b16 v[178:179], v123 offset:29184
  ds_read_b64_tr_b16 v[180:181], v124 offset:40960
  v_mfma_f32_16x16x32_bf16 v[48:51], v[132:135], a[52:55], v[48:51]
  ds_read_b64_tr_b16 v[182:183], v124 offset:41472
  buffer_load_dwordx4 v108, s[8:11], s17 offen offset:1024 lds
  v_mfma_f32_16x16x32_bf16 v[4:7], v[136:139], a[48:51], v[4:7]
  ds_read_b128 v[188:191], v125 offset:52224
  ds_read_b64_tr_b16 v[184:185], v124 offset:41984
  ds_read_b64_tr_b16 v[186:187], v124 offset:42496
  v_mfma_f32_16x16x32_bf16 v[52:55], v[136:139], a[52:55], v[52:55]
  buffer_load_dwordx4 v109, s[8:11], s17 offen offset:2048 lds
  v_mfma_f32_16x16x32_bf16 v[8:11], v[140:143], a[48:51], v[8:11]
  ds_read_b64_tr_b16 v[132:133], v120 offset:39936
  ds_read_b64_tr_b16 v[134:135], v120 offset:40448
  v_mfma_f32_16x16x32_bf16 v[56:59], v[140:143], a[52:55], v[56:59]
  ds_read_b64_tr_b16 v[136:137], v121 offset:39936
  s_add_u32 s17, s17, 196608
  v_mfma_f32_16x16x32_bf16 v[12:15], v[144:147], a[48:51], v[12:15]
  ds_read_b64_tr_b16 v[138:139], v121 offset:40448
  ds_read_b64_tr_b16 v[140:141], v122 offset:39936
  v_mfma_f32_16x16x32_bf16 v[60:63], v[144:147], a[52:55], v[60:63]
  ds_read_b64_tr_b16 v[142:143], v122 offset:40448
  s_cmp_eq_u32 s17, s10
  v_mfma_f32_16x16x32_bf16 v[16:19], v[148:151], a[48:51], v[16:19]
  ds_read_b64_tr_b16 v[144:145], v123 offset:39936
  ds_read_b64_tr_b16 v[146:147], v123 offset:40448
  v_mfma_f32_16x16x32_bf16 v[64:67], v[148:151], a[52:55], v[64:67]
  ds_read_b64_tr_b16 v[148:149], v120 offset:40960
  s_cselect_b32 s17, 0, s17
  v_mfma_f32_16x16x32_bf16 v[20:23], v[152:155], a[48:51], v[20:23]
  ds_read_b64_tr_b16 v[150:151], v120 offset:41472
  v_mfma_f32_16x16x32_bf16 v[68:71], v[152:155], a[52:55], v[68:71]
  ds_read_b64_tr_b16 v[152:153], v121 offset:40960
  s_add_u32 m0, s39, 66560
  s_waitcnt lgkmcnt(10)
  v_mfma_f32_16x16x32_bf16 v[24:27], v[156:159], a[48:51], v[24:27]
  ds_read_b64_tr_b16 v[154:155], v121 offset:41472
  v_mfma_f32_16x16x32_bf16 v[72:75], v[156:159], a[52:55], v[72:75]
  buffer_load_dword v106, s[4:7], s16 offen sc1 lds
  v_mfma_f32_16x16x32_bf16 v[28:31], v[160:163], a[48:51], v[28:31]
  ds_read_b64_tr_b16 v[156:157], v122 offset:40960
  ds_read_b64_tr_b16 v[158:159], v122 offset:41472
  v_mfma_f32_16x16x32_bf16 v[76:79], v[160:163], a[52:55], v[76:79]
  buffer_load_dwordx4 a[40:43], v105, s[4:7], s16 offen sc1
  v_mfma_f32_16x16x32_bf16 v[32:35], a[48:51], v[164:167], v[32:35]
  ds_read_b64_tr_b16 v[160:161], v123 offset:40960
  ds_read_b64_tr_b16 v[162:163], v123 offset:41472
  v_mfma_f32_16x16x32_bf16 v[80:83], a[52:55], v[164:167], v[80:83]
  buffer_load_dwordx4 a[44:47], v105, s[4:7], s16 offen offset:1024 sc1
  v_mfma_f32_16x16x32_bf16 v[36:39], a[48:51], v[168:171], v[36:39]
  ds_read_b64_tr_b16 v[164:165], v120 offset:41984
  ds_read_b64_tr_b16 v[166:167], v120 offset:42496
  v_mfma_f32_16x16x32_bf16 v[84:87], a[52:55], v[168:171], v[84:87]
  ds_read_b64_tr_b16 v[168:169], v121 offset:41984
  s_add_u32 s16, s16, 131072
  v_mfma_f32_16x16x32_bf16 v[40:43], a[48:51], v[172:175], v[40:43]
  ds_read_b64_tr_b16 v[170:171], v121 offset:42496
  v_mfma_f32_16x16x32_bf16 v[88:91], a[52:55], v[172:175], v[88:91]
  ds_read_b64_tr_b16 v[172:173], v122 offset:41984
  s_bitset0_b32 s16, 20
  v_mfma_f32_16x16x32_bf16 v[44:47], a[48:51], v[176:179], v[44:47]
  ds_read_b64_tr_b16 v[174:175], v122 offset:42496
  v_mfma_f32_16x16x32_bf16 v[92:95], a[52:55], v[176:179], v[92:95]
  s_waitcnt vmcnt(33) lgkmcnt(10)
  s_barrier
  v_mfma_f32_16x16x32_bf16 v[96:99], v[180:183], v[188:191], v[96:99]
  ds_read_b64_tr_b16 v[176:177], v123 offset:41984
  s_add_u32 m0, s38, 79872
  v_mfma_f32_16x16x32_bf16 v[100:103], v[188:191], v[184:187], v[100:103]
  buffer_load_dwordx4 v107, s[8:11], s17 offen lds
  v_mfma_f32_16x16x32_bf16 v[0:3], v[132:135], a[56:59], v[0:3]
  ds_read_b64_tr_b16 v[178:179], v123 offset:42496
  ds_read_b64_tr_b16 v[180:181], v118 offset:1024
  v_mfma_f32_16x16x32_bf16 v[48:51], v[132:135], a[60:63], v[48:51]
  ds_read_b64_tr_b16 v[182:183], v118 offset:1536
  buffer_load_dwordx4 v108, s[8:11], s17 offen offset:1024 lds
  v_mfma_f32_16x16x32_bf16 v[4:7], v[136:139], a[56:59], v[4:7]
  ds_read_b128 v[188:191], v119 offset:12288
  ds_read_b64_tr_b16 v[184:185], v118 offset:2048
  ds_read_b64_tr_b16 v[186:187], v118 offset:2560
  v_mfma_f32_16x16x32_bf16 v[52:55], v[136:139], a[60:63], v[52:55]
  buffer_load_dwordx4 v109, s[8:11], s17 offen offset:2048 lds
  v_mfma_f32_16x16x32_bf16 v[8:11], v[140:143], a[56:59], v[8:11]
  ds_read_b64_tr_b16 v[132:133], v114 offset:0
  ds_read_b64_tr_b16 v[134:135], v114 offset:512
  v_mfma_f32_16x16x32_bf16 v[56:59], v[140:143], a[60:63], v[56:59]
  ds_read_b64_tr_b16 v[136:137], v115 offset:0
  s_add_u32 s17, s17, 196608
  v_mfma_f32_16x16x32_bf16 v[12:15], v[144:147], a[56:59], v[12:15]
  ds_read_b64_tr_b16 v[138:139], v115 offset:512
  ds_read_b64_tr_b16 v[140:141], v116 offset:0
  v_mfma_f32_16x16x32_bf16 v[60:63], v[144:147], a[60:63], v[60:63]
  ds_read_b64_tr_b16 v[142:143], v116 offset:512
  s_cmp_eq_u32 s17, s10
  v_mfma_f32_16x16x32_bf16 v[16:19], v[148:151], a[56:59], v[16:19]
  ds_read_b64_tr_b16 v[144:145], v117 offset:0
  ds_read_b64_tr_b16 v[146:147], v117 offset:512
  v_mfma_f32_16x16x32_bf16 v[64:67], v[148:151], a[60:63], v[64:67]
  ds_read_b64_tr_b16 v[148:149], v114 offset:1024
  s_cselect_b32 s17, 0, s17
  v_mfma_f32_16x16x32_bf16 v[20:23], v[152:155], a[56:59], v[20:23]
  ds_read_b64_tr_b16 v[150:151], v114 offset:1536
  v_mfma_f32_16x16x32_bf16 v[68:71], v[152:155], a[60:63], v[68:71]
  ds_read_b64_tr_b16 v[152:153], v115 offset:1024
  s_add_u32 m0, s39, 79872
  s_waitcnt lgkmcnt(10)
  v_mfma_f32_16x16x32_bf16 v[24:27], v[156:159], a[56:59], v[24:27]
  ds_read_b64_tr_b16 v[154:155], v115 offset:1536
  v_mfma_f32_16x16x32_bf16 v[72:75], v[156:159], a[60:63], v[72:75]
  buffer_load_dword v106, s[4:7], s16 offen sc1 lds
  v_mfma_f32_16x16x32_bf16 v[28:31], v[160:163], a[56:59], v[28:31]
  ds_read_b64_tr_b16 v[156:157], v116 offset:1024
  ds_read_b64_tr_b16 v[158:159], v116 offset:1536
  v_mfma_f32_16x16x32_bf16 v[76:79], v[160:163], a[60:63], v[76:79]
  buffer_load_dwordx4 a[48:51], v105, s[4:7], s16 offen sc1
  v_mfma_f32_16x16x32_bf16 v[32:35], a[56:59], v[164:167], v[32:35]
  ds_read_b64_tr_b16 v[160:161], v117 offset:1024
  ds_read_b64_tr_b16 v[162:163], v117 offset:1536
  v_mfma_f32_16x16x32_bf16 v[80:83], a[60:63], v[164:167], v[80:83]
  buffer_load_dwordx4 a[52:55], v105, s[4:7], s16 offen offset:1024 sc1
  v_mfma_f32_16x16x32_bf16 v[36:39], a[56:59], v[168:171], v[36:39]
  ds_read_b64_tr_b16 v[164:165], v114 offset:2048
  ds_read_b64_tr_b16 v[166:167], v114 offset:2560
  v_mfma_f32_16x16x32_bf16 v[84:87], a[60:63], v[168:171], v[84:87]
  ds_read_b64_tr_b16 v[168:169], v115 offset:2048
  s_add_u32 s16, s16, 131072
  v_mfma_f32_16x16x32_bf16 v[40:43], a[56:59], v[172:175], v[40:43]
  ds_read_b64_tr_b16 v[170:171], v115 offset:2560
  v_mfma_f32_16x16x32_bf16 v[88:91], a[60:63], v[172:175], v[88:91]
  ds_read_b64_tr_b16 v[172:173], v116 offset:2048
  s_bitset0_b32 s16, 20
  v_mfma_f32_16x16x32_bf16 v[44:47], a[56:59], v[176:179], v[44:47]
  ds_read_b64_tr_b16 v[174:175], v116 offset:2560
  v_mfma_f32_16x16x32_bf16 v[92:95], a[60:63], v[176:179], v[92:95]
  s_waitcnt vmcnt(33) lgkmcnt(10)
  s_barrier
  v_mfma_f32_16x16x32_bf16 v[96:99], v[180:183], v[188:191], v[96:99]
  ds_read_b64_tr_b16 v[176:177], v117 offset:2048
  s_add_u32 m0, s38, 93184
  v_mfma_f32_16x16x32_bf16 v[100:103], v[188:191], v[184:187], v[100:103]
  buffer_load_dwordx4 v107, s[8:11], s17 offen lds
  v_mfma_f32_16x16x32_bf16 v[0:3], v[132:135], a[0:3], v[0:3]
  ds_read_b64_tr_b16 v[178:179], v117 offset:2560
  buffer_load_dwordx4 v108, s[8:11], s17 offen offset:1024 lds
  v_mfma_f32_16x16x32_bf16 v[48:51], v[132:135], a[4:7], v[48:51]
  ds_read_b64_tr_b16 v[180:181], v118 offset:14336
  ds_read_b64_tr_b16 v[182:183], v118 offset:14848
  buffer_load_dwordx4 v109, s[8:11], s17 offen offset:2048 lds
  v_mfma_f32_16x16x32_bf16 v[4:7], v[136:139], a[0:3], v[4:7]
  ds_read_b128 v[188:191], v119 offset:25600
  ds_read_b64_tr_b16 v[184:185], v118 offset:15360
  ds_read_b64_tr_b16 v[186:187], v118 offset:15872
  s_add_u32 s17, s17, 196608
  v_mfma_f32_16x16x32_bf16 v[52:55], v[136:139], a[4:7], v[52:55]
  ds_read_b64_tr_b16 v[132:133], v114 offset:13312
  s_cmp_eq_u32 s17, s10
  v_mfma_f32_16x16x32_bf16 v[8:11], v[140:143], a[0:3], v[8:11]
  ds_read_b64_tr_b16 v[134:135], v114 offset:13824
  s_cselect_b32 s17, 0, s17
  v_mfma_f32_16x16x32_bf16 v[56:59], v[140:143], a[4:7], v[56:59]
  s_add_u32 s8, s8, s10
  s_addc_u32 s9, s9, 0
  v_mfma_f32_16x16x32_bf16 v[12:15], v[144:147], a[0:3], v[12:15]
  ds_read_b64_tr_b16 v[136:137], v115 offset:13312
  ds_read_b64_tr_b16 v[138:139], v115 offset:13824
  s_add_u32 m0, s39, 93184
  v_mfma_f32_16x16x32_bf16 v[60:63], v[144:147], a[4:7], v[60:63]
  buffer_load_dword v106, s[4:7], s16 offen sc1 lds
  v_mfma_f32_16x16x32_bf16 v[16:19], v[148:151], a[0:3], v[16:19]
  ds_read_b64_tr_b16 v[140:141], v116 offset:13312
  ds_read_b64_tr_b16 v[142:143], v116 offset:13824
  buffer_load_dwordx4 a[56:59], v105, s[4:7], s16 offen sc1
  v_mfma_f32_16x16x32_bf16 v[64:67], v[148:151], a[4:7], v[64:67]
  buffer_load_dwordx4 a[60:63], v105, s[4:7], s16 offen offset:1024 sc1
  v_mfma_f32_16x16x32_bf16 v[20:23], v[152:155], a[0:3], v[20:23]
  ds_read_b64_tr_b16 v[144:145], v117 offset:13312
  ds_read_b64_tr_b16 v[146:147], v117 offset:13824
  s_add_u32 s16, s16, 131072
  v_mfma_f32_16x16x32_bf16 v[68:71], v[152:155], a[4:7], v[68:71]
  ds_read_b64_tr_b16 v[148:149], v114 offset:14336
  s_bitset0_b32 s16, 20
  s_waitcnt lgkmcnt(10)
  v_mfma_f32_16x16x32_bf16 v[24:27], v[156:159], a[0:3], v[24:27]
  ds_read_b64_tr_b16 v[150:151], v114 offset:14848
  s_add_u32 s4, s4, s6
  s_addc_u32 s5, s5, 0
  v_mfma_f32_16x16x32_bf16 v[72:75], v[156:159], a[4:7], v[72:75]
  ds_read_b64_tr_b16 v[152:153], v115 offset:14336
  s_mov_b32 m0, s51
  v_mfma_f32_16x16x32_bf16 v[28:31], v[160:163], a[0:3], v[28:31]
  ds_read_b64_tr_b16 v[154:155], v115 offset:14848
  s_add_u32 s51, s51, 1024
  v_mfma_f32_16x16x32_bf16 v[76:79], v[160:163], a[4:7], v[76:79]
  buffer_load_dwordx4 v129, s[52:55], s50 offen nt lds
  v_mfma_f32_16x16x32_bf16 v[32:35], a[0:3], v[164:167], v[32:35]
  ds_read_b64_tr_b16 v[156:157], v116 offset:14336
  ds_read_b64_tr_b16 v[158:159], v116 offset:14848
  s_add_u32 s50, s50, 98304
  v_mfma_f32_16x16x32_bf16 v[80:83], a[4:7], v[164:167], v[80:83]
  ds_read_b64_tr_b16 v[160:161], v117 offset:14336
  s_mov_b32 m0, s51
  v_mfma_f32_16x16x32_bf16 v[36:39], a[0:3], v[168:171], v[36:39]
  ds_read_b64_tr_b16 v[162:163], v117 offset:14848
  s_add_u32 s51, s51, 1024
  v_mfma_f32_16x16x32_bf16 v[84:87], a[4:7], v[168:171], v[84:87]
  buffer_load_dwordx4 v129, s[52:55], s50 offen nt lds
  v_mfma_f32_16x16x32_bf16 v[40:43], a[0:3], v[172:175], v[40:43]
  ds_read_b64_tr_b16 v[164:165], v114 offset:15360
  ds_read_b64_tr_b16 v[166:167], v114 offset:15872
  s_add_u32 s50, s50, 98304
  v_mfma_f32_16x16x32_bf16 v[88:91], a[4:7], v[172:175], v[88:91]
  buffer_store_dwordx4 v[244:247], v119, s[92:95], s35 offen offset:1024 sc1
  v_mfma_f32_16x16x32_bf16 v[44:47], a[0:3], v[176:179], v[44:47]
  ds_read_b64_tr_b16 v[168:169], v115 offset:15360
  ds_read_b64_tr_b16 v[170:171], v115 offset:15872
  v_mfma_f32_16x16x32_bf16 v[92:95], a[4:7], v[176:179], v[92:95]
  s_waitcnt vmcnt(36) lgkmcnt(10)
  s_barrier
  v_mfma_f32_16x16x32_bf16 v[96:99], v[180:183], v[188:191], v[96:99]
  ds_read_b64_tr_b16 v[172:173], v116 offset:15360
  ds_read_b64_tr_b16 v[174:175], v116 offset:15872
  s_add_u32 m0, s38, 0
  v_mfma_f32_16x16x32_bf16 v[100:103], v[188:191], v[184:187], v[100:103]
  buffer_load_dwordx4 v107, s[8:11], s17 offen lds
  v_mfma_f32_16x16x32_bf16 v[0:3], v[132:135], a[8:11], v[0:3]
  ds_read_b64_tr_b16 v[176:177], v117 offset:15360
  ds_read_b64_tr_b16 v[178:179], v117 offset:15872
  v_mfma_f32_16x16x32_bf16 v[48:51], v[132:135], a[12:15], v[48:51]
  ds_read_b64_tr_b16 v[180:181], v118 offset:27648
  ds_read_b64_tr_b16 v[182:183], v118 offset:28160
  buffer_load_dwordx4 v108, s[8:11], s17 offen offset:1024 lds
  v_mfma_f32_16x16x32_bf16 v[4:7], v[136:139], a[8:11], v[4:7]
  ds_read_b128 v[188:191], v119 offset:38912
  ds_read_b64_tr_b16 v[184:185], v118 offset:28672
  ds_read_b64_tr_b16 v[186:187], v118 offset:29184
  v_mfma_f32_16x16x32_bf16 v[52:55], v[136:139], a[12:15], v[52:55]
  buffer_load_dwordx4 v109, s[8:11], s17 offen offset:2048 lds
  v_mfma_f32_16x16x32_bf16 v[8:11], v[140:143], a[8:11], v[8:11]
  ds_read_b64_tr_b16 v[132:133], v114 offset:26624
  ds_read_b64_tr_b16 v[134:135], v114 offset:27136
  v_mfma_f32_16x16x32_bf16 v[56:59], v[140:143], a[12:15], v[56:59]
  ds_read_b64_tr_b16 v[136:137], v115 offset:26624
  s_add_u32 s17, s17, 196608
  v_mfma_f32_16x16x32_bf16 v[12:15], v[144:147], a[8:11], v[12:15]
  ds_read_b64_tr_b16 v[138:139], v115 offset:27136
  ds_read_b64_tr_b16 v[140:141], v116 offset:26624
  v_mfma_f32_16x16x32_bf16 v[60:63], v[144:147], a[12:15], v[60:63]
  ds_read_b64_tr_b16 v[142:143], v116 offset:27136
  s_cmp_eq_u32 s17, s10
  v_mfma_f32_16x16x32_bf16 v[16:19], v[148:151], a[8:11], v[16:19]
  ds_read_b64_tr_b16 v[144:145], v117 offset:26624
  ds_read_b64_tr_b16 v[146:147], v117 offset:27136
  v_mfma_f32_16x16x32_bf16 v[64:67], v[148:151], a[12:15], v[64:67]
  ds_read_b64_tr_b16 v[148:149], v114 offset:27648
  s_cselect_b32 s17, 0, s17
  s_waitcnt lgkmcnt(10)
  v_mfma_f32_16x16x32_bf16 v[20:23], v[152:155], a[8:11], v[20:23]
  ds_read_b64_tr_b16 v[150:151], v114 offset:28160
  v_mfma_f32_16x16x32_bf16 v[68:71], v[152:155], a[12:15], v[68:71]
  ds_read_b64_tr_b16 v[152:153], v115 offset:27648
  s_add_u32 m0, s39, 0
  v_mfma_f32_16x16x32_bf16 v[24:27], v[156:159], a[8:11], v[24:27]
  ds_read_b64_tr_b16 v[154:155], v115 offset:28160
  v_mfma_f32_16x16x32_bf16 v[72:75], v[156:159], a[12:15], v[72:75]
  buffer_load_dword v106, s[4:7], s16 offen sc1 lds
  v_mfma_f32_16x16x32_bf16 v[28:31], v[160:163], a[8:11], v[28:31]
  ds_read_b64_tr_b16 v[156:157], v116 offset:27648
  ds_read_b64_tr_b16 v[158:159], v116 offset:28160
  v_mfma_f32_16x16x32_bf16 v[76:79], v[160:163], a[12:15], v[76:79]
  buffer_load_dwordx4 a[0:3], v105, s[4:7], s16 offen sc1
  v_mfma_f32_16x16x32_bf16 v[32:35], a[8:11], v[164:167], v[32:35]
  ds_read_b64_tr_b16 v[160:161], v117 offset:27648
  ds_read_b64_tr_b16 v[162:163], v117 offset:28160
  v_mfma_f32_16x16x32_bf16 v[80:83], a[12:15], v[164:167], v[80:83]
  buffer_load_dwordx4 a[4:7], v105, s[4:7], s16 offen offset:1024 sc1
  v_mfma_f32_16x16x32_bf16 v[36:39], a[8:11], v[168:171], v[36:39]
  ds_read_b64_tr_b16 v[164:165], v114 offset:28672
  ds_read_b64_tr_b16 v[166:167], v114 offset:29184
  v_mfma_f32_16x16x32_bf16 v[84:87], a[12:15], v[168:171], v[84:87]
  ds_read_b64_tr_b16 v[168:169], v115 offset:28672
  s_add_u32 s16, s16, 131072
  v_mfma_f32_16x16x32_bf16 v[40:43], a[8:11], v[172:175], v[40:43]
  ds_read_b64_tr_b16 v[170:171], v115 offset:29184
  v_mfma_f32_16x16x32_bf16 v[88:91], a[12:15], v[172:175], v[88:91]
  ds_read_b64_tr_b16 v[172:173], v116 offset:28672
  s_bitset0_b32 s16, 20
  v_mfma_f32_16x16x32_bf16 v[44:47], a[8:11], v[176:179], v[44:47]
  ds_read_b64_tr_b16 v[174:175], v116 offset:29184
  v_mfma_f32_16x16x32_bf16 v[92:95], a[12:15], v[176:179], v[92:95]
  s_waitcnt vmcnt(36) lgkmcnt(10)
  s_barrier
  v_mfma_f32_16x16x32_bf16 v[96:99], v[180:183], v[188:191], v[96:99]
  ds_read_b64_tr_b16 v[176:177], v117 offset:28672
  s_add_u32 m0, s38, 13312
  v_mfma_f32_16x16x32_bf16 v[100:103], v[188:191], v[184:187], v[100:103]
  buffer_load_dwordx4 v107, s[8:11], s17 offen lds
  v_mfma_f32_16x16x32_bf16 v[0:3], v[132:135], a[16:19], v[0:3]
  ds_read_b64_tr_b16 v[178:179], v117 offset:29184
  ds_read_b64_tr_b16 v[180:181], v118 offset:40960
  v_mfma_f32_16x16x32_bf16 v[48:51], v[132:135], a[20:23], v[48:51]
  ds_read_b64_tr_b16 v[182:183], v118 offset:41472
  buffer_load_dwordx4 v108, s[8:11], s17 offen offset:1024 lds
  v_mfma_f32_16x16x32_bf16 v[4:7], v[136:139], a[16:19], v[4:7]
  ds_read_b128 v[188:191], v119 offset:52224
  ds_read_b64_tr_b16 v[184:185], v118 offset:41984
  ds_read_b64_tr_b16 v[186:187], v118 offset:42496
  v_mfma_f32_16x16x32_bf16 v[52:55], v[136:139], a[20:23], v[52:55]
  buffer_load_dwordx4 v109, s[8:11], s17 offen offset:2048 lds
  v_mfma_f32_16x16x32_bf16 v[8:11], v[140:143], a[16:19], v[8:11]
  ds_read_b64_tr_b16 v[132:133], v114 offset:39936
  ds_read_b64_tr_b16 v[134:135], v114 offset:40448
  v_mfma_f32_16x16x32_bf16 v[56:59], v[140:143], a[20:23], v[56:59]
  ds_read_b64_tr_b16 v[136:137], v115 offset:39936
  s_add_u32 s17, s17, 196608
  v_mfma_f32_16x16x32_bf16 v[12:15], v[144:147], a[16:19], v[12:15]
  ds_read_b64_tr_b16 v[138:139], v115 offset:40448
  s_cmp_eq_u32 s17, s10
  v_mfma_f32_16x16x32_bf16 v[60:63], v[144:147], a[20:23], v[60:63]
  ds_read_b64_tr_b16 v[140:141], v116 offset:39936
  ds_read_b64_tr_b16 v[142:143], v116 offset:40448
  v_mfma_f32_16x16x32_bf16 v[16:19], v[148:151], a[16:19], v[16:19]
  ds_read_b64_tr_b16 v[144:145], v117 offset:39936
  s_cselect_b32 s17, 0, s17
  v_mfma_f32_16x16x32_bf16 v[64:67], v[148:151], a[20:23], v[64:67]
  ds_read_b64_tr_b16 v[146:147], v117 offset:40448
  ds_read_b64_tr_b16 v[148:149], v114 offset:40960
  v_mfma_f32_16x16x32_bf16 v[20:23], v[152:155], a[16:19], v[20:23]
  ds_read_b64_tr_b16 v[150:151], v114 offset:41472
  s_add_u32 m0, s39, 13312
  v_mfma_f32_16x16x32_bf16 v[68:71], v[152:155], a[20:23], v[68:71]
  ds_read_b64_tr_b16 v[152:153], v115 offset:40960
  ds_read_b64_tr_b16 v[154:155], v115 offset:41472
  s_waitcnt lgkmcnt(10)
  v_mfma_f32_16x16x32_bf16 v[24:27], v[156:159], a[16:19], v[24:27]
  buffer_load_dword v106, s[4:7], s16 offen sc1 lds
  v_mfma_f32_16x16x32_bf16 v[72:75], v[156:159], a[20:23], v[72:75]
  ds_read_b64_tr_b16 v[156:157], v116 offset:40960
  ds_read_b64_tr_b16 v[158:159], v116 offset:41472
  v_mfma_f32_16x16x32_bf16 v[28:31], v[160:163], a[16:19], v[28:31]
  buffer_load_dwordx4 a[8:11], v105, s[4:7], s16 offen sc1
  v_mfma_f32_16x16x32_bf16 v[76:79], v[160:163], a[20:23], v[76:79]
  buffer_load_dwordx4 a[12:15], v105, s[4:7], s16 offen offset:1024 sc1
  v_mfma_f32_16x16x32_bf16 v[32:35], a[16:19], v[164:167], v[32:35]
  ds_read_b64_tr_b16 v[160:161], v117 offset:40960
  ds_read_b64_tr_b16 v[162:163], v117 offset:41472
  v_mfma_f32_16x16x32_bf16 v[80:83], a[20:23], v[164:167], v[80:83]
  ds_read_b64_tr_b16 v[164:165], v114 offset:41984
  s_add_u32 s16, s16, 131072
  v_mfma_f32_16x16x32_bf16 v[36:39], a[16:19], v[168:171], v[36:39]
  ds_read_b64_tr_b16 v[166:167], v114 offset:42496
  v_mfma_f32_16x16x32_bf16 v[84:87], a[20:23], v[168:171], v[84:87]
  ds_read_b64_tr_b16 v[168:169], v115 offset:41984
  s_bitset0_b32 s16, 20
  v_mfma_f32_16x16x32_bf16 v[40:43], a[16:19], v[172:175], v[40:43]
  ds_read_b64_tr_b16 v[170:171], v115 offset:42496
  v_mfma_f32_16x16x32_bf16 v[88:91], a[20:23], v[172:175], v[88:91]
  buffer_load_dword v131, v130, s[56:59], s97 offen
  v_mfma_f32_16x16x32_bf16 v[44:47], a[16:19], v[176:179], v[44:47]
  ds_read_b64_tr_b16 v[172:173], v116 offset:41984
  ds_read_b64_tr_b16 v[174:175], v116 offset:42496
  v_mfma_f32_16x16x32_bf16 v[92:95], a[20:23], v[176:179], v[92:95]
  s_waitcnt vmcnt(34) lgkmcnt(10)
  s_barrier
  v_mfma_f32_16x16x32_bf16 v[96:99], v[180:183], v[188:191], v[96:99]
  ds_read_b64_tr_b16 v[176:177], v117 offset:41984
  s_add_u32 m0, s38, 26624
  v_mfma_f32_16x16x32_bf16 v[100:103], v[188:191], v[184:187], v[100:103]
  buffer_load_dwordx4 v107, s[8:11], s17 offen lds
  v_mfma_f32_16x16x32_bf16 v[0:3], v[132:135], a[24:27], v[0:3]
  ds_read_b64_tr_b16 v[178:179], v117 offset:42496
  ds_read_b64_tr_b16 v[180:181], v124 offset:1024
  v_mfma_f32_16x16x32_bf16 v[48:51], v[132:135], a[28:31], v[48:51]
  ds_read_b64_tr_b16 v[182:183], v124 offset:1536
  buffer_load_dwordx4 v108, s[8:11], s17 offen offset:1024 lds
  v_mfma_f32_16x16x32_bf16 v[4:7], v[136:139], a[24:27], v[4:7]
  ds_read_b128 v[188:191], v125 offset:12288
  ds_read_b64_tr_b16 v[184:185], v124 offset:2048
  ds_read_b64_tr_b16 v[186:187], v124 offset:2560
  v_mfma_f32_16x16x32_bf16 v[52:55], v[136:139], a[28:31], v[52:55]
  buffer_load_dwordx4 v109, s[8:11], s17 offen offset:2048 lds
  v_mfma_f32_16x16x32_bf16 v[8:11], v[140:143], a[24:27], v[8:11]
  ds_read_b64_tr_b16 v[132:133], v120 offset:0
  ds_read_b64_tr_b16 v[134:135], v120 offset:512
  v_mfma_f32_16x16x32_bf16 v[56:59], v[140:143], a[28:31], v[56:59]
  ds_read_b64_tr_b16 v[136:137], v121 offset:0
  s_add_u32 s17, s17, 196608
  v_mfma_f32_16x16x32_bf16 v[12:15], v[144:147], a[24:27], v[12:15]
  ds_read_b64_tr_b16 v[138:139], v121 offset:512
  ds_read_b64_tr_b16 v[140:141], v122 offset:0
  v_mfma_f32_16x16x32_bf16 v[60:63], v[144:147], a[28:31], v[60:63]
  ds_read_b64_tr_b16 v[142:143], v122 offset:512
  s_cmp_eq_u32 s17, s10
  v_mfma_f32_16x16x32_bf16 v[16:19], v[148:151], a[24:27], v[16:19]
  ds_read_b64_tr_b16 v[144:145], v123 offset:0
  ds_read_b64_tr_b16 v[146:147], v123 offset:512
  v_mfma_f32_16x16x32_bf16 v[64:67], v[148:151], a[28:31], v[64:67]
  ds_read_b64_tr_b16 v[148:149], v120 offset:1024
  s_cselect_b32 s17, 0, s17
  v_mfma_f32_16x16x32_bf16 v[20:23], v[152:155], a[24:27], v[20:23]
  ds_read_b64_tr_b16 v[150:151], v120 offset:1536
  v_mfma_f32_16x16x32_bf16 v[68:71], v[152:155], a[28:31], v[68:71]
  ds_read_b64_tr_b16 v[152:153], v121 offset:1024
  s_add_u32 m0, s39, 26624
  s_waitcnt lgkmcnt(10)
  v_mfma_f32_16x16x32_bf16 v[24:27], v[156:159], a[24:27], v[24:27]
  ds_read_b64_tr_b16 v[154:155], v121 offset:1536
  v_mfma_f32_16x16x32_bf16 v[72:75], v[156:159], a[28:31], v[72:75]
  buffer_load_dword v106, s[4:7], s16 offen sc1 lds
  v_mfma_f32_16x16x32_bf16 v[28:31], v[160:163], a[24:27], v[28:31]
  ds_read_b64_tr_b16 v[156:157], v122 offset:1024
  ds_read_b64_tr_b16 v[158:159], v122 offset:1536
  v_mfma_f32_16x16x32_bf16 v[76:79], v[160:163], a[28:31], v[76:79]
  buffer_load_dwordx4 a[16:19], v105, s[4:7], s16 offen sc1
  v_mfma_f32_16x16x32_bf16 v[32:35], a[24:27], v[164:167], v[32:35]
  ds_read_b64_tr_b16 v[160:161], v123 offset:1024
  ds_read_b64_tr_b16 v[162:163], v123 offset:1536
  v_mfma_f32_16x16x32_bf16 v[80:83], a[28:31], v[164:167], v[80:83]
  buffer_load_dwordx4 a[20:23], v105, s[4:7], s16 offen offset:1024 sc1
  v_mfma_f32_16x16x32_bf16 v[36:39], a[24:27], v[168:171], v[36:39]
  ds_read_b64_tr_b16 v[164:165], v120 offset:2048
  ds_read_b64_tr_b16 v[166:167], v120 offset:2560
  v_mfma_f32_16x16x32_bf16 v[84:87], a[28:31], v[168:171], v[84:87]
  ds_read_b64_tr_b16 v[168:169], v121 offset:2048
  s_add_u32 s16, s16, 131072
  v_mfma_f32_16x16x32_bf16 v[40:43], a[24:27], v[172:175], v[40:43]
  ds_read_b64_tr_b16 v[170:171], v121 offset:2560
  v_mfma_f32_16x16x32_bf16 v[88:91], a[28:31], v[172:175], v[88:91]
  ds_read_b64_tr_b16 v[172:173], v122 offset:2048
  s_bitset0_b32 s16, 20
  v_mfma_f32_16x16x32_bf16 v[44:47], a[24:27], v[176:179], v[44:47]
  ds_read_b64_tr_b16 v[174:175], v122 offset:2560
  v_mfma_f32_16x16x32_bf16 v[92:95], a[28:31], v[176:179], v[92:95]
  s_waitcnt vmcnt(34) lgkmcnt(10)
  s_barrier
  v_mfma_f32_16x16x32_bf16 v[96:99], v[180:183], v[188:191], v[96:99]
  ds_read_b64_tr_b16 v[176:177], v123 offset:2048
  s_add_u32 m0, s38, 39936
  v_mfma_f32_16x16x32_bf16 v[100:103], v[188:191], v[184:187], v[100:103]
  buffer_load_dwordx4 v107, s[8:11], s17 offen lds
  v_mfma_f32_16x16x32_bf16 v[0:3], v[132:135], a[32:35], v[0:3]
  ds_read_b64_tr_b16 v[178:179], v123 offset:2560
  buffer_load_dwordx4 v108, s[8:11], s17 offen offset:1024 lds
  v_mfma_f32_16x16x32_bf16 v[48:51], v[132:135], a[36:39], v[48:51]
  ds_read_b64_tr_b16 v[180:181], v124 offset:14336
  ds_read_b64_tr_b16 v[182:183], v124 offset:14848
  buffer_load_dwordx4 v109, s[8:11], s17 offen offset:2048 lds
  v_mfma_f32_16x16x32_bf16 v[4:7], v[136:139], a[32:35], v[4:7]
  ds_read_b128 v[188:191], v125 offset:25600
  ds_read_b64_tr_b16 v[184:185], v124 offset:15360
  ds_read_b64_tr_b16 v[186:187], v124 offset:15872
  s_add_u32 s17, s17, 196608
  v_mfma_f32_16x16x32_bf16 v[52:55], v[136:139], a[36:39], v[52:55]
  ds_read_b64_tr_b16 v[132:133], v120 offset:13312
  s_cmp_eq_u32 s17, s10
  v_mfma_f32_16x16x32_bf16 v[8:11], v[140:143], a[32:35], v[8:11]
  ds_read_b64_tr_b16 v[134:135], v120 offset:13824
  s_cselect_b32 s17, 0, s17
  v_mfma_f32_16x16x32_bf16 v[56:59], v[140:143], a[36:39], v[56:59]
  ds_read_b64_tr_b16 v[136:137], v121 offset:13312
  s_add_u32 m0, s39, 39936
  v_mfma_f32_16x16x32_bf16 v[12:15], v[144:147], a[32:35], v[12:15]
  ds_read_b64_tr_b16 v[138:139], v121 offset:13824
  ds_read_b64_tr_b16 v[140:141], v122 offset:13312
  v_mfma_f32_16x16x32_bf16 v[60:63], v[144:147], a[36:39], v[60:63]
  buffer_load_dword v106, s[4:7], s16 offen sc1 lds
  v_mfma_f32_16x16x32_bf16 v[16:19], v[148:151], a[32:35], v[16:19]
  ds_read_b64_tr_b16 v[142:143], v122 offset:13824
  buffer_load_dwordx4 a[24:27], v105, s[4:7], s16 offen sc1
  v_mfma_f32_16x16x32_bf16 v[64:67], v[148:151], a[36:39], v[64:67]
  buffer_load_dwordx4 a[28:31], v105, s[4:7], s16 offen offset:1024 sc1
  v_mfma_f32_16x16x32_bf16 v[20:23], v[152:155], a[32:35], v[20:23]
  ds_read_b64_tr_b16 v[144:145], v123 offset:13312
  ds_read_b64_tr_b16 v[146:147], v123 offset:13824
  s_add_u32 s16, s16, 131072
  v_mfma_f32_16x16x32_bf16 v[68:71], v[152:155], a[36:39], v[68:71]
  ds_read_b64_tr_b16 v[148:149], v120 offset:14336
  s_bitset0_b32 s16, 20
  s_waitcnt lgkmcnt(10)
  v_mfma_f32_16x16x32_bf16 v[24:27], v[156:159], a[32:35], v[24:27]
  ds_read_b64_tr_b16 v[150:151], v120 offset:14848
  s_mov_b32 m0, s51
  v_mfma_f32_16x16x32_bf16 v[72:75], v[156:159], a[36:39], v[72:75]
  ds_read_b64_tr_b16 v[152:153], v121 offset:14336
  s_add_u32 s51, s51, 1024
  v_mfma_f32_16x16x32_bf16 v[28:31], v[160:163], a[32:35], v[28:31]
  ds_read_b64_tr_b16 v[154:155], v121 offset:14848
  ds_read_b64_tr_b16 v[156:157], v122 offset:14336
  v_mfma_f32_16x16x32_bf16 v[76:79], v[160:163], a[36:39], v[76:79]
  buffer_load_dwordx4 v129, s[52:55], s50 offen nt lds
  v_mfma_f32_16x16x32_bf16 v[32:35], a[32:35], v[164:167], v[32:35]
  ds_read_b64_tr_b16 v[158:159], v122 offset:14848
  s_add_u32 s50, s50, 98304
  v_mfma_f32_16x16x32_bf16 v[80:83], a[36:39], v[164:167], v[80:83]
  ds_read_b64_tr_b16 v[160:161], v123 offset:14336
  s_mov_b32 m0, s51
  v_mfma_f32_16x16x32_bf16 v[36:39], a[32:35], v[168:171], v[36:39]
  ds_read_b64_tr_b16 v[162:163], v123 offset:14848
  s_add_u32 s51, s51, 1024
  v_mfma_f32_16x16x32_bf16 v[84:87], a[36:39], v[168:171], v[84:87]
  buffer_load_dwordx4 v129, s[52:55], s50 offen nt lds
  v_mfma_f32_16x16x32_bf16 v[40:43], a[32:35], v[172:175], v[40:43]
  ds_read_b64_tr_b16 v[164:165], v120 offset:15360
  ds_read_b64_tr_b16 v[166:167], v120 offset:15872
  s_add_u32 s50, s50, 98304
  v_mfma_f32_16x16x32_bf16 v[88:91], a[36:39], v[172:175], v[88:91]
  buffer_store_dwordx4 v[244:247], v119, s[92:95], s35 offen offset:2048 sc1
  v_mfma_f32_16x16x32_bf16 v[44:47], a[32:35], v[176:179], v[44:47]
  ds_read_b64_tr_b16 v[168:169], v121 offset:15360
  ds_read_b64_tr_b16 v[170:171], v121 offset:15872
  v_mfma_f32_16x16x32_bf16 v[92:95], a[36:39], v[176:179], v[92:95]
  s_waitcnt vmcnt(37) lgkmcnt(10)
  s_barrier
  v_mfma_f32_16x16x32_bf16 v[96:99], v[180:183], v[188:191], v[96:99]
  ds_read_b64_tr_b16 v[172:173], v122 offset:15360
  ds_read_b64_tr_b16 v[174:175], v122 offset:15872
  s_add_u32 m0, s38, 53248
  v_mfma_f32_16x16x32_bf16 v[100:103], v[188:191], v[184:187], v[100:103]
  buffer_load_dwordx4 v107, s[8:11], s17 offen lds
  v_mfma_f32_16x16x32_bf16 v[0:3], v[132:135], a[40:43], v[0:3]
  ds_read_b64_tr_b16 v[176:177], v123 offset:15360
  ds_read_b64_tr_b16 v[178:179], v123 offset:15872
  v_mfma_f32_16x16x32_bf16 v[48:51], v[132:135], a[44:47], v[48:51]
  ds_read_b64_tr_b16 v[180:181], v124 offset:27648
  ds_read_b64_tr_b16 v[182:183], v124 offset:28160
  buffer_load_dwordx4 v108, s[8:11], s17 offen offset:1024 lds
  v_mfma_f32_16x16x32_bf16 v[4:7], v[136:139], a[40:43], v[4:7]
  ds_read_b128 v[188:191], v125 offset:38912
  ds_read_b64_tr_b16 v[184:185], v124 offset:28672
  ds_read_b64_tr_b16 v[186:187], v124 offset:29184
  v_mfma_f32_16x16x32_bf16 v[52:55], v[136:139], a[44:47], v[52:55]
  buffer_load_dwordx4 v109, s[8:11], s17 offen offset:2048 lds
  v_mfma_f32_16x16x32_bf16 v[8:11], v[140:143], a[40:43], v[8:11]
  ds_read_b64_tr_b16 v[132:133], v120 offset:26624
  ds_read_b64_tr_b16 v[134:135], v120 offset:27136
  v_mfma_f32_16x16x32_bf16 v[56:59], v[140:143], a[44:47], v[56:59]
  ds_read_b64_tr_b16 v[136:137], v121 offset:26624
  s_add_u32 s17, s17, 196608
  v_mfma_f32_16x16x32_bf16 v[12:15], v[144:147], a[40:43], v[12:15]
  ds_read_b64_tr_b16 v[138:139], v121 offset:27136
  ds_read_b64_tr_b16 v[140:141], v122 offset:26624
  v_mfma_f32_16x16x32_bf16 v[60:63], v[144:147], a[44:47], v[60:63]
  ds_read_b64_tr_b16 v[142:143], v122 offset:27136
  s_cmp_eq_u32 s17, s10
  v_mfma_f32_16x16x32_bf16 v[16:19], v[148:151], a[40:43], v[16:19]
  ds_read_b64_tr_b16 v[144:145], v123 offset:26624
  ds_read_b64_tr_b16 v[146:147], v123 offset:27136
  v_mfma_f32_16x16x32_bf16 v[64:67], v[148:151], a[44:47], v[64:67]
  ds_read_b64_tr_b16 v[148:149], v120 offset:27648
  s_cselect_b32 s17, 0, s17
  s_waitcnt lgkmcnt(10)
  v_mfma_f32_16x16x32_bf16 v[20:23], v[152:155], a[40:43], v[20:23]
  ds_read_b64_tr_b16 v[150:151], v120 offset:28160
  v_mfma_f32_16x16x32_bf16 v[68:71], v[152:155], a[44:47], v[68:71]
  ds_read_b64_tr_b16 v[152:153], v121 offset:27648
  s_add_u32 m0, s39, 53248
  v_mfma_f32_16x16x32_bf16 v[24:27], v[156:159], a[40:43], v[24:27]
  ds_read_b64_tr_b16 v[154:155], v121 offset:28160
  v_mfma_f32_16x16x32_bf16 v[72:75], v[156:159], a[44:47], v[72:75]
  buffer_load_dword v106, s[4:7], s16 offen sc1 lds
  v_mfma_f32_16x16x32_bf16 v[28:31], v[160:163], a[40:43], v[28:31]
  ds_read_b64_tr_b16 v[156:157], v122 offset:27648
  ds_read_b64_tr_b16 v[158:159], v122 offset:28160
  v_mfma_f32_16x16x32_bf16 v[76:79], v[160:163], a[44:47], v[76:79]
  buffer_load_dwordx4 a[32:35], v105, s[4:7], s16 offen sc1
  v_mfma_f32_16x16x32_bf16 v[32:35], a[40:43], v[164:167], v[32:35]
  ds_read_b64_tr_b16 v[160:161], v123 offset:27648
  ds_read_b64_tr_b16 v[162:163], v123 offset:28160
  v_mfma_f32_16x16x32_bf16 v[80:83], a[44:47], v[164:167], v[80:83]
  buffer_load_dwordx4 a[36:39], v105, s[4:7], s16 offen offset:1024 sc1
  v_mfma_f32_16x16x32_bf16 v[36:39], a[40:43], v[168:171], v[36:39]
  ds_read_b64_tr_b16 v[164:165], v120 offset:28672
  ds_read_b64_tr_b16 v[166:167], v120 offset:29184
  v_mfma_f32_16x16x32_bf16 v[84:87], a[44:47], v[168:171], v[84:87]
  ds_read_b64_tr_b16 v[168:169], v121 offset:28672
  s_add_u32 s16, s16, 131072
  v_mfma_f32_16x16x32_bf16 v[40:43], a[40:43], v[172:175], v[40:43]
  ds_read_b64_tr_b16 v[170:171], v121 offset:29184
  v_mfma_f32_16x16x32_bf16 v[88:91], a[44:47], v[172:175], v[88:91]
  ds_read_b64_tr_b16 v[172:173], v122 offset:28672
  s_bitset0_b32 s16, 20
  v_mfma_f32_16x16x32_bf16 v[44:47], a[40:43], v[176:179], v[44:47]
  ds_read_b64_tr_b16 v[174:175], v122 offset:29184
  v_mfma_f32_16x16x32_bf16 v[92:95], a[44:47], v[176:179], v[92:95]
  s_waitcnt vmcnt(37) lgkmcnt(10)
  s_barrier
  v_mfma_f32_16x16x32_bf16 v[96:99], v[180:183], v[188:191], v[96:99]
  ds_read_b64_tr_b16 v[176:177], v123 offset:28672
  s_add_u32 m0, s38, 66560
  v_mfma_f32_16x16x32_bf16 v[100:103], v[188:191], v[184:187], v[100:103]
  buffer_load_dwordx4 v107, s[8:11], s17 offen lds
  v_mfma_f32_16x16x32_bf16 v[0:3], v[132:135], a[48:51], v[0:3]
  ds_read_b64_tr_b16 v[178:179], v123 offset:29184
  ds_read_b64_tr_b16 v[180:181], v124 offset:40960
  v_mfma_f32_16x16x32_bf16 v[48:51], v[132:135], a[52:55], v[48:51]
  ds_read_b64_tr_b16 v[182:183], v124 offset:41472
  buffer_load_dwordx4 v108, s[8:11], s17 offen offset:1024 lds
  v_mfma_f32_16x16x32_bf16 v[4:7], v[136:139], a[48:51], v[4:7]
  ds_read_b128 v[188:191], v125 offset:52224
  ds_read_b64_tr_b16 v[184:185], v124 offset:41984
  ds_read_b64_tr_b16 v[186:187], v124 offset:42496
  v_mfma_f32_16x16x32_bf16 v[52:55], v[136:139], a[52:55], v[52:55]
  buffer_load_dwordx4 v109, s[8:11], s17 offen offset:2048 lds
  v_mfma_f32_16x16x32_bf16 v[8:11], v[140:143], a[48:51], v[8:11]
  ds_read_b64_tr_b16 v[132:133], v120 offset:39936
  ds_read_b64_tr_b16 v[134:135], v120 offset:40448
  v_mfma_f32_16x16x32_bf16 v[56:59], v[140:143], a[52:55], v[56:59]
  ds_read_b64_tr_b16 v[136:137], v121 offset:39936
  s_add_u32 s17, s17, 196608
  v_mfma_f32_16x16x32_bf16 v[12:15], v[144:147], a[48:51], v[12:15]
  ds_read_b64_tr_b16 v[138:139], v121 offset:40448
  s_cmp_eq_u32 s17, s10
  v_mfma_f32_16x16x32_bf16 v[60:63], v[144:147], a[52:55], v[60:63]
  ds_read_b64_tr_b16 v[140:141], v122 offset:39936
  ds_read_b64_tr_b16 v[142:143], v122 offset:40448
  v_mfma_f32_16x16x32_bf16 v[16:19], v[148:151], a[48:51], v[16:19]
  ds_read_b64_tr_b16 v[144:145], v123 offset:39936
  s_cselect_b32 s17, 0, s17
  v_mfma_f32_16x16x32_bf16 v[64:67], v[148:151], a[52:55], v[64:67]
  ds_read_b64_tr_b16 v[146:147], v123 offset:40448
  ds_read_b64_tr_b16 v[148:149], v120 offset:40960
  v_mfma_f32_16x16x32_bf16 v[20:23], v[152:155], a[48:51], v[20:23]
  ds_read_b64_tr_b16 v[150:151], v120 offset:41472
  s_add_u32 m0, s39, 66560
  v_mfma_f32_16x16x32_bf16 v[68:71], v[152:155], a[52:55], v[68:71]
  ds_read_b64_tr_b16 v[152:153], v121 offset:40960
  ds_read_b64_tr_b16 v[154:155], v121 offset:41472
  s_waitcnt lgkmcnt(10)
  v_mfma_f32_16x16x32_bf16 v[24:27], v[156:159], a[48:51], v[24:27]
  buffer_load_dword v106, s[4:7], s16 offen sc1 lds
  v_mfma_f32_16x16x32_bf16 v[72:75], v[156:159], a[52:55], v[72:75]
  ds_read_b64_tr_b16 v[156:157], v122 offset:40960
  ds_read_b64_tr_b16 v[158:159], v122 offset:41472
  v_mfma_f32_16x16x32_bf16 v[28:31], v[160:163], a[48:51], v[28:31]
  buffer_load_dwordx4 a[40:43], v105, s[4:7], s16 offen sc1
  v_mfma_f32_16x16x32_bf16 v[76:79], v[160:163], a[52:55], v[76:79]
  buffer_load_dwordx4 a[44:47], v105, s[4:7], s16 offen offset:1024 sc1
  v_mfma_f32_16x16x32_bf16 v[32:35], a[48:51], v[164:167], v[32:35]
  ds_read_b64_tr_b16 v[160:161], v123 offset:40960
  ds_read_b64_tr_b16 v[162:163], v123 offset:41472
  v_mfma_f32_16x16x32_bf16 v[80:83], a[52:55], v[164:167], v[80:83]
  ds_read_b64_tr_b16 v[164:165], v120 offset:41984
  s_add_u32 s16, s16, 131072
  v_mfma_f32_16x16x32_bf16 v[36:39], a[48:51], v[168:171], v[36:39]
  ds_read_b64_tr_b16 v[166:167], v120 offset:42496
  v_mfma_f32_16x16x32_bf16 v[84:87], a[52:55], v[168:171], v[84:87]
  ds_read_b64_tr_b16 v[168:169], v121 offset:41984
  s_bitset0_b32 s16, 20
  v_mfma_f32_16x16x32_bf16 v[40:43], a[48:51], v[172:175], v[40:43]
  ds_read_b64_tr_b16 v[170:171], v121 offset:42496
  v_mfma_f32_16x16x32_bf16 v[88:91], a[52:55], v[172:175], v[88:91]
  s_mov_b32 s40, s20
  s_mov_b32 s41, s21
  s_mov_b32 s42, 0x200000
  s_mov_b32 s43, 0x20000
  v_min_u32 v200, 9, v104
  v_lshlrev_b32 v201, 16, v200
  v_add_u32 v201, 524288, v201
  v_lshlrev_b32 v202, 7, v200
  s_lshl2_add_u32 s33, s2, s3
  s_mul_i32 s32, s33, 448
  s_add_u32 s32, s32, 1572096
  v_add_u32 v202, s32, v202
  v_cmp_le_u32 vcc, 6, v104
  s_lshl_b32 s33, s33, 6
  s_nop 0
  v_cndmask_b32 v201, v201, v202, vcc
  buffer_load_dword v131, v201, s[40:43], s33 offen
  v_mfma_f32_16x16x32_bf16 v[44:47], a[48:51], v[176:179], v[44:47]
  ds_read_b64_tr_b16 v[172:173], v122 offset:41984
  ds_read_b64_tr_b16 v[174:175], v122 offset:42496
  v_mfma_f32_16x16x32_bf16 v[92:95], a[52:55], v[176:179], v[92:95]
  s_waitcnt vmcnt(35) lgkmcnt(10)
  s_barrier
  v_mfma_f32_16x16x32_bf16 v[96:99], v[180:183], v[188:191], v[96:99]
  ds_read_b64_tr_b16 v[176:177], v123 offset:41984
  s_add_u32 m0, s38, 79872
  v_mfma_f32_16x16x32_bf16 v[100:103], v[188:191], v[184:187], v[100:103]
  buffer_load_dwordx4 v107, s[8:11], s17 offen lds
  v_mfma_f32_16x16x32_bf16 v[0:3], v[132:135], a[56:59], v[0:3]
  ds_read_b64_tr_b16 v[178:179], v123 offset:42496
  ds_read_b64_tr_b16 v[180:181], v118 offset:1024
  v_mfma_f32_16x16x32_bf16 v[48:51], v[132:135], a[60:63], v[48:51]
  ds_read_b64_tr_b16 v[182:183], v118 offset:1536
  buffer_load_dwordx4 v108, s[8:11], s17 offen offset:1024 lds
  v_mfma_f32_16x16x32_bf16 v[4:7], v[136:139], a[56:59], v[4:7]
  ds_read_b128 v[188:191], v119 offset:12288
  ds_read_b64_tr_b16 v[184:185], v118 offset:2048
  ds_read_b64_tr_b16 v[186:187], v118 offset:2560
  v_mfma_f32_16x16x32_bf16 v[52:55], v[136:139], a[60:63], v[52:55]
  buffer_load_dwordx4 v109, s[8:11], s17 offen offset:2048 lds
  v_mfma_f32_16x16x32_bf16 v[8:11], v[140:143], a[56:59], v[8:11]
  ds_read_b64_tr_b16 v[132:133], v114 offset:0
  ds_read_b64_tr_b16 v[134:135], v114 offset:512
  v_mfma_f32_16x16x32_bf16 v[56:59], v[140:143], a[60:63], v[56:59]
  ds_read_b64_tr_b16 v[136:137], v115 offset:0
  s_add_u32 s17, s17, 196608
  v_mfma_f32_16x16x32_bf16 v[12:15], v[144:147], a[56:59], v[12:15]
  ds_read_b64_tr_b16 v[138:139], v115 offset:512
  ds_read_b64_tr_b16 v[140:141], v116 offset:0
  v_mfma_f32_16x16x32_bf16 v[60:63], v[144:147], a[60:63], v[60:63]
  ds_read_b64_tr_b16 v[142:143], v116 offset:512
  s_cmp_eq_u32 s17, s10
  v_mfma_f32_16x16x32_bf16 v[16:19], v[148:151], a[56:59], v[16:19]
  ds_read_b64_tr_b16 v[144:145], v117 offset:0
  ds_read_b64_tr_b16 v[146:147], v117 offset:512
  v_mfma_f32_16x16x32_bf16 v[64:67], v[148:151], a[60:63], v[64:67]
  ds_read_b64_tr_b16 v[148:149], v114 offset:1024
  s_cselect_b32 s17, 0, s17
  v_mfma_f32_16x16x32_bf16 v[20:23], v[152:155], a[56:59], v[20:23]
  ds_read_b64_tr_b16 v[150:151], v114 offset:1536
  v_mfma_f32_16x16x32_bf16 v[68:71], v[152:155], a[60:63], v[68:71]
  ds_read_b64_tr_b16 v[152:153], v115 offset:1024
  s_add_u32 m0, s39, 79872
  s_waitcnt lgkmcnt(10)
  v_mfma_f32_16x16x32_bf16 v[24:27], v[156:159], a[56:59], v[24:27]
  ds_read_b64_tr_b16 v[154:155], v115 offset:1536
  v_mfma_f32_16x16x32_bf16 v[72:75], v[156:159], a[60:63], v[72:75]
  buffer_load_dword v106, s[4:7], s16 offen sc1 lds
  v_mfma_f32_16x16x32_bf16 v[28:31], v[160:163], a[56:59], v[28:31]
  ds_read_b64_tr_b16 v[156:157], v116 offset:1024
  ds_read_b64_tr_b16 v[158:159], v116 offset:1536
  v_mfma_f32_16x16x32_bf16 v[76:79], v[160:163], a[60:63], v[76:79]
  buffer_load_dwordx4 a[48:51], v105, s[4:7], s16 offen sc1
  v_mfma_f32_16x16x32_bf16 v[32:35], a[56:59], v[164:167], v[32:35]
  ds_read_b64_tr_b16 v[160:161], v117 offset:1024
  ds_read_b64_tr_b16 v[162:163], v117 offset:1536
  v_mfma_f32_16x16x32_bf16 v[80:83], a[60:63], v[164:167], v[80:83]
  buffer_load_dwordx4 a[52:55], v105, s[4:7], s16 offen offset:1024 sc1
  v_mfma_f32_16x16x32_bf16 v[36:39], a[56:59], v[168:171], v[36:39]
  ds_read_b64_tr_b16 v[164:165], v114 offset:2048
  ds_read_b64_tr_b16 v[166:167], v114 offset:2560
  v_mfma_f32_16x16x32_bf16 v[84:87], a[60:63], v[168:171], v[84:87]
  ds_read_b64_tr_b16 v[168:169], v115 offset:2048
  s_add_u32 s16, s16, 131072
  v_mfma_f32_16x16x32_bf16 v[40:43], a[56:59], v[172:175], v[40:43]
  ds_read_b64_tr_b16 v[170:171], v115 offset:2560
  v_mfma_f32_16x16x32_bf16 v[88:91], a[60:63], v[172:175], v[88:91]
  ds_read_b64_tr_b16 v[172:173], v116 offset:2048
  s_bitset0_b32 s16, 20
  v_mfma_f32_16x16x32_bf16 v[44:47], a[56:59], v[176:179], v[44:47]
  ds_read_b64_tr_b16 v[174:175], v116 offset:2560
  v_mfma_f32_16x16x32_bf16 v[92:95], a[60:63], v[176:179], v[92:95]
  s_waitcnt vmcnt(35) lgkmcnt(10)
  s_barrier
  v_mfma_f32_16x16x32_bf16 v[96:99], v[180:183], v[188:191], v[96:99]
  ds_read_b64_tr_b16 v[176:177], v117 offset:2048
  s_add_u32 m0, s38, 93184
  v_mfma_f32_16x16x32_bf16 v[100:103], v[188:191], v[184:187], v[100:103]
  buffer_load_dwordx4 v107, s[8:11], s17 offen lds
  v_mfma_f32_16x16x32_bf16 v[0:3], v[132:135], a[0:3], v[0:3]
  ds_read_b64_tr_b16 v[178:179], v117 offset:2560
  buffer_load_dwordx4 v108, s[8:11], s17 offen offset:1024 lds
  v_mfma_f32_16x16x32_bf16 v[48:51], v[132:135], a[4:7], v[48:51]
  ds_read_b64_tr_b16 v[180:181], v118 offset:14336
  ds_read_b64_tr_b16 v[182:183], v118 offset:14848
  buffer_load_dwordx4 v109, s[8:11], s17 offen offset:2048 lds
  v_mfma_f32_16x16x32_bf16 v[4:7], v[136:139], a[0:3], v[4:7]
  ds_read_b128 v[188:191], v119 offset:25600
  ds_read_b64_tr_b16 v[184:185], v118 offset:15360
  ds_read_b64_tr_b16 v[186:187], v118 offset:15872
  s_add_u32 s17, s17, 196608
  v_mfma_f32_16x16x32_bf16 v[52:55], v[136:139], a[4:7], v[52:55]
  ds_read_b64_tr_b16 v[132:133], v114 offset:13312
  s_cmp_eq_u32 s17, s10
  v_mfma_f32_16x16x32_bf16 v[8:11], v[140:143], a[0:3], v[8:11]
  ds_read_b64_tr_b16 v[134:135], v114 offset:13824
  s_cselect_b32 s17, 0, s17
  v_mfma_f32_16x16x32_bf16 v[56:59], v[140:143], a[4:7], v[56:59]
  s_add_u32 s8, s8, s10
  s_addc_u32 s9, s9, 0
  v_mfma_f32_16x16x32_bf16 v[12:15], v[144:147], a[0:3], v[12:15]
  ds_read_b64_tr_b16 v[136:137], v115 offset:13312
  ds_read_b64_tr_b16 v[138:139], v115 offset:13824
  s_add_u32 m0, s39, 93184
  v_mfma_f32_16x16x32_bf16 v[60:63], v[144:147], a[4:7], v[60:63]
  buffer_load_dword v106, s[4:7], s16 offen sc1 lds
  v_mfma_f32_16x16x32_bf16 v[16:19], v[148:151], a[0:3], v[16:19]
  ds_read_b64_tr_b16 v[140:141], v116 offset:13312
  ds_read_b64_tr_b16 v[142:143], v116 offset:13824
  buffer_load_dwordx4 a[56:59], v105, s[4:7], s16 offen sc1
  v_mfma_f32_16x16x32_bf16 v[64:67], v[148:151], a[4:7], v[64:67]
  buffer_load_dwordx4 a[60:63], v105, s[4:7], s16 offen offset:1024 sc1
  v_mfma_f32_16x16x32_bf16 v[20:23], v[152:155], a[0:3], v[20:23]
  ds_read_b64_tr_b16 v[144:145], v117 offset:13312
  ds_read_b64_tr_b16 v[146:147], v117 offset:13824
  s_add_u32 s16, s16, 131072
  v_mfma_f32_16x16x32_bf16 v[68:71], v[152:155], a[4:7], v[68:71]
  ds_read_b64_tr_b16 v[148:149], v114 offset:14336
  s_bitset0_b32 s16, 20
  s_waitcnt lgkmcnt(10)
  v_mfma_f32_16x16x32_bf16 v[24:27], v[156:159], a[0:3], v[24:27]
  ds_read_b64_tr_b16 v[150:151], v114 offset:14848
  s_add_u32 s4, s4, s6
  s_addc_u32 s5, s5, 0
  v_mfma_f32_16x16x32_bf16 v[72:75], v[156:159], a[4:7], v[72:75]
  ds_read_b64_tr_b16 v[152:153], v115 offset:14336
  s_mov_b32 m0, s51
  v_mfma_f32_16x16x32_bf16 v[28:31], v[160:163], a[0:3], v[28:31]
  ds_read_b64_tr_b16 v[154:155], v115 offset:14848
  s_add_u32 s51, s51, 1024
  v_mfma_f32_16x16x32_bf16 v[76:79], v[160:163], a[4:7], v[76:79]
  buffer_load_dwordx4 v129, s[52:55], s50 offen nt lds
  v_mfma_f32_16x16x32_bf16 v[32:35], a[0:3], v[164:167], v[32:35]
  ds_read_b64_tr_b16 v[156:157], v116 offset:14336
  ds_read_b64_tr_b16 v[158:159], v116 offset:14848
  s_add_u32 s50, s50, 98304
  v_mfma_f32_16x16x32_bf16 v[80:83], a[4:7], v[164:167], v[80:83]
  ds_read_b64_tr_b16 v[160:161], v117 offset:14336
  s_mov_b32 m0, s51
  v_mfma_f32_16x16x32_bf16 v[36:39], a[0:3], v[168:171], v[36:39]
  ds_read_b64_tr_b16 v[162:163], v117 offset:14848
  s_add_u32 s51, s51, 1024
  v_mfma_f32_16x16x32_bf16 v[84:87], a[4:7], v[168:171], v[84:87]
  buffer_load_dwordx4 v129, s[52:55], s50 offen nt lds
  v_mfma_f32_16x16x32_bf16 v[40:43], a[0:3], v[172:175], v[40:43]
  ds_read_b64_tr_b16 v[164:165], v114 offset:15360
  ds_read_b64_tr_b16 v[166:167], v114 offset:15872
  s_add_u32 s50, s50, 98304
  v_mfma_f32_16x16x32_bf16 v[88:91], a[4:7], v[172:175], v[88:91]
  buffer_store_dwordx4 v[244:247], v119, s[92:95], s35 offen offset:3072 sc1
  v_mfma_f32_16x16x32_bf16 v[44:47], a[0:3], v[176:179], v[44:47]
  ds_read_b64_tr_b16 v[168:169], v115 offset:15360
  ds_read_b64_tr_b16 v[170:171], v115 offset:15872
  v_mfma_f32_16x16x32_bf16 v[92:95], a[4:7], v[176:179], v[92:95]
  s_waitcnt vmcnt(37) lgkmcnt(10)
  s_barrier
  v_mfma_f32_16x16x32_bf16 v[96:99], v[180:183], v[188:191], v[96:99]
  ds_read_b64_tr_b16 v[172:173], v116 offset:15360
  ds_read_b64_tr_b16 v[174:175], v116 offset:15872
  s_add_u32 m0, s38, 0
  v_mfma_f32_16x16x32_bf16 v[100:103], v[188:191], v[184:187], v[100:103]
  buffer_load_dwordx4 v107, s[8:11], s17 offen lds
  v_mfma_f32_16x16x32_bf16 v[0:3], v[132:135], a[8:11], v[0:3]
  ds_read_b64_tr_b16 v[176:177], v117 offset:15360
  ds_read_b64_tr_b16 v[178:179], v117 offset:15872
  v_mfma_f32_16x16x32_bf16 v[48:51], v[132:135], a[12:15], v[48:51]
  ds_read_b64_tr_b16 v[180:181], v118 offset:27648
  ds_read_b64_tr_b16 v[182:183], v118 offset:28160
  buffer_load_dwordx4 v108, s[8:11], s17 offen offset:1024 lds
  v_mfma_f32_16x16x32_bf16 v[4:7], v[136:139], a[8:11], v[4:7]
  ds_read_b128 v[188:191], v119 offset:38912
  ds_read_b64_tr_b16 v[184:185], v118 offset:28672
  ds_read_b64_tr_b16 v[186:187], v118 offset:29184
  v_mfma_f32_16x16x32_bf16 v[52:55], v[136:139], a[12:15], v[52:55]
  buffer_load_dwordx4 v109, s[8:11], s17 offen offset:2048 lds
  v_mfma_f32_16x16x32_bf16 v[8:11], v[140:143], a[8:11], v[8:11]
  ds_read_b64_tr_b16 v[132:133], v114 offset:26624
  ds_read_b64_tr_b16 v[134:135], v114 offset:27136
  v_mfma_f32_16x16x32_bf16 v[56:59], v[140:143], a[12:15], v[56:59]
  ds_read_b64_tr_b16 v[136:137], v115 offset:26624
  s_add_u32 s17, s17, 196608
  v_mfma_f32_16x16x32_bf16 v[12:15], v[144:147], a[8:11], v[12:15]
  ds_read_b64_tr_b16 v[138:139], v115 offset:27136
  ds_read_b64_tr_b16 v[140:141], v116 offset:26624
  v_mfma_f32_16x16x32_bf16 v[60:63], v[144:147], a[12:15], v[60:63]
  ds_read_b64_tr_b16 v[142:143], v116 offset:27136
  s_cmp_eq_u32 s17, s10
  v_mfma_f32_16x16x32_bf16 v[16:19], v[148:151], a[8:11], v[16:19]
  ds_read_b64_tr_b16 v[144:145], v117 offset:26624
  ds_read_b64_tr_b16 v[146:147], v117 offset:27136
  v_mfma_f32_16x16x32_bf16 v[64:67], v[148:151], a[12:15], v[64:67]
  ds_read_b64_tr_b16 v[148:149], v114 offset:27648
  s_cselect_b32 s17, 0, s17
  s_waitcnt lgkmcnt(10)
  v_mfma_f32_16x16x32_bf16 v[20:23], v[152:155], a[8:11], v[20:23]
  ds_read_b64_tr_b16 v[150:151], v114 offset:28160
  v_mfma_f32_16x16x32_bf16 v[68:71], v[152:155], a[12:15], v[68:71]
  ds_read_b64_tr_b16 v[152:153], v115 offset:27648
  s_add_u32 m0, s39, 0
  v_mfma_f32_16x16x32_bf16 v[24:27], v[156:159], a[8:11], v[24:27]
  ds_read_b64_tr_b16 v[154:155], v115 offset:28160
  v_mfma_f32_16x16x32_bf16 v[72:75], v[156:159], a[12:15], v[72:75]
  buffer_load_dword v106, s[4:7], s16 offen sc1 lds
  v_mfma_f32_16x16x32_bf16 v[28:31], v[160:163], a[8:11], v[28:31]
  ds_read_b64_tr_b16 v[156:157], v116 offset:27648
  ds_read_b64_tr_b16 v[158:159], v116 offset:28160
  v_mfma_f32_16x16x32_bf16 v[76:79], v[160:163], a[12:15], v[76:79]
  buffer_load_dwordx4 a[0:3], v105, s[4:7], s16 offen sc1
  v_mfma_f32_16x16x32_bf16 v[32:35], a[8:11], v[164:167], v[32:35]
  ds_read_b64_tr_b16 v[160:161], v117 offset:27648
  ds_read_b64_tr_b16 v[162:163], v117 offset:28160
  v_mfma_f32_16x16x32_bf16 v[80:83], a[12:15], v[164:167], v[80:83]
  buffer_load_dwordx4 a[4:7], v105, s[4:7], s16 offen offset:1024 sc1
  v_mfma_f32_16x16x32_bf16 v[36:39], a[8:11], v[168:171], v[36:39]
  ds_read_b64_tr_b16 v[164:165], v114 offset:28672
  ds_read_b64_tr_b16 v[166:167], v114 offset:29184
  v_mfma_f32_16x16x32_bf16 v[84:87], a[12:15], v[168:171], v[84:87]
  ds_read_b64_tr_b16 v[168:169], v115 offset:28672
  s_add_u32 s16, s16, 131072
  v_mfma_f32_16x16x32_bf16 v[40:43], a[8:11], v[172:175], v[40:43]
  ds_read_b64_tr_b16 v[170:171], v115 offset:29184
  v_mfma_f32_16x16x32_bf16 v[88:91], a[12:15], v[172:175], v[88:91]
  ds_read_b64_tr_b16 v[172:173], v116 offset:28672
  s_bitset0_b32 s16, 20
  v_mfma_f32_16x16x32_bf16 v[44:47], a[8:11], v[176:179], v[44:47]
  ds_read_b64_tr_b16 v[174:175], v116 offset:29184
  v_mfma_f32_16x16x32_bf16 v[92:95], a[12:15], v[176:179], v[92:95]
  s_waitcnt vmcnt(37) lgkmcnt(10)
  s_barrier
  v_mfma_f32_16x16x32_bf16 v[96:99], v[180:183], v[188:191], v[96:99]
  ds_read_b64_tr_b16 v[176:177], v117 offset:28672
  s_add_u32 m0, s38, 13312
  v_mfma_f32_16x16x32_bf16 v[100:103], v[188:191], v[184:187], v[100:103]
  buffer_load_dwordx4 v107, s[8:11], s17 offen lds
  v_mfma_f32_16x16x32_bf16 v[0:3], v[132:135], a[16:19], v[0:3]
  ds_read_b64_tr_b16 v[178:179], v117 offset:29184
  ds_read_b64_tr_b16 v[180:181], v118 offset:40960
  v_mfma_f32_16x16x32_bf16 v[48:51], v[132:135], a[20:23], v[48:51]
  ds_read_b64_tr_b16 v[182:183], v118 offset:41472
  buffer_load_dwordx4 v108, s[8:11], s17 offen offset:1024 lds
  v_mfma_f32_16x16x32_bf16 v[4:7], v[136:139], a[16:19], v[4:7]
  ds_read_b128 v[188:191], v119 offset:52224
  ds_read_b64_tr_b16 v[184:185], v118 offset:41984
  ds_read_b64_tr_b16 v[186:187], v118 offset:42496
  v_mfma_f32_16x16x32_bf16 v[52:55], v[136:139], a[20:23], v[52:55]
  buffer_load_dwordx4 v109, s[8:11], s17 offen offset:2048 lds
  v_mfma_f32_16x16x32_bf16 v[8:11], v[140:143], a[16:19], v[8:11]
  ds_read_b64_tr_b16 v[132:133], v114 offset:39936
  ds_read_b64_tr_b16 v[134:135], v114 offset:40448
  v_mfma_f32_16x16x32_bf16 v[56:59], v[140:143], a[20:23], v[56:59]
  ds_read_b64_tr_b16 v[136:137], v115 offset:39936
  s_add_u32 s17, s17, 196608
  v_mfma_f32_16x16x32_bf16 v[12:15], v[144:147], a[16:19], v[12:15]
  ds_read_b64_tr_b16 v[138:139], v115 offset:40448
  ds_read_b64_tr_b16 v[140:141], v116 offset:39936
  v_mfma_f32_16x16x32_bf16 v[60:63], v[144:147], a[20:23], v[60:63]
  ds_read_b64_tr_b16 v[142:143], v116 offset:40448
  s_cmp_eq_u32 s17, s10
  v_mfma_f32_16x16x32_bf16 v[16:19], v[148:151], a[16:19], v[16:19]
  ds_read_b64_tr_b16 v[144:145], v117 offset:39936
  ds_read_b64_tr_b16 v[146:147], v117 offset:40448
  v_mfma_f32_16x16x32_bf16 v[64:67], v[148:151], a[20:23], v[64:67]
  ds_read_b64_tr_b16 v[148:149], v114 offset:40960
  s_cselect_b32 s17, 0, s17
  v_mfma_f32_16x16x32_bf16 v[20:23], v[152:155], a[16:19], v[20:23]
  ds_read_b64_tr_b16 v[150:151], v114 offset:41472
  v_mfma_f32_16x16x32_bf16 v[68:71], v[152:155], a[20:23], v[68:71]
  ds_read_b64_tr_b16 v[152:153], v115 offset:40960
  s_add_u32 m0, s39, 13312
  s_waitcnt lgkmcnt(10)
  v_mfma_f32_16x16x32_bf16 v[24:27], v[156:159], a[16:19], v[24:27]
  ds_read_b64_tr_b16 v[154:155], v115 offset:41472
  v_mfma_f32_16x16x32_bf16 v[72:75], v[156:159], a[20:23], v[72:75]
  buffer_load_dword v106, s[4:7], s16 offen sc1 lds
  v_mfma_f32_16x16x32_bf16 v[28:31], v[160:163], a[16:19], v[28:31]
  ds_read_b64_tr_b16 v[156:157], v116 offset:40960
  ds_read_b64_tr_b16 v[158:159], v116 offset:41472
  v_mfma_f32_16x16x32_bf16 v[76:79], v[160:163], a[20:23], v[76:79]
  buffer_load_dwordx4 a[8:11], v105, s[4:7], s16 offen sc1
  v_mfma_f32_16x16x32_bf16 v[32:35], a[16:19], v[164:167], v[32:35]
  ds_read_b64_tr_b16 v[160:161], v117 offset:40960
  ds_read_b64_tr_b16 v[162:163], v117 offset:41472
  v_mfma_f32_16x16x32_bf16 v[80:83], a[20:23], v[164:167], v[80:83]
  buffer_load_dwordx4 a[12:15], v105, s[4:7], s16 offen offset:1024 sc1
  v_mfma_f32_16x16x32_bf16 v[36:39], a[16:19], v[168:171], v[36:39]
  ds_read_b64_tr_b16 v[164:165], v114 offset:41984
  ds_read_b64_tr_b16 v[166:167], v114 offset:42496
  v_mfma_f32_16x16x32_bf16 v[84:87], a[20:23], v[168:171], v[84:87]
  ds_read_b64_tr_b16 v[168:169], v115 offset:41984
  s_add_u32 s16, s16, 131072
  v_mfma_f32_16x16x32_bf16 v[40:43], a[16:19], v[172:175], v[40:43]
  ds_read_b64_tr_b16 v[170:171], v115 offset:42496
  v_mfma_f32_16x16x32_bf16 v[88:91], a[20:23], v[172:175], v[88:91]
  ds_read_b64_tr_b16 v[172:173], v116 offset:41984
  s_bitset0_b32 s16, 20
  v_mfma_f32_16x16x32_bf16 v[44:47], a[16:19], v[176:179], v[44:47]
  ds_read_b64_tr_b16 v[174:175], v116 offset:42496
  v_mfma_f32_16x16x32_bf16 v[92:95], a[20:23], v[176:179], v[92:95]
  s_waitcnt vmcnt(34) lgkmcnt(10)
  s_barrier
  v_mfma_f32_16x16x32_bf16 v[96:99], v[180:183], v[188:191], v[96:99]
  ds_read_b64_tr_b16 v[176:177], v117 offset:41984
  s_add_u32 m0, s38, 26624
  v_mfma_f32_16x16x32_bf16 v[100:103], v[188:191], v[184:187], v[100:103]
  buffer_load_dwordx4 v107, s[8:11], s17 offen lds
  v_mfma_f32_16x16x32_bf16 v[0:3], v[132:135], a[24:27], v[0:3]
  ds_read_b64_tr_b16 v[178:179], v117 offset:42496
  ds_read_b64_tr_b16 v[180:181], v124 offset:1024
  v_mfma_f32_16x16x32_bf16 v[48:51], v[132:135], a[28:31], v[48:51]
  ds_read_b64_tr_b16 v[182:183], v124 offset:1536
  buffer_load_dwordx4 v108, s[8:11], s17 offen offset:1024 lds
  v_mfma_f32_16x16x32_bf16 v[4:7], v[136:139], a[24:27], v[4:7]
  ds_read_b128 v[188:191], v125 offset:12288
  ds_read_b64_tr_b16 v[184:185], v124 offset:2048
  ds_read_b64_tr_b16 v[186:187], v124 offset:2560
  v_mfma_f32_16x16x32_bf16 v[52:55], v[136:139], a[28:31], v[52:55]
  buffer_load_dwordx4 v109, s[8:11], s17 offen offset:2048 lds
  v_mfma_f32_16x16x32_bf16 v[8:11], v[140:143], a[24:27], v[8:11]
  ds_read_b64_tr_b16 v[132:133], v120 offset:0
  ds_read_b64_tr_b16 v[134:135], v120 offset:512
  v_mfma_f32_16x16x32_bf16 v[56:59], v[140:143], a[28:31], v[56:59]
  ds_read_b64_tr_b16 v[136:137], v121 offset:0
  s_add_u32 s17, s17, 196608
  v_mfma_f32_16x16x32_bf16 v[12:15], v[144:147], a[24:27], v[12:15]
  ds_read_b64_tr_b16 v[138:139], v121 offset:512
  ds_read_b64_tr_b16 v[140:141], v122 offset:0
  v_mfma_f32_16x16x32_bf16 v[60:63], v[144:147], a[28:31], v[60:63]
  ds_read_b64_tr_b16 v[142:143], v122 offset:512
  s_cmp_eq_u32 s17, s10
  v_mfma_f32_16x16x32_bf16 v[16:19], v[148:151], a[24:27], v[16:19]
  ds_read_b64_tr_b16 v[144:145], v123 offset:0
  ds_read_b64_tr_b16 v[146:147], v123 offset:512
  v_mfma_f32_16x16x32_bf16 v[64:67], v[148:151], a[28:31], v[64:67]
  ds_read_b64_tr_b16 v[148:149], v120 offset:1024
  s_cselect_b32 s17, 0, s17
  v_mfma_f32_16x16x32_bf16 v[20:23], v[152:155], a[24:27], v[20:23]
  ds_read_b64_tr_b16 v[150:151], v120 offset:1536
  v_mfma_f32_16x16x32_bf16 v[68:71], v[152:155], a[28:31], v[68:71]
  ds_read_b64_tr_b16 v[152:153], v121 offset:1024
  s_add_u32 m0, s39, 26624
  s_waitcnt lgkmcnt(10)
  v_mfma_f32_16x16x32_bf16 v[24:27], v[156:159], a[24:27], v[24:27]
  ds_read_b64_tr_b16 v[154:155], v121 offset:1536
  v_mfma_f32_16x16x32_bf16 v[72:75], v[156:159], a[28:31], v[72:75]
  buffer_load_dword v106, s[4:7], s16 offen sc1 lds
  v_mfma_f32_16x16x32_bf16 v[28:31], v[160:163], a[24:27], v[28:31]
  ds_read_b64_tr_b16 v[156:157], v122 offset:1024
  ds_read_b64_tr_b16 v[158:159], v122 offset:1536
  v_mfma_f32_16x16x32_bf16 v[76:79], v[160:163], a[28:31], v[76:79]
  buffer_load_dwordx4 a[16:19], v105, s[4:7], s16 offen sc1
  v_mfma_f32_16x16x32_bf16 v[32:35], a[24:27], v[164:167], v[32:35]
  ds_read_b64_tr_b16 v[160:161], v123 offset:1024
  ds_read_b64_tr_b16 v[162:163], v123 offset:1536
  v_mfma_f32_16x16x32_bf16 v[80:83], a[28:31], v[164:167], v[80:83]
  buffer_load_dwordx4 a[20:23], v105, s[4:7], s16 offen offset:1024 sc1
  v_mfma_f32_16x16x32_bf16 v[36:39], a[24:27], v[168:171], v[36:39]
  ds_read_b64_tr_b16 v[164:165], v120 offset:2048
  ds_read_b64_tr_b16 v[166:167], v120 offset:2560
  v_mfma_f32_16x16x32_bf16 v[84:87], a[28:31], v[168:171], v[84:87]
  ds_read_b64_tr_b16 v[168:169], v121 offset:2048
  s_add_u32 s16, s16, 131072
  v_mfma_f32_16x16x32_bf16 v[40:43], a[24:27], v[172:175], v[40:43]
  ds_read_b64_tr_b16 v[170:171], v121 offset:2560
  v_mfma_f32_16x16x32_bf16 v[88:91], a[28:31], v[172:175], v[88:91]
  ds_read_b64_tr_b16 v[172:173], v122 offset:2048
  s_bitset0_b32 s16, 20
  v_mfma_f32_16x16x32_bf16 v[44:47], a[24:27], v[176:179], v[44:47]
  ds_read_b64_tr_b16 v[174:175], v122 offset:2560
  v_mfma_f32_16x16x32_bf16 v[92:95], a[28:31], v[176:179], v[92:95]
  s_waitcnt vmcnt(18) lgkmcnt(10)
  s_barrier
  v_mfma_f32_16x16x32_bf16 v[96:99], v[180:183], v[188:191], v[96:99]
  ds_read_b64_tr_b16 v[176:177], v123 offset:2048
  s_add_u32 m0, s38, 39936
  v_mfma_f32_16x16x32_bf16 v[100:103], v[188:191], v[184:187], v[100:103]
  ds_read_b64_tr_b16 a[64:65], v196 offset:0
  buffer_load_dwordx4 v107, s[8:11], s17 offen lds
  v_mfma_f32_16x16x32_bf16 v[0:3], v[132:135], a[32:35], v[0:3]
  ds_read_b64_tr_b16 v[178:179], v123 offset:2560
  buffer_load_dwordx4 v108, s[8:11], s17 offen offset:1024 lds
  v_mfma_f32_16x16x32_bf16 v[48:51], v[132:135], a[36:39], v[48:51]
  ds_read_b64_tr_b16 v[180:181], v124 offset:14336
  ds_read_b64_tr_b16 v[182:183], v124 offset:14848
  ds_read_b64_tr_b16 a[66:67], v196 offset:512
  v_mfma_f32_16x16x32_bf16 v[4:7], v[136:139], a[32:35], v[4:7]
  ds_read_b128 v[188:191], v125 offset:25600
  ds_read_b64_tr_b16 v[184:185], v124 offset:15360
  ds_read_b64_tr_b16 v[186:187], v124 offset:15872
  buffer_load_dwordx4 v109, s[8:11], s17 offen offset:2048 lds
  v_mfma_f32_16x16x32_bf16 v[52:55], v[136:139], a[36:39], v[52:55]
  ds_read_b128 a[68:71], v197 offset:0
  s_add_u32 s17, s17, 196608
  v_mfma_f32_16x16x32_bf16 v[8:11], v[140:143], a[32:35], v[8:11]
  ds_read_b64_tr_b16 v[132:133], v120 offset:13312
  ds_read_b64_tr_b16 v[134:135], v120 offset:13824
  s_cmp_eq_u32 s17, s10
  v_mfma_f32_16x16x32_bf16 v[56:59], v[140:143], a[36:39], v[56:59]
  ds_read_b64_tr_b16 v[136:137], v121 offset:13312
  ds_read_b64_tr_b16 a[72:73], v196 offset:4096
  v_mfma_f32_16x16x32_bf16 v[12:15], v[144:147], a[32:35], v[12:15]
  ds_read_b64_tr_b16 v[138:139], v121 offset:13824
  s_cselect_b32 s17, 0, s17
  v_mfma_f32_16x16x32_bf16 v[60:63], v[144:147], a[36:39], v[60:63]
  ds_read_b64_tr_b16 v[140:141], v122 offset:13312
  ds_read_b64_tr_b16 a[74:75], v196 offset:4608
  v_mfma_f32_16x16x32_bf16 v[16:19], v[148:151], a[32:35], v[16:19]
  ds_read_b64_tr_b16 v[142:143], v122 offset:13824
  s_add_u32 m0, s39, 39936
  v_mfma_f32_16x16x32_bf16 v[64:67], v[148:151], a[36:39], v[64:67]
  ds_read_b128 a[76:79], v197 offset:64
  buffer_load_dword v106, s[4:7], s16 offen sc1 lds
  v_mfma_f32_16x16x32_bf16 v[20:23], v[152:155], a[32:35], v[20:23]
  ds_read_b64_tr_b16 v[144:145], v123 offset:13312
  ds_read_b64_tr_b16 v[146:147], v123 offset:13824
  buffer_load_dwordx4 a[24:27], v105, s[4:7], s16 offen sc1
  v_mfma_f32_16x16x32_bf16 v[68:71], v[152:155], a[36:39], v[68:71]
  ds_read_b64_tr_b16 v[148:149], v120 offset:14336
  ds_read_b64_tr_b16 a[80:81], v196 offset:8192
  s_waitcnt lgkmcnt(10)
  v_mfma_f32_16x16x32_bf16 v[24:27], v[156:159], a[32:35], v[24:27]
  ds_read_b64_tr_b16 v[150:151], v120 offset:14848
  buffer_load_dwordx4 a[28:31], v105, s[4:7], s16 offen offset:1024 sc1
  v_mfma_f32_16x16x32_bf16 v[72:75], v[156:159], a[36:39], v[72:75]
  ds_read_b64_tr_b16 a[82:83], v196 offset:8704
  s_add_u32 s16, s16, 131072
  v_mfma_f32_16x16x32_bf16 v[28:31], v[160:163], a[32:35], v[28:31]
  ds_read_b64_tr_b16 v[152:153], v121 offset:14336
  ds_read_b64_tr_b16 v[154:155], v121 offset:14848
  s_bitset0_b32 s16, 20
  v_mfma_f32_16x16x32_bf16 v[76:79], v[160:163], a[36:39], v[76:79]
  ds_read_b64_tr_b16 v[156:157], v122 offset:14336
  ds_read_b128 a[84:87], v197 offset:128
  v_mfma_f32_16x16x32_bf16 v[32:35], a[32:35], v[164:167], v[32:35]
  ds_read_b64_tr_b16 v[158:159], v122 offset:14848
  s_mov_b32 s52, s24
  v_mfma_f32_16x16x32_bf16 v[80:83], a[36:39], v[164:167], v[80:83]
  ds_read_b64_tr_b16 a[88:89], v196 offset:12288
  s_mov_b32 s53, s25
  v_mfma_f32_16x16x32_bf16 v[36:39], a[32:35], v[168:171], v[36:39]
  ds_read_b64_tr_b16 v[160:161], v123 offset:14336
  ds_read_b64_tr_b16 v[162:163], v123 offset:14848
  s_mov_b32 s54, 0x200000
  v_mfma_f32_16x16x32_bf16 v[84:87], a[36:39], v[168:171], v[84:87]
  ds_read_b64_tr_b16 v[164:165], v120 offset:15360
  ds_read_b64_tr_b16 a[90:91], v196 offset:12800
  v_mfma_f32_16x16x32_bf16 v[40:43], a[32:35], v[172:175], v[40:43]
  ds_read_b64_tr_b16 v[166:167], v120 offset:15872
  s_mov_b32 s55, 0x20000
  v_mfma_f32_16x16x32_bf16 v[88:91], a[36:39], v[172:175], v[88:91]
  ds_read_b64_tr_b16 v[168:169], v121 offset:15360
  ds_read_b128 a[92:95], v197 offset:192
  v_mfma_f32_16x16x32_bf16 v[44:47], a[32:35], v[176:179], v[44:47]
  ds_read_b64_tr_b16 v[170:171], v121 offset:15872
  s_lshl_b32 s51, s3, 11
  v_mfma_f32_16x16x32_bf16 v[92:95], a[36:39], v[176:179], v[92:95]
  s_waitcnt vmcnt(33) lgkmcnt(10)
  s_barrier
  v_mfma_f32_16x16x32_bf16 v[96:99], v[180:183], v[188:191], v[96:99]
  ds_read_b64_tr_b16 v[172:173], v122 offset:15360
  ds_read_b64_tr_b16 v[174:175], v122 offset:15872
  s_add_u32 m0, s38, 53248
  v_mfma_f32_16x16x32_bf16 v[100:103], v[188:191], v[184:187], v[100:103]
  ds_read_b64_tr_b16 a[96:97], v196 offset:16384
  buffer_load_dwordx4 v107, s[8:11], s17 offen lds
  v_mfma_f32_16x16x32_bf16 v[0:3], v[132:135], a[40:43], v[0:3]
  ds_read_b64_tr_b16 v[176:177], v123 offset:15360
  ds_read_b64_tr_b16 v[178:179], v123 offset:15872
  v_mfma_f32_16x16x32_bf16 v[192:195], a[64:67], a[68:71], 0
  v_mfma_f32_16x16x32_bf16 v[48:51], v[132:135], a[44:47], v[48:51]
  ds_read_b64_tr_b16 v[180:181], v124 offset:27648
  ds_read_b64_tr_b16 v[182:183], v124 offset:28160
  ds_read_b64_tr_b16 a[98:99], v196 offset:16896
  v_mfma_f32_16x16x32_bf16 v[4:7], v[136:139], a[40:43], v[4:7]
  ds_read_b128 v[188:191], v125 offset:38912
  ds_read_b64_tr_b16 v[184:185], v124 offset:28672
  ds_read_b64_tr_b16 v[186:187], v124 offset:29184
  buffer_load_dwordx4 v108, s[8:11], s17 offen offset:1024 lds
  v_mfma_f32_16x16x32_bf16 v[52:55], v[136:139], a[44:47], v[52:55]
  ds_read_b64_tr_b16 v[132:133], v120 offset:26624
  ds_read_b128 a[100:103], v197 offset:256
  v_mfma_f32_16x16x32_bf16 v[8:11], v[140:143], a[40:43], v[8:11]
  ds_read_b64_tr_b16 v[134:135], v120 offset:27136
  buffer_load_dwordx4 v109, s[8:11], s17 offen offset:2048 lds
  v_mfma_f32_16x16x32_bf16 v[56:59], v[140:143], a[44:47], v[56:59]
  ds_read_b64_tr_b16 a[104:105], v196 offset:20480
  s_add_u32 s17, s17, 196608
  v_mfma_f32_16x16x32_bf16 v[12:15], v[144:147], a[40:43], v[12:15]
  ds_read_b64_tr_b16 v[136:137], v121 offset:26624
  ds_read_b64_tr_b16 v[138:139], v121 offset:27136
  v_mfma_f32_16x16x32_bf16 v[192:195], a[72:75], a[76:79], v[192:195]
  v_mfma_f32_16x16x32_bf16 v[60:63], v[144:147], a[44:47], v[60:63]
  ds_read_b64_tr_b16 v[140:141], v122 offset:26624
  ds_read_b64_tr_b16 a[106:107], v196 offset:20992
  v_mfma_f32_16x16x32_bf16 v[16:19], v[148:151], a[40:43], v[16:19]
  ds_read_b64_tr_b16 v[142:143], v122 offset:27136
  s_cmp_eq_u32 s17, s10
  v_mfma_f32_16x16x32_bf16 v[64:67], v[148:151], a[44:47], v[64:67]
  ds_read_b64_tr_b16 v[144:145], v123 offset:26624
  ds_read_b128 a[108:111], v197 offset:320
  v_mfma_f32_16x16x32_bf16 v[20:23], v[152:155], a[40:43], v[20:23]
  ds_read_b64_tr_b16 v[146:147], v123 offset:27136
  s_cselect_b32 s17, 0, s17
  v_mfma_f32_16x16x32_bf16 v[68:71], v[152:155], a[44:47], v[68:71]
  ds_read_b64_tr_b16 a[112:113], v196 offset:24576
  s_add_u32 m0, s39, 53248
  s_waitcnt lgkmcnt(10)
  v_mfma_f32_16x16x32_bf16 v[24:27], v[156:159], a[40:43], v[24:27]
  ds_read_b64_tr_b16 v[148:149], v120 offset:27648
  ds_read_b64_tr_b16 v[150:151], v120 offset:28160
  v_mfma_f32_16x16x32_bf16 v[192:195], a[80:83], a[84:87], v[192:195]
  v_mfma_f32_16x16x32_bf16 v[72:75], v[156:159], a[44:47], v[72:75]
  ds_read_b64_tr_b16 v[152:153], v121 offset:27648
  ds_read_b64_tr_b16 a[114:115], v196 offset:25088
  v_mfma_f32_16x16x32_bf16 v[28:31], v[160:163], a[40:43], v[28:31]
  ds_read_b64_tr_b16 v[154:155], v121 offset:28160
  buffer_load_dword v106, s[4:7], s16 offen sc1 lds
  v_mfma_f32_16x16x32_bf16 v[76:79], v[160:163], a[44:47], v[76:79]
  ds_read_b64_tr_b16 v[156:157], v122 offset:27648
  ds_read_b128 a[116:119], v197 offset:384
  v_mfma_f32_16x16x32_bf16 v[32:35], a[40:43], v[164:167], v[32:35]
  ds_read_b64_tr_b16 v[158:159], v122 offset:28160
  buffer_load_dwordx4 a[32:35], v105, s[4:7], s16 offen sc1
  v_mfma_f32_16x16x32_bf16 v[80:83], a[44:47], v[164:167], v[80:83]
  ds_read_b64_tr_b16 a[120:121], v196 offset:28672
  buffer_load_dwordx4 a[36:39], v105, s[4:7], s16 offen offset:1024 sc1
  v_mfma_f32_16x16x32_bf16 v[36:39], a[40:43], v[168:171], v[36:39]
  ds_read_b64_tr_b16 v[160:161], v123 offset:27648
  ds_read_b64_tr_b16 v[162:163], v123 offset:28160
  v_mfma_f32_16x16x32_bf16 v[192:195], a[88:91], a[92:95], v[192:195]
  v_mfma_f32_16x16x32_bf16 v[84:87], a[44:47], v[168:171], v[84:87]
  ds_read_b64_tr_b16 v[164:165], v120 offset:28672
  ds_read_b64_tr_b16 a[122:123], v196 offset:29184
  v_mfma_f32_16x16x32_bf16 v[40:43], a[40:43], v[172:175], v[40:43]
  ds_read_b64_tr_b16 v[166:167], v120 offset:29184
  s_add_u32 s16, s16, 131072
  v_mfma_f32_16x16x32_bf16 v[88:91], a[44:47], v[172:175], v[88:91]
  ds_read_b64_tr_b16 v[168:169], v121 offset:28672
  ds_read_b128 a[124:127], v197 offset:448
  v_mfma_f32_16x16x32_bf16 v[44:47], a[40:43], v[176:179], v[44:47]
  ds_read_b64_tr_b16 v[170:171], v121 offset:29184
  s_bitset0_b32 s16, 20
  v_mfma_f32_16x16x32_bf16 v[92:95], a[44:47], v[176:179], v[92:95]
  s_waitcnt vmcnt(33) lgkmcnt(10)
  s_barrier
  v_mfma_f32_16x16x32_bf16 v[96:99], v[180:183], v[188:191], v[96:99]
  ds_read_b64_tr_b16 v[172:173], v122 offset:28672
  ds_read_b64_tr_b16 v[174:175], v122 offset:29184
  s_add_u32 m0, s38, 66560
  v_mfma_f32_16x16x32_bf16 v[100:103], v[188:191], v[184:187], v[100:103]
  buffer_load_dwordx4 v107, s[8:11], s17 offen lds
  v_mfma_f32_16x16x32_bf16 v[0:3], v[132:135], a[48:51], v[0:3]
  ds_read_b64_tr_b16 v[176:177], v123 offset:28672
  ds_read_b64_tr_b16 v[178:179], v123 offset:29184
  v_mfma_f32_16x16x32_bf16 v[192:195], a[96:99], a[100:103], v[192:195]
  v_mfma_f32_16x16x32_bf16 v[48:51], v[132:135], a[52:55], v[48:51]
  ds_read_b64_tr_b16 v[180:181], v124 offset:40960
  ds_read_b64_tr_b16 v[182:183], v124 offset:41472
  buffer_load_dwordx4 v108, s[8:11], s17 offen offset:1024 lds
  v_mfma_f32_16x16x32_bf16 v[4:7], v[136:139], a[48:51], v[4:7]
  ds_read_b128 v[188:191], v125 offset:52224
  ds_read_b64_tr_b16 v[184:185], v124 offset:41984
  ds_read_b64_tr_b16 v[186:187], v124 offset:42496
  v_mfma_f32_16x16x32_bf16 v[52:55], v[136:139], a[52:55], v[52:55]
  buffer_load_dwordx4 v109, s[8:11], s17 offen offset:2048 lds
  v_mfma_f32_16x16x32_bf16 v[8:11], v[140:143], a[48:51], v[8:11]
  ds_read_b64_tr_b16 v[132:133], v120 offset:39936
  ds_read_b64_tr_b16 v[134:135], v120 offset:40448
  v_mfma_f32_16x16x32_bf16 v[56:59], v[140:143], a[52:55], v[56:59]
  ds_read_b64_tr_b16 v[136:137], v121 offset:39936
  s_add_u32 s17, s17, 196608
  v_mfma_f32_16x16x32_bf16 v[12:15], v[144:147], a[48:51], v[12:15]
  ds_read_b64_tr_b16 v[138:139], v121 offset:40448
  v_mfma_f32_16x16x32_bf16 v[192:195], a[104:107], a[108:111], v[192:195]
  v_mfma_f32_16x16x32_bf16 v[60:63], v[144:147], a[52:55], v[60:63]
  ds_read_b64_tr_b16 v[140:141], v122 offset:39936
  s_cmp_eq_u32 s17, s10
  v_mfma_f32_16x16x32_bf16 v[16:19], v[148:151], a[48:51], v[16:19]
  ds_read_b64_tr_b16 v[142:143], v122 offset:40448
  ds_read_b64_tr_b16 v[144:145], v123 offset:39936
  v_mfma_f32_16x16x32_bf16 v[64:67], v[148:151], a[52:55], v[64:67]
  ds_read_b64_tr_b16 v[146:147], v123 offset:40448
  s_cselect_b32 s17, 0, s17
  v_mfma_f32_16x16x32_bf16 v[20:23], v[152:155], a[48:51], v[20:23]
  ds_read_b64_tr_b16 v[148:149], v120 offset:40960
  ds_read_b64_tr_b16 v[150:151], v120 offset:41472
  v_mfma_f32_16x16x32_bf16 v[68:71], v[152:155], a[52:55], v[68:71]
  ds_read_b64_tr_b16 v[152:153], v121 offset:40960
  s_add_u32 m0, s39, 66560
  s_waitcnt lgkmcnt(10)
  v_mfma_f32_16x16x32_bf16 v[24:27], v[156:159], a[48:51], v[24:27]
  v_mfma_f32_16x16x32_bf16 v[192:195], a[112:115], a[116:119], v[192:195]
  v_mfma_f32_16x16x32_bf16 v[72:75], v[156:159], a[52:55], v[72:75]
  buffer_load_dword v106, s[4:7], s16 offen sc1 lds
  v_mfma_f32_16x16x32_bf16 v[28:31], v[160:163], a[48:51], v[28:31]
  ds_read_b64_tr_b16 v[154:155], v121 offset:41472
  ds_read_b64_tr_b16 v[156:157], v122 offset:40960
  v_mfma_f32_16x16x32_bf16 v[76:79], v[160:163], a[52:55], v[76:79]
  buffer_load_dwordx4 a[40:43], v105, s[4:7], s16 offen sc1
  v_mfma_f32_16x16x32_bf16 v[32:35], a[48:51], v[164:167], v[32:35]
  ds_read_b64_tr_b16 v[158:159], v122 offset:41472
  ds_read_b64_tr_b16 v[160:161], v123 offset:40960
  v_mfma_f32_16x16x32_bf16 v[80:83], a[52:55], v[164:167], v[80:83]
  buffer_load_dwordx4 a[44:47], v105, s[4:7], s16 offen offset:1024 sc1
  v_mfma_f32_16x16x32_bf16 v[36:39], a[48:51], v[168:171], v[36:39]
  ds_read_b64_tr_b16 v[162:163], v123 offset:41472
  v_mfma_f32_16x16x32_bf16 v[192:195], a[120:123], a[124:127], v[192:195]
  v_mfma_f32_16x16x32_bf16 v[84:87], a[52:55], v[168:171], v[84:87]
  ds_read_b64_tr_b16 v[164:165], v120 offset:41984
  s_add_u32 s16, s16, 131072
  v_mfma_f32_16x16x32_bf16 v[40:43], a[48:51], v[172:175], v[40:43]
  ds_read_b64_tr_b16 v[166:167], v120 offset:42496
  ds_read_b64_tr_b16 v[168:169], v121 offset:41984
  v_mfma_f32_16x16x32_bf16 v[88:91], a[52:55], v[172:175], v[88:91]
  ds_read_b64_tr_b16 v[170:171], v121 offset:42496
  s_bitset0_b32 s16, 20
  v_mfma_f32_16x16x32_bf16 v[44:47], a[48:51], v[176:179], v[44:47]
  ds_read_b64_tr_b16 v[172:173], v122 offset:41984
  ds_read_b64_tr_b16 v[174:175], v122 offset:42496
  v_mfma_f32_16x16x32_bf16 v[92:95], a[52:55], v[176:179], v[92:95]
  s_waitcnt vmcnt(30) lgkmcnt(10)
  s_barrier
  v_mfma_f32_16x16x32_bf16 v[96:99], v[180:183], v[188:191], v[96:99]
  ds_read_b64_tr_b16 v[176:177], v123 offset:41984
  s_add_u32 m0, s38, 79872
  v_mfma_f32_16x16x32_bf16 v[100:103], v[188:191], v[184:187], v[100:103]
  buffer_load_dwordx4 v107, s[8:11], s17 offen lds
  v_mfma_f32_16x16x32_bf16 v[0:3], v[132:135], a[56:59], v[0:3]
  ds_read_b64_tr_b16 v[178:179], v123 offset:42496
  buffer_load_dwordx4 v108, s[8:11], s17 offen offset:1024 lds
  v_mfma_f32_16x16x32_bf16 v[48:51], v[132:135], a[60:63], v[48:51]
  ds_read_b64_tr_b16 v[180:181], v118 offset:1024
  ds_read_b64_tr_b16 v[182:183], v118 offset:1536
  buffer_load_dwordx4 v109, s[8:11], s17 offen offset:2048 lds
  v_mfma_f32_16x16x32_bf16 v[4:7], v[136:139], a[56:59], v[4:7]
  ds_read_b128 v[188:191], v119 offset:12288
  ds_read_b64_tr_b16 v[184:185], v118 offset:2048
  ds_read_b64_tr_b16 v[186:187], v118 offset:2560
  s_add_u32 s17, s17, 196608
  v_mfma_f32_16x16x32_bf16 v[52:55], v[136:139], a[60:63], v[52:55]
  s_bfe_u32 s40, s19, 0x80000
  s_bfe_u32 s41, s19, 0x80008
  s_bfe_u32 s42, s19, 0x80010
  s_bfe_u32 s43, s19, 0x80018
  v_and_or_b32 v192, v192, v198, s40
  v_and_or_b32 v193, v193, v198, s41
  v_and_or_b32 v194, v194, v198, s42
  v_and_or_b32 v195, v195, v198, s43
  buffer_store_dwordx4 v[192:195], v255, s[12:15], s96 offen sc1
  s_cmp_eq_u32 s17, s10
  s_cselect_b32 s17, 0, s17
  v_mfma_f32_16x16x32_bf16 v[8:11], v[140:143], a[56:59], v[8:11]
  ds_read_b64_tr_b16 v[132:133], v114 offset:0
  ds_read_b64_tr_b16 v[134:135], v114 offset:512
  s_add_u32 m0, s39, 79872
  v_mfma_f32_16x16x32_bf16 v[56:59], v[140:143], a[60:63], v[56:59]
  buffer_load_dword v106, s[4:7], s16 offen sc1 lds
  v_mfma_f32_16x16x32_bf16 v[12:15], v[144:147], a[56:59], v[12:15]
  ds_read_b64_tr_b16 v[136:137], v115 offset:0
  ds_read_b64_tr_b16 v[138:139], v115 offset:512
  buffer_load_dwordx4 a[48:51], v105, s[4:7], s16 offen sc1
  v_mfma_f32_16x16x32_bf16 v[60:63], v[144:147], a[60:63], v[60:63]
  buffer_load_dwordx4 a[52:55], v105, s[4:7], s16 offen offset:1024 sc1
  v_mfma_f32_16x16x32_bf16 v[16:19], v[148:151], a[56:59], v[16:19]
  ds_read_b64_tr_b16 v[140:141], v116 offset:0
  ds_read_b64_tr_b16 v[142:143], v116 offset:512
  s_add_u32 s16, s16, 131072
  v_mfma_f32_16x16x32_bf16 v[64:67], v[148:151], a[60:63], v[64:67]
  ds_read_b64_tr_b16 v[144:145], v117 offset:0
  s_bitset0_b32 s16, 20
  v_mfma_f32_16x16x32_bf16 v[20:23], v[152:155], a[56:59], v[20:23]
  ds_read_b64_tr_b16 v[146:147], v117 offset:512
  s_add_u32 m0, s51, 106496
  v_mfma_f32_16x16x32_bf16 v[68:71], v[152:155], a[60:63], v[68:71]
  ds_read_b64_tr_b16 v[148:149], v114 offset:1024
  s_mov_b32 s50, 1966080
  s_waitcnt lgkmcnt(10)
  v_mfma_f32_16x16x32_bf16 v[24:27], v[156:159], a[56:59], v[24:27]
  ds_read_b64_tr_b16 v[150:151], v114 offset:1536
  buffer_load_dwordx4 v248, s[52:55], s50 offen lds
  v_mfma_f32_16x16x32_bf16 v[72:75], v[156:159], a[60:63], v[72:75]
  buffer_load_dwordx4 v249, s[52:55], s50 offen offset:1024 lds
  v_mfma_f32_16x16x32_bf16 v[28:31], v[160:163], a[56:59], v[28:31]
  ds_read_b64_tr_b16 v[152:153], v115 offset:1024
  ds_read_b64_tr_b16 v[154:155], v115 offset:1536
  s_add_u32 m0, s51, 114688
  v_mfma_f32_16x16x32_bf16 v[76:79], v[160:163], a[60:63], v[76:79]
  ds_read_b64_tr_b16 v[156:157], v116 offset:1024
  s_mov_b32 s50, 393216
  v_mfma_f32_16x16x32_bf16 v[32:35], a[56:59], v[164:167], v[32:35]
  ds_read_b64_tr_b16 v[158:159], v116 offset:1536
  buffer_load_dwordx4 v248, s[52:55], s50 offen lds
  v_mfma_f32_16x16x32_bf16 v[80:83], a[60:63], v[164:167], v[80:83]
  buffer_load_dwordx4 v249, s[52:55], s50 offen offset:1024 lds
  v_mfma_f32_16x16x32_bf16 v[36:39], a[56:59], v[168:171], v[36:39]
  ds_read_b64_tr_b16 v[160:161], v117 offset:1024
  ds_read_b64_tr_b16 v[162:163], v117 offset:1536
  s_add_u32 m0, s51, 122880
  v_mfma_f32_16x16x32_bf16 v[84:87], a[60:63], v[168:171], v[84:87]
  ds_read_b64_tr_b16 v[164:165], v114 offset:2048
  s_mov_b32 s50, 1441792
  v_mfma_f32_16x16x32_bf16 v[40:43], a[56:59], v[172:175], v[40:43]
  ds_read_b64_tr_b16 v[166:167], v114 offset:2560
  buffer_load_dwordx4 v248, s[52:55], s50 offen lds
  v_mfma_f32_16x16x32_bf16 v[88:91], a[60:63], v[172:175], v[88:91]
  buffer_load_dwordx4 v249, s[52:55], s50 offen offset:1024 lds
  v_mfma_f32_16x16x32_bf16 v[44:47], a[56:59], v[176:179], v[44:47]
  ds_read_b64_tr_b16 v[168:169], v115 offset:2048
  ds_read_b64_tr_b16 v[170:171], v115 offset:2560
  v_mfma_f32_16x16x32_bf16 v[92:95], a[60:63], v[176:179], v[92:95]
  s_waitcnt vmcnt(37) lgkmcnt(10)
  s_barrier
  v_mfma_f32_16x16x32_bf16 v[96:99], v[180:183], v[188:191], v[96:99]
  ds_read_b64_tr_b16 v[172:173], v116 offset:2048
  ds_read_b64_tr_b16 v[174:175], v116 offset:2560
  s_add_u32 m0, s38, 93184
  v_mfma_f32_16x16x32_bf16 v[100:103], v[188:191], v[184:187], v[100:103]
  buffer_load_dwordx4 v107, s[8:11], s17 offen lds
  v_mfma_f32_16x16x32_bf16 v[0:3], v[132:135], a[0:3], v[0:3]
  ds_read_b64_tr_b16 v[176:177], v117 offset:2048
  ds_read_b64_tr_b16 v[178:179], v117 offset:2560
  v_mfma_f32_16x16x32_bf16 v[48:51], v[132:135], a[4:7], v[48:51]
  ds_read_b64_tr_b16 v[180:181], v118 offset:14336
  ds_read_b64_tr_b16 v[182:183], v118 offset:14848
  buffer_load_dwordx4 v108, s[8:11], s17 offen offset:1024 lds
  v_mfma_f32_16x16x32_bf16 v[4:7], v[136:139], a[0:3], v[4:7]
  ds_read_b128 v[188:191], v119 offset:25600
  ds_read_b64_tr_b16 v[184:185], v118 offset:15360
  ds_read_b64_tr_b16 v[186:187], v118 offset:15872
  v_mfma_f32_16x16x32_bf16 v[52:55], v[136:139], a[4:7], v[52:55]
  buffer_load_dwordx4 v109, s[8:11], s17 offen offset:2048 lds
  v_mfma_f32_16x16x32_bf16 v[8:11], v[140:143], a[0:3], v[8:11]
  ds_read_b64_tr_b16 v[132:133], v114 offset:13312
  ds_read_b64_tr_b16 v[134:135], v114 offset:13824
  v_mfma_f32_16x16x32_bf16 v[56:59], v[140:143], a[4:7], v[56:59]
  ds_read_b64_tr_b16 v[136:137], v115 offset:13312
  s_add_u32 s17, s17, 196608
  v_mfma_f32_16x16x32_bf16 v[12:15], v[144:147], a[0:3], v[12:15]
  ds_read_b64_tr_b16 v[138:139], v115 offset:13824
  ds_read_b64_tr_b16 v[140:141], v116 offset:13312
  v_mfma_f32_16x16x32_bf16 v[60:63], v[144:147], a[4:7], v[60:63]
  ds_read_b64_tr_b16 v[142:143], v116 offset:13824
  s_cmp_eq_u32 s17, s10
  v_mfma_f32_16x16x32_bf16 v[16:19], v[148:151], a[0:3], v[16:19]
  ds_read_b64_tr_b16 v[144:145], v117 offset:13312
  ds_read_b64_tr_b16 v[146:147], v117 offset:13824
  v_mfma_f32_16x16x32_bf16 v[64:67], v[148:151], a[4:7], v[64:67]
  ds_read_b64_tr_b16 v[148:149], v114 offset:14336
  s_cselect_b32 s17, 0, s17
  s_waitcnt lgkmcnt(10)
  v_mfma_f32_16x16x32_bf16 v[20:23], v[152:155], a[0:3], v[20:23]
  ds_read_b64_tr_b16 v[150:151], v114 offset:14848
  v_mfma_f32_16x16x32_bf16 v[68:71], v[152:155], a[4:7], v[68:71]
  ds_read_b64_tr_b16 v[152:153], v115 offset:14336
  s_add_u32 m0, s39, 93184
  v_mfma_f32_16x16x32_bf16 v[24:27], v[156:159], a[0:3], v[24:27]
  ds_read_b64_tr_b16 v[154:155], v115 offset:14848
  v_mfma_f32_16x16x32_bf16 v[72:75], v[156:159], a[4:7], v[72:75]
  buffer_load_dword v106, s[4:7], s16 offen sc1 lds
  v_mfma_f32_16x16x32_bf16 v[28:31], v[160:163], a[0:3], v[28:31]
  ds_read_b64_tr_b16 v[156:157], v116 offset:14336
  ds_read_b64_tr_b16 v[158:159], v116 offset:14848
  v_mfma_f32_16x16x32_bf16 v[76:79], v[160:163], a[4:7], v[76:79]
  buffer_load_dwordx4 a[56:59], v105, s[4:7], s16 offen sc1
  v_mfma_f32_16x16x32_bf16 v[32:35], a[0:3], v[164:167], v[32:35]
  ds_read_b64_tr_b16 v[160:161], v117 offset:14336
  ds_read_b64_tr_b16 v[162:163], v117 offset:14848
  v_mfma_f32_16x16x32_bf16 v[80:83], a[4:7], v[164:167], v[80:83]
  buffer_load_dwordx4 a[60:63], v105, s[4:7], s16 offen offset:1024 sc1
  v_mfma_f32_16x16x32_bf16 v[36:39], a[0:3], v[168:171], v[36:39]
  ds_read_b64_tr_b16 v[164:165], v114 offset:15360
  ds_read_b64_tr_b16 v[166:167], v114 offset:15872
  v_mfma_f32_16x16x32_bf16 v[84:87], a[4:7], v[168:171], v[84:87]
  ds_read_b64_tr_b16 v[168:169], v115 offset:15360
  s_add_u32 s16, s16, 131072
  v_mfma_f32_16x16x32_bf16 v[40:43], a[0:3], v[172:175], v[40:43]
  ds_read_b64_tr_b16 v[170:171], v115 offset:15872
  v_mfma_f32_16x16x32_bf16 v[88:91], a[4:7], v[172:175], v[88:91]
  ds_read_b64_tr_b16 v[172:173], v116 offset:15360
  s_bitset0_b32 s16, 20
  v_mfma_f32_16x16x32_bf16 v[44:47], a[0:3], v[176:179], v[44:47]
  ds_read_b64_tr_b16 v[174:175], v116 offset:15872
  v_mfma_f32_16x16x32_bf16 v[92:95], a[4:7], v[176:179], v[92:95]
  s_waitcnt vmcnt(37) lgkmcnt(10)
  s_barrier
  v_mfma_f32_16x16x32_bf16 v[96:99], v[180:183], v[188:191], v[96:99]
  ds_read_b64_tr_b16 v[176:177], v117 offset:15360
  s_add_u32 m0, s51, 0
  v_mfma_f32_16x16x32_bf16 v[100:103], v[188:191], v[184:187], v[100:103]
  ds_read_b64_tr_b16 v[178:179], v117 offset:15872
  ds_read_b64_tr_b16 v[180:181], v118 offset:27648
  v_mfma_f32_16x16x32_bf16 v[0:3], v[132:135], a[8:11], v[0:3]
  ds_read_b64_tr_b16 v[182:183], v118 offset:28160
  ds_read_b128 v[188:191], v119 offset:38912
  v_mfma_f32_16x16x32_bf16 v[48:51], v[132:135], a[12:15], v[48:51]
  ds_read_b64_tr_b16 v[184:185], v118 offset:28672
  ds_read_b64_tr_b16 v[186:187], v118 offset:29184
  v_mfma_f32_16x16x32_bf16 v[4:7], v[136:139], a[8:11], v[4:7]
  ds_read_b64_tr_b16 v[132:133], v114 offset:26624
  ds_read_b64_tr_b16 v[134:135], v114 offset:27136
  v_mfma_f32_16x16x32_bf16 v[52:55], v[136:139], a[12:15], v[52:55]
  ds_read_b64_tr_b16 v[136:137], v115 offset:26624
  ds_read_b64_tr_b16 v[138:139], v115 offset:27136
  v_mfma_f32_16x16x32_bf16 v[8:11], v[140:143], a[8:11], v[8:11]
  s_mov_b32 s50, 0
  v_mfma_f32_16x16x32_bf16 v[56:59], v[140:143], a[12:15], v[56:59]
  ds_read_b64_tr_b16 v[140:141], v116 offset:26624
  ds_read_b64_tr_b16 v[142:143], v116 offset:27136
  v_mfma_f32_16x16x32_bf16 v[12:15], v[144:147], a[8:11], v[12:15]
  v_mfma_f32_16x16x32_bf16 v[60:63], v[144:147], a[12:15], v[60:63]
  ds_read_b64_tr_b16 v[144:145], v117 offset:26624
  ds_read_b64_tr_b16 v[146:147], v117 offset:27136
  v_mfma_f32_16x16x32_bf16 v[16:19], v[148:151], a[8:11], v[16:19]
  v_mfma_f32_16x16x32_bf16 v[64:67], v[148:151], a[12:15], v[64:67]
  ds_read_b64_tr_b16 v[148:149], v114 offset:27648
  ds_read_b64_tr_b16 v[150:151], v114 offset:28160
  v_mfma_f32_16x16x32_bf16 v[20:23], v[152:155], a[8:11], v[20:23]
  buffer_load_dwordx4 v248, s[52:55], s50 offen lds
  v_mfma_f32_16x16x32_bf16 v[68:71], v[152:155], a[12:15], v[68:71]
  ds_read_b64_tr_b16 v[152:153], v115 offset:27648
  ds_read_b64_tr_b16 v[154:155], v115 offset:28160
  s_waitcnt lgkmcnt(10)
  v_mfma_f32_16x16x32_bf16 v[24:27], v[156:159], a[8:11], v[24:27]
  v_mfma_f32_16x16x32_bf16 v[72:75], v[156:159], a[12:15], v[72:75]
  ds_read_b64_tr_b16 v[156:157], v116 offset:27648
  ds_read_b64_tr_b16 v[158:159], v116 offset:28160
  v_mfma_f32_16x16x32_bf16 v[28:31], v[160:163], a[8:11], v[28:31]
  v_mfma_f32_16x16x32_bf16 v[76:79], v[160:163], a[12:15], v[76:79]
  ds_read_b64_tr_b16 v[160:161], v117 offset:27648
  ds_read_b64_tr_b16 v[162:163], v117 offset:28160
  v_mfma_f32_16x16x32_bf16 v[32:35], a[8:11], v[164:167], v[32:35]
  buffer_load_dwordx4 v249, s[52:55], s50 offen offset:1024 lds
  v_mfma_f32_16x16x32_bf16 v[80:83], a[12:15], v[164:167], v[80:83]
  ds_read_b64_tr_b16 v[164:165], v114 offset:28672
  ds_read_b64_tr_b16 v[166:167], v114 offset:29184
  v_mfma_f32_16x16x32_bf16 v[36:39], a[8:11], v[168:171], v[36:39]
  v_mfma_f32_16x16x32_bf16 v[84:87], a[12:15], v[168:171], v[84:87]
  ds_read_b64_tr_b16 v[168:169], v115 offset:28672
  ds_read_b64_tr_b16 v[170:171], v115 offset:29184
  v_mfma_f32_16x16x32_bf16 v[40:43], a[8:11], v[172:175], v[40:43]
  v_mfma_f32_16x16x32_bf16 v[88:91], a[12:15], v[172:175], v[88:91]
  ds_read_b64_tr_b16 v[172:173], v116 offset:28672
  ds_read_b64_tr_b16 v[174:175], v116 offset:29184
  v_mfma_f32_16x16x32_bf16 v[44:47], a[8:11], v[176:179], v[44:47]
  v_mfma_f32_16x16x32_bf16 v[92:95], a[12:15], v[176:179], v[92:95]
  s_waitcnt vmcnt(33) lgkmcnt(10)
  s_barrier
  v_mfma_f32_16x16x32_bf16 v[96:99], v[180:183], v[188:191], v[96:99]
  ds_read_b64_tr_b16 v[176:177], v117 offset:28672
  s_add_u32 m0, s51, 8192
  v_mfma_f32_16x16x32_bf16 v[100:103], v[188:191], v[184:187], v[100:103]
  ds_read_b64_tr_b16 v[178:179], v117 offset:29184
  ds_read_b64_tr_b16 v[180:181], v118 offset:40960
  v_mfma_f32_16x16x32_bf16 v[0:3], v[132:135], a[16:19], v[0:3]
  ds_read_b64_tr_b16 v[182:183], v118 offset:41472
  ds_read_b128 v[188:191], v119 offset:52224
  v_mfma_f32_16x16x32_bf16 v[48:51], v[132:135], a[20:23], v[48:51]
  ds_read_b64_tr_b16 v[184:185], v118 offset:41984
  s_mov_b32 s50, 131072
  v_mfma_f32_16x16x32_bf16 v[4:7], v[136:139], a[16:19], v[4:7]
  ds_read_b64_tr_b16 v[186:187], v118 offset:42496
  ds_read_b64_tr_b16 v[132:133], v114 offset:39936
  v_mfma_f32_16x16x32_bf16 v[52:55], v[136:139], a[20:23], v[52:55]
  ds_read_b64_tr_b16 v[134:135], v114 offset:40448
  ds_read_b64_tr_b16 v[136:137], v115 offset:39936
  v_mfma_f32_16x16x32_bf16 v[8:11], v[140:143], a[16:19], v[8:11]
  buffer_load_dwordx4 v248, s[52:55], s50 offen lds
  v_mfma_f32_16x16x32_bf16 v[56:59], v[140:143], a[20:23], v[56:59]
  ds_read_b64_tr_b16 v[138:139], v115 offset:40448
  ds_read_b64_tr_b16 v[140:141], v116 offset:39936
  v_mfma_f32_16x16x32_bf16 v[12:15], v[144:147], a[16:19], v[12:15]
  ds_read_b64_tr_b16 v[142:143], v116 offset:40448
  v_mfma_f32_16x16x32_bf16 v[60:63], v[144:147], a[20:23], v[60:63]
  buffer_load_dwordx4 v249, s[52:55], s50 offen offset:1024 lds
  v_mfma_f32_16x16x32_bf16 v[16:19], v[148:151], a[16:19], v[16:19]
  ds_read_b64_tr_b16 v[144:145], v117 offset:39936
  ds_read_b64_tr_b16 v[146:147], v117 offset:40448
  v_mfma_f32_16x16x32_bf16 v[64:67], v[148:151], a[20:23], v[64:67]
  ds_read_b64_tr_b16 v[148:149], v114 offset:40960
  ds_read_b64_tr_b16 v[150:151], v114 offset:41472
  v_mfma_f32_16x16x32_bf16 v[20:23], v[152:155], a[16:19], v[20:23]
  s_add_u32 m0, s51, 16384
  v_mfma_f32_16x16x32_bf16 v[68:71], v[152:155], a[20:23], v[68:71]
  ds_read_b64_tr_b16 v[152:153], v115 offset:40960
  ds_read_b64_tr_b16 v[154:155], v115 offset:41472
  s_waitcnt lgkmcnt(10)
  v_mfma_f32_16x16x32_bf16 v[24:27], v[156:159], a[16:19], v[24:27]
  v_mfma_f32_16x16x32_bf16 v[72:75], v[156:159], a[20:23], v[72:75]
  ds_read_b64_tr_b16 v[156:157], v116 offset:40960
  s_mov_b32 s50, 262144
  v_mfma_f32_16x16x32_bf16 v[28:31], v[160:163], a[16:19], v[28:31]
  ds_read_b64_tr_b16 v[158:159], v116 offset:41472
  v_mfma_f32_16x16x32_bf16 v[76:79], v[160:163], a[20:23], v[76:79]
  ds_read_b64_tr_b16 v[160:161], v117 offset:40960
  ds_read_b64_tr_b16 v[162:163], v117 offset:41472
  v_mfma_f32_16x16x32_bf16 v[32:35], a[16:19], v[164:167], v[32:35]
  buffer_load_dwordx4 v248, s[52:55], s50 offen lds
  v_mfma_f32_16x16x32_bf16 v[80:83], a[20:23], v[164:167], v[80:83]
  ds_read_b64_tr_b16 v[164:165], v114 offset:41984
  ds_read_b64_tr_b16 v[166:167], v114 offset:42496
  v_mfma_f32_16x16x32_bf16 v[36:39], a[16:19], v[168:171], v[36:39]
  v_mfma_f32_16x16x32_bf16 v[84:87], a[20:23], v[168:171], v[84:87]
  buffer_load_dwordx4 v249, s[52:55], s50 offen offset:1024 lds
  v_mfma_f32_16x16x32_bf16 v[40:43], a[16:19], v[172:175], v[40:43]
  ds_read_b64_tr_b16 v[168:169], v115 offset:41984
  ds_read_b64_tr_b16 v[170:171], v115 offset:42496
  v_mfma_f32_16x16x32_bf16 v[88:91], a[20:23], v[172:175], v[88:91]
  ds_read_b64_tr_b16 v[172:173], v116 offset:41984
  ds_read_b64_tr_b16 v[174:175], v116 offset:42496
  v_mfma_f32_16x16x32_bf16 v[44:47], a[16:19], v[176:179], v[44:47]
  v_mfma_f32_16x16x32_bf16 v[92:95], a[20:23], v[176:179], v[92:95]
  s_waitcnt vmcnt(31) lgkmcnt(10)
  s_barrier
  v_mfma_f32_16x16x32_bf16 v[96:99], v[180:183], v[188:191], v[96:99]
  ds_read_b64_tr_b16 v[176:177], v117 offset:41984
  s_add_u32 m0, s51, 24576
  v_mfma_f32_16x16x32_bf16 v[100:103], v[188:191], v[184:187], v[100:103]
  ds_read_b64_tr_b16 v[178:179], v117 offset:42496
  ds_read_b64_tr_b16 v[180:181], v124 offset:1024
  v_mfma_f32_16x16x32_bf16 v[0:3], v[132:135], a[24:27], v[0:3]
  ds_read_b64_tr_b16 v[182:183], v124 offset:1536
  ds_read_b128 v[188:191], v125 offset:12288
  v_mfma_f32_16x16x32_bf16 v[48:51], v[132:135], a[28:31], v[48:51]
  ds_read_b64_tr_b16 v[184:185], v124 offset:2048
  ds_read_b64_tr_b16 v[186:187], v124 offset:2560
  v_mfma_f32_16x16x32_bf16 v[4:7], v[136:139], a[24:27], v[4:7]
  ds_read_b64_tr_b16 v[132:133], v120 offset:0
  ds_read_b64_tr_b16 v[134:135], v120 offset:512
  v_mfma_f32_16x16x32_bf16 v[52:55], v[136:139], a[28:31], v[52:55]
  ds_read_b64_tr_b16 v[136:137], v121 offset:0
  ds_read_b64_tr_b16 v[138:139], v121 offset:512
  v_mfma_f32_16x16x32_bf16 v[8:11], v[140:143], a[24:27], v[8:11]
  s_mov_b32 s50, 524288
  v_mfma_f32_16x16x32_bf16 v[56:59], v[140:143], a[28:31], v[56:59]
  ds_read_b64_tr_b16 v[140:141], v122 offset:0
  ds_read_b64_tr_b16 v[142:143], v122 offset:512
  v_mfma_f32_16x16x32_bf16 v[12:15], v[144:147], a[24:27], v[12:15]
  v_mfma_f32_16x16x32_bf16 v[60:63], v[144:147], a[28:31], v[60:63]
  ds_read_b64_tr_b16 v[144:145], v123 offset:0
  ds_read_b64_tr_b16 v[146:147], v123 offset:512
  v_mfma_f32_16x16x32_bf16 v[16:19], v[148:151], a[24:27], v[16:19]
  v_mfma_f32_16x16x32_bf16 v[64:67], v[148:151], a[28:31], v[64:67]
  ds_read_b64_tr_b16 v[148:149], v120 offset:1024
  ds_read_b64_tr_b16 v[150:151], v120 offset:1536
  v_mfma_f32_16x16x32_bf16 v[20:23], v[152:155], a[24:27], v[20:23]
  buffer_load_dwordx4 v248, s[52:55], s50 offen lds
  v_mfma_f32_16x16x32_bf16 v[68:71], v[152:155], a[28:31], v[68:71]
  ds_read_b64_tr_b16 v[152:153], v121 offset:1024
  ds_read_b64_tr_b16 v[154:155], v121 offset:1536
  s_waitcnt lgkmcnt(10)
  v_mfma_f32_16x16x32_bf16 v[24:27], v[156:159], a[24:27], v[24:27]
  v_mfma_f32_16x16x32_bf16 v[72:75], v[156:159], a[28:31], v[72:75]
  ds_read_b64_tr_b16 v[156:157], v122 offset:1024
  ds_read_b64_tr_b16 v[158:159], v122 offset:1536
  v_mfma_f32_16x16x32_bf16 v[28:31], v[160:163], a[24:27], v[28:31]
  v_mfma_f32_16x16x32_bf16 v[76:79], v[160:163], a[28:31], v[76:79]
  ds_read_b64_tr_b16 v[160:161], v123 offset:1024
  ds_read_b64_tr_b16 v[162:163], v123 offset:1536
  v_mfma_f32_16x16x32_bf16 v[32:35], a[24:27], v[164:167], v[32:35]
  buffer_load_dwordx4 v249, s[52:55], s50 offen offset:1024 lds
  v_mfma_f32_16x16x32_bf16 v[80:83], a[28:31], v[164:167], v[80:83]
  ds_read_b64_tr_b16 v[164:165], v120 offset:2048
  ds_read_b64_tr_b16 v[166:167], v120 offset:2560
  v_mfma_f32_16x16x32_bf16 v[36:39], a[24:27], v[168:171], v[36:39]
  v_mfma_f32_16x16x32_bf16 v[84:87], a[28:31], v[168:171], v[84:87]
  ds_read_b64_tr_b16 v[168:169], v121 offset:2048
  ds_read_b64_tr_b16 v[170:171], v121 offset:2560
  v_mfma_f32_16x16x32_bf16 v[40:43], a[24:27], v[172:175], v[40:43]
  v_mfma_f32_16x16x32_bf16 v[88:91], a[28:31], v[172:175], v[88:91]
  ds_read_b64_tr_b16 v[172:173], v122 offset:2048
  ds_read_b64_tr_b16 v[174:175], v122 offset:2560
  v_mfma_f32_16x16x32_bf16 v[44:47], a[24:27], v[176:179], v[44:47]
  v_mfma_f32_16x16x32_bf16 v[92:95], a[28:31], v[176:179], v[92:95]
  s_waitcnt vmcnt(27) lgkmcnt(10)
  s_barrier
  v_mfma_f32_16x16x32_bf16 v[96:99], v[180:183], v[188:191], v[96:99]
  ds_read_b64_tr_b16 v[176:177], v123 offset:2048
  s_add_u32 m0, s51, 32768
  v_mfma_f32_16x16x32_bf16 v[100:103], v[188:191], v[184:187], v[100:103]
  ds_read_b64_tr_b16 v[178:179], v123 offset:2560
  ds_read_b64_tr_b16 v[180:181], v124 offset:14336
  v_mfma_f32_16x16x32_bf16 v[0:3], v[132:135], a[32:35], v[0:3]
  ds_read_b64_tr_b16 v[182:183], v124 offset:14848
  ds_read_b128 v[188:191], v125 offset:25600
  v_mfma_f32_16x16x32_bf16 v[48:51], v[132:135], a[36:39], v[48:51]
  ds_read_b64_tr_b16 v[184:185], v124 offset:15360
  s_mov_b32 s50, 655360
  v_mfma_f32_16x16x32_bf16 v[4:7], v[136:139], a[32:35], v[4:7]
  ds_read_b64_tr_b16 v[186:187], v124 offset:15872
  ds_read_b64_tr_b16 v[132:133], v120 offset:13312
  v_mfma_f32_16x16x32_bf16 v[52:55], v[136:139], a[36:39], v[52:55]
  ds_read_b64_tr_b16 v[134:135], v120 offset:13824
  ds_read_b64_tr_b16 v[136:137], v121 offset:13312
  v_mfma_f32_16x16x32_bf16 v[8:11], v[140:143], a[32:35], v[8:11]
  buffer_load_dwordx4 v248, s[52:55], s50 offen lds
  v_mfma_f32_16x16x32_bf16 v[56:59], v[140:143], a[36:39], v[56:59]
  ds_read_b64_tr_b16 v[138:139], v121 offset:13824
  ds_read_b64_tr_b16 v[140:141], v122 offset:13312
  v_mfma_f32_16x16x32_bf16 v[12:15], v[144:147], a[32:35], v[12:15]
  ds_read_b64_tr_b16 v[142:143], v122 offset:13824
  v_mfma_f32_16x16x32_bf16 v[60:63], v[144:147], a[36:39], v[60:63]
  buffer_load_dwordx4 v249, s[52:55], s50 offen offset:1024 lds
  v_mfma_f32_16x16x32_bf16 v[16:19], v[148:151], a[32:35], v[16:19]
  ds_read_b64_tr_b16 v[144:145], v123 offset:13312
  ds_read_b64_tr_b16 v[146:147], v123 offset:13824
  v_mfma_f32_16x16x32_bf16 v[64:67], v[148:151], a[36:39], v[64:67]
  ds_read_b64_tr_b16 v[148:149], v120 offset:14336
  ds_read_b64_tr_b16 v[150:151], v120 offset:14848
  v_mfma_f32_16x16x32_bf16 v[20:23], v[152:155], a[32:35], v[20:23]
  s_add_u32 m0, s51, 40960
  v_mfma_f32_16x16x32_bf16 v[68:71], v[152:155], a[36:39], v[68:71]
  ds_read_b64_tr_b16 v[152:153], v121 offset:14336
  ds_read_b64_tr_b16 v[154:155], v121 offset:14848
  s_waitcnt lgkmcnt(10)
  v_mfma_f32_16x16x32_bf16 v[24:27], v[156:159], a[32:35], v[24:27]
  v_mfma_f32_16x16x32_bf16 v[72:75], v[156:159], a[36:39], v[72:75]
  ds_read_b64_tr_b16 v[156:157], v122 offset:14336
  s_mov_b32 s50, 786432
  v_mfma_f32_16x16x32_bf16 v[28:31], v[160:163], a[32:35], v[28:31]
  ds_read_b64_tr_b16 v[158:159], v122 offset:14848
  v_mfma_f32_16x16x32_bf16 v[76:79], v[160:163], a[36:39], v[76:79]
  ds_read_b64_tr_b16 v[160:161], v123 offset:14336
  ds_read_b64_tr_b16 v[162:163], v123 offset:14848
  v_mfma_f32_16x16x32_bf16 v[32:35], a[32:35], v[164:167], v[32:35]
  buffer_load_dwordx4 v248, s[52:55], s50 offen lds
  v_mfma_f32_16x16x32_bf16 v[80:83], a[36:39], v[164:167], v[80:83]
  ds_read_b64_tr_b16 v[164:165], v120 offset:15360
  ds_read_b64_tr_b16 v[166:167], v120 offset:15872
  v_mfma_f32_16x16x32_bf16 v[36:39], a[32:35], v[168:171], v[36:39]
  v_mfma_f32_16x16x32_bf16 v[84:87], a[36:39], v[168:171], v[84:87]
  buffer_load_dwordx4 v249, s[52:55], s50 offen offset:1024 lds
  v_mfma_f32_16x16x32_bf16 v[40:43], a[32:35], v[172:175], v[40:43]
  ds_read_b64_tr_b16 v[168:169], v121 offset:15360
  ds_read_b64_tr_b16 v[170:171], v121 offset:15872
  v_mfma_f32_16x16x32_bf16 v[88:91], a[36:39], v[172:175], v[88:91]
  ds_read_b64_tr_b16 v[172:173], v122 offset:15360
  ds_read_b64_tr_b16 v[174:175], v122 offset:15872
  v_mfma_f32_16x16x32_bf16 v[44:47], a[32:35], v[176:179], v[44:47]
  v_mfma_f32_16x16x32_bf16 v[92:95], a[36:39], v[176:179], v[92:95]
  s_waitcnt vmcnt(24) lgkmcnt(10)
  s_barrier
  v_mfma_f32_16x16x32_bf16 v[96:99], v[180:183], v[188:191], v[96:99]
  ds_read_b64_tr_b16 v[176:177], v123 offset:15360
  s_add_u32 m0, s51, 49152
  v_mfma_f32_16x16x32_bf16 v[100:103], v[188:191], v[184:187], v[100:103]
  ds_read_b64_tr_b16 v[178:179], v123 offset:15872
  s_mov_b32 s50, 917504
  v_mfma_f32_16x16x32_bf16 v[0:3], v[132:135], a[40:43], v[0:3]
  buffer_load_dwordx4 v248, s[52:55], s50 offen lds
  v_mfma_f32_16x16x32_bf16 v[48:51], v[132:135], a[44:47], v[48:51]
  ds_read_b64_tr_b16 v[180:181], v124 offset:27648
  ds_read_b64_tr_b16 v[182:183], v124 offset:28160
  v_mfma_f32_16x16x32_bf16 v[4:7], v[136:139], a[40:43], v[4:7]
  ds_read_b128 v[188:191], v125 offset:38912
  ds_read_b64_tr_b16 v[184:185], v124 offset:28672
  ds_read_b64_tr_b16 v[186:187], v124 offset:29184
  buffer_load_dwordx4 v249, s[52:55], s50 offen offset:1024 lds
  v_mfma_f32_16x16x32_bf16 v[52:55], v[136:139], a[44:47], v[52:55]
  ds_read_b64_tr_b16 v[132:133], v120 offset:26624
  s_add_u32 m0, s51, 57344
  v_mfma_f32_16x16x32_bf16 v[8:11], v[140:143], a[40:43], v[8:11]
  ds_read_b64_tr_b16 v[134:135], v120 offset:27136
  ds_read_b64_tr_b16 v[136:137], v121 offset:26624
  v_mfma_f32_16x16x32_bf16 v[56:59], v[140:143], a[44:47], v[56:59]
  ds_read_b64_tr_b16 v[138:139], v121 offset:27136
  s_mov_b32 s50, 1048576
  v_mfma_f32_16x16x32_bf16 v[12:15], v[144:147], a[40:43], v[12:15]
  buffer_load_dwordx4 v248, s[52:55], s50 offen lds
  v_mfma_f32_16x16x32_bf16 v[60:63], v[144:147], a[44:47], v[60:63]
  ds_read_b64_tr_b16 v[140:141], v122 offset:26624
  ds_read_b64_tr_b16 v[142:143], v122 offset:27136
  v_mfma_f32_16x16x32_bf16 v[16:19], v[148:151], a[40:43], v[16:19]
  buffer_load_dwordx4 v249, s[52:55], s50 offen offset:1024 lds
  v_mfma_f32_16x16x32_bf16 v[64:67], v[148:151], a[44:47], v[64:67]
  ds_read_b64_tr_b16 v[144:145], v123 offset:26624
  s_mov_b32 s56, s26
  v_mfma_f32_16x16x32_bf16 v[20:23], v[152:155], a[40:43], v[20:23]
  ds_read_b64_tr_b16 v[146:147], v123 offset:27136
  ds_read_b64_tr_b16 v[148:149], v120 offset:27648
  v_mfma_f32_16x16x32_bf16 v[68:71], v[152:155], a[44:47], v[68:71]
  ds_read_b64_tr_b16 v[150:151], v120 offset:28160
  s_mov_b32 s57, s27
  s_waitcnt lgkmcnt(10)
  v_mfma_f32_16x16x32_bf16 v[24:27], v[156:159], a[40:43], v[24:27]
  ds_read_b64_tr_b16 v[152:153], v121 offset:27648
  s_mov_b32 s58, 0x400000
  v_mfma_f32_16x16x32_bf16 v[72:75], v[156:159], a[44:47], v[72:75]
  ds_read_b64_tr_b16 v[154:155], v121 offset:28160
  ds_read_b64_tr_b16 v[156:157], v122 offset:27648
  v_mfma_f32_16x16x32_bf16 v[28:31], v[160:163], a[40:43], v[28:31]
  ds_read_b64_tr_b16 v[158:159], v122 offset:28160
  s_mov_b32 s59, 0x20000
  v_mfma_f32_16x16x32_bf16 v[76:79], v[160:163], a[44:47], v[76:79]
  ds_read_b64_tr_b16 v[160:161], v123 offset:27648
  s_mov_b32 s33, 0x8000
  v_mfma_f32_16x16x32_bf16 v[32:35], a[40:43], v[164:167], v[32:35]
  ds_read_b64_tr_b16 v[162:163], v123 offset:28160
  v_mfma_f32_16x16x32_bf16 v[80:83], a[44:47], v[164:167], v[80:83]
  buffer_load_dwordx4 a[240:243], v128, s[56:59], 0 offen offset:0
  v_mfma_f32_16x16x32_bf16 v[36:39], a[40:43], v[168:171], v[36:39]
  buffer_load_dwordx4 a[244:247], v128, s[56:59], 0 offen offset:64
  v_mfma_f32_16x16x32_bf16 v[84:87], a[44:47], v[168:171], v[84:87]
  ds_read_b64_tr_b16 v[164:165], v120 offset:28672
  ds_read_b64_tr_b16 v[166:167], v120 offset:29184
  v_mfma_f32_16x16x32_bf16 v[40:43], a[40:43], v[172:175], v[40:43]
  buffer_load_dwordx4 a[248:251], v128, s[56:59], s33 offen offset:0
  v_mfma_f32_16x16x32_bf16 v[88:91], a[44:47], v[172:175], v[88:91]
  buffer_load_dwordx4 a[252:255], v128, s[56:59], s33 offen offset:64
  v_mfma_f32_16x16x32_bf16 v[44:47], a[40:43], v[176:179], v[44:47]
  ds_read_b64_tr_b16 v[168:169], v121 offset:28672
  ds_read_b64_tr_b16 v[170:171], v121 offset:29184
  v_mfma_f32_16x16x32_bf16 v[92:95], a[44:47], v[176:179], v[92:95]
  s_waitcnt vmcnt(20) lgkmcnt(10)
  s_barrier
  v_mfma_f32_16x16x32_bf16 v[96:99], v[180:183], v[188:191], v[96:99]
  ds_read_b64_tr_b16 v[172:173], v122 offset:28672
  ds_read_b64_tr_b16 v[174:175], v122 offset:29184
  s_add_u32 m0, s51, 65536
  v_mfma_f32_16x16x32_bf16 v[100:103], v[188:191], v[184:187], v[100:103]
  ds_read_b64_tr_b16 v[176:177], v123 offset:28672
  ds_read_b64_tr_b16 v[178:179], v123 offset:29184
  v_mfma_f32_16x16x32_bf16 v[0:3], v[132:135], a[48:51], v[0:3]
  ds_read_b64_tr_b16 v[180:181], v124 offset:40960
  ds_read_b64_tr_b16 v[182:183], v124 offset:41472
  v_mfma_f32_16x16x32_bf16 v[48:51], v[132:135], a[52:55], v[48:51]
  ds_read_b128 v[188:191], v125 offset:52224
  ds_read_b64_tr_b16 v[184:185], v124 offset:41984
  v_mfma_f32_16x16x32_bf16 v[4:7], v[136:139], a[48:51], v[4:7]
  ds_read_b64_tr_b16 v[186:187], v124 offset:42496
  ds_read_b64_tr_b16 v[132:133], v120 offset:39936
  v_mfma_f32_16x16x32_bf16 v[52:55], v[136:139], a[52:55], v[52:55]
  ds_read_b64_tr_b16 v[134:135], v120 offset:40448
  ds_read_b64_tr_b16 v[136:137], v121 offset:39936
  v_mfma_f32_16x16x32_bf16 v[8:11], v[140:143], a[48:51], v[8:11]
  ds_read_b64_tr_b16 v[138:139], v121 offset:40448
  s_mov_b32 s50, 1179648
  v_mfma_f32_16x16x32_bf16 v[56:59], v[140:143], a[52:55], v[56:59]
  ds_read_b64_tr_b16 v[140:141], v122 offset:39936
  ds_read_b64_tr_b16 v[142:143], v122 offset:40448
  v_mfma_f32_16x16x32_bf16 v[12:15], v[144:147], a[48:51], v[12:15]
  v_mfma_f32_16x16x32_bf16 v[60:63], v[144:147], a[52:55], v[60:63]
  ds_read_b64_tr_b16 v[144:145], v123 offset:39936
  ds_read_b64_tr_b16 v[146:147], v123 offset:40448
  v_mfma_f32_16x16x32_bf16 v[16:19], v[148:151], a[48:51], v[16:19]
  v_mfma_f32_16x16x32_bf16 v[64:67], v[148:151], a[52:55], v[64:67]
  ds_read_b64_tr_b16 v[148:149], v120 offset:40960
  ds_read_b64_tr_b16 v[150:151], v120 offset:41472
  s_waitcnt lgkmcnt(10)
  v_mfma_f32_16x16x32_bf16 v[20:23], v[152:155], a[48:51], v[20:23]
  buffer_load_dwordx4 v248, s[52:55], s50 offen lds
  v_mfma_f32_16x16x32_bf16 v[68:71], v[152:155], a[52:55], v[68:71]
  ds_read_b64_tr_b16 v[152:153], v121 offset:40960
  ds_read_b64_tr_b16 v[154:155], v121 offset:41472
  v_mfma_f32_16x16x32_bf16 v[24:27], v[156:159], a[48:51], v[24:27]
  v_mfma_f32_16x16x32_bf16 v[72:75], v[156:159], a[52:55], v[72:75]
  ds_read_b64_tr_b16 v[156:157], v122 offset:40960
  ds_read_b64_tr_b16 v[158:159], v122 offset:41472
  v_mfma_f32_16x16x32_bf16 v[28:31], v[160:163], a[48:51], v[28:31]
  v_mfma_f32_16x16x32_bf16 v[76:79], v[160:163], a[52:55], v[76:79]
  ds_read_b64_tr_b16 v[160:161], v123 offset:40960
  ds_read_b64_tr_b16 v[162:163], v123 offset:41472
  v_mfma_f32_16x16x32_bf16 v[32:35], a[48:51], v[164:167], v[32:35]
  buffer_load_dwordx4 v249, s[52:55], s50 offen offset:1024 lds
  v_mfma_f32_16x16x32_bf16 v[80:83], a[52:55], v[164:167], v[80:83]
  ds_read_b64_tr_b16 v[164:165], v120 offset:41984
  ds_read_b64_tr_b16 v[166:167], v120 offset:42496
  v_mfma_f32_16x16x32_bf16 v[36:39], a[48:51], v[168:171], v[36:39]
  v_mfma_f32_16x16x32_bf16 v[84:87], a[52:55], v[168:171], v[84:87]
  ds_read_b64_tr_b16 v[168:169], v121 offset:41984
  ds_read_b64_tr_b16 v[170:171], v121 offset:42496
  v_mfma_f32_16x16x32_bf16 v[40:43], a[48:51], v[172:175], v[40:43]
  v_mfma_f32_16x16x32_bf16 v[88:91], a[52:55], v[172:175], v[88:91]
  ds_read_b64_tr_b16 v[172:173], v122 offset:41984
  ds_read_b64_tr_b16 v[174:175], v122 offset:42496
  v_mfma_f32_16x16x32_bf16 v[44:47], a[48:51], v[176:179], v[44:47]
  v_mfma_f32_16x16x32_bf16 v[92:95], a[52:55], v[176:179], v[92:95]
  s_waitcnt vmcnt(22) lgkmcnt(10)
  s_barrier
  v_mfma_f32_16x16x32_bf16 v[96:99], v[180:183], v[188:191], v[96:99]
  ds_read_b64_tr_b16 v[176:177], v123 offset:41984
  s_add_u32 m0, s51, 73728
  v_mfma_f32_16x16x32_bf16 v[100:103], v[188:191], v[184:187], v[100:103]
  ds_read_b64_tr_b16 v[178:179], v123 offset:42496
  s_mov_b32 s50, 1310720
  v_mfma_f32_16x16x32_bf16 v[0:3], v[132:135], a[56:59], v[0:3]
  v_mfma_f32_16x16x32_bf16 v[48:51], v[132:135], a[60:63], v[48:51]
  buffer_load_dwordx4 v248, s[52:55], s50 offen lds
  v_mfma_f32_16x16x32_bf16 v[4:7], v[136:139], a[56:59], v[4:7]
  v_mfma_f32_16x16x32_bf16 v[52:55], v[136:139], a[60:63], v[52:55]
  buffer_load_dwordx4 v249, s[52:55], s50 offen offset:1024 lds
  v_mfma_f32_16x16x32_bf16 v[8:11], v[140:143], a[56:59], v[8:11]
  v_mfma_f32_16x16x32_bf16 v[56:59], v[140:143], a[60:63], v[56:59]
  s_add_u32 m0, s51, 81920
  v_mfma_f32_16x16x32_bf16 v[12:15], v[144:147], a[56:59], v[12:15]
  v_mfma_f32_16x16x32_bf16 v[60:63], v[144:147], a[60:63], v[60:63]
  s_mov_b32 s50, 1572864
  v_mfma_f32_16x16x32_bf16 v[16:19], v[148:151], a[56:59], v[16:19]
  v_mfma_f32_16x16x32_bf16 v[64:67], v[148:151], a[60:63], v[64:67]
  buffer_load_dwordx4 v248, s[52:55], s50 offen lds
  v_mfma_f32_16x16x32_bf16 v[20:23], v[152:155], a[56:59], v[20:23]
  v_mfma_f32_16x16x32_bf16 v[68:71], v[152:155], a[60:63], v[68:71]
  buffer_load_dwordx4 v249, s[52:55], s50 offen offset:1024 lds
  s_waitcnt lgkmcnt(10)
  v_mfma_f32_16x16x32_bf16 v[24:27], v[156:159], a[56:59], v[24:27]
  v_mfma_f32_16x16x32_bf16 v[72:75], v[156:159], a[60:63], v[72:75]
  s_lshl_b32 s34, s37, 8
  s_waitcnt lgkmcnt(8)
  v_mfma_f32_16x16x32_bf16 v[28:31], v[160:163], a[56:59], v[28:31]
  v_mfma_f32_16x16x32_bf16 v[76:79], v[160:163], a[60:63], v[76:79]
  s_lshl_b32 s33, s3, 12
  s_waitcnt lgkmcnt(6)
  v_mfma_f32_16x16x32_bf16 v[32:35], a[56:59], v[164:167], v[32:35]
  v_mfma_f32_16x16x32_bf16 v[80:83], a[60:63], v[164:167], v[80:83]
  s_add_u32 s34, s34, s33
  s_waitcnt lgkmcnt(4)
  v_mfma_f32_16x16x32_bf16 v[36:39], a[56:59], v[168:171], v[36:39]
  v_mfma_f32_16x16x32_bf16 v[84:87], a[60:63], v[168:171], v[84:87]
  s_add_u32 s68, s34, 8192
  s_waitcnt lgkmcnt(2)
  v_mfma_f32_16x16x32_bf16 v[40:43], a[56:59], v[172:175], v[40:43]
  v_mfma_f32_16x16x32_bf16 v[88:91], a[60:63], v[172:175], v[88:91]
  buffer_load_dwordx4 v[250:253], v254, s[12:15], s68 offen sc1
  s_waitcnt lgkmcnt(0)
  v_mfma_f32_16x16x32_bf16 v[44:47], a[56:59], v[176:179], v[44:47]
  v_mfma_f32_16x16x32_bf16 v[92:95], a[60:63], v[176:179], v[92:95]
  s_nop 7
  s_nop 1
L_att:
  s_add_u32 s4, s20, 0x600000
  s_addc_u32 s5, s21, 0
  s_mov_b32 s6, 0x400000
  s_mov_b32 s7, 0x20000
  s_lshl_b32 s33, s3, 12
  s_add_u32 s33, s33, 139264
  v_add_u32 v110, s33, v119
  s_lshr_b32 s33, s3, 1
  s_lshl_b32 s33, s33, 10
  s_and_b32 s34, s3, 1
  s_lshl_b32 s34, s34, 3
  s_add_u32 s33, s33, s34
  s_add_u32 s33, s33, 139264
  v_add_u32 v111, s33, v119
  v_cvt_pk_bf16_f32 v196, v96, v97
  v_cvt_pk_bf16_f32 v197, v98, v99
  v_cvt_pk_bf16_f32 v198, v100, v101
  v_cvt_pk_bf16_f32 v199, v102, v103
  v_cvt_pk_bf16_f32 v164, v64, v65
  v_cvt_pk_bf16_f32 v165, v66, v67
  v_cvt_pk_bf16_f32 v176, v80, v81
  v_cvt_pk_bf16_f32 v177, v82, v83
  v_cvt_pk_bf16_f32 v166, v68, v69
  v_cvt_pk_bf16_f32 v167, v70, v71
  v_cvt_pk_bf16_f32 v182, v84, v85
  v_cvt_pk_bf16_f32 v183, v86, v87
  v_cvt_pk_bf16_f32 v168, v72, v73
  v_cvt_pk_bf16_f32 v169, v74, v75
  v_cvt_pk_bf16_f32 v188, v88, v89
  v_cvt_pk_bf16_f32 v189, v90, v91
  v_cvt_pk_bf16_f32 v170, v76, v77
  v_cvt_pk_bf16_f32 v171, v78, v79
  v_cvt_pk_bf16_f32 v194, v92, v93
  v_cvt_pk_bf16_f32 v195, v94, v95
  ds_write_b64 v111, v[196:197]
  ds_write_b64 v111, v[198:199] offset:2048
  ds_write_b128 v110, v[164:167] offset:4096
  ds_write_b64 v110, v[176:177] offset:6144
  ds_write_b64 v110, v[182:183] offset:6152
  ds_write_b128 v110, v[168:171] offset:5120
  ds_write_b64 v110, v[188:189] offset:7168
  ds_write_b64 v110, v[194:195] offset:7176
  v_cvt_pk_bf16_f32 v132, v0, v1
  v_cvt_pk_bf16_f32 v133, v2, v3
  v_cvt_pk_bf16_f32 v140, v48, v49
  v_cvt_pk_bf16_f32 v141, v50, v51
  v_cvt_pk_bf16_f32 v156, v16, v17
  v_cvt_pk_bf16_f32 v157, v18, v19
  v_cvt_pk_bf16_f32 v174, v32, v33
  v_cvt_pk_bf16_f32 v175, v34, v35
  v_cvt_pk_bf16_f32 v134, v4, v5
  v_cvt_pk_bf16_f32 v135, v6, v7
  v_cvt_pk_bf16_f32 v142, v52, v53
  v_cvt_pk_bf16_f32 v143, v54, v55
  v_cvt_pk_bf16_f32 v158, v20, v21
  v_cvt_pk_bf16_f32 v159, v22, v23
  v_cvt_pk_bf16_f32 v180, v36, v37
  v_cvt_pk_bf16_f32 v181, v38, v39
  v_cvt_pk_bf16_f32 v136, v8, v9
  v_cvt_pk_bf16_f32 v137, v10, v11
  v_cvt_pk_bf16_f32 v144, v56, v57
  v_cvt_pk_bf16_f32 v145, v58, v59
  v_cvt_pk_bf16_f32 v160, v24, v25
  v_cvt_pk_bf16_f32 v161, v26, v27
  v_cvt_pk_bf16_f32 v186, v40, v41
  v_cvt_pk_bf16_f32 v187, v42, v43
  v_cvt_pk_bf16_f32 v138, v12, v13
  v_cvt_pk_bf16_f32 v139, v14, v15
  v_cvt_pk_bf16_f32 v146, v60, v61
  v_cvt_pk_bf16_f32 v147, v62, v63
  v_cvt_pk_bf16_f32 v162, v28, v29
  v_cvt_pk_bf16_f32 v163, v30, v31
  v_cvt_pk_bf16_f32 v192, v44, v45
  v_cvt_pk_bf16_f32 v193, v46, v47
  s_waitcnt lgkmcnt(0)
  s_barrier
  ds_read_b128 v[148:151], v110 offset:0
  ds_read_b64 v[172:173], v110 offset:2048
  ds_read_b64 v[178:179], v110 offset:2056
  ds_read_b128 v[152:155], v110 offset:1024
  ds_read_b64 v[184:185], v110 offset:3072
  ds_read_b64 v[190:191], v110 offset:3080
  s_add_u32 m0, s51, 90112
  s_mov_b32 s50, 1703936
  buffer_load_dwordx4 v248, s[52:55], s50 offen lds
  buffer_load_dwordx4 v249, s[52:55], s50 offen offset:1024 lds
  s_add_u32 m0, s51, 98304
  s_mov_b32 s50, 1835008
  buffer_load_dwordx4 v248, s[52:55], s50 offen lds
  buffer_load_dwordx4 v249, s[52:55], s50 offen offset:1024 lds
  v_mfma_f32_16x16x32_bf16 v[200:203], v[156:159], v[140:143], 0
  v_mfma_f32_16x16x32_bf16 v[204:207], v[164:167], v[140:143], 0
  v_mfma_f32_16x16x32_bf16 v[208:211], v[160:163], v[144:147], 0
  v_mfma_f32_16x16x32_bf16 v[212:215], v[168:171], v[144:147], 0
  s_or_b32 s33, s30, s3
  s_cmp_eq_u32 s33, 0
  s_cselect_b32 s33, 0xf149f2ca, 0
  v_mov_b32 v232, s33
  v_cndmask_b32_e64 v120, v232, 0, s[44:45]
  v_cndmask_b32_e64 v121, v232, 0, s[46:47]
  v_and_b32 v122, 1, v104
  v_lshlrev_b32 v122, 4, v122
  s_waitcnt lgkmcnt(0)
  v_mfma_f32_16x16x32_bf16 v[216:219], v[148:151], v[132:135], 0
  v_mfma_f32_16x16x32_bf16 v[220:223], v[156:159], v[132:135], 0
  v_mfma_f32_16x16x32_bf16 v[224:227], v[152:155], v[136:139], 0
  v_mfma_f32_16x16x32_bf16 v[228:231], v[160:163], v[136:139], 0
  s_mov_b32 s40, 0x3e8293ee
  v_cndmask_b32_e64 v200, v200, v201, s[48:49]
  v_cndmask_b32_e64 v202, v202, v203, s[48:49]
  v_cndmask_b32_e64 v204, v204, v205, s[48:49]
  v_cndmask_b32_e64 v206, v206, v207, s[48:49]
  v_cndmask_b32_e64 v208, v208, v209, s[48:49]
  v_cndmask_b32_e64 v210, v210, v211, s[48:49]
  v_cndmask_b32_e64 v212, v212, v213, s[48:49]
  v_cndmask_b32_e64 v214, v214, v215, s[48:49]
  v_cndmask_b32_e64 v216, v216, v217, s[48:49]
  v_cndmask_b32_e64 v218, v218, v219, s[48:49]
  v_cndmask_b32_e64 v220, v220, v221, s[48:49]
  v_cndmask_b32_e64 v222, v222, v223, s[48:49]
  v_cndmask_b32_e64 v224, v224, v225, s[48:49]
  v_cndmask_b32_e64 v226, v226, v227, s[48:49]
  v_cndmask_b32_e64 v228, v228, v229, s[48:49]
  v_cndmask_b32_e64 v230, v230, v231, s[48:49]
  v_cndmask_b32_e64 v200, v200, v204, s[44:45]
  v_cndmask_b32_e64 v201, v202, v206, s[46:47]
  v_cndmask_b32_e64 v208, v208, v212, s[44:45]
  v_cndmask_b32_e64 v209, v210, v214, s[46:47]
  v_cndmask_b32_e64 v216, v216, v220, s[44:45]
  v_cndmask_b32_e64 v217, v218, v222, s[46:47]
  v_cndmask_b32_e64 v224, v224, v228, s[44:45]
  v_cndmask_b32_e64 v225, v226, v230, s[46:47]
  v_mul_f32 v200, s40, v200
  v_mul_f32 v201, s40, v201
  v_mul_f32 v208, s40, v208
  v_mul_f32 v209, s40, v209
  v_fma_f32 v216, v216, s40, v120
  v_fma_f32 v217, v217, s40, v121
  v_fma_f32 v224, v224, s40, v120
  v_fma_f32 v225, v225, s40, v121
  v_max_f32 v232, v200, v201
  v_max_f32 v233, v208, v209
  v_max_f32 v234, v216, v217
  v_max_f32 v235, v224, v225
  v_mov_b32 v236, v232
  v_mov_b32 v237, v233
  v_mov_b32 v238, v234
  v_mov_b32 v239, v235
  s_nop 1
  v_permlane16_swap_b32 v236, v232
  v_permlane16_swap_b32 v237, v233
  v_permlane16_swap_b32 v238, v234
  v_permlane16_swap_b32 v239, v235
  s_nop 1
  v_max_f32 v232, v232, v236
  v_max_f32 v233, v233, v237
  v_max_f32 v234, v234, v238
  v_max_f32 v235, v235, v239
  v_mov_b32 v236, v232
  v_mov_b32 v237, v233
  v_mov_b32 v238, v234
  v_mov_b32 v239, v235
  s_nop 1
  v_permlane32_swap_b32 v236, v232
  v_permlane32_swap_b32 v237, v233
  v_permlane32_swap_b32 v238, v234
  v_permlane32_swap_b32 v239, v235
  s_nop 1
  v_max_f32 v232, v232, v236
  v_max_f32 v233, v233, v237
  v_max_f32 v234, v234, v238
  v_max_f32 v235, v235, v239
  v_sub_f32 v200, v200, v232
  v_sub_f32 v201, v201, v232
  v_sub_f32 v208, v208, v233
  v_sub_f32 v209, v209, v233
  v_sub_f32 v216, v216, v234
  v_sub_f32 v217, v217, v234
  v_sub_f32 v224, v224, v235
  v_sub_f32 v225, v225, v235
  v_exp_f32 v200, v200
  v_exp_f32 v201, v201
  v_exp_f32 v208, v208
  v_exp_f32 v209, v209
  v_exp_f32 v216, v216
  v_exp_f32 v217, v217
  v_exp_f32 v224, v224
  v_exp_f32 v225, v225
  s_nop 0
  v_add_f32 v232, v200, v201
  v_add_f32 v233, v208, v209
  v_add_f32 v234, v216, v217
  v_add_f32 v235, v224, v225
  v_mov_b32 v236, v232
  v_mov_b32 v237, v233
  v_mov_b32 v238, v234
  v_mov_b32 v239, v235
  s_nop 1
  v_permlane16_swap_b32 v236, v232
  v_permlane16_swap_b32 v237, v233
  v_permlane16_swap_b32 v238, v234
  v_permlane16_swap_b32 v239, v235
  s_nop 1
  v_add_f32 v232, v232, v236
  v_add_f32 v233, v233, v237
  v_add_f32 v234, v234, v238
  v_add_f32 v235, v235, v239
  v_mov_b32 v236, v232
  v_mov_b32 v237, v233
  v_mov_b32 v238, v234
  v_mov_b32 v239, v235
  s_nop 1
  v_permlane32_swap_b32 v236, v232
  v_permlane32_swap_b32 v237, v233
  v_permlane32_swap_b32 v238, v234
  v_permlane32_swap_b32 v239, v235
  s_nop 1
  v_add_f32 v232, v232, v236
  v_add_f32 v233, v233, v237
  v_add_f32 v234, v234, v238
  v_add_f32 v235, v235, v239
  v_rcp_f32 v232, v232
  v_rcp_f32 v233, v233
  v_rcp_f32 v234, v234
  v_rcp_f32 v235, v235
  s_nop 0
  v_mul_f32 v200, v200, v232
  v_mul_f32 v201, v201, v232
  v_mul_f32 v208, v208, v233
  v_mul_f32 v209, v209, v233
  v_mul_f32 v216, v216, v234
  v_mul_f32 v217, v217, v234
  v_mul_f32 v224, v224, v235
  v_mul_f32 v225, v225, v235
  v_cvt_pk_bf16_f32 v200, v200, 0
  v_cvt_pk_bf16_f32 v201, v201, 0
  v_cvt_pk_bf16_f32 v208, v208, 0
  v_cvt_pk_bf16_f32 v209, v209, 0
  v_cvt_pk_bf16_f32 v216, v216, 0
  v_cvt_pk_bf16_f32 v217, v217, 0
  v_cvt_pk_bf16_f32 v224, v224, 0
  v_cvt_pk_bf16_f32 v225, v225, 0
  v_lshlrev_b32 v200, v122, v200
  v_lshlrev_b32 v201, v122, v201
  v_lshlrev_b32 v208, v122, v208
  v_lshlrev_b32 v209, v122, v209
  v_lshlrev_b32 v216, v122, v216
  v_lshlrev_b32 v217, v122, v217
  v_lshlrev_b32 v224, v122, v224
  v_lshlrev_b32 v225, v122, v225
  v_cndmask_b32_e64 v132, v200, 0, s[44:45]
  v_cndmask_b32_e64 v134, 0, v200, s[44:45]
  v_cndmask_b32_e64 v133, v201, 0, s[46:47]
  v_cndmask_b32_e64 v135, 0, v201, s[46:47]
  v_cndmask_b32_e64 v136, v208, 0, s[44:45]
  v_cndmask_b32_e64 v138, 0, v208, s[44:45]
  v_cndmask_b32_e64 v137, v209, 0, s[46:47]
  v_cndmask_b32_e64 v139, 0, v209, s[46:47]
  v_cndmask_b32_e64 v140, v216, 0, s[44:45]
  v_cndmask_b32_e64 v142, 0, v216, s[44:45]
  v_cndmask_b32_e64 v141, v217, 0, s[46:47]
  v_cndmask_b32_e64 v143, 0, v217, s[46:47]
  v_cndmask_b32_e64 v144, v224, 0, s[44:45]
  v_cndmask_b32_e64 v146, 0, v224, s[44:45]
  v_cndmask_b32_e64 v145, v225, 0, s[46:47]
  v_cndmask_b32_e64 v147, 0, v225, s[46:47]
  s_nop 1
  v_mfma_f32_16x16x32_bf16 v[200:203], v[174:177], v[132:135], 0
  v_mfma_f32_16x16x32_bf16 v[204:207], v[180:183], v[132:135], 0
  v_mfma_f32_16x16x32_bf16 v[208:211], v[186:189], v[136:139], 0
  v_mfma_f32_16x16x32_bf16 v[212:215], v[192:195], v[136:139], 0
  v_mfma_f32_16x16x32_bf16 v[216:219], v[172:175], v[140:143], 0
  v_mfma_f32_16x16x32_bf16 v[220:223], v[178:181], v[140:143], 0
  v_mfma_f32_16x16x32_bf16 v[224:227], v[184:187], v[144:147], 0
  v_mfma_f32_16x16x32_bf16 v[228:231], v[190:193], v[144:147], 0
  s_lshl_b32 s41, s31, 18
  s_add_u32 s42, s41, 131072
  s_nop 1
  v_cvt_pk_bf16_f32 v148, v200, v201
  v_cvt_pk_bf16_f32 v149, v202, v203
  v_cvt_pk_bf16_f32 v150, v204, v205
  v_cvt_pk_bf16_f32 v151, v206, v207
  buffer_store_dwordx4 v[148:151], v105, s[4:7], s41 offen offset:1024 sc1
  v_cvt_pk_bf16_f32 v152, v208, v209
  v_cvt_pk_bf16_f32 v153, v210, v211
  v_cvt_pk_bf16_f32 v154, v212, v213
  v_cvt_pk_bf16_f32 v155, v214, v215
  buffer_store_dwordx4 v[152:155], v105, s[4:7], s42 offen offset:1024 sc1
  v_cvt_pk_bf16_f32 v156, v216, v217
  v_cvt_pk_bf16_f32 v157, v218, v219
  v_cvt_pk_bf16_f32 v158, v220, v221
  v_cvt_pk_bf16_f32 v159, v222, v223
  buffer_store_dwordx4 v[156:159], v105, s[4:7], s41 offen offset:0 sc1
  s_nop 0
  v_cvt_pk_bf16_f32 v160, v224, v225
  v_cvt_pk_bf16_f32 v161, v226, v227
  v_cvt_pk_bf16_f32 v162, v228, v229
  v_cvt_pk_bf16_f32 v163, v230, v231
  buffer_store_dwordx4 v[160:163], v105, s[4:7], s42 offen offset:0 sc1
  s_lshl_b32 s69, s30, 2
  s_add_u32 s69, s69, s3
  s_lshl_b32 s69, s69, 4
  s_add_u32 s69, s69, s31
  s_add_u32 s69, s69, 1024
  s_lshl_b32 s69, s69, 6
  s_mov_b32 s30, s36
  s_mov_b32 s31, s37
  v_mov_b32 v32, v104
  v_mov_b32 v231, v104
  v_mov_b32 v43, v128
  v_and_b32 v44, 15, v32
  s_lshl_b32 s32, s30, 13
  s_lshl_b32 s33, s3, 11
  s_add_u32 s32, s32, s33
  v_lshlrev_b32 v80, 4, v32
  v_add_u32 v33, s32, v80
  v_add_u32 v34, 131072, v33
  s_lshl_b32 s16, s98, 1
  s_lshl_b32 s32, s30, 2
  s_add_u32 s32, s32, s3
  s_lshl_b32 s32, s32, 4
  s_add_u32 s32, s32, 1024
  v_add_u32 v45, s32, v44
  v_lshlrev_b32 v45, 6, v45
  v_mov_b32 v158, s19
  v_mov_b32 v159, s19
  v_lshlrev_b32 v46, 2, v32
  s_bfe_u32 s48, s19, 0x80000
  s_bfe_u32 s49, s19, 0x80008
  s_bfe_u32 s50, s19, 0x80010
  s_bfe_u32 s51, s19, 0x80018
  s_mov_b32 s92, s30
  s_mov_b32 s93, s31
  s_and_b32 s28, s2, 7
  s_lshr_b32 s29, s2, 3
  s_and_b32 s30, s28, 1
  s_lshl_b32 s30, s30, 2
  s_and_b32 s31, s29, 3
  s_add_u32 s30, s30, s31
  s_lshr_b32 s31, s28, 1
  s_lshl_b32 s31, s31, 3
  s_lshr_b32 s29, s29, 2
  s_add_u32 s31, s31, s29
  s_lshl_b32 s32, s30, 14
  s_lshl_b32 s33, s3, 12
  s_add_u32 s32, s32, s33
  v_lshlrev_b32 v224, 4, v231
  v_add_u32 v224, s32, v224
  s_and_b32 s33, s3, 1
  s_mul_i32 s34, s33, 114688
  s_mul_i32 s35, s31, 224
  s_add_u32 s34, s34, s35
  s_movk_i32 s36, 4682
  s_movk_i32 s37, 7168
  s_and_b32 s39, s31, 1
  s_lshl_b32 s39, s39, 1
  v_add_u32 v234, 0, v231
  v_mul_u32_u24 v235, s36, v234
  v_lshrrev_b32 v235, 16, v235
  v_mul_u32_u24 v236, 14, v235
  v_sub_u32 v236, v234, v236
  v_add_u32 v236, s39, v236
  v_subrev_u32 v237, 14, v236
  v_min_u32 v236, v236, v237
  v_mul_u32_u24 v235, s37, v235
  v_lshl_add_u32 v235, v236, 4, v235
  v_add_u32 v235, s34, v235
  v_subrev_u32 v225, 0, v235
  v_add_u32 v234, 64, v231
  v_mul_u32_u24 v235, s36, v234
  v_lshrrev_b32 v235, 16, v235
  v_mul_u32_u24 v236, 14, v235
  v_sub_u32 v236, v234, v236
  v_add_u32 v236, s39, v236
  v_subrev_u32 v237, 14, v236
  v_min_u32 v236, v236, v237
  v_mul_u32_u24 v235, s37, v235
  v_lshl_add_u32 v235, v236, 4, v235
  v_add_u32 v235, s34, v235
  v_subrev_u32 v226, 1024, v235
  v_add_u32 v234, 128, v231
  v_mul_u32_u24 v235, s36, v234
  v_lshrrev_b32 v235, 16, v235
  v_mul_u32_u24 v236, 14, v235
  v_sub_u32 v236, v234, v236
  v_add_u32 v236, s39, v236
  v_subrev_u32 v237, 14, v236
  v_min_u32 v236, v236, v237
  v_mul_u32_u24 v235, s37, v235
  v_lshl_add_u32 v235, v236, 4, v235
  v_add_u32 v235, s34, v235
  v_subrev_u32 v227, 2048, v235
  v_add_u32 v234, 192, v231
  v_mul_u32_u24 v235, s36, v234
  v_lshrrev_b32 v235, 16, v235
  v_mul_u32_u24 v236, 14, v235
  v_sub_u32 v236, v234, v236
  v_add_u32 v236, s39, v236
  v_subrev_u32 v237, 14, v236
  v_min_u32 v236, v236, v237
  v_mul_u32_u24 v235, s37, v235
  v_lshl_add_u32 v235, v236, 4, v235
  v_add_u32 v235, s34, v235
  v_subrev_u32 v228, 3072, v235
  s_mov_b32 s94, s30
  s_mov_b32 s95, s31
  s_mov_b32 s30, s92
  s_mov_b32 s31, s93
  s_mul_i32 s38, s3, 3584
  s_mov_b32 s17, 0
  s_cmp_lt_u32 s3, 2
  s_cselect_b32 s8, s60, s62
  s_cselect_b32 s9, s61, s63
  s_mov_b32 s10, 7340032
  s_mov_b32 s11, 0x20000
  s_waitcnt vmcnt(0)
  s_mov_b64 exec, 1
  buffer_store_dword v158, v46, s[64:67], s69 offen sc1
  s_mov_b64 exec, -1
  v_xor_b32 v168, s48, v250
  v_xor_b32 v169, s49, v251
  v_xor_b32 v170, s50, v252
  v_xor_b32 v171, s51, v253
  v_or3_b32 v172, v168, v169, v170
  v_or_b32 v172, v172, v171
  v_and_b32 v172, 0xff, v172
  v_cmp_ne_u32 vcc, 0, v172
  s_nop 1
  s_cmp_lg_u64 vcc, 0
  s_cbranch_scc1 L_vslow_11
L_vback_12:
  v_mov_b32 v172, v168
  v_mov_b32 v173, v169
  v_mov_b32 v174, v170
  v_mov_b32 v175, v171
  s_nop 1
  v_permlane16_swap_b32 v172, v168
  v_permlane16_swap_b32 v173, v169
  v_permlane16_swap_b32 v174, v170
  v_permlane16_swap_b32 v175, v171
  s_nop 1
  v_add_f32 v168, v168, v172
  v_add_f32 v169, v169, v173
  v_add_f32 v170, v170, v174
  v_add_f32 v171, v171, v175
  v_mov_b32 v172, v168
  v_mov_b32 v173, v169
  v_mov_b32 v174, v170
  v_mov_b32 v175, v171
  s_nop 1
  v_permlane32_swap_b32 v172, v168
  v_permlane32_swap_b32 v173, v169
  v_permlane32_swap_b32 v174, v170
  v_permlane32_swap_b32 v175, v171
  s_nop 1
  v_add_f32 v168, v168, v172
  v_add_f32 v169, v169, v173
  v_add_f32 v170, v170, v174
  v_add_f32 v171, v171, v175
  v_cvt_pk_bf16_f32 v172, v168, v169
  v_lshlrev_b32 v168, 16, v172
  v_and_b32 v169, 0xffff0000, v172
  v_cvt_pk_bf16_f32 v173, v170, v171
  v_lshlrev_b32 v170, 16, v173
  v_and_b32 v171, 0xffff0000, v173
  s_cmp_eq_u32 s3, 2
  s_cselect_b32 s33, 1.0, 0
  v_add_f32 v168, s33, v168
  v_add_f32 v169, s33, v169
  v_add_f32 v170, s33, v170
  v_add_f32 v171, s33, v171
  v_cvt_pk_bf16_f32 v172, v168, v169
  v_lshlrev_b32 v168, 16, v172
  v_and_b32 v169, 0xffff0000, v172
  v_cvt_pk_bf16_f32 v173, v170, v171
  v_lshlrev_b32 v170, 16, v173
  v_and_b32 v171, 0xffff0000, v173
  v_lshlrev_b32 v172, 4, v44
  s_lshl_b32 s33, s3, 8
  s_add_u32 s33, s33, 162816
  v_add_u32 v172, s33, v172
  ds_write_b128 v172, v[168:171]
  v_lshrrev_b32 v82, 2, v32
  v_lshlrev_b32 v82, 7, v82
  v_bfe_u32 v81, v32, 3, 2
  v_lshl_add_u32 v82, v81, 5, v82
  v_and_b32 v81, 3, v32
  v_lshl_add_u32 v35, v81, 3, v82
  v_xor_b32 v36, 32, v35
  v_xor_b32 v37, 64, v35
  v_xor_b32 v38, 96, v35
  v_add_u32 v39, 65536, v35
  v_add_u32 v40, 65536, v36
  v_add_u32 v41, 65536, v37
  v_add_u32 v42, 65536, v38
  v_lshrrev_b32 v47, 4, v32
  v_lshlrev_b32 v46, 4, v47
  v_add_u32 v253, 162816, v46
  s_waitcnt lgkmcnt(0)
  s_waitcnt vmcnt(63)
  s_barrier
  ds_read_b64_tr_b16 v[88:89], v35 offset:0
  ds_read_b64_tr_b16 v[90:91], v35 offset:2048
  ds_read_b64_tr_b16 v[92:93], v36 offset:0
  ds_read_b64_tr_b16 v[94:95], v36 offset:2048
  ds_read_b64_tr_b16 v[96:97], v37 offset:0
  ds_read_b64_tr_b16 v[98:99], v37 offset:2048
  ds_read_b64_tr_b16 v[100:101], v38 offset:0
  ds_read_b64_tr_b16 v[102:103], v38 offset:2048
  ds_read_b64_tr_b16 v[104:105], v35 offset:4096
  ds_read_b64_tr_b16 v[106:107], v35 offset:6144
  ds_read_b64_tr_b16 v[108:109], v36 offset:4096
  ds_read_b64_tr_b16 v[110:111], v36 offset:6144
  ds_read_b64_tr_b16 v[112:113], v37 offset:4096
  ds_read_b64_tr_b16 v[114:115], v37 offset:6144
  ds_read_b64_tr_b16 v[116:117], v38 offset:4096
  ds_read_b64_tr_b16 v[118:119], v38 offset:6144
  ds_read_b128 v[64:67], v253 offset:0
  ds_read_b128 v[68:71], v253 offset:64
  ds_read_b128 v[72:75], v253 offset:128
  ds_read_b128 v[76:79], v253 offset:192
  ds_read_b128 v[168:171], v253 offset:256
  ds_read_b128 v[172:175], v253 offset:320
  ds_read_b128 v[176:179], v253 offset:384
  ds_read_b128 v[180:183], v253 offset:448
  ds_read_b128 v[184:187], v253 offset:512
  ds_read_b128 v[188:191], v253 offset:576
  ds_read_b128 v[192:195], v253 offset:640
  ds_read_b128 v[196:199], v253 offset:704
  buffer_load_dword v87, v45, s[64:67], 0 offen sc1
  v_mov_b32 v252, v43
  v_accvgpr_read_b32 v48, a240
  v_accvgpr_read_b32 v49, a241
  v_accvgpr_read_b32 v50, a242
  v_accvgpr_read_b32 v51, a243
  v_accvgpr_read_b32 v52, a244
  v_accvgpr_read_b32 v53, a245
  v_accvgpr_read_b32 v54, a246
  v_accvgpr_read_b32 v55, a247
  v_accvgpr_read_b32 v56, a248
  v_accvgpr_read_b32 v57, a249
  v_accvgpr_read_b32 v58, a250
  v_accvgpr_read_b32 v59, a251
  v_accvgpr_read_b32 v60, a252
  v_accvgpr_read_b32 v61, a253
  v_accvgpr_read_b32 v62, a254
  v_accvgpr_read_b32 v63, a255
  s_lshl_b32 s41, s31, 18
  s_add_u32 s42, s41, 131072
  v_permlane16_swap_b32 v48, v50
  v_permlane16_swap_b32 v49, v51
  v_permlane16_swap_b32 v52, v54
  v_permlane16_swap_b32 v53, v55
  v_permlane16_swap_b32 v56, v58
  v_permlane16_swap_b32 v57, v59
  v_permlane16_swap_b32 v60, v62
  v_permlane16_swap_b32 v61, v63
  v_lshlrev_b32 v120, 16, v48
  v_and_b32 v121, 0xffff0000, v48
  v_lshlrev_b32 v122, 16, v49
  v_and_b32 v123, 0xffff0000, v49
  v_lshlrev_b32 v124, 16, v50
  v_and_b32 v125, 0xffff0000, v50
  v_lshlrev_b32 v126, 16, v51
  v_and_b32 v127, 0xffff0000, v51
  v_lshlrev_b32 v128, 16, v52
  v_and_b32 v129, 0xffff0000, v52
  v_lshlrev_b32 v130, 16, v53
  v_and_b32 v131, 0xffff0000, v53
  v_lshlrev_b32 v132, 16, v54
  v_and_b32 v133, 0xffff0000, v54
  v_lshlrev_b32 v134, 16, v55
  v_and_b32 v135, 0xffff0000, v55
  v_lshlrev_b32 v136, 16, v56
  v_and_b32 v137, 0xffff0000, v56
  v_lshlrev_b32 v138, 16, v57
  v_and_b32 v139, 0xffff0000, v57
  v_lshlrev_b32 v140, 16, v58
  v_and_b32 v141, 0xffff0000, v58
  v_lshlrev_b32 v142, 16, v59
  v_and_b32 v143, 0xffff0000, v59
  v_lshlrev_b32 v144, 16, v60
  v_and_b32 v145, 0xffff0000, v60
  v_lshlrev_b32 v146, 16, v61
  v_and_b32 v147, 0xffff0000, v61
  v_lshlrev_b32 v148, 16, v62
  v_and_b32 v149, 0xffff0000, v62
  v_lshlrev_b32 v150, 16, v63
  v_and_b32 v151, 0xffff0000, v63
  s_add_u32 s52, s20, 0x180000
  s_addc_u32 s53, s21, 0
  s_mov_b32 s54, 0x80000
  s_mov_b32 s55, 0x20000
  s_lshl_b32 s56, s30, 15
  s_lshl_b32 s57, s3, 9
  s_add_u32 s56, s56, s57
  s_add_u32 s58, s56, 4096
  s_lshl_b32 s57, s31, 11
  s_add_u32 s57, s57, s56
  v_lshlrev_b32 v81, 13, v47
  v_lshl_add_u32 v81, v44, 4, v81
  v_cmp_gt_u32 s[34:35], 16, v32
  s_mov_b32 s33, 262144
L_spin_15:
  s_waitcnt vmcnt(0)
  v_cmp_ne_u32 vcc, s19, v87
  s_nop 1
  s_and_b32 s32, vcc_lo, 0x7f7
  s_cbranch_scc0 L_rdy_16
  buffer_load_dword v87, v45, s[64:67], 0 offen sc1
  s_sub_u32 s33, s33, 1
  s_cmp_lg_u32 s33, 0
  s_cbranch_scc1 L_spin_15
L_rdy_16:
  s_mov_b32 s16, 0
  buffer_load_dwordx4 a[0:3], v33, s[4:7], s16 offen offset:0 sc1
  buffer_load_dwordx4 a[4:7], v33, s[4:7], s16 offen offset:1024 sc1
  buffer_load_dwordx4 a[8:11], v34, s[4:7], s16 offen offset:0 sc1
  buffer_load_dwordx4 a[12:15], v34, s[4:7], s16 offen offset:1024 sc1
  s_mov_b32 s16, 262144
  buffer_load_dwordx4 a[16:19], v33, s[4:7], s16 offen offset:0 sc1
  buffer_load_dwordx4 a[20:23], v33, s[4:7], s16 offen offset:1024 sc1
  buffer_load_dwordx4 a[24:27], v34, s[4:7], s16 offen offset:0 sc1
  buffer_load_dwordx4 a[28:31], v34, s[4:7], s16 offen offset:1024 sc1
  s_mov_b32 s16, 524288
  buffer_load_dwordx4 a[32:35], v33, s[4:7], s16 offen offset:0 sc1
  buffer_load_dwordx4 a[36:39], v33, s[4:7], s16 offen offset:1024 sc1
  buffer_load_dwordx4 a[40:43], v34, s[4:7], s16 offen offset:0 sc1
  buffer_load_dwordx4 a[44:47], v34, s[4:7], s16 offen offset:1024 sc1
  s_mov_b32 s16, 1048576
  buffer_load_dwordx4 a[48:51], v33, s[4:7], s16 offen offset:0 sc1
  buffer_load_dwordx4 a[52:55], v33, s[4:7], s16 offen offset:1024 sc1
  buffer_load_dwordx4 a[56:59], v34, s[4:7], s16 offen offset:0 sc1
  buffer_load_dwordx4 a[60:63], v34, s[4:7], s16 offen offset:1024 sc1
  s_waitcnt vmcnt(12) lgkmcnt(10)
  v_mfma_f32_16x16x32_bf16 v[0:3], v[88:91], a[0:3], 0
  s_mov_b32 s16, 1310720
  v_mfma_f32_16x16x32_bf16 v[16:19], v[88:91], a[4:7], 0
  ds_read_b64_tr_b16 v[88:89], v35 offset:8192
  ds_read_b64_tr_b16 v[90:91], v35 offset:10240
  v_mfma_f32_16x16x32_bf16 v[4:7], v[92:95], a[0:3], 0
  v_mfma_f32_16x16x32_bf16 v[20:23], v[92:95], a[4:7], 0
  buffer_load_dwordx4 a[64:67], v33, s[4:7], s16 offen offset:0 sc1
  v_mfma_f32_16x16x32_bf16 v[8:11], v[96:99], a[0:3], 0
  ds_read_b64_tr_b16 v[92:93], v36 offset:8192
  ds_read_b64_tr_b16 v[94:95], v36 offset:10240
  v_mfma_f32_16x16x32_bf16 v[24:27], v[96:99], a[4:7], 0
  ds_read_b64_tr_b16 v[96:97], v37 offset:8192
  ds_read_b64_tr_b16 v[98:99], v37 offset:10240
  v_mfma_f32_16x16x32_bf16 v[12:15], v[100:103], a[0:3], 0
  buffer_load_dwordx4 a[68:71], v33, s[4:7], s16 offen offset:1024 sc1
  v_mfma_f32_16x16x32_bf16 v[28:31], v[100:103], a[4:7], 0
  ds_read_b64_tr_b16 v[100:101], v38 offset:8192
  ds_read_b64_tr_b16 v[102:103], v38 offset:10240
  v_mfma_f32_16x16x32_bf16 v[0:3], v[104:107], a[8:11], v[0:3]
  v_mfma_f32_16x16x32_bf16 v[16:19], v[104:107], a[12:15], v[16:19]
  buffer_load_dwordx4 a[72:75], v34, s[4:7], s16 offen offset:0 sc1
  v_mfma_f32_16x16x32_bf16 v[4:7], v[108:111], a[8:11], v[4:7]
  ds_read_b64_tr_b16 v[104:105], v35 offset:12288
  ds_read_b64_tr_b16 v[106:107], v35 offset:14336
  v_mfma_f32_16x16x32_bf16 v[20:23], v[108:111], a[12:15], v[20:23]
  ds_read_b64_tr_b16 v[108:109], v36 offset:12288
  ds_read_b64_tr_b16 v[110:111], v36 offset:14336
  v_mfma_f32_16x16x32_bf16 v[8:11], v[112:115], a[8:11], v[8:11]
  buffer_load_dwordx4 a[76:79], v34, s[4:7], s16 offen offset:1024 sc1
  v_mfma_f32_16x16x32_bf16 v[24:27], v[112:115], a[12:15], v[24:27]
  ds_read_b64_tr_b16 v[112:113], v37 offset:12288
  ds_read_b64_tr_b16 v[114:115], v37 offset:14336
  v_mfma_f32_16x16x32_bf16 v[12:15], v[116:119], a[8:11], v[12:15]
  v_mfma_f32_16x16x32_bf16 v[28:31], v[116:119], a[12:15], v[28:31]
  s_waitcnt vmcnt(12) lgkmcnt(10)
  ds_read_b64_tr_b16 v[116:117], v38 offset:12288
  v_mfma_f32_16x16x32_bf16 v[0:3], v[88:91], a[16:19], v[0:3]
  ds_read_b64_tr_b16 v[118:119], v38 offset:14336
  s_mov_b32 s16, 1572864
  v_mfma_f32_16x16x32_bf16 v[16:19], v[88:91], a[20:23], v[16:19]
  ds_read_b64_tr_b16 v[88:89], v35 offset:16384
  ds_read_b64_tr_b16 v[90:91], v35 offset:18432
  v_mfma_f32_16x16x32_bf16 v[4:7], v[92:95], a[16:19], v[4:7]
  v_mfma_f32_16x16x32_bf16 v[20:23], v[92:95], a[20:23], v[20:23]
  buffer_load_dwordx4 a[80:83], v33, s[4:7], s16 offen offset:0 sc1
  s_waitcnt lgkmcnt(10)
  v_mfma_f32_16x16x32_bf16 v[8:11], v[96:99], a[16:19], v[8:11]
  ds_read_b64_tr_b16 v[92:93], v36 offset:16384
  ds_read_b64_tr_b16 v[94:95], v36 offset:18432
  v_mfma_f32_16x16x32_bf16 v[24:27], v[96:99], a[20:23], v[24:27]
  ds_read_b64_tr_b16 v[96:97], v37 offset:16384
  ds_read_b64_tr_b16 v[98:99], v37 offset:18432
  v_mfma_f32_16x16x32_bf16 v[12:15], v[100:103], a[16:19], v[12:15]
  buffer_load_dwordx4 a[84:87], v33, s[4:7], s16 offen offset:1024 sc1
  v_mfma_f32_16x16x32_bf16 v[28:31], v[100:103], a[20:23], v[28:31]
  ds_read_b64_tr_b16 v[100:101], v38 offset:16384
  ds_read_b64_tr_b16 v[102:103], v38 offset:18432
  s_waitcnt lgkmcnt(10)
  v_mfma_f32_16x16x32_bf16 v[0:3], v[104:107], a[24:27], v[0:3]
  v_mfma_f32_16x16x32_bf16 v[16:19], v[104:107], a[28:31], v[16:19]
  buffer_load_dwordx4 a[88:91], v34, s[4:7], s16 offen offset:0 sc1
  v_mfma_f32_16x16x32_bf16 v[4:7], v[108:111], a[24:27], v[4:7]
  ds_read_b64_tr_b16 v[104:105], v35 offset:20480
  ds_read_b64_tr_b16 v[106:107], v35 offset:22528
  v_mfma_f32_16x16x32_bf16 v[20:23], v[108:111], a[28:31], v[20:23]
  ds_read_b64_tr_b16 v[108:109], v36 offset:20480
  ds_read_b64_tr_b16 v[110:111], v36 offset:22528
  v_mfma_f32_16x16x32_bf16 v[8:11], v[112:115], a[24:27], v[8:11]
  buffer_load_dwordx4 a[92:95], v34, s[4:7], s16 offen offset:1024 sc1
  v_mfma_f32_16x16x32_bf16 v[24:27], v[112:115], a[28:31], v[24:27]
  ds_read_b64_tr_b16 v[112:113], v37 offset:20480
  ds_read_b64_tr_b16 v[114:115], v37 offset:22528
  s_waitcnt lgkmcnt(10)
  v_mfma_f32_16x16x32_bf16 v[12:15], v[116:119], a[24:27], v[12:15]
  v_mfma_f32_16x16x32_bf16 v[28:31], v[116:119], a[28:31], v[28:31]
  s_waitcnt vmcnt(12) lgkmcnt(10)
  ds_read_b64_tr_b16 v[116:117], v38 offset:20480
  v_mfma_f32_16x16x32_bf16 v[0:3], v[88:91], a[32:35], v[0:3]
  ds_read_b64_tr_b16 v[118:119], v38 offset:22528
  s_mov_b32 s16, 1835008
  v_mfma_f32_16x16x32_bf16 v[16:19], v[88:91], a[36:39], v[16:19]
  ds_read_b64_tr_b16 v[88:89], v35 offset:24576
  ds_read_b64_tr_b16 v[90:91], v35 offset:26624
  v_mfma_f32_16x16x32_bf16 v[4:7], v[92:95], a[32:35], v[4:7]
  v_mfma_f32_16x16x32_bf16 v[20:23], v[92:95], a[36:39], v[20:23]
  buffer_load_dwordx4 a[96:99], v33, s[4:7], s16 offen offset:0 sc1
  s_waitcnt lgkmcnt(10)
  v_mfma_f32_16x16x32_bf16 v[8:11], v[96:99], a[32:35], v[8:11]
  ds_read_b64_tr_b16 v[92:93], v36 offset:24576
  ds_read_b64_tr_b16 v[94:95], v36 offset:26624
  v_mfma_f32_16x16x32_bf16 v[24:27], v[96:99], a[36:39], v[24:27]
  ds_read_b64_tr_b16 v[96:97], v37 offset:24576
  ds_read_b64_tr_b16 v[98:99], v37 offset:26624
  v_mfma_f32_16x16x32_bf16 v[12:15], v[100:103], a[32:35], v[12:15]
  buffer_load_dwordx4 a[100:103], v33, s[4:7], s16 offen offset:1024 sc1
  v_mfma_f32_16x16x32_bf16 v[28:31], v[100:103], a[36:39], v[28:31]
  ds_read_b64_tr_b16 v[100:101], v38 offset:24576
  ds_read_b64_tr_b16 v[102:103], v38 offset:26624
  s_waitcnt lgkmcnt(10)
  v_mfma_f32_16x16x32_bf16 v[0:3], v[104:107], a[40:43], v[0:3]
  v_mfma_f32_16x16x32_bf16 v[16:19], v[104:107], a[44:47], v[16:19]
  buffer_load_dwordx4 a[104:107], v34, s[4:7], s16 offen offset:0 sc1
  v_mfma_f32_16x16x32_bf16 v[4:7], v[108:111], a[40:43], v[4:7]
  ds_read_b64_tr_b16 v[104:105], v35 offset:28672
  ds_read_b64_tr_b16 v[106:107], v35 offset:30720
  v_mfma_f32_16x16x32_bf16 v[20:23], v[108:111], a[44:47], v[20:23]
  ds_read_b64_tr_b16 v[108:109], v36 offset:28672
  ds_read_b64_tr_b16 v[110:111], v36 offset:30720
  v_mfma_f32_16x16x32_bf16 v[8:11], v[112:115], a[40:43], v[8:11]
  buffer_load_dwordx4 a[108:111], v34, s[4:7], s16 offen offset:1024 sc1
  v_mfma_f32_16x16x32_bf16 v[24:27], v[112:115], a[44:47], v[24:27]
  ds_read_b64_tr_b16 v[112:113], v37 offset:28672
  ds_read_b64_tr_b16 v[114:115], v37 offset:30720
  s_waitcnt lgkmcnt(10)
  v_mfma_f32_16x16x32_bf16 v[12:15], v[116:119], a[40:43], v[12:15]
  v_mfma_f32_16x16x32_bf16 v[28:31], v[116:119], a[44:47], v[28:31]
  s_waitcnt vmcnt(12) lgkmcnt(10)
  ds_read_b64_tr_b16 v[116:117], v38 offset:28672
  v_mfma_f32_16x16x32_bf16 v[0:3], v[88:91], a[48:51], v[0:3]
  ds_read_b64_tr_b16 v[118:119], v38 offset:30720
  s_mov_b32 s16, 2097152
  v_mfma_f32_16x16x32_bf16 v[16:19], v[88:91], a[52:55], v[16:19]
  ds_read_b64_tr_b16 v[88:89], v35 offset:32768
  ds_read_b64_tr_b16 v[90:91], v35 offset:34816
  v_mfma_f32_16x16x32_bf16 v[4:7], v[92:95], a[48:51], v[4:7]
  v_mfma_f32_16x16x32_bf16 v[20:23], v[92:95], a[52:55], v[20:23]
  buffer_load_dwordx4 a[112:115], v33, s[4:7], s16 offen offset:0 sc1
  s_waitcnt lgkmcnt(10)
  v_mfma_f32_16x16x32_bf16 v[8:11], v[96:99], a[48:51], v[8:11]
  ds_read_b64_tr_b16 v[92:93], v36 offset:32768
  ds_read_b64_tr_b16 v[94:95], v36 offset:34816
  v_mfma_f32_16x16x32_bf16 v[24:27], v[96:99], a[52:55], v[24:27]
  ds_read_b64_tr_b16 v[96:97], v37 offset:32768
  ds_read_b64_tr_b16 v[98:99], v37 offset:34816
  v_mfma_f32_16x16x32_bf16 v[12:15], v[100:103], a[48:51], v[12:15]
  buffer_load_dwordx4 a[116:119], v33, s[4:7], s16 offen offset:1024 sc1
  v_mfma_f32_16x16x32_bf16 v[28:31], v[100:103], a[52:55], v[28:31]
  ds_read_b64_tr_b16 v[100:101], v38 offset:32768
  ds_read_b64_tr_b16 v[102:103], v38 offset:34816
  s_waitcnt lgkmcnt(10)
  v_mfma_f32_16x16x32_bf16 v[0:3], v[104:107], a[56:59], v[0:3]
  v_mfma_f32_16x16x32_bf16 v[16:19], v[104:107], a[60:63], v[16:19]
  buffer_load_dwordx4 a[120:123], v34, s[4:7], s16 offen offset:0 sc1
  v_mfma_f32_16x16x32_bf16 v[4:7], v[108:111], a[56:59], v[4:7]
  ds_read_b64_tr_b16 v[104:105], v35 offset:36864
  ds_read_b64_tr_b16 v[106:107], v35 offset:38912
  v_mfma_f32_16x16x32_bf16 v[20:23], v[108:111], a[60:63], v[20:23]
  ds_read_b64_tr_b16 v[108:109], v36 offset:36864
  ds_read_b64_tr_b16 v[110:111], v36 offset:38912
  v_mfma_f32_16x16x32_bf16 v[8:11], v[112:115], a[56:59], v[8:11]
  buffer_load_dwordx4 a[124:127], v34, s[4:7], s16 offen offset:1024 sc1
  v_mfma_f32_16x16x32_bf16 v[24:27], v[112:115], a[60:63], v[24:27]
  ds_read_b64_tr_b16 v[112:113], v37 offset:36864
  ds_read_b64_tr_b16 v[114:115], v37 offset:38912
  s_waitcnt lgkmcnt(10)
  v_mfma_f32_16x16x32_bf16 v[12:15], v[116:119], a[56:59], v[12:15]
  v_mfma_f32_16x16x32_bf16 v[28:31], v[116:119], a[60:63], v[28:31]
  s_waitcnt vmcnt(12) lgkmcnt(10)
  ds_read_b64_tr_b16 v[116:117], v38 offset:36864
  v_mfma_f32_16x16x32_bf16 v[0:3], v[88:91], a[64:67], v[0:3]
  ds_read_b64_tr_b16 v[118:119], v38 offset:38912
  s_mov_b32 s16, 2359296
  v_mfma_f32_16x16x32_bf16 v[16:19], v[88:91], a[68:71], v[16:19]
  ds_read_b64_tr_b16 v[88:89], v35 offset:40960
  ds_read_b64_tr_b16 v[90:91], v35 offset:43008
  v_mfma_f32_16x16x32_bf16 v[4:7], v[92:95], a[64:67], v[4:7]
  v_mfma_f32_16x16x32_bf16 v[20:23], v[92:95], a[68:71], v[20:23]
  buffer_load_dwordx4 a[128:131], v33, s[4:7], s16 offen offset:0 sc1
  s_waitcnt lgkmcnt(10)
  v_mfma_f32_16x16x32_bf16 v[8:11], v[96:99], a[64:67], v[8:11]
  ds_read_b64_tr_b16 v[92:93], v36 offset:40960
  ds_read_b64_tr_b16 v[94:95], v36 offset:43008
  v_mfma_f32_16x16x32_bf16 v[24:27], v[96:99], a[68:71], v[24:27]
  ds_read_b64_tr_b16 v[96:97], v37 offset:40960
  ds_read_b64_tr_b16 v[98:99], v37 offset:43008
  v_mfma_f32_16x16x32_bf16 v[12:15], v[100:103], a[64:67], v[12:15]
  buffer_load_dwordx4 a[132:135], v33, s[4:7], s16 offen offset:1024 sc1
  v_mfma_f32_16x16x32_bf16 v[28:31], v[100:103], a[68:71], v[28:31]
  ds_read_b64_tr_b16 v[100:101], v38 offset:40960
  ds_read_b64_tr_b16 v[102:103], v38 offset:43008
  s_waitcnt lgkmcnt(10)
  v_mfma_f32_16x16x32_bf16 v[0:3], v[104:107], a[72:75], v[0:3]
  v_mfma_f32_16x16x32_bf16 v[16:19], v[104:107], a[76:79], v[16:19]
  buffer_load_dwordx4 a[136:139], v34, s[4:7], s16 offen offset:0 sc1
  v_mfma_f32_16x16x32_bf16 v[4:7], v[108:111], a[72:75], v[4:7]
  ds_read_b64_tr_b16 v[104:105], v35 offset:45056
  ds_read_b64_tr_b16 v[106:107], v35 offset:47104
  v_mfma_f32_16x16x32_bf16 v[20:23], v[108:111], a[76:79], v[20:23]
  ds_read_b64_tr_b16 v[108:109], v36 offset:45056
  ds_read_b64_tr_b16 v[110:111], v36 offset:47104
  v_mfma_f32_16x16x32_bf16 v[8:11], v[112:115], a[72:75], v[8:11]
  buffer_load_dwordx4 a[140:143], v34, s[4:7], s16 offen offset:1024 sc1
  v_mfma_f32_16x16x32_bf16 v[24:27], v[112:115], a[76:79], v[24:27]
  ds_read_b64_tr_b16 v[112:113], v37 offset:45056
  ds_read_b64_tr_b16 v[114:115], v37 offset:47104
  s_waitcnt lgkmcnt(10)
  v_mfma_f32_16x16x32_bf16 v[12:15], v[116:119], a[72:75], v[12:15]
  v_mfma_f32_16x16x32_bf16 v[28:31], v[116:119], a[76:79], v[28:31]
  s_waitcnt vmcnt(12) lgkmcnt(10)
  buffer_load_dword v87, v45, s[64:67], 0 offen sc1
  v_mfma_f32_16x16x32_bf16 v[0:3], v[88:91], a[80:83], v[0:3]
  ds_read_b64_tr_b16 v[116:117], v38 offset:45056
  s_mov_b32 s16, 2621440
  v_mfma_f32_16x16x32_bf16 v[16:19], v[88:91], a[84:87], v[16:19]
  ds_read_b64_tr_b16 v[118:119], v38 offset:47104
  ds_read_b64_tr_b16 v[88:89], v35 offset:49152
  v_mfma_f32_16x16x32_bf16 v[4:7], v[92:95], a[80:83], v[4:7]
  ds_read_b64_tr_b16 v[90:91], v35 offset:51200
  v_mfma_f32_16x16x32_bf16 v[20:23], v[92:95], a[84:87], v[20:23]
  buffer_load_dwordx4 a[144:147], v33, s[4:7], s16 offen offset:0 sc1
  s_waitcnt lgkmcnt(10)
  v_mfma_f32_16x16x32_bf16 v[8:11], v[96:99], a[80:83], v[8:11]
  ds_read_b64_tr_b16 v[92:93], v36 offset:49152
  ds_read_b64_tr_b16 v[94:95], v36 offset:51200
  v_mfma_f32_16x16x32_bf16 v[24:27], v[96:99], a[84:87], v[24:27]
  ds_read_b64_tr_b16 v[96:97], v37 offset:49152
  ds_read_b64_tr_b16 v[98:99], v37 offset:51200
  v_mfma_f32_16x16x32_bf16 v[12:15], v[100:103], a[80:83], v[12:15]
  buffer_load_dwordx4 a[148:151], v33, s[4:7], s16 offen offset:1024 sc1
  v_mfma_f32_16x16x32_bf16 v[28:31], v[100:103], a[84:87], v[28:31]
  ds_read_b64_tr_b16 v[100:101], v38 offset:49152
  ds_read_b64_tr_b16 v[102:103], v38 offset:51200
  s_waitcnt lgkmcnt(10)
  v_mfma_f32_16x16x32_bf16 v[0:3], v[104:107], a[88:91], v[0:3]
  v_mfma_f32_16x16x32_bf16 v[16:19], v[104:107], a[92:95], v[16:19]
  buffer_load_dwordx4 a[152:155], v34, s[4:7], s16 offen offset:0 sc1
  v_mfma_f32_16x16x32_bf16 v[4:7], v[108:111], a[88:91], v[4:7]
  ds_read_b64_tr_b16 v[104:105], v35 offset:53248
  ds_read_b64_tr_b16 v[106:107], v35 offset:55296
  v_mfma_f32_16x16x32_bf16 v[20:23], v[108:111], a[92:95], v[20:23]
  ds_read_b64_tr_b16 v[108:109], v36 offset:53248
  ds_read_b64_tr_b16 v[110:111], v36 offset:55296
  v_mfma_f32_16x16x32_bf16 v[8:11], v[112:115], a[88:91], v[8:11]
  buffer_load_dwordx4 a[156:159], v34, s[4:7], s16 offen offset:1024 sc1
  v_mfma_f32_16x16x32_bf16 v[24:27], v[112:115], a[92:95], v[24:27]
  ds_read_b64_tr_b16 v[112:113], v37 offset:53248
  ds_read_b64_tr_b16 v[114:115], v37 offset:55296
  s_waitcnt lgkmcnt(10)
  v_mfma_f32_16x16x32_bf16 v[12:15], v[116:119], a[88:91], v[12:15]
  v_mfma_f32_16x16x32_bf16 v[28:31], v[116:119], a[92:95], v[28:31]
  s_waitcnt vmcnt(4) lgkmcnt(10)
  v_cmp_ne_u32 vcc, s19, v87
  s_nop 1
  s_cmp_lg_u64 vcc, 0
  s_cbranch_scc1 L_slow_13
  L_back_14:
  v_mfma_f32_16x16x32_bf16 v[0:3], v[88:91], a[96:99], v[0:3]
  ds_read_b64_tr_b16 v[116:117], v38 offset:53248
  s_mov_b32 s16, 3145728
  v_mfma_f32_16x16x32_bf16 v[16:19], v[88:91], a[100:103], v[16:19]
  ds_read_b64_tr_b16 v[118:119], v38 offset:55296
  ds_read_b64_tr_b16 v[88:89], v35 offset:57344
  v_mfma_f32_16x16x32_bf16 v[4:7], v[92:95], a[96:99], v[4:7]
  ds_read_b64_tr_b16 v[90:91], v35 offset:59392
  v_mfma_f32_16x16x32_bf16 v[20:23], v[92:95], a[100:103], v[20:23]
  buffer_load_dwordx4 a[160:163], v33, s[4:7], s16 offen offset:0 sc1
  s_waitcnt lgkmcnt(10)
  v_mfma_f32_16x16x32_bf16 v[8:11], v[96:99], a[96:99], v[8:11]
  ds_read_b64_tr_b16 v[92:93], v36 offset:57344
  ds_read_b64_tr_b16 v[94:95], v36 offset:59392
  v_mfma_f32_16x16x32_bf16 v[24:27], v[96:99], a[100:103], v[24:27]
  ds_read_b64_tr_b16 v[96:97], v37 offset:57344
  ds_read_b64_tr_b16 v[98:99], v37 offset:59392
  v_mfma_f32_16x16x32_bf16 v[12:15], v[100:103], a[96:99], v[12:15]
  buffer_load_dwordx4 a[164:167], v33, s[4:7], s16 offen offset:1024 sc1
  v_mfma_f32_16x16x32_bf16 v[28:31], v[100:103], a[100:103], v[28:31]
  ds_read_b64_tr_b16 v[100:101], v38 offset:57344
  ds_read_b64_tr_b16 v[102:103], v38 offset:59392
  s_waitcnt lgkmcnt(10)
  v_mfma_f32_16x16x32_bf16 v[0:3], v[104:107], a[104:107], v[0:3]
  v_mfma_f32_16x16x32_bf16 v[16:19], v[104:107], a[108:111], v[16:19]
  buffer_load_dwordx4 a[168:171], v34, s[4:7], s16 offen offset:0 sc1
  v_mfma_f32_16x16x32_bf16 v[4:7], v[108:111], a[104:107], v[4:7]
  ds_read_b64_tr_b16 v[104:105], v35 offset:61440
  ds_read_b64_tr_b16 v[106:107], v35 offset:63488
  v_mfma_f32_16x16x32_bf16 v[20:23], v[108:111], a[108:111], v[20:23]
  ds_read_b64_tr_b16 v[108:109], v36 offset:61440
  ds_read_b64_tr_b16 v[110:111], v36 offset:63488
  v_mfma_f32_16x16x32_bf16 v[8:11], v[112:115], a[104:107], v[8:11]
  buffer_load_dwordx4 a[172:175], v34, s[4:7], s16 offen offset:1024 sc1
  v_mfma_f32_16x16x32_bf16 v[24:27], v[112:115], a[108:111], v[24:27]
  ds_read_b64_tr_b16 v[112:113], v37 offset:61440
  ds_read_b64_tr_b16 v[114:115], v37 offset:63488
  s_waitcnt lgkmcnt(10)
  v_mfma_f32_16x16x32_bf16 v[12:15], v[116:119], a[104:107], v[12:15]
  v_mfma_f32_16x16x32_bf16 v[28:31], v[116:119], a[108:111], v[28:31]
  s_waitcnt vmcnt(13) lgkmcnt(10)
  ds_read_b64_tr_b16 v[116:117], v38 offset:61440
  v_mfma_f32_16x16x32_bf16 v[0:3], v[88:91], a[112:115], v[0:3]
  ds_read_b64_tr_b16 v[118:119], v38 offset:63488
  s_mov_b32 s16, 3407872
  v_mfma_f32_16x16x32_bf16 v[16:19], v[88:91], a[116:119], v[16:19]
  ds_read_b64_tr_b16 v[88:89], v39 offset:0
  ds_read_b64_tr_b16 v[90:91], v39 offset:2048
  v_mfma_f32_16x16x32_bf16 v[4:7], v[92:95], a[112:115], v[4:7]
  v_mfma_f32_16x16x32_bf16 v[20:23], v[92:95], a[116:119], v[20:23]
  buffer_load_dwordx4 a[176:179], v33, s[4:7], s16 offen offset:0 sc1
  s_waitcnt lgkmcnt(10)
  v_mfma_f32_16x16x32_bf16 v[8:11], v[96:99], a[112:115], v[8:11]
  ds_read_b64_tr_b16 v[92:93], v40 offset:0
  ds_read_b64_tr_b16 v[94:95], v40 offset:2048
  v_mfma_f32_16x16x32_bf16 v[24:27], v[96:99], a[116:119], v[24:27]
  ds_read_b64_tr_b16 v[96:97], v41 offset:0
  ds_read_b64_tr_b16 v[98:99], v41 offset:2048
  v_mfma_f32_16x16x32_bf16 v[12:15], v[100:103], a[112:115], v[12:15]
  buffer_load_dwordx4 a[180:183], v33, s[4:7], s16 offen offset:1024 sc1
  v_mfma_f32_16x16x32_bf16 v[28:31], v[100:103], a[116:119], v[28:31]
  ds_read_b64_tr_b16 v[100:101], v42 offset:0
  ds_read_b64_tr_b16 v[102:103], v42 offset:2048
  s_waitcnt lgkmcnt(10)
  v_mfma_f32_16x16x32_bf16 v[0:3], v[104:107], a[120:123], v[0:3]
  v_mfma_f32_16x16x32_bf16 v[16:19], v[104:107], a[124:127], v[16:19]
  buffer_load_dwordx4 a[184:187], v34, s[4:7], s16 offen offset:0 sc1
  v_mfma_f32_16x16x32_bf16 v[4:7], v[108:111], a[120:123], v[4:7]
  ds_read_b64_tr_b16 v[104:105], v39 offset:4096
  ds_read_b64_tr_b16 v[106:107], v39 offset:6144
  v_mfma_f32_16x16x32_bf16 v[20:23], v[108:111], a[124:127], v[20:23]
  ds_read_b64_tr_b16 v[108:109], v40 offset:4096
  ds_read_b64_tr_b16 v[110:111], v40 offset:6144
  v_mfma_f32_16x16x32_bf16 v[8:11], v[112:115], a[120:123], v[8:11]
  buffer_load_dwordx4 a[188:191], v34, s[4:7], s16 offen offset:1024 sc1
  v_mfma_f32_16x16x32_bf16 v[24:27], v[112:115], a[124:127], v[24:27]
  ds_read_b64_tr_b16 v[112:113], v41 offset:4096
  ds_read_b64_tr_b16 v[114:115], v41 offset:6144
  s_waitcnt lgkmcnt(10)
  v_mfma_f32_16x16x32_bf16 v[12:15], v[116:119], a[120:123], v[12:15]
  v_mfma_f32_16x16x32_bf16 v[28:31], v[116:119], a[124:127], v[28:31]
  s_waitcnt vmcnt(13) lgkmcnt(10)
  ds_read_b64_tr_b16 v[116:117], v42 offset:4096
  v_mfma_f32_16x16x32_bf16 v[0:3], v[88:91], a[128:131], v[0:3]
  ds_read_b64_tr_b16 v[118:119], v42 offset:6144
  s_mov_b32 s16, 3670016
  v_mfma_f32_16x16x32_bf16 v[16:19], v[88:91], a[132:135], v[16:19]
  ds_read_b64_tr_b16 v[88:89], v39 offset:8192
  ds_read_b64_tr_b16 v[90:91], v39 offset:10240
  v_mfma_f32_16x16x32_bf16 v[4:7], v[92:95], a[128:131], v[4:7]
  v_mfma_f32_16x16x32_bf16 v[20:23], v[92:95], a[132:135], v[20:23]
  buffer_load_dwordx4 a[192:195], v33, s[4:7], s16 offen offset:0 sc1
  s_waitcnt lgkmcnt(10)
  v_mfma_f32_16x16x32_bf16 v[8:11], v[96:99], a[128:131], v[8:11]
  ds_read_b64_tr_b16 v[92:93], v40 offset:8192
  ds_read_b64_tr_b16 v[94:95], v40 offset:10240
  v_mfma_f32_16x16x32_bf16 v[24:27], v[96:99], a[132:135], v[24:27]
  ds_read_b64_tr_b16 v[96:97], v41 offset:8192
  ds_read_b64_tr_b16 v[98:99], v41 offset:10240
  v_mfma_f32_16x16x32_bf16 v[12:15], v[100:103], a[128:131], v[12:15]
  buffer_load_dwordx4 a[196:199], v33, s[4:7], s16 offen offset:1024 sc1
  v_mfma_f32_16x16x32_bf16 v[28:31], v[100:103], a[132:135], v[28:31]
  ds_read_b64_tr_b16 v[100:101], v42 offset:8192
  ds_read_b64_tr_b16 v[102:103], v42 offset:10240
  s_waitcnt lgkmcnt(10)
  v_mfma_f32_16x16x32_bf16 v[0:3], v[104:107], a[136:139], v[0:3]
  v_mfma_f32_16x16x32_bf16 v[16:19], v[104:107], a[140:143], v[16:19]
  buffer_load_dwordx4 a[200:203], v34, s[4:7], s16 offen offset:0 sc1
  v_mfma_f32_16x16x32_bf16 v[4:7], v[108:111], a[136:139], v[4:7]
  ds_read_b64_tr_b16 v[104:105], v39 offset:12288
  ds_read_b64_tr_b16 v[106:107], v39 offset:14336
  v_mfma_f32_16x16x32_bf16 v[20:23], v[108:111], a[140:143], v[20:23]
  ds_read_b64_tr_b16 v[108:109], v40 offset:12288
  ds_read_b64_tr_b16 v[110:111], v40 offset:14336
  v_mfma_f32_16x16x32_bf16 v[8:11], v[112:115], a[136:139], v[8:11]
  buffer_load_dwordx4 a[204:207], v34, s[4:7], s16 offen offset:1024 sc1
  v_mfma_f32_16x16x32_bf16 v[24:27], v[112:115], a[140:143], v[24:27]
  ds_read_b64_tr_b16 v[112:113], v41 offset:12288
  ds_read_b64_tr_b16 v[114:115], v41 offset:14336
  s_waitcnt lgkmcnt(10)
  v_mfma_f32_16x16x32_bf16 v[12:15], v[116:119], a[136:139], v[12:15]
  v_mfma_f32_16x16x32_bf16 v[28:31], v[116:119], a[140:143], v[28:31]
  s_waitcnt vmcnt(12) lgkmcnt(10)
  ds_read_b64_tr_b16 v[116:117], v42 offset:12288
  v_mfma_f32_16x16x32_bf16 v[0:3], v[88:91], a[144:147], v[0:3]
  ds_read_b64_tr_b16 v[118:119], v42 offset:14336
  s_mov_b32 s16, 3932160
  v_mfma_f32_16x16x32_bf16 v[16:19], v[88:91], a[148:151], v[16:19]
  ds_read_b64_tr_b16 v[88:89], v39 offset:16384
  ds_read_b64_tr_b16 v[90:91], v39 offset:18432
  v_mfma_f32_16x16x32_bf16 v[4:7], v[92:95], a[144:147], v[4:7]
  v_mfma_f32_16x16x32_bf16 v[20:23], v[92:95], a[148:151], v[20:23]
  buffer_load_dwordx4 a[208:211], v33, s[4:7], s16 offen offset:0 sc1
  s_waitcnt lgkmcnt(10)
  v_mfma_f32_16x16x32_bf16 v[8:11], v[96:99], a[144:147], v[8:11]
  ds_read_b64_tr_b16 v[92:93], v40 offset:16384
  ds_read_b64_tr_b16 v[94:95], v40 offset:18432
  v_mfma_f32_16x16x32_bf16 v[24:27], v[96:99], a[148:151], v[24:27]
  ds_read_b64_tr_b16 v[96:97], v41 offset:16384
  ds_read_b64_tr_b16 v[98:99], v41 offset:18432
  v_mfma_f32_16x16x32_bf16 v[12:15], v[100:103], a[144:147], v[12:15]
  buffer_load_dwordx4 a[212:215], v33, s[4:7], s16 offen offset:1024 sc1
  v_mfma_f32_16x16x32_bf16 v[28:31], v[100:103], a[148:151], v[28:31]
  ds_read_b64_tr_b16 v[100:101], v42 offset:16384
  ds_read_b64_tr_b16 v[102:103], v42 offset:18432
  s_waitcnt lgkmcnt(10)
  v_mfma_f32_16x16x32_bf16 v[0:3], v[104:107], a[152:155], v[0:3]
  v_mfma_f32_16x16x32_bf16 v[16:19], v[104:107], a[156:159], v[16:19]
  buffer_load_dwordx4 a[216:219], v34, s[4:7], s16 offen offset:0 sc1
  v_mfma_f32_16x16x32_bf16 v[4:7], v[108:111], a[152:155], v[4:7]
  ds_read_b64_tr_b16 v[104:105], v39 offset:20480
  ds_read_b64_tr_b16 v[106:107], v39 offset:22528
  v_mfma_f32_16x16x32_bf16 v[20:23], v[108:111], a[156:159], v[20:23]
  ds_read_b64_tr_b16 v[108:109], v40 offset:20480
  ds_read_b64_tr_b16 v[110:111], v40 offset:22528
  v_mfma_f32_16x16x32_bf16 v[8:11], v[112:115], a[152:155], v[8:11]
  buffer_load_dwordx4 a[220:223], v34, s[4:7], s16 offen offset:1024 sc1
  v_mfma_f32_16x16x32_bf16 v[24:27], v[112:115], a[156:159], v[24:27]
  ds_read_b64_tr_b16 v[112:113], v41 offset:20480
  ds_read_b64_tr_b16 v[114:115], v41 offset:22528
  s_waitcnt lgkmcnt(10)
  v_mfma_f32_16x16x32_bf16 v[12:15], v[116:119], a[152:155], v[12:15]
  v_mfma_f32_16x16x32_bf16 v[28:31], v[116:119], a[156:159], v[28:31]
  s_waitcnt vmcnt(12) lgkmcnt(10)
  ds_read_b64_tr_b16 v[116:117], v42 offset:20480
  v_mfma_f32_16x16x32_bf16 v[0:3], v[88:91], a[160:163], v[0:3]
  ds_read_b64_tr_b16 v[118:119], v42 offset:22528
  s_mov_b32 s16, 786432
  v_mfma_f32_16x16x32_bf16 v[16:19], v[88:91], a[164:167], v[16:19]
  ds_read_b64_tr_b16 v[88:89], v39 offset:24576
  ds_read_b64_tr_b16 v[90:91], v39 offset:26624
  v_mfma_f32_16x16x32_bf16 v[4:7], v[92:95], a[160:163], v[4:7]
  v_mfma_f32_16x16x32_bf16 v[20:23], v[92:95], a[164:167], v[20:23]
  buffer_load_dwordx4 a[0:3], v33, s[4:7], s16 offen offset:0 sc1
  s_waitcnt lgkmcnt(10)
  v_mfma_f32_16x16x32_bf16 v[8:11], v[96:99], a[160:163], v[8:11]
  ds_read_b64_tr_b16 v[92:93], v40 offset:24576
  ds_read_b64_tr_b16 v[94:95], v40 offset:26624
  v_mfma_f32_16x16x32_bf16 v[24:27], v[96:99], a[164:167], v[24:27]
  ds_read_b64_tr_b16 v[96:97], v41 offset:24576
  ds_read_b64_tr_b16 v[98:99], v41 offset:26624
  v_mfma_f32_16x16x32_bf16 v[12:15], v[100:103], a[160:163], v[12:15]
  buffer_load_dwordx4 a[4:7], v33, s[4:7], s16 offen offset:1024 sc1
  v_mfma_f32_16x16x32_bf16 v[28:31], v[100:103], a[164:167], v[28:31]
  ds_read_b64_tr_b16 v[100:101], v42 offset:24576
  ds_read_b64_tr_b16 v[102:103], v42 offset:26624
  s_waitcnt lgkmcnt(10)
  v_mfma_f32_16x16x32_bf16 v[0:3], v[104:107], a[168:171], v[0:3]
  v_mfma_f32_16x16x32_bf16 v[16:19], v[104:107], a[172:175], v[16:19]
  buffer_load_dwordx4 a[8:11], v34, s[4:7], s16 offen offset:0 sc1
  v_mfma_f32_16x16x32_bf16 v[4:7], v[108:111], a[168:171], v[4:7]
  ds_read_b64_tr_b16 v[104:105], v39 offset:28672
  ds_read_b64_tr_b16 v[106:107], v39 offset:30720
  v_mfma_f32_16x16x32_bf16 v[20:23], v[108:111], a[172:175], v[20:23]
  ds_read_b64_tr_b16 v[108:109], v40 offset:28672
  ds_read_b64_tr_b16 v[110:111], v40 offset:30720
  v_mfma_f32_16x16x32_bf16 v[8:11], v[112:115], a[168:171], v[8:11]
  buffer_load_dwordx4 a[12:15], v34, s[4:7], s16 offen offset:1024 sc1
  v_mfma_f32_16x16x32_bf16 v[24:27], v[112:115], a[172:175], v[24:27]
  ds_read_b64_tr_b16 v[112:113], v41 offset:28672
  ds_read_b64_tr_b16 v[114:115], v41 offset:30720
  s_waitcnt lgkmcnt(10)
  v_mfma_f32_16x16x32_bf16 v[12:15], v[116:119], a[168:171], v[12:15]
  v_mfma_f32_16x16x32_bf16 v[28:31], v[116:119], a[172:175], v[28:31]
  s_waitcnt vmcnt(12) lgkmcnt(10)
  ds_read_b64_tr_b16 v[116:117], v42 offset:28672
  v_mfma_f32_16x16x32_bf16 v[0:3], v[88:91], a[176:179], v[0:3]
  ds_read_b64_tr_b16 v[118:119], v42 offset:30720
  s_mov_b32 s16, 2883584
  v_mfma_f32_16x16x32_bf16 v[16:19], v[88:91], a[180:183], v[16:19]
  ds_read_b64_tr_b16 v[88:89], v39 offset:32768
  ds_read_b64_tr_b16 v[90:91], v39 offset:34816
  v_mfma_f32_16x16x32_bf16 v[4:7], v[92:95], a[176:179], v[4:7]
  v_mfma_f32_16x16x32_bf16 v[20:23], v[92:95], a[180:183], v[20:23]
  buffer_load_dwordx4 a[16:19], v33, s[4:7], s16 offen offset:0 sc1
  s_waitcnt lgkmcnt(10)
  v_mfma_f32_16x16x32_bf16 v[8:11], v[96:99], a[176:179], v[8:11]
  ds_read_b64_tr_b16 v[92:93], v40 offset:32768
  ds_read_b64_tr_b16 v[94:95], v40 offset:34816
  v_mfma_f32_16x16x32_bf16 v[24:27], v[96:99], a[180:183], v[24:27]
  ds_read_b64_tr_b16 v[96:97], v41 offset:32768
  ds_read_b64_tr_b16 v[98:99], v41 offset:34816
  v_mfma_f32_16x16x32_bf16 v[12:15], v[100:103], a[176:179], v[12:15]
  buffer_load_dwordx4 a[20:23], v33, s[4:7], s16 offen offset:1024 sc1
  v_mfma_f32_16x16x32_bf16 v[28:31], v[100:103], a[180:183], v[28:31]
  ds_read_b64_tr_b16 v[100:101], v42 offset:32768
  ds_read_b64_tr_b16 v[102:103], v42 offset:34816
  s_waitcnt lgkmcnt(10)
  v_mfma_f32_16x16x32_bf16 v[0:3], v[104:107], a[184:187], v[0:3]
  v_mfma_f32_16x16x32_bf16 v[16:19], v[104:107], a[188:191], v[16:19]
  buffer_load_dwordx4 a[24:27], v34, s[4:7], s16 offen offset:0 sc1
  v_mfma_f32_16x16x32_bf16 v[4:7], v[108:111], a[184:187], v[4:7]
  ds_read_b64_tr_b16 v[104:105], v39 offset:36864
  ds_read_b64_tr_b16 v[106:107], v39 offset:38912
  v_mfma_f32_16x16x32_bf16 v[20:23], v[108:111], a[188:191], v[20:23]
  ds_read_b64_tr_b16 v[108:109], v40 offset:36864
  ds_read_b64_tr_b16 v[110:111], v40 offset:38912
  v_mfma_f32_16x16x32_bf16 v[8:11], v[112:115], a[184:187], v[8:11]
  buffer_load_dwordx4 a[28:31], v34, s[4:7], s16 offen offset:1024 sc1
  v_mfma_f32_16x16x32_bf16 v[24:27], v[112:115], a[188:191], v[24:27]
  ds_read_b64_tr_b16 v[112:113], v41 offset:36864
  ds_read_b64_tr_b16 v[114:115], v41 offset:38912
  s_waitcnt lgkmcnt(10)
  v_mfma_f32_16x16x32_bf16 v[12:15], v[116:119], a[184:187], v[12:15]
  v_mfma_f32_16x16x32_bf16 v[28:31], v[116:119], a[188:191], v[28:31]
  s_waitcnt vmcnt(12) lgkmcnt(10)
  ds_read_b64_tr_b16 v[116:117], v42 offset:36864
  v_mfma_f32_16x16x32_bf16 v[0:3], v[88:91], a[192:195], v[0:3]
  ds_read_b64_tr_b16 v[118:119], v42 offset:38912
  v_mfma_f32_16x16x32_bf16 v[16:19], v[88:91], a[196:199], v[16:19]
  ds_read_b64_tr_b16 v[88:89], v39 offset:40960
  ds_read_b64_tr_b16 v[90:91], v39 offset:43008
  v_mfma_f32_16x16x32_bf16 v[4:7], v[92:95], a[192:195], v[4:7]
  v_mfma_f32_16x16x32_bf16 v[20:23], v[92:95], a[196:199], v[20:23]
  ds_read_b64_tr_b16 v[92:93], v40 offset:40960
  ds_read_b64_tr_b16 v[94:95], v40 offset:43008
  s_waitcnt lgkmcnt(10)
  v_mfma_f32_16x16x32_bf16 v[8:11], v[96:99], a[192:195], v[8:11]
  v_mfma_f32_16x16x32_bf16 v[24:27], v[96:99], a[196:199], v[24:27]
  ds_read_b64_tr_b16 v[96:97], v41 offset:40960
  ds_read_b64_tr_b16 v[98:99], v41 offset:43008
  v_mfma_f32_16x16x32_bf16 v[12:15], v[100:103], a[192:195], v[12:15]
  v_mfma_f32_16x16x32_bf16 v[28:31], v[100:103], a[196:199], v[28:31]
  ds_read_b64_tr_b16 v[100:101], v42 offset:40960
  ds_read_b64_tr_b16 v[102:103], v42 offset:43008
  v_mfma_f32_16x16x32_bf16 v[0:3], v[104:107], a[200:203], v[0:3]
  v_mfma_f32_16x16x32_bf16 v[16:19], v[104:107], a[204:207], v[16:19]
  ds_read_b64_tr_b16 v[104:105], v39 offset:45056
  ds_read_b64_tr_b16 v[106:107], v39 offset:47104
  s_waitcnt lgkmcnt(10)
  v_mfma_f32_16x16x32_bf16 v[4:7], v[108:111], a[200:203], v[4:7]
  v_mfma_f32_16x16x32_bf16 v[20:23], v[108:111], a[204:207], v[20:23]
  ds_read_b64_tr_b16 v[108:109], v40 offset:45056
  ds_read_b64_tr_b16 v[110:111], v40 offset:47104
  v_mfma_f32_16x16x32_bf16 v[8:11], v[112:115], a[200:203], v[8:11]
  v_mfma_f32_16x16x32_bf16 v[24:27], v[112:115], a[204:207], v[24:27]
  ds_read_b64_tr_b16 v[112:113], v41 offset:45056
  ds_read_b64_tr_b16 v[114:115], v41 offset:47104
  v_mfma_f32_16x16x32_bf16 v[12:15], v[116:119], a[200:203], v[12:15]
  v_mfma_f32_16x16x32_bf16 v[28:31], v[116:119], a[204:207], v[28:31]
  s_waitcnt vmcnt(8) lgkmcnt(10)
  ds_read_b64_tr_b16 v[116:117], v42 offset:45056
  v_mfma_f32_16x16x32_bf16 v[0:3], v[88:91], a[208:211], v[0:3]
  ds_read_b64_tr_b16 v[118:119], v42 offset:47104
  v_mfma_f32_16x16x32_bf16 v[16:19], v[88:91], a[212:215], v[16:19]
  ds_read_b64_tr_b16 v[88:89], v39 offset:49152
  ds_read_b64_tr_b16 v[90:91], v39 offset:51200
  v_mfma_f32_16x16x32_bf16 v[4:7], v[92:95], a[208:211], v[4:7]
  v_mfma_f32_16x16x32_bf16 v[20:23], v[92:95], a[212:215], v[20:23]
  ds_read_b64_tr_b16 v[92:93], v40 offset:49152
  ds_read_b64_tr_b16 v[94:95], v40 offset:51200
  s_waitcnt lgkmcnt(10)
  v_mfma_f32_16x16x32_bf16 v[8:11], v[96:99], a[208:211], v[8:11]
  v_mfma_f32_16x16x32_bf16 v[24:27], v[96:99], a[212:215], v[24:27]
  ds_read_b64_tr_b16 v[96:97], v41 offset:49152
  ds_read_b64_tr_b16 v[98:99], v41 offset:51200
  v_mfma_f32_16x16x32_bf16 v[12:15], v[100:103], a[208:211], v[12:15]
  v_mfma_f32_16x16x32_bf16 v[28:31], v[100:103], a[212:215], v[28:31]
  ds_read_b64_tr_b16 v[100:101], v42 offset:49152
  ds_read_b64_tr_b16 v[102:103], v42 offset:51200
  v_mfma_f32_16x16x32_bf16 v[0:3], v[104:107], a[216:219], v[0:3]
  v_mfma_f32_16x16x32_bf16 v[16:19], v[104:107], a[220:223], v[16:19]
  ds_read_b64_tr_b16 v[104:105], v39 offset:53248
  ds_read_b64_tr_b16 v[106:107], v39 offset:55296
  s_waitcnt lgkmcnt(10)
  v_mfma_f32_16x16x32_bf16 v[4:7], v[108:111], a[216:219], v[4:7]
  v_mfma_f32_16x16x32_bf16 v[20:23], v[108:111], a[220:223], v[20:23]
  ds_read_b64_tr_b16 v[108:109], v40 offset:53248
  ds_read_b64_tr_b16 v[110:111], v40 offset:55296
  v_mfma_f32_16x16x32_bf16 v[8:11], v[112:115], a[216:219], v[8:11]
  v_mfma_f32_16x16x32_bf16 v[24:27], v[112:115], a[220:223], v[24:27]
  ds_read_b64_tr_b16 v[112:113], v41 offset:53248
  ds_read_b64_tr_b16 v[114:115], v41 offset:55296
  v_mfma_f32_16x16x32_bf16 v[12:15], v[116:119], a[216:219], v[12:15]
  v_mfma_f32_16x16x32_bf16 v[28:31], v[116:119], a[220:223], v[28:31]
  s_waitcnt vmcnt(4) lgkmcnt(10)
  ds_read_b64_tr_b16 v[116:117], v42 offset:53248
  v_mfma_f32_16x16x32_bf16 v[0:3], v[88:91], a[0:3], v[0:3]
  ds_read_b64_tr_b16 v[118:119], v42 offset:55296
  v_mfma_f32_16x16x32_bf16 v[16:19], v[88:91], a[4:7], v[16:19]
  ds_read_b64_tr_b16 v[88:89], v39 offset:57344
  ds_read_b64_tr_b16 v[90:91], v39 offset:59392
  v_mfma_f32_16x16x32_bf16 v[4:7], v[92:95], a[0:3], v[4:7]
  v_mfma_f32_16x16x32_bf16 v[20:23], v[92:95], a[4:7], v[20:23]
  ds_read_b64_tr_b16 v[92:93], v40 offset:57344
  ds_read_b64_tr_b16 v[94:95], v40 offset:59392
  s_waitcnt lgkmcnt(10)
  v_mfma_f32_16x16x32_bf16 v[8:11], v[96:99], a[0:3], v[8:11]
  v_mfma_f32_16x16x32_bf16 v[24:27], v[96:99], a[4:7], v[24:27]
  ds_read_b64_tr_b16 v[96:97], v41 offset:57344
  ds_read_b64_tr_b16 v[98:99], v41 offset:59392
  v_mfma_f32_16x16x32_bf16 v[12:15], v[100:103], a[0:3], v[12:15]
  v_mfma_f32_16x16x32_bf16 v[28:31], v[100:103], a[4:7], v[28:31]
  ds_read_b64_tr_b16 v[100:101], v42 offset:57344
  ds_read_b64_tr_b16 v[102:103], v42 offset:59392
  v_mfma_f32_16x16x32_bf16 v[0:3], v[104:107], a[8:11], v[0:3]
  v_mfma_f32_16x16x32_bf16 v[16:19], v[104:107], a[12:15], v[16:19]
  ds_read_b64_tr_b16 v[104:105], v39 offset:61440
  ds_read_b64_tr_b16 v[106:107], v39 offset:63488
  s_waitcnt lgkmcnt(10)
  v_mfma_f32_16x16x32_bf16 v[4:7], v[108:111], a[8:11], v[4:7]
  v_mfma_f32_16x16x32_bf16 v[20:23], v[108:111], a[12:15], v[20:23]
  ds_read_b64_tr_b16 v[108:109], v40 offset:61440
  ds_read_b64_tr_b16 v[110:111], v40 offset:63488
  v_mfma_f32_16x16x32_bf16 v[8:11], v[112:115], a[8:11], v[8:11]
  v_mfma_f32_16x16x32_bf16 v[24:27], v[112:115], a[12:15], v[24:27]
  ds_read_b64_tr_b16 v[112:113], v41 offset:61440
  ds_read_b64_tr_b16 v[114:115], v41 offset:63488
  v_mfma_f32_16x16x32_bf16 v[12:15], v[116:119], a[8:11], v[12:15]
  v_mfma_f32_16x16x32_bf16 v[28:31], v[116:119], a[12:15], v[28:31]
  s_waitcnt vmcnt(0) lgkmcnt(10)
  ds_read_b64_tr_b16 v[116:117], v42 offset:61440
  v_mfma_f32_16x16x32_bf16 v[0:3], v[88:91], a[16:19], v[0:3]
  ds_read_b64_tr_b16 v[118:119], v42 offset:63488
  v_mfma_f32_16x16x32_bf16 v[16:19], v[88:91], a[20:23], v[16:19]
  v_mfma_f32_16x16x32_bf16 v[4:7], v[92:95], a[16:19], v[4:7]
  v_mfma_f32_16x16x32_bf16 v[20:23], v[92:95], a[20:23], v[20:23]
  s_waitcnt lgkmcnt(10)
  v_mfma_f32_16x16x32_bf16 v[8:11], v[96:99], a[16:19], v[8:11]
  v_mfma_f32_16x16x32_bf16 v[24:27], v[96:99], a[20:23], v[24:27]
  s_waitcnt lgkmcnt(8)
  v_mfma_f32_16x16x32_bf16 v[12:15], v[100:103], a[16:19], v[12:15]
  v_mfma_f32_16x16x32_bf16 v[28:31], v[100:103], a[20:23], v[28:31]
  s_waitcnt lgkmcnt(6)
  v_mfma_f32_16x16x32_bf16 v[0:3], v[104:107], a[24:27], v[0:3]
  v_mfma_f32_16x16x32_bf16 v[16:19], v[104:107], a[28:31], v[16:19]
  s_waitcnt lgkmcnt(4)
  v_mfma_f32_16x16x32_bf16 v[4:7], v[108:111], a[24:27], v[4:7]
  v_mfma_f32_16x16x32_bf16 v[20:23], v[108:111], a[28:31], v[20:23]
  s_waitcnt lgkmcnt(2)
  v_mfma_f32_16x16x32_bf16 v[8:11], v[112:115], a[24:27], v[8:11]
  v_mfma_f32_16x16x32_bf16 v[24:27], v[112:115], a[28:31], v[24:27]
  s_waitcnt lgkmcnt(0)
  v_mfma_f32_16x16x32_bf16 v[12:15], v[116:119], a[24:27], v[12:15]
  v_mfma_f32_16x16x32_bf16 v[28:31], v[116:119], a[28:31], v[28:31]
  s_nop 7
  s_nop 1
  s_barrier
  v_pk_fma_f32 v[120:121], v[0:1], v[64:65], v[120:121]
  v_pk_fma_f32 v[122:123], v[2:3], v[66:67], v[122:123]
  v_pk_fma_f32 v[124:125], v[4:5], v[68:69], v[124:125]
  v_pk_fma_f32 v[126:127], v[6:7], v[70:71], v[126:127]
  v_pk_fma_f32 v[128:129], v[8:9], v[72:73], v[128:129]
  v_pk_fma_f32 v[130:131], v[10:11], v[74:75], v[130:131]
  v_pk_fma_f32 v[132:133], v[12:13], v[76:77], v[132:133]
  v_pk_fma_f32 v[134:135], v[14:15], v[78:79], v[134:135]
  v_pk_fma_f32 v[136:137], v[16:17], v[64:65], v[136:137]
  v_pk_fma_f32 v[138:139], v[18:19], v[66:67], v[138:139]
  v_pk_fma_f32 v[140:141], v[20:21], v[68:69], v[140:141]
  v_pk_fma_f32 v[142:143], v[22:23], v[70:71], v[142:143]
  v_pk_fma_f32 v[144:145], v[24:25], v[72:73], v[144:145]
  v_pk_fma_f32 v[146:147], v[26:27], v[74:75], v[146:147]
  v_pk_fma_f32 v[148:149], v[28:29], v[76:77], v[148:149]
  v_pk_fma_f32 v[150:151], v[30:31], v[78:79], v[150:151]
  v_pk_mul_f32 v[160:161], v[120:121], v[120:121]
  v_pk_mul_f32 v[162:163], v[136:137], v[136:137]
  v_pk_fma_f32 v[160:161], v[122:123], v[122:123], v[160:161]
  v_pk_add_f32 v[152:153], v[120:121], v[122:123]
  v_pk_fma_f32 v[162:163], v[138:139], v[138:139], v[162:163]
  v_pk_add_f32 v[154:155], v[136:137], v[138:139]
  v_pk_fma_f32 v[160:161], v[124:125], v[124:125], v[160:161]
  v_pk_add_f32 v[152:153], v[152:153], v[124:125]
  v_pk_fma_f32 v[162:163], v[140:141], v[140:141], v[162:163]
  v_pk_add_f32 v[154:155], v[154:155], v[140:141]
  v_pk_fma_f32 v[160:161], v[126:127], v[126:127], v[160:161]
  v_pk_add_f32 v[152:153], v[152:153], v[126:127]
  v_pk_fma_f32 v[162:163], v[142:143], v[142:143], v[162:163]
  v_pk_add_f32 v[154:155], v[154:155], v[142:143]
  v_pk_fma_f32 v[160:161], v[128:129], v[128:129], v[160:161]
  v_pk_add_f32 v[152:153], v[152:153], v[128:129]
  v_pk_fma_f32 v[162:163], v[144:145], v[144:145], v[162:163]
  v_pk_add_f32 v[154:155], v[154:155], v[144:145]
  v_pk_fma_f32 v[160:161], v[130:131], v[130:131], v[160:161]
  v_pk_add_f32 v[152:153], v[152:153], v[130:131]
  v_pk_fma_f32 v[162:163], v[146:147], v[146:147], v[162:163]
  v_pk_add_f32 v[154:155], v[154:155], v[146:147]
  v_pk_fma_f32 v[160:161], v[132:133], v[132:133], v[160:161]
  v_pk_add_f32 v[152:153], v[152:153], v[132:133]
  v_pk_fma_f32 v[162:163], v[148:149], v[148:149], v[162:163]
  v_pk_add_f32 v[154:155], v[154:155], v[148:149]
  v_pk_fma_f32 v[160:161], v[134:135], v[134:135], v[160:161]
  v_pk_add_f32 v[152:153], v[152:153], v[134:135]
  v_pk_fma_f32 v[162:163], v[150:151], v[150:151], v[162:163]
  v_pk_add_f32 v[154:155], v[154:155], v[150:151]
  v_add_f32 v152, v152, v153
  v_add_f32 v153, v160, v161
  v_add_f32 v154, v154, v155
  v_add_f32 v155, v162, v163
  v_mov_b32 v160, v152
  v_mov_b32 v161, v153
  v_mov_b32 v162, v154
  v_mov_b32 v163, v155
  s_nop 1
  v_permlane16_swap_b32 v160, v152
  v_permlane16_swap_b32 v161, v153
  v_permlane16_swap_b32 v162, v154
  v_permlane16_swap_b32 v163, v155
  s_nop 1
  v_add_f32 v152, v152, v160
  v_add_f32 v153, v153, v161
  v_add_f32 v154, v154, v162
  v_add_f32 v155, v155, v163
  v_mov_b32 v160, v152
  v_mov_b32 v161, v153
  v_mov_b32 v162, v154
  v_mov_b32 v163, v155
  s_nop 1
  v_permlane32_swap_b32 v160, v152
  v_permlane32_swap_b32 v161, v153
  v_permlane32_swap_b32 v162, v154
  v_permlane32_swap_b32 v163, v155
  s_nop 1
  v_add_f32 v152, v152, v160
  v_add_f32 v153, v153, v161
  v_add_f32 v154, v154, v162
  v_add_f32 v155, v155, v163
  v_cndmask_b32_e64 v156, v154, v152, s[34:35]
  v_cndmask_b32_e64 v157, v155, v153, s[34:35]
  s_mov_b32 exec_hi, 0
  buffer_store_dwordx4 v[156:159], v80, s[52:55], s57 offen sc1
  s_mov_b64 exec, -1
  s_add_u32 m0, s38, 0
  s_nop 0
  buffer_load_dwordx4 v225, s[8:11], s17 offen lds
  buffer_load_dwordx4 v226, s[8:11], s17 offen offset:1024 lds
  buffer_load_dwordx4 v227, s[8:11], s17 offen offset:2048 lds
  s_mov_b32 exec_hi, 0
  buffer_load_dwordx4 v228, s[8:11], s17 offen offset:3072 lds
  s_mov_b32 exec_hi, -1
  s_add_u32 s17, s17, 229376
  s_add_u32 m0, s38, 14336
  s_nop 0
  buffer_load_dwordx4 v225, s[8:11], s17 offen lds
  buffer_load_dwordx4 v226, s[8:11], s17 offen offset:1024 lds
  buffer_load_dwordx4 v227, s[8:11], s17 offen offset:2048 lds
  s_mov_b32 exec_hi, 0
  buffer_load_dwordx4 v228, s[8:11], s17 offen offset:3072 lds
  s_mov_b32 exec_hi, -1
  s_add_u32 s17, s17, 229376
  s_add_u32 m0, s38, 28672
  s_nop 0
  buffer_load_dwordx4 v225, s[8:11], s17 offen lds
  buffer_load_dwordx4 v226, s[8:11], s17 offen offset:1024 lds
  buffer_load_dwordx4 v227, s[8:11], s17 offen offset:2048 lds
  s_mov_b32 exec_hi, 0
  buffer_load_dwordx4 v228, s[8:11], s17 offen offset:3072 lds
  s_mov_b32 exec_hi, -1
  s_add_u32 s17, s17, 229376
  v_cvt_pk_bf16_f32 v48, v120, v121
  v_cvt_pk_bf16_f32 v49, v122, v123
  v_cvt_pk_bf16_f32 v50, v124, v125
  v_cvt_pk_bf16_f32 v51, v126, v127
  v_cvt_pk_bf16_f32 v52, v128, v129
  v_cvt_pk_bf16_f32 v53, v130, v131
  v_cvt_pk_bf16_f32 v54, v132, v133
  v_cvt_pk_bf16_f32 v55, v134, v135
  v_cvt_pk_bf16_f32 v56, v136, v137
  v_cvt_pk_bf16_f32 v57, v138, v139
  v_cvt_pk_bf16_f32 v58, v140, v141
  v_cvt_pk_bf16_f32 v59, v142, v143
  v_cvt_pk_bf16_f32 v60, v144, v145
  v_cvt_pk_bf16_f32 v61, v146, v147
  v_cvt_pk_bf16_f32 v62, v148, v149
  v_cvt_pk_bf16_f32 v63, v150, v151
  v_accvgpr_write_b32 a128, v48
  v_lshlrev_b32 v0, 16, v48
  v_and_b32 v1, 0xffff0000, v48
  v_accvgpr_write_b32 a129, v49
  v_lshlrev_b32 v2, 16, v49
  v_and_b32 v3, 0xffff0000, v49
  v_accvgpr_write_b32 a130, v50
  v_lshlrev_b32 v4, 16, v50
  v_and_b32 v5, 0xffff0000, v50
  v_accvgpr_write_b32 a131, v51
  v_lshlrev_b32 v6, 16, v51
  v_and_b32 v7, 0xffff0000, v51
  v_accvgpr_write_b32 a132, v52
  v_lshlrev_b32 v8, 16, v52
  v_and_b32 v9, 0xffff0000, v52
  v_accvgpr_write_b32 a133, v53
  v_lshlrev_b32 v10, 16, v53
  v_and_b32 v11, 0xffff0000, v53
  v_accvgpr_write_b32 a134, v54
  v_lshlrev_b32 v12, 16, v54
  v_and_b32 v13, 0xffff0000, v54
  v_accvgpr_write_b32 a135, v55
  v_lshlrev_b32 v14, 16, v55
  v_and_b32 v15, 0xffff0000, v55
  v_accvgpr_write_b32 a136, v56
  v_lshlrev_b32 v16, 16, v56
  v_and_b32 v17, 0xffff0000, v56
  v_accvgpr_write_b32 a137, v57
  v_lshlrev_b32 v18, 16, v57
  v_and_b32 v19, 0xffff0000, v57
  v_accvgpr_write_b32 a138, v58
  v_lshlrev_b32 v20, 16, v58
  v_and_b32 v21, 0xffff0000, v58
  v_accvgpr_write_b32 a139, v59
  v_lshlrev_b32 v22, 16, v59
  v_and_b32 v23, 0xffff0000, v59
  v_accvgpr_write_b32 a140, v60
  v_lshlrev_b32 v24, 16, v60
  v_and_b32 v25, 0xffff0000, v60
  v_accvgpr_write_b32 a141, v61
  v_lshlrev_b32 v26, 16, v61
  v_and_b32 v27, 0xffff0000, v61
  v_accvgpr_write_b32 a142, v62
  v_lshlrev_b32 v28, 16, v62
  v_and_b32 v29, 0xffff0000, v62
  v_accvgpr_write_b32 a143, v63
  v_lshlrev_b32 v30, 16, v63
  v_and_b32 v31, 0xffff0000, v63
  s_add_u32 s48, s20, 0xa00000
  s_addc_u32 s49, s21, 0
  s_mov_b32 s50, 0x400000
  s_mov_b32 s51, 0x20000
  s_mov_b32 s59, 262144
L_poll_17:
  buffer_load_dwordx3 v[88:90], v81, s[52:55], s56 offen offset:0 sc1
  buffer_load_dwordx3 v[92:94], v81, s[52:55], s56 offen offset:2048 sc1
  buffer_load_dwordx3 v[96:98], v81, s[52:55], s58 offen offset:0 sc1
  buffer_load_dwordx3 v[100:102], v81, s[52:55], s58 offen offset:2048 sc1
  buffer_load_dwordx3 v[104:106], v81, s[52:55], s56 offen offset:256 sc1
  buffer_load_dwordx3 v[108:110], v81, s[52:55], s56 offen offset:2304 sc1
  buffer_load_dwordx3 v[112:114], v81, s[52:55], s58 offen offset:256 sc1
  buffer_load_dwordx3 v[116:118], v81, s[52:55], s58 offen offset:2304 sc1
  s_waitcnt vmcnt(0)
  v_xor_b32 v160, s19, v90
  v_bitop3_b32 v160, v94, s19, v160 bitop3:0xbe
  v_bitop3_b32 v160, v98, s19, v160 bitop3:0xbe
  v_bitop3_b32 v160, v102, s19, v160 bitop3:0xbe
  v_bitop3_b32 v160, v106, s19, v160 bitop3:0xbe
  v_bitop3_b32 v160, v110, s19, v160 bitop3:0xbe
  v_bitop3_b32 v160, v114, s19, v160 bitop3:0xbe
  v_bitop3_b32 v160, v118, s19, v160 bitop3:0xbe
  v_cmp_ne_u32 vcc, 0, v160
  s_nop 1
  s_cmp_eq_u64 vcc, 0
  s_cbranch_scc1 L_ready_18
  s_sub_u32 s59, s59, 1
  s_cmp_lg_u32 s59, 0
  s_cbranch_scc1 L_poll_17
L_ready_18:
  v_pk_add_f32 v[152:153], v[88:89], v[92:93]
  v_pk_add_f32 v[160:161], v[96:97], v[100:101]
  v_pk_add_f32 v[154:155], v[104:105], v[108:109]
  v_pk_add_f32 v[162:163], v[112:113], v[116:117]
  v_pk_add_f32 v[152:153], v[152:153], v[160:161]
  v_pk_add_f32 v[154:155], v[154:155], v[162:163]
  v_mov_b32 v160, v152
  v_mov_b32 v161, v153
  v_mov_b32 v162, v154
  v_mov_b32 v163, v155
  s_nop 1
  v_permlane16_swap_b32 v160, v152
  v_permlane16_swap_b32 v161, v153
  v_permlane16_swap_b32 v162, v154
  v_permlane16_swap_b32 v163, v155
  s_nop 1
  v_add_f32 v152, v152, v160
  v_add_f32 v153, v153, v161
  v_add_f32 v154, v154, v162
  v_add_f32 v155, v155, v163
  v_mov_b32 v160, v152
  v_mov_b32 v161, v153
  v_mov_b32 v162, v154
  v_mov_b32 v163, v155
  s_nop 1
  v_permlane32_swap_b32 v160, v152
  v_permlane32_swap_b32 v161, v153
  v_permlane32_swap_b32 v162, v154
  v_permlane32_swap_b32 v163, v155
  s_nop 1
  v_add_f32 v152, v152, v160
  v_add_f32 v153, v153, v161
  v_add_f32 v154, v154, v162
  v_add_f32 v155, v155, v163
  v_mul_f32 v120, 0x3a800000, v152
  v_mul_f32 v124, 0x3a800000, v153
  v_mul_f32 v132, 0x3a800000, v154
  v_mul_f32 v136, 0x3a800000, v155
  v_fma_f32 v124, -v120, v120, v124
  v_fma_f32 v136, -v132, v132, v136
  v_max_f32 v124, 0, v124
  v_max_f32 v136, 0, v136
  v_cvt_pk_bf16_f32 v128, v120, v124
  v_lshlrev_b32 v120, 16, v128
  v_and_b32 v124, 0xffff0000, v128
  v_add_f32 v124, 0x3727c5ac, v124
  v_cvt_pk_bf16_f32 v128, v124, v125
  v_lshlrev_b32 v124, 16, v128
  v_and_b32 v125, 0xffff0000, v128
  v_sqrt_f32 v124, v124
  s_nop 0
  v_cvt_pk_bf16_f32 v128, v124, v125
  v_lshlrev_b32 v124, 16, v128
  v_and_b32 v125, 0xffff0000, v128
  v_rcp_f32 v124, v124
  v_mov_b32 v121, v120
  s_nop 0
  v_mov_b32 v125, v124
  v_cvt_pk_bf16_f32 v140, v132, v136
  v_lshlrev_b32 v132, 16, v140
  v_and_b32 v136, 0xffff0000, v140
  v_add_f32 v136, 0x3727c5ac, v136
  v_cvt_pk_bf16_f32 v140, v136, v137
  v_lshlrev_b32 v136, 16, v140
  v_and_b32 v137, 0xffff0000, v140
  v_sqrt_f32 v136, v136
  s_nop 0
  v_cvt_pk_bf16_f32 v140, v136, v137
  v_lshlrev_b32 v136, 16, v140
  v_and_b32 v137, 0xffff0000, v140
  v_rcp_f32 v136, v136
  v_mov_b32 v133, v132
  s_nop 0
  v_mov_b32 v137, v136
  v_pk_add_f32 v[0:1], v[0:1], v[120:121] neg_lo:[0,1] neg_hi:[0,1]
  v_pk_add_f32 v[2:3], v[2:3], v[120:121] neg_lo:[0,1] neg_hi:[0,1]
  v_pk_add_f32 v[4:5], v[4:5], v[120:121] neg_lo:[0,1] neg_hi:[0,1]
  v_pk_add_f32 v[6:7], v[6:7], v[120:121] neg_lo:[0,1] neg_hi:[0,1]
  v_pk_add_f32 v[8:9], v[8:9], v[120:121] neg_lo:[0,1] neg_hi:[0,1]
  v_pk_add_f32 v[10:11], v[10:11], v[120:121] neg_lo:[0,1] neg_hi:[0,1]
  v_pk_add_f32 v[12:13], v[12:13], v[120:121] neg_lo:[0,1] neg_hi:[0,1]
  v_pk_add_f32 v[14:15], v[14:15], v[120:121] neg_lo:[0,1] neg_hi:[0,1]
  v_pk_mul_f32 v[0:1], v[0:1], v[124:125]
  v_pk_mul_f32 v[2:3], v[2:3], v[124:125]
  v_pk_mul_f32 v[4:5], v[4:5], v[124:125]
  v_pk_mul_f32 v[6:7], v[6:7], v[124:125]
  v_pk_mul_f32 v[8:9], v[8:9], v[124:125]
  v_pk_mul_f32 v[10:11], v[10:11], v[124:125]
  v_pk_mul_f32 v[12:13], v[12:13], v[124:125]
  v_pk_mul_f32 v[14:15], v[14:15], v[124:125]
  v_pk_fma_f32 v[0:1], v[0:1], v[184:185], v[168:169]
  v_pk_fma_f32 v[2:3], v[2:3], v[186:187], v[170:171]
  v_pk_fma_f32 v[4:5], v[4:5], v[188:189], v[172:173]
  v_pk_fma_f32 v[6:7], v[6:7], v[190:191], v[174:175]
  v_pk_fma_f32 v[8:9], v[8:9], v[192:193], v[176:177]
  v_pk_fma_f32 v[10:11], v[10:11], v[194:195], v[178:179]
  v_pk_fma_f32 v[12:13], v[12:13], v[196:197], v[180:181]
  v_pk_fma_f32 v[14:15], v[14:15], v[198:199], v[182:183]
  v_cvt_pk_bf16_f32 v88, v0, v1
  v_cvt_pk_bf16_f32 v89, v2, v3
  v_cvt_pk_bf16_f32 v90, v4, v5
  v_cvt_pk_bf16_f32 v91, v6, v7
  v_cvt_pk_bf16_f32 v92, v8, v9
  v_cvt_pk_bf16_f32 v93, v10, v11
  v_cvt_pk_bf16_f32 v94, v12, v13
  v_cvt_pk_bf16_f32 v95, v14, v15
  buffer_store_dwordx4 v[88:91], v33, s[48:51], s41 offen offset:0 sc1
  buffer_store_dwordx4 v[92:95], v33, s[48:51], s42 offen offset:0 sc1
  v_pk_add_f32 v[16:17], v[16:17], v[132:133] neg_lo:[0,1] neg_hi:[0,1]
  v_pk_add_f32 v[18:19], v[18:19], v[132:133] neg_lo:[0,1] neg_hi:[0,1]
  v_pk_add_f32 v[20:21], v[20:21], v[132:133] neg_lo:[0,1] neg_hi:[0,1]
  v_pk_add_f32 v[22:23], v[22:23], v[132:133] neg_lo:[0,1] neg_hi:[0,1]
  v_pk_add_f32 v[24:25], v[24:25], v[132:133] neg_lo:[0,1] neg_hi:[0,1]
  v_pk_add_f32 v[26:27], v[26:27], v[132:133] neg_lo:[0,1] neg_hi:[0,1]
  v_pk_add_f32 v[28:29], v[28:29], v[132:133] neg_lo:[0,1] neg_hi:[0,1]
  v_pk_add_f32 v[30:31], v[30:31], v[132:133] neg_lo:[0,1] neg_hi:[0,1]
  v_pk_mul_f32 v[16:17], v[16:17], v[136:137]
  v_pk_mul_f32 v[18:19], v[18:19], v[136:137]
  v_pk_mul_f32 v[20:21], v[20:21], v[136:137]
  v_pk_mul_f32 v[22:23], v[22:23], v[136:137]
  v_pk_mul_f32 v[24:25], v[24:25], v[136:137]
  v_pk_mul_f32 v[26:27], v[26:27], v[136:137]
  v_pk_mul_f32 v[28:29], v[28:29], v[136:137]
  v_pk_mul_f32 v[30:31], v[30:31], v[136:137]
  v_pk_fma_f32 v[16:17], v[16:17], v[184:185], v[168:169]
  v_pk_fma_f32 v[18:19], v[18:19], v[186:187], v[170:171]
  v_pk_fma_f32 v[20:21], v[20:21], v[188:189], v[172:173]
  v_pk_fma_f32 v[22:23], v[22:23], v[190:191], v[174:175]
  v_pk_fma_f32 v[24:25], v[24:25], v[192:193], v[176:177]
  v_pk_fma_f32 v[26:27], v[26:27], v[194:195], v[178:179]
  v_pk_fma_f32 v[28:29], v[28:29], v[196:197], v[180:181]
  v_pk_fma_f32 v[30:31], v[30:31], v[198:199], v[182:183]
  v_cvt_pk_bf16_f32 v96, v16, v17
  v_cvt_pk_bf16_f32 v97, v18, v19
  v_cvt_pk_bf16_f32 v98, v20, v21
  v_cvt_pk_bf16_f32 v99, v22, v23
  v_cvt_pk_bf16_f32 v100, v24, v25
  v_cvt_pk_bf16_f32 v101, v26, v27
  v_cvt_pk_bf16_f32 v102, v28, v29
  v_cvt_pk_bf16_f32 v103, v30, v31
  buffer_store_dwordx4 v[96:99], v33, s[48:51], s41 offen offset:1024 sc1
  buffer_store_dwordx4 v[100:103], v33, s[48:51], s42 offen offset:1024 sc1
  s_add_u32 s64, s20, 0xb0000
  s_addc_u32 s65, s21, 0
  s_mov_b32 s66, 0x10000
  s_mov_b32 s67, 0x20000
  s_lshl_b32 s32, s30, 2
  s_add_u32 s32, s32, s3
  s_lshl_b32 s32, s32, 4
  s_add_u32 s32, s32, s31
  s_lshl_b32 s32, s32, 6
  s_mov_b32 s30, s94
  s_mov_b32 s31, s95
  s_lshl_b32 s33, s30, 2
  s_add_u32 s33, s33, s3
  s_lshl_b32 s68, s33, 11
  v_lshlrev_b32 v250, 2, v231
  v_mov_b32 v248, s19
  v_and_b32 v246, 31, v231
  v_and_b32 v245, 17, v246
  v_lshlrev_b32 v245, 6, v245
  v_lshlrev_b32 v246, 6, v246
  s_mov_b64 s[24:25], s[60:61]
  s_mov_b64 s[26:27], s[62:63]
  s_add_u32 s4, s20, 0xa00000
  s_addc_u32 s5, s21, 0
  s_mov_b32 s6, 0x400000
  s_mov_b32 s7, 0x20000
  s_mov_b32 s16, 0
  s_waitcnt vmcnt(0)
  s_mov_b64 exec, 1
  buffer_store_dword v248, v250, s[64:67], s32 offen sc1
  s_mov_b64 exec, -1
  s_mov_b32 s34, 262144
L_spin_19:
  buffer_load_dword v247, v245, s[64:67], s68 offen sc1
  s_waitcnt vmcnt(0)
  v_cmp_ne_u32 vcc, s19, v247
  s_nop 1
  s_cmp_eq_u64 vcc, 0
  s_cbranch_scc1 L_rdy_20
  s_sub_u32 s34, s34, 1
  s_cmp_lg_u32 s34, 0
  s_cbranch_scc1 L_spin_19
L_rdy_20:
  buffer_load_dwordx4 a[0:3], v224, s[4:7], s16 offen offset:0 sc1
  buffer_load_dwordx4 a[4:7], v224, s[4:7], s16 offen offset:1024 sc1
  buffer_load_dwordx4 a[8:11], v224, s[4:7], s16 offen offset:2048 sc1
  buffer_load_dwordx4 a[12:15], v224, s[4:7], s16 offen offset:3072 sc1
  s_add_u32 s16, s16, 131072
  buffer_load_dwordx4 a[16:19], v224, s[4:7], s16 offen offset:0 sc1
  buffer_load_dwordx4 a[20:23], v224, s[4:7], s16 offen offset:1024 sc1
  buffer_load_dwordx4 a[24:27], v224, s[4:7], s16 offen offset:2048 sc1
  buffer_load_dwordx4 a[28:31], v224, s[4:7], s16 offen offset:3072 sc1
  s_add_u32 s16, s16, 131072
  s_bitcmp1_b32 s3, 0
  s_cselect_b32 s52, s26, s24
  s_cselect_b32 s53, s27, s25
  s_cselect_b32 s60, 3670016, 0
  s_mov_b32 s54, 7340032
  s_mov_b32 s55, 0x20000
  s_lshl_b32 s56, s2, 1
  s_lshr_b32 s59, s3, 1
  s_add_u32 s56, s56, s59
  s_lshl_b32 s56, s56, 10
  s_add_u32 s60, s60, s56
  s_add_u32 s56, s56, 3670016
  s_mov_b32 s59, 0
  v_lshrrev_b32 v249, 3, v231
  v_lshlrev_b32 v249, 7, v249
  s_add_u32 s12, s20, 0x1600000
  s_addc_u32 s13, s21, 0
  s_mov_b32 s14, 0xe00000
  s_mov_b32 s15, 0x20000
  v_lshrrev_b32 v234, 2, v231
  v_mul_u32_u24 v234, 224, v234
  v_and_b32 v235, 3, v231
  v_lshl_add_u32 v229, v235, 3, v234
  v_add_u32 v230, 57344, v229
  s_waitcnt vmcnt(16)
  s_barrier
  ds_read_b64_tr_b16 a[64:65], v229 offset:0
  ds_read_b64_tr_b16 a[66:67], v229 offset:3584
  ds_read_b64_tr_b16 a[68:69], v229 offset:32
  ds_read_b64_tr_b16 a[70:71], v229 offset:3616
  ds_read_b64_tr_b16 a[72:73], v229 offset:64
  ds_read_b64_tr_b16 a[74:75], v229 offset:3648
  ds_read_b64_tr_b16 a[76:77], v229 offset:96
  ds_read_b64_tr_b16 a[78:79], v229 offset:3680
  ds_read_b64_tr_b16 a[80:81], v229 offset:128
  ds_read_b64_tr_b16 a[82:83], v229 offset:3712
  ds_read_b64_tr_b16 a[84:85], v229 offset:160
  ds_read_b64_tr_b16 a[86:87], v229 offset:3744
  ds_read_b64_tr_b16 a[88:89], v229 offset:192
  ds_read_b64_tr_b16 a[90:91], v229 offset:3776
  ds_read_b64_tr_b16 a[92:93], v229 offset:7168
  ds_read_b64_tr_b16 a[94:95], v229 offset:10752
  ds_read_b64_tr_b16 a[96:97], v229 offset:7200
  ds_read_b64_tr_b16 a[98:99], v229 offset:10784
  ds_read_b64_tr_b16 a[100:101], v229 offset:7232
  ds_read_b64_tr_b16 a[102:103], v229 offset:10816
  ds_read_b64_tr_b16 a[104:105], v229 offset:7264
  ds_read_b64_tr_b16 a[106:107], v229 offset:10848
  ds_read_b64_tr_b16 a[108:109], v229 offset:7296
  ds_read_b64_tr_b16 a[110:111], v229 offset:10880
  ds_read_b64_tr_b16 a[112:113], v229 offset:7328
  ds_read_b64_tr_b16 a[114:115], v229 offset:10912
  ds_read_b64_tr_b16 a[116:117], v229 offset:7360
  ds_read_b64_tr_b16 a[118:119], v229 offset:10944
  s_waitcnt vmcnt(4) lgkmcnt(10)
  s_barrier
  buffer_load_dword v247, v246, s[64:67], s68 offen sc1
  v_mfma_f32_16x16x32_bf16 v[0:3], a[64:67], a[0:3], 0
  buffer_load_dwordx4 a[32:35], v224, s[4:7], s16 offen offset:0 sc1
  v_mfma_f32_16x16x32_bf16 v[56:59], a[64:67], a[4:7], 0
  v_mfma_f32_16x16x32_bf16 v[112:115], a[64:67], a[8:11], 0
  buffer_load_dwordx4 a[36:39], v224, s[4:7], s16 offen offset:1024 sc1
  v_mfma_f32_16x16x32_bf16 v[168:171], a[64:67], a[12:15], 0
  ds_read_b64_tr_b16 a[64:65], v229 offset:14336
  ds_read_b64_tr_b16 a[66:67], v229 offset:17920
  v_mfma_f32_16x16x32_bf16 v[4:7], a[68:71], a[0:3], 0
  buffer_load_dwordx4 a[40:43], v224, s[4:7], s16 offen offset:2048 sc1
  v_mfma_f32_16x16x32_bf16 v[60:63], a[68:71], a[4:7], 0
  v_mfma_f32_16x16x32_bf16 v[116:119], a[68:71], a[8:11], 0
  v_mfma_f32_16x16x32_bf16 v[172:175], a[68:71], a[12:15], 0
  buffer_load_dwordx4 a[44:47], v224, s[4:7], s16 offen offset:3072 sc1
  v_mfma_f32_16x16x32_bf16 v[8:11], a[72:75], a[0:3], 0
  ds_read_b64_tr_b16 a[68:69], v229 offset:14368
  ds_read_b64_tr_b16 a[70:71], v229 offset:17952
  v_mfma_f32_16x16x32_bf16 v[64:67], a[72:75], a[4:7], 0
  s_add_u32 s16, s16, 131072
  v_mfma_f32_16x16x32_bf16 v[120:123], a[72:75], a[8:11], 0
  v_mfma_f32_16x16x32_bf16 v[176:179], a[72:75], a[12:15], 0
  ds_read_b64_tr_b16 a[72:73], v229 offset:14400
  s_add_u32 m0, s38, 43008
  v_mfma_f32_16x16x32_bf16 v[12:15], a[76:79], a[0:3], 0
  ds_read_b64_tr_b16 a[74:75], v229 offset:17984
  v_mfma_f32_16x16x32_bf16 v[68:71], a[76:79], a[4:7], 0
  v_mfma_f32_16x16x32_bf16 v[124:127], a[76:79], a[8:11], 0
  buffer_load_dwordx4 v225, s[8:11], s17 offen lds
  v_mfma_f32_16x16x32_bf16 v[180:183], a[76:79], a[12:15], 0
  ds_read_b64_tr_b16 a[76:77], v229 offset:14432
  ds_read_b64_tr_b16 a[78:79], v229 offset:18016
  v_mfma_f32_16x16x32_bf16 v[16:19], a[80:83], a[0:3], 0
  buffer_load_dwordx4 v226, s[8:11], s17 offen offset:1024 lds
  v_mfma_f32_16x16x32_bf16 v[72:75], a[80:83], a[4:7], 0
  v_mfma_f32_16x16x32_bf16 v[128:131], a[80:83], a[8:11], 0
  v_mfma_f32_16x16x32_bf16 v[184:187], a[80:83], a[12:15], 0
  buffer_load_dwordx4 v227, s[8:11], s17 offen offset:2048 lds
  v_mfma_f32_16x16x32_bf16 v[20:23], a[84:87], a[0:3], 0
  ds_read_b64_tr_b16 a[80:81], v229 offset:14464
  ds_read_b64_tr_b16 a[82:83], v229 offset:18048
  v_mfma_f32_16x16x32_bf16 v[76:79], a[84:87], a[4:7], 0
  s_mov_b32 exec_hi, 0
  buffer_load_dwordx4 v228, s[8:11], s17 offen offset:3072 lds
  s_mov_b32 exec_hi, -1
  v_mfma_f32_16x16x32_bf16 v[132:135], a[84:87], a[8:11], 0
  v_mfma_f32_16x16x32_bf16 v[188:191], a[84:87], a[12:15], 0
  ds_read_b64_tr_b16 a[84:85], v229 offset:14496
  s_add_u32 s17, s17, 229376
  v_mfma_f32_16x16x32_bf16 v[24:27], a[88:91], a[0:3], 0
  ds_read_b64_tr_b16 a[86:87], v229 offset:18080
  v_mfma_f32_16x16x32_bf16 v[80:83], a[88:91], a[4:7], 0
  v_mfma_f32_16x16x32_bf16 v[136:139], a[88:91], a[8:11], 0
  buffer_load_dwordx4 a[48:51], v224, s[4:7], s16 offen offset:0 sc1
  v_mfma_f32_16x16x32_bf16 v[192:195], a[88:91], a[12:15], 0
  ds_read_b64_tr_b16 a[88:89], v229 offset:14528
  ds_read_b64_tr_b16 a[90:91], v229 offset:18112
  v_mfma_f32_16x16x32_bf16 v[28:31], a[92:95], a[0:3], 0
  buffer_load_dwordx4 a[52:55], v224, s[4:7], s16 offen offset:1024 sc1
  v_mfma_f32_16x16x32_bf16 v[84:87], a[92:95], a[4:7], 0
  v_mfma_f32_16x16x32_bf16 v[140:143], a[92:95], a[8:11], 0
  v_mfma_f32_16x16x32_bf16 v[196:199], a[92:95], a[12:15], 0
  buffer_load_dwordx4 a[56:59], v224, s[4:7], s16 offen offset:2048 sc1
  v_mfma_f32_16x16x32_bf16 v[32:35], a[96:99], a[0:3], 0
  ds_read_b64_tr_b16 a[92:93], v229 offset:21504
  ds_read_b64_tr_b16 a[94:95], v229 offset:25088
  v_mfma_f32_16x16x32_bf16 v[88:91], a[96:99], a[4:7], 0
  buffer_load_dwordx4 a[60:63], v224, s[4:7], s16 offen offset:3072 sc1
  v_mfma_f32_16x16x32_bf16 v[144:147], a[96:99], a[8:11], 0
  v_mfma_f32_16x16x32_bf16 v[200:203], a[96:99], a[12:15], 0
  ds_read_b64_tr_b16 a[96:97], v229 offset:21536
  s_add_u32 s16, s16, 131072
  s_waitcnt lgkmcnt(10)
  v_mfma_f32_16x16x32_bf16 v[36:39], a[100:103], a[0:3], 0
  ds_read_b64_tr_b16 a[98:99], v229 offset:25120
  v_mfma_f32_16x16x32_bf16 v[92:95], a[100:103], a[4:7], 0
  v_mfma_f32_16x16x32_bf16 v[148:151], a[100:103], a[8:11], 0
  buffer_load_dword v251, v249, s[52:55], s56 offen
  v_mfma_f32_16x16x32_bf16 v[204:207], a[100:103], a[12:15], 0
  ds_read_b64_tr_b16 a[100:101], v229 offset:21568
  ds_read_b64_tr_b16 a[102:103], v229 offset:25152
  v_mfma_f32_16x16x32_bf16 v[40:43], a[104:107], a[0:3], 0
  s_add_u32 s56, s56, 0x80000
  v_mfma_f32_16x16x32_bf16 v[96:99], a[104:107], a[4:7], 0
  v_mfma_f32_16x16x32_bf16 v[152:155], a[104:107], a[8:11], 0
  v_mfma_f32_16x16x32_bf16 v[208:211], a[104:107], a[12:15], 0
  ds_read_b64_tr_b16 a[104:105], v229 offset:21600
  s_add_u32 s59, s59, 1
  v_mfma_f32_16x16x32_bf16 v[44:47], a[108:111], a[0:3], 0
  ds_read_b64_tr_b16 a[106:107], v229 offset:25184
  v_mfma_f32_16x16x32_bf16 v[100:103], a[108:111], a[4:7], 0
  s_cmp_eq_u32 s59, 7
  v_mfma_f32_16x16x32_bf16 v[156:159], a[108:111], a[8:11], 0
  v_mfma_f32_16x16x32_bf16 v[212:215], a[108:111], a[12:15], 0
  ds_read_b64_tr_b16 a[108:109], v229 offset:21632
  s_cselect_b32 s52, s22, s52
  v_mfma_f32_16x16x32_bf16 v[48:51], a[112:115], a[0:3], 0
  ds_read_b64_tr_b16 a[110:111], v229 offset:25216
  v_mfma_f32_16x16x32_bf16 v[104:107], a[112:115], a[4:7], 0
  v_mfma_f32_16x16x32_bf16 v[160:163], a[112:115], a[8:11], 0
  s_cselect_b32 s53, s23, s53
  v_mfma_f32_16x16x32_bf16 v[216:219], a[112:115], a[12:15], 0
  ds_read_b64_tr_b16 a[112:113], v229 offset:21664
  ds_read_b64_tr_b16 a[114:115], v229 offset:25248
  v_mfma_f32_16x16x32_bf16 v[52:55], a[116:119], a[0:3], 0
  s_cselect_b32 s56, s60, s56
  v_mfma_f32_16x16x32_bf16 v[108:111], a[116:119], a[4:7], 0
  v_mfma_f32_16x16x32_bf16 v[164:167], a[116:119], a[8:11], 0
  v_mfma_f32_16x16x32_bf16 v[220:223], a[116:119], a[12:15], 0
  s_waitcnt vmcnt(13) lgkmcnt(10)
  s_barrier
  v_cmp_ne_u32 vcc, s19, v247
  s_nop 1
  s_cmp_lg_u64 vcc, 0
  s_cbranch_scc1 L_slow_21
  L_back_22:
  v_mfma_f32_16x16x32_bf16 v[0:3], a[64:67], a[16:19], v[0:3]
  ds_read_b64_tr_b16 a[116:117], v229 offset:21696
  s_add_u32 m0, s38, 0
  v_mfma_f32_16x16x32_bf16 v[56:59], a[64:67], a[20:23], v[56:59]
  ds_read_b64_tr_b16 a[118:119], v229 offset:25280
  v_mfma_f32_16x16x32_bf16 v[112:115], a[64:67], a[24:27], v[112:115]
  v_mfma_f32_16x16x32_bf16 v[168:171], a[64:67], a[28:31], v[168:171]
  buffer_load_dwordx4 v225, s[8:11], s17 offen lds
  v_mfma_f32_16x16x32_bf16 v[4:7], a[68:71], a[16:19], v[4:7]
  ds_read_b64_tr_b16 a[64:65], v229 offset:28672
  ds_read_b64_tr_b16 a[66:67], v229 offset:32256
  v_mfma_f32_16x16x32_bf16 v[60:63], a[68:71], a[20:23], v[60:63]
  v_mfma_f32_16x16x32_bf16 v[116:119], a[68:71], a[24:27], v[116:119]
  buffer_load_dwordx4 v226, s[8:11], s17 offen offset:1024 lds
  v_mfma_f32_16x16x32_bf16 v[172:175], a[68:71], a[28:31], v[172:175]
  ds_read_b64_tr_b16 a[68:69], v229 offset:28704
  ds_read_b64_tr_b16 a[70:71], v229 offset:32288
  v_mfma_f32_16x16x32_bf16 v[8:11], a[72:75], a[16:19], v[8:11]
  v_mfma_f32_16x16x32_bf16 v[64:67], a[72:75], a[20:23], v[64:67]
  buffer_load_dwordx4 v227, s[8:11], s17 offen offset:2048 lds
  v_mfma_f32_16x16x32_bf16 v[120:123], a[72:75], a[24:27], v[120:123]
  v_mfma_f32_16x16x32_bf16 v[176:179], a[72:75], a[28:31], v[176:179]
  ds_read_b64_tr_b16 a[72:73], v229 offset:28736
  ds_read_b64_tr_b16 a[74:75], v229 offset:32320
  v_mfma_f32_16x16x32_bf16 v[12:15], a[76:79], a[16:19], v[12:15]
  s_mov_b32 exec_hi, 0
  buffer_load_dwordx4 v228, s[8:11], s17 offen offset:3072 lds
  s_mov_b32 exec_hi, -1
  v_mfma_f32_16x16x32_bf16 v[68:71], a[76:79], a[20:23], v[68:71]
  v_mfma_f32_16x16x32_bf16 v[124:127], a[76:79], a[24:27], v[124:127]
  v_mfma_f32_16x16x32_bf16 v[180:183], a[76:79], a[28:31], v[180:183]
  ds_read_b64_tr_b16 a[76:77], v229 offset:28768
  s_add_u32 s17, s17, 229376
  v_mfma_f32_16x16x32_bf16 v[16:19], a[80:83], a[16:19], v[16:19]
  ds_read_b64_tr_b16 a[78:79], v229 offset:32352
  v_mfma_f32_16x16x32_bf16 v[72:75], a[80:83], a[20:23], v[72:75]
  v_mfma_f32_16x16x32_bf16 v[128:131], a[80:83], a[24:27], v[128:131]
  buffer_load_dwordx4 a[0:3], v224, s[4:7], s16 offen offset:0 sc1
  v_mfma_f32_16x16x32_bf16 v[184:187], a[80:83], a[28:31], v[184:187]
  ds_read_b64_tr_b16 a[80:81], v229 offset:28800
  ds_read_b64_tr_b16 a[82:83], v229 offset:32384
  v_mfma_f32_16x16x32_bf16 v[20:23], a[84:87], a[16:19], v[20:23]
  v_mfma_f32_16x16x32_bf16 v[76:79], a[84:87], a[20:23], v[76:79]
  buffer_load_dwordx4 a[4:7], v224, s[4:7], s16 offen offset:1024 sc1
  v_mfma_f32_16x16x32_bf16 v[132:135], a[84:87], a[24:27], v[132:135]
  v_mfma_f32_16x16x32_bf16 v[188:191], a[84:87], a[28:31], v[188:191]
  ds_read_b64_tr_b16 a[84:85], v229 offset:28832
  ds_read_b64_tr_b16 a[86:87], v229 offset:32416
  v_mfma_f32_16x16x32_bf16 v[24:27], a[88:91], a[16:19], v[24:27]
  buffer_load_dwordx4 a[8:11], v224, s[4:7], s16 offen offset:2048 sc1
  v_mfma_f32_16x16x32_bf16 v[80:83], a[88:91], a[20:23], v[80:83]
  v_mfma_f32_16x16x32_bf16 v[136:139], a[88:91], a[24:27], v[136:139]
  v_mfma_f32_16x16x32_bf16 v[192:195], a[88:91], a[28:31], v[192:195]
  buffer_load_dwordx4 a[12:15], v224, s[4:7], s16 offen offset:3072 sc1
  v_mfma_f32_16x16x32_bf16 v[28:31], a[92:95], a[16:19], v[28:31]
  ds_read_b64_tr_b16 a[88:89], v229 offset:28864
  ds_read_b64_tr_b16 a[90:91], v229 offset:32448
  v_mfma_f32_16x16x32_bf16 v[84:87], a[92:95], a[20:23], v[84:87]
  v_mfma_f32_16x16x32_bf16 v[140:143], a[92:95], a[24:27], v[140:143]
  s_add_u32 s16, s16, 131072
  v_mfma_f32_16x16x32_bf16 v[196:199], a[92:95], a[28:31], v[196:199]
  ds_read_b64_tr_b16 a[92:93], v229 offset:35840
  ds_read_b64_tr_b16 a[94:95], v229 offset:39424
  s_waitcnt lgkmcnt(10)
  v_mfma_f32_16x16x32_bf16 v[32:35], a[96:99], a[16:19], v[32:35]
  v_mfma_f32_16x16x32_bf16 v[88:91], a[96:99], a[20:23], v[88:91]
  buffer_load_dword v251, v249, s[52:55], s56 offen
  v_mfma_f32_16x16x32_bf16 v[144:147], a[96:99], a[24:27], v[144:147]
  v_mfma_f32_16x16x32_bf16 v[200:203], a[96:99], a[28:31], v[200:203]
  ds_read_b64_tr_b16 a[96:97], v229 offset:35872
  ds_read_b64_tr_b16 a[98:99], v229 offset:39456
  v_mfma_f32_16x16x32_bf16 v[36:39], a[100:103], a[16:19], v[36:39]
  s_add_u32 s56, s56, 0x80000
  v_mfma_f32_16x16x32_bf16 v[92:95], a[100:103], a[20:23], v[92:95]
  v_mfma_f32_16x16x32_bf16 v[148:151], a[100:103], a[24:27], v[148:151]
  v_mfma_f32_16x16x32_bf16 v[204:207], a[100:103], a[28:31], v[204:207]
  ds_read_b64_tr_b16 a[100:101], v229 offset:35904
  s_add_u32 s59, s59, 1
  v_mfma_f32_16x16x32_bf16 v[40:43], a[104:107], a[16:19], v[40:43]
  ds_read_b64_tr_b16 a[102:103], v229 offset:39488
  v_mfma_f32_16x16x32_bf16 v[96:99], a[104:107], a[20:23], v[96:99]
  v_mfma_f32_16x16x32_bf16 v[152:155], a[104:107], a[24:27], v[152:155]
  s_cmp_eq_u32 s59, 7
  v_mfma_f32_16x16x32_bf16 v[208:211], a[104:107], a[28:31], v[208:211]
  ds_read_b64_tr_b16 a[104:105], v229 offset:35936
  ds_read_b64_tr_b16 a[106:107], v229 offset:39520
  v_mfma_f32_16x16x32_bf16 v[44:47], a[108:111], a[16:19], v[44:47]
  v_mfma_f32_16x16x32_bf16 v[100:103], a[108:111], a[20:23], v[100:103]
  s_cselect_b32 s52, s22, s52
  v_mfma_f32_16x16x32_bf16 v[156:159], a[108:111], a[24:27], v[156:159]
  v_mfma_f32_16x16x32_bf16 v[212:215], a[108:111], a[28:31], v[212:215]
  ds_read_b64_tr_b16 a[108:109], v229 offset:35968
  ds_read_b64_tr_b16 a[110:111], v229 offset:39552
  v_mfma_f32_16x16x32_bf16 v[48:51], a[112:115], a[16:19], v[48:51]
  s_cselect_b32 s53, s23, s53
  v_mfma_f32_16x16x32_bf16 v[104:107], a[112:115], a[20:23], v[104:107]
  v_mfma_f32_16x16x32_bf16 v[160:163], a[112:115], a[24:27], v[160:163]
  v_mfma_f32_16x16x32_bf16 v[216:219], a[112:115], a[28:31], v[216:219]
  ds_read_b64_tr_b16 a[112:113], v229 offset:36000
  s_cselect_b32 s56, s60, s56
  v_mfma_f32_16x16x32_bf16 v[52:55], a[116:119], a[16:19], v[52:55]
  ds_read_b64_tr_b16 a[114:115], v229 offset:39584
  v_mfma_f32_16x16x32_bf16 v[108:111], a[116:119], a[20:23], v[108:111]
  v_mfma_f32_16x16x32_bf16 v[164:167], a[116:119], a[24:27], v[164:167]
  v_mfma_f32_16x16x32_bf16 v[220:223], a[116:119], a[28:31], v[220:223]
  s_waitcnt vmcnt(14) lgkmcnt(10)
  s_barrier
  v_mfma_f32_16x16x32_bf16 v[0:3], a[64:67], a[32:35], v[0:3]
  ds_read_b64_tr_b16 a[116:117], v229 offset:36032
  s_add_u32 m0, s38, 14336
  v_mfma_f32_16x16x32_bf16 v[56:59], a[64:67], a[36:39], v[56:59]
  ds_read_b64_tr_b16 a[118:119], v229 offset:39616
  v_mfma_f32_16x16x32_bf16 v[112:115], a[64:67], a[40:43], v[112:115]
  v_mfma_f32_16x16x32_bf16 v[168:171], a[64:67], a[44:47], v[168:171]
  buffer_load_dwordx4 v225, s[8:11], s17 offen lds
  v_mfma_f32_16x16x32_bf16 v[4:7], a[68:71], a[32:35], v[4:7]
  ds_read_b64_tr_b16 a[64:65], v229 offset:43008
  ds_read_b64_tr_b16 a[66:67], v229 offset:46592
  v_mfma_f32_16x16x32_bf16 v[60:63], a[68:71], a[36:39], v[60:63]
  v_mfma_f32_16x16x32_bf16 v[116:119], a[68:71], a[40:43], v[116:119]
  buffer_load_dwordx4 v226, s[8:11], s17 offen offset:1024 lds
  v_mfma_f32_16x16x32_bf16 v[172:175], a[68:71], a[44:47], v[172:175]
  ds_read_b64_tr_b16 a[68:69], v229 offset:43040
  ds_read_b64_tr_b16 a[70:71], v229 offset:46624
  v_mfma_f32_16x16x32_bf16 v[8:11], a[72:75], a[32:35], v[8:11]
  v_mfma_f32_16x16x32_bf16 v[64:67], a[72:75], a[36:39], v[64:67]
  buffer_load_dwordx4 v227, s[8:11], s17 offen offset:2048 lds
  v_mfma_f32_16x16x32_bf16 v[120:123], a[72:75], a[40:43], v[120:123]
  v_mfma_f32_16x16x32_bf16 v[176:179], a[72:75], a[44:47], v[176:179]
  ds_read_b64_tr_b16 a[72:73], v229 offset:43072
  ds_read_b64_tr_b16 a[74:75], v229 offset:46656
  v_mfma_f32_16x16x32_bf16 v[12:15], a[76:79], a[32:35], v[12:15]
  s_mov_b32 exec_hi, 0
  buffer_load_dwordx4 v228, s[8:11], s17 offen offset:3072 lds
  s_mov_b32 exec_hi, -1
  v_mfma_f32_16x16x32_bf16 v[68:71], a[76:79], a[36:39], v[68:71]
  v_mfma_f32_16x16x32_bf16 v[124:127], a[76:79], a[40:43], v[124:127]
  v_mfma_f32_16x16x32_bf16 v[180:183], a[76:79], a[44:47], v[180:183]
  ds_read_b64_tr_b16 a[76:77], v229 offset:43104
  s_add_u32 s17, s17, 229376
  v_mfma_f32_16x16x32_bf16 v[16:19], a[80:83], a[32:35], v[16:19]
  ds_read_b64_tr_b16 a[78:79], v229 offset:46688
  v_mfma_f32_16x16x32_bf16 v[72:75], a[80:83], a[36:39], v[72:75]
  v_mfma_f32_16x16x32_bf16 v[128:131], a[80:83], a[40:43], v[128:131]
  buffer_load_dwordx4 a[16:19], v224, s[4:7], s16 offen offset:0 sc1
  v_mfma_f32_16x16x32_bf16 v[184:187], a[80:83], a[44:47], v[184:187]
  ds_read_b64_tr_b16 a[80:81], v229 offset:43136
  ds_read_b64_tr_b16 a[82:83], v229 offset:46720
  v_mfma_f32_16x16x32_bf16 v[20:23], a[84:87], a[32:35], v[20:23]
  v_mfma_f32_16x16x32_bf16 v[76:79], a[84:87], a[36:39], v[76:79]
  buffer_load_dwordx4 a[20:23], v224, s[4:7], s16 offen offset:1024 sc1
  v_mfma_f32_16x16x32_bf16 v[132:135], a[84:87], a[40:43], v[132:135]
  v_mfma_f32_16x16x32_bf16 v[188:191], a[84:87], a[44:47], v[188:191]
  ds_read_b64_tr_b16 a[84:85], v229 offset:43168
  ds_read_b64_tr_b16 a[86:87], v229 offset:46752
  v_mfma_f32_16x16x32_bf16 v[24:27], a[88:91], a[32:35], v[24:27]
  buffer_load_dwordx4 a[24:27], v224, s[4:7], s16 offen offset:2048 sc1
  v_mfma_f32_16x16x32_bf16 v[80:83], a[88:91], a[36:39], v[80:83]
  v_mfma_f32_16x16x32_bf16 v[136:139], a[88:91], a[40:43], v[136:139]
  v_mfma_f32_16x16x32_bf16 v[192:195], a[88:91], a[44:47], v[192:195]
  buffer_load_dwordx4 a[28:31], v224, s[4:7], s16 offen offset:3072 sc1
  v_mfma_f32_16x16x32_bf16 v[28:31], a[92:95], a[32:35], v[28:31]
  ds_read_b64_tr_b16 a[88:89], v229 offset:43200
  ds_read_b64_tr_b16 a[90:91], v229 offset:46784
  v_mfma_f32_16x16x32_bf16 v[84:87], a[92:95], a[36:39], v[84:87]
  v_mfma_f32_16x16x32_bf16 v[140:143], a[92:95], a[40:43], v[140:143]
  s_add_u32 s16, s16, 131072
  v_mfma_f32_16x16x32_bf16 v[196:199], a[92:95], a[44:47], v[196:199]
  ds_read_b64_tr_b16 a[92:93], v229 offset:50176
  ds_read_b64_tr_b16 a[94:95], v229 offset:53760
  s_waitcnt lgkmcnt(10)
  v_mfma_f32_16x16x32_bf16 v[32:35], a[96:99], a[32:35], v[32:35]
  v_mfma_f32_16x16x32_bf16 v[88:91], a[96:99], a[36:39], v[88:91]
  buffer_load_dword v251, v249, s[52:55], s56 offen
  v_mfma_f32_16x16x32_bf16 v[144:147], a[96:99], a[40:43], v[144:147]
  v_mfma_f32_16x16x32_bf16 v[200:203], a[96:99], a[44:47], v[200:203]
  ds_read_b64_tr_b16 a[96:97], v229 offset:50208
  ds_read_b64_tr_b16 a[98:99], v229 offset:53792
  v_mfma_f32_16x16x32_bf16 v[36:39], a[100:103], a[32:35], v[36:39]
  s_add_u32 s56, s56, 0x80000
  v_mfma_f32_16x16x32_bf16 v[92:95], a[100:103], a[36:39], v[92:95]
  v_mfma_f32_16x16x32_bf16 v[148:151], a[100:103], a[40:43], v[148:151]
  v_mfma_f32_16x16x32_bf16 v[204:207], a[100:103], a[44:47], v[204:207]
  ds_read_b64_tr_b16 a[100:101], v229 offset:50240
  s_add_u32 s59, s59, 1
  v_mfma_f32_16x16x32_bf16 v[40:43], a[104:107], a[32:35], v[40:43]
  ds_read_b64_tr_b16 a[102:103], v229 offset:53824
  v_mfma_f32_16x16x32_bf16 v[96:99], a[104:107], a[36:39], v[96:99]
  v_mfma_f32_16x16x32_bf16 v[152:155], a[104:107], a[40:43], v[152:155]
  s_cmp_eq_u32 s59, 7
  v_mfma_f32_16x16x32_bf16 v[208:211], a[104:107], a[44:47], v[208:211]
  ds_read_b64_tr_b16 a[104:105], v229 offset:50272
  ds_read_b64_tr_b16 a[106:107], v229 offset:53856
  v_mfma_f32_16x16x32_bf16 v[44:47], a[108:111], a[32:35], v[44:47]
  v_mfma_f32_16x16x32_bf16 v[100:103], a[108:111], a[36:39], v[100:103]
  s_cselect_b32 s52, s22, s52
  v_mfma_f32_16x16x32_bf16 v[156:159], a[108:111], a[40:43], v[156:159]
  v_mfma_f32_16x16x32_bf16 v[212:215], a[108:111], a[44:47], v[212:215]
  ds_read_b64_tr_b16 a[108:109], v229 offset:50304
  ds_read_b64_tr_b16 a[110:111], v229 offset:53888
  v_mfma_f32_16x16x32_bf16 v[48:51], a[112:115], a[32:35], v[48:51]
  s_cselect_b32 s53, s23, s53
  v_mfma_f32_16x16x32_bf16 v[104:107], a[112:115], a[36:39], v[104:107]
  v_mfma_f32_16x16x32_bf16 v[160:163], a[112:115], a[40:43], v[160:163]
  v_mfma_f32_16x16x32_bf16 v[216:219], a[112:115], a[44:47], v[216:219]
  ds_read_b64_tr_b16 a[112:113], v229 offset:50336
  s_cselect_b32 s56, s60, s56
  v_mfma_f32_16x16x32_bf16 v[52:55], a[116:119], a[32:35], v[52:55]
  ds_read_b64_tr_b16 a[114:115], v229 offset:53920
  v_mfma_f32_16x16x32_bf16 v[108:111], a[116:119], a[36:39], v[108:111]
  v_mfma_f32_16x16x32_bf16 v[164:167], a[116:119], a[40:43], v[164:167]
  v_mfma_f32_16x16x32_bf16 v[220:223], a[116:119], a[44:47], v[220:223]
  s_waitcnt vmcnt(14) lgkmcnt(10)
  s_barrier
  v_mfma_f32_16x16x32_bf16 v[0:3], a[64:67], a[48:51], v[0:3]
  ds_read_b64_tr_b16 a[116:117], v229 offset:50368
  s_add_u32 m0, s38, 28672
  v_mfma_f32_16x16x32_bf16 v[56:59], a[64:67], a[52:55], v[56:59]
  ds_read_b64_tr_b16 a[118:119], v229 offset:53952
  v_mfma_f32_16x16x32_bf16 v[112:115], a[64:67], a[56:59], v[112:115]
  v_mfma_f32_16x16x32_bf16 v[168:171], a[64:67], a[60:63], v[168:171]
  ds_read_b64_tr_b16 a[64:65], v229 offset:0
  ds_read_b64_tr_b16 a[66:67], v229 offset:3584
  v_mfma_f32_16x16x32_bf16 v[4:7], a[68:71], a[48:51], v[4:7]
  v_mfma_f32_16x16x32_bf16 v[60:63], a[68:71], a[52:55], v[60:63]
  buffer_load_dwordx4 v225, s[8:11], s17 offen lds
  v_mfma_f32_16x16x32_bf16 v[116:119], a[68:71], a[56:59], v[116:119]
  v_mfma_f32_16x16x32_bf16 v[172:175], a[68:71], a[60:63], v[172:175]
  ds_read_b64_tr_b16 a[68:69], v229 offset:32
  ds_read_b64_tr_b16 a[70:71], v229 offset:3616
  v_mfma_f32_16x16x32_bf16 v[8:11], a[72:75], a[48:51], v[8:11]
  v_mfma_f32_16x16x32_bf16 v[64:67], a[72:75], a[52:55], v[64:67]
  v_mfma_f32_16x16x32_bf16 v[120:123], a[72:75], a[56:59], v[120:123]
  buffer_load_dwordx4 v226, s[8:11], s17 offen offset:1024 lds
  v_mfma_f32_16x16x32_bf16 v[176:179], a[72:75], a[60:63], v[176:179]
  ds_read_b64_tr_b16 a[72:73], v229 offset:64
  ds_read_b64_tr_b16 a[74:75], v229 offset:3648
  v_mfma_f32_16x16x32_bf16 v[12:15], a[76:79], a[48:51], v[12:15]
  v_mfma_f32_16x16x32_bf16 v[68:71], a[76:79], a[52:55], v[68:71]
  v_mfma_f32_16x16x32_bf16 v[124:127], a[76:79], a[56:59], v[124:127]
  v_mfma_f32_16x16x32_bf16 v[180:183], a[76:79], a[60:63], v[180:183]
  buffer_load_dwordx4 v227, s[8:11], s17 offen offset:2048 lds
  v_mfma_f32_16x16x32_bf16 v[16:19], a[80:83], a[48:51], v[16:19]
  ds_read_b64_tr_b16 a[76:77], v229 offset:96
  ds_read_b64_tr_b16 a[78:79], v229 offset:3680
  v_mfma_f32_16x16x32_bf16 v[72:75], a[80:83], a[52:55], v[72:75]
  v_mfma_f32_16x16x32_bf16 v[128:131], a[80:83], a[56:59], v[128:131]
  v_mfma_f32_16x16x32_bf16 v[184:187], a[80:83], a[60:63], v[184:187]
  ds_read_b64_tr_b16 a[80:81], v229 offset:128
  ds_read_b64_tr_b16 a[82:83], v229 offset:3712
  v_mfma_f32_16x16x32_bf16 v[20:23], a[84:87], a[48:51], v[20:23]
  s_mov_b32 exec_hi, 0
  buffer_load_dwordx4 v228, s[8:11], s17 offen offset:3072 lds
  s_mov_b32 exec_hi, -1
  v_mfma_f32_16x16x32_bf16 v[76:79], a[84:87], a[52:55], v[76:79]
  v_mfma_f32_16x16x32_bf16 v[132:135], a[84:87], a[56:59], v[132:135]
  v_mfma_f32_16x16x32_bf16 v[188:191], a[84:87], a[60:63], v[188:191]
  ds_read_b64_tr_b16 a[84:85], v229 offset:160
  ds_read_b64_tr_b16 a[86:87], v229 offset:3744
  v_mfma_f32_16x16x32_bf16 v[24:27], a[88:91], a[48:51], v[24:27]
  v_mfma_f32_16x16x32_bf16 v[80:83], a[88:91], a[52:55], v[80:83]
  s_add_u32 s17, s17, 229376
  v_mfma_f32_16x16x32_bf16 v[136:139], a[88:91], a[56:59], v[136:139]
  v_mfma_f32_16x16x32_bf16 v[192:195], a[88:91], a[60:63], v[192:195]
  ds_read_b64_tr_b16 a[88:89], v229 offset:192
  ds_read_b64_tr_b16 a[90:91], v229 offset:3776
  v_mfma_f32_16x16x32_bf16 v[28:31], a[92:95], a[48:51], v[28:31]
  v_mfma_f32_16x16x32_bf16 v[84:87], a[92:95], a[52:55], v[84:87]
  v_mfma_f32_16x16x32_bf16 v[140:143], a[92:95], a[56:59], v[140:143]
  buffer_load_dwordx4 a[32:35], v224, s[4:7], s16 offen offset:0 sc1
  v_mfma_f32_16x16x32_bf16 v[196:199], a[92:95], a[60:63], v[196:199]
  ds_read_b64_tr_b16 a[92:93], v229 offset:7168
  ds_read_b64_tr_b16 a[94:95], v229 offset:10752
  s_waitcnt lgkmcnt(10)
  v_mfma_f32_16x16x32_bf16 v[32:35], a[96:99], a[48:51], v[32:35]
  v_mfma_f32_16x16x32_bf16 v[88:91], a[96:99], a[52:55], v[88:91]
  v_mfma_f32_16x16x32_bf16 v[144:147], a[96:99], a[56:59], v[144:147]
  v_mfma_f32_16x16x32_bf16 v[200:203], a[96:99], a[60:63], v[200:203]
  buffer_load_dwordx4 a[36:39], v224, s[4:7], s16 offen offset:1024 sc1
  v_mfma_f32_16x16x32_bf16 v[36:39], a[100:103], a[48:51], v[36:39]
  ds_read_b64_tr_b16 a[96:97], v229 offset:7200
  ds_read_b64_tr_b16 a[98:99], v229 offset:10784
  v_mfma_f32_16x16x32_bf16 v[92:95], a[100:103], a[52:55], v[92:95]
  v_mfma_f32_16x16x32_bf16 v[148:151], a[100:103], a[56:59], v[148:151]
  v_mfma_f32_16x16x32_bf16 v[204:207], a[100:103], a[60:63], v[204:207]
  ds_read_b64_tr_b16 a[100:101], v229 offset:7232
  ds_read_b64_tr_b16 a[102:103], v229 offset:10816
  v_mfma_f32_16x16x32_bf16 v[40:43], a[104:107], a[48:51], v[40:43]
  buffer_load_dwordx4 a[40:43], v224, s[4:7], s16 offen offset:2048 sc1
  v_mfma_f32_16x16x32_bf16 v[96:99], a[104:107], a[52:55], v[96:99]
  v_mfma_f32_16x16x32_bf16 v[152:155], a[104:107], a[56:59], v[152:155]
  v_mfma_f32_16x16x32_bf16 v[208:211], a[104:107], a[60:63], v[208:211]
  ds_read_b64_tr_b16 a[104:105], v229 offset:7264
  ds_read_b64_tr_b16 a[106:107], v229 offset:10848
  v_mfma_f32_16x16x32_bf16 v[44:47], a[108:111], a[48:51], v[44:47]
  v_mfma_f32_16x16x32_bf16 v[100:103], a[108:111], a[52:55], v[100:103]
  buffer_load_dwordx4 a[44:47], v224, s[4:7], s16 offen offset:3072 sc1
  v_mfma_f32_16x16x32_bf16 v[156:159], a[108:111], a[56:59], v[156:159]
  v_mfma_f32_16x16x32_bf16 v[212:215], a[108:111], a[60:63], v[212:215]
  ds_read_b64_tr_b16 a[108:109], v229 offset:7296
  ds_read_b64_tr_b16 a[110:111], v229 offset:10880
  v_mfma_f32_16x16x32_bf16 v[48:51], a[112:115], a[48:51], v[48:51]
  v_mfma_f32_16x16x32_bf16 v[104:107], a[112:115], a[52:55], v[104:107]
  v_mfma_f32_16x16x32_bf16 v[160:163], a[112:115], a[56:59], v[160:163]
  s_add_u32 s16, s16, 131072
  v_mfma_f32_16x16x32_bf16 v[216:219], a[112:115], a[60:63], v[216:219]
  ds_read_b64_tr_b16 a[112:113], v229 offset:7328
  ds_read_b64_tr_b16 a[114:115], v229 offset:10912
  v_mfma_f32_16x16x32_bf16 v[52:55], a[116:119], a[48:51], v[52:55]
  v_mfma_f32_16x16x32_bf16 v[108:111], a[116:119], a[52:55], v[108:111]
  v_mfma_f32_16x16x32_bf16 v[164:167], a[116:119], a[56:59], v[164:167]
  v_mfma_f32_16x16x32_bf16 v[220:223], a[116:119], a[60:63], v[220:223]
  s_mov_b32 s18, 5
  .p2align 6
L_loop_24:
  s_waitcnt vmcnt(13) lgkmcnt(10)
  s_barrier
  v_mfma_f32_16x16x32_bf16 v[0:3], a[64:67], a[0:3], v[0:3]
  ds_read_b64_tr_b16 a[116:117], v229 offset:7360
  s_add_u32 m0, s38, 43008
  v_mfma_f32_16x16x32_bf16 v[56:59], a[64:67], a[4:7], v[56:59]
  ds_read_b64_tr_b16 a[118:119], v229 offset:10944
  v_mfma_f32_16x16x32_bf16 v[112:115], a[64:67], a[8:11], v[112:115]
  v_mfma_f32_16x16x32_bf16 v[168:171], a[64:67], a[12:15], v[168:171]
  buffer_load_dwordx4 v225, s[8:11], s17 offen lds
  v_mfma_f32_16x16x32_bf16 v[4:7], a[68:71], a[0:3], v[4:7]
  ds_read_b64_tr_b16 a[64:65], v229 offset:14336
  ds_read_b64_tr_b16 a[66:67], v229 offset:17920
  v_mfma_f32_16x16x32_bf16 v[60:63], a[68:71], a[4:7], v[60:63]
  v_mfma_f32_16x16x32_bf16 v[116:119], a[68:71], a[8:11], v[116:119]
  buffer_load_dwordx4 v226, s[8:11], s17 offen offset:1024 lds
  v_mfma_f32_16x16x32_bf16 v[172:175], a[68:71], a[12:15], v[172:175]
  ds_read_b64_tr_b16 a[68:69], v229 offset:14368
  ds_read_b64_tr_b16 a[70:71], v229 offset:17952
  v_mfma_f32_16x16x32_bf16 v[8:11], a[72:75], a[0:3], v[8:11]
  v_mfma_f32_16x16x32_bf16 v[64:67], a[72:75], a[4:7], v[64:67]
  buffer_load_dwordx4 v227, s[8:11], s17 offen offset:2048 lds
  v_mfma_f32_16x16x32_bf16 v[120:123], a[72:75], a[8:11], v[120:123]
  v_mfma_f32_16x16x32_bf16 v[176:179], a[72:75], a[12:15], v[176:179]
  ds_read_b64_tr_b16 a[72:73], v229 offset:14400
  ds_read_b64_tr_b16 a[74:75], v229 offset:17984
  v_mfma_f32_16x16x32_bf16 v[12:15], a[76:79], a[0:3], v[12:15]
  s_mov_b32 exec_hi, 0
  buffer_load_dwordx4 v228, s[8:11], s17 offen offset:3072 lds
  s_mov_b32 exec_hi, -1
  v_mfma_f32_16x16x32_bf16 v[68:71], a[76:79], a[4:7], v[68:71]
  v_mfma_f32_16x16x32_bf16 v[124:127], a[76:79], a[8:11], v[124:127]
  v_mfma_f32_16x16x32_bf16 v[180:183], a[76:79], a[12:15], v[180:183]
  ds_read_b64_tr_b16 a[76:77], v229 offset:14432
  s_add_u32 s17, s17, 229376
  v_mfma_f32_16x16x32_bf16 v[16:19], a[80:83], a[0:3], v[16:19]
  ds_read_b64_tr_b16 a[78:79], v229 offset:18016
  v_mfma_f32_16x16x32_bf16 v[72:75], a[80:83], a[4:7], v[72:75]
  v_mfma_f32_16x16x32_bf16 v[128:131], a[80:83], a[8:11], v[128:131]
  buffer_load_dwordx4 a[48:51], v224, s[4:7], s16 offen offset:0 sc1
  v_mfma_f32_16x16x32_bf16 v[184:187], a[80:83], a[12:15], v[184:187]
  ds_read_b64_tr_b16 a[80:81], v229 offset:14464
  ds_read_b64_tr_b16 a[82:83], v229 offset:18048
  v_mfma_f32_16x16x32_bf16 v[20:23], a[84:87], a[0:3], v[20:23]
  v_mfma_f32_16x16x32_bf16 v[76:79], a[84:87], a[4:7], v[76:79]
  buffer_load_dwordx4 a[52:55], v224, s[4:7], s16 offen offset:1024 sc1
  v_mfma_f32_16x16x32_bf16 v[132:135], a[84:87], a[8:11], v[132:135]
  v_mfma_f32_16x16x32_bf16 v[188:191], a[84:87], a[12:15], v[188:191]
  ds_read_b64_tr_b16 a[84:85], v229 offset:14496
  ds_read_b64_tr_b16 a[86:87], v229 offset:18080
  v_mfma_f32_16x16x32_bf16 v[24:27], a[88:91], a[0:3], v[24:27]
  buffer_load_dwordx4 a[56:59], v224, s[4:7], s16 offen offset:2048 sc1
  v_mfma_f32_16x16x32_bf16 v[80:83], a[88:91], a[4:7], v[80:83]
  v_mfma_f32_16x16x32_bf16 v[136:139], a[88:91], a[8:11], v[136:139]
  v_mfma_f32_16x16x32_bf16 v[192:195], a[88:91], a[12:15], v[192:195]
  buffer_load_dwordx4 a[60:63], v224, s[4:7], s16 offen offset:3072 sc1
  v_mfma_f32_16x16x32_bf16 v[28:31], a[92:95], a[0:3], v[28:31]
  ds_read_b64_tr_b16 a[88:89], v229 offset:14528
  ds_read_b64_tr_b16 a[90:91], v229 offset:18112
  v_mfma_f32_16x16x32_bf16 v[84:87], a[92:95], a[4:7], v[84:87]
  v_mfma_f32_16x16x32_bf16 v[140:143], a[92:95], a[8:11], v[140:143]
  s_add_u32 s16, s16, 131072
  v_mfma_f32_16x16x32_bf16 v[196:199], a[92:95], a[12:15], v[196:199]
  ds_read_b64_tr_b16 a[92:93], v229 offset:21504
  ds_read_b64_tr_b16 a[94:95], v229 offset:25088
  s_waitcnt lgkmcnt(10)
  v_mfma_f32_16x16x32_bf16 v[32:35], a[96:99], a[0:3], v[32:35]
  v_mfma_f32_16x16x32_bf16 v[88:91], a[96:99], a[4:7], v[88:91]
  buffer_load_dword v251, v249, s[52:55], s56 offen
  v_mfma_f32_16x16x32_bf16 v[144:147], a[96:99], a[8:11], v[144:147]
  v_mfma_f32_16x16x32_bf16 v[200:203], a[96:99], a[12:15], v[200:203]
  ds_read_b64_tr_b16 a[96:97], v229 offset:21536
  ds_read_b64_tr_b16 a[98:99], v229 offset:25120
  v_mfma_f32_16x16x32_bf16 v[36:39], a[100:103], a[0:3], v[36:39]
  s_add_u32 s56, s56, 0x80000
  v_mfma_f32_16x16x32_bf16 v[92:95], a[100:103], a[4:7], v[92:95]
  v_mfma_f32_16x16x32_bf16 v[148:151], a[100:103], a[8:11], v[148:151]
  v_mfma_f32_16x16x32_bf16 v[204:207], a[100:103], a[12:15], v[204:207]
  ds_read_b64_tr_b16 a[100:101], v229 offset:21568
  s_add_u32 s59, s59, 1
  v_mfma_f32_16x16x32_bf16 v[40:43], a[104:107], a[0:3], v[40:43]
  ds_read_b64_tr_b16 a[102:103], v229 offset:25152
  v_mfma_f32_16x16x32_bf16 v[96:99], a[104:107], a[4:7], v[96:99]
  v_mfma_f32_16x16x32_bf16 v[152:155], a[104:107], a[8:11], v[152:155]
  s_cmp_eq_u32 s59, 7
  v_mfma_f32_16x16x32_bf16 v[208:211], a[104:107], a[12:15], v[208:211]
  ds_read_b64_tr_b16 a[104:105], v229 offset:21600
  ds_read_b64_tr_b16 a[106:107], v229 offset:25184
  v_mfma_f32_16x16x32_bf16 v[44:47], a[108:111], a[0:3], v[44:47]
  v_mfma_f32_16x16x32_bf16 v[100:103], a[108:111], a[4:7], v[100:103]
  s_cselect_b32 s52, s22, s52
  v_mfma_f32_16x16x32_bf16 v[156:159], a[108:111], a[8:11], v[156:159]
  v_mfma_f32_16x16x32_bf16 v[212:215], a[108:111], a[12:15], v[212:215]
  ds_read_b64_tr_b16 a[108:109], v229 offset:21632
  ds_read_b64_tr_b16 a[110:111], v229 offset:25216
  v_mfma_f32_16x16x32_bf16 v[48:51], a[112:115], a[0:3], v[48:51]
  s_cselect_b32 s53, s23, s53
  v_mfma_f32_16x16x32_bf16 v[104:107], a[112:115], a[4:7], v[104:107]
  v_mfma_f32_16x16x32_bf16 v[160:163], a[112:115], a[8:11], v[160:163]
  v_mfma_f32_16x16x32_bf16 v[216:219], a[112:115], a[12:15], v[216:219]
  ds_read_b64_tr_b16 a[112:113], v229 offset:21664
  s_cselect_b32 s56, s60, s56
  v_mfma_f32_16x16x32_bf16 v[52:55], a[116:119], a[0:3], v[52:55]
  ds_read_b64_tr_b16 a[114:115], v229 offset:25248
  v_mfma_f32_16x16x32_bf16 v[108:111], a[116:119], a[4:7], v[108:111]
  v_mfma_f32_16x16x32_bf16 v[164:167], a[116:119], a[8:11], v[164:167]
  v_mfma_f32_16x16x32_bf16 v[220:223], a[116:119], a[12:15], v[220:223]
  s_waitcnt vmcnt(13) lgkmcnt(10)
  s_barrier
  v_mfma_f32_16x16x32_bf16 v[0:3], a[64:67], a[16:19], v[0:3]
  ds_read_b64_tr_b16 a[116:117], v229 offset:21696
  s_add_u32 m0, s38, 0
  v_mfma_f32_16x16x32_bf16 v[56:59], a[64:67], a[20:23], v[56:59]
  ds_read_b64_tr_b16 a[118:119], v229 offset:25280
  v_mfma_f32_16x16x32_bf16 v[112:115], a[64:67], a[24:27], v[112:115]
  v_mfma_f32_16x16x32_bf16 v[168:171], a[64:67], a[28:31], v[168:171]
  ds_read_b64_tr_b16 a[64:65], v229 offset:28672
  ds_read_b64_tr_b16 a[66:67], v229 offset:32256
  v_mfma_f32_16x16x32_bf16 v[4:7], a[68:71], a[16:19], v[4:7]
  v_mfma_f32_16x16x32_bf16 v[60:63], a[68:71], a[20:23], v[60:63]
  buffer_load_dwordx4 v225, s[8:11], s17 offen lds
  v_mfma_f32_16x16x32_bf16 v[116:119], a[68:71], a[24:27], v[116:119]
  v_mfma_f32_16x16x32_bf16 v[172:175], a[68:71], a[28:31], v[172:175]
  ds_read_b64_tr_b16 a[68:69], v229 offset:28704
  ds_read_b64_tr_b16 a[70:71], v229 offset:32288
  v_mfma_f32_16x16x32_bf16 v[8:11], a[72:75], a[16:19], v[8:11]
  v_mfma_f32_16x16x32_bf16 v[64:67], a[72:75], a[20:23], v[64:67]
  v_mfma_f32_16x16x32_bf16 v[120:123], a[72:75], a[24:27], v[120:123]
  buffer_load_dwordx4 v226, s[8:11], s17 offen offset:1024 lds
  v_mfma_f32_16x16x32_bf16 v[176:179], a[72:75], a[28:31], v[176:179]
  ds_read_b64_tr_b16 a[72:73], v229 offset:28736
  ds_read_b64_tr_b16 a[74:75], v229 offset:32320
  v_mfma_f32_16x16x32_bf16 v[12:15], a[76:79], a[16:19], v[12:15]
  v_mfma_f32_16x16x32_bf16 v[68:71], a[76:79], a[20:23], v[68:71]
  v_mfma_f32_16x16x32_bf16 v[124:127], a[76:79], a[24:27], v[124:127]
  v_mfma_f32_16x16x32_bf16 v[180:183], a[76:79], a[28:31], v[180:183]
  buffer_load_dwordx4 v227, s[8:11], s17 offen offset:2048 lds
  v_mfma_f32_16x16x32_bf16 v[16:19], a[80:83], a[16:19], v[16:19]
  ds_read_b64_tr_b16 a[76:77], v229 offset:28768
  ds_read_b64_tr_b16 a[78:79], v229 offset:32352
  v_mfma_f32_16x16x32_bf16 v[72:75], a[80:83], a[20:23], v[72:75]
  v_mfma_f32_16x16x32_bf16 v[128:131], a[80:83], a[24:27], v[128:131]
  v_mfma_f32_16x16x32_bf16 v[184:187], a[80:83], a[28:31], v[184:187]
  ds_read_b64_tr_b16 a[80:81], v229 offset:28800
  ds_read_b64_tr_b16 a[82:83], v229 offset:32384
  v_mfma_f32_16x16x32_bf16 v[20:23], a[84:87], a[16:19], v[20:23]
  s_mov_b32 exec_hi, 0
  buffer_load_dwordx4 v228, s[8:11], s17 offen offset:3072 lds
  s_mov_b32 exec_hi, -1
  v_mfma_f32_16x16x32_bf16 v[76:79], a[84:87], a[20:23], v[76:79]
  v_mfma_f32_16x16x32_bf16 v[132:135], a[84:87], a[24:27], v[132:135]
  v_mfma_f32_16x16x32_bf16 v[188:191], a[84:87], a[28:31], v[188:191]
  ds_read_b64_tr_b16 a[84:85], v229 offset:28832
  ds_read_b64_tr_b16 a[86:87], v229 offset:32416
  v_mfma_f32_16x16x32_bf16 v[24:27], a[88:91], a[16:19], v[24:27]
  v_mfma_f32_16x16x32_bf16 v[80:83], a[88:91], a[20:23], v[80:83]
  s_add_u32 s17, s17, 229376
  v_mfma_f32_16x16x32_bf16 v[136:139], a[88:91], a[24:27], v[136:139]
  v_mfma_f32_16x16x32_bf16 v[192:195], a[88:91], a[28:31], v[192:195]
  ds_read_b64_tr_b16 a[88:89], v229 offset:28864
  ds_read_b64_tr_b16 a[90:91], v229 offset:32448
  v_mfma_f32_16x16x32_bf16 v[28:31], a[92:95], a[16:19], v[28:31]
  v_mfma_f32_16x16x32_bf16 v[84:87], a[92:95], a[20:23], v[84:87]
  v_mfma_f32_16x16x32_bf16 v[140:143], a[92:95], a[24:27], v[140:143]
  buffer_load_dwordx4 a[0:3], v224, s[4:7], s16 offen offset:0 sc1
  v_mfma_f32_16x16x32_bf16 v[196:199], a[92:95], a[28:31], v[196:199]
  ds_read_b64_tr_b16 a[92:93], v229 offset:35840
  ds_read_b64_tr_b16 a[94:95], v229 offset:39424
  s_waitcnt lgkmcnt(10)
  v_mfma_f32_16x16x32_bf16 v[32:35], a[96:99], a[16:19], v[32:35]
  v_mfma_f32_16x16x32_bf16 v[88:91], a[96:99], a[20:23], v[88:91]
  v_mfma_f32_16x16x32_bf16 v[144:147], a[96:99], a[24:27], v[144:147]
  v_mfma_f32_16x16x32_bf16 v[200:203], a[96:99], a[28:31], v[200:203]
  buffer_load_dwordx4 a[4:7], v224, s[4:7], s16 offen offset:1024 sc1
  v_mfma_f32_16x16x32_bf16 v[36:39], a[100:103], a[16:19], v[36:39]
  ds_read_b64_tr_b16 a[96:97], v229 offset:35872
  ds_read_b64_tr_b16 a[98:99], v229 offset:39456
  v_mfma_f32_16x16x32_bf16 v[92:95], a[100:103], a[20:23], v[92:95]
  v_mfma_f32_16x16x32_bf16 v[148:151], a[100:103], a[24:27], v[148:151]
  v_mfma_f32_16x16x32_bf16 v[204:207], a[100:103], a[28:31], v[204:207]
  ds_read_b64_tr_b16 a[100:101], v229 offset:35904
  ds_read_b64_tr_b16 a[102:103], v229 offset:39488
  v_mfma_f32_16x16x32_bf16 v[40:43], a[104:107], a[16:19], v[40:43]
  buffer_load_dwordx4 a[8:11], v224, s[4:7], s16 offen offset:2048 sc1
  v_mfma_f32_16x16x32_bf16 v[96:99], a[104:107], a[20:23], v[96:99]
  v_mfma_f32_16x16x32_bf16 v[152:155], a[104:107], a[24:27], v[152:155]
  v_mfma_f32_16x16x32_bf16 v[208:211], a[104:107], a[28:31], v[208:211]
  ds_read_b64_tr_b16 a[104:105], v229 offset:35936
  ds_read_b64_tr_b16 a[106:107], v229 offset:39520
  v_mfma_f32_16x16x32_bf16 v[44:47], a[108:111], a[16:19], v[44:47]
  v_mfma_f32_16x16x32_bf16 v[100:103], a[108:111], a[20:23], v[100:103]
  buffer_load_dwordx4 a[12:15], v224, s[4:7], s16 offen offset:3072 sc1
  v_mfma_f32_16x16x32_bf16 v[156:159], a[108:111], a[24:27], v[156:159]
  v_mfma_f32_16x16x32_bf16 v[212:215], a[108:111], a[28:31], v[212:215]
  ds_read_b64_tr_b16 a[108:109], v229 offset:35968
  ds_read_b64_tr_b16 a[110:111], v229 offset:39552
  v_mfma_f32_16x16x32_bf16 v[48:51], a[112:115], a[16:19], v[48:51]
  v_mfma_f32_16x16x32_bf16 v[104:107], a[112:115], a[20:23], v[104:107]
  v_mfma_f32_16x16x32_bf16 v[160:163], a[112:115], a[24:27], v[160:163]
  s_add_u32 s16, s16, 131072
  v_mfma_f32_16x16x32_bf16 v[216:219], a[112:115], a[28:31], v[216:219]
  ds_read_b64_tr_b16 a[112:113], v229 offset:36000
  ds_read_b64_tr_b16 a[114:115], v229 offset:39584
  v_mfma_f32_16x16x32_bf16 v[52:55], a[116:119], a[16:19], v[52:55]
  v_mfma_f32_16x16x32_bf16 v[108:111], a[116:119], a[20:23], v[108:111]
  v_mfma_f32_16x16x32_bf16 v[164:167], a[116:119], a[24:27], v[164:167]
  v_mfma_f32_16x16x32_bf16 v[220:223], a[116:119], a[28:31], v[220:223]
  s_waitcnt vmcnt(13) lgkmcnt(10)
  s_barrier
  v_mfma_f32_16x16x32_bf16 v[0:3], a[64:67], a[32:35], v[0:3]
  ds_read_b64_tr_b16 a[116:117], v229 offset:36032
  s_add_u32 m0, s38, 14336
  v_mfma_f32_16x16x32_bf16 v[56:59], a[64:67], a[36:39], v[56:59]
  ds_read_b64_tr_b16 a[118:119], v229 offset:39616
  v_mfma_f32_16x16x32_bf16 v[112:115], a[64:67], a[40:43], v[112:115]
  v_mfma_f32_16x16x32_bf16 v[168:171], a[64:67], a[44:47], v[168:171]
  buffer_load_dwordx4 v225, s[8:11], s17 offen lds
  v_mfma_f32_16x16x32_bf16 v[4:7], a[68:71], a[32:35], v[4:7]
  ds_read_b64_tr_b16 a[64:65], v229 offset:43008
  ds_read_b64_tr_b16 a[66:67], v229 offset:46592
  v_mfma_f32_16x16x32_bf16 v[60:63], a[68:71], a[36:39], v[60:63]
  v_mfma_f32_16x16x32_bf16 v[116:119], a[68:71], a[40:43], v[116:119]
  buffer_load_dwordx4 v226, s[8:11], s17 offen offset:1024 lds
  v_mfma_f32_16x16x32_bf16 v[172:175], a[68:71], a[44:47], v[172:175]
  ds_read_b64_tr_b16 a[68:69], v229 offset:43040
  ds_read_b64_tr_b16 a[70:71], v229 offset:46624
  v_mfma_f32_16x16x32_bf16 v[8:11], a[72:75], a[32:35], v[8:11]
  v_mfma_f32_16x16x32_bf16 v[64:67], a[72:75], a[36:39], v[64:67]
  buffer_load_dwordx4 v227, s[8:11], s17 offen offset:2048 lds
  v_mfma_f32_16x16x32_bf16 v[120:123], a[72:75], a[40:43], v[120:123]
  v_mfma_f32_16x16x32_bf16 v[176:179], a[72:75], a[44:47], v[176:179]
  ds_read_b64_tr_b16 a[72:73], v229 offset:43072
  ds_read_b64_tr_b16 a[74:75], v229 offset:46656
  v_mfma_f32_16x16x32_bf16 v[12:15], a[76:79], a[32:35], v[12:15]
  s_mov_b32 exec_hi, 0
  buffer_load_dwordx4 v228, s[8:11], s17 offen offset:3072 lds
  s_mov_b32 exec_hi, -1
  v_mfma_f32_16x16x32_bf16 v[68:71], a[76:79], a[36:39], v[68:71]
  v_mfma_f32_16x16x32_bf16 v[124:127], a[76:79], a[40:43], v[124:127]
  v_mfma_f32_16x16x32_bf16 v[180:183], a[76:79], a[44:47], v[180:183]
  ds_read_b64_tr_b16 a[76:77], v229 offset:43104
  s_add_u32 s17, s17, 229376
  v_mfma_f32_16x16x32_bf16 v[16:19], a[80:83], a[32:35], v[16:19]
  ds_read_b64_tr_b16 a[78:79], v229 offset:46688
  v_mfma_f32_16x16x32_bf16 v[72:75], a[80:83], a[36:39], v[72:75]
  v_mfma_f32_16x16x32_bf16 v[128:131], a[80:83], a[40:43], v[128:131]
  buffer_load_dwordx4 a[16:19], v224, s[4:7], s16 offen offset:0 sc1
  v_mfma_f32_16x16x32_bf16 v[184:187], a[80:83], a[44:47], v[184:187]
  ds_read_b64_tr_b16 a[80:81], v229 offset:43136
  ds_read_b64_tr_b16 a[82:83], v229 offset:46720
  v_mfma_f32_16x16x32_bf16 v[20:23], a[84:87], a[32:35], v[20:23]
  v_mfma_f32_16x16x32_bf16 v[76:79], a[84:87], a[36:39], v[76:79]
  buffer_load_dwordx4 a[20:23], v224, s[4:7], s16 offen offset:1024 sc1
  v_mfma_f32_16x16x32_bf16 v[132:135], a[84:87], a[40:43], v[132:135]
  v_mfma_f32_16x16x32_bf16 v[188:191], a[84:87], a[44:47], v[188:191]
  ds_read_b64_tr_b16 a[84:85], v229 offset:43168
  ds_read_b64_tr_b16 a[86:87], v229 offset:46752
  v_mfma_f32_16x16x32_bf16 v[24:27], a[88:91], a[32:35], v[24:27]
  buffer_load_dwordx4 a[24:27], v224, s[4:7], s16 offen offset:2048 sc1
  v_mfma_f32_16x16x32_bf16 v[80:83], a[88:91], a[36:39], v[80:83]
  v_mfma_f32_16x16x32_bf16 v[136:139], a[88:91], a[40:43], v[136:139]
  v_mfma_f32_16x16x32_bf16 v[192:195], a[88:91], a[44:47], v[192:195]
  buffer_load_dwordx4 a[28:31], v224, s[4:7], s16 offen offset:3072 sc1
  v_mfma_f32_16x16x32_bf16 v[28:31], a[92:95], a[32:35], v[28:31]
  ds_read_b64_tr_b16 a[88:89], v229 offset:43200
  ds_read_b64_tr_b16 a[90:91], v229 offset:46784
  v_mfma_f32_16x16x32_bf16 v[84:87], a[92:95], a[36:39], v[84:87]
  v_mfma_f32_16x16x32_bf16 v[140:143], a[92:95], a[40:43], v[140:143]
  s_add_u32 s16, s16, 131072
  v_mfma_f32_16x16x32_bf16 v[196:199], a[92:95], a[44:47], v[196:199]
  ds_read_b64_tr_b16 a[92:93], v229 offset:50176
  ds_read_b64_tr_b16 a[94:95], v229 offset:53760
  s_waitcnt lgkmcnt(10)
  v_mfma_f32_16x16x32_bf16 v[32:35], a[96:99], a[32:35], v[32:35]
  v_mfma_f32_16x16x32_bf16 v[88:91], a[96:99], a[36:39], v[88:91]
  buffer_load_dword v251, v249, s[52:55], s56 offen
  v_mfma_f32_16x16x32_bf16 v[144:147], a[96:99], a[40:43], v[144:147]
  v_mfma_f32_16x16x32_bf16 v[200:203], a[96:99], a[44:47], v[200:203]
  ds_read_b64_tr_b16 a[96:97], v229 offset:50208
  ds_read_b64_tr_b16 a[98:99], v229 offset:53792
  v_mfma_f32_16x16x32_bf16 v[36:39], a[100:103], a[32:35], v[36:39]
  s_add_u32 s56, s56, 0x80000
  v_mfma_f32_16x16x32_bf16 v[92:95], a[100:103], a[36:39], v[92:95]
  v_mfma_f32_16x16x32_bf16 v[148:151], a[100:103], a[40:43], v[148:151]
  v_mfma_f32_16x16x32_bf16 v[204:207], a[100:103], a[44:47], v[204:207]
  ds_read_b64_tr_b16 a[100:101], v229 offset:50240
  s_add_u32 s59, s59, 1
  v_mfma_f32_16x16x32_bf16 v[40:43], a[104:107], a[32:35], v[40:43]
  ds_read_b64_tr_b16 a[102:103], v229 offset:53824
  v_mfma_f32_16x16x32_bf16 v[96:99], a[104:107], a[36:39], v[96:99]
  v_mfma_f32_16x16x32_bf16 v[152:155], a[104:107], a[40:43], v[152:155]
  s_cmp_eq_u32 s59, 7
  v_mfma_f32_16x16x32_bf16 v[208:211], a[104:107], a[44:47], v[208:211]
  ds_read_b64_tr_b16 a[104:105], v229 offset:50272
  ds_read_b64_tr_b16 a[106:107], v229 offset:53856
  v_mfma_f32_16x16x32_bf16 v[44:47], a[108:111], a[32:35], v[44:47]
  v_mfma_f32_16x16x32_bf16 v[100:103], a[108:111], a[36:39], v[100:103]
  s_cselect_b32 s52, s22, s52
  v_mfma_f32_16x16x32_bf16 v[156:159], a[108:111], a[40:43], v[156:159]
  v_mfma_f32_16x16x32_bf16 v[212:215], a[108:111], a[44:47], v[212:215]
  ds_read_b64_tr_b16 a[108:109], v229 offset:50304
  ds_read_b64_tr_b16 a[110:111], v229 offset:53888
  v_mfma_f32_16x16x32_bf16 v[48:51], a[112:115], a[32:35], v[48:51]
  s_cselect_b32 s53, s23, s53
  v_mfma_f32_16x16x32_bf16 v[104:107], a[112:115], a[36:39], v[104:107]
  v_mfma_f32_16x16x32_bf16 v[160:163], a[112:115], a[40:43], v[160:163]
  v_mfma_f32_16x16x32_bf16 v[216:219], a[112:115], a[44:47], v[216:219]
  ds_read_b64_tr_b16 a[112:113], v229 offset:50336
  s_cselect_b32 s56, s60, s56
  v_mfma_f32_16x16x32_bf16 v[52:55], a[116:119], a[32:35], v[52:55]
  ds_read_b64_tr_b16 a[114:115], v229 offset:53920
  v_mfma_f32_16x16x32_bf16 v[108:111], a[116:119], a[36:39], v[108:111]
  v_mfma_f32_16x16x32_bf16 v[164:167], a[116:119], a[40:43], v[164:167]
  v_mfma_f32_16x16x32_bf16 v[220:223], a[116:119], a[44:47], v[220:223]
  s_waitcnt vmcnt(13) lgkmcnt(10)
  s_barrier
  v_mfma_f32_16x16x32_bf16 v[0:3], a[64:67], a[48:51], v[0:3]
  ds_read_b64_tr_b16 a[116:117], v229 offset:50368
  s_add_u32 m0, s38, 28672
  v_mfma_f32_16x16x32_bf16 v[56:59], a[64:67], a[52:55], v[56:59]
  ds_read_b64_tr_b16 a[118:119], v229 offset:53952
  v_mfma_f32_16x16x32_bf16 v[112:115], a[64:67], a[56:59], v[112:115]
  v_mfma_f32_16x16x32_bf16 v[168:171], a[64:67], a[60:63], v[168:171]
  ds_read_b64_tr_b16 a[64:65], v229 offset:0
  ds_read_b64_tr_b16 a[66:67], v229 offset:3584
  v_mfma_f32_16x16x32_bf16 v[4:7], a[68:71], a[48:51], v[4:7]
  v_mfma_f32_16x16x32_bf16 v[60:63], a[68:71], a[52:55], v[60:63]
  buffer_load_dwordx4 v225, s[8:11], s17 offen lds
  v_mfma_f32_16x16x32_bf16 v[116:119], a[68:71], a[56:59], v[116:119]
  v_mfma_f32_16x16x32_bf16 v[172:175], a[68:71], a[60:63], v[172:175]
  ds_read_b64_tr_b16 a[68:69], v229 offset:32
  ds_read_b64_tr_b16 a[70:71], v229 offset:3616
  v_mfma_f32_16x16x32_bf16 v[8:11], a[72:75], a[48:51], v[8:11]
  v_mfma_f32_16x16x32_bf16 v[64:67], a[72:75], a[52:55], v[64:67]
  v_mfma_f32_16x16x32_bf16 v[120:123], a[72:75], a[56:59], v[120:123]
  buffer_load_dwordx4 v226, s[8:11], s17 offen offset:1024 lds
  v_mfma_f32_16x16x32_bf16 v[176:179], a[72:75], a[60:63], v[176:179]
  ds_read_b64_tr_b16 a[72:73], v229 offset:64
  ds_read_b64_tr_b16 a[74:75], v229 offset:3648
  v_mfma_f32_16x16x32_bf16 v[12:15], a[76:79], a[48:51], v[12:15]
  v_mfma_f32_16x16x32_bf16 v[68:71], a[76:79], a[52:55], v[68:71]
  v_mfma_f32_16x16x32_bf16 v[124:127], a[76:79], a[56:59], v[124:127]
  v_mfma_f32_16x16x32_bf16 v[180:183], a[76:79], a[60:63], v[180:183]
  buffer_load_dwordx4 v227, s[8:11], s17 offen offset:2048 lds
  v_mfma_f32_16x16x32_bf16 v[16:19], a[80:83], a[48:51], v[16:19]
  ds_read_b64_tr_b16 a[76:77], v229 offset:96
  ds_read_b64_tr_b16 a[78:79], v229 offset:3680
  v_mfma_f32_16x16x32_bf16 v[72:75], a[80:83], a[52:55], v[72:75]
  v_mfma_f32_16x16x32_bf16 v[128:131], a[80:83], a[56:59], v[128:131]
  v_mfma_f32_16x16x32_bf16 v[184:187], a[80:83], a[60:63], v[184:187]
  ds_read_b64_tr_b16 a[80:81], v229 offset:128
  ds_read_b64_tr_b16 a[82:83], v229 offset:3712
  v_mfma_f32_16x16x32_bf16 v[20:23], a[84:87], a[48:51], v[20:23]
  s_mov_b32 exec_hi, 0
  buffer_load_dwordx4 v228, s[8:11], s17 offen offset:3072 lds
  s_mov_b32 exec_hi, -1
  v_mfma_f32_16x16x32_bf16 v[76:79], a[84:87], a[52:55], v[76:79]
  v_mfma_f32_16x16x32_bf16 v[132:135], a[84:87], a[56:59], v[132:135]
  v_mfma_f32_16x16x32_bf16 v[188:191], a[84:87], a[60:63], v[188:191]
  ds_read_b64_tr_b16 a[84:85], v229 offset:160
  ds_read_b64_tr_b16 a[86:87], v229 offset:3744
  v_mfma_f32_16x16x32_bf16 v[24:27], a[88:91], a[48:51], v[24:27]
  v_mfma_f32_16x16x32_bf16 v[80:83], a[88:91], a[52:55], v[80:83]
  s_add_u32 s17, s17, 229376
  v_mfma_f32_16x16x32_bf16 v[136:139], a[88:91], a[56:59], v[136:139]
  v_mfma_f32_16x16x32_bf16 v[192:195], a[88:91], a[60:63], v[192:195]
  ds_read_b64_tr_b16 a[88:89], v229 offset:192
  ds_read_b64_tr_b16 a[90:91], v229 offset:3776
  v_mfma_f32_16x16x32_bf16 v[28:31], a[92:95], a[48:51], v[28:31]
  v_mfma_f32_16x16x32_bf16 v[84:87], a[92:95], a[52:55], v[84:87]
  v_mfma_f32_16x16x32_bf16 v[140:143], a[92:95], a[56:59], v[140:143]
  buffer_load_dwordx4 a[32:35], v224, s[4:7], s16 offen offset:0 sc1
  v_mfma_f32_16x16x32_bf16 v[196:199], a[92:95], a[60:63], v[196:199]
  ds_read_b64_tr_b16 a[92:93], v229 offset:7168
  ds_read_b64_tr_b16 a[94:95], v229 offset:10752
  s_waitcnt lgkmcnt(10)
  v_mfma_f32_16x16x32_bf16 v[32:35], a[96:99], a[48:51], v[32:35]
  v_mfma_f32_16x16x32_bf16 v[88:91], a[96:99], a[52:55], v[88:91]
  v_mfma_f32_16x16x32_bf16 v[144:147], a[96:99], a[56:59], v[144:147]
  v_mfma_f32_16x16x32_bf16 v[200:203], a[96:99], a[60:63], v[200:203]
  buffer_load_dwordx4 a[36:39], v224, s[4:7], s16 offen offset:1024 sc1
  v_mfma_f32_16x16x32_bf16 v[36:39], a[100:103], a[48:51], v[36:39]
  ds_read_b64_tr_b16 a[96:97], v229 offset:7200
  ds_read_b64_tr_b16 a[98:99], v229 offset:10784
  v_mfma_f32_16x16x32_bf16 v[92:95], a[100:103], a[52:55], v[92:95]
  v_mfma_f32_16x16x32_bf16 v[148:151], a[100:103], a[56:59], v[148:151]
  v_mfma_f32_16x16x32_bf16 v[204:207], a[100:103], a[60:63], v[204:207]
  ds_read_b64_tr_b16 a[100:101], v229 offset:7232
  ds_read_b64_tr_b16 a[102:103], v229 offset:10816
  v_mfma_f32_16x16x32_bf16 v[40:43], a[104:107], a[48:51], v[40:43]
  buffer_load_dwordx4 a[40:43], v224, s[4:7], s16 offen offset:2048 sc1
  v_mfma_f32_16x16x32_bf16 v[96:99], a[104:107], a[52:55], v[96:99]
  v_mfma_f32_16x16x32_bf16 v[152:155], a[104:107], a[56:59], v[152:155]
  v_mfma_f32_16x16x32_bf16 v[208:211], a[104:107], a[60:63], v[208:211]
  ds_read_b64_tr_b16 a[104:105], v229 offset:7264
  ds_read_b64_tr_b16 a[106:107], v229 offset:10848
  v_mfma_f32_16x16x32_bf16 v[44:47], a[108:111], a[48:51], v[44:47]
  v_mfma_f32_16x16x32_bf16 v[100:103], a[108:111], a[52:55], v[100:103]
  buffer_load_dwordx4 a[44:47], v224, s[4:7], s16 offen offset:3072 sc1
  v_mfma_f32_16x16x32_bf16 v[156:159], a[108:111], a[56:59], v[156:159]
  v_mfma_f32_16x16x32_bf16 v[212:215], a[108:111], a[60:63], v[212:215]
  ds_read_b64_tr_b16 a[108:109], v229 offset:7296
  ds_read_b64_tr_b16 a[110:111], v229 offset:10880
  v_mfma_f32_16x16x32_bf16 v[48:51], a[112:115], a[48:51], v[48:51]
  v_mfma_f32_16x16x32_bf16 v[104:107], a[112:115], a[52:55], v[104:107]
  v_mfma_f32_16x16x32_bf16 v[160:163], a[112:115], a[56:59], v[160:163]
  s_add_u32 s16, s16, 131072
  v_mfma_f32_16x16x32_bf16 v[216:219], a[112:115], a[60:63], v[216:219]
  ds_read_b64_tr_b16 a[112:113], v229 offset:7328
  ds_read_b64_tr_b16 a[114:115], v229 offset:10912
  v_mfma_f32_16x16x32_bf16 v[52:55], a[116:119], a[48:51], v[52:55]
  v_mfma_f32_16x16x32_bf16 v[108:111], a[116:119], a[52:55], v[108:111]
  v_mfma_f32_16x16x32_bf16 v[164:167], a[116:119], a[56:59], v[164:167]
  v_mfma_f32_16x16x32_bf16 v[220:223], a[116:119], a[60:63], v[220:223]
  s_sub_u32 s18, s18, 1
  s_cmp_lg_u32 s18, 0
  s_cbranch_scc1 L_loop_24
  s_waitcnt vmcnt(13) lgkmcnt(10)
  s_barrier
  v_mfma_f32_16x16x32_bf16 v[0:3], a[64:67], a[0:3], v[0:3]
  ds_read_b64_tr_b16 a[116:117], v229 offset:7360
  s_add_u32 m0, s38, 43008
  v_mfma_f32_16x16x32_bf16 v[56:59], a[64:67], a[4:7], v[56:59]
  ds_read_b64_tr_b16 a[118:119], v229 offset:10944
  v_mfma_f32_16x16x32_bf16 v[112:115], a[64:67], a[8:11], v[112:115]
  v_mfma_f32_16x16x32_bf16 v[168:171], a[64:67], a[12:15], v[168:171]
  buffer_load_dwordx4 v225, s[8:11], s17 offen lds
  v_mfma_f32_16x16x32_bf16 v[4:7], a[68:71], a[0:3], v[4:7]
  ds_read_b64_tr_b16 a[64:65], v229 offset:14336
  ds_read_b64_tr_b16 a[66:67], v229 offset:17920
  v_mfma_f32_16x16x32_bf16 v[60:63], a[68:71], a[4:7], v[60:63]
  v_mfma_f32_16x16x32_bf16 v[116:119], a[68:71], a[8:11], v[116:119]
  buffer_load_dwordx4 v226, s[8:11], s17 offen offset:1024 lds
  v_mfma_f32_16x16x32_bf16 v[172:175], a[68:71], a[12:15], v[172:175]
  ds_read_b64_tr_b16 a[68:69], v229 offset:14368
  ds_read_b64_tr_b16 a[70:71], v229 offset:17952
  v_mfma_f32_16x16x32_bf16 v[8:11], a[72:75], a[0:3], v[8:11]
  v_mfma_f32_16x16x32_bf16 v[64:67], a[72:75], a[4:7], v[64:67]
  buffer_load_dwordx4 v227, s[8:11], s17 offen offset:2048 lds
  v_mfma_f32_16x16x32_bf16 v[120:123], a[72:75], a[8:11], v[120:123]
  v_mfma_f32_16x16x32_bf16 v[176:179], a[72:75], a[12:15], v[176:179]
  ds_read_b64_tr_b16 a[72:73], v229 offset:14400
  ds_read_b64_tr_b16 a[74:75], v229 offset:17984
  v_mfma_f32_16x16x32_bf16 v[12:15], a[76:79], a[0:3], v[12:15]
  s_mov_b32 exec_hi, 0
  buffer_load_dwordx4 v228, s[8:11], s17 offen offset:3072 lds
  s_mov_b32 exec_hi, -1
  v_mfma_f32_16x16x32_bf16 v[68:71], a[76:79], a[4:7], v[68:71]
  v_mfma_f32_16x16x32_bf16 v[124:127], a[76:79], a[8:11], v[124:127]
  v_mfma_f32_16x16x32_bf16 v[180:183], a[76:79], a[12:15], v[180:183]
  ds_read_b64_tr_b16 a[76:77], v229 offset:14432
  s_add_u32 s17, s17, 229376
  v_mfma_f32_16x16x32_bf16 v[16:19], a[80:83], a[0:3], v[16:19]
  ds_read_b64_tr_b16 a[78:79], v229 offset:18016
  v_mfma_f32_16x16x32_bf16 v[72:75], a[80:83], a[4:7], v[72:75]
  v_mfma_f32_16x16x32_bf16 v[128:131], a[80:83], a[8:11], v[128:131]
  buffer_load_dwordx4 a[48:51], v224, s[4:7], s16 offen offset:0 sc1
  v_mfma_f32_16x16x32_bf16 v[184:187], a[80:83], a[12:15], v[184:187]
  ds_read_b64_tr_b16 a[80:81], v229 offset:14464
  ds_read_b64_tr_b16 a[82:83], v229 offset:18048
  v_mfma_f32_16x16x32_bf16 v[20:23], a[84:87], a[0:3], v[20:23]
  v_mfma_f32_16x16x32_bf16 v[76:79], a[84:87], a[4:7], v[76:79]
  buffer_load_dwordx4 a[52:55], v224, s[4:7], s16 offen offset:1024 sc1
  v_mfma_f32_16x16x32_bf16 v[132:135], a[84:87], a[8:11], v[132:135]
  v_mfma_f32_16x16x32_bf16 v[188:191], a[84:87], a[12:15], v[188:191]
  ds_read_b64_tr_b16 a[84:85], v229 offset:14496
  ds_read_b64_tr_b16 a[86:87], v229 offset:18080
  v_mfma_f32_16x16x32_bf16 v[24:27], a[88:91], a[0:3], v[24:27]
  buffer_load_dwordx4 a[56:59], v224, s[4:7], s16 offen offset:2048 sc1
  v_mfma_f32_16x16x32_bf16 v[80:83], a[88:91], a[4:7], v[80:83]
  v_mfma_f32_16x16x32_bf16 v[136:139], a[88:91], a[8:11], v[136:139]
  v_mfma_f32_16x16x32_bf16 v[192:195], a[88:91], a[12:15], v[192:195]
  buffer_load_dwordx4 a[60:63], v224, s[4:7], s16 offen offset:3072 sc1
  v_mfma_f32_16x16x32_bf16 v[28:31], a[92:95], a[0:3], v[28:31]
  ds_read_b64_tr_b16 a[88:89], v229 offset:14528
  ds_read_b64_tr_b16 a[90:91], v229 offset:18112
  v_mfma_f32_16x16x32_bf16 v[84:87], a[92:95], a[4:7], v[84:87]
  v_mfma_f32_16x16x32_bf16 v[140:143], a[92:95], a[8:11], v[140:143]
  s_add_u32 s16, s16, 131072
  v_mfma_f32_16x16x32_bf16 v[196:199], a[92:95], a[12:15], v[196:199]
  ds_read_b64_tr_b16 a[92:93], v229 offset:21504
  ds_read_b64_tr_b16 a[94:95], v229 offset:25088
  s_waitcnt lgkmcnt(10)
  v_mfma_f32_16x16x32_bf16 v[32:35], a[96:99], a[0:3], v[32:35]
  v_mfma_f32_16x16x32_bf16 v[88:91], a[96:99], a[4:7], v[88:91]
  buffer_load_dword v251, v249, s[52:55], s56 offen
  v_mfma_f32_16x16x32_bf16 v[144:147], a[96:99], a[8:11], v[144:147]
  v_mfma_f32_16x16x32_bf16 v[200:203], a[96:99], a[12:15], v[200:203]
  ds_read_b64_tr_b16 a[96:97], v229 offset:21536
  ds_read_b64_tr_b16 a[98:99], v229 offset:25120
  v_mfma_f32_16x16x32_bf16 v[36:39], a[100:103], a[0:3], v[36:39]
  s_add_u32 s56, s56, 0x80000
  v_mfma_f32_16x16x32_bf16 v[92:95], a[100:103], a[4:7], v[92:95]
  v_mfma_f32_16x16x32_bf16 v[148:151], a[100:103], a[8:11], v[148:151]
  v_mfma_f32_16x16x32_bf16 v[204:207], a[100:103], a[12:15], v[204:207]
  ds_read_b64_tr_b16 a[100:101], v229 offset:21568
  s_add_u32 s59, s59, 1
  v_mfma_f32_16x16x32_bf16 v[40:43], a[104:107], a[0:3], v[40:43]
  ds_read_b64_tr_b16 a[102:103], v229 offset:25152
  v_mfma_f32_16x16x32_bf16 v[96:99], a[104:107], a[4:7], v[96:99]
  v_mfma_f32_16x16x32_bf16 v[152:155], a[104:107], a[8:11], v[152:155]
  s_cmp_eq_u32 s59, 7
  v_mfma_f32_16x16x32_bf16 v[208:211], a[104:107], a[12:15], v[208:211]
  ds_read_b64_tr_b16 a[104:105], v229 offset:21600
  ds_read_b64_tr_b16 a[106:107], v229 offset:25184
  v_mfma_f32_16x16x32_bf16 v[44:47], a[108:111], a[0:3], v[44:47]
  v_mfma_f32_16x16x32_bf16 v[100:103], a[108:111], a[4:7], v[100:103]
  s_cselect_b32 s52, s22, s52
  v_mfma_f32_16x16x32_bf16 v[156:159], a[108:111], a[8:11], v[156:159]
  v_mfma_f32_16x16x32_bf16 v[212:215], a[108:111], a[12:15], v[212:215]
  ds_read_b64_tr_b16 a[108:109], v229 offset:21632
  ds_read_b64_tr_b16 a[110:111], v229 offset:25216
  v_mfma_f32_16x16x32_bf16 v[48:51], a[112:115], a[0:3], v[48:51]
  s_cselect_b32 s53, s23, s53
  v_mfma_f32_16x16x32_bf16 v[104:107], a[112:115], a[4:7], v[104:107]
  v_mfma_f32_16x16x32_bf16 v[160:163], a[112:115], a[8:11], v[160:163]
  v_mfma_f32_16x16x32_bf16 v[216:219], a[112:115], a[12:15], v[216:219]
  ds_read_b64_tr_b16 a[112:113], v229 offset:21664
  s_cselect_b32 s56, s60, s56
  v_mfma_f32_16x16x32_bf16 v[52:55], a[116:119], a[0:3], v[52:55]
  ds_read_b64_tr_b16 a[114:115], v229 offset:25248
  v_mfma_f32_16x16x32_bf16 v[108:111], a[116:119], a[4:7], v[108:111]
  v_mfma_f32_16x16x32_bf16 v[164:167], a[116:119], a[8:11], v[164:167]
  v_mfma_f32_16x16x32_bf16 v[220:223], a[116:119], a[12:15], v[220:223]
  s_waitcnt vmcnt(13) lgkmcnt(10)
  s_barrier
  v_mfma_f32_16x16x32_bf16 v[0:3], a[64:67], a[16:19], v[0:3]
  ds_read_b64_tr_b16 a[116:117], v229 offset:21696
  s_add_u32 m0, s38, 0
  v_mfma_f32_16x16x32_bf16 v[56:59], a[64:67], a[20:23], v[56:59]
  ds_read_b64_tr_b16 a[118:119], v229 offset:25280
  v_mfma_f32_16x16x32_bf16 v[112:115], a[64:67], a[24:27], v[112:115]
  v_mfma_f32_16x16x32_bf16 v[168:171], a[64:67], a[28:31], v[168:171]
  ds_read_b64_tr_b16 a[64:65], v229 offset:28672
  ds_read_b64_tr_b16 a[66:67], v229 offset:32256
  v_mfma_f32_16x16x32_bf16 v[4:7], a[68:71], a[16:19], v[4:7]
  v_mfma_f32_16x16x32_bf16 v[60:63], a[68:71], a[20:23], v[60:63]
  buffer_load_dwordx4 v225, s[8:11], s17 offen lds
  v_mfma_f32_16x16x32_bf16 v[116:119], a[68:71], a[24:27], v[116:119]
  v_mfma_f32_16x16x32_bf16 v[172:175], a[68:71], a[28:31], v[172:175]
  ds_read_b64_tr_b16 a[68:69], v229 offset:28704
  ds_read_b64_tr_b16 a[70:71], v229 offset:32288
  v_mfma_f32_16x16x32_bf16 v[8:11], a[72:75], a[16:19], v[8:11]
  v_mfma_f32_16x16x32_bf16 v[64:67], a[72:75], a[20:23], v[64:67]
  v_mfma_f32_16x16x32_bf16 v[120:123], a[72:75], a[24:27], v[120:123]
  buffer_load_dwordx4 v226, s[8:11], s17 offen offset:1024 lds
  v_mfma_f32_16x16x32_bf16 v[176:179], a[72:75], a[28:31], v[176:179]
  ds_read_b64_tr_b16 a[72:73], v229 offset:28736
  ds_read_b64_tr_b16 a[74:75], v229 offset:32320
  v_mfma_f32_16x16x32_bf16 v[12:15], a[76:79], a[16:19], v[12:15]
  v_mfma_f32_16x16x32_bf16 v[68:71], a[76:79], a[20:23], v[68:71]
  v_mfma_f32_16x16x32_bf16 v[124:127], a[76:79], a[24:27], v[124:127]
  v_mfma_f32_16x16x32_bf16 v[180:183], a[76:79], a[28:31], v[180:183]
  buffer_load_dwordx4 v227, s[8:11], s17 offen offset:2048 lds
  v_mfma_f32_16x16x32_bf16 v[16:19], a[80:83], a[16:19], v[16:19]
  ds_read_b64_tr_b16 a[76:77], v229 offset:28768
  ds_read_b64_tr_b16 a[78:79], v229 offset:32352
  v_mfma_f32_16x16x32_bf16 v[72:75], a[80:83], a[20:23], v[72:75]
  v_mfma_f32_16x16x32_bf16 v[128:131], a[80:83], a[24:27], v[128:131]
  v_mfma_f32_16x16x32_bf16 v[184:187], a[80:83], a[28:31], v[184:187]
  ds_read_b64_tr_b16 a[80:81], v229 offset:28800
  ds_read_b64_tr_b16 a[82:83], v229 offset:32384
  v_mfma_f32_16x16x32_bf16 v[20:23], a[84:87], a[16:19], v[20:23]
  s_mov_b32 exec_hi, 0
  buffer_load_dwordx4 v228, s[8:11], s17 offen offset:3072 lds
  s_mov_b32 exec_hi, -1
  v_mfma_f32_16x16x32_bf16 v[76:79], a[84:87], a[20:23], v[76:79]
  v_mfma_f32_16x16x32_bf16 v[132:135], a[84:87], a[24:27], v[132:135]
  v_mfma_f32_16x16x32_bf16 v[188:191], a[84:87], a[28:31], v[188:191]
  ds_read_b64_tr_b16 a[84:85], v229 offset:28832
  ds_read_b64_tr_b16 a[86:87], v229 offset:32416
  v_mfma_f32_16x16x32_bf16 v[24:27], a[88:91], a[16:19], v[24:27]
  v_mfma_f32_16x16x32_bf16 v[80:83], a[88:91], a[20:23], v[80:83]
  s_add_u32 s17, s17, 229376
  v_mfma_f32_16x16x32_bf16 v[136:139], a[88:91], a[24:27], v[136:139]
  v_mfma_f32_16x16x32_bf16 v[192:195], a[88:91], a[28:31], v[192:195]
  ds_read_b64_tr_b16 a[88:89], v229 offset:28864
  ds_read_b64_tr_b16 a[90:91], v229 offset:32448
  v_mfma_f32_16x16x32_bf16 v[28:31], a[92:95], a[16:19], v[28:31]
  v_mfma_f32_16x16x32_bf16 v[84:87], a[92:95], a[20:23], v[84:87]
  v_mfma_f32_16x16x32_bf16 v[140:143], a[92:95], a[24:27], v[140:143]
  buffer_load_dwordx4 a[0:3], v224, s[4:7], s16 offen offset:0 sc1
  v_mfma_f32_16x16x32_bf16 v[196:199], a[92:95], a[28:31], v[196:199]
  ds_read_b64_tr_b16 a[92:93], v229 offset:35840
  ds_read_b64_tr_b16 a[94:95], v229 offset:39424
  s_waitcnt lgkmcnt(10)
  v_mfma_f32_16x16x32_bf16 v[32:35], a[96:99], a[16:19], v[32:35]
  v_mfma_f32_16x16x32_bf16 v[88:91], a[96:99], a[20:23], v[88:91]
  v_mfma_f32_16x16x32_bf16 v[144:147], a[96:99], a[24:27], v[144:147]
  v_mfma_f32_16x16x32_bf16 v[200:203], a[96:99], a[28:31], v[200:203]
  buffer_load_dwordx4 a[4:7], v224, s[4:7], s16 offen offset:1024 sc1
  v_mfma_f32_16x16x32_bf16 v[36:39], a[100:103], a[16:19], v[36:39]
  ds_read_b64_tr_b16 a[96:97], v229 offset:35872
  ds_read_b64_tr_b16 a[98:99], v229 offset:39456
  v_mfma_f32_16x16x32_bf16 v[92:95], a[100:103], a[20:23], v[92:95]
  v_mfma_f32_16x16x32_bf16 v[148:151], a[100:103], a[24:27], v[148:151]
  v_mfma_f32_16x16x32_bf16 v[204:207], a[100:103], a[28:31], v[204:207]
  ds_read_b64_tr_b16 a[100:101], v229 offset:35904
  ds_read_b64_tr_b16 a[102:103], v229 offset:39488
  v_mfma_f32_16x16x32_bf16 v[40:43], a[104:107], a[16:19], v[40:43]
  buffer_load_dwordx4 a[8:11], v224, s[4:7], s16 offen offset:2048 sc1
  v_mfma_f32_16x16x32_bf16 v[96:99], a[104:107], a[20:23], v[96:99]
  v_mfma_f32_16x16x32_bf16 v[152:155], a[104:107], a[24:27], v[152:155]
  v_mfma_f32_16x16x32_bf16 v[208:211], a[104:107], a[28:31], v[208:211]
  ds_read_b64_tr_b16 a[104:105], v229 offset:35936
  ds_read_b64_tr_b16 a[106:107], v229 offset:39520
  v_mfma_f32_16x16x32_bf16 v[44:47], a[108:111], a[16:19], v[44:47]
  v_mfma_f32_16x16x32_bf16 v[100:103], a[108:111], a[20:23], v[100:103]
  buffer_load_dwordx4 a[12:15], v224, s[4:7], s16 offen offset:3072 sc1
  v_mfma_f32_16x16x32_bf16 v[156:159], a[108:111], a[24:27], v[156:159]
  v_mfma_f32_16x16x32_bf16 v[212:215], a[108:111], a[28:31], v[212:215]
  ds_read_b64_tr_b16 a[108:109], v229 offset:35968
  ds_read_b64_tr_b16 a[110:111], v229 offset:39552
  v_mfma_f32_16x16x32_bf16 v[48:51], a[112:115], a[16:19], v[48:51]
  v_mfma_f32_16x16x32_bf16 v[104:107], a[112:115], a[20:23], v[104:107]
  v_mfma_f32_16x16x32_bf16 v[160:163], a[112:115], a[24:27], v[160:163]
  s_add_u32 s16, s16, 131072
  v_mfma_f32_16x16x32_bf16 v[216:219], a[112:115], a[28:31], v[216:219]
  ds_read_b64_tr_b16 a[112:113], v229 offset:36000
  ds_read_b64_tr_b16 a[114:115], v229 offset:39584
  v_mfma_f32_16x16x32_bf16 v[52:55], a[116:119], a[16:19], v[52:55]
  v_mfma_f32_16x16x32_bf16 v[108:111], a[116:119], a[20:23], v[108:111]
  v_mfma_f32_16x16x32_bf16 v[164:167], a[116:119], a[24:27], v[164:167]
  v_mfma_f32_16x16x32_bf16 v[220:223], a[116:119], a[28:31], v[220:223]
  s_waitcnt vmcnt(13) lgkmcnt(10)
  s_barrier
  v_mfma_f32_16x16x32_bf16 v[0:3], a[64:67], a[32:35], v[0:3]
  ds_read_b64_tr_b16 a[116:117], v229 offset:36032
  s_add_u32 m0, s38, 14336
  v_mfma_f32_16x16x32_bf16 v[56:59], a[64:67], a[36:39], v[56:59]
  ds_read_b64_tr_b16 a[118:119], v229 offset:39616
  v_mfma_f32_16x16x32_bf16 v[112:115], a[64:67], a[40:43], v[112:115]
  v_mfma_f32_16x16x32_bf16 v[168:171], a[64:67], a[44:47], v[168:171]
  ds_read_b64_tr_b16 a[64:65], v229 offset:43008
  ds_read_b64_tr_b16 a[66:67], v229 offset:46592
  v_mfma_f32_16x16x32_bf16 v[4:7], a[68:71], a[32:35], v[4:7]
  v_mfma_f32_16x16x32_bf16 v[60:63], a[68:71], a[36:39], v[60:63]
  buffer_load_dwordx4 v225, s[8:11], s17 offen lds
  v_mfma_f32_16x16x32_bf16 v[116:119], a[68:71], a[40:43], v[116:119]
  v_mfma_f32_16x16x32_bf16 v[172:175], a[68:71], a[44:47], v[172:175]
  ds_read_b64_tr_b16 a[68:69], v229 offset:43040
  ds_read_b64_tr_b16 a[70:71], v229 offset:46624
  v_mfma_f32_16x16x32_bf16 v[8:11], a[72:75], a[32:35], v[8:11]
  v_mfma_f32_16x16x32_bf16 v[64:67], a[72:75], a[36:39], v[64:67]
  v_mfma_f32_16x16x32_bf16 v[120:123], a[72:75], a[40:43], v[120:123]
  buffer_load_dwordx4 v226, s[8:11], s17 offen offset:1024 lds
  v_mfma_f32_16x16x32_bf16 v[176:179], a[72:75], a[44:47], v[176:179]
  ds_read_b64_tr_b16 a[72:73], v229 offset:43072
  ds_read_b64_tr_b16 a[74:75], v229 offset:46656
  v_mfma_f32_16x16x32_bf16 v[12:15], a[76:79], a[32:35], v[12:15]
  v_mfma_f32_16x16x32_bf16 v[68:71], a[76:79], a[36:39], v[68:71]
  v_mfma_f32_16x16x32_bf16 v[124:127], a[76:79], a[40:43], v[124:127]
  v_mfma_f32_16x16x32_bf16 v[180:183], a[76:79], a[44:47], v[180:183]
  buffer_load_dwordx4 v227, s[8:11], s17 offen offset:2048 lds
  v_mfma_f32_16x16x32_bf16 v[16:19], a[80:83], a[32:35], v[16:19]
  ds_read_b64_tr_b16 a[76:77], v229 offset:43104
  ds_read_b64_tr_b16 a[78:79], v229 offset:46688
  v_mfma_f32_16x16x32_bf16 v[72:75], a[80:83], a[36:39], v[72:75]
  v_mfma_f32_16x16x32_bf16 v[128:131], a[80:83], a[40:43], v[128:131]
  v_mfma_f32_16x16x32_bf16 v[184:187], a[80:83], a[44:47], v[184:187]
  ds_read_b64_tr_b16 a[80:81], v229 offset:43136
  ds_read_b64_tr_b16 a[82:83], v229 offset:46720
  v_mfma_f32_16x16x32_bf16 v[20:23], a[84:87], a[32:35], v[20:23]
  s_mov_b32 exec_hi, 0
  buffer_load_dwordx4 v228, s[8:11], s17 offen offset:3072 lds
  s_mov_b32 exec_hi, -1
  v_mfma_f32_16x16x32_bf16 v[76:79], a[84:87], a[36:39], v[76:79]
  v_mfma_f32_16x16x32_bf16 v[132:135], a[84:87], a[40:43], v[132:135]
  v_mfma_f32_16x16x32_bf16 v[188:191], a[84:87], a[44:47], v[188:191]
  ds_read_b64_tr_b16 a[84:85], v229 offset:43168
  ds_read_b64_tr_b16 a[86:87], v229 offset:46752
  v_mfma_f32_16x16x32_bf16 v[24:27], a[88:91], a[32:35], v[24:27]
  v_mfma_f32_16x16x32_bf16 v[80:83], a[88:91], a[36:39], v[80:83]
  s_add_u32 s17, s17, 229376
  v_mfma_f32_16x16x32_bf16 v[136:139], a[88:91], a[40:43], v[136:139]
  v_mfma_f32_16x16x32_bf16 v[192:195], a[88:91], a[44:47], v[192:195]
  ds_read_b64_tr_b16 a[88:89], v229 offset:43200
  ds_read_b64_tr_b16 a[90:91], v229 offset:46784
  v_mfma_f32_16x16x32_bf16 v[28:31], a[92:95], a[32:35], v[28:31]
  v_mfma_f32_16x16x32_bf16 v[84:87], a[92:95], a[36:39], v[84:87]
  v_mfma_f32_16x16x32_bf16 v[140:143], a[92:95], a[40:43], v[140:143]
  buffer_load_dwordx4 a[16:19], v224, s[4:7], s16 offen offset:0 sc1
  v_mfma_f32_16x16x32_bf16 v[196:199], a[92:95], a[44:47], v[196:199]
  ds_read_b64_tr_b16 a[92:93], v229 offset:50176
  ds_read_b64_tr_b16 a[94:95], v229 offset:53760
  s_waitcnt lgkmcnt(10)
  v_mfma_f32_16x16x32_bf16 v[32:35], a[96:99], a[32:35], v[32:35]
  v_mfma_f32_16x16x32_bf16 v[88:91], a[96:99], a[36:39], v[88:91]
  v_mfma_f32_16x16x32_bf16 v[144:147], a[96:99], a[40:43], v[144:147]
  v_mfma_f32_16x16x32_bf16 v[200:203], a[96:99], a[44:47], v[200:203]
  buffer_load_dwordx4 a[20:23], v224, s[4:7], s16 offen offset:1024 sc1
  v_mfma_f32_16x16x32_bf16 v[36:39], a[100:103], a[32:35], v[36:39]
  ds_read_b64_tr_b16 a[96:97], v229 offset:50208
  ds_read_b64_tr_b16 a[98:99], v229 offset:53792
  v_mfma_f32_16x16x32_bf16 v[92:95], a[100:103], a[36:39], v[92:95]
  v_mfma_f32_16x16x32_bf16 v[148:151], a[100:103], a[40:43], v[148:151]
  v_mfma_f32_16x16x32_bf16 v[204:207], a[100:103], a[44:47], v[204:207]
  ds_read_b64_tr_b16 a[100:101], v229 offset:50240
  ds_read_b64_tr_b16 a[102:103], v229 offset:53824
  v_mfma_f32_16x16x32_bf16 v[40:43], a[104:107], a[32:35], v[40:43]
  buffer_load_dwordx4 a[24:27], v224, s[4:7], s16 offen offset:2048 sc1
  v_mfma_f32_16x16x32_bf16 v[96:99], a[104:107], a[36:39], v[96:99]
  v_mfma_f32_16x16x32_bf16 v[152:155], a[104:107], a[40:43], v[152:155]
  v_mfma_f32_16x16x32_bf16 v[208:211], a[104:107], a[44:47], v[208:211]
  ds_read_b64_tr_b16 a[104:105], v229 offset:50272
  ds_read_b64_tr_b16 a[106:107], v229 offset:53856
  v_mfma_f32_16x16x32_bf16 v[44:47], a[108:111], a[32:35], v[44:47]
  v_mfma_f32_16x16x32_bf16 v[100:103], a[108:111], a[36:39], v[100:103]
  buffer_load_dwordx4 a[28:31], v224, s[4:7], s16 offen offset:3072 sc1
  v_mfma_f32_16x16x32_bf16 v[156:159], a[108:111], a[40:43], v[156:159]
  v_mfma_f32_16x16x32_bf16 v[212:215], a[108:111], a[44:47], v[212:215]
  ds_read_b64_tr_b16 a[108:109], v229 offset:50304
  ds_read_b64_tr_b16 a[110:111], v229 offset:53888
  v_mfma_f32_16x16x32_bf16 v[48:51], a[112:115], a[32:35], v[48:51]
  v_mfma_f32_16x16x32_bf16 v[104:107], a[112:115], a[36:39], v[104:107]
  v_mfma_f32_16x16x32_bf16 v[160:163], a[112:115], a[40:43], v[160:163]
  s_add_u32 s16, s16, 131072
  v_mfma_f32_16x16x32_bf16 v[216:219], a[112:115], a[44:47], v[216:219]
  ds_read_b64_tr_b16 a[112:113], v229 offset:50336
  ds_read_b64_tr_b16 a[114:115], v229 offset:53920
  v_mfma_f32_16x16x32_bf16 v[52:55], a[116:119], a[32:35], v[52:55]
  v_mfma_f32_16x16x32_bf16 v[108:111], a[116:119], a[36:39], v[108:111]
  v_mfma_f32_16x16x32_bf16 v[164:167], a[116:119], a[40:43], v[164:167]
  v_mfma_f32_16x16x32_bf16 v[220:223], a[116:119], a[44:47], v[220:223]
  s_waitcnt vmcnt(12) lgkmcnt(10)
  s_barrier
  v_mfma_f32_16x16x32_bf16 v[0:3], a[64:67], a[48:51], v[0:3]
  ds_read_b64_tr_b16 a[116:117], v229 offset:50368
  s_add_u32 m0, s38, 28672
  v_mfma_f32_16x16x32_bf16 v[56:59], a[64:67], a[52:55], v[56:59]
  ds_read_b64_tr_b16 a[118:119], v229 offset:53952
  v_mfma_f32_16x16x32_bf16 v[112:115], a[64:67], a[56:59], v[112:115]
  v_mfma_f32_16x16x32_bf16 v[168:171], a[64:67], a[60:63], v[168:171]
  ds_read_b64_tr_b16 a[64:65], v229 offset:0
  ds_read_b64_tr_b16 a[66:67], v229 offset:3584
  v_mfma_f32_16x16x32_bf16 v[4:7], a[68:71], a[48:51], v[4:7]
  v_mfma_f32_16x16x32_bf16 v[60:63], a[68:71], a[52:55], v[60:63]
  buffer_load_dwordx4 v225, s[8:11], s17 offen lds
  v_mfma_f32_16x16x32_bf16 v[116:119], a[68:71], a[56:59], v[116:119]
  v_mfma_f32_16x16x32_bf16 v[172:175], a[68:71], a[60:63], v[172:175]
  ds_read_b64_tr_b16 a[68:69], v229 offset:32
  ds_read_b64_tr_b16 a[70:71], v229 offset:3616
  v_mfma_f32_16x16x32_bf16 v[8:11], a[72:75], a[48:51], v[8:11]
  v_mfma_f32_16x16x32_bf16 v[64:67], a[72:75], a[52:55], v[64:67]
  v_mfma_f32_16x16x32_bf16 v[120:123], a[72:75], a[56:59], v[120:123]
  buffer_load_dwordx4 v226, s[8:11], s17 offen offset:1024 lds
  v_mfma_f32_16x16x32_bf16 v[176:179], a[72:75], a[60:63], v[176:179]
  ds_read_b64_tr_b16 a[72:73], v229 offset:64
  ds_read_b64_tr_b16 a[74:75], v229 offset:3648
  v_mfma_f32_16x16x32_bf16 v[12:15], a[76:79], a[48:51], v[12:15]
  v_mfma_f32_16x16x32_bf16 v[68:71], a[76:79], a[52:55], v[68:71]
  v_mfma_f32_16x16x32_bf16 v[124:127], a[76:79], a[56:59], v[124:127]
  v_mfma_f32_16x16x32_bf16 v[180:183], a[76:79], a[60:63], v[180:183]
  buffer_load_dwordx4 v227, s[8:11], s17 offen offset:2048 lds
  v_mfma_f32_16x16x32_bf16 v[16:19], a[80:83], a[48:51], v[16:19]
  ds_read_b64_tr_b16 a[76:77], v229 offset:96
  ds_read_b64_tr_b16 a[78:79], v229 offset:3680
  v_mfma_f32_16x16x32_bf16 v[72:75], a[80:83], a[52:55], v[72:75]
  v_mfma_f32_16x16x32_bf16 v[128:131], a[80:83], a[56:59], v[128:131]
  v_mfma_f32_16x16x32_bf16 v[184:187], a[80:83], a[60:63], v[184:187]
  ds_read_b64_tr_b16 a[80:81], v229 offset:128
  ds_read_b64_tr_b16 a[82:83], v229 offset:3712
  v_mfma_f32_16x16x32_bf16 v[20:23], a[84:87], a[48:51], v[20:23]
  s_mov_b32 exec_hi, 0
  buffer_load_dwordx4 v228, s[8:11], s17 offen offset:3072 lds
  s_mov_b32 exec_hi, -1
  v_mfma_f32_16x16x32_bf16 v[76:79], a[84:87], a[52:55], v[76:79]
  v_mfma_f32_16x16x32_bf16 v[132:135], a[84:87], a[56:59], v[132:135]
  v_mfma_f32_16x16x32_bf16 v[188:191], a[84:87], a[60:63], v[188:191]
  ds_read_b64_tr_b16 a[84:85], v229 offset:160
  ds_read_b64_tr_b16 a[86:87], v229 offset:3744
  v_mfma_f32_16x16x32_bf16 v[24:27], a[88:91], a[48:51], v[24:27]
  v_mfma_f32_16x16x32_bf16 v[80:83], a[88:91], a[52:55], v[80:83]
  s_add_u32 s17, s17, 229376
  v_mfma_f32_16x16x32_bf16 v[136:139], a[88:91], a[56:59], v[136:139]
  v_mfma_f32_16x16x32_bf16 v[192:195], a[88:91], a[60:63], v[192:195]
  ds_read_b64_tr_b16 a[88:89], v229 offset:192
  ds_read_b64_tr_b16 a[90:91], v229 offset:3776
  v_mfma_f32_16x16x32_bf16 v[28:31], a[92:95], a[48:51], v[28:31]
  v_mfma_f32_16x16x32_bf16 v[84:87], a[92:95], a[52:55], v[84:87]
  v_mfma_f32_16x16x32_bf16 v[140:143], a[92:95], a[56:59], v[140:143]
  buffer_load_dwordx4 a[32:35], v224, s[4:7], s16 offen offset:0 sc1
  v_mfma_f32_16x16x32_bf16 v[196:199], a[92:95], a[60:63], v[196:199]
  ds_read_b64_tr_b16 a[92:93], v229 offset:7168
  ds_read_b64_tr_b16 a[94:95], v229 offset:10752
  s_waitcnt lgkmcnt(10)
  v_mfma_f32_16x16x32_bf16 v[32:35], a[96:99], a[48:51], v[32:35]
  v_mfma_f32_16x16x32_bf16 v[88:91], a[96:99], a[52:55], v[88:91]
  v_mfma_f32_16x16x32_bf16 v[144:147], a[96:99], a[56:59], v[144:147]
  v_mfma_f32_16x16x32_bf16 v[200:203], a[96:99], a[60:63], v[200:203]
  buffer_load_dwordx4 a[36:39], v224, s[4:7], s16 offen offset:1024 sc1
  v_mfma_f32_16x16x32_bf16 v[36:39], a[100:103], a[48:51], v[36:39]
  ds_read_b64_tr_b16 a[96:97], v229 offset:7200
  ds_read_b64_tr_b16 a[98:99], v229 offset:10784
  v_mfma_f32_16x16x32_bf16 v[92:95], a[100:103], a[52:55], v[92:95]
  v_mfma_f32_16x16x32_bf16 v[148:151], a[100:103], a[56:59], v[148:151]
  v_mfma_f32_16x16x32_bf16 v[204:207], a[100:103], a[60:63], v[204:207]
  ds_read_b64_tr_b16 a[100:101], v229 offset:7232
  ds_read_b64_tr_b16 a[102:103], v229 offset:10816
  v_mfma_f32_16x16x32_bf16 v[40:43], a[104:107], a[48:51], v[40:43]
  buffer_load_dwordx4 a[40:43], v224, s[4:7], s16 offen offset:2048 sc1
  v_mfma_f32_16x16x32_bf16 v[96:99], a[104:107], a[52:55], v[96:99]
  v_mfma_f32_16x16x32_bf16 v[152:155], a[104:107], a[56:59], v[152:155]
  v_mfma_f32_16x16x32_bf16 v[208:211], a[104:107], a[60:63], v[208:211]
  ds_read_b64_tr_b16 a[104:105], v229 offset:7264
  ds_read_b64_tr_b16 a[106:107], v229 offset:10848
  v_mfma_f32_16x16x32_bf16 v[44:47], a[108:111], a[48:51], v[44:47]
  v_mfma_f32_16x16x32_bf16 v[100:103], a[108:111], a[52:55], v[100:103]
  buffer_load_dwordx4 a[44:47], v224, s[4:7], s16 offen offset:3072 sc1
  v_mfma_f32_16x16x32_bf16 v[156:159], a[108:111], a[56:59], v[156:159]
  v_mfma_f32_16x16x32_bf16 v[212:215], a[108:111], a[60:63], v[212:215]
  ds_read_b64_tr_b16 a[108:109], v229 offset:7296
  ds_read_b64_tr_b16 a[110:111], v229 offset:10880
  v_mfma_f32_16x16x32_bf16 v[48:51], a[112:115], a[48:51], v[48:51]
  v_mfma_f32_16x16x32_bf16 v[104:107], a[112:115], a[52:55], v[104:107]
  v_mfma_f32_16x16x32_bf16 v[160:163], a[112:115], a[56:59], v[160:163]
  s_add_u32 s16, s16, 131072
  v_mfma_f32_16x16x32_bf16 v[216:219], a[112:115], a[60:63], v[216:219]
  ds_read_b64_tr_b16 a[112:113], v229 offset:7328
  ds_read_b64_tr_b16 a[114:115], v229 offset:10912
  v_mfma_f32_16x16x32_bf16 v[52:55], a[116:119], a[48:51], v[52:55]
  v_mfma_f32_16x16x32_bf16 v[108:111], a[116:119], a[52:55], v[108:111]
  v_mfma_f32_16x16x32_bf16 v[164:167], a[116:119], a[56:59], v[164:167]
  v_mfma_f32_16x16x32_bf16 v[220:223], a[116:119], a[60:63], v[220:223]
  s_waitcnt vmcnt(12) lgkmcnt(10)
  s_barrier
  v_mfma_f32_16x16x32_bf16 v[0:3], a[64:67], a[0:3], v[0:3]
  ds_read_b64_tr_b16 a[116:117], v229 offset:7360
  s_add_u32 m0, s38, 43008
  v_mfma_f32_16x16x32_bf16 v[56:59], a[64:67], a[4:7], v[56:59]
  ds_read_b64_tr_b16 a[118:119], v229 offset:10944
  v_mfma_f32_16x16x32_bf16 v[112:115], a[64:67], a[8:11], v[112:115]
  v_mfma_f32_16x16x32_bf16 v[168:171], a[64:67], a[12:15], v[168:171]
  ds_read_b64_tr_b16 a[64:65], v229 offset:14336
  ds_read_b64_tr_b16 a[66:67], v229 offset:17920
  v_mfma_f32_16x16x32_bf16 v[4:7], a[68:71], a[0:3], v[4:7]
  buffer_load_dwordx4 v225, s[8:11], s17 offen lds
  v_mfma_f32_16x16x32_bf16 v[60:63], a[68:71], a[4:7], v[60:63]
  v_mfma_f32_16x16x32_bf16 v[116:119], a[68:71], a[8:11], v[116:119]
  v_mfma_f32_16x16x32_bf16 v[172:175], a[68:71], a[12:15], v[172:175]
  ds_read_b64_tr_b16 a[68:69], v229 offset:14368
  ds_read_b64_tr_b16 a[70:71], v229 offset:17952
  v_mfma_f32_16x16x32_bf16 v[8:11], a[72:75], a[0:3], v[8:11]
  v_mfma_f32_16x16x32_bf16 v[64:67], a[72:75], a[4:7], v[64:67]
  buffer_load_dwordx4 v226, s[8:11], s17 offen offset:1024 lds
  v_mfma_f32_16x16x32_bf16 v[120:123], a[72:75], a[8:11], v[120:123]
  v_mfma_f32_16x16x32_bf16 v[176:179], a[72:75], a[12:15], v[176:179]
  ds_read_b64_tr_b16 a[72:73], v229 offset:14400
  ds_read_b64_tr_b16 a[74:75], v229 offset:17984
  v_mfma_f32_16x16x32_bf16 v[12:15], a[76:79], a[0:3], v[12:15]
  v_mfma_f32_16x16x32_bf16 v[68:71], a[76:79], a[4:7], v[68:71]
  buffer_load_dwordx4 v227, s[8:11], s17 offen offset:2048 lds
  v_mfma_f32_16x16x32_bf16 v[124:127], a[76:79], a[8:11], v[124:127]
  v_mfma_f32_16x16x32_bf16 v[180:183], a[76:79], a[12:15], v[180:183]
  ds_read_b64_tr_b16 a[76:77], v229 offset:14432
  ds_read_b64_tr_b16 a[78:79], v229 offset:18016
  v_mfma_f32_16x16x32_bf16 v[16:19], a[80:83], a[0:3], v[16:19]
  v_mfma_f32_16x16x32_bf16 v[72:75], a[80:83], a[4:7], v[72:75]
  v_mfma_f32_16x16x32_bf16 v[128:131], a[80:83], a[8:11], v[128:131]
  s_mov_b32 exec_hi, 0
  buffer_load_dwordx4 v228, s[8:11], s17 offen offset:3072 lds
  s_mov_b32 exec_hi, -1
  v_mfma_f32_16x16x32_bf16 v[184:187], a[80:83], a[12:15], v[184:187]
  ds_read_b64_tr_b16 a[80:81], v229 offset:14464
  ds_read_b64_tr_b16 a[82:83], v229 offset:18048
  v_mfma_f32_16x16x32_bf16 v[20:23], a[84:87], a[0:3], v[20:23]
  v_mfma_f32_16x16x32_bf16 v[76:79], a[84:87], a[4:7], v[76:79]
  v_mfma_f32_16x16x32_bf16 v[132:135], a[84:87], a[8:11], v[132:135]
  s_add_u32 s17, s17, 229376
  v_mfma_f32_16x16x32_bf16 v[188:191], a[84:87], a[12:15], v[188:191]
  ds_read_b64_tr_b16 a[84:85], v229 offset:14496
  ds_read_b64_tr_b16 a[86:87], v229 offset:18080
  v_mfma_f32_16x16x32_bf16 v[24:27], a[88:91], a[0:3], v[24:27]
  v_mfma_f32_16x16x32_bf16 v[80:83], a[88:91], a[4:7], v[80:83]
  v_mfma_f32_16x16x32_bf16 v[136:139], a[88:91], a[8:11], v[136:139]
  v_mfma_f32_16x16x32_bf16 v[192:195], a[88:91], a[12:15], v[192:195]
  buffer_load_dwordx4 a[48:51], v224, s[4:7], s16 offen offset:0 sc1
  v_mfma_f32_16x16x32_bf16 v[28:31], a[92:95], a[0:3], v[28:31]
  ds_read_b64_tr_b16 a[88:89], v229 offset:14528
  ds_read_b64_tr_b16 a[90:91], v229 offset:18112
  v_mfma_f32_16x16x32_bf16 v[84:87], a[92:95], a[4:7], v[84:87]
  v_mfma_f32_16x16x32_bf16 v[140:143], a[92:95], a[8:11], v[140:143]
  v_mfma_f32_16x16x32_bf16 v[196:199], a[92:95], a[12:15], v[196:199]
  ds_read_b64_tr_b16 a[92:93], v229 offset:21504
  ds_read_b64_tr_b16 a[94:95], v229 offset:25088
  s_waitcnt lgkmcnt(10)
  v_mfma_f32_16x16x32_bf16 v[32:35], a[96:99], a[0:3], v[32:35]
  buffer_load_dwordx4 a[52:55], v224, s[4:7], s16 offen offset:1024 sc1
  v_mfma_f32_16x16x32_bf16 v[88:91], a[96:99], a[4:7], v[88:91]
  v_mfma_f32_16x16x32_bf16 v[144:147], a[96:99], a[8:11], v[144:147]
  v_mfma_f32_16x16x32_bf16 v[200:203], a[96:99], a[12:15], v[200:203]
  ds_read_b64_tr_b16 a[96:97], v229 offset:21536
  ds_read_b64_tr_b16 a[98:99], v229 offset:25120
  v_mfma_f32_16x16x32_bf16 v[36:39], a[100:103], a[0:3], v[36:39]
  buffer_load_dwordx4 a[56:59], v224, s[4:7], s16 offen offset:2048 sc1
  v_mfma_f32_16x16x32_bf16 v[92:95], a[100:103], a[4:7], v[92:95]
  v_mfma_f32_16x16x32_bf16 v[148:151], a[100:103], a[8:11], v[148:151]
  v_mfma_f32_16x16x32_bf16 v[204:207], a[100:103], a[12:15], v[204:207]
  ds_read_b64_tr_b16 a[100:101], v229 offset:21568
  ds_read_b64_tr_b16 a[102:103], v229 offset:25152
  v_mfma_f32_16x16x32_bf16 v[40:43], a[104:107], a[0:3], v[40:43]
  v_mfma_f32_16x16x32_bf16 v[96:99], a[104:107], a[4:7], v[96:99]
  buffer_load_dwordx4 a[60:63], v224, s[4:7], s16 offen offset:3072 sc1
  v_mfma_f32_16x16x32_bf16 v[152:155], a[104:107], a[8:11], v[152:155]
  v_mfma_f32_16x16x32_bf16 v[208:211], a[104:107], a[12:15], v[208:211]
  ds_read_b64_tr_b16 a[104:105], v229 offset:21600
  ds_read_b64_tr_b16 a[106:107], v229 offset:25184
  v_mfma_f32_16x16x32_bf16 v[44:47], a[108:111], a[0:3], v[44:47]
  v_mfma_f32_16x16x32_bf16 v[100:103], a[108:111], a[4:7], v[100:103]
  s_add_u32 s16, s16, 131072
  v_mfma_f32_16x16x32_bf16 v[156:159], a[108:111], a[8:11], v[156:159]
  v_mfma_f32_16x16x32_bf16 v[212:215], a[108:111], a[12:15], v[212:215]
  ds_read_b64_tr_b16 a[108:109], v229 offset:21632
  ds_read_b64_tr_b16 a[110:111], v229 offset:25216
  v_mfma_f32_16x16x32_bf16 v[48:51], a[112:115], a[0:3], v[48:51]
  v_mfma_f32_16x16x32_bf16 v[104:107], a[112:115], a[4:7], v[104:107]
  v_mfma_f32_16x16x32_bf16 v[160:163], a[112:115], a[8:11], v[160:163]
  s_getpc_b64 s[52:53]
  L_pc_23:
  s_add_u32 s52, s52, L_k56_seam-L_pc_23
  s_addc_u32 s53, s53, 0
  s_lshr_b32 s56, s2, 3
  s_lshl_b32 s56, s56, 2
  s_add_u32 s56, s56, s3
  s_lshl_b32 s56, s56, 13
  v_lshlrev_b32 v254, 7, v231
  v_add_u32 v254, s56, v254
  v_min_u32 v254, L_code_end-L_k56_seam-4, v254
  v_mov_b32 v255, s53
  v_add_co_u32 v254, vcc, s52, v254
  s_nop 1
  v_addc_co_u32 v255, vcc, 0, v255, vcc
  global_load_dword v251, v[254:255], off
  v_mfma_f32_16x16x32_bf16 v[216:219], a[112:115], a[12:15], v[216:219]
  ds_read_b64_tr_b16 a[112:113], v229 offset:21664
  ds_read_b64_tr_b16 a[114:115], v229 offset:25248
  v_mfma_f32_16x16x32_bf16 v[52:55], a[116:119], a[0:3], v[52:55]
  v_mfma_f32_16x16x32_bf16 v[108:111], a[116:119], a[4:7], v[108:111]
  v_mfma_f32_16x16x32_bf16 v[164:167], a[116:119], a[8:11], v[164:167]
  v_mfma_f32_16x16x32_bf16 v[220:223], a[116:119], a[12:15], v[220:223]
  s_waitcnt vmcnt(13) lgkmcnt(10)
  s_barrier
  s_lshr_b32 s32, s31, 4
  s_mul_i32 s32, s32, 56
  v_mfma_f32_16x16x32_bf16 v[0:3], a[64:67], a[16:19], v[0:3]
  s_and_b32 s33, s31, 15
  s_add_u32 s34, s33, s32
  v_mfma_f32_16x16x32_bf16 v[56:59], a[64:67], a[20:23], v[56:59]
  s_lshl_b32 s98, s34, 17
  s_add_u32 s99, s98, 2097152
  v_mfma_f32_16x16x32_bf16 v[112:115], a[64:67], a[24:27], v[112:115]
  ds_read_b64_tr_b16 a[116:117], v229 offset:21696
  ds_read_b64_tr_b16 a[118:119], v229 offset:25280
  s_add_u32 s100, s98, 4194304
  s_lshr_b32 s34, s33, 1
  v_mfma_f32_16x16x32_bf16 v[168:171], a[64:67], a[28:31], v[168:171]
  s_add_u32 s34, s34, s32
  s_add_u32 s34, s34, 48
  v_mfma_f32_16x16x32_bf16 v[4:7], a[68:71], a[16:19], v[4:7]
  s_lshl_b32 s101, s34, 17
  s_and_b32 s35, s31, 1
  v_mfma_f32_16x16x32_bf16 v[60:63], a[68:71], a[20:23], v[60:63]
  s_lshl_b32 s35, s35, 10
  s_add_u32 s101, s101, s35
  v_mfma_f32_16x16x32_bf16 v[116:119], a[68:71], a[24:27], v[116:119]
  ds_read_b64_tr_b16 a[64:65], v229 offset:28672
  ds_read_b64_tr_b16 a[66:67], v229 offset:32256
  s_lshl_b32 s92, s30, 2
  s_add_u32 s92, s92, s3
  v_mfma_f32_16x16x32_bf16 v[172:175], a[68:71], a[28:31], v[172:175]
  s_lshl_b32 s92, s92, 5
  s_add_u32 s92, s92, s31
  v_mfma_f32_16x16x32_bf16 v[8:11], a[72:75], a[16:19], v[8:11]
  s_lshl_b32 s92, s92, 6
  s_add_u32 s56, s20, 0x80000
  v_mfma_f32_16x16x32_bf16 v[64:67], a[72:75], a[20:23], v[64:67]
  s_addc_u32 s57, s21, 0
  s_mov_b32 s58, 0x30000
  v_mfma_f32_16x16x32_bf16 v[120:123], a[72:75], a[24:27], v[120:123]
  ds_read_b64_tr_b16 a[68:69], v229 offset:28704
  ds_read_b64_tr_b16 a[70:71], v229 offset:32288
  s_mov_b32 s59, 0x20000
  s_and_b32 s28, s2, 1
  v_mfma_f32_16x16x32_bf16 v[176:179], a[72:75], a[28:31], v[176:179]
  s_lshr_b32 s29, s2, 3
  s_bfe_u32 s30, s2, 0x20001
  v_mfma_f32_16x16x32_bf16 v[12:15], a[76:79], a[16:19], v[12:15]
  s_lshl_b32 s30, s30, 2
  s_and_b32 s31, s29, 3
  v_mfma_f32_16x16x32_bf16 v[68:71], a[76:79], a[20:23], v[68:71]
  s_add_u32 s30, s30, s31
  s_lshr_b32 s29, s29, 2
  v_mfma_f32_16x16x32_bf16 v[124:127], a[76:79], a[24:27], v[124:127]
  ds_read_b64_tr_b16 a[72:73], v229 offset:28736
  ds_read_b64_tr_b16 a[74:75], v229 offset:32320
  s_lshl_b32 s31, s29, 1
  s_add_u32 s31, s31, s28
  v_mfma_f32_16x16x32_bf16 v[180:183], a[76:79], a[28:31], v[180:183]
  s_lshl_b32 s94, s30, 1
  s_lshr_b32 s33, s3, 1
  v_mfma_f32_16x16x32_bf16 v[16:19], a[80:83], a[16:19], v[16:19]
  s_add_u32 s94, s94, s33
  s_lshl_b32 s94, s94, 11
  v_mfma_f32_16x16x32_bf16 v[72:75], a[80:83], a[20:23], v[72:75]
  ds_read_b64_tr_b16 a[76:77], v229 offset:28768
  s_lshl_b32 s33, s28, 10
  v_mfma_f32_16x16x32_bf16 v[128:131], a[80:83], a[24:27], v[128:131]
  ds_read_b64_tr_b16 a[78:79], v229 offset:32352
  s_add_u32 s94, s94, s33
  v_and_b32 v246, 15, v231
  v_mfma_f32_16x16x32_bf16 v[184:187], a[80:83], a[28:31], v[184:187]
  v_lshlrev_b32 v246, 6, v246
  s_lshl_b32 s32, s30, 13
  v_mfma_f32_16x16x32_bf16 v[20:23], a[84:87], a[16:19], v[20:23]
  s_lshl_b32 s33, s3, 11
  s_add_u32 s32, s32, s33
  v_mfma_f32_16x16x32_bf16 v[76:79], a[84:87], a[20:23], v[76:79]
  v_lshlrev_b32 v240, 4, v231
  v_add_u32 v240, s32, v240
  v_mfma_f32_16x16x32_bf16 v[132:135], a[84:87], a[24:27], v[132:135]
  ds_read_b64_tr_b16 a[80:81], v229 offset:28800
  ds_read_b64_tr_b16 a[82:83], v229 offset:32384
  v_add_u32 v241, 131072, v240
  v_lshrrev_b32 v232, 3, v231
  v_mfma_f32_16x16x32_bf16 v[188:191], a[84:87], a[28:31], v[188:191]
  v_and_b32 v233, 6, v232
  v_and_b32 v234, 7, v231
  v_mfma_f32_16x16x32_bf16 v[24:27], a[88:91], a[16:19], v[24:27]
  v_xor_b32 v233, v233, v234
  v_lshlrev_b32 v232, 11, v232
  v_mfma_f32_16x16x32_bf16 v[80:83], a[88:91], a[20:23], v[80:83]
  v_lshl_add_u32 v232, v233, 4, v232
  s_lshl_b32 s32, s3, 15
  v_mfma_f32_16x16x32_bf16 v[136:139], a[88:91], a[24:27], v[136:139]
  ds_read_b64_tr_b16 a[84:85], v229 offset:28832
  ds_read_b64_tr_b16 a[86:87], v229 offset:32416
  s_add_u32 s32, s32, 4096
  s_lshl_b32 s33, s31, 7
  v_mfma_f32_16x16x32_bf16 v[192:195], a[88:91], a[28:31], v[192:195]
  s_add_u32 s34, s32, s33
  s_xor_b32 s33, s33, 128
  v_mfma_f32_16x16x32_bf16 v[28:31], a[92:95], a[16:19], v[28:31]
  s_add_u32 s35, s32, s33
  v_add_u32 v225, s34, v232
  v_mfma_f32_16x16x32_bf16 v[84:87], a[92:95], a[20:23], v[84:87]
  v_add_u32 v226, 15360, v225
  v_add_u32 v227, s35, v232
  v_mfma_f32_16x16x32_bf16 v[140:143], a[92:95], a[24:27], v[140:143]
  ds_read_b64_tr_b16 a[88:89], v229 offset:28864
  ds_read_b64_tr_b16 a[90:91], v229 offset:32448
  v_add_u32 v228, 13312, v227
  v_subrev_u32 v227, 2048, v227
  v_mfma_f32_16x16x32_bf16 v[196:199], a[92:95], a[28:31], v[196:199]
  s_lshl_b32 s38, s3, 12
  s_add_u32 s38, s38, 57344
  s_waitcnt lgkmcnt(10)
  v_mfma_f32_16x16x32_bf16 v[32:35], a[96:99], a[16:19], v[32:35]
  s_mul_i32 s16, s28, 7340032
  s_mul_i32 s17, s28, 3670016
  v_mfma_f32_16x16x32_bf16 v[88:91], a[96:99], a[20:23], v[88:91]
  s_lshr_b32 s33, s3, 1
  s_mul_i32 s33, s33, 196608
  v_mfma_f32_16x16x32_bf16 v[144:147], a[96:99], a[24:27], v[144:147]
  ds_read_b64_tr_b16 a[92:93], v229 offset:35840
  ds_read_b64_tr_b16 a[94:95], v229 offset:39424
  s_add_u32 s17, s17, s33
  s_add_u32 s97, s17, s33
  v_mfma_f32_16x16x32_bf16 v[200:203], a[96:99], a[28:31], v[200:203]
  ds_read_b64_tr_b16 a[96:97], v229 offset:35872
  s_add_u32 s97, s97, 196608
  v_mfma_f32_16x16x32_bf16 v[36:39], a[100:103], a[16:19], v[36:39]
  s_add_u32 s96, s17, 1376256
  s_lshr_b32 s33, s2, 3
  v_mfma_f32_16x16x32_bf16 v[92:95], a[100:103], a[20:23], v[92:95]
  s_lshl_b32 s33, s33, 11
  s_lshr_b32 s34, s3, 1
  v_mfma_f32_16x16x32_bf16 v[148:151], a[100:103], a[24:27], v[148:151]
  ds_read_b64_tr_b16 a[98:99], v229 offset:39456
  s_lshl_b32 s34, s34, 16
  s_add_u32 s33, s33, s34
  v_mfma_f32_16x16x32_bf16 v[204:207], a[100:103], a[28:31], v[204:207]
  s_and_b32 s34, s3, 1
  s_lshl_b32 s34, s34, 10
  v_mfma_f32_16x16x32_bf16 v[40:43], a[104:107], a[16:19], v[40:43]
  s_add_u32 s33, s33, s34
  s_add_u32 s33, s33, 4352
  v_mfma_f32_16x16x32_bf16 v[96:99], a[104:107], a[20:23], v[96:99]
  v_and_b32 v255, 1, v231
  v_lshlrev_b32 v255, 7, v255
  v_mfma_f32_16x16x32_bf16 v[152:155], a[104:107], a[24:27], v[152:155]
  ds_read_b64_tr_b16 a[100:101], v229 offset:35904
  ds_read_b64_tr_b16 a[102:103], v229 offset:39488
  v_add_u32 v255, s33, v255
  s_sub_u32 s8, s22, 4096
  v_mfma_f32_16x16x32_bf16 v[208:211], a[104:107], a[28:31], v[208:211]
  s_subb_u32 s9, s23, 0
  s_mov_b32 s10, 7344128
  v_mfma_f32_16x16x32_bf16 v[44:47], a[108:111], a[16:19], v[44:47]
  s_add_u32 s4, s20, 0x1600000
  s_addc_u32 s5, s21, 0
  v_mfma_f32_16x16x32_bf16 v[100:103], a[108:111], a[20:23], v[100:103]
  s_mov_b32 s6, 0xe00000
  s_mov_b32 s7, 0x20000
  v_mfma_f32_16x16x32_bf16 v[156:159], a[108:111], a[24:27], v[156:159]
  ds_read_b64_tr_b16 a[104:105], v229 offset:35936
  ds_read_b64_tr_b16 a[106:107], v229 offset:39520
  v_lshrrev_b32 v232, 2, v231
  v_lshlrev_b32 v232, 7, v232
  v_mfma_f32_16x16x32_bf16 v[212:215], a[108:111], a[28:31], v[212:215]
  v_bfe_u32 v233, v231, 3, 2
  v_lshl_add_u32 v232, v233, 5, v232
  v_mfma_f32_16x16x32_bf16 v[48:51], a[112:115], a[16:19], v[48:51]
  v_and_b32 v233, 3, v231
  v_lshl_add_u32 v232, v233, 3, v232
  v_mfma_f32_16x16x32_bf16 v[104:107], a[112:115], a[20:23], v[104:107]
  v_xor_b32 v242, 0, v232
  v_add_u32 v242, 57344, v242
  v_mfma_f32_16x16x32_bf16 v[160:163], a[112:115], a[24:27], v[160:163]
  ds_read_b64_tr_b16 a[108:109], v229 offset:35968
  ds_read_b64_tr_b16 a[110:111], v229 offset:39552
  v_xor_b32 v243, 32, v232
  v_add_u32 v243, 57344, v243
  v_mfma_f32_16x16x32_bf16 v[216:219], a[112:115], a[28:31], v[216:219]
  v_xor_b32 v244, 64, v232
  v_add_u32 v244, 57344, v244
  v_mfma_f32_16x16x32_bf16 v[52:55], a[116:119], a[16:19], v[52:55]
  v_xor_b32 v245, 96, v232
  v_add_u32 v245, 57344, v245
  v_mfma_f32_16x16x32_bf16 v[108:111], a[116:119], a[20:23], v[108:111]
  ds_read_b64_tr_b16 a[112:113], v229 offset:36000
  s_mov_b32 s42, 0xbfb8aa3b
  v_mfma_f32_16x16x32_bf16 v[164:167], a[116:119], a[24:27], v[164:167]
  ds_read_b64_tr_b16 a[114:115], v229 offset:39584
  v_mfma_f32_16x16x32_bf16 v[220:223], a[116:119], a[28:31], v[220:223]
  s_waitcnt vmcnt(5) lgkmcnt(10)
  s_barrier
  v_mfma_f32_16x16x32_bf16 v[0:3], a[64:67], a[32:35], v[0:3]
  ds_read_b64_tr_b16 a[116:117], v229 offset:36032
  ds_read_b64_tr_b16 a[118:119], v229 offset:39616
  v_mfma_f32_16x16x32_bf16 v[56:59], a[64:67], a[36:39], v[56:59]
  s_add_u32 m0, s38, 0
  s_nop 0
  buffer_load_dwordx4 v225, s[8:11], s17 offen lds
  v_mfma_f32_16x16x32_bf16 v[112:115], a[64:67], a[40:43], v[112:115]
  v_mfma_f32_16x16x32_bf16 v[168:171], a[64:67], a[44:47], v[168:171]
  ds_read_b64_tr_b16 a[64:65], v229 offset:43008
  ds_read_b64_tr_b16 a[66:67], v229 offset:46592
  v_mfma_f32_16x16x32_bf16 v[4:7], a[68:71], a[32:35], v[4:7]
  buffer_load_dwordx4 v226, s[8:11], s17 offen offset:1024 lds
  v_mfma_f32_16x16x32_bf16 v[60:63], a[68:71], a[36:39], v[60:63]
  v_mfma_f32_16x16x32_bf16 v[116:119], a[68:71], a[40:43], v[116:119]
  v_mfma_f32_16x16x32_bf16 v[172:175], a[68:71], a[44:47], v[172:175]
  buffer_load_dwordx4 v227, s[8:11], s17 offen offset:2048 lds
  v_mfma_f32_16x16x32_bf16 v[8:11], a[72:75], a[32:35], v[8:11]
  ds_read_b64_tr_b16 a[68:69], v229 offset:43040
  ds_read_b64_tr_b16 a[70:71], v229 offset:46624
  v_mfma_f32_16x16x32_bf16 v[64:67], a[72:75], a[36:39], v[64:67]
  v_mfma_f32_16x16x32_bf16 v[120:123], a[72:75], a[40:43], v[120:123]
  buffer_load_dwordx4 v228, s[8:11], s17 offen offset:3072 lds
  s_add_u32 s17, s17, 458752
  v_mfma_f32_16x16x32_bf16 v[176:179], a[72:75], a[44:47], v[176:179]
  ds_read_b64_tr_b16 a[72:73], v229 offset:50176
  ds_read_b64_tr_b16 a[74:75], v229 offset:53760
  v_mfma_f32_16x16x32_bf16 v[12:15], a[76:79], a[32:35], v[12:15]
  v_mfma_f32_16x16x32_bf16 v[68:71], a[76:79], a[36:39], v[68:71]
  buffer_load_dword v251, v255, s[8:11], s96 offen
  s_add_u32 s96, s96, 458752
  v_mfma_f32_16x16x32_bf16 v[124:127], a[76:79], a[40:43], v[124:127]
  v_mfma_f32_16x16x32_bf16 v[180:183], a[76:79], a[44:47], v[180:183]
  ds_read_b64_tr_b16 a[76:77], v229 offset:50208
  ds_read_b64_tr_b16 a[78:79], v229 offset:53792
  v_mfma_f32_16x16x32_bf16 v[16:19], a[80:83], a[32:35], v[16:19]
  s_add_u32 m0, s38, 16384
  s_nop 0
  buffer_load_dwordx4 v225, s[8:11], s17 offen lds
  v_mfma_f32_16x16x32_bf16 v[72:75], a[80:83], a[36:39], v[72:75]
  v_mfma_f32_16x16x32_bf16 v[128:131], a[80:83], a[40:43], v[128:131]
  v_mfma_f32_16x16x32_bf16 v[184:187], a[80:83], a[44:47], v[184:187]
  buffer_load_dwordx4 v226, s[8:11], s17 offen offset:1024 lds
  v_mfma_f32_16x16x32_bf16 v[20:23], a[84:87], a[32:35], v[20:23]
  ds_read_b64_tr_b16 a[80:81], v229 offset:43072
  ds_read_b64_tr_b16 a[82:83], v229 offset:46656
  v_mfma_f32_16x16x32_bf16 v[76:79], a[84:87], a[36:39], v[76:79]
  v_mfma_f32_16x16x32_bf16 v[132:135], a[84:87], a[40:43], v[132:135]
  buffer_load_dwordx4 v227, s[8:11], s17 offen offset:2048 lds
  v_mfma_f32_16x16x32_bf16 v[188:191], a[84:87], a[44:47], v[188:191]
  ds_read_b64_tr_b16 a[84:85], v229 offset:43104
  ds_read_b64_tr_b16 a[86:87], v229 offset:46688
  v_mfma_f32_16x16x32_bf16 v[24:27], a[88:91], a[32:35], v[24:27]
  v_mfma_f32_16x16x32_bf16 v[80:83], a[88:91], a[36:39], v[80:83]
  buffer_load_dwordx4 v228, s[8:11], s17 offen offset:3072 lds
  s_add_u32 s17, s17, 458752
  v_mfma_f32_16x16x32_bf16 v[136:139], a[88:91], a[40:43], v[136:139]
  v_mfma_f32_16x16x32_bf16 v[192:195], a[88:91], a[44:47], v[192:195]
  ds_read_b64_tr_b16 a[88:89], v229 offset:50240
  ds_read_b64_tr_b16 a[90:91], v229 offset:53824
  v_mfma_f32_16x16x32_bf16 v[28:31], a[92:95], a[32:35], v[28:31]
  buffer_load_dword v251, v255, s[8:11], s96 offen
  s_add_u32 s96, s96, 458752
  v_mfma_f32_16x16x32_bf16 v[84:87], a[92:95], a[36:39], v[84:87]
  v_mfma_f32_16x16x32_bf16 v[140:143], a[92:95], a[40:43], v[140:143]
  v_mfma_f32_16x16x32_bf16 v[196:199], a[92:95], a[44:47], v[196:199]
  s_add_u32 m0, s38, 32768
  s_nop 0
  buffer_load_dwordx4 v225, s[8:11], s17 offen lds
  s_waitcnt lgkmcnt(10)
  v_mfma_f32_16x16x32_bf16 v[32:35], a[96:99], a[32:35], v[32:35]
  ds_read_b64_tr_b16 a[92:93], v229 offset:50272
  ds_read_b64_tr_b16 a[94:95], v229 offset:53856
  v_mfma_f32_16x16x32_bf16 v[88:91], a[96:99], a[36:39], v[88:91]
  v_mfma_f32_16x16x32_bf16 v[144:147], a[96:99], a[40:43], v[144:147]
  buffer_load_dwordx4 v226, s[8:11], s17 offen offset:1024 lds
  v_mfma_f32_16x16x32_bf16 v[200:203], a[96:99], a[44:47], v[200:203]
  ds_read_b64_tr_b16 a[96:97], v229 offset:43136
  ds_read_b64_tr_b16 a[98:99], v229 offset:46720
  v_mfma_f32_16x16x32_bf16 v[36:39], a[100:103], a[32:35], v[36:39]
  v_mfma_f32_16x16x32_bf16 v[92:95], a[100:103], a[36:39], v[92:95]
  buffer_load_dwordx4 v227, s[8:11], s17 offen offset:2048 lds
  v_mfma_f32_16x16x32_bf16 v[148:151], a[100:103], a[40:43], v[148:151]
  v_mfma_f32_16x16x32_bf16 v[204:207], a[100:103], a[44:47], v[204:207]
  ds_read_b64_tr_b16 a[100:101], v229 offset:43168
  ds_read_b64_tr_b16 a[102:103], v229 offset:46752
  v_mfma_f32_16x16x32_bf16 v[40:43], a[104:107], a[32:35], v[40:43]
  buffer_load_dwordx4 v228, s[8:11], s17 offen offset:3072 lds
  s_add_u32 s17, s17, 458752
  v_mfma_f32_16x16x32_bf16 v[96:99], a[104:107], a[36:39], v[96:99]
  v_mfma_f32_16x16x32_bf16 v[152:155], a[104:107], a[40:43], v[152:155]
  v_mfma_f32_16x16x32_bf16 v[208:211], a[104:107], a[44:47], v[208:211]
  buffer_load_dword v251, v255, s[8:11], s96 offen
  s_add_u32 s96, s96, 458752
  v_mfma_f32_16x16x32_bf16 v[44:47], a[108:111], a[32:35], v[44:47]
  ds_read_b64_tr_b16 a[104:105], v229 offset:43200
  ds_read_b64_tr_b16 a[106:107], v229 offset:46784
  v_mfma_f32_16x16x32_bf16 v[100:103], a[108:111], a[36:39], v[100:103]
  v_mfma_f32_16x16x32_bf16 v[156:159], a[108:111], a[40:43], v[156:159]
  v_mfma_f32_16x16x32_bf16 v[212:215], a[108:111], a[44:47], v[212:215]
  ds_read_b64_tr_b16 a[108:109], v229 offset:50304
  ds_read_b64_tr_b16 a[110:111], v229 offset:53888
  v_mfma_f32_16x16x32_bf16 v[48:51], a[112:115], a[32:35], v[48:51]
  v_mfma_f32_16x16x32_bf16 v[104:107], a[112:115], a[36:39], v[104:107]
  v_mfma_f32_16x16x32_bf16 v[160:163], a[112:115], a[40:43], v[160:163]
  v_mfma_f32_16x16x32_bf16 v[216:219], a[112:115], a[44:47], v[216:219]
  ds_read_b64_tr_b16 a[112:113], v229 offset:50336
  ds_read_b64_tr_b16 a[114:115], v229 offset:53920
  v_mfma_f32_16x16x32_bf16 v[52:55], a[116:119], a[32:35], v[52:55]
  v_mfma_f32_16x16x32_bf16 v[108:111], a[116:119], a[36:39], v[108:111]
  v_mfma_f32_16x16x32_bf16 v[164:167], a[116:119], a[40:43], v[164:167]
  v_mfma_f32_16x16x32_bf16 v[220:223], a[116:119], a[44:47], v[220:223]
  s_waitcnt vmcnt(16) lgkmcnt(10)
  s_barrier
  v_mfma_f32_16x16x32_bf16 v[0:3], a[64:67], a[48:51], v[0:3]
  ds_read_b64_tr_b16 a[116:117], v229 offset:50368
  ds_read_b64_tr_b16 a[118:119], v229 offset:53952
  v_mfma_f32_16x16x32_bf16 v[56:59], a[64:67], a[52:55], v[56:59]
  v_mfma_f32_16x16x32_bf16 v[112:115], a[64:67], a[56:59], v[112:115]
  v_mfma_f32_16x16x32_bf16 v[168:171], a[64:67], a[60:63], v[168:171]
  v_mfma_f32_16x16x32_bf16 v[4:7], a[68:71], a[48:51], v[4:7]
  v_mfma_f32_16x16x32_bf16 v[60:63], a[68:71], a[52:55], v[60:63]
  v_mfma_f32_16x16x32_bf16 v[116:119], a[68:71], a[56:59], v[116:119]
  v_mfma_f32_16x16x32_bf16 v[172:175], a[68:71], a[60:63], v[172:175]
  v_mfma_f32_16x16x32_bf16 v[28:31], a[72:75], a[48:51], v[28:31]
  v_mfma_f32_16x16x32_bf16 v[84:87], a[72:75], a[52:55], v[84:87]
  v_mfma_f32_16x16x32_bf16 v[140:143], a[72:75], a[56:59], v[140:143]
  v_mfma_f32_16x16x32_bf16 v[196:199], a[72:75], a[60:63], v[196:199]
  v_mfma_f32_16x16x32_bf16 v[32:35], a[76:79], a[48:51], v[32:35]
  v_mfma_f32_16x16x32_bf16 v[88:91], a[76:79], a[52:55], v[88:91]
  v_mfma_f32_16x16x32_bf16 v[144:147], a[76:79], a[56:59], v[144:147]
  v_mfma_f32_16x16x32_bf16 v[200:203], a[76:79], a[60:63], v[200:203]
  v_mfma_f32_16x16x32_bf16 v[8:11], a[80:83], a[48:51], v[8:11]
  v_mfma_f32_16x16x32_bf16 v[64:67], a[80:83], a[52:55], v[64:67]
  v_mfma_f32_16x16x32_bf16 v[120:123], a[80:83], a[56:59], v[120:123]
  v_mfma_f32_16x16x32_bf16 v[176:179], a[80:83], a[60:63], v[176:179]
  v_mfma_f32_16x16x32_bf16 v[12:15], a[84:87], a[48:51], v[12:15]
  v_mfma_f32_16x16x32_bf16 v[68:71], a[84:87], a[52:55], v[68:71]
  v_mfma_f32_16x16x32_bf16 v[124:127], a[84:87], a[56:59], v[124:127]
  v_mfma_f32_16x16x32_bf16 v[180:183], a[84:87], a[60:63], v[180:183]
  v_mfma_f32_16x16x32_bf16 v[36:39], a[88:91], a[48:51], v[36:39]
  v_mfma_f32_16x16x32_bf16 v[92:95], a[88:91], a[52:55], v[92:95]
  v_mfma_f32_16x16x32_bf16 v[148:151], a[88:91], a[56:59], v[148:151]
  v_mfma_f32_16x16x32_bf16 v[204:207], a[88:91], a[60:63], v[204:207]
  v_mfma_f32_16x16x32_bf16 v[40:43], a[92:95], a[48:51], v[40:43]
  v_mfma_f32_16x16x32_bf16 v[96:99], a[92:95], a[52:55], v[96:99]
  v_mfma_f32_16x16x32_bf16 v[152:155], a[92:95], a[56:59], v[152:155]
  v_mfma_f32_16x16x32_bf16 v[208:211], a[92:95], a[60:63], v[208:211]
  s_waitcnt lgkmcnt(10)
  v_mfma_f32_16x16x32_bf16 v[16:19], a[96:99], a[48:51], v[16:19]
  v_mfma_f32_16x16x32_bf16 v[72:75], a[96:99], a[52:55], v[72:75]
  v_mfma_f32_16x16x32_bf16 v[128:131], a[96:99], a[56:59], v[128:131]
  v_mfma_f32_16x16x32_bf16 v[184:187], a[96:99], a[60:63], v[184:187]
  s_waitcnt lgkmcnt(8)
  v_mfma_f32_16x16x32_bf16 v[20:23], a[100:103], a[48:51], v[20:23]
  v_mfma_f32_16x16x32_bf16 v[76:79], a[100:103], a[52:55], v[76:79]
  v_mfma_f32_16x16x32_bf16 v[132:135], a[100:103], a[56:59], v[132:135]
  v_mfma_f32_16x16x32_bf16 v[188:191], a[100:103], a[60:63], v[188:191]
  s_waitcnt lgkmcnt(6)
  v_mfma_f32_16x16x32_bf16 v[24:27], a[104:107], a[48:51], v[24:27]
  v_mfma_f32_16x16x32_bf16 v[80:83], a[104:107], a[52:55], v[80:83]
  v_mfma_f32_16x16x32_bf16 v[136:139], a[104:107], a[56:59], v[136:139]
  v_mfma_f32_16x16x32_bf16 v[192:195], a[104:107], a[60:63], v[192:195]
  s_waitcnt lgkmcnt(4)
  v_mfma_f32_16x16x32_bf16 v[44:47], a[108:111], a[48:51], v[44:47]
  v_mfma_f32_16x16x32_bf16 v[100:103], a[108:111], a[52:55], v[100:103]
  v_mfma_f32_16x16x32_bf16 v[156:159], a[108:111], a[56:59], v[156:159]
  v_mfma_f32_16x16x32_bf16 v[212:215], a[108:111], a[60:63], v[212:215]
  s_waitcnt lgkmcnt(2)
  v_mfma_f32_16x16x32_bf16 v[48:51], a[112:115], a[48:51], v[48:51]
  v_mfma_f32_16x16x32_bf16 v[104:107], a[112:115], a[52:55], v[104:107]
  v_mfma_f32_16x16x32_bf16 v[160:163], a[112:115], a[56:59], v[160:163]
  v_mfma_f32_16x16x32_bf16 v[216:219], a[112:115], a[60:63], v[216:219]
  s_waitcnt lgkmcnt(0)
  v_mfma_f32_16x16x32_bf16 v[52:55], a[116:119], a[48:51], v[52:55]
  v_mfma_f32_16x16x32_bf16 v[108:111], a[116:119], a[52:55], v[108:111]
  v_mfma_f32_16x16x32_bf16 v[164:167], a[116:119], a[56:59], v[164:167]
  v_mfma_f32_16x16x32_bf16 v[220:223], a[116:119], a[60:63], v[220:223]
  s_nop 7
  s_nop 1
L_k56_seam:
  v_mul_f32 v232, s42, v0
  v_mul_f32 v233, s42, v1
  v_mul_f32 v234, s42, v2
  v_mul_f32 v235, s42, v3
  v_exp_f32 v232, v232
  v_exp_f32 v233, v233
  v_exp_f32 v234, v234
  v_exp_f32 v235, v235
  v_add_f32 v232, 1.0, v232
  v_add_f32 v233, 1.0, v233
  v_add_f32 v234, 1.0, v234
  v_add_f32 v235, 1.0, v235
  v_rcp_f32 v232, v232
  v_rcp_f32 v233, v233
  v_rcp_f32 v234, v234
  v_rcp_f32 v235, v235
  v_mul_f32 v232, v232, v28
  v_mul_f32 v233, v233, v29
  v_mul_f32 v234, v234, v30
  v_mul_f32 v235, v235, v31
  v_cvt_pk_bf16_f32 v0, v232, v233
  v_cvt_pk_bf16_f32 v1, v234, v235
  v_mul_f32 v236, s42, v4
  v_mul_f32 v237, s42, v5
  v_mul_f32 v238, s42, v6
  v_mul_f32 v239, s42, v7
  v_exp_f32 v236, v236
  v_exp_f32 v237, v237
  v_exp_f32 v238, v238
  v_exp_f32 v239, v239
  v_add_f32 v236, 1.0, v236
  v_add_f32 v237, 1.0, v237
  v_add_f32 v238, 1.0, v238
  v_add_f32 v239, 1.0, v239
  v_rcp_f32 v236, v236
  v_rcp_f32 v237, v237
  v_rcp_f32 v238, v238
  v_rcp_f32 v239, v239
  v_mul_f32 v236, v236, v32
  v_mul_f32 v237, v237, v33
  v_mul_f32 v238, v238, v34
  v_mul_f32 v239, v239, v35
  v_cvt_pk_bf16_f32 v2, v236, v237
  v_cvt_pk_bf16_f32 v3, v238, v239
  buffer_store_dwordx4 v[0:3], v224, s[12:15], s98 offen offset:0 sc1
  v_mul_f32 v232, s42, v56
  v_mul_f32 v233, s42, v57
  v_mul_f32 v234, s42, v58
  v_mul_f32 v235, s42, v59
  v_exp_f32 v232, v232
  v_exp_f32 v233, v233
  v_exp_f32 v234, v234
  v_exp_f32 v235, v235
  v_add_f32 v232, 1.0, v232
  v_add_f32 v233, 1.0, v233
  v_add_f32 v234, 1.0, v234
  v_add_f32 v235, 1.0, v235
  v_rcp_f32 v232, v232
  v_rcp_f32 v233, v233
  v_rcp_f32 v234, v234
  v_rcp_f32 v235, v235
  v_mul_f32 v232, v232, v84
  v_mul_f32 v233, v233, v85
  v_mul_f32 v234, v234, v86
  v_mul_f32 v235, v235, v87
  v_cvt_pk_bf16_f32 v56, v232, v233
  v_cvt_pk_bf16_f32 v57, v234, v235
  v_mul_f32 v236, s42, v60
  v_mul_f32 v237, s42, v61
  v_mul_f32 v238, s42, v62
  v_mul_f32 v239, s42, v63
  v_exp_f32 v236, v236
  v_exp_f32 v237, v237
  v_exp_f32 v238, v238
  v_exp_f32 v239, v239
  v_add_f32 v236, 1.0, v236
  v_add_f32 v237, 1.0, v237
  v_add_f32 v238, 1.0, v238
  v_add_f32 v239, 1.0, v239
  v_rcp_f32 v236, v236
  v_rcp_f32 v237, v237
  v_rcp_f32 v238, v238
  v_rcp_f32 v239, v239
  v_mul_f32 v236, v236, v88
  v_mul_f32 v237, v237, v89
  v_mul_f32 v238, v238, v90
  v_mul_f32 v239, v239, v91
  v_cvt_pk_bf16_f32 v58, v236, v237
  v_cvt_pk_bf16_f32 v59, v238, v239
  buffer_store_dwordx4 v[56:59], v224, s[12:15], s98 offen offset:1024 sc1
  v_mul_f32 v232, s42, v112
  v_mul_f32 v233, s42, v113
  v_mul_f32 v234, s42, v114
  v_mul_f32 v235, s42, v115
  v_exp_f32 v232, v232
  v_exp_f32 v233, v233
  v_exp_f32 v234, v234
  v_exp_f32 v235, v235
  v_add_f32 v232, 1.0, v232
  v_add_f32 v233, 1.0, v233
  v_add_f32 v234, 1.0, v234
  v_add_f32 v235, 1.0, v235
  v_rcp_f32 v232, v232
  v_rcp_f32 v233, v233
  v_rcp_f32 v234, v234
  v_rcp_f32 v235, v235
  v_mul_f32 v232, v232, v140
  v_mul_f32 v233, v233, v141
  v_mul_f32 v234, v234, v142
  v_mul_f32 v235, v235, v143
  v_cvt_pk_bf16_f32 v112, v232, v233
  v_cvt_pk_bf16_f32 v113, v234, v235
  v_mul_f32 v236, s42, v116
  v_mul_f32 v237, s42, v117
  v_mul_f32 v238, s42, v118
  v_mul_f32 v239, s42, v119
  v_exp_f32 v236, v236
  v_exp_f32 v237, v237
  v_exp_f32 v238, v238
  v_exp_f32 v239, v239
  v_add_f32 v236, 1.0, v236
  v_add_f32 v237, 1.0, v237
  v_add_f32 v238, 1.0, v238
  v_add_f32 v239, 1.0, v239
  v_rcp_f32 v236, v236
  v_rcp_f32 v237, v237
  v_rcp_f32 v238, v238
  v_rcp_f32 v239, v239
  v_mul_f32 v236, v236, v144
  v_mul_f32 v237, v237, v145
  v_mul_f32 v238, v238, v146
  v_mul_f32 v239, v239, v147
  v_cvt_pk_bf16_f32 v114, v236, v237
  v_cvt_pk_bf16_f32 v115, v238, v239
  buffer_store_dwordx4 v[112:115], v224, s[12:15], s98 offen offset:2048 sc1
  v_mul_f32 v232, s42, v168
  v_mul_f32 v233, s42, v169
  v_mul_f32 v234, s42, v170
  v_mul_f32 v235, s42, v171
  v_exp_f32 v232, v232
  v_exp_f32 v233, v233
  v_exp_f32 v234, v234
  v_exp_f32 v235, v235
  v_add_f32 v232, 1.0, v232
  v_add_f32 v233, 1.0, v233
  v_add_f32 v234, 1.0, v234
  v_add_f32 v235, 1.0, v235
  v_rcp_f32 v232, v232
  v_rcp_f32 v233, v233
  v_rcp_f32 v234, v234
  v_rcp_f32 v235, v235
  v_mul_f32 v232, v232, v196
  v_mul_f32 v233, v233, v197
  v_mul_f32 v234, v234, v198
  v_mul_f32 v235, v235, v199
  v_cvt_pk_bf16_f32 v168, v232, v233
  v_cvt_pk_bf16_f32 v169, v234, v235
  v_mul_f32 v236, s42, v172
  v_mul_f32 v237, s42, v173
  v_mul_f32 v238, s42, v174
  v_mul_f32 v239, s42, v175
  v_exp_f32 v236, v236
  v_exp_f32 v237, v237
  v_exp_f32 v238, v238
  v_exp_f32 v239, v239
  v_add_f32 v236, 1.0, v236
  v_add_f32 v237, 1.0, v237
  v_add_f32 v238, 1.0, v238
  v_add_f32 v239, 1.0, v239
  v_rcp_f32 v236, v236
  v_rcp_f32 v237, v237
  v_rcp_f32 v238, v238
  v_rcp_f32 v239, v239
  v_mul_f32 v236, v236, v200
  v_mul_f32 v237, v237, v201
  v_mul_f32 v238, v238, v202
  v_mul_f32 v239, v239, v203
  v_cvt_pk_bf16_f32 v170, v236, v237
  v_cvt_pk_bf16_f32 v171, v238, v239
  buffer_store_dwordx4 v[168:171], v224, s[12:15], s98 offen offset:3072 sc1
  v_mul_f32 v232, s42, v8
  v_mul_f32 v233, s42, v9
  v_mul_f32 v234, s42, v10
  v_mul_f32 v235, s42, v11
  v_exp_f32 v232, v232
  v_exp_f32 v233, v233
  v_exp_f32 v234, v234
  v_exp_f32 v235, v235
  v_add_f32 v232, 1.0, v232
  v_add_f32 v233, 1.0, v233
  v_add_f32 v234, 1.0, v234
  v_add_f32 v235, 1.0, v235
  v_rcp_f32 v232, v232
  v_rcp_f32 v233, v233
  v_rcp_f32 v234, v234
  v_rcp_f32 v235, v235
  v_mul_f32 v232, v232, v36
  v_mul_f32 v233, v233, v37
  v_mul_f32 v234, v234, v38
  v_mul_f32 v235, v235, v39
  v_cvt_pk_bf16_f32 v4, v232, v233
  v_cvt_pk_bf16_f32 v5, v234, v235
  v_mul_f32 v236, s42, v12
  v_mul_f32 v237, s42, v13
  v_mul_f32 v238, s42, v14
  v_mul_f32 v239, s42, v15
  v_exp_f32 v236, v236
  v_exp_f32 v237, v237
  v_exp_f32 v238, v238
  v_exp_f32 v239, v239
  v_add_f32 v236, 1.0, v236
  v_add_f32 v237, 1.0, v237
  v_add_f32 v238, 1.0, v238
  v_add_f32 v239, 1.0, v239
  v_rcp_f32 v236, v236
  v_rcp_f32 v237, v237
  v_rcp_f32 v238, v238
  v_rcp_f32 v239, v239
  v_mul_f32 v236, v236, v40
  v_mul_f32 v237, v237, v41
  v_mul_f32 v238, v238, v42
  v_mul_f32 v239, v239, v43
  v_cvt_pk_bf16_f32 v6, v236, v237
  v_cvt_pk_bf16_f32 v7, v238, v239
  v_mul_f32 v232, s42, v64
  v_mul_f32 v233, s42, v65
  v_mul_f32 v234, s42, v66
  v_mul_f32 v235, s42, v67
  v_exp_f32 v232, v232
  v_exp_f32 v233, v233
  v_exp_f32 v234, v234
  v_exp_f32 v235, v235
  v_add_f32 v232, 1.0, v232
  v_add_f32 v233, 1.0, v233
  v_add_f32 v234, 1.0, v234
  v_add_f32 v235, 1.0, v235
  v_rcp_f32 v232, v232
  v_rcp_f32 v233, v233
  v_rcp_f32 v234, v234
  v_rcp_f32 v235, v235
  v_mul_f32 v232, v232, v92
  v_mul_f32 v233, v233, v93
  v_mul_f32 v234, v234, v94
  v_mul_f32 v235, v235, v95
  v_cvt_pk_bf16_f32 v60, v232, v233
  v_cvt_pk_bf16_f32 v61, v234, v235
  v_mul_f32 v236, s42, v68
  v_mul_f32 v237, s42, v69
  v_mul_f32 v238, s42, v70
  v_mul_f32 v239, s42, v71
  v_exp_f32 v236, v236
  v_exp_f32 v237, v237
  v_exp_f32 v238, v238
  v_exp_f32 v239, v239
  v_add_f32 v236, 1.0, v236
  v_add_f32 v237, 1.0, v237
  v_add_f32 v238, 1.0, v238
  v_add_f32 v239, 1.0, v239
  v_rcp_f32 v236, v236
  v_rcp_f32 v237, v237
  v_rcp_f32 v238, v238
  v_rcp_f32 v239, v239
  v_mul_f32 v236, v236, v96
  v_mul_f32 v237, v237, v97
  v_mul_f32 v238, v238, v98
  v_mul_f32 v239, v239, v99
  v_cvt_pk_bf16_f32 v62, v236, v237
  v_cvt_pk_bf16_f32 v63, v238, v239
  v_mul_f32 v232, s42, v120
  v_mul_f32 v233, s42, v121
  v_mul_f32 v234, s42, v122
  v_mul_f32 v235, s42, v123
  v_exp_f32 v232, v232
  v_exp_f32 v233, v233
  v_exp_f32 v234, v234
  v_exp_f32 v235, v235
  v_add_f32 v232, 1.0, v232
  v_add_f32 v233, 1.0, v233
  v_add_f32 v234, 1.0, v234
  v_add_f32 v235, 1.0, v235
  v_rcp_f32 v232, v232
  v_rcp_f32 v233, v233
  v_rcp_f32 v234, v234
  v_rcp_f32 v235, v235
  v_mul_f32 v232, v232, v148
  v_mul_f32 v233, v233, v149
  v_mul_f32 v234, v234, v150
  v_mul_f32 v235, v235, v151
  v_cvt_pk_bf16_f32 v116, v232, v233
  v_cvt_pk_bf16_f32 v117, v234, v235
  v_mul_f32 v236, s42, v124
  v_mul_f32 v237, s42, v125
  v_mul_f32 v238, s42, v126
  v_mul_f32 v239, s42, v127
  v_exp_f32 v236, v236
  v_exp_f32 v237, v237
  v_exp_f32 v238, v238
  v_exp_f32 v239, v239
  v_add_f32 v236, 1.0, v236
  v_add_f32 v237, 1.0, v237
  v_add_f32 v238, 1.0, v238
  v_add_f32 v239, 1.0, v239
  v_rcp_f32 v236, v236
  v_rcp_f32 v237, v237
  v_rcp_f32 v238, v238
  v_rcp_f32 v239, v239
  v_mul_f32 v236, v236, v152
  v_mul_f32 v237, v237, v153
  v_mul_f32 v238, v238, v154
  v_mul_f32 v239, v239, v155
  v_cvt_pk_bf16_f32 v118, v236, v237
  v_cvt_pk_bf16_f32 v119, v238, v239
  s_waitcnt vmcnt(0)
  s_mov_b64 exec, 1
  buffer_store_dword v248, v250, s[56:59], s92 offen sc1
  s_mov_b64 exec, -1
  s_add_u32 s92, s92, 65536
  v_mul_f32 v232, s42, v176
  v_mul_f32 v233, s42, v177
  v_mul_f32 v234, s42, v178
  v_mul_f32 v235, s42, v179
  v_exp_f32 v232, v232
  v_exp_f32 v233, v233
  v_exp_f32 v234, v234
  v_exp_f32 v235, v235
  v_add_f32 v232, 1.0, v232
  v_add_f32 v233, 1.0, v233
  v_add_f32 v234, 1.0, v234
  v_add_f32 v235, 1.0, v235
  v_rcp_f32 v232, v232
  v_rcp_f32 v233, v233
  v_rcp_f32 v234, v234
  v_rcp_f32 v235, v235
  v_mul_f32 v232, v232, v204
  v_mul_f32 v233, v233, v205
  v_mul_f32 v234, v234, v206
  v_mul_f32 v235, v235, v207
  v_cvt_pk_bf16_f32 v172, v232, v233
  v_cvt_pk_bf16_f32 v173, v234, v235
  v_mul_f32 v236, s42, v180
  v_mul_f32 v237, s42, v181
  v_mul_f32 v238, s42, v182
  v_mul_f32 v239, s42, v183
  v_exp_f32 v236, v236
  v_exp_f32 v237, v237
  v_exp_f32 v238, v238
  v_exp_f32 v239, v239
  v_add_f32 v236, 1.0, v236
  v_add_f32 v237, 1.0, v237
  v_add_f32 v238, 1.0, v238
  v_add_f32 v239, 1.0, v239
  v_rcp_f32 v236, v236
  v_rcp_f32 v237, v237
  v_rcp_f32 v238, v238
  v_rcp_f32 v239, v239
  v_mul_f32 v236, v236, v208
  v_mul_f32 v237, v237, v209
  v_mul_f32 v238, v238, v210
  v_mul_f32 v239, v239, v211
  v_cvt_pk_bf16_f32 v174, v236, v237
  v_cvt_pk_bf16_f32 v175, v238, v239
  v_mul_f32 v232, s42, v16
  v_mul_f32 v233, s42, v17
  v_mul_f32 v234, s42, v18
  v_mul_f32 v235, s42, v19
  v_exp_f32 v232, v232
  v_exp_f32 v233, v233
  v_exp_f32 v234, v234
  v_exp_f32 v235, v235
  v_add_f32 v232, 1.0, v232
  v_add_f32 v233, 1.0, v233
  v_add_f32 v234, 1.0, v234
  v_add_f32 v235, 1.0, v235
  v_rcp_f32 v232, v232
  v_rcp_f32 v233, v233
  v_rcp_f32 v234, v234
  v_rcp_f32 v235, v235
  v_mul_f32 v232, v232, v44
  v_mul_f32 v233, v233, v45
  v_mul_f32 v234, v234, v46
  v_mul_f32 v235, v235, v47
  v_cvt_pk_bf16_f32 v8, v232, v233
  v_cvt_pk_bf16_f32 v9, v234, v235
  v_mul_f32 v236, s42, v20
  v_mul_f32 v237, s42, v21
  v_mul_f32 v238, s42, v22
  v_mul_f32 v239, s42, v23
  v_exp_f32 v236, v236
  v_exp_f32 v237, v237
  v_exp_f32 v238, v238
  v_exp_f32 v239, v239
  v_add_f32 v236, 1.0, v236
  v_add_f32 v237, 1.0, v237
  v_add_f32 v238, 1.0, v238
  v_add_f32 v239, 1.0, v239
  v_rcp_f32 v236, v236
  v_rcp_f32 v237, v237
  v_rcp_f32 v238, v238
  v_rcp_f32 v239, v239
  v_mul_f32 v236, v236, v48
  v_mul_f32 v237, v237, v49
  v_mul_f32 v238, v238, v50
  v_mul_f32 v239, v239, v51
  v_cvt_pk_bf16_f32 v10, v236, v237
  v_cvt_pk_bf16_f32 v11, v238, v239
  v_mul_f32 v232, s42, v72
  v_mul_f32 v233, s42, v73
  v_mul_f32 v234, s42, v74
  v_mul_f32 v235, s42, v75
  v_exp_f32 v232, v232
  v_exp_f32 v233, v233
  v_exp_f32 v234, v234
  v_exp_f32 v235, v235
  v_add_f32 v232, 1.0, v232
  v_add_f32 v233, 1.0, v233
  v_add_f32 v234, 1.0, v234
  v_add_f32 v235, 1.0, v235
  v_rcp_f32 v232, v232
  v_rcp_f32 v233, v233
  v_rcp_f32 v234, v234
  v_rcp_f32 v235, v235
  v_mul_f32 v232, v232, v100
  v_mul_f32 v233, v233, v101
  v_mul_f32 v234, v234, v102
  v_mul_f32 v235, v235, v103
  v_cvt_pk_bf16_f32 v64, v232, v233
  v_cvt_pk_bf16_f32 v65, v234, v235
  v_mul_f32 v236, s42, v76
  v_mul_f32 v237, s42, v77
  v_mul_f32 v238, s42, v78
  v_mul_f32 v239, s42, v79
  v_exp_f32 v236, v236
  v_exp_f32 v237, v237
  v_exp_f32 v238, v238
  v_exp_f32 v239, v239
  v_add_f32 v236, 1.0, v236
  v_add_f32 v237, 1.0, v237
  v_add_f32 v238, 1.0, v238
  v_add_f32 v239, 1.0, v239
  v_rcp_f32 v236, v236
  v_rcp_f32 v237, v237
  v_rcp_f32 v238, v238
  v_rcp_f32 v239, v239
  v_mul_f32 v236, v236, v104
  v_mul_f32 v237, v237, v105
  v_mul_f32 v238, v238, v106
  v_mul_f32 v239, v239, v107
  v_cvt_pk_bf16_f32 v66, v236, v237
  v_cvt_pk_bf16_f32 v67, v238, v239
  v_mul_f32 v232, s42, v128
  v_mul_f32 v233, s42, v129
  v_mul_f32 v234, s42, v130
  v_mul_f32 v235, s42, v131
  v_exp_f32 v232, v232
  v_exp_f32 v233, v233
  v_exp_f32 v234, v234
  v_exp_f32 v235, v235
  v_add_f32 v232, 1.0, v232
  v_add_f32 v233, 1.0, v233
  v_add_f32 v234, 1.0, v234
  v_add_f32 v235, 1.0, v235
  v_rcp_f32 v232, v232
  v_rcp_f32 v233, v233
  v_rcp_f32 v234, v234
  v_rcp_f32 v235, v235
  v_mul_f32 v232, v232, v156
  v_mul_f32 v233, v233, v157
  v_mul_f32 v234, v234, v158
  v_mul_f32 v235, v235, v159
  v_cvt_pk_bf16_f32 v120, v232, v233
  v_cvt_pk_bf16_f32 v121, v234, v235
  v_mul_f32 v236, s42, v132
  v_mul_f32 v237, s42, v133
  v_mul_f32 v238, s42, v134
  v_mul_f32 v239, s42, v135
  v_exp_f32 v236, v236
  v_exp_f32 v237, v237
  v_exp_f32 v238, v238
  v_exp_f32 v239, v239
  v_add_f32 v236, 1.0, v236
  v_add_f32 v237, 1.0, v237
  v_add_f32 v238, 1.0, v238
  v_add_f32 v239, 1.0, v239
  v_rcp_f32 v236, v236
  v_rcp_f32 v237, v237
  v_rcp_f32 v238, v238
  v_rcp_f32 v239, v239
  v_mul_f32 v236, v236, v160
  v_mul_f32 v237, v237, v161
  v_mul_f32 v238, v238, v162
  v_mul_f32 v239, v239, v163
  v_cvt_pk_bf16_f32 v122, v236, v237
  v_cvt_pk_bf16_f32 v123, v238, v239
  v_mul_f32 v232, s42, v184
  v_mul_f32 v233, s42, v185
  v_mul_f32 v234, s42, v186
  v_mul_f32 v235, s42, v187
  v_exp_f32 v232, v232
  v_exp_f32 v233, v233
  v_exp_f32 v234, v234
  v_exp_f32 v235, v235
  v_add_f32 v232, 1.0, v232
  v_add_f32 v233, 1.0, v233
  v_add_f32 v234, 1.0, v234
  v_add_f32 v235, 1.0, v235
  v_rcp_f32 v232, v232
  v_rcp_f32 v233, v233
  v_rcp_f32 v234, v234
  v_rcp_f32 v235, v235
  v_mul_f32 v232, v232, v212
  v_mul_f32 v233, v233, v213
  v_mul_f32 v234, v234, v214
  v_mul_f32 v235, v235, v215
  v_cvt_pk_bf16_f32 v176, v232, v233
  v_cvt_pk_bf16_f32 v177, v234, v235
  v_mul_f32 v236, s42, v188
  v_mul_f32 v237, s42, v189
  v_mul_f32 v238, s42, v190
  v_mul_f32 v239, s42, v191
  v_exp_f32 v236, v236
  v_exp_f32 v237, v237
  v_exp_f32 v238, v238
  v_exp_f32 v239, v239
  v_add_f32 v236, 1.0, v236
  v_add_f32 v237, 1.0, v237
  v_add_f32 v238, 1.0, v238
  v_add_f32 v239, 1.0, v239
  v_rcp_f32 v236, v236
  v_rcp_f32 v237, v237
  v_rcp_f32 v238, v238
  v_rcp_f32 v239, v239
  v_mul_f32 v236, v236, v216
  v_mul_f32 v237, v237, v217
  v_mul_f32 v238, v238, v218
  v_mul_f32 v239, v239, v219
  v_cvt_pk_bf16_f32 v178, v236, v237
  v_cvt_pk_bf16_f32 v179, v238, v239
  buffer_load_dword v247, v246, s[56:59], s94 offen sc1
  buffer_store_dwordx4 v[4:7], v224, s[12:15], s99 offen offset:0 sc1
  buffer_store_dwordx4 v[60:63], v224, s[12:15], s99 offen offset:1024 sc1
  buffer_store_dwordx4 v[116:119], v224, s[12:15], s99 offen offset:2048 sc1
  buffer_store_dwordx4 v[172:175], v224, s[12:15], s99 offen offset:3072 sc1
  v_mul_f32 v232, s42, v24
  v_mul_f32 v233, s42, v25
  v_mul_f32 v234, s42, v26
  v_mul_f32 v235, s42, v27
  v_exp_f32 v232, v232
  v_exp_f32 v233, v233
  v_exp_f32 v234, v234
  v_exp_f32 v235, v235
  v_add_f32 v232, 1.0, v232
  v_add_f32 v233, 1.0, v233
  v_add_f32 v234, 1.0, v234
  v_add_f32 v235, 1.0, v235
  v_rcp_f32 v232, v232
  v_rcp_f32 v233, v233
  v_rcp_f32 v234, v234
  v_rcp_f32 v235, v235
  v_mul_f32 v232, v232, v52
  v_mul_f32 v233, v233, v53
  v_mul_f32 v234, v234, v54
  v_mul_f32 v235, v235, v55
  v_cvt_pk_bf16_f32 v12, v232, v233
  v_cvt_pk_bf16_f32 v13, v234, v235
  v_mul_f32 v236, s42, v80
  v_mul_f32 v237, s42, v81
  v_mul_f32 v238, s42, v82
  v_mul_f32 v239, s42, v83
  v_exp_f32 v236, v236
  v_exp_f32 v237, v237
  v_exp_f32 v238, v238
  v_exp_f32 v239, v239
  v_add_f32 v236, 1.0, v236
  v_add_f32 v237, 1.0, v237
  v_add_f32 v238, 1.0, v238
  v_add_f32 v239, 1.0, v239
  v_rcp_f32 v236, v236
  v_rcp_f32 v237, v237
  v_rcp_f32 v238, v238
  v_rcp_f32 v239, v239
  v_mul_f32 v236, v236, v108
  v_mul_f32 v237, v237, v109
  v_mul_f32 v238, v238, v110
  v_mul_f32 v239, v239, v111
  v_cvt_pk_bf16_f32 v14, v236, v237
  v_cvt_pk_bf16_f32 v15, v238, v239
  v_mul_f32 v232, s42, v136
  v_mul_f32 v233, s42, v137
  v_mul_f32 v234, s42, v138
  v_mul_f32 v235, s42, v139
  v_exp_f32 v232, v232
  v_exp_f32 v233, v233
  v_exp_f32 v234, v234
  v_exp_f32 v235, v235
  v_add_f32 v232, 1.0, v232
  v_add_f32 v233, 1.0, v233
  v_add_f32 v234, 1.0, v234
  v_add_f32 v235, 1.0, v235
  v_rcp_f32 v232, v232
  v_rcp_f32 v233, v233
  v_rcp_f32 v234, v234
  v_rcp_f32 v235, v235
  v_mul_f32 v232, v232, v164
  v_mul_f32 v233, v233, v165
  v_mul_f32 v234, v234, v166
  v_mul_f32 v235, v235, v167
  v_cvt_pk_bf16_f32 v124, v232, v233
  v_cvt_pk_bf16_f32 v125, v234, v235
  v_mul_f32 v236, s42, v192
  v_mul_f32 v237, s42, v193
  v_mul_f32 v238, s42, v194
  v_mul_f32 v239, s42, v195
  v_exp_f32 v236, v236
  v_exp_f32 v237, v237
  v_exp_f32 v238, v238
  v_exp_f32 v239, v239
  v_add_f32 v236, 1.0, v236
  v_add_f32 v237, 1.0, v237
  v_add_f32 v238, 1.0, v238
  v_add_f32 v239, 1.0, v239
  v_rcp_f32 v236, v236
  v_rcp_f32 v237, v237
  v_rcp_f32 v238, v238
  v_rcp_f32 v239, v239
  v_mul_f32 v236, v236, v220
  v_mul_f32 v237, v237, v221
  v_mul_f32 v238, v238, v222
  v_mul_f32 v239, v239, v223
  v_cvt_pk_bf16_f32 v126, v236, v237
  v_cvt_pk_bf16_f32 v127, v238, v239
  s_waitcnt vmcnt(4)
  v_cmp_ne_u32 vcc, s19, v247
  s_nop 1
  s_cmp_lg_u64 vcc, 0
  s_cbranch_scc1 L_slow_25
  L_back_26:
  s_add_u32 s94, s94, 65536
  buffer_load_dwordx4 a[0:3], v240, s[4:7], s16 offen offset:0 sc1
  buffer_load_dwordx4 a[4:7], v240, s[4:7], s16 offen offset:1024 sc1
  buffer_load_dwordx4 a[8:11], v241, s[4:7], s16 offen offset:0 sc1
  buffer_load_dwordx4 a[12:15], v241, s[4:7], s16 offen offset:1024 sc1
  s_add_u32 s16, s16, 262144
  buffer_load_dwordx4 a[16:19], v240, s[4:7], s16 offen offset:0 sc1
  buffer_load_dwordx4 a[20:23], v240, s[4:7], s16 offen offset:1024 sc1
  buffer_load_dwordx4 a[24:27], v241, s[4:7], s16 offen offset:0 sc1
  buffer_load_dwordx4 a[28:31], v241, s[4:7], s16 offen offset:1024 sc1
  s_add_u32 s16, s16, 262144
  buffer_load_dwordx4 a[32:35], v240, s[4:7], s16 offen offset:0 sc1
  buffer_load_dwordx4 a[36:39], v240, s[4:7], s16 offen offset:1024 sc1
  buffer_load_dwordx4 a[40:43], v241, s[4:7], s16 offen offset:0 sc1
  buffer_load_dwordx4 a[44:47], v241, s[4:7], s16 offen offset:1024 sc1
  s_add_u32 s16, s16, 262144
  s_waitcnt vmcnt(32)
  s_barrier
  ds_read_b64_tr_b16 a[80:81], v242 offset:2048
  ds_read_b64_tr_b16 a[82:83], v242 offset:6144
  ds_read_b64_tr_b16 a[84:85], v243 offset:2048
  ds_read_b64_tr_b16 a[86:87], v243 offset:6144
  ds_read_b64_tr_b16 a[88:89], v244 offset:2048
  ds_read_b64_tr_b16 a[90:91], v244 offset:6144
  ds_read_b64_tr_b16 a[92:93], v245 offset:2048
  ds_read_b64_tr_b16 a[94:95], v245 offset:6144
  ds_read_b64_tr_b16 a[112:113], v242 offset:10240
  ds_read_b64_tr_b16 a[114:115], v242 offset:14336
  ds_read_b64_tr_b16 a[116:117], v243 offset:10240
  ds_read_b64_tr_b16 a[118:119], v243 offset:14336
  ds_read_b64_tr_b16 a[120:121], v244 offset:10240
  ds_read_b64_tr_b16 a[122:123], v244 offset:14336
  ds_read_b64_tr_b16 a[124:125], v245 offset:10240
  ds_read_b64_tr_b16 a[126:127], v245 offset:14336
  ds_read_b64_tr_b16 a[64:65], v242 offset:0
  ds_read_b64_tr_b16 a[66:67], v242 offset:4096
  ds_read_b64_tr_b16 a[68:69], v243 offset:0
  ds_read_b64_tr_b16 a[70:71], v243 offset:4096
  ds_read_b64_tr_b16 a[72:73], v244 offset:0
  ds_read_b64_tr_b16 a[74:75], v244 offset:4096
  ds_read_b64_tr_b16 a[76:77], v245 offset:0
  ds_read_b64_tr_b16 a[78:79], v245 offset:4096
  ds_read_b64_tr_b16 a[96:97], v242 offset:8192
  ds_read_b64_tr_b16 a[98:99], v242 offset:12288
  ds_read_b64_tr_b16 a[100:101], v243 offset:8192
  ds_read_b64_tr_b16 a[102:103], v243 offset:12288
  ds_read_b64_tr_b16 a[104:105], v244 offset:8192
  ds_read_b64_tr_b16 a[106:107], v244 offset:12288
  ds_read_b64_tr_b16 a[108:109], v245 offset:8192
  ds_read_b64_tr_b16 a[110:111], v245 offset:12288
  s_waitcnt vmcnt(8) lgkmcnt(10)
  s_barrier
  s_mov_b64 exec, 1
  buffer_store_dword v248, v250, s[56:59], s92 offen sc1
  s_mov_b64 exec, -1
  s_add_u32 s92, s92, 65536
  v_mfma_f32_16x16x32_bf16 v[72:75], a[80:83], a[0:3], 0
  s_add_u32 m0, s38, 49152
  v_mfma_f32_16x16x32_bf16 v[88:91], a[80:83], a[4:7], 0
  ds_read_b64_tr_b16 a[80:81], v242 offset:18432
  ds_read_b64_tr_b16 a[82:83], v242 offset:22528
  v_mfma_f32_16x16x32_bf16 v[76:79], a[84:87], a[0:3], 0
  buffer_load_dwordx4 v225, s[8:11], s17 offen lds
  v_mfma_f32_16x16x32_bf16 v[92:95], a[84:87], a[4:7], 0
  ds_read_b64_tr_b16 a[84:85], v243 offset:18432
  ds_read_b64_tr_b16 a[86:87], v243 offset:22528
  v_mfma_f32_16x16x32_bf16 v[80:83], a[88:91], a[0:3], 0
  buffer_load_dwordx4 v226, s[8:11], s17 offen offset:1024 lds
  v_mfma_f32_16x16x32_bf16 v[96:99], a[88:91], a[4:7], 0
  ds_read_b64_tr_b16 a[88:89], v244 offset:18432
  ds_read_b64_tr_b16 a[90:91], v244 offset:22528
  v_mfma_f32_16x16x32_bf16 v[84:87], a[92:95], a[0:3], 0
  buffer_load_dwordx4 v227, s[8:11], s17 offen offset:2048 lds
  v_mfma_f32_16x16x32_bf16 v[100:103], a[92:95], a[4:7], 0
  ds_read_b64_tr_b16 a[92:93], v245 offset:18432
  ds_read_b64_tr_b16 a[94:95], v245 offset:22528
  v_mfma_f32_16x16x32_bf16 v[72:75], a[112:115], a[8:11], v[72:75]
  buffer_load_dwordx4 v228, s[8:11], s17 offen offset:3072 lds
  v_mfma_f32_16x16x32_bf16 v[88:91], a[112:115], a[12:15], v[88:91]
  ds_read_b64_tr_b16 a[112:113], v242 offset:26624
  ds_read_b64_tr_b16 a[114:115], v242 offset:30720
  v_mfma_f32_16x16x32_bf16 v[76:79], a[116:119], a[8:11], v[76:79]
  s_add_u32 s17, s17, 458752
  v_mfma_f32_16x16x32_bf16 v[92:95], a[116:119], a[12:15], v[92:95]
  ds_read_b64_tr_b16 a[116:117], v243 offset:26624
  ds_read_b64_tr_b16 a[118:119], v243 offset:30720
  v_mfma_f32_16x16x32_bf16 v[80:83], a[120:123], a[8:11], v[80:83]
  buffer_load_dword v251, v255, s[8:11], s96 offen
  v_mfma_f32_16x16x32_bf16 v[96:99], a[120:123], a[12:15], v[96:99]
  ds_read_b64_tr_b16 a[120:121], v244 offset:26624
  ds_read_b64_tr_b16 a[122:123], v244 offset:30720
  v_mfma_f32_16x16x32_bf16 v[84:87], a[124:127], a[8:11], v[84:87]
  s_add_u32 s96, s96, 458752
  v_mfma_f32_16x16x32_bf16 v[100:103], a[124:127], a[12:15], v[100:103]
  ds_read_b64_tr_b16 a[124:125], v245 offset:26624
  ds_read_b64_tr_b16 a[126:127], v245 offset:30720
  v_mfma_f32_16x16x32_bf16 v[16:19], a[64:67], a[0:3], 0
  buffer_load_dwordx4 a[48:51], v240, s[4:7], s16 offen offset:0 sc1
  v_mfma_f32_16x16x32_bf16 v[32:35], a[64:67], a[4:7], 0
  ds_read_b64_tr_b16 a[64:65], v242 offset:16384
  ds_read_b64_tr_b16 a[66:67], v242 offset:20480
  v_mfma_f32_16x16x32_bf16 v[20:23], a[68:71], a[0:3], 0
  buffer_load_dwordx4 a[52:55], v240, s[4:7], s16 offen offset:1024 sc1
  v_mfma_f32_16x16x32_bf16 v[36:39], a[68:71], a[4:7], 0
  ds_read_b64_tr_b16 a[68:69], v243 offset:16384
  ds_read_b64_tr_b16 a[70:71], v243 offset:20480
  v_mfma_f32_16x16x32_bf16 v[24:27], a[72:75], a[0:3], 0
  buffer_load_dwordx4 a[56:59], v241, s[4:7], s16 offen offset:0 sc1
  v_mfma_f32_16x16x32_bf16 v[40:43], a[72:75], a[4:7], 0
  ds_read_b64_tr_b16 a[72:73], v244 offset:16384
  ds_read_b64_tr_b16 a[74:75], v244 offset:20480
  s_waitcnt lgkmcnt(10)
  v_mfma_f32_16x16x32_bf16 v[28:31], a[76:79], a[0:3], 0
  buffer_load_dwordx4 a[60:63], v241, s[4:7], s16 offen offset:1024 sc1
  v_mfma_f32_16x16x32_bf16 v[44:47], a[76:79], a[4:7], 0
  ds_read_b64_tr_b16 a[76:77], v245 offset:16384
  ds_read_b64_tr_b16 a[78:79], v245 offset:20480
  v_mfma_f32_16x16x32_bf16 v[16:19], a[96:99], a[8:11], v[16:19]
  s_add_u32 s16, s16, 262144
  v_mfma_f32_16x16x32_bf16 v[32:35], a[96:99], a[12:15], v[32:35]
  ds_read_b64_tr_b16 a[96:97], v242 offset:24576
  ds_read_b64_tr_b16 a[98:99], v242 offset:28672
  v_mfma_f32_16x16x32_bf16 v[20:23], a[100:103], a[8:11], v[20:23]
  buffer_store_dwordx4 v[8:11], v224, s[12:15], s100 offen offset:0 sc1
  v_mfma_f32_16x16x32_bf16 v[36:39], a[100:103], a[12:15], v[36:39]
  ds_read_b64_tr_b16 a[100:101], v243 offset:24576
  ds_read_b64_tr_b16 a[102:103], v243 offset:28672
  v_mfma_f32_16x16x32_bf16 v[24:27], a[104:107], a[8:11], v[24:27]
  buffer_store_dwordx4 v[64:67], v224, s[12:15], s100 offen offset:1024 sc1
  v_mfma_f32_16x16x32_bf16 v[40:43], a[104:107], a[12:15], v[40:43]
  ds_read_b64_tr_b16 a[104:105], v244 offset:24576
  ds_read_b64_tr_b16 a[106:107], v244 offset:28672
  v_mfma_f32_16x16x32_bf16 v[28:31], a[108:111], a[8:11], v[28:31]
  v_mfma_f32_16x16x32_bf16 v[44:47], a[108:111], a[12:15], v[44:47]
  s_waitcnt vmcnt(16) lgkmcnt(10)
  s_barrier
  v_mfma_f32_16x16x32_bf16 v[72:75], a[80:83], a[16:19], v[72:75]
  ds_read_b64_tr_b16 a[108:109], v245 offset:24576
  s_add_u32 m0, s38, 0
  v_mfma_f32_16x16x32_bf16 v[88:91], a[80:83], a[20:23], v[88:91]
  ds_read_b64_tr_b16 a[110:111], v245 offset:28672
  ds_read_b64_tr_b16 a[80:81], v242 offset:34816
  v_mfma_f32_16x16x32_bf16 v[76:79], a[84:87], a[16:19], v[76:79]
  buffer_load_dwordx4 v225, s[8:11], s17 offen lds
  v_mfma_f32_16x16x32_bf16 v[92:95], a[84:87], a[20:23], v[92:95]
  ds_read_b64_tr_b16 a[82:83], v242 offset:38912
  ds_read_b64_tr_b16 a[84:85], v243 offset:34816
  v_mfma_f32_16x16x32_bf16 v[80:83], a[88:91], a[16:19], v[80:83]
  buffer_load_dwordx4 v226, s[8:11], s17 offen offset:1024 lds
  v_mfma_f32_16x16x32_bf16 v[96:99], a[88:91], a[20:23], v[96:99]
  ds_read_b64_tr_b16 a[86:87], v243 offset:38912
  ds_read_b64_tr_b16 a[88:89], v244 offset:34816
  v_mfma_f32_16x16x32_bf16 v[84:87], a[92:95], a[16:19], v[84:87]
  buffer_load_dwordx4 v227, s[8:11], s17 offen offset:2048 lds
  v_mfma_f32_16x16x32_bf16 v[100:103], a[92:95], a[20:23], v[100:103]
  ds_read_b64_tr_b16 a[90:91], v244 offset:38912
  ds_read_b64_tr_b16 a[92:93], v245 offset:34816
  v_mfma_f32_16x16x32_bf16 v[72:75], a[112:115], a[24:27], v[72:75]
  buffer_load_dwordx4 v228, s[8:11], s17 offen offset:3072 lds
  v_mfma_f32_16x16x32_bf16 v[88:91], a[112:115], a[28:31], v[88:91]
  ds_read_b64_tr_b16 a[94:95], v245 offset:38912
  ds_read_b64_tr_b16 a[112:113], v242 offset:43008
  v_mfma_f32_16x16x32_bf16 v[76:79], a[116:119], a[24:27], v[76:79]
  ds_read_b64_tr_b16 a[114:115], v242 offset:47104
  s_add_u32 s17, s17, 458752
  v_mfma_f32_16x16x32_bf16 v[92:95], a[116:119], a[28:31], v[92:95]
  ds_read_b64_tr_b16 a[116:117], v243 offset:43008
  ds_read_b64_tr_b16 a[118:119], v243 offset:47104
  v_mfma_f32_16x16x32_bf16 v[80:83], a[120:123], a[24:27], v[80:83]
  buffer_load_dword v251, v255, s[8:11], s96 offen
  v_mfma_f32_16x16x32_bf16 v[96:99], a[120:123], a[28:31], v[96:99]
  ds_read_b64_tr_b16 a[120:121], v244 offset:43008
  ds_read_b64_tr_b16 a[122:123], v244 offset:47104
  v_mfma_f32_16x16x32_bf16 v[84:87], a[124:127], a[24:27], v[84:87]
  s_sub_u32 s96, s96, 3145728
  v_mfma_f32_16x16x32_bf16 v[100:103], a[124:127], a[28:31], v[100:103]
  ds_read_b64_tr_b16 a[124:125], v245 offset:43008
  ds_read_b64_tr_b16 a[126:127], v245 offset:47104
  v_mfma_f32_16x16x32_bf16 v[16:19], a[64:67], a[16:19], v[16:19]
  buffer_load_dwordx4 a[0:3], v240, s[4:7], s16 offen offset:0 sc1
  v_mfma_f32_16x16x32_bf16 v[32:35], a[64:67], a[20:23], v[32:35]
  ds_read_b64_tr_b16 a[64:65], v242 offset:32768
  ds_read_b64_tr_b16 a[66:67], v242 offset:36864
  v_mfma_f32_16x16x32_bf16 v[20:23], a[68:71], a[16:19], v[20:23]
  buffer_load_dwordx4 a[4:7], v240, s[4:7], s16 offen offset:1024 sc1
  v_mfma_f32_16x16x32_bf16 v[36:39], a[68:71], a[20:23], v[36:39]
  ds_read_b64_tr_b16 a[68:69], v243 offset:32768
  ds_read_b64_tr_b16 a[70:71], v243 offset:36864
  s_waitcnt lgkmcnt(10)
  v_mfma_f32_16x16x32_bf16 v[24:27], a[72:75], a[16:19], v[24:27]
  buffer_load_dwordx4 a[8:11], v241, s[4:7], s16 offen offset:0 sc1
  v_mfma_f32_16x16x32_bf16 v[40:43], a[72:75], a[20:23], v[40:43]
  ds_read_b64_tr_b16 a[72:73], v244 offset:32768
  ds_read_b64_tr_b16 a[74:75], v244 offset:36864
  v_mfma_f32_16x16x32_bf16 v[28:31], a[76:79], a[16:19], v[28:31]
  buffer_load_dwordx4 a[12:15], v241, s[4:7], s16 offen offset:1024 sc1
  v_mfma_f32_16x16x32_bf16 v[44:47], a[76:79], a[20:23], v[44:47]
  ds_read_b64_tr_b16 a[76:77], v245 offset:32768
  ds_read_b64_tr_b16 a[78:79], v245 offset:36864
  v_mfma_f32_16x16x32_bf16 v[16:19], a[96:99], a[24:27], v[16:19]
  s_add_u32 s16, s16, 262144
  v_mfma_f32_16x16x32_bf16 v[32:35], a[96:99], a[28:31], v[32:35]
  ds_read_b64_tr_b16 a[96:97], v242 offset:40960
  ds_read_b64_tr_b16 a[98:99], v242 offset:45056
  v_mfma_f32_16x16x32_bf16 v[20:23], a[100:103], a[24:27], v[20:23]
  buffer_store_dwordx4 v[120:123], v224, s[12:15], s100 offen offset:2048 sc1
  v_mfma_f32_16x16x32_bf16 v[36:39], a[100:103], a[28:31], v[36:39]
  ds_read_b64_tr_b16 a[100:101], v243 offset:40960
  ds_read_b64_tr_b16 a[102:103], v243 offset:45056
  v_mfma_f32_16x16x32_bf16 v[24:27], a[104:107], a[24:27], v[24:27]
  buffer_store_dwordx4 v[176:179], v224, s[12:15], s100 offen offset:3072 sc1
  v_mfma_f32_16x16x32_bf16 v[40:43], a[104:107], a[28:31], v[40:43]
  ds_read_b64_tr_b16 a[104:105], v244 offset:40960
  ds_read_b64_tr_b16 a[106:107], v244 offset:45056
  v_mfma_f32_16x16x32_bf16 v[28:31], a[108:111], a[24:27], v[28:31]
  v_mfma_f32_16x16x32_bf16 v[44:47], a[108:111], a[28:31], v[44:47]
  s_waitcnt vmcnt(17) lgkmcnt(10)
  s_barrier
  v_mfma_f32_16x16x32_bf16 v[72:75], a[80:83], a[32:35], v[72:75]
  ds_read_b64_tr_b16 a[108:109], v245 offset:40960
  s_add_u32 m0, s38, 16384
  v_mfma_f32_16x16x32_bf16 v[88:91], a[80:83], a[36:39], v[88:91]
  ds_read_b64_tr_b16 a[110:111], v245 offset:45056
  ds_read_b64_tr_b16 a[80:81], v242 offset:51200
  v_mfma_f32_16x16x32_bf16 v[76:79], a[84:87], a[32:35], v[76:79]
  buffer_load_dwordx4 v225, s[8:11], s17 offen lds
  v_mfma_f32_16x16x32_bf16 v[92:95], a[84:87], a[36:39], v[92:95]
  ds_read_b64_tr_b16 a[82:83], v242 offset:55296
  ds_read_b64_tr_b16 a[84:85], v243 offset:51200
  v_mfma_f32_16x16x32_bf16 v[80:83], a[88:91], a[32:35], v[80:83]
  buffer_load_dwordx4 v226, s[8:11], s17 offen offset:1024 lds
  v_mfma_f32_16x16x32_bf16 v[96:99], a[88:91], a[36:39], v[96:99]
  ds_read_b64_tr_b16 a[86:87], v243 offset:55296
  ds_read_b64_tr_b16 a[88:89], v244 offset:51200
  v_mfma_f32_16x16x32_bf16 v[84:87], a[92:95], a[32:35], v[84:87]
  buffer_load_dwordx4 v227, s[8:11], s17 offen offset:2048 lds
  v_mfma_f32_16x16x32_bf16 v[100:103], a[92:95], a[36:39], v[100:103]
  ds_read_b64_tr_b16 a[90:91], v244 offset:55296
  ds_read_b64_tr_b16 a[92:93], v245 offset:51200
  v_mfma_f32_16x16x32_bf16 v[72:75], a[112:115], a[40:43], v[72:75]
  buffer_load_dwordx4 v228, s[8:11], s17 offen offset:3072 lds
  v_mfma_f32_16x16x32_bf16 v[88:91], a[112:115], a[44:47], v[88:91]
  ds_read_b64_tr_b16 a[94:95], v245 offset:55296
  ds_read_b64_tr_b16 a[112:113], v242 offset:59392
  v_mfma_f32_16x16x32_bf16 v[76:79], a[116:119], a[40:43], v[76:79]
  ds_read_b64_tr_b16 a[114:115], v242 offset:63488
  s_add_u32 s17, s17, 458752
  v_mfma_f32_16x16x32_bf16 v[92:95], a[116:119], a[44:47], v[92:95]
  ds_read_b64_tr_b16 a[116:117], v243 offset:59392
  ds_read_b64_tr_b16 a[118:119], v243 offset:63488
  v_mfma_f32_16x16x32_bf16 v[80:83], a[120:123], a[40:43], v[80:83]
  buffer_load_dword v251, v255, s[8:11], s96 offen
  v_mfma_f32_16x16x32_bf16 v[96:99], a[120:123], a[44:47], v[96:99]
  ds_read_b64_tr_b16 a[120:121], v244 offset:59392
  ds_read_b64_tr_b16 a[122:123], v244 offset:63488
  v_mfma_f32_16x16x32_bf16 v[84:87], a[124:127], a[40:43], v[84:87]
  s_add_u32 s96, s96, 458752
  v_mfma_f32_16x16x32_bf16 v[100:103], a[124:127], a[44:47], v[100:103]
  ds_read_b64_tr_b16 a[124:125], v245 offset:59392
  ds_read_b64_tr_b16 a[126:127], v245 offset:63488
  v_mfma_f32_16x16x32_bf16 v[16:19], a[64:67], a[32:35], v[16:19]
  buffer_load_dwordx4 a[16:19], v240, s[4:7], s16 offen offset:0 sc1
  v_mfma_f32_16x16x32_bf16 v[32:35], a[64:67], a[36:39], v[32:35]
  ds_read_b64_tr_b16 a[64:65], v242 offset:49152
  ds_read_b64_tr_b16 a[66:67], v242 offset:53248
  v_mfma_f32_16x16x32_bf16 v[20:23], a[68:71], a[32:35], v[20:23]
  buffer_load_dwordx4 a[20:23], v240, s[4:7], s16 offen offset:1024 sc1
  v_mfma_f32_16x16x32_bf16 v[36:39], a[68:71], a[36:39], v[36:39]
  ds_read_b64_tr_b16 a[68:69], v243 offset:49152
  ds_read_b64_tr_b16 a[70:71], v243 offset:53248
  s_waitcnt lgkmcnt(10)
  v_mfma_f32_16x16x32_bf16 v[24:27], a[72:75], a[32:35], v[24:27]
  buffer_load_dwordx4 a[24:27], v241, s[4:7], s16 offen offset:0 sc1
  v_mfma_f32_16x16x32_bf16 v[40:43], a[72:75], a[36:39], v[40:43]
  ds_read_b64_tr_b16 a[72:73], v244 offset:49152
  ds_read_b64_tr_b16 a[74:75], v244 offset:53248
  v_mfma_f32_16x16x32_bf16 v[28:31], a[76:79], a[32:35], v[28:31]
  buffer_load_dwordx4 a[28:31], v241, s[4:7], s16 offen offset:1024 sc1
  v_mfma_f32_16x16x32_bf16 v[44:47], a[76:79], a[36:39], v[44:47]
  ds_read_b64_tr_b16 a[76:77], v245 offset:49152
  ds_read_b64_tr_b16 a[78:79], v245 offset:53248
  v_mfma_f32_16x16x32_bf16 v[16:19], a[96:99], a[40:43], v[16:19]
  s_add_u32 s16, s16, 262144
  v_mfma_f32_16x16x32_bf16 v[32:35], a[96:99], a[44:47], v[32:35]
  ds_read_b64_tr_b16 a[96:97], v242 offset:57344
  ds_read_b64_tr_b16 a[98:99], v242 offset:61440
  v_mfma_f32_16x16x32_bf16 v[20:23], a[100:103], a[40:43], v[20:23]
  buffer_store_dwordx4 v[12:15], v224, s[12:15], s101 offen offset:0 sc1
  v_mfma_f32_16x16x32_bf16 v[36:39], a[100:103], a[44:47], v[36:39]
  ds_read_b64_tr_b16 a[100:101], v243 offset:57344
  ds_read_b64_tr_b16 a[102:103], v243 offset:61440
  v_mfma_f32_16x16x32_bf16 v[24:27], a[104:107], a[40:43], v[24:27]
  buffer_store_dwordx4 v[124:127], v224, s[12:15], s101 offen offset:2048 sc1
  v_mfma_f32_16x16x32_bf16 v[40:43], a[104:107], a[44:47], v[40:43]
  ds_read_b64_tr_b16 a[104:105], v244 offset:57344
  ds_read_b64_tr_b16 a[106:107], v244 offset:61440
  v_mfma_f32_16x16x32_bf16 v[28:31], a[108:111], a[40:43], v[28:31]
  v_mfma_f32_16x16x32_bf16 v[44:47], a[108:111], a[44:47], v[44:47]
  s_waitcnt vmcnt(17) lgkmcnt(10)
  s_barrier
  v_mfma_f32_16x16x32_bf16 v[72:75], a[80:83], a[48:51], v[72:75]
  ds_read_b64_tr_b16 a[108:109], v245 offset:57344
  s_add_u32 m0, s38, 32768
  v_mfma_f32_16x16x32_bf16 v[88:91], a[80:83], a[52:55], v[88:91]
  ds_read_b64_tr_b16 a[110:111], v245 offset:61440
  ds_read_b64_tr_b16 a[80:81], v242 offset:2048
  v_mfma_f32_16x16x32_bf16 v[76:79], a[84:87], a[48:51], v[76:79]
  buffer_load_dwordx4 v225, s[8:11], s17 offen lds
  v_mfma_f32_16x16x32_bf16 v[92:95], a[84:87], a[52:55], v[92:95]
  ds_read_b64_tr_b16 a[82:83], v242 offset:6144
  ds_read_b64_tr_b16 a[84:85], v243 offset:2048
  v_mfma_f32_16x16x32_bf16 v[80:83], a[88:91], a[48:51], v[80:83]
  buffer_load_dwordx4 v226, s[8:11], s17 offen offset:1024 lds
  v_mfma_f32_16x16x32_bf16 v[96:99], a[88:91], a[52:55], v[96:99]
  ds_read_b64_tr_b16 a[86:87], v243 offset:6144
  ds_read_b64_tr_b16 a[88:89], v244 offset:2048
  v_mfma_f32_16x16x32_bf16 v[84:87], a[92:95], a[48:51], v[84:87]
  ds_read_b64_tr_b16 a[90:91], v244 offset:6144
  v_mfma_f32_16x16x32_bf16 v[100:103], a[92:95], a[52:55], v[100:103]
  buffer_load_dwordx4 v227, s[8:11], s17 offen offset:2048 lds
  v_mfma_f32_16x16x32_bf16 v[72:75], a[112:115], a[56:59], v[72:75]
  ds_read_b64_tr_b16 a[92:93], v245 offset:2048
  ds_read_b64_tr_b16 a[94:95], v245 offset:6144
  v_mfma_f32_16x16x32_bf16 v[88:91], a[112:115], a[60:63], v[88:91]
  buffer_load_dwordx4 v228, s[8:11], s17 offen offset:3072 lds
  v_mfma_f32_16x16x32_bf16 v[76:79], a[116:119], a[56:59], v[76:79]
  ds_read_b64_tr_b16 a[112:113], v242 offset:10240
  ds_read_b64_tr_b16 a[114:115], v242 offset:14336
  v_mfma_f32_16x16x32_bf16 v[92:95], a[116:119], a[60:63], v[92:95]
  ds_read_b64_tr_b16 a[116:117], v243 offset:10240
  s_add_u32 s17, s17, 458752
  v_mfma_f32_16x16x32_bf16 v[80:83], a[120:123], a[56:59], v[80:83]
  ds_read_b64_tr_b16 a[118:119], v243 offset:14336
  v_mfma_f32_16x16x32_bf16 v[96:99], a[120:123], a[60:63], v[96:99]
  ds_read_b64_tr_b16 a[120:121], v244 offset:10240
  ds_read_b64_tr_b16 a[122:123], v244 offset:14336
  v_mfma_f32_16x16x32_bf16 v[84:87], a[124:127], a[56:59], v[84:87]
  buffer_load_dword v251, v255, s[8:11], s96 offen
  v_mfma_f32_16x16x32_bf16 v[100:103], a[124:127], a[60:63], v[100:103]
  buffer_load_dword v247, v246, s[56:59], s94 offen sc1
  v_mfma_f32_16x16x32_bf16 v[16:19], a[64:67], a[48:51], v[16:19]
  ds_read_b64_tr_b16 a[124:125], v245 offset:10240
  s_add_u32 s96, s96, 458752
  v_mfma_f32_16x16x32_bf16 v[32:35], a[64:67], a[52:55], v[32:35]
  ds_read_b64_tr_b16 a[126:127], v245 offset:14336
  ds_read_b64_tr_b16 a[64:65], v242 offset:0
  v_mfma_f32_16x16x32_bf16 v[20:23], a[68:71], a[48:51], v[20:23]
  ds_read_b64_tr_b16 a[66:67], v242 offset:4096
  v_mfma_f32_16x16x32_bf16 v[36:39], a[68:71], a[52:55], v[36:39]
  buffer_load_dwordx4 a[32:35], v240, s[4:7], s16 offen offset:0 sc1
  s_waitcnt lgkmcnt(10)
  v_mfma_f32_16x16x32_bf16 v[24:27], a[72:75], a[48:51], v[24:27]
  ds_read_b64_tr_b16 a[68:69], v243 offset:0
  ds_read_b64_tr_b16 a[70:71], v243 offset:4096
  v_mfma_f32_16x16x32_bf16 v[40:43], a[72:75], a[52:55], v[40:43]
  buffer_load_dwordx4 a[36:39], v240, s[4:7], s16 offen offset:1024 sc1
  v_mfma_f32_16x16x32_bf16 v[28:31], a[76:79], a[48:51], v[28:31]
  ds_read_b64_tr_b16 a[72:73], v244 offset:0
  ds_read_b64_tr_b16 a[74:75], v244 offset:4096
  v_mfma_f32_16x16x32_bf16 v[44:47], a[76:79], a[52:55], v[44:47]
  buffer_load_dwordx4 a[40:43], v241, s[4:7], s16 offen offset:0 sc1
  v_mfma_f32_16x16x32_bf16 v[16:19], a[96:99], a[56:59], v[16:19]
  ds_read_b64_tr_b16 a[76:77], v245 offset:0
  ds_read_b64_tr_b16 a[78:79], v245 offset:4096
  v_mfma_f32_16x16x32_bf16 v[32:35], a[96:99], a[60:63], v[32:35]
  ds_read_b64_tr_b16 a[96:97], v242 offset:8192
  ds_read_b64_tr_b16 a[98:99], v242 offset:12288
  v_mfma_f32_16x16x32_bf16 v[20:23], a[100:103], a[56:59], v[20:23]
  buffer_load_dwordx4 a[44:47], v241, s[4:7], s16 offen offset:1024 sc1
  v_mfma_f32_16x16x32_bf16 v[36:39], a[100:103], a[60:63], v[36:39]
  ds_read_b64_tr_b16 a[100:101], v243 offset:8192
  ds_read_b64_tr_b16 a[102:103], v243 offset:12288
  v_mfma_f32_16x16x32_bf16 v[24:27], a[104:107], a[56:59], v[24:27]
  s_add_u32 s16, s16, 262144
  v_mfma_f32_16x16x32_bf16 v[40:43], a[104:107], a[60:63], v[40:43]
  ds_read_b64_tr_b16 a[104:105], v244 offset:8192
  ds_read_b64_tr_b16 a[106:107], v244 offset:12288
  v_mfma_f32_16x16x32_bf16 v[28:31], a[108:111], a[56:59], v[28:31]
  v_mfma_f32_16x16x32_bf16 v[44:47], a[108:111], a[60:63], v[44:47]
  s_waitcnt vmcnt(16) lgkmcnt(10)
  s_barrier
  v_mfma_f32_16x16x32_bf16 v[72:75], a[80:83], a[0:3], v[72:75]
  ds_read_b64_tr_b16 a[108:109], v245 offset:8192
  s_add_u32 m0, s38, 49152
  v_mfma_f32_16x16x32_bf16 v[88:91], a[80:83], a[4:7], v[88:91]
  ds_read_b64_tr_b16 a[110:111], v245 offset:12288
  ds_read_b64_tr_b16 a[80:81], v242 offset:18432
  v_mfma_f32_16x16x32_bf16 v[76:79], a[84:87], a[0:3], v[76:79]
  buffer_load_dwordx4 v225, s[8:11], s17 offen lds
  v_mfma_f32_16x16x32_bf16 v[92:95], a[84:87], a[4:7], v[92:95]
  ds_read_b64_tr_b16 a[82:83], v242 offset:22528
  ds_read_b64_tr_b16 a[84:85], v243 offset:18432
  v_mfma_f32_16x16x32_bf16 v[80:83], a[88:91], a[0:3], v[80:83]
  buffer_load_dwordx4 v226, s[8:11], s17 offen offset:1024 lds
  v_mfma_f32_16x16x32_bf16 v[96:99], a[88:91], a[4:7], v[96:99]
  ds_read_b64_tr_b16 a[86:87], v243 offset:22528
  ds_read_b64_tr_b16 a[88:89], v244 offset:18432
  v_mfma_f32_16x16x32_bf16 v[84:87], a[92:95], a[0:3], v[84:87]
  ds_read_b64_tr_b16 a[90:91], v244 offset:22528
  v_mfma_f32_16x16x32_bf16 v[100:103], a[92:95], a[4:7], v[100:103]
  buffer_load_dwordx4 v227, s[8:11], s17 offen offset:2048 lds
  v_mfma_f32_16x16x32_bf16 v[72:75], a[112:115], a[8:11], v[72:75]
  ds_read_b64_tr_b16 a[92:93], v245 offset:18432
  ds_read_b64_tr_b16 a[94:95], v245 offset:22528
  v_mfma_f32_16x16x32_bf16 v[88:91], a[112:115], a[12:15], v[88:91]
  buffer_load_dwordx4 v228, s[8:11], s17 offen offset:3072 lds
  v_mfma_f32_16x16x32_bf16 v[76:79], a[116:119], a[8:11], v[76:79]
  ds_read_b64_tr_b16 a[112:113], v242 offset:26624
  ds_read_b64_tr_b16 a[114:115], v242 offset:30720
  v_mfma_f32_16x16x32_bf16 v[92:95], a[116:119], a[12:15], v[92:95]
  ds_read_b64_tr_b16 a[116:117], v243 offset:26624
  s_sub_u32 s17, s17, 3145728
  v_mfma_f32_16x16x32_bf16 v[80:83], a[120:123], a[8:11], v[80:83]
  ds_read_b64_tr_b16 a[118:119], v243 offset:30720
  v_mfma_f32_16x16x32_bf16 v[96:99], a[120:123], a[12:15], v[96:99]
  ds_read_b64_tr_b16 a[120:121], v244 offset:26624
  ds_read_b64_tr_b16 a[122:123], v244 offset:30720
  v_mfma_f32_16x16x32_bf16 v[84:87], a[124:127], a[8:11], v[84:87]
  buffer_load_dword v251, v255, s[8:11], s96 offen
  v_mfma_f32_16x16x32_bf16 v[100:103], a[124:127], a[12:15], v[100:103]
  ds_read_b64_tr_b16 a[124:125], v245 offset:26624
  ds_read_b64_tr_b16 a[126:127], v245 offset:30720
  v_mfma_f32_16x16x32_bf16 v[16:19], a[64:67], a[0:3], v[16:19]
  s_add_u32 s96, s96, 458752
  v_mfma_f32_16x16x32_bf16 v[32:35], a[64:67], a[4:7], v[32:35]
  ds_read_b64_tr_b16 a[64:65], v242 offset:16384
  ds_read_b64_tr_b16 a[66:67], v242 offset:20480
  v_mfma_f32_16x16x32_bf16 v[20:23], a[68:71], a[0:3], v[20:23]
  v_mfma_f32_16x16x32_bf16 v[36:39], a[68:71], a[4:7], v[36:39]
  buffer_load_dwordx4 a[48:51], v240, s[4:7], s16 offen offset:0 sc1
  s_waitcnt lgkmcnt(10)
  v_mfma_f32_16x16x32_bf16 v[24:27], a[72:75], a[0:3], v[24:27]
  ds_read_b64_tr_b16 a[68:69], v243 offset:16384
  ds_read_b64_tr_b16 a[70:71], v243 offset:20480
  v_mfma_f32_16x16x32_bf16 v[40:43], a[72:75], a[4:7], v[40:43]
  buffer_load_dwordx4 a[52:55], v240, s[4:7], s16 offen offset:1024 sc1
  v_mfma_f32_16x16x32_bf16 v[28:31], a[76:79], a[0:3], v[28:31]
  ds_read_b64_tr_b16 a[72:73], v244 offset:16384
  ds_read_b64_tr_b16 a[74:75], v244 offset:20480
  v_mfma_f32_16x16x32_bf16 v[44:47], a[76:79], a[4:7], v[44:47]
  buffer_load_dwordx4 a[56:59], v241, s[4:7], s16 offen offset:0 sc1
  v_mfma_f32_16x16x32_bf16 v[16:19], a[96:99], a[8:11], v[16:19]
  ds_read_b64_tr_b16 a[76:77], v245 offset:16384
  ds_read_b64_tr_b16 a[78:79], v245 offset:20480
  v_mfma_f32_16x16x32_bf16 v[32:35], a[96:99], a[12:15], v[32:35]
  ds_read_b64_tr_b16 a[96:97], v242 offset:24576
  ds_read_b64_tr_b16 a[98:99], v242 offset:28672
  v_mfma_f32_16x16x32_bf16 v[20:23], a[100:103], a[8:11], v[20:23]
  buffer_load_dwordx4 a[60:63], v241, s[4:7], s16 offen offset:1024 sc1
  v_mfma_f32_16x16x32_bf16 v[36:39], a[100:103], a[12:15], v[36:39]
  ds_read_b64_tr_b16 a[100:101], v243 offset:24576
  ds_read_b64_tr_b16 a[102:103], v243 offset:28672
  v_mfma_f32_16x16x32_bf16 v[24:27], a[104:107], a[8:11], v[24:27]
  s_add_u32 s16, s16, 262144
  v_mfma_f32_16x16x32_bf16 v[40:43], a[104:107], a[12:15], v[40:43]
  ds_read_b64_tr_b16 a[104:105], v244 offset:24576
  ds_read_b64_tr_b16 a[106:107], v244 offset:28672
  v_mfma_f32_16x16x32_bf16 v[28:31], a[108:111], a[8:11], v[28:31]
  v_mfma_f32_16x16x32_bf16 v[44:47], a[108:111], a[12:15], v[44:47]
  s_waitcnt vmcnt(13) lgkmcnt(10)
  s_barrier
  v_cmp_ne_u32 vcc, s19, v247
  s_nop 1
  s_cmp_lg_u64 vcc, 0
  s_cbranch_scc1 L_slow_27
  L_back_28:
  s_add_u32 s94, s94, 65536
  v_mfma_f32_16x16x32_bf16 v[72:75], a[80:83], a[16:19], v[72:75]
  ds_read_b64_tr_b16 a[108:109], v245 offset:24576
  s_add_u32 m0, s38, 0
  v_mfma_f32_16x16x32_bf16 v[88:91], a[80:83], a[20:23], v[88:91]
  ds_read_b64_tr_b16 a[110:111], v245 offset:28672
  ds_read_b64_tr_b16 a[80:81], v242 offset:34816
  v_mfma_f32_16x16x32_bf16 v[76:79], a[84:87], a[16:19], v[76:79]
  buffer_load_dwordx4 v225, s[8:11], s17 offen lds
  v_mfma_f32_16x16x32_bf16 v[92:95], a[84:87], a[20:23], v[92:95]
  ds_read_b64_tr_b16 a[82:83], v242 offset:38912
  ds_read_b64_tr_b16 a[84:85], v243 offset:34816
  v_mfma_f32_16x16x32_bf16 v[80:83], a[88:91], a[16:19], v[80:83]
  buffer_load_dwordx4 v226, s[8:11], s17 offen offset:1024 lds
  v_mfma_f32_16x16x32_bf16 v[96:99], a[88:91], a[20:23], v[96:99]
  ds_read_b64_tr_b16 a[86:87], v243 offset:38912
  ds_read_b64_tr_b16 a[88:89], v244 offset:34816
  v_mfma_f32_16x16x32_bf16 v[84:87], a[92:95], a[16:19], v[84:87]
  ds_read_b64_tr_b16 a[90:91], v244 offset:38912
  v_mfma_f32_16x16x32_bf16 v[100:103], a[92:95], a[20:23], v[100:103]
  buffer_load_dwordx4 v227, s[8:11], s17 offen offset:2048 lds
  v_mfma_f32_16x16x32_bf16 v[72:75], a[112:115], a[24:27], v[72:75]
  ds_read_b64_tr_b16 a[92:93], v245 offset:34816
  ds_read_b64_tr_b16 a[94:95], v245 offset:38912
  v_mfma_f32_16x16x32_bf16 v[88:91], a[112:115], a[28:31], v[88:91]
  buffer_load_dwordx4 v228, s[8:11], s17 offen offset:3072 lds
  v_mfma_f32_16x16x32_bf16 v[76:79], a[116:119], a[24:27], v[76:79]
  ds_read_b64_tr_b16 a[112:113], v242 offset:43008
  ds_read_b64_tr_b16 a[114:115], v242 offset:47104
  v_mfma_f32_16x16x32_bf16 v[92:95], a[116:119], a[28:31], v[92:95]
  ds_read_b64_tr_b16 a[116:117], v243 offset:43008
  s_add_u32 s17, s17, 458752
  v_mfma_f32_16x16x32_bf16 v[80:83], a[120:123], a[24:27], v[80:83]
  ds_read_b64_tr_b16 a[118:119], v243 offset:47104
  v_mfma_f32_16x16x32_bf16 v[96:99], a[120:123], a[28:31], v[96:99]
  ds_read_b64_tr_b16 a[120:121], v244 offset:43008
  ds_read_b64_tr_b16 a[122:123], v244 offset:47104
  v_mfma_f32_16x16x32_bf16 v[84:87], a[124:127], a[24:27], v[84:87]
  buffer_load_dword v251, v255, s[8:11], s96 offen
  v_mfma_f32_16x16x32_bf16 v[100:103], a[124:127], a[28:31], v[100:103]
  ds_read_b64_tr_b16 a[124:125], v245 offset:43008
  ds_read_b64_tr_b16 a[126:127], v245 offset:47104
  v_mfma_f32_16x16x32_bf16 v[16:19], a[64:67], a[16:19], v[16:19]
  s_add_u32 s96, s96, 458752
  v_mfma_f32_16x16x32_bf16 v[32:35], a[64:67], a[20:23], v[32:35]
  ds_read_b64_tr_b16 a[64:65], v242 offset:32768
  ds_read_b64_tr_b16 a[66:67], v242 offset:36864
  v_mfma_f32_16x16x32_bf16 v[20:23], a[68:71], a[16:19], v[20:23]
  v_mfma_f32_16x16x32_bf16 v[36:39], a[68:71], a[20:23], v[36:39]
  buffer_load_dwordx4 a[0:3], v240, s[4:7], s16 offen offset:0 sc1
  s_waitcnt lgkmcnt(10)
  v_mfma_f32_16x16x32_bf16 v[24:27], a[72:75], a[16:19], v[24:27]
  ds_read_b64_tr_b16 a[68:69], v243 offset:32768
  ds_read_b64_tr_b16 a[70:71], v243 offset:36864
  v_mfma_f32_16x16x32_bf16 v[40:43], a[72:75], a[20:23], v[40:43]
  buffer_load_dwordx4 a[4:7], v240, s[4:7], s16 offen offset:1024 sc1
  v_mfma_f32_16x16x32_bf16 v[28:31], a[76:79], a[16:19], v[28:31]
  ds_read_b64_tr_b16 a[72:73], v244 offset:32768
  ds_read_b64_tr_b16 a[74:75], v244 offset:36864
  v_mfma_f32_16x16x32_bf16 v[44:47], a[76:79], a[20:23], v[44:47]
  buffer_load_dwordx4 a[8:11], v241, s[4:7], s16 offen offset:0 sc1
  v_mfma_f32_16x16x32_bf16 v[16:19], a[96:99], a[24:27], v[16:19]
  ds_read_b64_tr_b16 a[76:77], v245 offset:32768
  ds_read_b64_tr_b16 a[78:79], v245 offset:36864
  v_mfma_f32_16x16x32_bf16 v[32:35], a[96:99], a[28:31], v[32:35]
  ds_read_b64_tr_b16 a[96:97], v242 offset:40960
  ds_read_b64_tr_b16 a[98:99], v242 offset:45056
  v_mfma_f32_16x16x32_bf16 v[20:23], a[100:103], a[24:27], v[20:23]
  buffer_load_dwordx4 a[12:15], v241, s[4:7], s16 offen offset:1024 sc1
  v_mfma_f32_16x16x32_bf16 v[36:39], a[100:103], a[28:31], v[36:39]
  ds_read_b64_tr_b16 a[100:101], v243 offset:40960
  ds_read_b64_tr_b16 a[102:103], v243 offset:45056
  v_mfma_f32_16x16x32_bf16 v[24:27], a[104:107], a[24:27], v[24:27]
  s_add_u32 s16, s16, 262144
  v_mfma_f32_16x16x32_bf16 v[40:43], a[104:107], a[28:31], v[40:43]
  ds_read_b64_tr_b16 a[104:105], v244 offset:40960
  ds_read_b64_tr_b16 a[106:107], v244 offset:45056
  v_mfma_f32_16x16x32_bf16 v[28:31], a[108:111], a[24:27], v[28:31]
  v_mfma_f32_16x16x32_bf16 v[44:47], a[108:111], a[28:31], v[44:47]
  s_waitcnt vmcnt(13) lgkmcnt(10)
  s_barrier
  s_mov_b64 exec, 1
  buffer_store_dword v248, v250, s[56:59], s92 offen sc1
  s_mov_b64 exec, -1
  s_add_u32 s92, s92, 65536
  v_mfma_f32_16x16x32_bf16 v[72:75], a[80:83], a[32:35], v[72:75]
  ds_read_b64_tr_b16 a[108:109], v245 offset:40960
  s_add_u32 m0, s38, 16384
  v_mfma_f32_16x16x32_bf16 v[88:91], a[80:83], a[36:39], v[88:91]
  ds_read_b64_tr_b16 a[110:111], v245 offset:45056
  ds_read_b64_tr_b16 a[80:81], v242 offset:51200
  v_mfma_f32_16x16x32_bf16 v[76:79], a[84:87], a[32:35], v[76:79]
  buffer_load_dwordx4 v225, s[8:11], s17 offen lds
  v_mfma_f32_16x16x32_bf16 v[92:95], a[84:87], a[36:39], v[92:95]
  ds_read_b64_tr_b16 a[82:83], v242 offset:55296
  ds_read_b64_tr_b16 a[84:85], v243 offset:51200
  v_mfma_f32_16x16x32_bf16 v[80:83], a[88:91], a[32:35], v[80:83]
  buffer_load_dwordx4 v226, s[8:11], s17 offen offset:1024 lds
  v_mfma_f32_16x16x32_bf16 v[96:99], a[88:91], a[36:39], v[96:99]
  ds_read_b64_tr_b16 a[86:87], v243 offset:55296
  ds_read_b64_tr_b16 a[88:89], v244 offset:51200
  v_mfma_f32_16x16x32_bf16 v[84:87], a[92:95], a[32:35], v[84:87]
  ds_read_b64_tr_b16 a[90:91], v244 offset:55296
  v_mfma_f32_16x16x32_bf16 v[100:103], a[92:95], a[36:39], v[100:103]
  buffer_load_dwordx4 v227, s[8:11], s17 offen offset:2048 lds
  v_mfma_f32_16x16x32_bf16 v[72:75], a[112:115], a[40:43], v[72:75]
  ds_read_b64_tr_b16 a[92:93], v245 offset:51200
  ds_read_b64_tr_b16 a[94:95], v245 offset:55296
  v_mfma_f32_16x16x32_bf16 v[88:91], a[112:115], a[44:47], v[88:91]
  buffer_load_dwordx4 v228, s[8:11], s17 offen offset:3072 lds
  v_mfma_f32_16x16x32_bf16 v[76:79], a[116:119], a[40:43], v[76:79]
  ds_read_b64_tr_b16 a[112:113], v242 offset:59392
  ds_read_b64_tr_b16 a[114:115], v242 offset:63488
  v_mfma_f32_16x16x32_bf16 v[92:95], a[116:119], a[44:47], v[92:95]
  ds_read_b64_tr_b16 a[116:117], v243 offset:59392
  s_add_u32 s17, s17, 458752
  v_mfma_f32_16x16x32_bf16 v[80:83], a[120:123], a[40:43], v[80:83]
  ds_read_b64_tr_b16 a[118:119], v243 offset:63488
  v_mfma_f32_16x16x32_bf16 v[96:99], a[120:123], a[44:47], v[96:99]
  ds_read_b64_tr_b16 a[120:121], v244 offset:59392
  ds_read_b64_tr_b16 a[122:123], v244 offset:63488
  v_mfma_f32_16x16x32_bf16 v[84:87], a[124:127], a[40:43], v[84:87]
  buffer_load_dword v251, v255, s[8:11], s96 offen
  v_mfma_f32_16x16x32_bf16 v[100:103], a[124:127], a[44:47], v[100:103]
  ds_read_b64_tr_b16 a[124:125], v245 offset:59392
  ds_read_b64_tr_b16 a[126:127], v245 offset:63488
  v_mfma_f32_16x16x32_bf16 v[16:19], a[64:67], a[32:35], v[16:19]
  s_add_u32 s96, s96, 458752
  v_mfma_f32_16x16x32_bf16 v[32:35], a[64:67], a[36:39], v[32:35]
  ds_read_b64_tr_b16 a[64:65], v242 offset:49152
  ds_read_b64_tr_b16 a[66:67], v242 offset:53248
  v_mfma_f32_16x16x32_bf16 v[20:23], a[68:71], a[32:35], v[20:23]
  v_mfma_f32_16x16x32_bf16 v[36:39], a[68:71], a[36:39], v[36:39]
  buffer_load_dwordx4 a[16:19], v240, s[4:7], s16 offen offset:0 sc1
  s_waitcnt lgkmcnt(10)
  v_mfma_f32_16x16x32_bf16 v[24:27], a[72:75], a[32:35], v[24:27]
  ds_read_b64_tr_b16 a[68:69], v243 offset:49152
  ds_read_b64_tr_b16 a[70:71], v243 offset:53248
  v_mfma_f32_16x16x32_bf16 v[40:43], a[72:75], a[36:39], v[40:43]
  buffer_load_dwordx4 a[20:23], v240, s[4:7], s16 offen offset:1024 sc1
  v_mfma_f32_16x16x32_bf16 v[28:31], a[76:79], a[32:35], v[28:31]
  ds_read_b64_tr_b16 a[72:73], v244 offset:49152
  ds_read_b64_tr_b16 a[74:75], v244 offset:53248
  v_mfma_f32_16x16x32_bf16 v[44:47], a[76:79], a[36:39], v[44:47]
  buffer_load_dwordx4 a[24:27], v241, s[4:7], s16 offen offset:0 sc1
  v_mfma_f32_16x16x32_bf16 v[16:19], a[96:99], a[40:43], v[16:19]
  ds_read_b64_tr_b16 a[76:77], v245 offset:49152
  ds_read_b64_tr_b16 a[78:79], v245 offset:53248
  v_mfma_f32_16x16x32_bf16 v[32:35], a[96:99], a[44:47], v[32:35]
  ds_read_b64_tr_b16 a[96:97], v242 offset:57344
  ds_read_b64_tr_b16 a[98:99], v242 offset:61440
  v_mfma_f32_16x16x32_bf16 v[20:23], a[100:103], a[40:43], v[20:23]
  buffer_load_dwordx4 a[28:31], v241, s[4:7], s16 offen offset:1024 sc1
  v_mfma_f32_16x16x32_bf16 v[36:39], a[100:103], a[44:47], v[36:39]
  ds_read_b64_tr_b16 a[100:101], v243 offset:57344
  ds_read_b64_tr_b16 a[102:103], v243 offset:61440
  v_mfma_f32_16x16x32_bf16 v[24:27], a[104:107], a[40:43], v[24:27]
  s_add_u32 s16, s16, 262144
  v_mfma_f32_16x16x32_bf16 v[40:43], a[104:107], a[44:47], v[40:43]
  ds_read_b64_tr_b16 a[104:105], v244 offset:57344
  ds_read_b64_tr_b16 a[106:107], v244 offset:61440
  v_mfma_f32_16x16x32_bf16 v[28:31], a[108:111], a[40:43], v[28:31]
  v_mfma_f32_16x16x32_bf16 v[44:47], a[108:111], a[44:47], v[44:47]
  s_waitcnt vmcnt(14) lgkmcnt(10)
  s_barrier
  v_mfma_f32_16x16x32_bf16 v[72:75], a[80:83], a[48:51], v[72:75]
  ds_read_b64_tr_b16 a[108:109], v245 offset:57344
  s_add_u32 m0, s38, 32768
  v_mfma_f32_16x16x32_bf16 v[88:91], a[80:83], a[52:55], v[88:91]
  ds_read_b64_tr_b16 a[110:111], v245 offset:61440
  ds_read_b64_tr_b16 a[80:81], v242 offset:2048
  v_mfma_f32_16x16x32_bf16 v[76:79], a[84:87], a[48:51], v[76:79]
  buffer_load_dwordx4 v225, s[8:11], s17 offen lds
  v_mfma_f32_16x16x32_bf16 v[92:95], a[84:87], a[52:55], v[92:95]
  ds_read_b64_tr_b16 a[82:83], v242 offset:6144
  ds_read_b64_tr_b16 a[84:85], v243 offset:2048
  v_mfma_f32_16x16x32_bf16 v[80:83], a[88:91], a[48:51], v[80:83]
  buffer_load_dwordx4 v226, s[8:11], s17 offen offset:1024 lds
  v_mfma_f32_16x16x32_bf16 v[96:99], a[88:91], a[52:55], v[96:99]
  ds_read_b64_tr_b16 a[86:87], v243 offset:6144
  ds_read_b64_tr_b16 a[88:89], v244 offset:2048
  v_mfma_f32_16x16x32_bf16 v[84:87], a[92:95], a[48:51], v[84:87]
  ds_read_b64_tr_b16 a[90:91], v244 offset:6144
  v_mfma_f32_16x16x32_bf16 v[100:103], a[92:95], a[52:55], v[100:103]
  buffer_load_dwordx4 v227, s[8:11], s17 offen offset:2048 lds
  v_mfma_f32_16x16x32_bf16 v[72:75], a[112:115], a[56:59], v[72:75]
  ds_read_b64_tr_b16 a[92:93], v245 offset:2048
  ds_read_b64_tr_b16 a[94:95], v245 offset:6144
  v_mfma_f32_16x16x32_bf16 v[88:91], a[112:115], a[60:63], v[88:91]
  buffer_load_dwordx4 v228, s[8:11], s17 offen offset:3072 lds
  v_mfma_f32_16x16x32_bf16 v[76:79], a[116:119], a[56:59], v[76:79]
  ds_read_b64_tr_b16 a[112:113], v242 offset:10240
  ds_read_b64_tr_b16 a[114:115], v242 offset:14336
  v_mfma_f32_16x16x32_bf16 v[92:95], a[116:119], a[60:63], v[92:95]
  ds_read_b64_tr_b16 a[116:117], v243 offset:10240
  s_add_u32 s17, s17, 458752
  v_mfma_f32_16x16x32_bf16 v[80:83], a[120:123], a[56:59], v[80:83]
  ds_read_b64_tr_b16 a[118:119], v243 offset:14336
  v_mfma_f32_16x16x32_bf16 v[96:99], a[120:123], a[60:63], v[96:99]
  ds_read_b64_tr_b16 a[120:121], v244 offset:10240
  ds_read_b64_tr_b16 a[122:123], v244 offset:14336
  v_mfma_f32_16x16x32_bf16 v[84:87], a[124:127], a[56:59], v[84:87]
  buffer_load_dword v251, v255, s[8:11], s96 offen
  v_mfma_f32_16x16x32_bf16 v[100:103], a[124:127], a[60:63], v[100:103]
  ds_read_b64_tr_b16 a[124:125], v245 offset:10240
  ds_read_b64_tr_b16 a[126:127], v245 offset:14336
  v_mfma_f32_16x16x32_bf16 v[16:19], a[64:67], a[48:51], v[16:19]
  s_add_u32 s96, s96, 458752
  v_mfma_f32_16x16x32_bf16 v[32:35], a[64:67], a[52:55], v[32:35]
  ds_read_b64_tr_b16 a[64:65], v242 offset:0
  ds_read_b64_tr_b16 a[66:67], v242 offset:4096
  v_mfma_f32_16x16x32_bf16 v[20:23], a[68:71], a[48:51], v[20:23]
  v_mfma_f32_16x16x32_bf16 v[36:39], a[68:71], a[52:55], v[36:39]
  buffer_load_dwordx4 a[32:35], v240, s[4:7], s16 offen offset:0 sc1
  s_waitcnt lgkmcnt(10)
  v_mfma_f32_16x16x32_bf16 v[24:27], a[72:75], a[48:51], v[24:27]
  ds_read_b64_tr_b16 a[68:69], v243 offset:0
  ds_read_b64_tr_b16 a[70:71], v243 offset:4096
  v_mfma_f32_16x16x32_bf16 v[40:43], a[72:75], a[52:55], v[40:43]
  buffer_load_dwordx4 a[36:39], v240, s[4:7], s16 offen offset:1024 sc1
  v_mfma_f32_16x16x32_bf16 v[28:31], a[76:79], a[48:51], v[28:31]
  ds_read_b64_tr_b16 a[72:73], v244 offset:0
  ds_read_b64_tr_b16 a[74:75], v244 offset:4096
  v_mfma_f32_16x16x32_bf16 v[44:47], a[76:79], a[52:55], v[44:47]
  buffer_load_dwordx4 a[40:43], v241, s[4:7], s16 offen offset:0 sc1
  v_mfma_f32_16x16x32_bf16 v[16:19], a[96:99], a[56:59], v[16:19]
  ds_read_b64_tr_b16 a[76:77], v245 offset:0
  ds_read_b64_tr_b16 a[78:79], v245 offset:4096
  v_mfma_f32_16x16x32_bf16 v[32:35], a[96:99], a[60:63], v[32:35]
  ds_read_b64_tr_b16 a[96:97], v242 offset:8192
  ds_read_b64_tr_b16 a[98:99], v242 offset:12288
  v_mfma_f32_16x16x32_bf16 v[20:23], a[100:103], a[56:59], v[20:23]
  buffer_load_dwordx4 a[44:47], v241, s[4:7], s16 offen offset:1024 sc1
  v_mfma_f32_16x16x32_bf16 v[36:39], a[100:103], a[60:63], v[36:39]
  ds_read_b64_tr_b16 a[100:101], v243 offset:8192
  ds_read_b64_tr_b16 a[102:103], v243 offset:12288
  v_mfma_f32_16x16x32_bf16 v[24:27], a[104:107], a[56:59], v[24:27]
  s_add_u32 s16, s16, 262144
  v_mfma_f32_16x16x32_bf16 v[40:43], a[104:107], a[60:63], v[40:43]
  ds_read_b64_tr_b16 a[104:105], v244 offset:8192
  ds_read_b64_tr_b16 a[106:107], v244 offset:12288
  v_mfma_f32_16x16x32_bf16 v[28:31], a[108:111], a[56:59], v[28:31]
  v_mfma_f32_16x16x32_bf16 v[44:47], a[108:111], a[60:63], v[44:47]
  s_waitcnt vmcnt(13) lgkmcnt(10)
  s_barrier
  v_mfma_f32_16x16x32_bf16 v[72:75], a[80:83], a[0:3], v[72:75]
  ds_read_b64_tr_b16 a[108:109], v245 offset:8192
  s_add_u32 m0, s38, 49152
  v_mfma_f32_16x16x32_bf16 v[88:91], a[80:83], a[4:7], v[88:91]
  ds_read_b64_tr_b16 a[110:111], v245 offset:12288
  ds_read_b64_tr_b16 a[80:81], v242 offset:18432
  v_mfma_f32_16x16x32_bf16 v[76:79], a[84:87], a[0:3], v[76:79]
  buffer_load_dwordx4 v225, s[8:11], s17 offen lds
  v_mfma_f32_16x16x32_bf16 v[92:95], a[84:87], a[4:7], v[92:95]
  ds_read_b64_tr_b16 a[82:83], v242 offset:22528
  ds_read_b64_tr_b16 a[84:85], v243 offset:18432
  v_mfma_f32_16x16x32_bf16 v[80:83], a[88:91], a[0:3], v[80:83]
  buffer_load_dwordx4 v226, s[8:11], s17 offen offset:1024 lds
  v_mfma_f32_16x16x32_bf16 v[96:99], a[88:91], a[4:7], v[96:99]
  ds_read_b64_tr_b16 a[86:87], v243 offset:22528
  ds_read_b64_tr_b16 a[88:89], v244 offset:18432
  v_mfma_f32_16x16x32_bf16 v[84:87], a[92:95], a[0:3], v[84:87]
  ds_read_b64_tr_b16 a[90:91], v244 offset:22528
  v_mfma_f32_16x16x32_bf16 v[100:103], a[92:95], a[4:7], v[100:103]
  buffer_load_dwordx4 v227, s[8:11], s17 offen offset:2048 lds
  v_mfma_f32_16x16x32_bf16 v[72:75], a[112:115], a[8:11], v[72:75]
  ds_read_b64_tr_b16 a[92:93], v245 offset:18432
  ds_read_b64_tr_b16 a[94:95], v245 offset:22528
  v_mfma_f32_16x16x32_bf16 v[88:91], a[112:115], a[12:15], v[88:91]
  buffer_load_dwordx4 v228, s[8:11], s17 offen offset:3072 lds
  v_mfma_f32_16x16x32_bf16 v[76:79], a[116:119], a[8:11], v[76:79]
  ds_read_b64_tr_b16 a[112:113], v242 offset:26624
  ds_read_b64_tr_b16 a[114:115], v242 offset:30720
  v_mfma_f32_16x16x32_bf16 v[92:95], a[116:119], a[12:15], v[92:95]
  ds_read_b64_tr_b16 a[116:117], v243 offset:26624
  s_add_u32 s17, s17, 458752
  v_mfma_f32_16x16x32_bf16 v[80:83], a[120:123], a[8:11], v[80:83]
  ds_read_b64_tr_b16 a[118:119], v243 offset:30720
  v_mfma_f32_16x16x32_bf16 v[96:99], a[120:123], a[12:15], v[96:99]
  ds_read_b64_tr_b16 a[120:121], v244 offset:26624
  ds_read_b64_tr_b16 a[122:123], v244 offset:30720
  v_mfma_f32_16x16x32_bf16 v[84:87], a[124:127], a[8:11], v[84:87]
  buffer_load_dword v251, v255, s[8:11], s96 offen
  v_mfma_f32_16x16x32_bf16 v[100:103], a[124:127], a[12:15], v[100:103]
  ds_read_b64_tr_b16 a[124:125], v245 offset:26624
  ds_read_b64_tr_b16 a[126:127], v245 offset:30720
  v_mfma_f32_16x16x32_bf16 v[16:19], a[64:67], a[0:3], v[16:19]
  s_add_u32 s96, s96, 458752
  v_mfma_f32_16x16x32_bf16 v[32:35], a[64:67], a[4:7], v[32:35]
  ds_read_b64_tr_b16 a[64:65], v242 offset:16384
  ds_read_b64_tr_b16 a[66:67], v242 offset:20480
  v_mfma_f32_16x16x32_bf16 v[20:23], a[68:71], a[0:3], v[20:23]
  v_mfma_f32_16x16x32_bf16 v[36:39], a[68:71], a[4:7], v[36:39]
  buffer_load_dwordx4 a[48:51], v240, s[4:7], s16 offen offset:0 sc1
  s_waitcnt lgkmcnt(10)
  v_mfma_f32_16x16x32_bf16 v[24:27], a[72:75], a[0:3], v[24:27]
  ds_read_b64_tr_b16 a[68:69], v243 offset:16384
  ds_read_b64_tr_b16 a[70:71], v243 offset:20480
  v_mfma_f32_16x16x32_bf16 v[40:43], a[72:75], a[4:7], v[40:43]
  buffer_load_dwordx4 a[52:55], v240, s[4:7], s16 offen offset:1024 sc1
  v_mfma_f32_16x16x32_bf16 v[28:31], a[76:79], a[0:3], v[28:31]
  ds_read_b64_tr_b16 a[72:73], v244 offset:16384
  ds_read_b64_tr_b16 a[74:75], v244 offset:20480
  v_mfma_f32_16x16x32_bf16 v[44:47], a[76:79], a[4:7], v[44:47]
  buffer_load_dwordx4 a[56:59], v241, s[4:7], s16 offen offset:0 sc1
  v_mfma_f32_16x16x32_bf16 v[16:19], a[96:99], a[8:11], v[16:19]
  ds_read_b64_tr_b16 a[76:77], v245 offset:16384
  ds_read_b64_tr_b16 a[78:79], v245 offset:20480
  v_mfma_f32_16x16x32_bf16 v[32:35], a[96:99], a[12:15], v[32:35]
  ds_read_b64_tr_b16 a[96:97], v242 offset:24576
  ds_read_b64_tr_b16 a[98:99], v242 offset:28672
  v_mfma_f32_16x16x32_bf16 v[20:23], a[100:103], a[8:11], v[20:23]
  buffer_load_dwordx4 a[60:63], v241, s[4:7], s16 offen offset:1024 sc1
  v_mfma_f32_16x16x32_bf16 v[36:39], a[100:103], a[12:15], v[36:39]
  ds_read_b64_tr_b16 a[100:101], v243 offset:24576
  ds_read_b64_tr_b16 a[102:103], v243 offset:28672
  v_mfma_f32_16x16x32_bf16 v[24:27], a[104:107], a[8:11], v[24:27]
  s_add_u32 s16, s16, 262144
  v_mfma_f32_16x16x32_bf16 v[40:43], a[104:107], a[12:15], v[40:43]
  ds_read_b64_tr_b16 a[104:105], v244 offset:24576
  ds_read_b64_tr_b16 a[106:107], v244 offset:28672
  v_mfma_f32_16x16x32_bf16 v[28:31], a[108:111], a[8:11], v[28:31]
  v_mfma_f32_16x16x32_bf16 v[44:47], a[108:111], a[12:15], v[44:47]
  s_waitcnt vmcnt(13) lgkmcnt(10)
  s_barrier
  v_mfma_f32_16x16x32_bf16 v[72:75], a[80:83], a[16:19], v[72:75]
  ds_read_b64_tr_b16 a[108:109], v245 offset:24576
  s_add_u32 m0, s38, 0
  v_mfma_f32_16x16x32_bf16 v[88:91], a[80:83], a[20:23], v[88:91]
  ds_read_b64_tr_b16 a[110:111], v245 offset:28672
  ds_read_b64_tr_b16 a[80:81], v242 offset:34816
  v_mfma_f32_16x16x32_bf16 v[76:79], a[84:87], a[16:19], v[76:79]
  buffer_load_dwordx4 v225, s[8:11], s17 offen lds
  v_mfma_f32_16x16x32_bf16 v[92:95], a[84:87], a[20:23], v[92:95]
  ds_read_b64_tr_b16 a[82:83], v242 offset:38912
  ds_read_b64_tr_b16 a[84:85], v243 offset:34816
  v_mfma_f32_16x16x32_bf16 v[80:83], a[88:91], a[16:19], v[80:83]
  buffer_load_dwordx4 v226, s[8:11], s17 offen offset:1024 lds
  v_mfma_f32_16x16x32_bf16 v[96:99], a[88:91], a[20:23], v[96:99]
  ds_read_b64_tr_b16 a[86:87], v243 offset:38912
  ds_read_b64_tr_b16 a[88:89], v244 offset:34816
  v_mfma_f32_16x16x32_bf16 v[84:87], a[92:95], a[16:19], v[84:87]
  ds_read_b64_tr_b16 a[90:91], v244 offset:38912
  v_mfma_f32_16x16x32_bf16 v[100:103], a[92:95], a[20:23], v[100:103]
  buffer_load_dwordx4 v227, s[8:11], s17 offen offset:2048 lds
  v_mfma_f32_16x16x32_bf16 v[72:75], a[112:115], a[24:27], v[72:75]
  ds_read_b64_tr_b16 a[92:93], v245 offset:34816
  ds_read_b64_tr_b16 a[94:95], v245 offset:38912
  v_mfma_f32_16x16x32_bf16 v[88:91], a[112:115], a[28:31], v[88:91]
  buffer_load_dwordx4 v228, s[8:11], s17 offen offset:3072 lds
  v_mfma_f32_16x16x32_bf16 v[76:79], a[116:119], a[24:27], v[76:79]
  ds_read_b64_tr_b16 a[112:113], v242 offset:43008
  ds_read_b64_tr_b16 a[114:115], v242 offset:47104
  v_mfma_f32_16x16x32_bf16 v[92:95], a[116:119], a[28:31], v[92:95]
  ds_read_b64_tr_b16 a[116:117], v243 offset:43008
  s_add_u32 s17, s17, 458752
  v_mfma_f32_16x16x32_bf16 v[80:83], a[120:123], a[24:27], v[80:83]
  ds_read_b64_tr_b16 a[118:119], v243 offset:47104
  v_mfma_f32_16x16x32_bf16 v[96:99], a[120:123], a[28:31], v[96:99]
  ds_read_b64_tr_b16 a[120:121], v244 offset:43008
  ds_read_b64_tr_b16 a[122:123], v244 offset:47104
  v_mfma_f32_16x16x32_bf16 v[84:87], a[124:127], a[24:27], v[84:87]
  buffer_load_dword v251, v255, s[8:11], s96 offen
  v_mfma_f32_16x16x32_bf16 v[100:103], a[124:127], a[28:31], v[100:103]
  ds_read_b64_tr_b16 a[124:125], v245 offset:43008
  ds_read_b64_tr_b16 a[126:127], v245 offset:47104
  v_mfma_f32_16x16x32_bf16 v[16:19], a[64:67], a[16:19], v[16:19]
  s_sub_u32 s96, s96, 3145728
  v_mfma_f32_16x16x32_bf16 v[32:35], a[64:67], a[20:23], v[32:35]
  ds_read_b64_tr_b16 a[64:65], v242 offset:32768
  ds_read_b64_tr_b16 a[66:67], v242 offset:36864
  v_mfma_f32_16x16x32_bf16 v[20:23], a[68:71], a[16:19], v[20:23]
  v_mfma_f32_16x16x32_bf16 v[36:39], a[68:71], a[20:23], v[36:39]
  buffer_load_dwordx4 a[0:3], v240, s[4:7], s16 offen offset:0 sc1
  s_waitcnt lgkmcnt(10)
  v_mfma_f32_16x16x32_bf16 v[24:27], a[72:75], a[16:19], v[24:27]
  ds_read_b64_tr_b16 a[68:69], v243 offset:32768
  ds_read_b64_tr_b16 a[70:71], v243 offset:36864
  v_mfma_f32_16x16x32_bf16 v[40:43], a[72:75], a[20:23], v[40:43]
  buffer_load_dwordx4 a[4:7], v240, s[4:7], s16 offen offset:1024 sc1
  v_mfma_f32_16x16x32_bf16 v[28:31], a[76:79], a[16:19], v[28:31]
  ds_read_b64_tr_b16 a[72:73], v244 offset:32768
  ds_read_b64_tr_b16 a[74:75], v244 offset:36864
  v_mfma_f32_16x16x32_bf16 v[44:47], a[76:79], a[20:23], v[44:47]
  buffer_load_dwordx4 a[8:11], v241, s[4:7], s16 offen offset:0 sc1
  v_mfma_f32_16x16x32_bf16 v[16:19], a[96:99], a[24:27], v[16:19]
  ds_read_b64_tr_b16 a[76:77], v245 offset:32768
  ds_read_b64_tr_b16 a[78:79], v245 offset:36864
  v_mfma_f32_16x16x32_bf16 v[32:35], a[96:99], a[28:31], v[32:35]
  ds_read_b64_tr_b16 a[96:97], v242 offset:40960
  ds_read_b64_tr_b16 a[98:99], v242 offset:45056
  v_mfma_f32_16x16x32_bf16 v[20:23], a[100:103], a[24:27], v[20:23]
  buffer_load_dwordx4 a[12:15], v241, s[4:7], s16 offen offset:1024 sc1
  v_mfma_f32_16x16x32_bf16 v[36:39], a[100:103], a[28:31], v[36:39]
  ds_read_b64_tr_b16 a[100:101], v243 offset:40960
  ds_read_b64_tr_b16 a[102:103], v243 offset:45056
  v_mfma_f32_16x16x32_bf16 v[24:27], a[104:107], a[24:27], v[24:27]
  s_add_u32 s16, s16, 262144
  v_mfma_f32_16x16x32_bf16 v[40:43], a[104:107], a[28:31], v[40:43]
  ds_read_b64_tr_b16 a[104:105], v244 offset:40960
  ds_read_b64_tr_b16 a[106:107], v244 offset:45056
  v_mfma_f32_16x16x32_bf16 v[28:31], a[108:111], a[24:27], v[28:31]
  v_mfma_f32_16x16x32_bf16 v[44:47], a[108:111], a[28:31], v[44:47]
  s_waitcnt vmcnt(13) lgkmcnt(10)
  s_barrier
  v_mfma_f32_16x16x32_bf16 v[72:75], a[80:83], a[32:35], v[72:75]
  ds_read_b64_tr_b16 a[108:109], v245 offset:40960
  s_add_u32 m0, s38, 16384
  v_mfma_f32_16x16x32_bf16 v[88:91], a[80:83], a[36:39], v[88:91]
  ds_read_b64_tr_b16 a[110:111], v245 offset:45056
  ds_read_b64_tr_b16 a[80:81], v242 offset:51200
  v_mfma_f32_16x16x32_bf16 v[76:79], a[84:87], a[32:35], v[76:79]
  buffer_load_dwordx4 v225, s[8:11], s17 offen lds
  v_mfma_f32_16x16x32_bf16 v[92:95], a[84:87], a[36:39], v[92:95]
  ds_read_b64_tr_b16 a[82:83], v242 offset:55296
  ds_read_b64_tr_b16 a[84:85], v243 offset:51200
  v_mfma_f32_16x16x32_bf16 v[80:83], a[88:91], a[32:35], v[80:83]
  buffer_load_dwordx4 v226, s[8:11], s17 offen offset:1024 lds
  v_mfma_f32_16x16x32_bf16 v[96:99], a[88:91], a[36:39], v[96:99]
  ds_read_b64_tr_b16 a[86:87], v243 offset:55296
  ds_read_b64_tr_b16 a[88:89], v244 offset:51200
  v_mfma_f32_16x16x32_bf16 v[84:87], a[92:95], a[32:35], v[84:87]
  ds_read_b64_tr_b16 a[90:91], v244 offset:55296
  v_mfma_f32_16x16x32_bf16 v[100:103], a[92:95], a[36:39], v[100:103]
  buffer_load_dwordx4 v227, s[8:11], s17 offen offset:2048 lds
  v_mfma_f32_16x16x32_bf16 v[72:75], a[112:115], a[40:43], v[72:75]
  ds_read_b64_tr_b16 a[92:93], v245 offset:51200
  ds_read_b64_tr_b16 a[94:95], v245 offset:55296
  v_mfma_f32_16x16x32_bf16 v[88:91], a[112:115], a[44:47], v[88:91]
  buffer_load_dwordx4 v228, s[8:11], s17 offen offset:3072 lds
  v_mfma_f32_16x16x32_bf16 v[76:79], a[116:119], a[40:43], v[76:79]
  ds_read_b64_tr_b16 a[112:113], v242 offset:59392
  ds_read_b64_tr_b16 a[114:115], v242 offset:63488
  v_mfma_f32_16x16x32_bf16 v[92:95], a[116:119], a[44:47], v[92:95]
  ds_read_b64_tr_b16 a[116:117], v243 offset:59392
  s_add_u32 s17, s17, 458752
  v_mfma_f32_16x16x32_bf16 v[80:83], a[120:123], a[40:43], v[80:83]
  ds_read_b64_tr_b16 a[118:119], v243 offset:63488
  v_mfma_f32_16x16x32_bf16 v[96:99], a[120:123], a[44:47], v[96:99]
  ds_read_b64_tr_b16 a[120:121], v244 offset:59392
  ds_read_b64_tr_b16 a[122:123], v244 offset:63488
  v_mfma_f32_16x16x32_bf16 v[84:87], a[124:127], a[40:43], v[84:87]
  buffer_load_dword v251, v255, s[8:11], s96 offen
  v_mfma_f32_16x16x32_bf16 v[100:103], a[124:127], a[44:47], v[100:103]
  ds_read_b64_tr_b16 a[124:125], v245 offset:59392
  ds_read_b64_tr_b16 a[126:127], v245 offset:63488
  v_mfma_f32_16x16x32_bf16 v[16:19], a[64:67], a[32:35], v[16:19]
  s_add_u32 s96, s96, 458752
  v_mfma_f32_16x16x32_bf16 v[32:35], a[64:67], a[36:39], v[32:35]
  ds_read_b64_tr_b16 a[64:65], v242 offset:49152
  ds_read_b64_tr_b16 a[66:67], v242 offset:53248
  v_mfma_f32_16x16x32_bf16 v[20:23], a[68:71], a[32:35], v[20:23]
  v_mfma_f32_16x16x32_bf16 v[36:39], a[68:71], a[36:39], v[36:39]
  buffer_load_dwordx4 a[16:19], v240, s[4:7], s16 offen offset:0 sc1
  s_waitcnt lgkmcnt(10)
  v_mfma_f32_16x16x32_bf16 v[24:27], a[72:75], a[32:35], v[24:27]
  ds_read_b64_tr_b16 a[68:69], v243 offset:49152
  ds_read_b64_tr_b16 a[70:71], v243 offset:53248
  v_mfma_f32_16x16x32_bf16 v[40:43], a[72:75], a[36:39], v[40:43]
  buffer_load_dwordx4 a[20:23], v240, s[4:7], s16 offen offset:1024 sc1
  v_mfma_f32_16x16x32_bf16 v[28:31], a[76:79], a[32:35], v[28:31]
  ds_read_b64_tr_b16 a[72:73], v244 offset:49152
  ds_read_b64_tr_b16 a[74:75], v244 offset:53248
  v_mfma_f32_16x16x32_bf16 v[44:47], a[76:79], a[36:39], v[44:47]
  buffer_load_dwordx4 a[24:27], v241, s[4:7], s16 offen offset:0 sc1
  v_mfma_f32_16x16x32_bf16 v[16:19], a[96:99], a[40:43], v[16:19]
  ds_read_b64_tr_b16 a[76:77], v245 offset:49152
  ds_read_b64_tr_b16 a[78:79], v245 offset:53248
  v_mfma_f32_16x16x32_bf16 v[32:35], a[96:99], a[44:47], v[32:35]
  ds_read_b64_tr_b16 a[96:97], v242 offset:57344
  ds_read_b64_tr_b16 a[98:99], v242 offset:61440
  v_mfma_f32_16x16x32_bf16 v[20:23], a[100:103], a[40:43], v[20:23]
  buffer_load_dwordx4 a[28:31], v241, s[4:7], s16 offen offset:1024 sc1
  v_mfma_f32_16x16x32_bf16 v[36:39], a[100:103], a[44:47], v[36:39]
  ds_read_b64_tr_b16 a[100:101], v243 offset:57344
  ds_read_b64_tr_b16 a[102:103], v243 offset:61440
  v_mfma_f32_16x16x32_bf16 v[24:27], a[104:107], a[40:43], v[24:27]
  s_add_u32 s16, s16, 262144
  v_mfma_f32_16x16x32_bf16 v[40:43], a[104:107], a[44:47], v[40:43]
  ds_read_b64_tr_b16 a[104:105], v244 offset:57344
  ds_read_b64_tr_b16 a[106:107], v244 offset:61440
  v_mfma_f32_16x16x32_bf16 v[28:31], a[108:111], a[40:43], v[28:31]
  v_mfma_f32_16x16x32_bf16 v[44:47], a[108:111], a[44:47], v[44:47]
  s_waitcnt vmcnt(13) lgkmcnt(10)
  s_barrier
  v_mfma_f32_16x16x32_bf16 v[72:75], a[80:83], a[48:51], v[72:75]
  ds_read_b64_tr_b16 a[108:109], v245 offset:57344
  s_add_u32 m0, s38, 32768
  v_mfma_f32_16x16x32_bf16 v[88:91], a[80:83], a[52:55], v[88:91]
  ds_read_b64_tr_b16 a[110:111], v245 offset:61440
  ds_read_b64_tr_b16 a[80:81], v242 offset:2048
  v_mfma_f32_16x16x32_bf16 v[76:79], a[84:87], a[48:51], v[76:79]
  buffer_load_dwordx4 v225, s[8:11], s17 offen lds
  v_mfma_f32_16x16x32_bf16 v[92:95], a[84:87], a[52:55], v[92:95]
  ds_read_b64_tr_b16 a[82:83], v242 offset:6144
  ds_read_b64_tr_b16 a[84:85], v243 offset:2048
  v_mfma_f32_16x16x32_bf16 v[80:83], a[88:91], a[48:51], v[80:83]
  buffer_load_dwordx4 v226, s[8:11], s17 offen offset:1024 lds
  v_mfma_f32_16x16x32_bf16 v[96:99], a[88:91], a[52:55], v[96:99]
  ds_read_b64_tr_b16 a[86:87], v243 offset:6144
  ds_read_b64_tr_b16 a[88:89], v244 offset:2048
  v_mfma_f32_16x16x32_bf16 v[84:87], a[92:95], a[48:51], v[84:87]
  ds_read_b64_tr_b16 a[90:91], v244 offset:6144
  v_mfma_f32_16x16x32_bf16 v[100:103], a[92:95], a[52:55], v[100:103]
  buffer_load_dwordx4 v227, s[8:11], s17 offen offset:2048 lds
  v_mfma_f32_16x16x32_bf16 v[72:75], a[112:115], a[56:59], v[72:75]
  ds_read_b64_tr_b16 a[92:93], v245 offset:2048
  ds_read_b64_tr_b16 a[94:95], v245 offset:6144
  v_mfma_f32_16x16x32_bf16 v[88:91], a[112:115], a[60:63], v[88:91]
  buffer_load_dwordx4 v228, s[8:11], s17 offen offset:3072 lds
  v_mfma_f32_16x16x32_bf16 v[76:79], a[116:119], a[56:59], v[76:79]
  ds_read_b64_tr_b16 a[112:113], v242 offset:10240
  ds_read_b64_tr_b16 a[114:115], v242 offset:14336
  v_mfma_f32_16x16x32_bf16 v[92:95], a[116:119], a[60:63], v[92:95]
  ds_read_b64_tr_b16 a[116:117], v243 offset:10240
  s_add_u32 s17, s17, 458752
  v_mfma_f32_16x16x32_bf16 v[80:83], a[120:123], a[56:59], v[80:83]
  ds_read_b64_tr_b16 a[118:119], v243 offset:14336
  v_mfma_f32_16x16x32_bf16 v[96:99], a[120:123], a[60:63], v[96:99]
  ds_read_b64_tr_b16 a[120:121], v244 offset:10240
  ds_read_b64_tr_b16 a[122:123], v244 offset:14336
  v_mfma_f32_16x16x32_bf16 v[84:87], a[124:127], a[56:59], v[84:87]
  buffer_load_dword v251, v255, s[8:11], s96 offen
  v_mfma_f32_16x16x32_bf16 v[100:103], a[124:127], a[60:63], v[100:103]
  buffer_load_dword v247, v246, s[56:59], s94 offen sc1
  v_mfma_f32_16x16x32_bf16 v[16:19], a[64:67], a[48:51], v[16:19]
  ds_read_b64_tr_b16 a[124:125], v245 offset:10240
  s_add_u32 s96, s96, 458752
  v_mfma_f32_16x16x32_bf16 v[32:35], a[64:67], a[52:55], v[32:35]
  ds_read_b64_tr_b16 a[126:127], v245 offset:14336
  ds_read_b64_tr_b16 a[64:65], v242 offset:0
  v_mfma_f32_16x16x32_bf16 v[20:23], a[68:71], a[48:51], v[20:23]
  ds_read_b64_tr_b16 a[66:67], v242 offset:4096
  v_mfma_f32_16x16x32_bf16 v[36:39], a[68:71], a[52:55], v[36:39]
  buffer_load_dwordx4 a[32:35], v240, s[4:7], s16 offen offset:0 sc1
  s_waitcnt lgkmcnt(10)
  v_mfma_f32_16x16x32_bf16 v[24:27], a[72:75], a[48:51], v[24:27]
  ds_read_b64_tr_b16 a[68:69], v243 offset:0
  ds_read_b64_tr_b16 a[70:71], v243 offset:4096
  v_mfma_f32_16x16x32_bf16 v[40:43], a[72:75], a[52:55], v[40:43]
  buffer_load_dwordx4 a[36:39], v240, s[4:7], s16 offen offset:1024 sc1
  v_mfma_f32_16x16x32_bf16 v[28:31], a[76:79], a[48:51], v[28:31]
  ds_read_b64_tr_b16 a[72:73], v244 offset:0
  ds_read_b64_tr_b16 a[74:75], v244 offset:4096
  v_mfma_f32_16x16x32_bf16 v[44:47], a[76:79], a[52:55], v[44:47]
  buffer_load_dwordx4 a[40:43], v241, s[4:7], s16 offen offset:0 sc1
  v_mfma_f32_16x16x32_bf16 v[16:19], a[96:99], a[56:59], v[16:19]
  ds_read_b64_tr_b16 a[76:77], v245 offset:0
  ds_read_b64_tr_b16 a[78:79], v245 offset:4096
  v_mfma_f32_16x16x32_bf16 v[32:35], a[96:99], a[60:63], v[32:35]
  ds_read_b64_tr_b16 a[96:97], v242 offset:8192
  ds_read_b64_tr_b16 a[98:99], v242 offset:12288
  v_mfma_f32_16x16x32_bf16 v[20:23], a[100:103], a[56:59], v[20:23]
  buffer_load_dwordx4 a[44:47], v241, s[4:7], s16 offen offset:1024 sc1
  v_mfma_f32_16x16x32_bf16 v[36:39], a[100:103], a[60:63], v[36:39]
  ds_read_b64_tr_b16 a[100:101], v243 offset:8192
  ds_read_b64_tr_b16 a[102:103], v243 offset:12288
  v_mfma_f32_16x16x32_bf16 v[24:27], a[104:107], a[56:59], v[24:27]
  s_add_u32 s16, s16, 262144
  v_mfma_f32_16x16x32_bf16 v[40:43], a[104:107], a[60:63], v[40:43]
  ds_read_b64_tr_b16 a[104:105], v244 offset:8192
  ds_read_b64_tr_b16 a[106:107], v244 offset:12288
  v_mfma_f32_16x16x32_bf16 v[28:31], a[108:111], a[56:59], v[28:31]
  v_mfma_f32_16x16x32_bf16 v[44:47], a[108:111], a[60:63], v[44:47]
  s_waitcnt vmcnt(14) lgkmcnt(10)
  s_barrier
  v_mfma_f32_16x16x32_bf16 v[72:75], a[80:83], a[0:3], v[72:75]
  ds_read_b64_tr_b16 a[108:109], v245 offset:8192
  s_add_u32 m0, s38, 49152
  v_mfma_f32_16x16x32_bf16 v[88:91], a[80:83], a[4:7], v[88:91]
  ds_read_b64_tr_b16 a[110:111], v245 offset:12288
  ds_read_b64_tr_b16 a[80:81], v242 offset:18432
  v_mfma_f32_16x16x32_bf16 v[76:79], a[84:87], a[0:3], v[76:79]
  buffer_load_dwordx4 v225, s[8:11], s17 offen lds
  v_mfma_f32_16x16x32_bf16 v[92:95], a[84:87], a[4:7], v[92:95]
  ds_read_b64_tr_b16 a[82:83], v242 offset:22528
  ds_read_b64_tr_b16 a[84:85], v243 offset:18432
  v_mfma_f32_16x16x32_bf16 v[80:83], a[88:91], a[0:3], v[80:83]
  buffer_load_dwordx4 v226, s[8:11], s17 offen offset:1024 lds
  v_mfma_f32_16x16x32_bf16 v[96:99], a[88:91], a[4:7], v[96:99]
  ds_read_b64_tr_b16 a[86:87], v243 offset:22528
  ds_read_b64_tr_b16 a[88:89], v244 offset:18432
  v_mfma_f32_16x16x32_bf16 v[84:87], a[92:95], a[0:3], v[84:87]
  ds_read_b64_tr_b16 a[90:91], v244 offset:22528
  v_mfma_f32_16x16x32_bf16 v[100:103], a[92:95], a[4:7], v[100:103]
  buffer_load_dwordx4 v227, s[8:11], s17 offen offset:2048 lds
  v_mfma_f32_16x16x32_bf16 v[72:75], a[112:115], a[8:11], v[72:75]
  ds_read_b64_tr_b16 a[92:93], v245 offset:18432
  ds_read_b64_tr_b16 a[94:95], v245 offset:22528
  v_mfma_f32_16x16x32_bf16 v[88:91], a[112:115], a[12:15], v[88:91]
  buffer_load_dwordx4 v228, s[8:11], s17 offen offset:3072 lds
  v_mfma_f32_16x16x32_bf16 v[76:79], a[116:119], a[8:11], v[76:79]
  ds_read_b64_tr_b16 a[112:113], v242 offset:26624
  ds_read_b64_tr_b16 a[114:115], v242 offset:30720
  v_mfma_f32_16x16x32_bf16 v[92:95], a[116:119], a[12:15], v[92:95]
  ds_read_b64_tr_b16 a[116:117], v243 offset:26624
  s_sub_u32 s17, s17, 3145728
  v_mfma_f32_16x16x32_bf16 v[80:83], a[120:123], a[8:11], v[80:83]
  ds_read_b64_tr_b16 a[118:119], v243 offset:30720
  v_mfma_f32_16x16x32_bf16 v[96:99], a[120:123], a[12:15], v[96:99]
  ds_read_b64_tr_b16 a[120:121], v244 offset:26624
  ds_read_b64_tr_b16 a[122:123], v244 offset:30720
  v_mfma_f32_16x16x32_bf16 v[84:87], a[124:127], a[8:11], v[84:87]
  buffer_load_dword v251, v255, s[8:11], s96 offen
  v_mfma_f32_16x16x32_bf16 v[100:103], a[124:127], a[12:15], v[100:103]
  ds_read_b64_tr_b16 a[124:125], v245 offset:26624
  ds_read_b64_tr_b16 a[126:127], v245 offset:30720
  v_mfma_f32_16x16x32_bf16 v[16:19], a[64:67], a[0:3], v[16:19]
  s_add_u32 s96, s96, 458752
  v_mfma_f32_16x16x32_bf16 v[32:35], a[64:67], a[4:7], v[32:35]
  ds_read_b64_tr_b16 a[64:65], v242 offset:16384
  ds_read_b64_tr_b16 a[66:67], v242 offset:20480
  v_mfma_f32_16x16x32_bf16 v[20:23], a[68:71], a[0:3], v[20:23]
  v_mfma_f32_16x16x32_bf16 v[36:39], a[68:71], a[4:7], v[36:39]
  buffer_load_dwordx4 a[48:51], v240, s[4:7], s16 offen offset:0 sc1
  s_waitcnt lgkmcnt(10)
  v_mfma_f32_16x16x32_bf16 v[24:27], a[72:75], a[0:3], v[24:27]
  ds_read_b64_tr_b16 a[68:69], v243 offset:16384
  ds_read_b64_tr_b16 a[70:71], v243 offset:20480
  v_mfma_f32_16x16x32_bf16 v[40:43], a[72:75], a[4:7], v[40:43]
  buffer_load_dwordx4 a[52:55], v240, s[4:7], s16 offen offset:1024 sc1
  v_mfma_f32_16x16x32_bf16 v[28:31], a[76:79], a[0:3], v[28:31]
  ds_read_b64_tr_b16 a[72:73], v244 offset:16384
  ds_read_b64_tr_b16 a[74:75], v244 offset:20480
  v_mfma_f32_16x16x32_bf16 v[44:47], a[76:79], a[4:7], v[44:47]
  buffer_load_dwordx4 a[56:59], v241, s[4:7], s16 offen offset:0 sc1
  v_mfma_f32_16x16x32_bf16 v[16:19], a[96:99], a[8:11], v[16:19]
  ds_read_b64_tr_b16 a[76:77], v245 offset:16384
  ds_read_b64_tr_b16 a[78:79], v245 offset:20480
  v_mfma_f32_16x16x32_bf16 v[32:35], a[96:99], a[12:15], v[32:35]
  ds_read_b64_tr_b16 a[96:97], v242 offset:24576
  ds_read_b64_tr_b16 a[98:99], v242 offset:28672
  v_mfma_f32_16x16x32_bf16 v[20:23], a[100:103], a[8:11], v[20:23]
  buffer_load_dwordx4 a[60:63], v241, s[4:7], s16 offen offset:1024 sc1
  v_mfma_f32_16x16x32_bf16 v[36:39], a[100:103], a[12:15], v[36:39]
  ds_read_b64_tr_b16 a[100:101], v243 offset:24576
  ds_read_b64_tr_b16 a[102:103], v243 offset:28672
  v_mfma_f32_16x16x32_bf16 v[24:27], a[104:107], a[8:11], v[24:27]
  s_add_u32 s16, s16, 262144
  v_mfma_f32_16x16x32_bf16 v[40:43], a[104:107], a[12:15], v[40:43]
  ds_read_b64_tr_b16 a[104:105], v244 offset:24576
  ds_read_b64_tr_b16 a[106:107], v244 offset:28672
  v_mfma_f32_16x16x32_bf16 v[28:31], a[108:111], a[8:11], v[28:31]
  v_mfma_f32_16x16x32_bf16 v[44:47], a[108:111], a[12:15], v[44:47]
  s_waitcnt vmcnt(13) lgkmcnt(10)
  s_barrier
  v_cmp_ne_u32 vcc, s19, v247
  s_nop 1
  s_cmp_lg_u64 vcc, 0
  s_cbranch_scc1 L_slow_29
  L_back_30:
  s_add_u32 s94, s94, 65536
  v_mfma_f32_16x16x32_bf16 v[72:75], a[80:83], a[16:19], v[72:75]
  ds_read_b64_tr_b16 a[108:109], v245 offset:24576
  s_add_u32 m0, s38, 0
  v_mfma_f32_16x16x32_bf16 v[88:91], a[80:83], a[20:23], v[88:91]
  ds_read_b64_tr_b16 a[110:111], v245 offset:28672
  ds_read_b64_tr_b16 a[80:81], v242 offset:34816
  v_mfma_f32_16x16x32_bf16 v[76:79], a[84:87], a[16:19], v[76:79]
  buffer_load_dwordx4 v225, s[8:11], s17 offen lds
  v_mfma_f32_16x16x32_bf16 v[92:95], a[84:87], a[20:23], v[92:95]
  ds_read_b64_tr_b16 a[82:83], v242 offset:38912
  ds_read_b64_tr_b16 a[84:85], v243 offset:34816
  v_mfma_f32_16x16x32_bf16 v[80:83], a[88:91], a[16:19], v[80:83]
  buffer_load_dwordx4 v226, s[8:11], s17 offen offset:1024 lds
  v_mfma_f32_16x16x32_bf16 v[96:99], a[88:91], a[20:23], v[96:99]
  ds_read_b64_tr_b16 a[86:87], v243 offset:38912
  ds_read_b64_tr_b16 a[88:89], v244 offset:34816
  v_mfma_f32_16x16x32_bf16 v[84:87], a[92:95], a[16:19], v[84:87]
  ds_read_b64_tr_b16 a[90:91], v244 offset:38912
  v_mfma_f32_16x16x32_bf16 v[100:103], a[92:95], a[20:23], v[100:103]
  buffer_load_dwordx4 v227, s[8:11], s17 offen offset:2048 lds
  v_mfma_f32_16x16x32_bf16 v[72:75], a[112:115], a[24:27], v[72:75]
  ds_read_b64_tr_b16 a[92:93], v245 offset:34816
  ds_read_b64_tr_b16 a[94:95], v245 offset:38912
  v_mfma_f32_16x16x32_bf16 v[88:91], a[112:115], a[28:31], v[88:91]
  buffer_load_dwordx4 v228, s[8:11], s17 offen offset:3072 lds
  v_mfma_f32_16x16x32_bf16 v[76:79], a[116:119], a[24:27], v[76:79]
  ds_read_b64_tr_b16 a[112:113], v242 offset:43008
  ds_read_b64_tr_b16 a[114:115], v242 offset:47104
  v_mfma_f32_16x16x32_bf16 v[92:95], a[116:119], a[28:31], v[92:95]
  ds_read_b64_tr_b16 a[116:117], v243 offset:43008
  s_add_u32 s17, s17, 458752
  v_mfma_f32_16x16x32_bf16 v[80:83], a[120:123], a[24:27], v[80:83]
  ds_read_b64_tr_b16 a[118:119], v243 offset:47104
  v_mfma_f32_16x16x32_bf16 v[96:99], a[120:123], a[28:31], v[96:99]
  ds_read_b64_tr_b16 a[120:121], v244 offset:43008
  ds_read_b64_tr_b16 a[122:123], v244 offset:47104
  v_mfma_f32_16x16x32_bf16 v[84:87], a[124:127], a[24:27], v[84:87]
  buffer_load_dword v251, v255, s[8:11], s96 offen
  v_mfma_f32_16x16x32_bf16 v[100:103], a[124:127], a[28:31], v[100:103]
  ds_read_b64_tr_b16 a[124:125], v245 offset:43008
  ds_read_b64_tr_b16 a[126:127], v245 offset:47104
  v_mfma_f32_16x16x32_bf16 v[16:19], a[64:67], a[16:19], v[16:19]
  s_add_u32 s96, s96, 458752
  v_mfma_f32_16x16x32_bf16 v[32:35], a[64:67], a[20:23], v[32:35]
  ds_read_b64_tr_b16 a[64:65], v242 offset:32768
  ds_read_b64_tr_b16 a[66:67], v242 offset:36864
  v_mfma_f32_16x16x32_bf16 v[20:23], a[68:71], a[16:19], v[20:23]
  v_mfma_f32_16x16x32_bf16 v[36:39], a[68:71], a[20:23], v[36:39]
  buffer_load_dwordx4 a[0:3], v240, s[4:7], s16 offen offset:0 sc1
  s_waitcnt lgkmcnt(10)
  v_mfma_f32_16x16x32_bf16 v[24:27], a[72:75], a[16:19], v[24:27]
  ds_read_b64_tr_b16 a[68:69], v243 offset:32768
  ds_read_b64_tr_b16 a[70:71], v243 offset:36864
  v_mfma_f32_16x16x32_bf16 v[40:43], a[72:75], a[20:23], v[40:43]
  buffer_load_dwordx4 a[4:7], v240, s[4:7], s16 offen offset:1024 sc1
  v_mfma_f32_16x16x32_bf16 v[28:31], a[76:79], a[16:19], v[28:31]
  ds_read_b64_tr_b16 a[72:73], v244 offset:32768
  ds_read_b64_tr_b16 a[74:75], v244 offset:36864
  v_mfma_f32_16x16x32_bf16 v[44:47], a[76:79], a[20:23], v[44:47]
  buffer_load_dwordx4 a[8:11], v241, s[4:7], s16 offen offset:0 sc1
  v_mfma_f32_16x16x32_bf16 v[16:19], a[96:99], a[24:27], v[16:19]
  ds_read_b64_tr_b16 a[76:77], v245 offset:32768
  ds_read_b64_tr_b16 a[78:79], v245 offset:36864
  v_mfma_f32_16x16x32_bf16 v[32:35], a[96:99], a[28:31], v[32:35]
  ds_read_b64_tr_b16 a[96:97], v242 offset:40960
  ds_read_b64_tr_b16 a[98:99], v242 offset:45056
  v_mfma_f32_16x16x32_bf16 v[20:23], a[100:103], a[24:27], v[20:23]
  buffer_load_dwordx4 a[12:15], v241, s[4:7], s16 offen offset:1024 sc1
  v_mfma_f32_16x16x32_bf16 v[36:39], a[100:103], a[28:31], v[36:39]
  ds_read_b64_tr_b16 a[100:101], v243 offset:40960
  ds_read_b64_tr_b16 a[102:103], v243 offset:45056
  v_mfma_f32_16x16x32_bf16 v[24:27], a[104:107], a[24:27], v[24:27]
  s_add_u32 s16, s16, 262144
  v_mfma_f32_16x16x32_bf16 v[40:43], a[104:107], a[28:31], v[40:43]
  ds_read_b64_tr_b16 a[104:105], v244 offset:40960
  ds_read_b64_tr_b16 a[106:107], v244 offset:45056
  v_mfma_f32_16x16x32_bf16 v[28:31], a[108:111], a[24:27], v[28:31]
  v_mfma_f32_16x16x32_bf16 v[44:47], a[108:111], a[28:31], v[44:47]
  s_waitcnt vmcnt(13) lgkmcnt(10)
  s_barrier
  v_mfma_f32_16x16x32_bf16 v[72:75], a[80:83], a[32:35], v[72:75]
  ds_read_b64_tr_b16 a[108:109], v245 offset:40960
  s_add_u32 m0, s38, 16384
  v_mfma_f32_16x16x32_bf16 v[88:91], a[80:83], a[36:39], v[88:91]
  ds_read_b64_tr_b16 a[110:111], v245 offset:45056
  ds_read_b64_tr_b16 a[80:81], v242 offset:51200
  v_mfma_f32_16x16x32_bf16 v[76:79], a[84:87], a[32:35], v[76:79]
  buffer_load_dwordx4 v225, s[8:11], s17 offen lds
  v_mfma_f32_16x16x32_bf16 v[92:95], a[84:87], a[36:39], v[92:95]
  ds_read_b64_tr_b16 a[82:83], v242 offset:55296
  ds_read_b64_tr_b16 a[84:85], v243 offset:51200
  v_mfma_f32_16x16x32_bf16 v[80:83], a[88:91], a[32:35], v[80:83]
  buffer_load_dwordx4 v226, s[8:11], s17 offen offset:1024 lds
  v_mfma_f32_16x16x32_bf16 v[96:99], a[88:91], a[36:39], v[96:99]
  ds_read_b64_tr_b16 a[86:87], v243 offset:55296
  ds_read_b64_tr_b16 a[88:89], v244 offset:51200
  v_mfma_f32_16x16x32_bf16 v[84:87], a[92:95], a[32:35], v[84:87]
  ds_read_b64_tr_b16 a[90:91], v244 offset:55296
  v_mfma_f32_16x16x32_bf16 v[100:103], a[92:95], a[36:39], v[100:103]
  buffer_load_dwordx4 v227, s[8:11], s17 offen offset:2048 lds
  v_mfma_f32_16x16x32_bf16 v[72:75], a[112:115], a[40:43], v[72:75]
  ds_read_b64_tr_b16 a[92:93], v245 offset:51200
  ds_read_b64_tr_b16 a[94:95], v245 offset:55296
  v_mfma_f32_16x16x32_bf16 v[88:91], a[112:115], a[44:47], v[88:91]
  buffer_load_dwordx4 v228, s[8:11], s17 offen offset:3072 lds
  v_mfma_f32_16x16x32_bf16 v[76:79], a[116:119], a[40:43], v[76:79]
  ds_read_b64_tr_b16 a[112:113], v242 offset:59392
  ds_read_b64_tr_b16 a[114:115], v242 offset:63488
  v_mfma_f32_16x16x32_bf16 v[92:95], a[116:119], a[44:47], v[92:95]
  ds_read_b64_tr_b16 a[116:117], v243 offset:59392
  s_add_u32 s17, s17, 458752
  v_mfma_f32_16x16x32_bf16 v[80:83], a[120:123], a[40:43], v[80:83]
  ds_read_b64_tr_b16 a[118:119], v243 offset:63488
  v_mfma_f32_16x16x32_bf16 v[96:99], a[120:123], a[44:47], v[96:99]
  ds_read_b64_tr_b16 a[120:121], v244 offset:59392
  ds_read_b64_tr_b16 a[122:123], v244 offset:63488
  v_mfma_f32_16x16x32_bf16 v[84:87], a[124:127], a[40:43], v[84:87]
  buffer_load_dword v251, v255, s[8:11], s96 offen
  v_mfma_f32_16x16x32_bf16 v[100:103], a[124:127], a[44:47], v[100:103]
  ds_read_b64_tr_b16 a[124:125], v245 offset:59392
  ds_read_b64_tr_b16 a[126:127], v245 offset:63488
  v_mfma_f32_16x16x32_bf16 v[16:19], a[64:67], a[32:35], v[16:19]
  s_add_u32 s96, s96, 458752
  v_mfma_f32_16x16x32_bf16 v[32:35], a[64:67], a[36:39], v[32:35]
  ds_read_b64_tr_b16 a[64:65], v242 offset:49152
  ds_read_b64_tr_b16 a[66:67], v242 offset:53248
  v_mfma_f32_16x16x32_bf16 v[20:23], a[68:71], a[32:35], v[20:23]
  v_mfma_f32_16x16x32_bf16 v[36:39], a[68:71], a[36:39], v[36:39]
  buffer_load_dwordx4 a[16:19], v240, s[4:7], s16 offen offset:0 sc1
  s_waitcnt lgkmcnt(10)
  v_mfma_f32_16x16x32_bf16 v[24:27], a[72:75], a[32:35], v[24:27]
  ds_read_b64_tr_b16 a[68:69], v243 offset:49152
  ds_read_b64_tr_b16 a[70:71], v243 offset:53248
  v_mfma_f32_16x16x32_bf16 v[40:43], a[72:75], a[36:39], v[40:43]
  buffer_load_dwordx4 a[20:23], v240, s[4:7], s16 offen offset:1024 sc1
  v_mfma_f32_16x16x32_bf16 v[28:31], a[76:79], a[32:35], v[28:31]
  ds_read_b64_tr_b16 a[72:73], v244 offset:49152
  ds_read_b64_tr_b16 a[74:75], v244 offset:53248
  v_mfma_f32_16x16x32_bf16 v[44:47], a[76:79], a[36:39], v[44:47]
  buffer_load_dwordx4 a[24:27], v241, s[4:7], s16 offen offset:0 sc1
  v_mfma_f32_16x16x32_bf16 v[16:19], a[96:99], a[40:43], v[16:19]
  ds_read_b64_tr_b16 a[76:77], v245 offset:49152
  ds_read_b64_tr_b16 a[78:79], v245 offset:53248
  v_mfma_f32_16x16x32_bf16 v[32:35], a[96:99], a[44:47], v[32:35]
  ds_read_b64_tr_b16 a[96:97], v242 offset:57344
  ds_read_b64_tr_b16 a[98:99], v242 offset:61440
  v_mfma_f32_16x16x32_bf16 v[20:23], a[100:103], a[40:43], v[20:23]
  buffer_load_dwordx4 a[28:31], v241, s[4:7], s16 offen offset:1024 sc1
  v_mfma_f32_16x16x32_bf16 v[36:39], a[100:103], a[44:47], v[36:39]
  ds_read_b64_tr_b16 a[100:101], v243 offset:57344
  ds_read_b64_tr_b16 a[102:103], v243 offset:61440
  v_mfma_f32_16x16x32_bf16 v[24:27], a[104:107], a[40:43], v[24:27]
  s_add_u32 s16, s16, 262144
  v_mfma_f32_16x16x32_bf16 v[40:43], a[104:107], a[44:47], v[40:43]
  ds_read_b64_tr_b16 a[104:105], v244 offset:57344
  ds_read_b64_tr_b16 a[106:107], v244 offset:61440
  v_mfma_f32_16x16x32_bf16 v[28:31], a[108:111], a[40:43], v[28:31]
  v_mfma_f32_16x16x32_bf16 v[44:47], a[108:111], a[44:47], v[44:47]
  s_waitcnt vmcnt(13) lgkmcnt(10)
  s_barrier
  v_mfma_f32_16x16x32_bf16 v[72:75], a[80:83], a[48:51], v[72:75]
  ds_read_b64_tr_b16 a[108:109], v245 offset:57344
  s_add_u32 m0, s38, 32768
  v_mfma_f32_16x16x32_bf16 v[88:91], a[80:83], a[52:55], v[88:91]
  ds_read_b64_tr_b16 a[110:111], v245 offset:61440
  ds_read_b64_tr_b16 a[80:81], v242 offset:2048
  v_mfma_f32_16x16x32_bf16 v[76:79], a[84:87], a[48:51], v[76:79]
  buffer_load_dwordx4 v225, s[8:11], s17 offen lds
  v_mfma_f32_16x16x32_bf16 v[92:95], a[84:87], a[52:55], v[92:95]
  ds_read_b64_tr_b16 a[82:83], v242 offset:6144
  ds_read_b64_tr_b16 a[84:85], v243 offset:2048
  v_mfma_f32_16x16x32_bf16 v[80:83], a[88:91], a[48:51], v[80:83]
  buffer_load_dwordx4 v226, s[8:11], s17 offen offset:1024 lds
  v_mfma_f32_16x16x32_bf16 v[96:99], a[88:91], a[52:55], v[96:99]
  ds_read_b64_tr_b16 a[86:87], v243 offset:6144
  ds_read_b64_tr_b16 a[88:89], v244 offset:2048
  v_mfma_f32_16x16x32_bf16 v[84:87], a[92:95], a[48:51], v[84:87]
  ds_read_b64_tr_b16 a[90:91], v244 offset:6144
  v_mfma_f32_16x16x32_bf16 v[100:103], a[92:95], a[52:55], v[100:103]
  buffer_load_dwordx4 v227, s[8:11], s17 offen offset:2048 lds
  v_mfma_f32_16x16x32_bf16 v[72:75], a[112:115], a[56:59], v[72:75]
  ds_read_b64_tr_b16 a[92:93], v245 offset:2048
  ds_read_b64_tr_b16 a[94:95], v245 offset:6144
  v_mfma_f32_16x16x32_bf16 v[88:91], a[112:115], a[60:63], v[88:91]
  buffer_load_dwordx4 v228, s[8:11], s17 offen offset:3072 lds
  v_mfma_f32_16x16x32_bf16 v[76:79], a[116:119], a[56:59], v[76:79]
  ds_read_b64_tr_b16 a[112:113], v242 offset:10240
  ds_read_b64_tr_b16 a[114:115], v242 offset:14336
  v_mfma_f32_16x16x32_bf16 v[92:95], a[116:119], a[60:63], v[92:95]
  ds_read_b64_tr_b16 a[116:117], v243 offset:10240
  s_add_u32 s17, s17, 458752
  v_mfma_f32_16x16x32_bf16 v[80:83], a[120:123], a[56:59], v[80:83]
  ds_read_b64_tr_b16 a[118:119], v243 offset:14336
  v_mfma_f32_16x16x32_bf16 v[96:99], a[120:123], a[60:63], v[96:99]
  ds_read_b64_tr_b16 a[120:121], v244 offset:10240
  ds_read_b64_tr_b16 a[122:123], v244 offset:14336
  v_mfma_f32_16x16x32_bf16 v[84:87], a[124:127], a[56:59], v[84:87]
  buffer_load_dword v251, v255, s[8:11], s96 offen
  v_mfma_f32_16x16x32_bf16 v[100:103], a[124:127], a[60:63], v[100:103]
  ds_read_b64_tr_b16 a[124:125], v245 offset:10240
  ds_read_b64_tr_b16 a[126:127], v245 offset:14336
  v_mfma_f32_16x16x32_bf16 v[16:19], a[64:67], a[48:51], v[16:19]
  s_add_u32 s96, s96, 458752
  v_mfma_f32_16x16x32_bf16 v[32:35], a[64:67], a[52:55], v[32:35]
  ds_read_b64_tr_b16 a[64:65], v242 offset:0
  ds_read_b64_tr_b16 a[66:67], v242 offset:4096
  v_mfma_f32_16x16x32_bf16 v[20:23], a[68:71], a[48:51], v[20:23]
  v_mfma_f32_16x16x32_bf16 v[36:39], a[68:71], a[52:55], v[36:39]
  buffer_load_dwordx4 a[32:35], v240, s[4:7], s16 offen offset:0 sc1
  s_waitcnt lgkmcnt(10)
  v_mfma_f32_16x16x32_bf16 v[24:27], a[72:75], a[48:51], v[24:27]
  ds_read_b64_tr_b16 a[68:69], v243 offset:0
  ds_read_b64_tr_b16 a[70:71], v243 offset:4096
  v_mfma_f32_16x16x32_bf16 v[40:43], a[72:75], a[52:55], v[40:43]
  buffer_load_dwordx4 a[36:39], v240, s[4:7], s16 offen offset:1024 sc1
  v_mfma_f32_16x16x32_bf16 v[28:31], a[76:79], a[48:51], v[28:31]
  ds_read_b64_tr_b16 a[72:73], v244 offset:0
  ds_read_b64_tr_b16 a[74:75], v244 offset:4096
  v_mfma_f32_16x16x32_bf16 v[44:47], a[76:79], a[52:55], v[44:47]
  buffer_load_dwordx4 a[40:43], v241, s[4:7], s16 offen offset:0 sc1
  v_mfma_f32_16x16x32_bf16 v[16:19], a[96:99], a[56:59], v[16:19]
  ds_read_b64_tr_b16 a[76:77], v245 offset:0
  ds_read_b64_tr_b16 a[78:79], v245 offset:4096
  v_mfma_f32_16x16x32_bf16 v[32:35], a[96:99], a[60:63], v[32:35]
  ds_read_b64_tr_b16 a[96:97], v242 offset:8192
  ds_read_b64_tr_b16 a[98:99], v242 offset:12288
  v_mfma_f32_16x16x32_bf16 v[20:23], a[100:103], a[56:59], v[20:23]
  buffer_load_dwordx4 a[44:47], v241, s[4:7], s16 offen offset:1024 sc1
  v_mfma_f32_16x16x32_bf16 v[36:39], a[100:103], a[60:63], v[36:39]
  ds_read_b64_tr_b16 a[100:101], v243 offset:8192
  ds_read_b64_tr_b16 a[102:103], v243 offset:12288
  v_mfma_f32_16x16x32_bf16 v[24:27], a[104:107], a[56:59], v[24:27]
  s_add_u32 s16, s16, 262144
  v_mfma_f32_16x16x32_bf16 v[40:43], a[104:107], a[60:63], v[40:43]
  ds_read_b64_tr_b16 a[104:105], v244 offset:8192
  ds_read_b64_tr_b16 a[106:107], v244 offset:12288
  v_mfma_f32_16x16x32_bf16 v[28:31], a[108:111], a[56:59], v[28:31]
  v_mfma_f32_16x16x32_bf16 v[44:47], a[108:111], a[60:63], v[44:47]
  s_waitcnt vmcnt(13) lgkmcnt(10)
  s_barrier
  v_mfma_f32_16x16x32_bf16 v[72:75], a[80:83], a[0:3], v[72:75]
  ds_read_b64_tr_b16 a[108:109], v245 offset:8192
  s_add_u32 m0, s38, 49152
  v_mfma_f32_16x16x32_bf16 v[88:91], a[80:83], a[4:7], v[88:91]
  ds_read_b64_tr_b16 a[110:111], v245 offset:12288
  ds_read_b64_tr_b16 a[80:81], v242 offset:18432
  v_mfma_f32_16x16x32_bf16 v[76:79], a[84:87], a[0:3], v[76:79]
  buffer_load_dwordx4 v225, s[8:11], s17 offen lds
  v_mfma_f32_16x16x32_bf16 v[92:95], a[84:87], a[4:7], v[92:95]
  ds_read_b64_tr_b16 a[82:83], v242 offset:22528
  ds_read_b64_tr_b16 a[84:85], v243 offset:18432
  v_mfma_f32_16x16x32_bf16 v[80:83], a[88:91], a[0:3], v[80:83]
  buffer_load_dwordx4 v226, s[8:11], s17 offen offset:1024 lds
  v_mfma_f32_16x16x32_bf16 v[96:99], a[88:91], a[4:7], v[96:99]
  ds_read_b64_tr_b16 a[86:87], v243 offset:22528
  ds_read_b64_tr_b16 a[88:89], v244 offset:18432
  v_mfma_f32_16x16x32_bf16 v[84:87], a[92:95], a[0:3], v[84:87]
  ds_read_b64_tr_b16 a[90:91], v244 offset:22528
  v_mfma_f32_16x16x32_bf16 v[100:103], a[92:95], a[4:7], v[100:103]
  buffer_load_dwordx4 v227, s[8:11], s17 offen offset:2048 lds
  v_mfma_f32_16x16x32_bf16 v[72:75], a[112:115], a[8:11], v[72:75]
  ds_read_b64_tr_b16 a[92:93], v245 offset:18432
  ds_read_b64_tr_b16 a[94:95], v245 offset:22528
  v_mfma_f32_16x16x32_bf16 v[88:91], a[112:115], a[12:15], v[88:91]
  buffer_load_dwordx4 v228, s[8:11], s17 offen offset:3072 lds
  v_mfma_f32_16x16x32_bf16 v[76:79], a[116:119], a[8:11], v[76:79]
  ds_read_b64_tr_b16 a[112:113], v242 offset:26624
  ds_read_b64_tr_b16 a[114:115], v242 offset:30720
  v_mfma_f32_16x16x32_bf16 v[92:95], a[116:119], a[12:15], v[92:95]
  ds_read_b64_tr_b16 a[116:117], v243 offset:26624
  s_add_u32 s17, s17, 458752
  v_mfma_f32_16x16x32_bf16 v[80:83], a[120:123], a[8:11], v[80:83]
  ds_read_b64_tr_b16 a[118:119], v243 offset:30720
  v_mfma_f32_16x16x32_bf16 v[96:99], a[120:123], a[12:15], v[96:99]
  ds_read_b64_tr_b16 a[120:121], v244 offset:26624
  ds_read_b64_tr_b16 a[122:123], v244 offset:30720
  v_mfma_f32_16x16x32_bf16 v[84:87], a[124:127], a[8:11], v[84:87]
  buffer_load_dword v251, v255, s[8:11], s96 offen
  v_mfma_f32_16x16x32_bf16 v[100:103], a[124:127], a[12:15], v[100:103]
  ds_read_b64_tr_b16 a[124:125], v245 offset:26624
  ds_read_b64_tr_b16 a[126:127], v245 offset:30720
  v_mfma_f32_16x16x32_bf16 v[16:19], a[64:67], a[0:3], v[16:19]
  s_add_u32 s96, s96, 458752
  v_mfma_f32_16x16x32_bf16 v[32:35], a[64:67], a[4:7], v[32:35]
  ds_read_b64_tr_b16 a[64:65], v242 offset:16384
  ds_read_b64_tr_b16 a[66:67], v242 offset:20480
  v_mfma_f32_16x16x32_bf16 v[20:23], a[68:71], a[0:3], v[20:23]
  v_mfma_f32_16x16x32_bf16 v[36:39], a[68:71], a[4:7], v[36:39]
  buffer_load_dwordx4 a[48:51], v240, s[4:7], s16 offen offset:0 sc1
  s_waitcnt lgkmcnt(10)
  v_mfma_f32_16x16x32_bf16 v[24:27], a[72:75], a[0:3], v[24:27]
  ds_read_b64_tr_b16 a[68:69], v243 offset:16384
  ds_read_b64_tr_b16 a[70:71], v243 offset:20480
  v_mfma_f32_16x16x32_bf16 v[40:43], a[72:75], a[4:7], v[40:43]
  buffer_load_dwordx4 a[52:55], v240, s[4:7], s16 offen offset:1024 sc1
  v_mfma_f32_16x16x32_bf16 v[28:31], a[76:79], a[0:3], v[28:31]
  ds_read_b64_tr_b16 a[72:73], v244 offset:16384
  ds_read_b64_tr_b16 a[74:75], v244 offset:20480
  v_mfma_f32_16x16x32_bf16 v[44:47], a[76:79], a[4:7], v[44:47]
  buffer_load_dwordx4 a[56:59], v241, s[4:7], s16 offen offset:0 sc1
  v_mfma_f32_16x16x32_bf16 v[16:19], a[96:99], a[8:11], v[16:19]
  ds_read_b64_tr_b16 a[76:77], v245 offset:16384
  ds_read_b64_tr_b16 a[78:79], v245 offset:20480
  v_mfma_f32_16x16x32_bf16 v[32:35], a[96:99], a[12:15], v[32:35]
  ds_read_b64_tr_b16 a[96:97], v242 offset:24576
  ds_read_b64_tr_b16 a[98:99], v242 offset:28672
  v_mfma_f32_16x16x32_bf16 v[20:23], a[100:103], a[8:11], v[20:23]
  buffer_load_dwordx4 a[60:63], v241, s[4:7], s16 offen offset:1024 sc1
  v_mfma_f32_16x16x32_bf16 v[36:39], a[100:103], a[12:15], v[36:39]
  ds_read_b64_tr_b16 a[100:101], v243 offset:24576
  ds_read_b64_tr_b16 a[102:103], v243 offset:28672
  v_mfma_f32_16x16x32_bf16 v[24:27], a[104:107], a[8:11], v[24:27]
  s_add_u32 s16, s16, 262144
  v_mfma_f32_16x16x32_bf16 v[40:43], a[104:107], a[12:15], v[40:43]
  ds_read_b64_tr_b16 a[104:105], v244 offset:24576
  ds_read_b64_tr_b16 a[106:107], v244 offset:28672
  v_mfma_f32_16x16x32_bf16 v[28:31], a[108:111], a[8:11], v[28:31]
  v_mfma_f32_16x16x32_bf16 v[44:47], a[108:111], a[12:15], v[44:47]
  s_waitcnt vmcnt(13) lgkmcnt(10)
  s_barrier
  v_mfma_f32_16x16x32_bf16 v[72:75], a[80:83], a[16:19], v[72:75]
  ds_read_b64_tr_b16 a[108:109], v245 offset:24576
  s_add_u32 m0, s38, 0
  v_mfma_f32_16x16x32_bf16 v[88:91], a[80:83], a[20:23], v[88:91]
  ds_read_b64_tr_b16 a[110:111], v245 offset:28672
  ds_read_b64_tr_b16 a[80:81], v242 offset:34816
  v_mfma_f32_16x16x32_bf16 v[76:79], a[84:87], a[16:19], v[76:79]
  buffer_load_dwordx4 v225, s[8:11], s17 offen lds
  v_mfma_f32_16x16x32_bf16 v[92:95], a[84:87], a[20:23], v[92:95]
  ds_read_b64_tr_b16 a[82:83], v242 offset:38912
  ds_read_b64_tr_b16 a[84:85], v243 offset:34816
  v_mfma_f32_16x16x32_bf16 v[80:83], a[88:91], a[16:19], v[80:83]
  buffer_load_dwordx4 v226, s[8:11], s17 offen offset:1024 lds
  v_mfma_f32_16x16x32_bf16 v[96:99], a[88:91], a[20:23], v[96:99]
  ds_read_b64_tr_b16 a[86:87], v243 offset:38912
  ds_read_b64_tr_b16 a[88:89], v244 offset:34816
  v_mfma_f32_16x16x32_bf16 v[84:87], a[92:95], a[16:19], v[84:87]
  ds_read_b64_tr_b16 a[90:91], v244 offset:38912
  v_mfma_f32_16x16x32_bf16 v[100:103], a[92:95], a[20:23], v[100:103]
  buffer_load_dwordx4 v227, s[8:11], s17 offen offset:2048 lds
  v_mfma_f32_16x16x32_bf16 v[72:75], a[112:115], a[24:27], v[72:75]
  ds_read_b64_tr_b16 a[92:93], v245 offset:34816
  ds_read_b64_tr_b16 a[94:95], v245 offset:38912
  v_mfma_f32_16x16x32_bf16 v[88:91], a[112:115], a[28:31], v[88:91]
  buffer_load_dwordx4 v228, s[8:11], s17 offen offset:3072 lds
  v_mfma_f32_16x16x32_bf16 v[76:79], a[116:119], a[24:27], v[76:79]
  ds_read_b64_tr_b16 a[112:113], v242 offset:43008
  ds_read_b64_tr_b16 a[114:115], v242 offset:47104
  v_mfma_f32_16x16x32_bf16 v[92:95], a[116:119], a[28:31], v[92:95]
  ds_read_b64_tr_b16 a[116:117], v243 offset:43008
  s_add_u32 s17, s17, 458752
  v_mfma_f32_16x16x32_bf16 v[80:83], a[120:123], a[24:27], v[80:83]
  ds_read_b64_tr_b16 a[118:119], v243 offset:47104
  v_mfma_f32_16x16x32_bf16 v[96:99], a[120:123], a[28:31], v[96:99]
  ds_read_b64_tr_b16 a[120:121], v244 offset:43008
  ds_read_b64_tr_b16 a[122:123], v244 offset:47104
  v_mfma_f32_16x16x32_bf16 v[84:87], a[124:127], a[24:27], v[84:87]
  buffer_load_dword v251, v255, s[8:11], s96 offen
  v_mfma_f32_16x16x32_bf16 v[100:103], a[124:127], a[28:31], v[100:103]
  ds_read_b64_tr_b16 a[124:125], v245 offset:43008
  ds_read_b64_tr_b16 a[126:127], v245 offset:47104
  v_mfma_f32_16x16x32_bf16 v[16:19], a[64:67], a[16:19], v[16:19]
  s_mov_b32 s96, s97
  v_mfma_f32_16x16x32_bf16 v[32:35], a[64:67], a[20:23], v[32:35]
  ds_read_b64_tr_b16 a[64:65], v242 offset:32768
  ds_read_b64_tr_b16 a[66:67], v242 offset:36864
  v_mfma_f32_16x16x32_bf16 v[20:23], a[68:71], a[16:19], v[20:23]
  v_mfma_f32_16x16x32_bf16 v[36:39], a[68:71], a[20:23], v[36:39]
  buffer_load_dwordx4 a[0:3], v240, s[4:7], s16 offen offset:0 sc1
  s_waitcnt lgkmcnt(10)
  v_mfma_f32_16x16x32_bf16 v[24:27], a[72:75], a[16:19], v[24:27]
  ds_read_b64_tr_b16 a[68:69], v243 offset:32768
  ds_read_b64_tr_b16 a[70:71], v243 offset:36864
  v_mfma_f32_16x16x32_bf16 v[40:43], a[72:75], a[20:23], v[40:43]
  buffer_load_dwordx4 a[4:7], v240, s[4:7], s16 offen offset:1024 sc1
  v_mfma_f32_16x16x32_bf16 v[28:31], a[76:79], a[16:19], v[28:31]
  ds_read_b64_tr_b16 a[72:73], v244 offset:32768
  ds_read_b64_tr_b16 a[74:75], v244 offset:36864
  v_mfma_f32_16x16x32_bf16 v[44:47], a[76:79], a[20:23], v[44:47]
  buffer_load_dwordx4 a[8:11], v241, s[4:7], s16 offen offset:0 sc1
  v_mfma_f32_16x16x32_bf16 v[16:19], a[96:99], a[24:27], v[16:19]
  ds_read_b64_tr_b16 a[76:77], v245 offset:32768
  ds_read_b64_tr_b16 a[78:79], v245 offset:36864
  v_mfma_f32_16x16x32_bf16 v[32:35], a[96:99], a[28:31], v[32:35]
  ds_read_b64_tr_b16 a[96:97], v242 offset:40960
  ds_read_b64_tr_b16 a[98:99], v242 offset:45056
  v_mfma_f32_16x16x32_bf16 v[20:23], a[100:103], a[24:27], v[20:23]
  buffer_load_dwordx4 a[12:15], v241, s[4:7], s16 offen offset:1024 sc1
  v_mfma_f32_16x16x32_bf16 v[36:39], a[100:103], a[28:31], v[36:39]
  ds_read_b64_tr_b16 a[100:101], v243 offset:40960
  ds_read_b64_tr_b16 a[102:103], v243 offset:45056
  v_mfma_f32_16x16x32_bf16 v[24:27], a[104:107], a[24:27], v[24:27]
  s_add_u32 s16, s16, 262144
  v_mfma_f32_16x16x32_bf16 v[40:43], a[104:107], a[28:31], v[40:43]
  ds_read_b64_tr_b16 a[104:105], v244 offset:40960
  ds_read_b64_tr_b16 a[106:107], v244 offset:45056
  v_mfma_f32_16x16x32_bf16 v[28:31], a[108:111], a[24:27], v[28:31]
  v_mfma_f32_16x16x32_bf16 v[44:47], a[108:111], a[28:31], v[44:47]
  s_waitcnt vmcnt(13) lgkmcnt(10)
  s_barrier
  v_mfma_f32_16x16x32_bf16 v[72:75], a[80:83], a[32:35], v[72:75]
  ds_read_b64_tr_b16 a[108:109], v245 offset:40960
  s_add_u32 m0, s38, 16384
  v_mfma_f32_16x16x32_bf16 v[88:91], a[80:83], a[36:39], v[88:91]
  ds_read_b64_tr_b16 a[110:111], v245 offset:45056
  ds_read_b64_tr_b16 a[80:81], v242 offset:51200
  v_mfma_f32_16x16x32_bf16 v[76:79], a[84:87], a[32:35], v[76:79]
  buffer_load_dwordx4 v225, s[8:11], s17 offen lds
  v_mfma_f32_16x16x32_bf16 v[92:95], a[84:87], a[36:39], v[92:95]
  ds_read_b64_tr_b16 a[82:83], v242 offset:55296
  ds_read_b64_tr_b16 a[84:85], v243 offset:51200
  v_mfma_f32_16x16x32_bf16 v[80:83], a[88:91], a[32:35], v[80:83]
  buffer_load_dwordx4 v226, s[8:11], s17 offen offset:1024 lds
  v_mfma_f32_16x16x32_bf16 v[96:99], a[88:91], a[36:39], v[96:99]
  ds_read_b64_tr_b16 a[86:87], v243 offset:55296
  ds_read_b64_tr_b16 a[88:89], v244 offset:51200
  v_mfma_f32_16x16x32_bf16 v[84:87], a[92:95], a[32:35], v[84:87]
  ds_read_b64_tr_b16 a[90:91], v244 offset:55296
  v_mfma_f32_16x16x32_bf16 v[100:103], a[92:95], a[36:39], v[100:103]
  buffer_load_dwordx4 v227, s[8:11], s17 offen offset:2048 lds
  v_mfma_f32_16x16x32_bf16 v[72:75], a[112:115], a[40:43], v[72:75]
  ds_read_b64_tr_b16 a[92:93], v245 offset:51200
  ds_read_b64_tr_b16 a[94:95], v245 offset:55296
  v_mfma_f32_16x16x32_bf16 v[88:91], a[112:115], a[44:47], v[88:91]
  buffer_load_dwordx4 v228, s[8:11], s17 offen offset:3072 lds
  v_mfma_f32_16x16x32_bf16 v[76:79], a[116:119], a[40:43], v[76:79]
  ds_read_b64_tr_b16 a[112:113], v242 offset:59392
  ds_read_b64_tr_b16 a[114:115], v242 offset:63488
  v_mfma_f32_16x16x32_bf16 v[92:95], a[116:119], a[44:47], v[92:95]
  ds_read_b64_tr_b16 a[116:117], v243 offset:59392
  s_add_u32 s17, s17, 458752
  v_mfma_f32_16x16x32_bf16 v[80:83], a[120:123], a[40:43], v[80:83]
  ds_read_b64_tr_b16 a[118:119], v243 offset:63488
  v_mfma_f32_16x16x32_bf16 v[96:99], a[120:123], a[44:47], v[96:99]
  ds_read_b64_tr_b16 a[120:121], v244 offset:59392
  ds_read_b64_tr_b16 a[122:123], v244 offset:63488
  v_mfma_f32_16x16x32_bf16 v[84:87], a[124:127], a[40:43], v[84:87]
  buffer_load_dword v251, v255, s[8:11], s96 offen
  v_mfma_f32_16x16x32_bf16 v[100:103], a[124:127], a[44:47], v[100:103]
  ds_read_b64_tr_b16 a[124:125], v245 offset:59392
  ds_read_b64_tr_b16 a[126:127], v245 offset:63488
  v_mfma_f32_16x16x32_bf16 v[16:19], a[64:67], a[32:35], v[16:19]
  s_add_u32 s96, s96, 917504
  v_mfma_f32_16x16x32_bf16 v[32:35], a[64:67], a[36:39], v[32:35]
  ds_read_b64_tr_b16 a[64:65], v242 offset:49152
  ds_read_b64_tr_b16 a[66:67], v242 offset:53248
  v_mfma_f32_16x16x32_bf16 v[20:23], a[68:71], a[32:35], v[20:23]
  v_mfma_f32_16x16x32_bf16 v[36:39], a[68:71], a[36:39], v[36:39]
  buffer_load_dwordx4 a[16:19], v240, s[4:7], s16 offen offset:0 sc1
  s_waitcnt lgkmcnt(10)
  v_mfma_f32_16x16x32_bf16 v[24:27], a[72:75], a[32:35], v[24:27]
  ds_read_b64_tr_b16 a[68:69], v243 offset:49152
  ds_read_b64_tr_b16 a[70:71], v243 offset:53248
  v_mfma_f32_16x16x32_bf16 v[40:43], a[72:75], a[36:39], v[40:43]
  buffer_load_dwordx4 a[20:23], v240, s[4:7], s16 offen offset:1024 sc1
  v_mfma_f32_16x16x32_bf16 v[28:31], a[76:79], a[32:35], v[28:31]
  ds_read_b64_tr_b16 a[72:73], v244 offset:49152
  ds_read_b64_tr_b16 a[74:75], v244 offset:53248
  v_mfma_f32_16x16x32_bf16 v[44:47], a[76:79], a[36:39], v[44:47]
  buffer_load_dwordx4 a[24:27], v241, s[4:7], s16 offen offset:0 sc1
  v_mfma_f32_16x16x32_bf16 v[16:19], a[96:99], a[40:43], v[16:19]
  ds_read_b64_tr_b16 a[76:77], v245 offset:49152
  ds_read_b64_tr_b16 a[78:79], v245 offset:53248
  v_mfma_f32_16x16x32_bf16 v[32:35], a[96:99], a[44:47], v[32:35]
  ds_read_b64_tr_b16 a[96:97], v242 offset:57344
  ds_read_b64_tr_b16 a[98:99], v242 offset:61440
  v_mfma_f32_16x16x32_bf16 v[20:23], a[100:103], a[40:43], v[20:23]
  buffer_load_dwordx4 a[28:31], v241, s[4:7], s16 offen offset:1024 sc1
  v_mfma_f32_16x16x32_bf16 v[36:39], a[100:103], a[44:47], v[36:39]
  ds_read_b64_tr_b16 a[100:101], v243 offset:57344
  ds_read_b64_tr_b16 a[102:103], v243 offset:61440
  v_mfma_f32_16x16x32_bf16 v[24:27], a[104:107], a[40:43], v[24:27]
  s_add_u32 s16, s16, 262144
  v_mfma_f32_16x16x32_bf16 v[40:43], a[104:107], a[44:47], v[40:43]
  ds_read_b64_tr_b16 a[104:105], v244 offset:57344
  ds_read_b64_tr_b16 a[106:107], v244 offset:61440
  v_mfma_f32_16x16x32_bf16 v[28:31], a[108:111], a[40:43], v[28:31]
  v_mfma_f32_16x16x32_bf16 v[44:47], a[108:111], a[44:47], v[44:47]
  s_waitcnt vmcnt(13) lgkmcnt(10)
  s_barrier
  v_mfma_f32_16x16x32_bf16 v[72:75], a[80:83], a[48:51], v[72:75]
  ds_read_b64_tr_b16 a[108:109], v245 offset:57344
  s_add_u32 m0, s38, 32768
  v_mfma_f32_16x16x32_bf16 v[88:91], a[80:83], a[52:55], v[88:91]
  ds_read_b64_tr_b16 a[110:111], v245 offset:61440
  ds_read_b64_tr_b16 a[80:81], v242 offset:2048
  v_mfma_f32_16x16x32_bf16 v[76:79], a[84:87], a[48:51], v[76:79]
  buffer_load_dwordx4 v225, s[8:11], s17 offen lds
  v_mfma_f32_16x16x32_bf16 v[92:95], a[84:87], a[52:55], v[92:95]
  ds_read_b64_tr_b16 a[82:83], v242 offset:6144
  ds_read_b64_tr_b16 a[84:85], v243 offset:2048
  v_mfma_f32_16x16x32_bf16 v[80:83], a[88:91], a[48:51], v[80:83]
  buffer_load_dwordx4 v226, s[8:11], s17 offen offset:1024 lds
  v_mfma_f32_16x16x32_bf16 v[96:99], a[88:91], a[52:55], v[96:99]
  ds_read_b64_tr_b16 a[86:87], v243 offset:6144
  ds_read_b64_tr_b16 a[88:89], v244 offset:2048
  v_mfma_f32_16x16x32_bf16 v[84:87], a[92:95], a[48:51], v[84:87]
  ds_read_b64_tr_b16 a[90:91], v244 offset:6144
  v_mfma_f32_16x16x32_bf16 v[100:103], a[92:95], a[52:55], v[100:103]
  buffer_load_dwordx4 v227, s[8:11], s17 offen offset:2048 lds
  v_mfma_f32_16x16x32_bf16 v[72:75], a[112:115], a[56:59], v[72:75]
  ds_read_b64_tr_b16 a[92:93], v245 offset:2048
  ds_read_b64_tr_b16 a[94:95], v245 offset:6144
  v_mfma_f32_16x16x32_bf16 v[88:91], a[112:115], a[60:63], v[88:91]
  buffer_load_dwordx4 v228, s[8:11], s17 offen offset:3072 lds
  v_mfma_f32_16x16x32_bf16 v[76:79], a[116:119], a[56:59], v[76:79]
  ds_read_b64_tr_b16 a[112:113], v242 offset:10240
  ds_read_b64_tr_b16 a[114:115], v242 offset:14336
  v_mfma_f32_16x16x32_bf16 v[92:95], a[116:119], a[60:63], v[92:95]
  ds_read_b64_tr_b16 a[116:117], v243 offset:10240
  s_add_u32 s17, s17, 458752
  v_mfma_f32_16x16x32_bf16 v[80:83], a[120:123], a[56:59], v[80:83]
  ds_read_b64_tr_b16 a[118:119], v243 offset:14336
  v_mfma_f32_16x16x32_bf16 v[96:99], a[120:123], a[60:63], v[96:99]
  ds_read_b64_tr_b16 a[120:121], v244 offset:10240
  ds_read_b64_tr_b16 a[122:123], v244 offset:14336
  v_mfma_f32_16x16x32_bf16 v[84:87], a[124:127], a[56:59], v[84:87]
  buffer_load_dword v251, v255, s[8:11], s96 offen
  v_mfma_f32_16x16x32_bf16 v[100:103], a[124:127], a[60:63], v[100:103]
  ds_read_b64_tr_b16 a[124:125], v245 offset:10240
  ds_read_b64_tr_b16 a[126:127], v245 offset:14336
  v_mfma_f32_16x16x32_bf16 v[16:19], a[64:67], a[48:51], v[16:19]
  s_add_u32 s96, s96, 917504
  v_mfma_f32_16x16x32_bf16 v[32:35], a[64:67], a[52:55], v[32:35]
  ds_read_b64_tr_b16 a[64:65], v242 offset:0
  ds_read_b64_tr_b16 a[66:67], v242 offset:4096
  v_mfma_f32_16x16x32_bf16 v[20:23], a[68:71], a[48:51], v[20:23]
  v_mfma_f32_16x16x32_bf16 v[36:39], a[68:71], a[52:55], v[36:39]
  buffer_load_dwordx4 a[32:35], v240, s[4:7], s16 offen offset:0 sc1
  s_waitcnt lgkmcnt(10)
  v_mfma_f32_16x16x32_bf16 v[24:27], a[72:75], a[48:51], v[24:27]
  ds_read_b64_tr_b16 a[68:69], v243 offset:0
  ds_read_b64_tr_b16 a[70:71], v243 offset:4096
  v_mfma_f32_16x16x32_bf16 v[40:43], a[72:75], a[52:55], v[40:43]
  buffer_load_dwordx4 a[36:39], v240, s[4:7], s16 offen offset:1024 sc1
  v_mfma_f32_16x16x32_bf16 v[28:31], a[76:79], a[48:51], v[28:31]
  ds_read_b64_tr_b16 a[72:73], v244 offset:0
  ds_read_b64_tr_b16 a[74:75], v244 offset:4096
  v_mfma_f32_16x16x32_bf16 v[44:47], a[76:79], a[52:55], v[44:47]
  buffer_load_dwordx4 a[40:43], v241, s[4:7], s16 offen offset:0 sc1
  v_mfma_f32_16x16x32_bf16 v[16:19], a[96:99], a[56:59], v[16:19]
  ds_read_b64_tr_b16 a[76:77], v245 offset:0
  ds_read_b64_tr_b16 a[78:79], v245 offset:4096
  v_mfma_f32_16x16x32_bf16 v[32:35], a[96:99], a[60:63], v[32:35]
  ds_read_b64_tr_b16 a[96:97], v242 offset:8192
  ds_read_b64_tr_b16 a[98:99], v242 offset:12288
  v_mfma_f32_16x16x32_bf16 v[20:23], a[100:103], a[56:59], v[20:23]
  buffer_load_dwordx4 a[44:47], v241, s[4:7], s16 offen offset:1024 sc1
  v_mfma_f32_16x16x32_bf16 v[36:39], a[100:103], a[60:63], v[36:39]
  ds_read_b64_tr_b16 a[100:101], v243 offset:8192
  ds_read_b64_tr_b16 a[102:103], v243 offset:12288
  v_mfma_f32_16x16x32_bf16 v[24:27], a[104:107], a[56:59], v[24:27]
  s_add_u32 s16, s16, 262144
  v_mfma_f32_16x16x32_bf16 v[40:43], a[104:107], a[60:63], v[40:43]
  ds_read_b64_tr_b16 a[104:105], v244 offset:8192
  ds_read_b64_tr_b16 a[106:107], v244 offset:12288
  v_mfma_f32_16x16x32_bf16 v[28:31], a[108:111], a[56:59], v[28:31]
  v_mfma_f32_16x16x32_bf16 v[44:47], a[108:111], a[60:63], v[44:47]
  s_waitcnt vmcnt(13) lgkmcnt(10)
  s_barrier
  v_mfma_f32_16x16x32_bf16 v[72:75], a[80:83], a[0:3], v[72:75]
  ds_read_b64_tr_b16 a[108:109], v245 offset:8192
  s_add_u32 m0, s38, 49152
  v_mfma_f32_16x16x32_bf16 v[88:91], a[80:83], a[4:7], v[88:91]
  ds_read_b64_tr_b16 a[110:111], v245 offset:12288
  ds_read_b64_tr_b16 a[80:81], v242 offset:18432
  v_mfma_f32_16x16x32_bf16 v[76:79], a[84:87], a[0:3], v[76:79]
  buffer_load_dwordx4 v225, s[8:11], s17 offen lds
  v_mfma_f32_16x16x32_bf16 v[92:95], a[84:87], a[4:7], v[92:95]
  ds_read_b64_tr_b16 a[82:83], v242 offset:22528
  ds_read_b64_tr_b16 a[84:85], v243 offset:18432
  v_mfma_f32_16x16x32_bf16 v[80:83], a[88:91], a[0:3], v[80:83]
  buffer_load_dwordx4 v226, s[8:11], s17 offen offset:1024 lds
  v_mfma_f32_16x16x32_bf16 v[96:99], a[88:91], a[4:7], v[96:99]
  ds_read_b64_tr_b16 a[86:87], v243 offset:22528
  ds_read_b64_tr_b16 a[88:89], v244 offset:18432
  v_mfma_f32_16x16x32_bf16 v[84:87], a[92:95], a[0:3], v[84:87]
  ds_read_b64_tr_b16 a[90:91], v244 offset:22528
  v_mfma_f32_16x16x32_bf16 v[100:103], a[92:95], a[4:7], v[100:103]
  buffer_load_dwordx4 v227, s[8:11], s17 offen offset:2048 lds
  v_mfma_f32_16x16x32_bf16 v[72:75], a[112:115], a[8:11], v[72:75]
  ds_read_b64_tr_b16 a[92:93], v245 offset:18432
  ds_read_b64_tr_b16 a[94:95], v245 offset:22528
  v_mfma_f32_16x16x32_bf16 v[88:91], a[112:115], a[12:15], v[88:91]
  buffer_load_dwordx4 v228, s[8:11], s17 offen offset:3072 lds
  v_mfma_f32_16x16x32_bf16 v[76:79], a[116:119], a[8:11], v[76:79]
  ds_read_b64_tr_b16 a[112:113], v242 offset:26624
  ds_read_b64_tr_b16 a[114:115], v242 offset:30720
  v_mfma_f32_16x16x32_bf16 v[92:95], a[116:119], a[12:15], v[92:95]
  ds_read_b64_tr_b16 a[116:117], v243 offset:26624
  s_mov_b32 s17, s97
  v_mfma_f32_16x16x32_bf16 v[80:83], a[120:123], a[8:11], v[80:83]
  ds_read_b64_tr_b16 a[118:119], v243 offset:30720
  v_mfma_f32_16x16x32_bf16 v[96:99], a[120:123], a[12:15], v[96:99]
  ds_read_b64_tr_b16 a[120:121], v244 offset:26624
  ds_read_b64_tr_b16 a[122:123], v244 offset:30720
  v_mfma_f32_16x16x32_bf16 v[84:87], a[124:127], a[8:11], v[84:87]
  buffer_load_dword v251, v255, s[8:11], s96 offen
  v_mfma_f32_16x16x32_bf16 v[100:103], a[124:127], a[12:15], v[100:103]
  ds_read_b64_tr_b16 a[124:125], v245 offset:26624
  ds_read_b64_tr_b16 a[126:127], v245 offset:30720
  v_mfma_f32_16x16x32_bf16 v[16:19], a[64:67], a[0:3], v[16:19]
  s_add_u32 s96, s96, 917504
  v_mfma_f32_16x16x32_bf16 v[32:35], a[64:67], a[4:7], v[32:35]
  ds_read_b64_tr_b16 a[64:65], v242 offset:16384
  ds_read_b64_tr_b16 a[66:67], v242 offset:20480
  v_mfma_f32_16x16x32_bf16 v[20:23], a[68:71], a[0:3], v[20:23]
  v_mfma_f32_16x16x32_bf16 v[36:39], a[68:71], a[4:7], v[36:39]
  buffer_load_dwordx4 a[48:51], v240, s[4:7], s16 offen offset:0 sc1
  s_waitcnt lgkmcnt(10)
  v_mfma_f32_16x16x32_bf16 v[24:27], a[72:75], a[0:3], v[24:27]
  ds_read_b64_tr_b16 a[68:69], v243 offset:16384
  ds_read_b64_tr_b16 a[70:71], v243 offset:20480
  v_mfma_f32_16x16x32_bf16 v[40:43], a[72:75], a[4:7], v[40:43]
  buffer_load_dwordx4 a[52:55], v240, s[4:7], s16 offen offset:1024 sc1
  v_mfma_f32_16x16x32_bf16 v[28:31], a[76:79], a[0:3], v[28:31]
  ds_read_b64_tr_b16 a[72:73], v244 offset:16384
  ds_read_b64_tr_b16 a[74:75], v244 offset:20480
  v_mfma_f32_16x16x32_bf16 v[44:47], a[76:79], a[4:7], v[44:47]
  buffer_load_dwordx4 a[56:59], v241, s[4:7], s16 offen offset:0 sc1
  v_mfma_f32_16x16x32_bf16 v[16:19], a[96:99], a[8:11], v[16:19]
  ds_read_b64_tr_b16 a[76:77], v245 offset:16384
  ds_read_b64_tr_b16 a[78:79], v245 offset:20480
  v_mfma_f32_16x16x32_bf16 v[32:35], a[96:99], a[12:15], v[32:35]
  ds_read_b64_tr_b16 a[96:97], v242 offset:24576
  ds_read_b64_tr_b16 a[98:99], v242 offset:28672
  v_mfma_f32_16x16x32_bf16 v[20:23], a[100:103], a[8:11], v[20:23]
  buffer_load_dwordx4 a[60:63], v241, s[4:7], s16 offen offset:1024 sc1
  v_mfma_f32_16x16x32_bf16 v[36:39], a[100:103], a[12:15], v[36:39]
  ds_read_b64_tr_b16 a[100:101], v243 offset:24576
  ds_read_b64_tr_b16 a[102:103], v243 offset:28672
  v_mfma_f32_16x16x32_bf16 v[24:27], a[104:107], a[8:11], v[24:27]
  s_add_u32 s16, s16, 262144
  v_mfma_f32_16x16x32_bf16 v[40:43], a[104:107], a[12:15], v[40:43]
  ds_read_b64_tr_b16 a[104:105], v244 offset:24576
  ds_read_b64_tr_b16 a[106:107], v244 offset:28672
  v_mfma_f32_16x16x32_bf16 v[28:31], a[108:111], a[8:11], v[28:31]
  v_mfma_f32_16x16x32_bf16 v[44:47], a[108:111], a[12:15], v[44:47]
  s_waitcnt vmcnt(13) lgkmcnt(10)
  s_barrier
  v_mfma_f32_16x16x32_bf16 v[72:75], a[80:83], a[16:19], v[72:75]
  ds_read_b64_tr_b16 a[108:109], v245 offset:24576
  s_add_u32 m0, s38, 0
  v_mfma_f32_16x16x32_bf16 v[88:91], a[80:83], a[20:23], v[88:91]
  buffer_load_dwordx4 v227, s[8:11], s17 offen offset:2048 lds
  v_mfma_f32_16x16x32_bf16 v[76:79], a[84:87], a[16:19], v[76:79]
  ds_read_b64_tr_b16 a[110:111], v245 offset:28672
  ds_read_b64_tr_b16 a[80:81], v242 offset:34816
  v_mfma_f32_16x16x32_bf16 v[92:95], a[84:87], a[20:23], v[92:95]
  buffer_load_dwordx4 v228, s[8:11], s17 offen offset:3072 lds
  v_mfma_f32_16x16x32_bf16 v[80:83], a[88:91], a[16:19], v[80:83]
  ds_read_b64_tr_b16 a[82:83], v242 offset:38912
  ds_read_b64_tr_b16 a[84:85], v243 offset:34816
  v_mfma_f32_16x16x32_bf16 v[96:99], a[88:91], a[20:23], v[96:99]
  ds_read_b64_tr_b16 a[86:87], v243 offset:38912
  s_add_u32 s17, s17, 917504
  v_mfma_f32_16x16x32_bf16 v[84:87], a[92:95], a[16:19], v[84:87]
  ds_read_b64_tr_b16 a[88:89], v244 offset:34816
  s_add_u32 m0, s38, -2048
  v_mfma_f32_16x16x32_bf16 v[100:103], a[92:95], a[20:23], v[100:103]
  ds_read_b64_tr_b16 a[90:91], v244 offset:38912
  ds_read_b64_tr_b16 a[92:93], v245 offset:34816
  v_mfma_f32_16x16x32_bf16 v[72:75], a[112:115], a[24:27], v[72:75]
  buffer_load_dwordx4 v227, s[8:11], s17 offen offset:2048 lds
  v_mfma_f32_16x16x32_bf16 v[88:91], a[112:115], a[28:31], v[88:91]
  ds_read_b64_tr_b16 a[94:95], v245 offset:38912
  ds_read_b64_tr_b16 a[112:113], v242 offset:43008
  v_mfma_f32_16x16x32_bf16 v[76:79], a[116:119], a[24:27], v[76:79]
  buffer_load_dwordx4 v228, s[8:11], s17 offen offset:3072 lds
  v_mfma_f32_16x16x32_bf16 v[92:95], a[116:119], a[28:31], v[92:95]
  ds_read_b64_tr_b16 a[114:115], v242 offset:47104
  ds_read_b64_tr_b16 a[116:117], v243 offset:43008
  v_mfma_f32_16x16x32_bf16 v[80:83], a[120:123], a[24:27], v[80:83]
  ds_read_b64_tr_b16 a[118:119], v243 offset:47104
  s_add_u32 s17, s17, 917504
  v_mfma_f32_16x16x32_bf16 v[96:99], a[120:123], a[28:31], v[96:99]
  buffer_load_dwordx4 v[128:131], v240, s[4:7], s16 offen offset:0 sc1
  v_mfma_f32_16x16x32_bf16 v[84:87], a[124:127], a[24:27], v[84:87]
  ds_read_b64_tr_b16 a[120:121], v244 offset:43008
  ds_read_b64_tr_b16 a[122:123], v244 offset:47104
  v_mfma_f32_16x16x32_bf16 v[100:103], a[124:127], a[28:31], v[100:103]
  buffer_load_dwordx4 v[132:135], v240, s[4:7], s16 offen offset:1024 sc1
  v_mfma_f32_16x16x32_bf16 v[16:19], a[64:67], a[16:19], v[16:19]
  ds_read_b64_tr_b16 a[124:125], v245 offset:43008
  ds_read_b64_tr_b16 a[126:127], v245 offset:47104
  v_mfma_f32_16x16x32_bf16 v[32:35], a[64:67], a[20:23], v[32:35]
  buffer_load_dwordx4 v[136:139], v241, s[4:7], s16 offen offset:0 sc1
  v_mfma_f32_16x16x32_bf16 v[20:23], a[68:71], a[16:19], v[20:23]
  buffer_load_dwordx4 v[140:143], v241, s[4:7], s16 offen offset:1024 sc1
  v_mfma_f32_16x16x32_bf16 v[36:39], a[68:71], a[20:23], v[36:39]
  ds_read_b64_tr_b16 a[64:65], v242 offset:32768
  ds_read_b64_tr_b16 a[66:67], v242 offset:36864
  s_waitcnt lgkmcnt(10)
  v_mfma_f32_16x16x32_bf16 v[24:27], a[72:75], a[16:19], v[24:27]
  ds_read_b64_tr_b16 a[68:69], v243 offset:32768
  s_add_u32 s16, s16, 262144
  v_mfma_f32_16x16x32_bf16 v[40:43], a[72:75], a[20:23], v[40:43]
  ds_read_b64_tr_b16 a[70:71], v243 offset:36864
  ds_read_b64_tr_b16 a[72:73], v244 offset:32768
  v_mfma_f32_16x16x32_bf16 v[28:31], a[76:79], a[16:19], v[28:31]
  buffer_load_dwordx4 v[144:147], v240, s[4:7], s16 offen offset:0 sc1
  v_mfma_f32_16x16x32_bf16 v[44:47], a[76:79], a[20:23], v[44:47]
  ds_read_b64_tr_b16 a[74:75], v244 offset:36864
  ds_read_b64_tr_b16 a[76:77], v245 offset:32768
  v_mfma_f32_16x16x32_bf16 v[16:19], a[96:99], a[24:27], v[16:19]
  buffer_load_dwordx4 v[148:151], v240, s[4:7], s16 offen offset:1024 sc1
  v_mfma_f32_16x16x32_bf16 v[32:35], a[96:99], a[28:31], v[32:35]
  buffer_load_dwordx4 v[152:155], v241, s[4:7], s16 offen offset:0 sc1
  v_mfma_f32_16x16x32_bf16 v[20:23], a[100:103], a[24:27], v[20:23]
  ds_read_b64_tr_b16 a[78:79], v245 offset:36864
  ds_read_b64_tr_b16 a[96:97], v242 offset:40960
  v_mfma_f32_16x16x32_bf16 v[36:39], a[100:103], a[28:31], v[36:39]
  buffer_load_dwordx4 v[156:159], v241, s[4:7], s16 offen offset:1024 sc1
  v_mfma_f32_16x16x32_bf16 v[24:27], a[104:107], a[24:27], v[24:27]
  ds_read_b64_tr_b16 a[98:99], v242 offset:45056
  ds_read_b64_tr_b16 a[100:101], v243 offset:40960
  v_mfma_f32_16x16x32_bf16 v[40:43], a[104:107], a[28:31], v[40:43]
  ds_read_b64_tr_b16 a[102:103], v243 offset:45056
  s_add_u32 s16, s16, 262144
  v_mfma_f32_16x16x32_bf16 v[28:31], a[108:111], a[24:27], v[28:31]
  ds_read_b64_tr_b16 a[104:105], v244 offset:40960
  ds_read_b64_tr_b16 a[106:107], v244 offset:45056
  v_mfma_f32_16x16x32_bf16 v[44:47], a[108:111], a[28:31], v[44:47]
  s_waitcnt vmcnt(16) lgkmcnt(10)
  s_barrier
  v_mfma_f32_16x16x32_bf16 v[72:75], a[80:83], a[32:35], v[72:75]
  ds_read_b64_tr_b16 a[108:109], v245 offset:40960
  s_add_u32 m0, s38, 16384
  v_mfma_f32_16x16x32_bf16 v[88:91], a[80:83], a[36:39], v[88:91]
  buffer_load_dwordx4 v227, s[8:11], s17 offen offset:2048 lds
  v_mfma_f32_16x16x32_bf16 v[76:79], a[84:87], a[32:35], v[76:79]
  ds_read_b64_tr_b16 a[110:111], v245 offset:45056
  ds_read_b64_tr_b16 a[80:81], v242 offset:51200
  v_mfma_f32_16x16x32_bf16 v[92:95], a[84:87], a[36:39], v[92:95]
  buffer_load_dwordx4 v228, s[8:11], s17 offen offset:3072 lds
  v_mfma_f32_16x16x32_bf16 v[80:83], a[88:91], a[32:35], v[80:83]
  ds_read_b64_tr_b16 a[82:83], v242 offset:55296
  ds_read_b64_tr_b16 a[84:85], v243 offset:51200
  v_mfma_f32_16x16x32_bf16 v[96:99], a[88:91], a[36:39], v[96:99]
  ds_read_b64_tr_b16 a[86:87], v243 offset:55296
  s_add_u32 s17, s17, 917504
  v_mfma_f32_16x16x32_bf16 v[84:87], a[92:95], a[32:35], v[84:87]
  ds_read_b64_tr_b16 a[88:89], v244 offset:51200
  s_add_u32 m0, s38, 14336
  v_mfma_f32_16x16x32_bf16 v[100:103], a[92:95], a[36:39], v[100:103]
  ds_read_b64_tr_b16 a[90:91], v244 offset:55296
  ds_read_b64_tr_b16 a[92:93], v245 offset:51200
  v_mfma_f32_16x16x32_bf16 v[72:75], a[112:115], a[40:43], v[72:75]
  buffer_load_dwordx4 v227, s[8:11], s17 offen offset:2048 lds
  v_mfma_f32_16x16x32_bf16 v[88:91], a[112:115], a[44:47], v[88:91]
  ds_read_b64_tr_b16 a[94:95], v245 offset:55296
  ds_read_b64_tr_b16 a[112:113], v242 offset:59392
  v_mfma_f32_16x16x32_bf16 v[76:79], a[116:119], a[40:43], v[76:79]
  buffer_load_dwordx4 v228, s[8:11], s17 offen offset:3072 lds
  v_mfma_f32_16x16x32_bf16 v[92:95], a[116:119], a[44:47], v[92:95]
  ds_read_b64_tr_b16 a[114:115], v242 offset:63488
  ds_read_b64_tr_b16 a[116:117], v243 offset:59392
  v_mfma_f32_16x16x32_bf16 v[80:83], a[120:123], a[40:43], v[80:83]
  ds_read_b64_tr_b16 a[118:119], v243 offset:63488
  s_mov_b32 s17, s97
  v_mfma_f32_16x16x32_bf16 v[96:99], a[120:123], a[44:47], v[96:99]
  buffer_load_dwordx4 v[160:163], v240, s[4:7], s16 offen offset:0 sc1
  v_mfma_f32_16x16x32_bf16 v[84:87], a[124:127], a[40:43], v[84:87]
  ds_read_b64_tr_b16 a[120:121], v244 offset:59392
  ds_read_b64_tr_b16 a[122:123], v244 offset:63488
  v_mfma_f32_16x16x32_bf16 v[100:103], a[124:127], a[44:47], v[100:103]
  buffer_load_dwordx4 v[164:167], v240, s[4:7], s16 offen offset:1024 sc1
  v_mfma_f32_16x16x32_bf16 v[16:19], a[64:67], a[32:35], v[16:19]
  ds_read_b64_tr_b16 a[124:125], v245 offset:59392
  ds_read_b64_tr_b16 a[126:127], v245 offset:63488
  v_mfma_f32_16x16x32_bf16 v[32:35], a[64:67], a[36:39], v[32:35]
  buffer_load_dwordx4 v[168:171], v241, s[4:7], s16 offen offset:0 sc1
  v_mfma_f32_16x16x32_bf16 v[20:23], a[68:71], a[32:35], v[20:23]
  buffer_load_dwordx4 v[172:175], v241, s[4:7], s16 offen offset:1024 sc1
  v_mfma_f32_16x16x32_bf16 v[36:39], a[68:71], a[36:39], v[36:39]
  ds_read_b64_tr_b16 a[64:65], v242 offset:49152
  ds_read_b64_tr_b16 a[66:67], v242 offset:53248
  s_waitcnt lgkmcnt(10)
  v_mfma_f32_16x16x32_bf16 v[24:27], a[72:75], a[32:35], v[24:27]
  ds_read_b64_tr_b16 a[68:69], v243 offset:49152
  s_add_u32 s16, s16, 262144
  v_mfma_f32_16x16x32_bf16 v[40:43], a[72:75], a[36:39], v[40:43]
  ds_read_b64_tr_b16 a[70:71], v243 offset:53248
  ds_read_b64_tr_b16 a[72:73], v244 offset:49152
  v_mfma_f32_16x16x32_bf16 v[28:31], a[76:79], a[32:35], v[28:31]
  buffer_load_dwordx4 v[176:179], v240, s[4:7], s16 offen offset:0 sc1
  v_mfma_f32_16x16x32_bf16 v[44:47], a[76:79], a[36:39], v[44:47]
  ds_read_b64_tr_b16 a[74:75], v244 offset:53248
  ds_read_b64_tr_b16 a[76:77], v245 offset:49152
  v_mfma_f32_16x16x32_bf16 v[16:19], a[96:99], a[40:43], v[16:19]
  buffer_load_dwordx4 v[180:183], v240, s[4:7], s16 offen offset:1024 sc1
  v_mfma_f32_16x16x32_bf16 v[32:35], a[96:99], a[44:47], v[32:35]
  buffer_load_dwordx4 v[184:187], v241, s[4:7], s16 offen offset:0 sc1
  v_mfma_f32_16x16x32_bf16 v[20:23], a[100:103], a[40:43], v[20:23]
  ds_read_b64_tr_b16 a[78:79], v245 offset:53248
  ds_read_b64_tr_b16 a[96:97], v242 offset:57344
  v_mfma_f32_16x16x32_bf16 v[36:39], a[100:103], a[44:47], v[36:39]
  buffer_load_dwordx4 v[188:191], v241, s[4:7], s16 offen offset:1024 sc1
  v_mfma_f32_16x16x32_bf16 v[24:27], a[104:107], a[40:43], v[24:27]
  ds_read_b64_tr_b16 a[98:99], v242 offset:61440
  ds_read_b64_tr_b16 a[100:101], v243 offset:57344
  v_mfma_f32_16x16x32_bf16 v[40:43], a[104:107], a[44:47], v[40:43]
  ds_read_b64_tr_b16 a[102:103], v243 offset:61440
  s_add_u32 s16, s16, 262144
  v_mfma_f32_16x16x32_bf16 v[28:31], a[108:111], a[40:43], v[28:31]
  ds_read_b64_tr_b16 a[104:105], v244 offset:57344
  ds_read_b64_tr_b16 a[106:107], v244 offset:61440
  v_mfma_f32_16x16x32_bf16 v[44:47], a[108:111], a[44:47], v[44:47]
  s_waitcnt vmcnt(20) lgkmcnt(10)
  s_barrier
  v_mfma_f32_16x16x32_bf16 v[72:75], a[80:83], a[48:51], v[72:75]
  ds_read_b64_tr_b16 a[108:109], v245 offset:57344
  s_add_u32 m0, s38, 34816
  v_mfma_f32_16x16x32_bf16 v[88:91], a[80:83], a[52:55], v[88:91]
  ds_read_b64_tr_b16 a[110:111], v245 offset:61440
  ds_read_b64_tr_b16 a[80:81], v242 offset:2048
  v_mfma_f32_16x16x32_bf16 v[76:79], a[84:87], a[48:51], v[76:79]
  ds_read_b64_tr_b16 a[82:83], v242 offset:6144
  v_mfma_f32_16x16x32_bf16 v[92:95], a[84:87], a[52:55], v[92:95]
  buffer_load_dwordx4 v225, s[8:11], s17 offen offset:0 lds
  v_mfma_f32_16x16x32_bf16 v[80:83], a[88:91], a[48:51], v[80:83]
  ds_read_b64_tr_b16 a[84:85], v243 offset:2048
  ds_read_b64_tr_b16 a[86:87], v243 offset:6144
  v_mfma_f32_16x16x32_bf16 v[96:99], a[88:91], a[52:55], v[96:99]
  ds_read_b64_tr_b16 a[88:89], v244 offset:2048
  ds_read_b64_tr_b16 a[90:91], v244 offset:6144
  v_mfma_f32_16x16x32_bf16 v[84:87], a[92:95], a[48:51], v[84:87]
  v_mfma_f32_16x16x32_bf16 v[100:103], a[92:95], a[52:55], v[100:103]
  buffer_load_dwordx4 v226, s[8:11], s17 offen offset:1024 lds
  v_mfma_f32_16x16x32_bf16 v[72:75], a[112:115], a[56:59], v[72:75]
  ds_read_b64_tr_b16 a[92:93], v245 offset:2048
  ds_read_b64_tr_b16 a[94:95], v245 offset:6144
  v_mfma_f32_16x16x32_bf16 v[88:91], a[112:115], a[60:63], v[88:91]
  ds_read_b64_tr_b16 a[112:113], v242 offset:10240
  ds_read_b64_tr_b16 a[114:115], v242 offset:14336
  v_mfma_f32_16x16x32_bf16 v[76:79], a[116:119], a[56:59], v[76:79]
  v_mfma_f32_16x16x32_bf16 v[92:95], a[116:119], a[60:63], v[92:95]
  ds_read_b64_tr_b16 a[116:117], v243 offset:10240
  s_add_u32 s17, s17, 917504
  v_mfma_f32_16x16x32_bf16 v[80:83], a[120:123], a[56:59], v[80:83]
  ds_read_b64_tr_b16 a[118:119], v243 offset:14336
  v_mfma_f32_16x16x32_bf16 v[96:99], a[120:123], a[60:63], v[96:99]
  ds_read_b64_tr_b16 a[120:121], v244 offset:10240
  ds_read_b64_tr_b16 a[122:123], v244 offset:14336
  v_mfma_f32_16x16x32_bf16 v[84:87], a[124:127], a[56:59], v[84:87]
  v_mfma_f32_16x16x32_bf16 v[100:103], a[124:127], a[60:63], v[100:103]
  ds_read_b64_tr_b16 a[124:125], v245 offset:10240
  s_add_u32 m0, s38, 32768
  v_mfma_f32_16x16x32_bf16 v[16:19], a[64:67], a[48:51], v[16:19]
  ds_read_b64_tr_b16 a[126:127], v245 offset:14336
  v_mfma_f32_16x16x32_bf16 v[32:35], a[64:67], a[52:55], v[32:35]
  ds_read_b64_tr_b16 a[64:65], v242 offset:0
  ds_read_b64_tr_b16 a[66:67], v242 offset:4096
  v_mfma_f32_16x16x32_bf16 v[20:23], a[68:71], a[48:51], v[20:23]
  v_mfma_f32_16x16x32_bf16 v[36:39], a[68:71], a[52:55], v[36:39]
  buffer_load_dwordx4 v225, s[8:11], s17 offen offset:0 lds
  s_waitcnt lgkmcnt(10)
  v_mfma_f32_16x16x32_bf16 v[24:27], a[72:75], a[48:51], v[24:27]
  ds_read_b64_tr_b16 a[68:69], v243 offset:0
  ds_read_b64_tr_b16 a[70:71], v243 offset:4096
  v_mfma_f32_16x16x32_bf16 v[40:43], a[72:75], a[52:55], v[40:43]
  ds_read_b64_tr_b16 a[72:73], v244 offset:0
  ds_read_b64_tr_b16 a[74:75], v244 offset:4096
  v_mfma_f32_16x16x32_bf16 v[28:31], a[76:79], a[48:51], v[28:31]
  v_mfma_f32_16x16x32_bf16 v[44:47], a[76:79], a[52:55], v[44:47]
  buffer_load_dwordx4 v226, s[8:11], s17 offen offset:1024 lds
  v_mfma_f32_16x16x32_bf16 v[16:19], a[96:99], a[56:59], v[16:19]
  ds_read_b64_tr_b16 a[76:77], v245 offset:0
  ds_read_b64_tr_b16 a[78:79], v245 offset:4096
  v_mfma_f32_16x16x32_bf16 v[32:35], a[96:99], a[60:63], v[32:35]
  ds_read_b64_tr_b16 a[96:97], v242 offset:8192
  ds_read_b64_tr_b16 a[98:99], v242 offset:12288
  v_mfma_f32_16x16x32_bf16 v[20:23], a[100:103], a[56:59], v[20:23]
  v_mfma_f32_16x16x32_bf16 v[36:39], a[100:103], a[60:63], v[36:39]
  ds_read_b64_tr_b16 a[100:101], v243 offset:8192
  s_add_u32 s17, s17, 917504
  v_mfma_f32_16x16x32_bf16 v[24:27], a[104:107], a[56:59], v[24:27]
  ds_read_b64_tr_b16 a[102:103], v243 offset:12288
  v_mfma_f32_16x16x32_bf16 v[40:43], a[104:107], a[60:63], v[40:43]
  ds_read_b64_tr_b16 a[104:105], v244 offset:8192
  ds_read_b64_tr_b16 a[106:107], v244 offset:12288
  v_mfma_f32_16x16x32_bf16 v[28:31], a[108:111], a[56:59], v[28:31]
  v_mfma_f32_16x16x32_bf16 v[44:47], a[108:111], a[60:63], v[44:47]
  s_waitcnt vmcnt(12) lgkmcnt(10)
  s_barrier
  v_swap_b32 v130, v132
  v_swap_b32 v131, v133
  v_swap_b32 v138, v140
  v_swap_b32 v139, v141
  v_swap_b32 v146, v148
  v_swap_b32 v147, v149
  v_swap_b32 v154, v156
  v_swap_b32 v155, v157
  s_nop 1
  v_mfma_f32_16x16x32_bf16 v[72:75], a[80:83], v[128:131], v[72:75]
  ds_read_b64_tr_b16 a[108:109], v245 offset:8192
  s_add_u32 m0, s38, 51200
  v_mfma_f32_16x16x32_bf16 v[88:91], a[80:83], v[132:135], v[88:91]
  ds_read_b64_tr_b16 a[110:111], v245 offset:12288
  ds_read_b64_tr_b16 a[80:81], v242 offset:18432
  v_mfma_f32_16x16x32_bf16 v[76:79], a[84:87], v[128:131], v[76:79]
  ds_read_b64_tr_b16 a[82:83], v242 offset:22528
  v_mfma_f32_16x16x32_bf16 v[92:95], a[84:87], v[132:135], v[92:95]
  buffer_load_dwordx4 v225, s[8:11], s17 offen offset:0 lds
  v_mfma_f32_16x16x32_bf16 v[80:83], a[88:91], v[128:131], v[80:83]
  ds_read_b64_tr_b16 a[84:85], v243 offset:18432
  ds_read_b64_tr_b16 a[86:87], v243 offset:22528
  v_mfma_f32_16x16x32_bf16 v[96:99], a[88:91], v[132:135], v[96:99]
  ds_read_b64_tr_b16 a[88:89], v244 offset:18432
  ds_read_b64_tr_b16 a[90:91], v244 offset:22528
  v_mfma_f32_16x16x32_bf16 v[84:87], a[92:95], v[128:131], v[84:87]
  buffer_load_dwordx4 v226, s[8:11], s17 offen offset:1024 lds
  v_mfma_f32_16x16x32_bf16 v[100:103], a[92:95], v[132:135], v[100:103]
  ds_read_b64_tr_b16 a[92:93], v245 offset:18432
  ds_read_b64_tr_b16 a[94:95], v245 offset:22528
  v_mfma_f32_16x16x32_bf16 v[72:75], a[112:115], v[136:139], v[72:75]
  v_mfma_f32_16x16x32_bf16 v[88:91], a[112:115], v[140:143], v[88:91]
  ds_read_b64_tr_b16 a[112:113], v242 offset:26624
  ds_read_b64_tr_b16 a[114:115], v242 offset:30720
  v_mfma_f32_16x16x32_bf16 v[76:79], a[116:119], v[136:139], v[76:79]
  s_add_u32 s17, s17, 917504
  v_mfma_f32_16x16x32_bf16 v[92:95], a[116:119], v[140:143], v[92:95]
  ds_read_b64_tr_b16 a[116:117], v243 offset:26624
  ds_read_b64_tr_b16 a[118:119], v243 offset:30720
  v_mfma_f32_16x16x32_bf16 v[80:83], a[120:123], v[136:139], v[80:83]
  v_mfma_f32_16x16x32_bf16 v[96:99], a[120:123], v[140:143], v[96:99]
  ds_read_b64_tr_b16 a[120:121], v244 offset:26624
  s_add_u32 m0, s38, 49152
  v_mfma_f32_16x16x32_bf16 v[84:87], a[124:127], v[136:139], v[84:87]
  ds_read_b64_tr_b16 a[122:123], v244 offset:30720
  v_mfma_f32_16x16x32_bf16 v[100:103], a[124:127], v[140:143], v[100:103]
  ds_read_b64_tr_b16 a[124:125], v245 offset:26624
  ds_read_b64_tr_b16 a[126:127], v245 offset:30720
  v_mfma_f32_16x16x32_bf16 v[72:75], a[64:67], v[144:147], v[72:75]
  v_mfma_f32_16x16x32_bf16 v[88:91], a[64:67], v[148:151], v[88:91]
  buffer_load_dwordx4 v225, s[8:11], s17 offen offset:0 lds
  v_mfma_f32_16x16x32_bf16 v[76:79], a[68:71], v[144:147], v[76:79]
  ds_read_b64_tr_b16 a[64:65], v242 offset:16384
  ds_read_b64_tr_b16 a[66:67], v242 offset:20480
  v_mfma_f32_16x16x32_bf16 v[92:95], a[68:71], v[148:151], v[92:95]
  ds_read_b64_tr_b16 a[68:69], v243 offset:16384
  ds_read_b64_tr_b16 a[70:71], v243 offset:20480
  s_waitcnt lgkmcnt(10)
  v_mfma_f32_16x16x32_bf16 v[80:83], a[72:75], v[144:147], v[80:83]
  buffer_load_dwordx4 v226, s[8:11], s17 offen offset:1024 lds
  v_mfma_f32_16x16x32_bf16 v[96:99], a[72:75], v[148:151], v[96:99]
  ds_read_b64_tr_b16 a[72:73], v244 offset:16384
  ds_read_b64_tr_b16 a[74:75], v244 offset:20480
  v_mfma_f32_16x16x32_bf16 v[84:87], a[76:79], v[144:147], v[84:87]
  v_mfma_f32_16x16x32_bf16 v[100:103], a[76:79], v[148:151], v[100:103]
  ds_read_b64_tr_b16 a[76:77], v245 offset:16384
  ds_read_b64_tr_b16 a[78:79], v245 offset:20480
  v_mfma_f32_16x16x32_bf16 v[72:75], a[96:99], v[152:155], v[72:75]
  s_add_u32 s17, s17, 917504
  v_mfma_f32_16x16x32_bf16 v[88:91], a[96:99], v[156:159], v[88:91]
  ds_read_b64_tr_b16 a[96:97], v242 offset:24576
  ds_read_b64_tr_b16 a[98:99], v242 offset:28672
  v_mfma_f32_16x16x32_bf16 v[76:79], a[100:103], v[152:155], v[76:79]
  v_mfma_f32_16x16x32_bf16 v[92:95], a[100:103], v[156:159], v[92:95]
  s_add_u32 s52, s20, 0xe00000
  s_addc_u32 s53, s21, 0
  s_mov_b32 s54, 0x800000
  s_mov_b32 s55, 0x20000
  v_lshlrev_b32 v50, 4, v231
  s_lshl_b32 s36, s2, 2
  s_add_u32 s36, s36, s3
  s_xor_b32 s37, s36, 4
  s_lshl_b32 s39, s37, 13
  s_lshl_b32 s36, s36, 13
  s_mov_b32 s43, 0x8000
  s_mov_b32 s44, s90
  s_mov_b32 s45, s91
  s_mov_b32 s46, 0x400000
  s_mov_b32 s47, 0x20000
  v_mfma_f32_16x16x32_bf16 v[80:83], a[104:107], v[152:155], v[80:83]
  ds_read_b64_tr_b16 a[100:101], v243 offset:24576
  ds_read_b64_tr_b16 a[102:103], v243 offset:28672
  v_mfma_f32_16x16x32_bf16 v[96:99], a[104:107], v[156:159], v[96:99]
  ds_read_b64_tr_b16 a[104:105], v244 offset:24576
  ds_read_b64_tr_b16 a[106:107], v244 offset:28672
  v_mfma_f32_16x16x32_bf16 v[84:87], a[108:111], v[152:155], v[84:87]
  v_mfma_f32_16x16x32_bf16 v[100:103], a[108:111], v[156:159], v[100:103]
  s_waitcnt vmcnt(4) lgkmcnt(10)
  s_barrier
  v_swap_b32 v162, v164
  v_swap_b32 v163, v165
  v_swap_b32 v170, v172
  v_swap_b32 v171, v173
  v_swap_b32 v178, v180
  v_swap_b32 v179, v181
  v_swap_b32 v186, v188
  v_swap_b32 v187, v189
  s_nop 1
  v_mfma_f32_16x16x32_bf16 v[72:75], a[80:83], v[160:163], v[72:75]
  ds_read_b64_tr_b16 a[108:109], v245 offset:24576
  ds_read_b64_tr_b16 a[110:111], v245 offset:28672
  v_mfma_f32_16x16x32_bf16 v[88:91], a[80:83], v[164:167], v[88:91]
  ds_read_b64_tr_b16 a[80:81], v242 offset:34816
  ds_read_b64_tr_b16 a[82:83], v242 offset:38912
  v_mfma_f32_16x16x32_bf16 v[76:79], a[84:87], v[160:163], v[76:79]
  v_mfma_f32_16x16x32_bf16 v[92:95], a[84:87], v[164:167], v[92:95]
  ds_read_b64_tr_b16 a[84:85], v243 offset:34816
  ds_read_b64_tr_b16 a[86:87], v243 offset:38912
  v_mfma_f32_16x16x32_bf16 v[80:83], a[88:91], v[160:163], v[80:83]
  v_mfma_f32_16x16x32_bf16 v[96:99], a[88:91], v[164:167], v[96:99]
  ds_read_b64_tr_b16 a[88:89], v244 offset:34816
  ds_read_b64_tr_b16 a[90:91], v244 offset:38912
  v_mfma_f32_16x16x32_bf16 v[84:87], a[92:95], v[160:163], v[84:87]
  v_mfma_f32_16x16x32_bf16 v[100:103], a[92:95], v[164:167], v[100:103]
  ds_read_b64_tr_b16 a[92:93], v245 offset:34816
  ds_read_b64_tr_b16 a[94:95], v245 offset:38912
  v_mfma_f32_16x16x32_bf16 v[72:75], a[112:115], v[168:171], v[72:75]
  v_mfma_f32_16x16x32_bf16 v[88:91], a[112:115], v[172:175], v[88:91]
  ds_read_b64_tr_b16 a[112:113], v242 offset:43008
  ds_read_b64_tr_b16 a[114:115], v242 offset:47104
  v_mfma_f32_16x16x32_bf16 v[76:79], a[116:119], v[168:171], v[76:79]
  v_mfma_f32_16x16x32_bf16 v[92:95], a[116:119], v[172:175], v[92:95]
  ds_read_b64_tr_b16 a[116:117], v243 offset:43008
  ds_read_b64_tr_b16 a[118:119], v243 offset:47104
  v_mfma_f32_16x16x32_bf16 v[80:83], a[120:123], v[168:171], v[80:83]
  v_mfma_f32_16x16x32_bf16 v[96:99], a[120:123], v[172:175], v[96:99]
  ds_read_b64_tr_b16 a[120:121], v244 offset:43008
  ds_read_b64_tr_b16 a[122:123], v244 offset:47104
  v_mfma_f32_16x16x32_bf16 v[84:87], a[124:127], v[168:171], v[84:87]
  v_mfma_f32_16x16x32_bf16 v[100:103], a[124:127], v[172:175], v[100:103]
  ds_read_b64_tr_b16 a[124:125], v245 offset:43008
  ds_read_b64_tr_b16 a[126:127], v245 offset:47104
  v_mfma_f32_16x16x32_bf16 v[72:75], a[64:67], v[176:179], v[72:75]
  v_mfma_f32_16x16x32_bf16 v[88:91], a[64:67], v[180:183], v[88:91]
  ds_read_b64_tr_b16 a[64:65], v242 offset:32768
  ds_read_b64_tr_b16 a[66:67], v242 offset:36864
  v_mfma_f32_16x16x32_bf16 v[76:79], a[68:71], v[176:179], v[76:79]
  v_mfma_f32_16x16x32_bf16 v[92:95], a[68:71], v[180:183], v[92:95]
  ds_read_b64_tr_b16 a[68:69], v243 offset:32768
  ds_read_b64_tr_b16 a[70:71], v243 offset:36864
  s_waitcnt lgkmcnt(10)
  v_mfma_f32_16x16x32_bf16 v[80:83], a[72:75], v[176:179], v[80:83]
  v_mfma_f32_16x16x32_bf16 v[96:99], a[72:75], v[180:183], v[96:99]
  ds_read_b64_tr_b16 a[72:73], v244 offset:32768
  ds_read_b64_tr_b16 a[74:75], v244 offset:36864
  v_mfma_f32_16x16x32_bf16 v[84:87], a[76:79], v[176:179], v[84:87]
  v_mfma_f32_16x16x32_bf16 v[100:103], a[76:79], v[180:183], v[100:103]
  ds_read_b64_tr_b16 a[76:77], v245 offset:32768
  ds_read_b64_tr_b16 a[78:79], v245 offset:36864
  v_mfma_f32_16x16x32_bf16 v[72:75], a[96:99], v[184:187], v[72:75]
  v_mfma_f32_16x16x32_bf16 v[88:91], a[96:99], v[188:191], v[88:91]
  ds_read_b64_tr_b16 a[96:97], v242 offset:40960
  ds_read_b64_tr_b16 a[98:99], v242 offset:45056
  v_mfma_f32_16x16x32_bf16 v[76:79], a[100:103], v[184:187], v[76:79]
  v_mfma_f32_16x16x32_bf16 v[92:95], a[100:103], v[188:191], v[92:95]
  ds_read_b64_tr_b16 a[100:101], v243 offset:40960
  ds_read_b64_tr_b16 a[102:103], v243 offset:45056
  v_mfma_f32_16x16x32_bf16 v[80:83], a[104:107], v[184:187], v[80:83]
  v_mfma_f32_16x16x32_bf16 v[96:99], a[104:107], v[188:191], v[96:99]
  ds_read_b64_tr_b16 a[104:105], v244 offset:40960
  ds_read_b64_tr_b16 a[106:107], v244 offset:45056
  v_mfma_f32_16x16x32_bf16 v[84:87], a[108:111], v[184:187], v[84:87]
  v_mfma_f32_16x16x32_bf16 v[100:103], a[108:111], v[188:191], v[100:103]
  s_waitcnt vmcnt(0) lgkmcnt(10)
  s_barrier
  v_mfma_f32_16x16x32_bf16 v[16:19], a[80:83], v[128:131], v[16:19]
  ds_read_b64_tr_b16 a[108:109], v245 offset:40960
  ds_read_b64_tr_b16 a[110:111], v245 offset:45056
  v_mfma_f32_16x16x32_bf16 v[32:35], a[80:83], v[132:135], v[32:35]
  ds_read_b64_tr_b16 a[80:81], v242 offset:51200
  ds_read_b64_tr_b16 a[82:83], v242 offset:55296
  v_mfma_f32_16x16x32_bf16 v[20:23], a[84:87], v[128:131], v[20:23]
  v_mfma_f32_16x16x32_bf16 v[36:39], a[84:87], v[132:135], v[36:39]
  v_cvt_pk_bf16_f32 v108, v72, v73
  v_cvt_pk_bf16_f32 v109, v74, v75
  v_cvt_pk_bf16_f32 v110, v76, v77
  v_cvt_pk_bf16_f32 v111, v78, v79
  buffer_store_dwordx4 v[108:111], v50, s[52:55], s39 offen offset:0 sc1
  v_mfma_f32_16x16x32_bf16 v[24:27], a[88:91], v[128:131], v[24:27]
  v_cvt_pk_bf16_f32 v116, v88, v89
  v_cvt_pk_bf16_f32 v117, v90, v91
  v_cvt_pk_bf16_f32 v118, v92, v93
  v_cvt_pk_bf16_f32 v119, v94, v95
  buffer_store_dwordx4 v[116:119], v50, s[52:55], s39 offen offset:2048 sc1
  v_mfma_f32_16x16x32_bf16 v[40:43], a[88:91], v[132:135], v[40:43]
  ds_read_b64_tr_b16 a[84:85], v243 offset:51200
  ds_read_b64_tr_b16 a[86:87], v243 offset:55296
  v_mfma_f32_16x16x32_bf16 v[28:31], a[92:95], v[128:131], v[28:31]
  ds_read_b64_tr_b16 a[88:89], v244 offset:51200
  ds_read_b64_tr_b16 a[90:91], v244 offset:55296
  v_mfma_f32_16x16x32_bf16 v[44:47], a[92:95], v[132:135], v[44:47]
  v_cvt_pk_bf16_f32 v112, v80, v81
  v_cvt_pk_bf16_f32 v113, v82, v83
  v_cvt_pk_bf16_f32 v114, v84, v85
  v_cvt_pk_bf16_f32 v115, v86, v87
  buffer_store_dwordx4 v[112:115], v50, s[52:55], s39 offen offset:1024 sc1
  v_mfma_f32_16x16x32_bf16 v[16:19], a[112:115], v[136:139], v[16:19]
  v_cvt_pk_bf16_f32 v120, v96, v97
  v_cvt_pk_bf16_f32 v121, v98, v99
  v_cvt_pk_bf16_f32 v122, v100, v101
  v_cvt_pk_bf16_f32 v123, v102, v103
  buffer_store_dwordx4 v[120:123], v50, s[52:55], s39 offen offset:3072 sc1
  v_mfma_f32_16x16x32_bf16 v[32:35], a[112:115], v[140:143], v[32:35]
  ds_read_b64_tr_b16 a[92:93], v245 offset:51200
  ds_read_b64_tr_b16 a[94:95], v245 offset:55296
  v_mfma_f32_16x16x32_bf16 v[20:23], a[116:119], v[136:139], v[20:23]
  ds_read_b64_tr_b16 a[112:113], v242 offset:59392
  ds_read_b64_tr_b16 a[114:115], v242 offset:63488
  v_mfma_f32_16x16x32_bf16 v[36:39], a[116:119], v[140:143], v[36:39]
  ds_read_b64_tr_b16 a[116:117], v243 offset:59392
  ds_read_b64_tr_b16 a[118:119], v243 offset:63488
  v_mfma_f32_16x16x32_bf16 v[24:27], a[120:123], v[136:139], v[24:27]
  v_mfma_f32_16x16x32_bf16 v[40:43], a[120:123], v[140:143], v[40:43]
  ds_read_b64_tr_b16 a[120:121], v244 offset:59392
  ds_read_b64_tr_b16 a[122:123], v244 offset:63488
  v_mfma_f32_16x16x32_bf16 v[28:31], a[124:127], v[136:139], v[28:31]
  v_mfma_f32_16x16x32_bf16 v[44:47], a[124:127], v[140:143], v[44:47]
  ds_read_b64_tr_b16 a[124:125], v245 offset:59392
  ds_read_b64_tr_b16 a[126:127], v245 offset:63488
  v_mfma_f32_16x16x32_bf16 v[16:19], a[64:67], v[144:147], v[16:19]
  v_mfma_f32_16x16x32_bf16 v[32:35], a[64:67], v[148:151], v[32:35]
  ds_read_b64_tr_b16 a[64:65], v242 offset:49152
  ds_read_b64_tr_b16 a[66:67], v242 offset:53248
  v_mfma_f32_16x16x32_bf16 v[20:23], a[68:71], v[144:147], v[20:23]
  v_mfma_f32_16x16x32_bf16 v[36:39], a[68:71], v[148:151], v[36:39]
  ds_read_b64_tr_b16 a[68:69], v243 offset:49152
  ds_read_b64_tr_b16 a[70:71], v243 offset:53248
  s_waitcnt lgkmcnt(10)
  v_mfma_f32_16x16x32_bf16 v[24:27], a[72:75], v[144:147], v[24:27]
  v_mfma_f32_16x16x32_bf16 v[40:43], a[72:75], v[148:151], v[40:43]
  ds_read_b64_tr_b16 a[72:73], v244 offset:49152
  ds_read_b64_tr_b16 a[74:75], v244 offset:53248
  v_mfma_f32_16x16x32_bf16 v[28:31], a[76:79], v[144:147], v[28:31]
  v_mfma_f32_16x16x32_bf16 v[44:47], a[76:79], v[148:151], v[44:47]
  ds_read_b64_tr_b16 a[76:77], v245 offset:49152
  ds_read_b64_tr_b16 a[78:79], v245 offset:53248
  v_mfma_f32_16x16x32_bf16 v[16:19], a[96:99], v[152:155], v[16:19]
  v_mfma_f32_16x16x32_bf16 v[32:35], a[96:99], v[156:159], v[32:35]
  ds_read_b64_tr_b16 a[96:97], v242 offset:57344
  ds_read_b64_tr_b16 a[98:99], v242 offset:61440
  v_mfma_f32_16x16x32_bf16 v[20:23], a[100:103], v[152:155], v[20:23]
  v_mfma_f32_16x16x32_bf16 v[36:39], a[100:103], v[156:159], v[36:39]
  ds_read_b64_tr_b16 a[100:101], v243 offset:57344
  ds_read_b64_tr_b16 a[102:103], v243 offset:61440
  v_mfma_f32_16x16x32_bf16 v[24:27], a[104:107], v[152:155], v[24:27]
  v_mfma_f32_16x16x32_bf16 v[40:43], a[104:107], v[156:159], v[40:43]
  ds_read_b64_tr_b16 a[104:105], v244 offset:57344
  ds_read_b64_tr_b16 a[106:107], v244 offset:61440
  v_mfma_f32_16x16x32_bf16 v[28:31], a[108:111], v[152:155], v[28:31]
  v_mfma_f32_16x16x32_bf16 v[44:47], a[108:111], v[156:159], v[44:47]
  s_waitcnt vmcnt(63) lgkmcnt(10)
  s_barrier
  v_accvgpr_read_b32 v0, a128
  v_accvgpr_read_b32 v1, a129
  v_mfma_f32_16x16x32_bf16 v[16:19], a[80:83], v[160:163], v[16:19]
  v_accvgpr_read_b32 v2, a130
  v_accvgpr_read_b32 v3, a131
  v_mfma_f32_16x16x32_bf16 v[32:35], a[80:83], v[164:167], v[32:35]
  ds_read_b64_tr_b16 a[108:109], v245 offset:57344
  v_accvgpr_read_b32 v4, a132
  v_mfma_f32_16x16x32_bf16 v[20:23], a[84:87], v[160:163], v[20:23]
  ds_read_b64_tr_b16 a[110:111], v245 offset:61440
  v_accvgpr_read_b32 v5, a133
  v_accvgpr_read_b32 v6, a134
  v_mfma_f32_16x16x32_bf16 v[36:39], a[84:87], v[164:167], v[36:39]
  v_accvgpr_read_b32 v7, a135
  v_mfma_f32_16x16x32_bf16 v[24:27], a[88:91], v[160:163], v[24:27]
  v_accvgpr_read_b32 v8, a136
  v_accvgpr_read_b32 v9, a137
  v_mfma_f32_16x16x32_bf16 v[40:43], a[88:91], v[164:167], v[40:43]
  v_accvgpr_read_b32 v10, a138
  v_accvgpr_read_b32 v11, a139
  v_mfma_f32_16x16x32_bf16 v[28:31], a[92:95], v[160:163], v[28:31]
  v_accvgpr_read_b32 v12, a140
  v_mfma_f32_16x16x32_bf16 v[44:47], a[92:95], v[164:167], v[44:47]
  v_accvgpr_read_b32 v13, a141
  v_accvgpr_read_b32 v14, a142
  v_mfma_f32_16x16x32_bf16 v[16:19], a[112:115], v[168:171], v[16:19]
  v_accvgpr_read_b32 v15, a143
  v_mfma_f32_16x16x32_bf16 v[32:35], a[112:115], v[172:175], v[32:35]
  v_lshlrev_b32 v192, 16, v0
  v_and_b32 v193, 0xffff0000, v0
  v_mfma_f32_16x16x32_bf16 v[20:23], a[116:119], v[168:171], v[20:23]
  v_lshlrev_b32 v194, 16, v1
  v_and_b32 v195, 0xffff0000, v1
  v_mfma_f32_16x16x32_bf16 v[36:39], a[116:119], v[172:175], v[36:39]
  v_lshlrev_b32 v196, 16, v2
  v_mfma_f32_16x16x32_bf16 v[24:27], a[120:123], v[168:171], v[24:27]
  v_and_b32 v197, 0xffff0000, v2
  v_lshlrev_b32 v198, 16, v3
  v_mfma_f32_16x16x32_bf16 v[40:43], a[120:123], v[172:175], v[40:43]
  v_and_b32 v199, 0xffff0000, v3
  v_mfma_f32_16x16x32_bf16 v[28:31], a[124:127], v[168:171], v[28:31]
  v_lshlrev_b32 v200, 16, v4
  v_and_b32 v201, 0xffff0000, v4
  v_mfma_f32_16x16x32_bf16 v[44:47], a[124:127], v[172:175], v[44:47]
  v_lshlrev_b32 v202, 16, v5
  v_and_b32 v203, 0xffff0000, v5
  v_mfma_f32_16x16x32_bf16 v[16:19], a[64:67], v[176:179], v[16:19]
  v_lshlrev_b32 v204, 16, v6
  v_mfma_f32_16x16x32_bf16 v[32:35], a[64:67], v[180:183], v[32:35]
  v_and_b32 v205, 0xffff0000, v6
  v_lshlrev_b32 v206, 16, v7
  v_mfma_f32_16x16x32_bf16 v[20:23], a[68:71], v[176:179], v[20:23]
  v_and_b32 v207, 0xffff0000, v7
  v_mfma_f32_16x16x32_bf16 v[36:39], a[68:71], v[180:183], v[36:39]
  v_lshlrev_b32 v208, 16, v8
  v_and_b32 v209, 0xffff0000, v8
  ds_read_b128 v[56:59], v253 offset:768
  buffer_load_dwordx4 v[108:111], v50, s[52:55], s36 offen offset:0 sc1
  s_waitcnt lgkmcnt(10)
  v_mfma_f32_16x16x32_bf16 v[24:27], a[72:75], v[176:179], v[24:27]
  v_lshlrev_b32 v210, 16, v9
  v_and_b32 v211, 0xffff0000, v9
  ds_read_b128 v[60:63], v253 offset:832
  buffer_load_dwordx4 v[112:115], v50, s[52:55], s36 offen offset:1024 sc1
  v_mfma_f32_16x16x32_bf16 v[40:43], a[72:75], v[180:183], v[40:43]
  v_lshlrev_b32 v212, 16, v10
  ds_read_b128 v[64:67], v253 offset:896
  buffer_load_dwordx4 v[116:119], v50, s[52:55], s36 offen offset:2048 sc1
  s_waitcnt lgkmcnt(10)
  v_mfma_f32_16x16x32_bf16 v[28:31], a[76:79], v[176:179], v[28:31]
  v_and_b32 v213, 0xffff0000, v10
  v_lshlrev_b32 v214, 16, v11
  ds_read_b128 v[68:71], v253 offset:960
  buffer_load_dwordx4 v[120:123], v50, s[52:55], s36 offen offset:3072 sc1
  v_mfma_f32_16x16x32_bf16 v[44:47], a[76:79], v[180:183], v[44:47]
  v_and_b32 v215, 0xffff0000, v11
  s_waitcnt lgkmcnt(10)
  v_mfma_f32_16x16x32_bf16 v[16:19], a[96:99], v[184:187], v[16:19]
  v_lshlrev_b32 v216, 16, v12
  v_and_b32 v217, 0xffff0000, v12
  v_mfma_f32_16x16x32_bf16 v[32:35], a[96:99], v[188:191], v[32:35]
  v_lshlrev_b32 v218, 16, v13
  v_and_b32 v219, 0xffff0000, v13
  s_waitcnt lgkmcnt(8)
  v_mfma_f32_16x16x32_bf16 v[20:23], a[100:103], v[184:187], v[20:23]
  v_lshlrev_b32 v220, 16, v14
  v_mfma_f32_16x16x32_bf16 v[36:39], a[100:103], v[188:191], v[36:39]
  v_and_b32 v221, 0xffff0000, v14
  v_lshlrev_b32 v222, 16, v15
  s_waitcnt lgkmcnt(6)
  v_mfma_f32_16x16x32_bf16 v[24:27], a[104:107], v[184:187], v[24:27]
  v_and_b32 v223, 0xffff0000, v15
  v_mfma_f32_16x16x32_bf16 v[40:43], a[104:107], v[188:191], v[40:43]
  s_waitcnt lgkmcnt(4)
  v_mfma_f32_16x16x32_bf16 v[28:31], a[108:111], v[184:187], v[28:31]
  v_mfma_f32_16x16x32_bf16 v[44:47], a[108:111], v[188:191], v[44:47]
  s_nop 7
  s_nop 1
  s_waitcnt lgkmcnt(0)
  v_pk_fma_f32 v[192:193], v[16:17], v[56:57], v[192:193]
  v_pk_fma_f32 v[194:195], v[18:19], v[58:59], v[194:195]
  v_pk_fma_f32 v[196:197], v[20:21], v[60:61], v[196:197]
  v_pk_fma_f32 v[198:199], v[22:23], v[62:63], v[198:199]
  v_pk_fma_f32 v[200:201], v[24:25], v[64:65], v[200:201]
  v_pk_fma_f32 v[202:203], v[26:27], v[66:67], v[202:203]
  v_pk_fma_f32 v[204:205], v[28:29], v[68:69], v[204:205]
  v_pk_fma_f32 v[206:207], v[30:31], v[70:71], v[206:207]
  v_pk_fma_f32 v[208:209], v[32:33], v[56:57], v[208:209]
  v_pk_fma_f32 v[210:211], v[34:35], v[58:59], v[210:211]
  v_pk_fma_f32 v[212:213], v[36:37], v[60:61], v[212:213]
  v_pk_fma_f32 v[214:215], v[38:39], v[62:63], v[214:215]
  v_pk_fma_f32 v[216:217], v[40:41], v[64:65], v[216:217]
  v_pk_fma_f32 v[218:219], v[42:43], v[66:67], v[218:219]
  v_pk_fma_f32 v[220:221], v[44:45], v[68:69], v[220:221]
  v_pk_fma_f32 v[222:223], v[46:47], v[70:71], v[222:223]
  s_mov_b32 s60, 262144
  s_branch L_chk_33
L_poll_31:
  buffer_load_dwordx4 v[108:111], v50, s[52:55], s36 offen offset:0 sc1
  buffer_load_dwordx4 v[112:115], v50, s[52:55], s36 offen offset:1024 sc1
  buffer_load_dwordx4 v[116:119], v50, s[52:55], s36 offen offset:2048 sc1
  buffer_load_dwordx4 v[120:123], v50, s[52:55], s36 offen offset:3072 sc1
L_chk_33:
  s_waitcnt vmcnt(3)
  v_max3_u32 v51, v108, v109, v110
  v_max_u32 v51, v51, v111
  s_waitcnt vmcnt(2)
  v_max3_u32 v51, v51, v112, v113
  v_max3_u32 v51, v51, v114, v115
  s_waitcnt vmcnt(1)
  v_max3_u32 v51, v51, v116, v117
  v_max3_u32 v51, v51, v118, v119
  s_waitcnt vmcnt(0)
  v_max3_u32 v51, v51, v120, v121
  v_max3_u32 v51, v51, v122, v123
  v_cmp_eq_u32 vcc, -1, v51
  s_nop 1
  s_cmp_eq_u64 vcc, 0
  s_cbranch_scc1 L_ready_32
  s_sub_u32 s60, s60, 1
  s_cmp_lg_u32 s60, 0
  s_cbranch_scc1 L_poll_31
L_ready_32:
  v_lshlrev_b32 v72, 16, v108
  v_and_b32 v73, 0xffff0000, v108
  v_lshlrev_b32 v74, 16, v109
  v_and_b32 v75, 0xffff0000, v109
  v_pk_fma_f32 v[192:193], v[72:73], v[56:57], v[192:193]
  v_pk_fma_f32 v[194:195], v[74:75], v[58:59], v[194:195]
  v_cvt_pk_bf16_f32 v0, v192, v193
  v_cvt_pk_bf16_f32 v1, v194, v195
  v_lshlrev_b32 v76, 16, v110
  v_and_b32 v77, 0xffff0000, v110
  v_lshlrev_b32 v78, 16, v111
  v_and_b32 v79, 0xffff0000, v111
  v_pk_fma_f32 v[196:197], v[76:77], v[60:61], v[196:197]
  v_pk_fma_f32 v[198:199], v[78:79], v[62:63], v[198:199]
  v_cvt_pk_bf16_f32 v2, v196, v197
  v_cvt_pk_bf16_f32 v3, v198, v199
  s_nop 1
  v_permlane16_swap_b32 v0, v2
  v_permlane16_swap_b32 v1, v3
  s_nop 1
  buffer_store_dwordx4 v[0:3], v252, s[44:47], 0 offen offset:0 sc1
  v_lshlrev_b32 v80, 16, v112
  v_and_b32 v81, 0xffff0000, v112
  v_lshlrev_b32 v82, 16, v113
  v_and_b32 v83, 0xffff0000, v113
  v_pk_fma_f32 v[200:201], v[80:81], v[64:65], v[200:201]
  v_pk_fma_f32 v[202:203], v[82:83], v[66:67], v[202:203]
  v_cvt_pk_bf16_f32 v4, v200, v201
  v_cvt_pk_bf16_f32 v5, v202, v203
  v_lshlrev_b32 v84, 16, v114
  v_and_b32 v85, 0xffff0000, v114
  v_lshlrev_b32 v86, 16, v115
  v_and_b32 v87, 0xffff0000, v115
  v_pk_fma_f32 v[204:205], v[84:85], v[68:69], v[204:205]
  v_pk_fma_f32 v[206:207], v[86:87], v[70:71], v[206:207]
  v_cvt_pk_bf16_f32 v6, v204, v205
  v_cvt_pk_bf16_f32 v7, v206, v207
  s_nop 1
  v_permlane16_swap_b32 v4, v6
  v_permlane16_swap_b32 v5, v7
  s_nop 1
  buffer_store_dwordx4 v[4:7], v252, s[44:47], 0 offen offset:64 sc1
  v_lshlrev_b32 v88, 16, v116
  v_and_b32 v89, 0xffff0000, v116
  v_lshlrev_b32 v90, 16, v117
  v_and_b32 v91, 0xffff0000, v117
  v_pk_fma_f32 v[208:209], v[88:89], v[56:57], v[208:209]
  v_pk_fma_f32 v[210:211], v[90:91], v[58:59], v[210:211]
  v_cvt_pk_bf16_f32 v8, v208, v209
  v_cvt_pk_bf16_f32 v9, v210, v211
  v_lshlrev_b32 v92, 16, v118
  v_and_b32 v93, 0xffff0000, v118
  v_lshlrev_b32 v94, 16, v119
  v_and_b32 v95, 0xffff0000, v119
  v_pk_fma_f32 v[212:213], v[92:93], v[60:61], v[212:213]
  v_pk_fma_f32 v[214:215], v[94:95], v[62:63], v[214:215]
  v_cvt_pk_bf16_f32 v10, v212, v213
  v_cvt_pk_bf16_f32 v11, v214, v215
  s_nop 1
  v_permlane16_swap_b32 v8, v10
  v_permlane16_swap_b32 v9, v11
  s_nop 1
  buffer_store_dwordx4 v[8:11], v252, s[44:47], s43 offen offset:0 sc1
  v_lshlrev_b32 v96, 16, v120
  v_and_b32 v97, 0xffff0000, v120
  v_lshlrev_b32 v98, 16, v121
  v_and_b32 v99, 0xffff0000, v121
  v_pk_fma_f32 v[216:217], v[96:97], v[64:65], v[216:217]
  v_pk_fma_f32 v[218:219], v[98:99], v[66:67], v[218:219]
  v_cvt_pk_bf16_f32 v12, v216, v217
  v_cvt_pk_bf16_f32 v13, v218, v219
  v_lshlrev_b32 v100, 16, v122
  v_and_b32 v101, 0xffff0000, v122
  v_lshlrev_b32 v102, 16, v123
  v_and_b32 v103, 0xffff0000, v123
  v_pk_fma_f32 v[220:221], v[100:101], v[68:69], v[220:221]
  v_pk_fma_f32 v[222:223], v[102:103], v[70:71], v[222:223]
  v_cvt_pk_bf16_f32 v14, v220, v221
  v_cvt_pk_bf16_f32 v15, v222, v223
  s_nop 1
  v_permlane16_swap_b32 v12, v14
  v_permlane16_swap_b32 v13, v15
  s_nop 1
  buffer_store_dwordx4 v[12:15], v252, s[44:47], s43 offen offset:64 sc1
  s_endpgm
L_slow_9:
  s_mov_b32 s33, 262144
L_spin_34:
  buffer_load_dword v127, v126, s[64:67], 0 offen sc1
  s_waitcnt vmcnt(0)
  v_cmp_ne_u32 vcc, s19, v127
  s_nop 1
  s_cmp_eq_u64 vcc, 0
  s_cbranch_scc1 L_back_10
  s_sub_u32 s33, s33, 1
  s_cmp_lg_u32 s33, 0
  s_cbranch_scc1 L_spin_34
  s_branch L_back_10
L_vslow_11:
  s_mov_b32 s33, 262144
L_spin_35:
  buffer_load_dwordx4 v[250:253], v254, s[12:15], s68 offen sc1
  s_waitcnt vmcnt(0)
  v_xor_b32 v168, s48, v250
  v_xor_b32 v169, s49, v251
  v_xor_b32 v170, s50, v252
  v_xor_b32 v171, s51, v253
  v_or3_b32 v172, v168, v169, v170
  v_or_b32 v172, v172, v171
  v_and_b32 v172, 0xff, v172
  v_cmp_ne_u32 vcc, 0, v172
  s_nop 1
  s_cmp_eq_u64 vcc, 0
  s_cbranch_scc1 L_vback_12
  s_sub_u32 s33, s33, 1
  s_cmp_lg_u32 s33, 0
  s_cbranch_scc1 L_spin_35
  s_branch L_vback_12
L_slow_13:
  s_mov_b32 s33, 262144
L_spin_36:
  buffer_load_dword v87, v45, s[64:67], 0 offen sc1
  s_waitcnt vmcnt(0)
  v_cmp_ne_u32 vcc, s19, v87
  s_nop 1
  s_cmp_eq_u64 vcc, 0
  s_cbranch_scc1 L_back_14
  s_sub_u32 s33, s33, 1
  s_cmp_lg_u32 s33, 0
  s_cbranch_scc1 L_spin_36
  s_branch L_back_14
L_slow_21:
  s_mov_b32 s69, 262144
L_spin_37:
  buffer_load_dword v247, v246, s[64:67], s68 offen sc1
  s_waitcnt vmcnt(0)
  v_cmp_ne_u32 vcc, s19, v247
  s_nop 1
  s_cmp_eq_u64 vcc, 0
  s_cbranch_scc1 L_back_22
  s_sub_u32 s69, s69, 1
  s_cmp_lg_u32 s69, 0
  s_cbranch_scc1 L_spin_37
  s_branch L_back_22
L_slow_25:
  s_mov_b32 s60, 262144
L_spin_38:
  buffer_load_dword v247, v246, s[56:59], s94 offen sc1
  s_waitcnt vmcnt(0)
  v_cmp_ne_u32 vcc, s19, v247
  s_nop 1
  s_cmp_eq_u64 vcc, 0
  s_cbranch_scc1 L_back_26
  s_sub_u32 s60, s60, 1
  s_cmp_lg_u32 s60, 0
  s_cbranch_scc1 L_spin_38
  s_branch L_back_26
L_slow_27:
  s_mov_b32 s60, 262144
L_spin_39:
  buffer_load_dword v247, v246, s[56:59], s94 offen sc1
  s_waitcnt vmcnt(0)
  v_cmp_ne_u32 vcc, s19, v247
  s_nop 1
  s_cmp_eq_u64 vcc, 0
  s_cbranch_scc1 L_back_28
  s_sub_u32 s60, s60, 1
  s_cmp_lg_u32 s60, 0
  s_cbranch_scc1 L_spin_39
  s_branch L_back_28
L_slow_29:
  s_mov_b32 s60, 262144
L_spin_40:
  buffer_load_dword v247, v246, s[56:59], s94 offen sc1
  s_waitcnt vmcnt(0)
  v_cmp_ne_u32 vcc, s19, v247
  s_nop 1
  s_cmp_eq_u64 vcc, 0
  s_cbranch_scc1 L_back_30
  s_sub_u32 s60, s60, 1
  s_cmp_lg_u32 s60, 0
  s_cbranch_scc1 L_spin_40
  s_branch L_back_30
L_end_1:
  s_endpgm
L_code_end:
  s_endpgm
.section .rodata,"a"
.p2align 6
.amdhsa_kernel adaLN_cond__sliding_local_dilated__glu_gated_glu__prompt_kernel
  .amdhsa_next_free_vgpr 512
  .amdhsa_next_free_sgpr 102
  .amdhsa_accum_offset 256
  .amdhsa_group_segment_fixed_size 0
  .amdhsa_kernarg_size 96
  .amdhsa_user_sgpr_count 2
  .amdhsa_user_sgpr_kernarg_segment_ptr 1
  .amdhsa_system_sgpr_workgroup_id_x 1
  .amdhsa_float_denorm_mode_32 3
.end_amdhsa_kernel
```

```asm
; @launch grid=(256,1,1) block=(256,1,1) lds=163840
.amdgcn_target "amdgcn-amd-amdhsa--gfx950"
.text
.globl adaLN_cond__sliding_local_dilated__glu_gated_glu__prompt_kernel
.p2align 8
.type adaLN_cond__sliding_local_dilated__glu_gated_glu__prompt_kernel,@function
adaLN_cond__sliding_local_dilated__glu_gated_glu__prompt_kernel:
  s_cmp_ge_u32 s2, 256
  s_cbranch_scc1 L_end_1
  s_load_dwordx2 s[44:45], s[0:1], 56
  s_load_dwordx2 s[52:53], s[0:1], 64
  s_load_dwordx2 s[12:13], s[0:1], 0
  s_load_dwordx2 s[20:21], s[0:1], 88
  s_load_dwordx2 s[8:9], s[0:1], 8
  s_getpc_b64 s[58:59]
  v_and_b32 v86, 31, v0
  v_lshlrev_b32 v86, 7, v86
  global_load_dword v131, v86, s[58:59] offset:128
  v_lshrrev_b32 v110, 6, v0
  v_and_b32 v104, 63, v0
  s_nop 0
  v_readfirstlane_b32 s3, v110
  s_and_b32 s29, s2, 3
  s_and_b32 s28, s2, 4
  s_lshl_b32 s28, s28, 3
  s_lshr_b32 s31, s2, 3
  s_or_b32 s28, s28, s31
  v_lshrrev_b32 v1, 2, v104
  v_mul_u32_u24 v1, 12288, v1
  v_and_b32 v66, 3, v104
  v_lshl_add_u32 v1, v66, 4, v1
  v_lshlrev_b32 v2, 1, v0
  s_lshl2_add_u32 s30, s29, s3
  s_mul_i32 s50, s30, 786432
  s_lshl_b32 s31, s28, 6
  s_add_u32 s35, s50, s31
  s_lshl_b32 s34, s29, 9
  s_lshl_b32 s31, s3, 12
  s_add_u32 m0, s31, 79872
  v_and_b32 v66, 7, v104
  v_lshlrev_b32 v3, 11, v66
  v_lshrrev_b32 v67, 3, v104
  v_lshl_add_u32 v3, v67, 4, v3
  s_lshl_b32 s36, s2, 14
  s_lshl_b32 s31, s3, 9
  s_add_u32 s36, s36, s31
  s_movk_i32 s46, 2048
  s_mov_b32 s47, 0x20000
  s_mov_b32 s54, 12582912
  s_mov_b32 s55, 0x20000
  s_mov_b32 s14, 4194304
  s_mov_b32 s15, 0x20000
  s_waitcnt lgkmcnt(0)
  s_load_dword s19, s[20:21], 0x40000
  buffer_load_ushort v4, v2, s[44:47], s34 offen
  buffer_load_dwordx4 v1, s[52:55], s35 offen offset:0 lds
  s_add_u32 s35, s35, 195584
  buffer_load_dwordx4 v1, s[52:55], s35 offen offset:1024 lds
  s_add_u32 s35, s35, 195584
  buffer_load_dwordx4 v1, s[52:55], s35 offen offset:2048 lds
  s_add_u32 s35, s35, 195584
  buffer_load_dwordx4 v1, s[52:55], s35 offen offset:3072 lds
  s_barrier
  buffer_load_dwordx4 v[8:11], v3, s[12:15], s36 offen offset:0
  buffer_load_dwordx4 v[12:15], v3, s[12:15], s36 offen offset:128
  buffer_load_dwordx4 v[16:19], v3, s[12:15], s36 offen offset:256
  buffer_load_dwordx4 v[20:23], v3, s[12:15], s36 offen offset:384
  s_load_dwordx2 s[24:25], s[0:1], 16
  s_load_dwordx4 s[60:63], s[0:1], 32
  s_load_dwordx2 s[22:23], s[0:1], 48
  s_load_dwordx2 s[90:91], s[0:1], 72
  s_mov_b64 s[26:27], s[12:13]
  s_and_b32 s30, s2, 1
  s_lshl_b32 s30, s30, 3
  s_bfe_u32 s31, s2, 0x30003
  s_add_u32 s30, s30, s31
  s_bfe_u32 s31, s2, 0x20001
  s_lshl_b32 s31, s31, 2
  s_lshr_b32 s34, s2, 6
  s_add_u32 s31, s31, s34
  v_and_b32 v111, 2, v67
  v_xor_b32 v111, v111, v66
  v_mul_u32_u24 v129, 12288, v67
  v_lshl_add_u32 v129, v111, 4, v129
  s_and_b32 s33, s3, 1
  s_lshl_b32 s33, s33, 2
  v_xor_b32 v111, s33, v111
  v_mul_u32_u24 v110, 6144, v67
  v_lshl_add_u32 v110, v111, 4, v110
  s_mul_i32 s32, s3, 49152
  s_lshl_b32 s33, s31, 7
  s_add_u32 s32, s32, s33
  v_add_u32 v107, s32, v110
  v_add_u32 v108, 1024, v107
  v_add_u32 v109, 2048, v107
  s_mul_i32 s38, s3, 3072
  s_and_b32 s33, s30, 7
  s_mul_i32 s16, s33, 131072
  s_mul_i32 s17, s33, 196608
  s_mov_b32 s10, 1572864
  s_mov_b32 s11, 0x20000
  s_barrier
  s_getpc_b64 s[100:101]
  L_pc_2:
  s_add_u32 s100, s100, L_gemm_a-L_pc_2
  s_addc_u32 s101, s101, 0
  s_lshr_b32 s33, s2, 3
  s_lshl_b32 s33, s33, 2
  s_add_u32 s33, s33, s3
  s_lshl_b32 s33, s33, 13
  v_lshlrev_b32 v200, 7, v104
  v_add_u32 v200, s33, v200
  v_min_u32 v200, L_code_end-L_gemm_a-4, v200
  v_mov_b32 v201, s101
  v_add_co_u32 v200, vcc, s100, v200
  s_nop 1
  v_addc_co_u32 v201, vcc, 0, v201, vcc
  global_load_dword v131, v[200:201], off
  v_lshrrev_b32 v68, 4, v104
  v_bfe_u32 v69, v104, 2, 2
  v_lshl_add_u32 v69, v68, 3, v69
  v_and_b32 v70, 3, v104
  v_lshlrev_b32 v70, 3, v70
  s_lshl_b32 s33, s3, 5
  s_add_u32 s33, s33, 106496
  v_add_u32 v70, s33, v70
  v_lshl_add_u32 v5, v69, 6, v70
  v_subrev_u32 v5, 26624, v5
  v_lshl_add_u32 v196, v69, 7, v70
  v_and_b32 v70, 8, v104
  v_lshlrev_b32 v70, 2, v70
  v_xor_b32 v196, v196, v70
  v_lshlrev_b32 v255, 4, v68
  v_add_u32 v197, 147456, v255
  v_and_b32 v70, 15, v104
  v_lshl_or_b32 v255, v70, 24, v255
  v_mov_b32 v198, 0xffffff00
  v_add_u32 v2, 147456, v2
  s_mov_b32 s12, s20
  s_mov_b32 s13, s21
  s_mov_b32 s14, 0x18000
  s_mov_b32 s15, 0x20000
  s_mul_i32 s96, s29, 24576
  s_lshl_b32 s33, s3, 6
  s_add_u32 s96, s96, s33
  s_lshl_b32 s33, s28, 7
  s_add_u32 s34, s96, s33
  s_add_u32 s96, s34, s33
  s_add_u32 s96, s96, 8192
  s_add_u32 s50, s50, s33
  s_add_u32 s50, s50, 4096
  s_lshl_b32 s51, s3, 13
  s_add_u32 s51, s51, 106496
  s_waitcnt vmcnt(9)
  v_lshlrev_b32 v4, 16, v4
  v_mul_f32 v6, 0xbfb8aa3b, v4
  v_exp_f32 v6, v6
  s_nop 0
  v_add_f32 v6, 1.0, v6
  v_rcp_f32 v6, v6
  s_nop 0
  v_mul_f32 v4, v4, v6
  v_cvt_pk_bf16_f32 v4, v4, v4
  ds_write_b16 v2, v4
  s_waitcnt vmcnt(5) lgkmcnt(0)
  s_barrier
  s_mul_i32 s19, s19, 0x9e3779b1
  s_add_u32 s19, s19, 0x7f4a7c15
  s_bfe_u32 s40, s19, 0x80000
  s_bfe_u32 s41, s19, 0x80008
  s_bfe_u32 s42, s19, 0x80010
  s_bfe_u32 s43, s19, 0x80018
  s_cmp_ge_u32 s3, 2
  s_cbranch_scc1 L_nog_3
  ds_read_b64_tr_b16 a[64:65], v5 offset:0
  ds_read_b64_tr_b16 a[66:67], v5 offset:256
  ds_read_b128 a[68:71], v197 offset:0
  ds_read_b64_tr_b16 a[72:73], v5 offset:2048
  ds_read_b64_tr_b16 a[74:75], v5 offset:2304
  ds_read_b128 a[76:79], v197 offset:64
  ds_read_b64_tr_b16 a[80:81], v5 offset:4096
  ds_read_b64_tr_b16 a[82:83], v5 offset:4352
  ds_read_b128 a[84:87], v197 offset:128
  ds_read_b64_tr_b16 a[88:89], v5 offset:6144
  ds_read_b64_tr_b16 a[90:91], v5 offset:6400
  ds_read_b128 a[92:95], v197 offset:192
  ds_read_b64_tr_b16 a[96:97], v5 offset:8192
  ds_read_b64_tr_b16 a[98:99], v5 offset:8448
  ds_read_b128 a[100:103], v197 offset:256
  s_waitcnt lgkmcnt(12)
  v_mfma_f32_16x16x32_bf16 v[192:195], a[64:67], a[68:71], 0
  ds_read_b64_tr_b16 a[104:105], v5 offset:10240
  ds_read_b64_tr_b16 a[106:107], v5 offset:10496
  ds_read_b128 a[108:111], v197 offset:320
  s_waitcnt lgkmcnt(12)
  v_mfma_f32_16x16x32_bf16 v[192:195], a[72:75], a[76:79], v[192:195]
  ds_read_b64_tr_b16 a[112:113], v5 offset:12288
  ds_read_b64_tr_b16 a[114:115], v5 offset:12544
  ds_read_b128 a[116:119], v197 offset:384
  s_waitcnt lgkmcnt(12)
  v_mfma_f32_16x16x32_bf16 v[192:195], a[80:83], a[84:87], v[192:195]
  ds_read_b64_tr_b16 a[120:121], v5 offset:14336
  ds_read_b64_tr_b16 a[122:123], v5 offset:14592
  ds_read_b128 a[124:127], v197 offset:448
  s_waitcnt lgkmcnt(12)
  v_mfma_f32_16x16x32_bf16 v[192:195], a[88:91], a[92:95], v[192:195]
  s_waitcnt lgkmcnt(9)
  v_mfma_f32_16x16x32_bf16 v[192:195], a[96:99], a[100:103], v[192:195]
  s_waitcnt lgkmcnt(6)
  v_mfma_f32_16x16x32_bf16 v[192:195], a[104:107], a[108:111], v[192:195]
  s_waitcnt lgkmcnt(3)
  v_mfma_f32_16x16x32_bf16 v[192:195], a[112:115], a[116:119], v[192:195]
  s_waitcnt lgkmcnt(0)
  v_mfma_f32_16x16x32_bf16 v[192:195], a[120:123], a[124:127], v[192:195]
  s_nop 7
  v_and_or_b32 v192, v192, v198, s40
  v_and_or_b32 v193, v193, v198, s41
  v_and_or_b32 v194, v194, v198, s42
  v_and_or_b32 v195, v195, v198, s43
  buffer_store_dwordx4 v[192:195], v255, s[12:15], s34 offen sc1
L_nog_3:
  s_waitcnt vmcnt(1)
  v_lshlrev_b32 v24, 16, v8
  v_and_b32 v25, 0xffff0000, v8
  v_lshlrev_b32 v26, 16, v9
  v_and_b32 v27, 0xffff0000, v9
  v_lshlrev_b32 v28, 16, v10
  v_and_b32 v29, 0xffff0000, v10
  v_lshlrev_b32 v30, 16, v11
  v_and_b32 v31, 0xffff0000, v11
  v_lshlrev_b32 v32, 16, v12
  v_and_b32 v33, 0xffff0000, v12
  v_lshlrev_b32 v34, 16, v13
  v_and_b32 v35, 0xffff0000, v13
  v_lshlrev_b32 v36, 16, v14
  v_and_b32 v37, 0xffff0000, v14
  v_lshlrev_b32 v38, 16, v15
  v_and_b32 v39, 0xffff0000, v15
  v_lshlrev_b32 v40, 16, v16
  v_and_b32 v41, 0xffff0000, v16
  v_lshlrev_b32 v42, 16, v17
  v_and_b32 v43, 0xffff0000, v17
  v_lshlrev_b32 v44, 16, v18
  v_and_b32 v45, 0xffff0000, v18
  v_lshlrev_b32 v46, 16, v19
  v_and_b32 v47, 0xffff0000, v19
  v_lshlrev_b32 v48, 16, v20
  v_and_b32 v49, 0xffff0000, v20
  v_lshlrev_b32 v50, 16, v21
  v_and_b32 v51, 0xffff0000, v21
  v_lshlrev_b32 v52, 16, v22
  v_and_b32 v53, 0xffff0000, v22
  v_lshlrev_b32 v54, 16, v23
  v_and_b32 v55, 0xffff0000, v23
  v_pk_add_f32 v[56:57], v[24:25], v[26:27]
  v_pk_mul_f32 v[58:59], v[24:25], v[24:25]
  v_pk_mul_f32 v[60:61], v[26:27], v[26:27]
  v_pk_add_f32 v[56:57], v[56:57], v[28:29]
  v_pk_fma_f32 v[58:59], v[28:29], v[28:29], v[58:59]
  v_pk_add_f32 v[56:57], v[56:57], v[30:31]
  v_pk_fma_f32 v[60:61], v[30:31], v[30:31], v[60:61]
  v_pk_add_f32 v[56:57], v[56:57], v[32:33]
  v_pk_fma_f32 v[58:59], v[32:33], v[32:33], v[58:59]
  v_pk_add_f32 v[56:57], v[56:57], v[34:35]
  v_pk_fma_f32 v[60:61], v[34:35], v[34:35], v[60:61]
  v_pk_add_f32 v[56:57], v[56:57], v[36:37]
  v_pk_fma_f32 v[58:59], v[36:37], v[36:37], v[58:59]
  v_pk_add_f32 v[56:57], v[56:57], v[38:39]
  v_pk_fma_f32 v[60:61], v[38:39], v[38:39], v[60:61]
  v_pk_add_f32 v[56:57], v[56:57], v[40:41]
  v_pk_fma_f32 v[58:59], v[40:41], v[40:41], v[58:59]
  v_pk_add_f32 v[56:57], v[56:57], v[42:43]
  v_pk_fma_f32 v[60:61], v[42:43], v[42:43], v[60:61]
  v_pk_add_f32 v[56:57], v[56:57], v[44:45]
  v_pk_fma_f32 v[58:59], v[44:45], v[44:45], v[58:59]
  v_pk_add_f32 v[56:57], v[56:57], v[46:47]
  v_pk_fma_f32 v[60:61], v[46:47], v[46:47], v[60:61]
  v_pk_add_f32 v[56:57], v[56:57], v[48:49]
  v_pk_fma_f32 v[58:59], v[48:49], v[48:49], v[58:59]
  v_pk_add_f32 v[56:57], v[56:57], v[50:51]
  v_pk_fma_f32 v[60:61], v[50:51], v[50:51], v[60:61]
  v_pk_add_f32 v[56:57], v[56:57], v[52:53]
  v_pk_fma_f32 v[58:59], v[52:53], v[52:53], v[58:59]
  v_pk_add_f32 v[56:57], v[56:57], v[54:55]
  v_pk_fma_f32 v[60:61], v[54:55], v[54:55], v[60:61]
  v_pk_add_f32 v[58:59], v[58:59], v[60:61]
  v_add_f32 v56, v56, v57
  v_add_f32 v57, v58, v59
  s_nop 1
  v_add_f32_dpp v56, v56, v56 row_ror:8 row_mask:0xf bank_mask:0xf
  v_add_f32_dpp v57, v57, v57 row_ror:8 row_mask:0xf bank_mask:0xf
  v_mov_b32 v58, v56
  v_mov_b32 v59, v57
  s_nop 1
  v_permlane16_swap_b32 v58, v56
  v_permlane16_swap_b32 v59, v57
  s_nop 1
  v_add_f32 v56, v56, v58
  v_add_f32 v57, v57, v59
  v_mov_b32 v58, v56
  v_mov_b32 v59, v57
  s_nop 1
  v_permlane32_swap_b32 v58, v56
  v_permlane32_swap_b32 v59, v57
  s_nop 1
  v_add_f32 v56, v56, v58
  v_add_f32 v57, v57, v59
  v_lshlrev_b32 v68, 5, v66
  v_add_u32 v68, 147968, v68
  s_lshl_b32 s33, s3, 3
  v_add_u32 v69, s33, v68
  ds_write_b64 v69, v[56:57]
  v_lshlrev_b32 v119, 4, v104
  s_lshl_b32 s33, s3, 10
  v_add_u32 v1, s33, v119
  v_add_u32 v2, 4096, v1
  s_lshl_b32 s33, s3, 11
  s_add_u32 s33, s33, 139264
  v_add_u32 v3, s33, v119
  v_lshlrev_b32 v4, 5, v67
  v_add_u32 v4, s33, v4
  v_lshrrev_b32 v5, 5, v104
  v_lshlrev_b32 v5, 17, v5
  v_and_b32 v70, 3, v67
  v_lshl_add_u32 v5, v70, 8, v5
  v_lshl_add_u32 v5, v66, 4, v5
  s_waitcnt lgkmcnt(0)
  s_barrier
  ds_read_b128 v[132:135], v68 offset:0
  ds_read_b128 v[136:139], v68 offset:16
  s_add_u32 m0, s38, 0
  s_nop 0
  buffer_load_dwordx4 v107, s[8:11], s17 offen lds
  buffer_load_dwordx4 v108, s[8:11], s17 offen offset:1024 lds
  buffer_load_dwordx4 v109, s[8:11], s17 offen offset:2048 lds
  s_add_u32 s17, s17, 196608
  s_cmp_eq_u32 s17, s10
  s_cselect_b32 s17, 0, s17
  s_mov_b32 s32, 24576
  s_mov_b32 s35, 49152
  s_mov_b32 s36, 73728
  s_add_u32 s4, s20, 0x200000
  s_addc_u32 s5, s21, 0
  s_mov_b32 s6, 0x400000
  s_mov_b32 s7, 0x20000
  s_add_u32 s64, s20, 0xc0000
  s_addc_u32 s65, s21, 0
  s_mov_b32 s66, 0x20000
  s_mov_b32 s67, 0x20000
  s_waitcnt lgkmcnt(0)
  v_pk_add_f32 v[132:133], v[132:133], v[134:135]
  v_pk_add_f32 v[136:137], v[136:137], v[138:139]
  v_pk_add_f32 v[132:133], v[132:133], v[136:137]
  v_mul_f32 v56, 0x3a800000, v132
  v_mul_f32 v60, 0x3a800000, v133
  v_fma_f32 v60, -v56, v56, v60
  v_max_f32 v60, 0, v60
  buffer_load_dwordx4 v[72:75], v1, s[12:15], 0 offen sc1
  buffer_load_dwordx4 v[76:79], v1, s[12:15], s32 offen sc1
  buffer_load_dwordx4 v[80:83], v1, s[12:15], s35 offen sc1
  buffer_load_dwordx4 v[84:87], v1, s[12:15], s36 offen sc1
  buffer_load_dwordx4 v[88:91], v2, s[12:15], 0 offen sc1
  buffer_load_dwordx4 v[92:95], v2, s[12:15], s32 offen sc1
  buffer_load_dwordx4 v[96:99], v2, s[12:15], s35 offen sc1
  buffer_load_dwordx4 v[100:103], v2, s[12:15], s36 offen sc1
  v_cvt_pk_bf16_f32 v64, v56, v60
  v_lshlrev_b32 v56, 16, v64
  v_and_b32 v60, 0xffff0000, v64
  v_add_f32 v60, 0x3727c5ac, v60
  v_cvt_pk_bf16_f32 v64, v60, v61
  v_lshlrev_b32 v60, 16, v64
  v_and_b32 v61, 0xffff0000, v64
  v_sqrt_f32 v60, v60
  s_nop 0
  v_cvt_pk_bf16_f32 v64, v60, v61
  v_lshlrev_b32 v60, 16, v64
  v_and_b32 v61, 0xffff0000, v64
  v_rcp_f32 v60, v60
  v_mov_b32 v57, v56
  s_nop 0
  v_mov_b32 v61, v60
  v_pk_add_f32 v[24:25], v[24:25], v[56:57] neg_lo:[0,1] neg_hi:[0,1]
  v_pk_add_f32 v[26:27], v[26:27], v[56:57] neg_lo:[0,1] neg_hi:[0,1]
  v_pk_add_f32 v[28:29], v[28:29], v[56:57] neg_lo:[0,1] neg_hi:[0,1]
  v_pk_add_f32 v[30:31], v[30:31], v[56:57] neg_lo:[0,1] neg_hi:[0,1]
  v_pk_add_f32 v[32:33], v[32:33], v[56:57] neg_lo:[0,1] neg_hi:[0,1]
  v_pk_add_f32 v[34:35], v[34:35], v[56:57] neg_lo:[0,1] neg_hi:[0,1]
  v_pk_add_f32 v[36:37], v[36:37], v[56:57] neg_lo:[0,1] neg_hi:[0,1]
  v_pk_add_f32 v[38:39], v[38:39], v[56:57] neg_lo:[0,1] neg_hi:[0,1]
  v_pk_add_f32 v[40:41], v[40:41], v[56:57] neg_lo:[0,1] neg_hi:[0,1]
  v_pk_add_f32 v[42:43], v[42:43], v[56:57] neg_lo:[0,1] neg_hi:[0,1]
  v_pk_add_f32 v[44:45], v[44:45], v[56:57] neg_lo:[0,1] neg_hi:[0,1]
  v_pk_add_f32 v[46:47], v[46:47], v[56:57] neg_lo:[0,1] neg_hi:[0,1]
  v_pk_add_f32 v[48:49], v[48:49], v[56:57] neg_lo:[0,1] neg_hi:[0,1]
  v_pk_add_f32 v[50:51], v[50:51], v[56:57] neg_lo:[0,1] neg_hi:[0,1]
  v_pk_add_f32 v[52:53], v[52:53], v[56:57] neg_lo:[0,1] neg_hi:[0,1]
  v_pk_add_f32 v[54:55], v[54:55], v[56:57] neg_lo:[0,1] neg_hi:[0,1]
  v_pk_mul_f32 v[24:25], v[24:25], v[60:61]
  v_pk_mul_f32 v[26:27], v[26:27], v[60:61]
  v_pk_mul_f32 v[28:29], v[28:29], v[60:61]
  v_pk_mul_f32 v[30:31], v[30:31], v[60:61]
  v_pk_mul_f32 v[32:33], v[32:33], v[60:61]
  v_pk_mul_f32 v[34:35], v[34:35], v[60:61]
  v_pk_mul_f32 v[36:37], v[36:37], v[60:61]
  v_pk_mul_f32 v[38:39], v[38:39], v[60:61]
  v_pk_mul_f32 v[40:41], v[40:41], v[60:61]
  v_pk_mul_f32 v[42:43], v[42:43], v[60:61]
  v_pk_mul_f32 v[44:45], v[44:45], v[60:61]
  v_pk_mul_f32 v[46:47], v[46:47], v[60:61]
  v_pk_mul_f32 v[48:49], v[48:49], v[60:61]
  v_pk_mul_f32 v[50:51], v[50:51], v[60:61]
  v_pk_mul_f32 v[52:53], v[52:53], v[60:61]
  v_pk_mul_f32 v[54:55], v[54:55], v[60:61]
  s_lshl_b32 s39, s3, 8
  s_add_u32 s39, s39, 12288
  s_lshl_b32 s33, s30, 6
  s_lshl_b32 s34, s3, 4
  s_add_u32 s34, s34, s33
  s_max_u32 s33, s33, 8
  s_sub_u32 s33, s33, 8
  v_add_u32 v110, s33, v66
  v_add_u32 v126, s34, v104
  v_cmp_lt_u32 vcc, 15, v104
  s_nop 1
  v_cndmask_b32 v126, v126, v110, vcc
  s_mov_b32 s33, 0
  v_and_b32 v128, 0, v126
  v_add_u32 v128, s33, v128
  v_and_b32 v128, 3, v128
  v_and_or_b32 v128, v126, -4, v128
  v_lshlrev_b32 v126, 6, v126
  v_lshlrev_b32 v128, 6, v128
  s_lshl_b32 s34, s30, 13
  s_lshl_b32 s33, s3, 11
  s_add_u32 s34, s34, s33
  v_add_u32 v105, s34, v119
  s_lshl_b32 s34, s30, 3
  s_max_u32 s34, s34, 1
  s_sub_u32 s34, s34, 1
  s_lshl_b32 s34, s34, 10
  s_lshl_b32 s33, s3, 8
  s_add_u32 s34, s34, s33
  v_lshlrev_b32 v106, 2, v104
  v_add_u32 v106, s34, v106
  v_lshrrev_b32 v110, 4, v104
  v_mul_u32_u24 v110, 3072, v110
  v_bfe_u32 v111, v104, 2, 2
  v_lshl_add_u32 v110, v111, 7, v110
  v_bfe_u32 v111, v104, 3, 2
  v_lshl_add_u32 v110, v111, 5, v110
  v_and_b32 v111, 3, v104
  v_lshl_add_u32 v114, v111, 3, v110
  v_xor_b32 v115, 32, v114
  v_xor_b32 v116, 64, v114
  v_xor_b32 v117, 96, v114
  s_lshl_b32 s33, s3, 5
  v_xor_b32 v118, s33, v114
  v_add_u32 v120, 53248, v114
  v_add_u32 v121, 53248, v115
  v_add_u32 v122, 53248, v116
  v_add_u32 v123, 53248, v117
  v_add_u32 v124, 53248, v118
  v_add_u32 v125, 53248, v119
  v_and_b32 v110, 14, v104
  v_lshrrev_b32 v111, 4, v104
  v_lshlrev_b32 v111, 2, v111
  v_cmp_le_u32 s[44:45], v111, v110
  v_add_u32 v111, 2, v111
  v_cmp_le_u32 s[46:47], v111, v110
  v_and_b32 v110, 1, v104
  v_cmp_eq_u32 s[48:49], 1, v110
  s_lshl_b32 s56, s3, 20
  s_lshr_b32 s33, s2, 1
  s_lshl_b32 s33, s33, 10
  s_add_u32 s56, s56, s33
  s_and_b32 s33, s2, 1
  s_lshl_b32 s33, s33, 7
  s_add_u32 s56, s56, s33
  s_add_u32 s57, s56, 262144
  s_add_u32 s58, s56, 524288
  s_add_u32 s59, s56, 786432
  s_lshl_b32 s37, s2, 2
  s_add_u32 s37, s37, s3
  s_lshl_b32 s37, s37, 6
  s_mov_b32 s33, 262144
L_mod_4:
  s_waitcnt vmcnt(7)
  v_xor_b32 v72, s40, v72
  v_xor_b32 v73, s41, v73
  v_xor_b32 v74, s42, v74
  v_xor_b32 v75, s43, v75
  v_or3_b32 v66, v72, v73, v74
  v_or_b32 v66, v66, v75
  s_waitcnt vmcnt(6)
  v_xor_b32 v76, s40, v76
  v_xor_b32 v77, s41, v77
  v_xor_b32 v78, s42, v78
  v_xor_b32 v79, s43, v79
  v_or3_b32 v66, v66, v76, v77
  v_or3_b32 v66, v66, v78, v79
  s_waitcnt vmcnt(5)
  v_xor_b32 v80, s40, v80
  v_xor_b32 v81, s41, v81
  v_xor_b32 v82, s42, v82
  v_xor_b32 v83, s43, v83
  v_or3_b32 v66, v66, v80, v81
  v_or3_b32 v66, v66, v82, v83
  s_waitcnt vmcnt(4)
  v_xor_b32 v84, s40, v84
  v_xor_b32 v85, s41, v85
  v_xor_b32 v86, s42, v86
  v_xor_b32 v87, s43, v87
  v_or3_b32 v66, v66, v84, v85
  v_or3_b32 v66, v66, v86, v87
  s_waitcnt vmcnt(3)
  v_xor_b32 v88, s40, v88
  v_xor_b32 v89, s41, v89
  v_xor_b32 v90, s42, v90
  v_xor_b32 v91, s43, v91
  v_or3_b32 v66, v66, v88, v89
  v_or3_b32 v66, v66, v90, v91
  s_waitcnt vmcnt(2)
  v_xor_b32 v92, s40, v92
  v_xor_b32 v93, s41, v93
  v_xor_b32 v94, s42, v94
  v_xor_b32 v95, s43, v95
  v_or3_b32 v66, v66, v92, v93
  v_or3_b32 v66, v66, v94, v95
  s_waitcnt vmcnt(1)
  v_xor_b32 v96, s40, v96
  v_xor_b32 v97, s41, v97
  v_xor_b32 v98, s42, v98
  v_xor_b32 v99, s43, v99
  v_or3_b32 v66, v66, v96, v97
  v_or3_b32 v66, v66, v98, v99
  s_waitcnt vmcnt(0)
  v_xor_b32 v100, s40, v100
  v_xor_b32 v101, s41, v101
  v_xor_b32 v102, s42, v102
  v_xor_b32 v103, s43, v103
  v_or3_b32 v66, v66, v100, v101
  v_or3_b32 v66, v66, v102, v103
  v_and_b32 v66, 0xff, v66
  v_cmp_ne_u32 vcc, 0, v66
  s_nop 1
  s_cmp_eq_u64 vcc, 0
  s_cbranch_scc1 L_mok_5
  s_mov_b64 exec, vcc
  buffer_load_dwordx4 v[72:75], v1, s[12:15], 0 offen sc1
  buffer_load_dwordx4 v[76:79], v1, s[12:15], s32 offen sc1
  buffer_load_dwordx4 v[80:83], v1, s[12:15], s35 offen sc1
  buffer_load_dwordx4 v[84:87], v1, s[12:15], s36 offen sc1
  buffer_load_dwordx4 v[88:91], v2, s[12:15], 0 offen sc1
  buffer_load_dwordx4 v[92:95], v2, s[12:15], s32 offen sc1
  buffer_load_dwordx4 v[96:99], v2, s[12:15], s35 offen sc1
  buffer_load_dwordx4 v[100:103], v2, s[12:15], s36 offen sc1
  s_sub_u32 s33, s33, 1
  s_cmp_lg_u32 s33, 0
  s_cbranch_scc1 L_mod_4
  s_waitcnt vmcnt(0)
L_mok_5:
  s_mov_b64 exec, -1
  v_pk_add_f32 v[72:73], v[72:73], v[80:81]
  v_pk_add_f32 v[74:75], v[74:75], v[82:83]
  v_pk_add_f32 v[76:77], v[76:77], v[84:85]
  v_pk_add_f32 v[78:79], v[78:79], v[86:87]
  v_pk_add_f32 v[88:89], v[88:89], v[96:97]
  v_pk_add_f32 v[90:91], v[90:91], v[98:99]
  v_pk_add_f32 v[92:93], v[92:93], v[100:101]
  v_pk_add_f32 v[94:95], v[94:95], v[102:103]
  v_pk_add_f32 v[72:73], v[72:73], v[76:77]
  v_pk_add_f32 v[74:75], v[74:75], v[78:79]
  v_pk_add_f32 v[88:89], v[88:89], v[92:93]
  v_pk_add_f32 v[90:91], v[90:91], v[94:95]
  v_cvt_pk_bf16_f32 v80, v72, v73
  v_lshlrev_b32 v72, 16, v80
  v_and_b32 v73, 0xffff0000, v80
  v_cvt_pk_bf16_f32 v81, v74, v75
  v_lshlrev_b32 v74, 16, v81
  v_and_b32 v75, 0xffff0000, v81
  v_cvt_pk_bf16_f32 v82, v88, v89
  v_lshlrev_b32 v88, 16, v82
  v_and_b32 v89, 0xffff0000, v82
  v_cvt_pk_bf16_f32 v83, v90, v91
  v_lshlrev_b32 v90, 16, v83
  v_and_b32 v91, 0xffff0000, v83
  ds_write_b128 v3, v[72:75]
  v_add_f32 v88, 1.0, v88
  v_add_f32 v89, 1.0, v89
  v_add_f32 v90, 1.0, v90
  v_add_f32 v91, 1.0, v91
  v_cvt_pk_bf16_f32 v80, v88, v89
  v_lshlrev_b32 v88, 16, v80
  v_and_b32 v89, 0xffff0000, v80
  v_cvt_pk_bf16_f32 v81, v90, v91
  v_lshlrev_b32 v90, 16, v81
  v_and_b32 v91, 0xffff0000, v81
  ds_write_b128 v3, v[88:91] offset:1024
  ds_read_b128 v[132:135], v4 offset:0
  ds_read_b128 v[164:167], v4 offset:1024
  ds_read_b128 v[136:139], v4 offset:16
  ds_read_b128 v[168:171], v4 offset:1040
  ds_read_b128 v[140:143], v4 offset:256
  ds_read_b128 v[172:175], v4 offset:1280
  ds_read_b128 v[144:147], v4 offset:272
  ds_read_b128 v[176:179], v4 offset:1296
  ds_read_b128 v[148:151], v4 offset:512
  ds_read_b128 v[180:183], v4 offset:1536
  ds_read_b128 v[152:155], v4 offset:528
  ds_read_b128 v[184:187], v4 offset:1552
  s_waitcnt lgkmcnt(8)
  ds_read_b128 v[156:159], v4 offset:768
  ds_read_b128 v[188:191], v4 offset:1792
  ds_read_b128 v[160:163], v4 offset:784
  ds_read_b128 v[192:195], v4 offset:1808
  s_waitcnt lgkmcnt(12)
  v_pk_fma_f32 v[24:25], v[24:25], v[164:165], v[132:133]
  v_pk_fma_f32 v[26:27], v[26:27], v[166:167], v[134:135]
  v_pk_fma_f32 v[28:29], v[28:29], v[168:169], v[136:137]
  v_pk_fma_f32 v[30:31], v[30:31], v[170:171], v[138:139]
  v_cvt_pk_bf16_f32 v8, v24, v25
  v_cvt_pk_bf16_f32 v9, v26, v27
  v_cvt_pk_bf16_f32 v10, v28, v29
  v_cvt_pk_bf16_f32 v11, v30, v31
  buffer_store_dwordx4 v[8:11], v5, s[4:7], s56 offen sc1
  s_waitcnt lgkmcnt(8)
  v_pk_fma_f32 v[32:33], v[32:33], v[172:173], v[140:141]
  v_pk_fma_f32 v[34:35], v[34:35], v[174:175], v[142:143]
  v_pk_fma_f32 v[36:37], v[36:37], v[176:177], v[144:145]
  v_pk_fma_f32 v[38:39], v[38:39], v[178:179], v[146:147]
  v_cvt_pk_bf16_f32 v12, v32, v33
  v_cvt_pk_bf16_f32 v13, v34, v35
  v_cvt_pk_bf16_f32 v14, v36, v37
  v_cvt_pk_bf16_f32 v15, v38, v39
  buffer_store_dwordx4 v[12:15], v5, s[4:7], s57 offen sc1
  s_waitcnt lgkmcnt(4)
  v_pk_fma_f32 v[40:41], v[40:41], v[180:181], v[148:149]
  v_pk_fma_f32 v[42:43], v[42:43], v[182:183], v[150:151]
  v_pk_fma_f32 v[44:45], v[44:45], v[184:185], v[152:153]
  v_pk_fma_f32 v[46:47], v[46:47], v[186:187], v[154:155]
  v_cvt_pk_bf16_f32 v16, v40, v41
  v_cvt_pk_bf16_f32 v17, v42, v43
  v_cvt_pk_bf16_f32 v18, v44, v45
  v_cvt_pk_bf16_f32 v19, v46, v47
  buffer_store_dwordx4 v[16:19], v5, s[4:7], s58 offen sc1
  s_waitcnt lgkmcnt(0)
  v_pk_fma_f32 v[48:49], v[48:49], v[188:189], v[156:157]
  v_pk_fma_f32 v[50:51], v[50:51], v[190:191], v[158:159]
  v_pk_fma_f32 v[52:53], v[52:53], v[192:193], v[160:161]
  v_pk_fma_f32 v[54:55], v[54:55], v[194:195], v[162:163]
  v_cvt_pk_bf16_f32 v20, v48, v49
  v_cvt_pk_bf16_f32 v21, v50, v51
  v_cvt_pk_bf16_f32 v22, v52, v53
  v_cvt_pk_bf16_f32 v23, v54, v55
  buffer_store_dwordx4 v[20:23], v5, s[4:7], s59 offen sc1
  v_mov_b32 v7, s19
  v_lshlrev_b32 v6, 2, v104
  s_waitcnt vmcnt(0)
  s_mov_b64 exec, 1
  buffer_store_dword v7, v6, s[64:67], s37 offen sc1
  s_mov_b64 exec, -1
  s_barrier
  s_add_u32 m0, s38, 13312
  s_nop 0
  buffer_load_dwordx4 v107, s[8:11], s17 offen lds
  buffer_load_dwordx4 v108, s[8:11], s17 offen offset:1024 lds
  buffer_load_dwordx4 v109, s[8:11], s17 offen offset:2048 lds
  s_add_u32 s17, s17, 196608
  s_cmp_eq_u32 s17, s10
  s_cselect_b32 s17, 0, s17
  s_add_u32 m0, s38, 26624
  s_nop 0
  buffer_load_dwordx4 v107, s[8:11], s17 offen lds
  buffer_load_dwordx4 v108, s[8:11], s17 offen offset:1024 lds
  buffer_load_dwordx4 v109, s[8:11], s17 offen offset:2048 lds
  s_add_u32 s17, s17, 196608
  s_cmp_eq_u32 s17, s10
  s_cselect_b32 s17, 0, s17
  s_add_u32 m0, s38, 39936
  s_nop 0
  buffer_load_dwordx4 v107, s[8:11], s17 offen lds
  buffer_load_dwordx4 v108, s[8:11], s17 offen offset:1024 lds
  buffer_load_dwordx4 v109, s[8:11], s17 offen offset:2048 lds
  s_add_u32 s17, s17, 196608
  s_cmp_eq_u32 s17, s10
  s_cselect_b32 s17, 0, s17
  s_add_u32 m0, s38, 53248
  s_nop 0
  buffer_load_dwordx4 v107, s[8:11], s17 offen lds
  buffer_load_dwordx4 v108, s[8:11], s17 offen offset:1024 lds
  buffer_load_dwordx4 v109, s[8:11], s17 offen offset:2048 lds
  s_add_u32 s17, s17, 196608
  s_cmp_eq_u32 s17, s10
  s_cselect_b32 s17, 0, s17
  s_add_u32 m0, s38, 66560
  s_nop 0
  buffer_load_dwordx4 v107, s[8:11], s17 offen lds
  buffer_load_dwordx4 v108, s[8:11], s17 offen offset:1024 lds
  buffer_load_dwordx4 v109, s[8:11], s17 offen offset:2048 lds
  s_add_u32 s17, s17, 196608
  s_cmp_eq_u32 s17, s10
  s_cselect_b32 s17, 0, s17
  s_add_u32 m0, s38, 79872
  s_nop 0
  buffer_load_dwordx4 v107, s[8:11], s17 offen lds
  buffer_load_dwordx4 v108, s[8:11], s17 offen offset:1024 lds
  buffer_load_dwordx4 v109, s[8:11], s17 offen offset:2048 lds
  s_add_u32 s17, s17, 196608
  s_cmp_eq_u32 s17, s10
  s_cselect_b32 s17, 0, s17
L_slow_6:
  s_mov_b32 s33, 262144
L_spin_8:
  buffer_load_dword v127, v128, s[64:67], 0 offen sc1
  s_waitcnt vmcnt(0)
  v_cmp_ne_u32 vcc, s19, v127
  s_nop 1
  s_cmp_eq_u64 vcc, 0
  s_cbranch_scc1 L_back_7
  s_sub_u32 s33, s33, 1
  s_cmp_lg_u32 s33, 0
  s_cbranch_scc1 L_spin_8
  s_branch L_back_7
L_back_7:
L_gemm_a:
  s_mov_b32 s6, 1048576
  s_add_u32 m0, s39, 0
  s_nop 0
  buffer_load_dword v106, s[4:7], s16 offen sc1 lds
  buffer_load_dwordx4 a[0:3], v105, s[4:7], s16 offen sc1
  buffer_load_dwordx4 a[4:7], v105, s[4:7], s16 offen offset:1024 sc1
  s_add_u32 s16, s16, 131072
  s_bitset0_b32 s16, 20
  s_add_u32 m0, s39, 13312
  s_nop 0
  buffer_load_dword v106, s[4:7], s16 offen sc1 lds
  buffer_load_dwordx4 a[8:11], v105, s[4:7], s16 offen sc1
  buffer_load_dwordx4 a[12:15], v105, s[4:7], s16 offen offset:1024 sc1
  s_add_u32 s16, s16, 131072
  s_bitset0_b32 s16, 20
  s_add_u32 m0, s39, 26624
  s_nop 0
  buffer_load_dword v106, s[4:7], s16 offen sc1 lds
  buffer_load_dwordx4 a[16:19], v105, s[4:7], s16 offen sc1
  buffer_load_dwordx4 a[20:23], v105, s[4:7], s16 offen offset:1024 sc1
  s_add_u32 s16, s16, 131072
  s_bitset0_b32 s16, 20
  s_bitcmp1_b32 s3, 0
  s_cselect_b32 s56, s62, s60
  s_cselect_b32 s57, s63, s61
  s_mov_b32 s58, 7340032
  s_mov_b32 s59, 0x20000
  s_lshl_b32 s97, s2, 1
  s_lshr_b32 s33, s3, 1
  s_add_u32 s97, s97, s33
  s_lshl_b32 s97, s97, 10
  v_lshrrev_b32 v110, 3, v104
  v_min_u32 v130, 2, v110
  v_lshlrev_b32 v130, 19, v130
  v_and_b32 v112, 7, v104
  v_lshl_add_u32 v130, v112, 7, v130
  s_bfe_u32 s36, s2, 0x20001
  s_lshl_b32 s36, s36, 2
  s_bfe_u32 s33, s2, 0x20003
  s_add_u32 s36, s36, s33
  s_lshr_b32 s37, s2, 5
  s_lshl_b32 s37, s37, 1
  s_and_b32 s33, s2, 1
  s_add_u32 s37, s37, s33
  s_and_b32 s33, s36, 3
  s_lshl_b32 s98, s33, 19
  v_and_b32 v111, 6, v110
  v_and_b32 v112, 7, v104
  v_xor_b32 v111, v111, v112
  v_lshlrev_b32 v110, 11, v110
  v_lshl_add_u32 v110, v111, 4, v110
  s_lshl_b32 s32, s3, 15
  s_lshl_b32 s33, s37, 7
  s_add_u32 s32, s32, s33
  v_add_u32 v248, s32, v110
  v_add_u32 v249, 15360, v248
  v_mov_b32 v244, -1
  v_mov_b32 v245, -1
  v_mov_b32 v246, -1
  v_mov_b32 v247, -1
  s_add_u32 s92, s20, 0xe00000
  s_addc_u32 s93, s21, 0
  s_mov_b32 s94, 0x800000
  s_mov_b32 s95, 0x20000
  s_lshl_b32 s35, s2, 2
  s_add_u32 s35, s35, s3
  s_lshl_b32 s35, s35, 13
  v_lshrrev_b32 v254, 4, v104
  s_movk_i32 s33, 24576
  v_mul_u32_u24 v254, s33, v254
  v_and_b32 v110, 15, v104
  v_lshl_add_u32 v254, v110, 4, v254
  v_and_b32 v110, 15, v104
  v_lshlrev_b32 v128, 11, v110
  v_bfe_u32 v112, v104, 4, 1
  v_lshl_add_u32 v128, v112, 5, v128
  v_lshrrev_b32 v112, 5, v104
  v_lshl_add_u32 v128, v112, 4, v128
  s_lshl_b32 s32, s36, 18
  s_lshl_b32 s33, s3, 16
  s_add_u32 s32, s32, s33
  s_lshl_b32 s33, s37, 7
  s_add_u32 s32, s32, s33
  v_add_u32 v128, s32, v128
  s_waitcnt vmcnt(6)
  s_barrier
  ds_read_b64_tr_b16 v[180:181], v118 offset:1024
  ds_read_b64_tr_b16 v[182:183], v118 offset:1536
  ds_read_b128 v[188:191], v119 offset:12288
  ds_read_b64_tr_b16 v[184:185], v118 offset:2048
  ds_read_b64_tr_b16 v[186:187], v118 offset:2560
  ds_read_b64_tr_b16 v[132:133], v114 offset:0
  ds_read_b64_tr_b16 v[134:135], v114 offset:512
  ds_read_b64_tr_b16 v[136:137], v115 offset:0
  ds_read_b64_tr_b16 v[138:139], v115 offset:512
  ds_read_b64_tr_b16 v[140:141], v116 offset:0
  ds_read_b64_tr_b16 v[142:143], v116 offset:512
  ds_read_b64_tr_b16 v[144:145], v117 offset:0
  ds_read_b64_tr_b16 v[146:147], v117 offset:512
  ds_read_b64_tr_b16 v[148:149], v114 offset:1024
  ds_read_b64_tr_b16 v[150:151], v114 offset:1536
  ds_read_b64_tr_b16 v[152:153], v115 offset:1024
  ds_read_b64_tr_b16 v[154:155], v115 offset:1536
  ds_read_b64_tr_b16 v[156:157], v116 offset:1024
  ds_read_b64_tr_b16 v[158:159], v116 offset:1536
  ds_read_b64_tr_b16 v[160:161], v117 offset:1024
  ds_read_b64_tr_b16 v[162:163], v117 offset:1536
  ds_read_b64_tr_b16 v[164:165], v114 offset:2048
  ds_read_b64_tr_b16 v[166:167], v114 offset:2560
  ds_read_b64_tr_b16 v[168:169], v115 offset:2048
  ds_read_b64_tr_b16 v[170:171], v115 offset:2560
  ds_read_b64_tr_b16 v[172:173], v116 offset:2048
  ds_read_b64_tr_b16 v[174:175], v116 offset:2560
  ds_read_b64_tr_b16 v[176:177], v117 offset:2048
  ds_read_b64_tr_b16 v[178:179], v117 offset:2560
  s_waitcnt vmcnt(3) lgkmcnt(10)
  s_barrier
  v_mfma_f32_16x16x32_bf16 v[96:99], v[180:183], v[188:191], 0
  ds_read_b64_tr_b16 v[180:181], v118 offset:14336
  s_add_u32 m0, s39, 39936
  v_mfma_f32_16x16x32_bf16 v[100:103], v[188:191], v[184:187], 0
  buffer_load_dword v106, s[4:7], s16 offen sc1 lds
  v_mfma_f32_16x16x32_bf16 v[0:3], v[132:135], a[0:3], 0
  buffer_load_dwordx4 a[24:27], v105, s[4:7], s16 offen sc1
  v_mfma_f32_16x16x32_bf16 v[48:51], v[132:135], a[4:7], 0
  ds_read_b64_tr_b16 v[182:183], v118 offset:14848
  buffer_load_dwordx4 a[28:31], v105, s[4:7], s16 offen offset:1024 sc1
  v_mfma_f32_16x16x32_bf16 v[4:7], v[136:139], a[0:3], 0
  ds_read_b128 v[188:191], v119 offset:25600
  ds_read_b64_tr_b16 v[184:185], v118 offset:15360
  ds_read_b64_tr_b16 v[186:187], v118 offset:15872
  s_add_u32 s16, s16, 131072
  v_mfma_f32_16x16x32_bf16 v[52:55], v[136:139], a[4:7], 0
  ds_read_b64_tr_b16 v[132:133], v114 offset:13312
  s_bitset0_b32 s16, 20
  v_mfma_f32_16x16x32_bf16 v[8:11], v[140:143], a[0:3], 0
  ds_read_b64_tr_b16 v[134:135], v114 offset:13824
  s_add_u32 m0, s39, 53248
  v_mfma_f32_16x16x32_bf16 v[56:59], v[140:143], a[4:7], 0
  buffer_load_dword v106, s[4:7], s16 offen sc1 lds
  v_mfma_f32_16x16x32_bf16 v[12:15], v[144:147], a[0:3], 0
  ds_read_b64_tr_b16 v[136:137], v115 offset:13312
  ds_read_b64_tr_b16 v[138:139], v115 offset:13824
  buffer_load_dwordx4 a[32:35], v105, s[4:7], s16 offen sc1
  v_mfma_f32_16x16x32_bf16 v[60:63], v[144:147], a[4:7], 0
  buffer_load_dwordx4 a[36:39], v105, s[4:7], s16 offen offset:1024 sc1
  v_mfma_f32_16x16x32_bf16 v[16:19], v[148:151], a[0:3], 0
  ds_read_b64_tr_b16 v[140:141], v116 offset:13312
  ds_read_b64_tr_b16 v[142:143], v116 offset:13824
  s_add_u32 s16, s16, 131072
  v_mfma_f32_16x16x32_bf16 v[64:67], v[148:151], a[4:7], 0
  ds_read_b64_tr_b16 v[144:145], v117 offset:13312
  s_bitset0_b32 s16, 20
  v_mfma_f32_16x16x32_bf16 v[20:23], v[152:155], a[0:3], 0
  ds_read_b64_tr_b16 v[146:147], v117 offset:13824
  s_add_u32 m0, s39, 66560
  v_mfma_f32_16x16x32_bf16 v[68:71], v[152:155], a[4:7], 0
  buffer_load_dword v106, s[4:7], s16 offen sc1 lds
  v_mfma_f32_16x16x32_bf16 v[24:27], v[156:159], a[0:3], 0
  ds_read_b64_tr_b16 v[148:149], v114 offset:14336
  ds_read_b64_tr_b16 v[150:151], v114 offset:14848
  buffer_load_dwordx4 a[40:43], v105, s[4:7], s16 offen sc1
  v_mfma_f32_16x16x32_bf16 v[72:75], v[156:159], a[4:7], 0
  buffer_load_dwordx4 a[44:47], v105, s[4:7], s16 offen offset:1024 sc1
  s_waitcnt lgkmcnt(10)
  v_mfma_f32_16x16x32_bf16 v[28:31], v[160:163], a[0:3], 0
  ds_read_b64_tr_b16 v[152:153], v115 offset:14336
  ds_read_b64_tr_b16 v[154:155], v115 offset:14848
  s_add_u32 s16, s16, 131072
  v_mfma_f32_16x16x32_bf16 v[76:79], v[160:163], a[4:7], 0
  ds_read_b64_tr_b16 v[156:157], v116 offset:14336
  s_bitset0_b32 s16, 20
  v_mfma_f32_16x16x32_bf16 v[32:35], a[0:3], v[164:167], 0
  ds_read_b64_tr_b16 v[158:159], v116 offset:14848
  s_add_u32 m0, s39, 79872
  v_mfma_f32_16x16x32_bf16 v[80:83], a[4:7], v[164:167], 0
  buffer_load_dword v106, s[4:7], s16 offen sc1 lds
  v_mfma_f32_16x16x32_bf16 v[36:39], a[0:3], v[168:171], 0
  ds_read_b64_tr_b16 v[160:161], v117 offset:14336
  ds_read_b64_tr_b16 v[162:163], v117 offset:14848
  buffer_load_dwordx4 a[48:51], v105, s[4:7], s16 offen sc1
  v_mfma_f32_16x16x32_bf16 v[84:87], a[4:7], v[168:171], 0
  buffer_load_dwordx4 a[52:55], v105, s[4:7], s16 offen offset:1024 sc1
  v_mfma_f32_16x16x32_bf16 v[40:43], a[0:3], v[172:175], 0
  ds_read_b64_tr_b16 v[164:165], v114 offset:15360
  ds_read_b64_tr_b16 v[166:167], v114 offset:15872
  s_add_u32 s16, s16, 131072
  v_mfma_f32_16x16x32_bf16 v[88:91], a[4:7], v[172:175], 0
  ds_read_b64_tr_b16 v[168:169], v115 offset:15360
  s_bitset0_b32 s16, 20
  v_mfma_f32_16x16x32_bf16 v[44:47], a[0:3], v[176:179], 0
  ds_read_b64_tr_b16 v[170:171], v115 offset:15872
  ds_read_b64_tr_b16 v[172:173], v116 offset:15360
  v_mfma_f32_16x16x32_bf16 v[92:95], a[4:7], v[176:179], 0
  s_waitcnt vmcnt(12) lgkmcnt(10)
  s_barrier
  v_mfma_f32_16x16x32_bf16 v[96:99], v[180:183], v[188:191], v[96:99]
  ds_read_b64_tr_b16 v[174:175], v116 offset:15872
  s_add_u32 m0, s38, 93184
  v_mfma_f32_16x16x32_bf16 v[100:103], v[188:191], v[184:187], v[100:103]
  buffer_load_dwordx4 v107, s[8:11], s17 offen lds
  v_mfma_f32_16x16x32_bf16 v[0:3], v[132:135], a[8:11], v[0:3]
  ds_read_b64_tr_b16 v[176:177], v117 offset:15360
  ds_read_b64_tr_b16 v[178:179], v117 offset:15872
  buffer_load_dwordx4 v108, s[8:11], s17 offen offset:1024 lds
  v_mfma_f32_16x16x32_bf16 v[48:51], v[132:135], a[12:15], v[48:51]
  ds_read_b64_tr_b16 v[180:181], v118 offset:27648
  ds_read_b64_tr_b16 v[182:183], v118 offset:28160
  buffer_load_dword v127, v126, s[64:67], 0 offen sc1
  v_mfma_f32_16x16x32_bf16 v[4:7], v[136:139], a[8:11], v[4:7]
  ds_read_b128 v[188:191], v119 offset:38912
  ds_read_b64_tr_b16 v[184:185], v118 offset:28672
  ds_read_b64_tr_b16 v[186:187], v118 offset:29184
  buffer_load_dwordx4 v109, s[8:11], s17 offen offset:2048 lds
  v_mfma_f32_16x16x32_bf16 v[52:55], v[136:139], a[12:15], v[52:55]
  ds_read_b64_tr_b16 v[132:133], v114 offset:26624
  s_add_u32 s17, s17, 196608
  v_mfma_f32_16x16x32_bf16 v[8:11], v[140:143], a[8:11], v[8:11]
  ds_read_b64_tr_b16 v[134:135], v114 offset:27136
  s_cmp_eq_u32 s17, s10
  s_cselect_b32 s17, 0, s17
  v_mfma_f32_16x16x32_bf16 v[56:59], v[140:143], a[12:15], v[56:59]
  s_add_u32 s8, s8, s10
  s_addc_u32 s9, s9, 0
  v_mfma_f32_16x16x32_bf16 v[12:15], v[144:147], a[8:11], v[12:15]
  ds_read_b64_tr_b16 v[136:137], v115 offset:26624
  ds_read_b64_tr_b16 v[138:139], v115 offset:27136
  s_add_u32 m0, s39, 93184
  v_mfma_f32_16x16x32_bf16 v[60:63], v[144:147], a[12:15], v[60:63]
  ds_read_b64_tr_b16 v[140:141], v116 offset:26624
  ds_read_b64_tr_b16 v[142:143], v116 offset:27136
  v_mfma_f32_16x16x32_bf16 v[16:19], v[148:151], a[8:11], v[16:19]
  buffer_load_dword v106, s[4:7], s16 offen sc1 lds
  v_mfma_f32_16x16x32_bf16 v[64:67], v[148:151], a[12:15], v[64:67]
  buffer_load_dwordx4 a[56:59], v105, s[4:7], s16 offen sc1
  s_waitcnt lgkmcnt(10)
  v_mfma_f32_16x16x32_bf16 v[20:23], v[152:155], a[8:11], v[20:23]
  ds_read_b64_tr_b16 v[144:145], v117 offset:26624
  ds_read_b64_tr_b16 v[146:147], v117 offset:27136
  buffer_load_dwordx4 a[60:63], v105, s[4:7], s16 offen offset:1024 sc1
  v_mfma_f32_16x16x32_bf16 v[68:71], v[152:155], a[12:15], v[68:71]
  s_add_u32 s40, s20, 0x40000
  s_addc_u32 s41, s21, 0
  s_mov_b32 s42, 0x0
  s_mov_b32 s43, 0x20000
  s_or_b32 s33, s2, s3
  s_cmp_eq_u32 s33, 0
  s_cselect_b32 s42, 4, 0
  v_mov_b32 v192, s19
  buffer_store_dword v192, v119, s[40:43], 0 offen sc1
  v_mfma_f32_16x16x32_bf16 v[24:27], v[156:159], a[8:11], v[24:27]
  ds_read_b64_tr_b16 v[148:149], v114 offset:27648
  ds_read_b64_tr_b16 v[150:151], v114 offset:28160
  s_add_u32 s16, s16, 131072
  v_mfma_f32_16x16x32_bf16 v[72:75], v[156:159], a[12:15], v[72:75]
  ds_read_b64_tr_b16 v[152:153], v115 offset:27648
  s_bitset0_b32 s16, 20
  v_mfma_f32_16x16x32_bf16 v[28:31], v[160:163], a[8:11], v[28:31]
  ds_read_b64_tr_b16 v[154:155], v115 offset:28160
  s_add_u32 s4, s4, s6
  s_addc_u32 s5, s5, 0
  v_mfma_f32_16x16x32_bf16 v[76:79], v[160:163], a[12:15], v[76:79]
  ds_read_b64_tr_b16 v[156:157], v116 offset:27648
  s_add_u32 m0, s38, 0
  v_mfma_f32_16x16x32_bf16 v[32:35], a[8:11], v[164:167], v[32:35]
  ds_read_b64_tr_b16 v[158:159], v116 offset:28160
  buffer_load_dwordx4 v107, s[8:11], s17 offen lds
  v_mfma_f32_16x16x32_bf16 v[80:83], a[12:15], v[164:167], v[80:83]
  ds_read_b64_tr_b16 v[160:161], v117 offset:27648
  ds_read_b64_tr_b16 v[162:163], v117 offset:28160
  v_mfma_f32_16x16x32_bf16 v[36:39], a[8:11], v[168:171], v[36:39]
  buffer_load_dwordx4 v108, s[8:11], s17 offen offset:1024 lds
  v_mfma_f32_16x16x32_bf16 v[84:87], a[12:15], v[168:171], v[84:87]
  buffer_load_dwordx4 v109, s[8:11], s17 offen offset:2048 lds
  v_mfma_f32_16x16x32_bf16 v[40:43], a[8:11], v[172:175], v[40:43]
  ds_read_b64_tr_b16 v[164:165], v114 offset:28672
  ds_read_b64_tr_b16 v[166:167], v114 offset:29184
  s_add_u32 s17, s17, 196608
  v_mfma_f32_16x16x32_bf16 v[88:91], a[12:15], v[172:175], v[88:91]
  s_cmp_eq_u32 s17, s10
  s_cselect_b32 s17, 0, s17
  v_mfma_f32_16x16x32_bf16 v[44:47], a[8:11], v[176:179], v[44:47]
  ds_read_b64_tr_b16 v[168:169], v115 offset:28672
  ds_read_b64_tr_b16 v[170:171], v115 offset:29184
  v_mfma_f32_16x16x32_bf16 v[92:95], a[12:15], v[176:179], v[92:95]
  s_waitcnt vmcnt(8) lgkmcnt(10)
  s_barrier
  v_cmp_ne_u32 vcc, s19, v127
  s_nop 1
  s_cmp_lg_u64 vcc, 0
  s_cbranch_scc1 L_slow_9
  L_back_10:
  v_mfma_f32_16x16x32_bf16 v[96:99], v[180:183], v[188:191], v[96:99]
  ds_read_b64_tr_b16 v[172:173], v116 offset:28672
  ds_read_b64_tr_b16 v[174:175], v116 offset:29184
  s_add_u32 m0, s39, 0
  v_mfma_f32_16x16x32_bf16 v[100:103], v[188:191], v[184:187], v[100:103]
  buffer_load_dword v106, s[4:7], s16 offen sc1 lds
  v_mfma_f32_16x16x32_bf16 v[0:3], v[132:135], a[16:19], v[0:3]
  ds_read_b64_tr_b16 v[176:177], v117 offset:28672
  ds_read_b64_tr_b16 v[178:179], v117 offset:29184
  buffer_load_dwordx4 a[0:3], v105, s[4:7], s16 offen sc1
  v_mfma_f32_16x16x32_bf16 v[48:51], v[132:135], a[20:23], v[48:51]
  ds_read_b64_tr_b16 v[180:181], v118 offset:40960
  ds_read_b64_tr_b16 v[182:183], v118 offset:41472
  buffer_load_dwordx4 a[4:7], v105, s[4:7], s16 offen offset:1024 sc1
  v_mfma_f32_16x16x32_bf16 v[4:7], v[136:139], a[16:19], v[4:7]
  ds_read_b128 v[188:191], v119 offset:52224
  ds_read_b64_tr_b16 v[184:185], v118 offset:41984
  ds_read_b64_tr_b16 v[186:187], v118 offset:42496
  v_mfma_f32_16x16x32_bf16 v[52:55], v[136:139], a[20:23], v[52:55]
  ds_read_b64_tr_b16 v[132:133], v114 offset:39936
  s_add_u32 s16, s16, 131072
  v_mfma_f32_16x16x32_bf16 v[8:11], v[140:143], a[16:19], v[8:11]
  ds_read_b64_tr_b16 v[134:135], v114 offset:40448
  s_bitset0_b32 s16, 20
  v_mfma_f32_16x16x32_bf16 v[56:59], v[140:143], a[20:23], v[56:59]
  ds_read_b64_tr_b16 v[136:137], v115 offset:39936
  s_add_u32 m0, s38, 13312
  v_mfma_f32_16x16x32_bf16 v[12:15], v[144:147], a[16:19], v[12:15]
  ds_read_b64_tr_b16 v[138:139], v115 offset:40448
  ds_read_b64_tr_b16 v[140:141], v116 offset:39936
  v_mfma_f32_16x16x32_bf16 v[60:63], v[144:147], a[20:23], v[60:63]
  buffer_load_dwordx4 v107, s[8:11], s17 offen lds
  v_mfma_f32_16x16x32_bf16 v[16:19], v[148:151], a[16:19], v[16:19]
  ds_read_b64_tr_b16 v[142:143], v116 offset:40448
  buffer_load_dwordx4 v108, s[8:11], s17 offen offset:1024 lds
  v_mfma_f32_16x16x32_bf16 v[64:67], v[148:151], a[20:23], v[64:67]
  buffer_load_dwordx4 v109, s[8:11], s17 offen offset:2048 lds
  s_waitcnt lgkmcnt(10)
  v_mfma_f32_16x16x32_bf16 v[20:23], v[152:155], a[16:19], v[20:23]
  ds_read_b64_tr_b16 v[144:145], v117 offset:39936
  ds_read_b64_tr_b16 v[146:147], v117 offset:40448
  v_mfma_f32_16x16x32_bf16 v[68:71], v[152:155], a[20:23], v[68:71]
  ds_read_b64_tr_b16 v[148:149], v114 offset:40960
  s_add_u32 s17, s17, 196608
  v_mfma_f32_16x16x32_bf16 v[24:27], v[156:159], a[16:19], v[24:27]
  ds_read_b64_tr_b16 v[150:151], v114 offset:41472
  s_cmp_eq_u32 s17, s10
  v_mfma_f32_16x16x32_bf16 v[72:75], v[156:159], a[20:23], v[72:75]
  ds_read_b64_tr_b16 v[152:153], v115 offset:40960
  s_cselect_b32 s17, 0, s17
  v_mfma_f32_16x16x32_bf16 v[28:31], v[160:163], a[16:19], v[28:31]
  ds_read_b64_tr_b16 v[154:155], v115 offset:41472
  ds_read_b64_tr_b16 v[156:157], v116 offset:40960
  v_mfma_f32_16x16x32_bf16 v[76:79], v[160:163], a[20:23], v[76:79]
  ds_read_b64_tr_b16 v[158:159], v116 offset:41472
  s_add_u32 m0, s39, 13312
  v_mfma_f32_16x16x32_bf16 v[32:35], a[16:19], v[164:167], v[32:35]
  buffer_load_dword v106, s[4:7], s16 offen sc1 lds
  v_mfma_f32_16x16x32_bf16 v[80:83], a[20:23], v[164:167], v[80:83]
  buffer_load_dwordx4 a[8:11], v105, s[4:7], s16 offen sc1
  v_mfma_f32_16x16x32_bf16 v[36:39], a[16:19], v[168:171], v[36:39]
  ds_read_b64_tr_b16 v[160:161], v117 offset:40960
  ds_read_b64_tr_b16 v[162:163], v117 offset:41472
  v_mfma_f32_16x16x32_bf16 v[84:87], a[20:23], v[168:171], v[84:87]
  buffer_load_dwordx4 a[12:15], v105, s[4:7], s16 offen offset:1024 sc1
  v_mfma_f32_16x16x32_bf16 v[40:43], a[16:19], v[172:175], v[40:43]
  ds_read_b64_tr_b16 v[164:165], v114 offset:41984
  ds_read_b64_tr_b16 v[166:167], v114 offset:42496
  s_add_u32 s16, s16, 131072
  v_mfma_f32_16x16x32_bf16 v[88:91], a[20:23], v[172:175], v[88:91]
  ds_read_b64_tr_b16 v[168:169], v115 offset:41984
  s_bitset0_b32 s16, 20
  v_mfma_f32_16x16x32_bf16 v[44:47], a[16:19], v[176:179], v[44:47]
  ds_read_b64_tr_b16 v[170:171], v115 offset:42496
  ds_read_b64_tr_b16 v[172:173], v116 offset:41984
  v_mfma_f32_16x16x32_bf16 v[92:95], a[20:23], v[176:179], v[92:95]
  s_waitcnt vmcnt(26) lgkmcnt(10)
  s_barrier
  v_mfma_f32_16x16x32_bf16 v[96:99], v[180:183], v[188:191], v[96:99]
  ds_read_b64_tr_b16 v[174:175], v116 offset:42496
  s_add_u32 m0, s38, 26624
  v_mfma_f32_16x16x32_bf16 v[100:103], v[188:191], v[184:187], v[100:103]
  buffer_load_dwordx4 v107, s[8:11], s17 offen lds
  v_mfma_f32_16x16x32_bf16 v[0:3], v[132:135], a[24:27], v[0:3]
  ds_read_b64_tr_b16 v[176:177], v117 offset:41984
  ds_read_b64_tr_b16 v[178:179], v117 offset:42496
  v_mfma_f32_16x16x32_bf16 v[48:51], v[132:135], a[28:31], v[48:51]
  ds_read_b64_tr_b16 v[180:181], v124 offset:1024
  ds_read_b64_tr_b16 v[182:183], v124 offset:1536
  buffer_load_dwordx4 v108, s[8:11], s17 offen offset:1024 lds
  v_mfma_f32_16x16x32_bf16 v[4:7], v[136:139], a[24:27], v[4:7]
  ds_read_b128 v[188:191], v125 offset:12288
  ds_read_b64_tr_b16 v[184:185], v124 offset:2048
  ds_read_b64_tr_b16 v[186:187], v124 offset:2560
  v_mfma_f32_16x16x32_bf16 v[52:55], v[136:139], a[28:31], v[52:55]
  buffer_load_dwordx4 v109, s[8:11], s17 offen offset:2048 lds
  v_mfma_f32_16x16x32_bf16 v[8:11], v[140:143], a[24:27], v[8:11]
  ds_read_b64_tr_b16 v[132:133], v120 offset:0
  ds_read_b64_tr_b16 v[134:135], v120 offset:512
  v_mfma_f32_16x16x32_bf16 v[56:59], v[140:143], a[28:31], v[56:59]
  ds_read_b64_tr_b16 v[136:137], v121 offset:0
  s_add_u32 s17, s17, 196608
  v_mfma_f32_16x16x32_bf16 v[12:15], v[144:147], a[24:27], v[12:15]
  ds_read_b64_tr_b16 v[138:139], v121 offset:512
  ds_read_b64_tr_b16 v[140:141], v122 offset:0
  v_mfma_f32_16x16x32_bf16 v[60:63], v[144:147], a[28:31], v[60:63]
  ds_read_b64_tr_b16 v[142:143], v122 offset:512
  s_cmp_eq_u32 s17, s10
  v_mfma_f32_16x16x32_bf16 v[16:19], v[148:151], a[24:27], v[16:19]
  ds_read_b64_tr_b16 v[144:145], v123 offset:0
  ds_read_b64_tr_b16 v[146:147], v123 offset:512
  v_mfma_f32_16x16x32_bf16 v[64:67], v[148:151], a[28:31], v[64:67]
  ds_read_b64_tr_b16 v[148:149], v120 offset:1024
  s_cselect_b32 s17, 0, s17
  s_waitcnt lgkmcnt(10)
  v_mfma_f32_16x16x32_bf16 v[20:23], v[152:155], a[24:27], v[20:23]
  ds_read_b64_tr_b16 v[150:151], v120 offset:1536
  v_mfma_f32_16x16x32_bf16 v[68:71], v[152:155], a[28:31], v[68:71]
  ds_read_b64_tr_b16 v[152:153], v121 offset:1024
  s_add_u32 m0, s39, 26624
  v_mfma_f32_16x16x32_bf16 v[24:27], v[156:159], a[24:27], v[24:27]
  ds_read_b64_tr_b16 v[154:155], v121 offset:1536
  v_mfma_f32_16x16x32_bf16 v[72:75], v[156:159], a[28:31], v[72:75]
  buffer_load_dword v106, s[4:7], s16 offen sc1 lds
  v_mfma_f32_16x16x32_bf16 v[28:31], v[160:163], a[24:27], v[28:31]
  ds_read_b64_tr_b16 v[156:157], v122 offset:1024
  ds_read_b64_tr_b16 v[158:159], v122 offset:1536
  v_mfma_f32_16x16x32_bf16 v[76:79], v[160:163], a[28:31], v[76:79]
  buffer_load_dwordx4 a[16:19], v105, s[4:7], s16 offen sc1
  v_mfma_f32_16x16x32_bf16 v[32:35], a[24:27], v[164:167], v[32:35]
  ds_read_b64_tr_b16 v[160:161], v123 offset:1024
  ds_read_b64_tr_b16 v[162:163], v123 offset:1536
  v_mfma_f32_16x16x32_bf16 v[80:83], a[28:31], v[164:167], v[80:83]
  buffer_load_dwordx4 a[20:23], v105, s[4:7], s16 offen offset:1024 sc1
  v_mfma_f32_16x16x32_bf16 v[36:39], a[24:27], v[168:171], v[36:39]
  ds_read_b64_tr_b16 v[164:165], v120 offset:2048
  ds_read_b64_tr_b16 v[166:167], v120 offset:2560
  v_mfma_f32_16x16x32_bf16 v[84:87], a[28:31], v[168:171], v[84:87]
  ds_read_b64_tr_b16 v[168:169], v121 offset:2048
  s_add_u32 s16, s16, 131072
  v_mfma_f32_16x16x32_bf16 v[40:43], a[24:27], v[172:175], v[40:43]
  ds_read_b64_tr_b16 v[170:171], v121 offset:2560
  v_mfma_f32_16x16x32_bf16 v[88:91], a[28:31], v[172:175], v[88:91]
  ds_read_b64_tr_b16 v[172:173], v122 offset:2048
  s_bitset0_b32 s16, 20
  v_mfma_f32_16x16x32_bf16 v[44:47], a[24:27], v[176:179], v[44:47]
  ds_read_b64_tr_b16 v[174:175], v122 offset:2560
  v_mfma_f32_16x16x32_bf16 v[92:95], a[28:31], v[176:179], v[92:95]
  s_waitcnt vmcnt(29) lgkmcnt(10)
  s_barrier
  v_mfma_f32_16x16x32_bf16 v[96:99], v[180:183], v[188:191], v[96:99]
  ds_read_b64_tr_b16 v[176:177], v123 offset:2048
  s_add_u32 m0, s38, 39936
  v_mfma_f32_16x16x32_bf16 v[100:103], v[188:191], v[184:187], v[100:103]
  buffer_load_dwordx4 v107, s[8:11], s17 offen lds
  v_mfma_f32_16x16x32_bf16 v[0:3], v[132:135], a[32:35], v[0:3]
  ds_read_b64_tr_b16 v[178:179], v123 offset:2560
  buffer_load_dwordx4 v108, s[8:11], s17 offen offset:1024 lds
  v_mfma_f32_16x16x32_bf16 v[48:51], v[132:135], a[36:39], v[48:51]
  ds_read_b64_tr_b16 v[180:181], v124 offset:14336
  ds_read_b64_tr_b16 v[182:183], v124 offset:14848
  buffer_load_dwordx4 v109, s[8:11], s17 offen offset:2048 lds
  v_mfma_f32_16x16x32_bf16 v[4:7], v[136:139], a[32:35], v[4:7]
  ds_read_b128 v[188:191], v125 offset:25600
  ds_read_b64_tr_b16 v[184:185], v124 offset:15360
  ds_read_b64_tr_b16 v[186:187], v124 offset:15872
  s_add_u32 s17, s17, 196608
  v_mfma_f32_16x16x32_bf16 v[52:55], v[136:139], a[36:39], v[52:55]
  ds_read_b64_tr_b16 v[132:133], v120 offset:13312
  s_cmp_eq_u32 s17, s10
  v_mfma_f32_16x16x32_bf16 v[8:11], v[140:143], a[32:35], v[8:11]
  ds_read_b64_tr_b16 v[134:135], v120 offset:13824
  s_cselect_b32 s17, 0, s17
  v_mfma_f32_16x16x32_bf16 v[56:59], v[140:143], a[36:39], v[56:59]
  ds_read_b64_tr_b16 v[136:137], v121 offset:13312
  s_add_u32 m0, s39, 39936
  v_mfma_f32_16x16x32_bf16 v[12:15], v[144:147], a[32:35], v[12:15]
  ds_read_b64_tr_b16 v[138:139], v121 offset:13824
  ds_read_b64_tr_b16 v[140:141], v122 offset:13312
  v_mfma_f32_16x16x32_bf16 v[60:63], v[144:147], a[36:39], v[60:63]
  buffer_load_dword v106, s[4:7], s16 offen sc1 lds
  v_mfma_f32_16x16x32_bf16 v[16:19], v[148:151], a[32:35], v[16:19]
  ds_read_b64_tr_b16 v[142:143], v122 offset:13824
  buffer_load_dwordx4 a[24:27], v105, s[4:7], s16 offen sc1
  v_mfma_f32_16x16x32_bf16 v[64:67], v[148:151], a[36:39], v[64:67]
  buffer_load_dwordx4 a[28:31], v105, s[4:7], s16 offen offset:1024 sc1
  v_mfma_f32_16x16x32_bf16 v[20:23], v[152:155], a[32:35], v[20:23]
  ds_read_b64_tr_b16 v[144:145], v123 offset:13312
  ds_read_b64_tr_b16 v[146:147], v123 offset:13824
  s_add_u32 s16, s16, 131072
  v_mfma_f32_16x16x32_bf16 v[68:71], v[152:155], a[36:39], v[68:71]
  ds_read_b64_tr_b16 v[148:149], v120 offset:14336
  s_bitset0_b32 s16, 20
  s_waitcnt lgkmcnt(10)
  v_mfma_f32_16x16x32_bf16 v[24:27], v[156:159], a[32:35], v[24:27]
  ds_read_b64_tr_b16 v[150:151], v120 offset:14848
  s_mov_b32 m0, s51
  v_mfma_f32_16x16x32_bf16 v[72:75], v[156:159], a[36:39], v[72:75]
  ds_read_b64_tr_b16 v[152:153], v121 offset:14336
  s_add_u32 s51, s51, 1024
  v_mfma_f32_16x16x32_bf16 v[28:31], v[160:163], a[32:35], v[28:31]
  ds_read_b64_tr_b16 v[154:155], v121 offset:14848
  ds_read_b64_tr_b16 v[156:157], v122 offset:14336
  v_mfma_f32_16x16x32_bf16 v[76:79], v[160:163], a[36:39], v[76:79]
  buffer_load_dwordx4 v129, s[52:55], s50 offen nt lds
  v_mfma_f32_16x16x32_bf16 v[32:35], a[32:35], v[164:167], v[32:35]
  ds_read_b64_tr_b16 v[158:159], v122 offset:14848
  s_add_u32 s50, s50, 98304
  v_mfma_f32_16x16x32_bf16 v[80:83], a[36:39], v[164:167], v[80:83]
  ds_read_b64_tr_b16 v[160:161], v123 offset:14336
  s_mov_b32 m0, s51
  v_mfma_f32_16x16x32_bf16 v[36:39], a[32:35], v[168:171], v[36:39]
  ds_read_b64_tr_b16 v[162:163], v123 offset:14848
  s_add_u32 s51, s51, 1024
  v_mfma_f32_16x16x32_bf16 v[84:87], a[36:39], v[168:171], v[84:87]
  buffer_load_dwordx4 v129, s[52:55], s50 offen nt lds
  v_mfma_f32_16x16x32_bf16 v[40:43], a[32:35], v[172:175], v[40:43]
  ds_read_b64_tr_b16 v[164:165], v120 offset:15360
  ds_read_b64_tr_b16 v[166:167], v120 offset:15872
  s_add_u32 s50, s50, 98304
  v_mfma_f32_16x16x32_bf16 v[88:91], a[36:39], v[172:175], v[88:91]
  buffer_store_dwordx4 v[244:247], v119, s[92:95], s35 offen offset:0 sc1
  v_mfma_f32_16x16x32_bf16 v[44:47], a[32:35], v[176:179], v[44:47]
  ds_read_b64_tr_b16 v[168:169], v121 offset:15360
  ds_read_b64_tr_b16 v[170:171], v121 offset:15872
  v_mfma_f32_16x16x32_bf16 v[92:95], a[36:39], v[176:179], v[92:95]
  s_waitcnt vmcnt(35) lgkmcnt(10)
  s_barrier
  v_mfma_f32_16x16x32_bf16 v[96:99], v[180:183], v[188:191], v[96:99]
  ds_read_b64_tr_b16 v[172:173], v122 offset:15360
  ds_read_b64_tr_b16 v[174:175], v122 offset:15872
  s_add_u32 m0, s38, 53248
  v_mfma_f32_16x16x32_bf16 v[100:103], v[188:191], v[184:187], v[100:103]
  buffer_load_dwordx4 v107, s[8:11], s17 offen lds
  v_mfma_f32_16x16x32_bf16 v[0:3], v[132:135], a[40:43], v[0:3]
  ds_read_b64_tr_b16 v[176:177], v123 offset:15360
  ds_read_b64_tr_b16 v[178:179], v123 offset:15872
  v_mfma_f32_16x16x32_bf16 v[48:51], v[132:135], a[44:47], v[48:51]
  ds_read_b64_tr_b16 v[180:181], v124 offset:27648
  ds_read_b64_tr_b16 v[182:183], v124 offset:28160
  buffer_load_dwordx4 v108, s[8:11], s17 offen offset:1024 lds
  v_mfma_f32_16x16x32_bf16 v[4:7], v[136:139], a[40:43], v[4:7]
  ds_read_b128 v[188:191], v125 offset:38912
  ds_read_b64_tr_b16 v[184:185], v124 offset:28672
  ds_read_b64_tr_b16 v[186:187], v124 offset:29184
  v_mfma_f32_16x16x32_bf16 v[52:55], v[136:139], a[44:47], v[52:55]
  buffer_load_dwordx4 v109, s[8:11], s17 offen offset:2048 lds
  v_mfma_f32_16x16x32_bf16 v[8:11], v[140:143], a[40:43], v[8:11]
  ds_read_b64_tr_b16 v[132:133], v120 offset:26624
  ds_read_b64_tr_b16 v[134:135], v120 offset:27136
  v_mfma_f32_16x16x32_bf16 v[56:59], v[140:143], a[44:47], v[56:59]
  ds_read_b64_tr_b16 v[136:137], v121 offset:26624
  s_add_u32 s17, s17, 196608
  v_mfma_f32_16x16x32_bf16 v[12:15], v[144:147], a[40:43], v[12:15]
  ds_read_b64_tr_b16 v[138:139], v121 offset:27136
  ds_read_b64_tr_b16 v[140:141], v122 offset:26624
  v_mfma_f32_16x16x32_bf16 v[60:63], v[144:147], a[44:47], v[60:63]
  ds_read_b64_tr_b16 v[142:143], v122 offset:27136
  s_cmp_eq_u32 s17, s10
  v_mfma_f32_16x16x32_bf16 v[16:19], v[148:151], a[40:43], v[16:19]
  ds_read_b64_tr_b16 v[144:145], v123 offset:26624
  ds_read_b64_tr_b16 v[146:147], v123 offset:27136
  v_mfma_f32_16x16x32_bf16 v[64:67], v[148:151], a[44:47], v[64:67]
  ds_read_b64_tr_b16 v[148:149], v120 offset:27648
  s_cselect_b32 s17, 0, s17
  s_waitcnt lgkmcnt(10)
  v_mfma_f32_16x16x32_bf16 v[20:23], v[152:155], a[40:43], v[20:23]
  ds_read_b64_tr_b16 v[150:151], v120 offset:28160
  v_mfma_f32_16x16x32_bf16 v[68:71], v[152:155], a[44:47], v[68:71]
  ds_read_b64_tr_b16 v[152:153], v121 offset:27648
  s_add_u32 m0, s39, 53248
  v_mfma_f32_16x16x32_bf16 v[24:27], v[156:159], a[40:43], v[24:27]
  ds_read_b64_tr_b16 v[154:155], v121 offset:28160
  v_mfma_f32_16x16x32_bf16 v[72:75], v[156:159], a[44:47], v[72:75]
  buffer_load_dword v106, s[4:7], s16 offen sc1 lds
  v_mfma_f32_16x16x32_bf16 v[28:31], v[160:163], a[40:43], v[28:31]
  ds_read_b64_tr_b16 v[156:157], v122 offset:27648
  ds_read_b64_tr_b16 v[158:159], v122 offset:28160
  v_mfma_f32_16x16x32_bf16 v[76:79], v[160:163], a[44:47], v[76:79]
  buffer_load_dwordx4 a[32:35], v105, s[4:7], s16 offen sc1
  v_mfma_f32_16x16x32_bf16 v[32:35], a[40:43], v[164:167], v[32:35]
  ds_read_b64_tr_b16 v[160:161], v123 offset:27648
  ds_read_b64_tr_b16 v[162:163], v123 offset:28160
  v_mfma_f32_16x16x32_bf16 v[80:83], a[44:47], v[164:167], v[80:83]
  buffer_load_dwordx4 a[36:39], v105, s[4:7], s16 offen offset:1024 sc1
  v_mfma_f32_16x16x32_bf16 v[36:39], a[40:43], v[168:171], v[36:39]
  ds_read_b64_tr_b16 v[164:165], v120 offset:28672
  ds_read_b64_tr_b16 v[166:167], v120 offset:29184
  v_mfma_f32_16x16x32_bf16 v[84:87], a[44:47], v[168:171], v[84:87]
  ds_read_b64_tr_b16 v[168:169], v121 offset:28672
  s_add_u32 s16, s16, 131072
  v_mfma_f32_16x16x32_bf16 v[40:43], a[40:43], v[172:175], v[40:43]
  ds_read_b64_tr_b16 v[170:171], v121 offset:29184
  v_mfma_f32_16x16x32_bf16 v[88:91], a[44:47], v[172:175], v[88:91]
  ds_read_b64_tr_b16 v[172:173], v122 offset:28672
  s_bitset0_b32 s16, 20
  v_mfma_f32_16x16x32_bf16 v[44:47], a[40:43], v[176:179], v[44:47]
  ds_read_b64_tr_b16 v[174:175], v122 offset:29184
  v_mfma_f32_16x16x32_bf16 v[92:95], a[44:47], v[176:179], v[92:95]
  s_waitcnt vmcnt(34) lgkmcnt(10)
  s_barrier
  v_mfma_f32_16x16x32_bf16 v[96:99], v[180:183], v[188:191], v[96:99]
  ds_read_b64_tr_b16 v[176:177], v123 offset:28672
  s_add_u32 m0, s38, 66560
  v_mfma_f32_16x16x32_bf16 v[100:103], v[188:191], v[184:187], v[100:103]
  buffer_load_dwordx4 v107, s[8:11], s17 offen lds
  v_mfma_f32_16x16x32_bf16 v[0:3], v[132:135], a[48:51], v[0:3]
  ds_read_b64_tr_b16 v[178:179], v123 offset:29184
  ds_read_b64_tr_b16 v[180:181], v124 offset:40960
  v_mfma_f32_16x16x32_bf16 v[48:51], v[132:135], a[52:55], v[48:51]
  ds_read_b64_tr_b16 v[182:183], v124 offset:41472
  buffer_load_dwordx4 v108, s[8:11], s17 offen offset:1024 lds
  v_mfma_f32_16x16x32_bf16 v[4:7], v[136:139], a[48:51], v[4:7]
  ds_read_b128 v[188:191], v125 offset:52224
  ds_read_b64_tr_b16 v[184:185], v124 offset:41984
  ds_read_b64_tr_b16 v[186:187], v124 offset:42496
  v_mfma_f32_16x16x32_bf16 v[52:55], v[136:139], a[52:55], v[52:55]
  buffer_load_dwordx4 v109, s[8:11], s17 offen offset:2048 lds
  v_mfma_f32_16x16x32_bf16 v[8:11], v[140:143], a[48:51], v[8:11]
  ds_read_b64_tr_b16 v[132:133], v120 offset:39936
  ds_read_b64_tr_b16 v[134:135], v120 offset:40448
  v_mfma_f32_16x16x32_bf16 v[56:59], v[140:143], a[52:55], v[56:59]
  ds_read_b64_tr_b16 v[136:137], v121 offset:39936
  s_add_u32 s17, s17, 196608
  v_mfma_f32_16x16x32_bf16 v[12:15], v[144:147], a[48:51], v[12:15]
  ds_read_b64_tr_b16 v[138:139], v121 offset:40448
  ds_read_b64_tr_b16 v[140:141], v122 offset:39936
  v_mfma_f32_16x16x32_bf16 v[60:63], v[144:147], a[52:55], v[60:63]
  ds_read_b64_tr_b16 v[142:143], v122 offset:40448
  s_cmp_eq_u32 s17, s10
  v_mfma_f32_16x16x32_bf16 v[16:19], v[148:151], a[48:51], v[16:19]
  ds_read_b64_tr_b16 v[144:145], v123 offset:39936
  ds_read_b64_tr_b16 v[146:147], v123 offset:40448
  v_mfma_f32_16x16x32_bf16 v[64:67], v[148:151], a[52:55], v[64:67]
  ds_read_b64_tr_b16 v[148:149], v120 offset:40960
  s_cselect_b32 s17, 0, s17
  v_mfma_f32_16x16x32_bf16 v[20:23], v[152:155], a[48:51], v[20:23]
  ds_read_b64_tr_b16 v[150:151], v120 offset:41472
  v_mfma_f32_16x16x32_bf16 v[68:71], v[152:155], a[52:55], v[68:71]
  ds_read_b64_tr_b16 v[152:153], v121 offset:40960
  s_add_u32 m0, s39, 66560
  s_waitcnt lgkmcnt(10)
  v_mfma_f32_16x16x32_bf16 v[24:27], v[156:159], a[48:51], v[24:27]
  ds_read_b64_tr_b16 v[154:155], v121 offset:41472
  v_mfma_f32_16x16x32_bf16 v[72:75], v[156:159], a[52:55], v[72:75]
  buffer_load_dword v106, s[4:7], s16 offen sc1 lds
  v_mfma_f32_16x16x32_bf16 v[28:31], v[160:163], a[48:51], v[28:31]
  ds_read_b64_tr_b16 v[156:157], v122 offset:40960
  ds_read_b64_tr_b16 v[158:159], v122 offset:41472
  v_mfma_f32_16x16x32_bf16 v[76:79], v[160:163], a[52:55], v[76:79]
  buffer_load_dwordx4 a[40:43], v105, s[4:7], s16 offen sc1
  v_mfma_f32_16x16x32_bf16 v[32:35], a[48:51], v[164:167], v[32:35]
  ds_read_b64_tr_b16 v[160:161], v123 offset:40960
  ds_read_b64_tr_b16 v[162:163], v123 offset:41472
  v_mfma_f32_16x16x32_bf16 v[80:83], a[52:55], v[164:167], v[80:83]
  buffer_load_dwordx4 a[44:47], v105, s[4:7], s16 offen offset:1024 sc1
  v_mfma_f32_16x16x32_bf16 v[36:39], a[48:51], v[168:171], v[36:39]
  ds_read_b64_tr_b16 v[164:165], v120 offset:41984
  ds_read_b64_tr_b16 v[166:167], v120 offset:42496
  v_mfma_f32_16x16x32_bf16 v[84:87], a[52:55], v[168:171], v[84:87]
  ds_read_b64_tr_b16 v[168:169], v121 offset:41984
  s_add_u32 s16, s16, 131072
  v_mfma_f32_16x16x32_bf16 v[40:43], a[48:51], v[172:175], v[40:43]
  ds_read_b64_tr_b16 v[170:171], v121 offset:42496
  v_mfma_f32_16x16x32_bf16 v[88:91], a[52:55], v[172:175], v[88:91]
  ds_read_b64_tr_b16 v[172:173], v122 offset:41984
  s_bitset0_b32 s16, 20
  v_mfma_f32_16x16x32_bf16 v[44:47], a[48:51], v[176:179], v[44:47]
  ds_read_b64_tr_b16 v[174:175], v122 offset:42496
  v_mfma_f32_16x16x32_bf16 v[92:95], a[52:55], v[176:179], v[92:95]
  s_waitcnt vmcnt(33) lgkmcnt(10)
  s_barrier
  v_mfma_f32_16x16x32_bf16 v[96:99], v[180:183], v[188:191], v[96:99]
  ds_read_b64_tr_b16 v[176:177], v123 offset:41984
  s_add_u32 m0, s38, 79872
  v_mfma_f32_16x16x32_bf16 v[100:103], v[188:191], v[184:187], v[100:103]
  buffer_load_dwordx4 v107, s[8:11], s17 offen lds
  v_mfma_f32_16x16x32_bf16 v[0:3], v[132:135], a[56:59], v[0:3]
  ds_read_b64_tr_b16 v[178:179], v123 offset:42496
  ds_read_b64_tr_b16 v[180:181], v118 offset:1024
  v_mfma_f32_16x16x32_bf16 v[48:51], v[132:135], a[60:63], v[48:51]
  ds_read_b64_tr_b16 v[182:183], v118 offset:1536
  buffer_load_dwordx4 v108, s[8:11], s17 offen offset:1024 lds
  v_mfma_f32_16x16x32_bf16 v[4:7], v[136:139], a[56:59], v[4:7]
  ds_read_b128 v[188:191], v119 offset:12288
  ds_read_b64_tr_b16 v[184:185], v118 offset:2048
  ds_read_b64_tr_b16 v[186:187], v118 offset:2560
  v_mfma_f32_16x16x32_bf16 v[52:55], v[136:139], a[60:63], v[52:55]
  buffer_load_dwordx4 v109, s[8:11], s17 offen offset:2048 lds
  v_mfma_f32_16x16x32_bf16 v[8:11], v[140:143], a[56:59], v[8:11]
  ds_read_b64_tr_b16 v[132:133], v114 offset:0
  ds_read_b64_tr_b16 v[134:135], v114 offset:512
  v_mfma_f32_16x16x32_bf16 v[56:59], v[140:143], a[60:63], v[56:59]
  ds_read_b64_tr_b16 v[136:137], v115 offset:0
  s_add_u32 s17, s17, 196608
  v_mfma_f32_16x16x32_bf16 v[12:15], v[144:147], a[56:59], v[12:15]
  ds_read_b64_tr_b16 v[138:139], v115 offset:512
  ds_read_b64_tr_b16 v[140:141], v116 offset:0
  v_mfma_f32_16x16x32_bf16 v[60:63], v[144:147], a[60:63], v[60:63]
  ds_read_b64_tr_b16 v[142:143], v116 offset:512
  s_cmp_eq_u32 s17, s10
  v_mfma_f32_16x16x32_bf16 v[16:19], v[148:151], a[56:59], v[16:19]
  ds_read_b64_tr_b16 v[144:145], v117 offset:0
  ds_read_b64_tr_b16 v[146:147], v117 offset:512
  v_mfma_f32_16x16x32_bf16 v[64:67], v[148:151], a[60:63], v[64:67]
  ds_read_b64_tr_b16 v[148:149], v114 offset:1024
  s_cselect_b32 s17, 0, s17
  v_mfma_f32_16x16x32_bf16 v[20:23], v[152:155], a[56:59], v[20:23]
  ds_read_b64_tr_b16 v[150:151], v114 offset:1536
  v_mfma_f32_16x16x32_bf16 v[68:71], v[152:155], a[60:63], v[68:71]
  ds_read_b64_tr_b16 v[152:153], v115 offset:1024
  s_add_u32 m0, s39, 79872
  s_waitcnt lgkmcnt(10)
  v_mfma_f32_16x16x32_bf16 v[24:27], v[156:159], a[56:59], v[24:27]
  ds_read_b64_tr_b16 v[154:155], v115 offset:1536
  v_mfma_f32_16x16x32_bf16 v[72:75], v[156:159], a[60:63], v[72:75]
  buffer_load_dword v106, s[4:7], s16 offen sc1 lds
  v_mfma_f32_16x16x32_bf16 v[28:31], v[160:163], a[56:59], v[28:31]
  ds_read_b64_tr_b16 v[156:157], v116 offset:1024
  ds_read_b64_tr_b16 v[158:159], v116 offset:1536
  v_mfma_f32_16x16x32_bf16 v[76:79], v[160:163], a[60:63], v[76:79]
  buffer_load_dwordx4 a[48:51], v105, s[4:7], s16 offen sc1
  v_mfma_f32_16x16x32_bf16 v[32:35], a[56:59], v[164:167], v[32:35]
  ds_read_b64_tr_b16 v[160:161], v117 offset:1024
  ds_read_b64_tr_b16 v[162:163], v117 offset:1536
  v_mfma_f32_16x16x32_bf16 v[80:83], a[60:63], v[164:167], v[80:83]
  buffer_load_dwordx4 a[52:55], v105, s[4:7], s16 offen offset:1024 sc1
  v_mfma_f32_16x16x32_bf16 v[36:39], a[56:59], v[168:171], v[36:39]
  ds_read_b64_tr_b16 v[164:165], v114 offset:2048
  ds_read_b64_tr_b16 v[166:167], v114 offset:2560
  v_mfma_f32_16x16x32_bf16 v[84:87], a[60:63], v[168:171], v[84:87]
  ds_read_b64_tr_b16 v[168:169], v115 offset:2048
  s_add_u32 s16, s16, 131072
  v_mfma_f32_16x16x32_bf16 v[40:43], a[56:59], v[172:175], v[40:43]
  ds_read_b64_tr_b16 v[170:171], v115 offset:2560
  v_mfma_f32_16x16x32_bf16 v[88:91], a[60:63], v[172:175], v[88:91]
  ds_read_b64_tr_b16 v[172:173], v116 offset:2048
  s_bitset0_b32 s16, 20
  v_mfma_f32_16x16x32_bf16 v[44:47], a[56:59], v[176:179], v[44:47]
  ds_read_b64_tr_b16 v[174:175], v116 offset:2560
  v_mfma_f32_16x16x32_bf16 v[92:95], a[60:63], v[176:179], v[92:95]
  s_waitcnt vmcnt(33) lgkmcnt(10)
  s_barrier
  v_mfma_f32_16x16x32_bf16 v[96:99], v[180:183], v[188:191], v[96:99]
  ds_read_b64_tr_b16 v[176:177], v117 offset:2048
  s_add_u32 m0, s38, 93184
  v_mfma_f32_16x16x32_bf16 v[100:103], v[188:191], v[184:187], v[100:103]
  buffer_load_dwordx4 v107, s[8:11], s17 offen lds
  v_mfma_f32_16x16x32_bf16 v[0:3], v[132:135], a[0:3], v[0:3]
  ds_read_b64_tr_b16 v[178:179], v117 offset:2560
  buffer_load_dwordx4 v108, s[8:11], s17 offen offset:1024 lds
  v_mfma_f32_16x16x32_bf16 v[48:51], v[132:135], a[4:7], v[48:51]
  ds_read_b64_tr_b16 v[180:181], v118 offset:14336
  ds_read_b64_tr_b16 v[182:183], v118 offset:14848
  buffer_load_dwordx4 v109, s[8:11], s17 offen offset:2048 lds
  v_mfma_f32_16x16x32_bf16 v[4:7], v[136:139], a[0:3], v[4:7]
  ds_read_b128 v[188:191], v119 offset:25600
  ds_read_b64_tr_b16 v[184:185], v118 offset:15360
  ds_read_b64_tr_b16 v[186:187], v118 offset:15872
  s_add_u32 s17, s17, 196608
  v_mfma_f32_16x16x32_bf16 v[52:55], v[136:139], a[4:7], v[52:55]
  ds_read_b64_tr_b16 v[132:133], v114 offset:13312
  s_cmp_eq_u32 s17, s10
  v_mfma_f32_16x16x32_bf16 v[8:11], v[140:143], a[0:3], v[8:11]
  ds_read_b64_tr_b16 v[134:135], v114 offset:13824
  s_cselect_b32 s17, 0, s17
  v_mfma_f32_16x16x32_bf16 v[56:59], v[140:143], a[4:7], v[56:59]
  s_add_u32 s8, s8, s10
  s_addc_u32 s9, s9, 0
  v_mfma_f32_16x16x32_bf16 v[12:15], v[144:147], a[0:3], v[12:15]
  ds_read_b64_tr_b16 v[136:137], v115 offset:13312
  ds_read_b64_tr_b16 v[138:139], v115 offset:13824
  s_add_u32 m0, s39, 93184
  v_mfma_f32_16x16x32_bf16 v[60:63], v[144:147], a[4:7], v[60:63]
  buffer_load_dword v106, s[4:7], s16 offen sc1 lds
  v_mfma_f32_16x16x32_bf16 v[16:19], v[148:151], a[0:3], v[16:19]
  ds_read_b64_tr_b16 v[140:141], v116 offset:13312
  ds_read_b64_tr_b16 v[142:143], v116 offset:13824
  buffer_load_dwordx4 a[56:59], v105, s[4:7], s16 offen sc1
  v_mfma_f32_16x16x32_bf16 v[64:67], v[148:151], a[4:7], v[64:67]
  buffer_load_dwordx4 a[60:63], v105, s[4:7], s16 offen offset:1024 sc1
  v_mfma_f32_16x16x32_bf16 v[20:23], v[152:155], a[0:3], v[20:23]
  ds_read_b64_tr_b16 v[144:145], v117 offset:13312
  ds_read_b64_tr_b16 v[146:147], v117 offset:13824
  s_add_u32 s16, s16, 131072
  v_mfma_f32_16x16x32_bf16 v[68:71], v[152:155], a[4:7], v[68:71]
  ds_read_b64_tr_b16 v[148:149], v114 offset:14336
  s_bitset0_b32 s16, 20
  s_waitcnt lgkmcnt(10)
  v_mfma_f32_16x16x32_bf16 v[24:27], v[156:159], a[0:3], v[24:27]
  ds_read_b64_tr_b16 v[150:151], v114 offset:14848
  s_add_u32 s4, s4, s6
  s_addc_u32 s5, s5, 0
  v_mfma_f32_16x16x32_bf16 v[72:75], v[156:159], a[4:7], v[72:75]
  ds_read_b64_tr_b16 v[152:153], v115 offset:14336
  s_mov_b32 m0, s51
  v_mfma_f32_16x16x32_bf16 v[28:31], v[160:163], a[0:3], v[28:31]
  ds_read_b64_tr_b16 v[154:155], v115 offset:14848
  s_add_u32 s51, s51, 1024
  v_mfma_f32_16x16x32_bf16 v[76:79], v[160:163], a[4:7], v[76:79]
  buffer_load_dwordx4 v129, s[52:55], s50 offen nt lds
  v_mfma_f32_16x16x32_bf16 v[32:35], a[0:3], v[164:167], v[32:35]
  ds_read_b64_tr_b16 v[156:157], v116 offset:14336
  ds_read_b64_tr_b16 v[158:159], v116 offset:14848
  s_add_u32 s50, s50, 98304
  v_mfma_f32_16x16x32_bf16 v[80:83], a[4:7], v[164:167], v[80:83]
  ds_read_b64_tr_b16 v[160:161], v117 offset:14336
  s_mov_b32 m0, s51
  v_mfma_f32_16x16x32_bf16 v[36:39], a[0:3], v[168:171], v[36:39]
  ds_read_b64_tr_b16 v[162:163], v117 offset:14848
  s_add_u32 s51, s51, 1024
  v_mfma_f32_16x16x32_bf16 v[84:87], a[4:7], v[168:171], v[84:87]
  buffer_load_dwordx4 v129, s[52:55], s50 offen nt lds
  v_mfma_f32_16x16x32_bf16 v[40:43], a[0:3], v[172:175], v[40:43]
  ds_read_b64_tr_b16 v[164:165], v114 offset:15360
  ds_read_b64_tr_b16 v[166:167], v114 offset:15872
  s_add_u32 s50, s50, 98304
  v_mfma_f32_16x16x32_bf16 v[88:91], a[4:7], v[172:175], v[88:91]
  buffer_store_dwordx4 v[244:247], v119, s[92:95], s35 offen offset:1024 sc1
  v_mfma_f32_16x16x32_bf16 v[44:47], a[0:3], v[176:179], v[44:47]
  ds_read_b64_tr_b16 v[168:169], v115 offset:15360
  ds_read_b64_tr_b16 v[170:171], v115 offset:15872
  v_mfma_f32_16x16x32_bf16 v[92:95], a[4:7], v[176:179], v[92:95]
  s_waitcnt vmcnt(36) lgkmcnt(10)
  s_barrier
  v_mfma_f32_16x16x32_bf16 v[96:99], v[180:183], v[188:191], v[96:99]
  ds_read_b64_tr_b16 v[172:173], v116 offset:15360
  ds_read_b64_tr_b16 v[174:175], v116 offset:15872
  s_add_u32 m0, s38, 0
  v_mfma_f32_16x16x32_bf16 v[100:103], v[188:191], v[184:187], v[100:103]
  buffer_load_dwordx4 v107, s[8:11], s17 offen lds
  v_mfma_f32_16x16x32_bf16 v[0:3], v[132:135], a[8:11], v[0:3]
  ds_read_b64_tr_b16 v[176:177], v117 offset:15360
  ds_read_b64_tr_b16 v[178:179], v117 offset:15872
  v_mfma_f32_16x16x32_bf16 v[48:51], v[132:135], a[12:15], v[48:51]
  ds_read_b64_tr_b16 v[180:181], v118 offset:27648
  ds_read_b64_tr_b16 v[182:183], v118 offset:28160
  buffer_load_dwordx4 v108, s[8:11], s17 offen offset:1024 lds
  v_mfma_f32_16x16x32_bf16 v[4:7], v[136:139], a[8:11], v[4:7]
  ds_read_b128 v[188:191], v119 offset:38912
  ds_read_b64_tr_b16 v[184:185], v118 offset:28672
  ds_read_b64_tr_b16 v[186:187], v118 offset:29184
  v_mfma_f32_16x16x32_bf16 v[52:55], v[136:139], a[12:15], v[52:55]
  buffer_load_dwordx4 v109, s[8:11], s17 offen offset:2048 lds
  v_mfma_f32_16x16x32_bf16 v[8:11], v[140:143], a[8:11], v[8:11]
  ds_read_b64_tr_b16 v[132:133], v114 offset:26624
  ds_read_b64_tr_b16 v[134:135], v114 offset:27136
  v_mfma_f32_16x16x32_bf16 v[56:59], v[140:143], a[12:15], v[56:59]
  ds_read_b64_tr_b16 v[136:137], v115 offset:26624
  s_add_u32 s17, s17, 196608
  v_mfma_f32_16x16x32_bf16 v[12:15], v[144:147], a[8:11], v[12:15]
  ds_read_b64_tr_b16 v[138:139], v115 offset:27136
  ds_read_b64_tr_b16 v[140:141], v116 offset:26624
  v_mfma_f32_16x16x32_bf16 v[60:63], v[144:147], a[12:15], v[60:63]
  ds_read_b64_tr_b16 v[142:143], v116 offset:27136
  s_cmp_eq_u32 s17, s10
  v_mfma_f32_16x16x32_bf16 v[16:19], v[148:151], a[8:11], v[16:19]
  ds_read_b64_tr_b16 v[144:145], v117 offset:26624
  ds_read_b64_tr_b16 v[146:147], v117 offset:27136
  v_mfma_f32_16x16x32_bf16 v[64:67], v[148:151], a[12:15], v[64:67]
  ds_read_b64_tr_b16 v[148:149], v114 offset:27648
  s_cselect_b32 s17, 0, s17
  s_waitcnt lgkmcnt(10)
  v_mfma_f32_16x16x32_bf16 v[20:23], v[152:155], a[8:11], v[20:23]
  ds_read_b64_tr_b16 v[150:151], v114 offset:28160
  v_mfma_f32_16x16x32_bf16 v[68:71], v[152:155], a[12:15], v[68:71]
  ds_read_b64_tr_b16 v[152:153], v115 offset:27648
  s_add_u32 m0, s39, 0
  v_mfma_f32_16x16x32_bf16 v[24:27], v[156:159], a[8:11], v[24:27]
  ds_read_b64_tr_b16 v[154:155], v115 offset:28160
  v_mfma_f32_16x16x32_bf16 v[72:75], v[156:159], a[12:15], v[72:75]
  buffer_load_dword v106, s[4:7], s16 offen sc1 lds
  v_mfma_f32_16x16x32_bf16 v[28:31], v[160:163], a[8:11], v[28:31]
  ds_read_b64_tr_b16 v[156:157], v116 offset:27648
  ds_read_b64_tr_b16 v[158:159], v116 offset:28160
  v_mfma_f32_16x16x32_bf16 v[76:79], v[160:163], a[12:15], v[76:79]
  buffer_load_dwordx4 a[0:3], v105, s[4:7], s16 offen sc1
  v_mfma_f32_16x16x32_bf16 v[32:35], a[8:11], v[164:167], v[32:35]
  ds_read_b64_tr_b16 v[160:161], v117 offset:27648
  ds_read_b64_tr_b16 v[162:163], v117 offset:28160
  v_mfma_f32_16x16x32_bf16 v[80:83], a[12:15], v[164:167], v[80:83]
  buffer_load_dwordx4 a[4:7], v105, s[4:7], s16 offen offset:1024 sc1
  v_mfma_f32_16x16x32_bf16 v[36:39], a[8:11], v[168:171], v[36:39]
  ds_read_b64_tr_b16 v[164:165], v114 offset:28672
  ds_read_b64_tr_b16 v[166:167], v114 offset:29184
  v_mfma_f32_16x16x32_bf16 v[84:87], a[12:15], v[168:171], v[84:87]
  ds_read_b64_tr_b16 v[168:169], v115 offset:28672
  s_add_u32 s16, s16, 131072
  v_mfma_f32_16x16x32_bf16 v[40:43], a[8:11], v[172:175], v[40:43]
  ds_read_b64_tr_b16 v[170:171], v115 offset:29184
  v_mfma_f32_16x16x32_bf16 v[88:91], a[12:15], v[172:175], v[88:91]
  ds_read_b64_tr_b16 v[172:173], v116 offset:28672
  s_bitset0_b32 s16, 20
  v_mfma_f32_16x16x32_bf16 v[44:47], a[8:11], v[176:179], v[44:47]
  ds_read_b64_tr_b16 v[174:175], v116 offset:29184
  v_mfma_f32_16x16x32_bf16 v[92:95], a[12:15], v[176:179], v[92:95]
  s_waitcnt vmcnt(36) lgkmcnt(10)
  s_barrier
  v_mfma_f32_16x16x32_bf16 v[96:99], v[180:183], v[188:191], v[96:99]
  ds_read_b64_tr_b16 v[176:177], v117 offset:28672
  s_add_u32 m0, s38, 13312
  v_mfma_f32_16x16x32_bf16 v[100:103], v[188:191], v[184:187], v[100:103]
  buffer_load_dwordx4 v107, s[8:11], s17 offen lds
  v_mfma_f32_16x16x32_bf16 v[0:3], v[132:135], a[16:19], v[0:3]
  ds_read_b64_tr_b16 v[178:179], v117 offset:29184
  ds_read_b64_tr_b16 v[180:181], v118 offset:40960
  v_mfma_f32_16x16x32_bf16 v[48:51], v[132:135], a[20:23], v[48:51]
  ds_read_b64_tr_b16 v[182:183], v118 offset:41472
  buffer_load_dwordx4 v108, s[8:11], s17 offen offset:1024 lds
  v_mfma_f32_16x16x32_bf16 v[4:7], v[136:139], a[16:19], v[4:7]
  ds_read_b128 v[188:191], v119 offset:52224
  ds_read_b64_tr_b16 v[184:185], v118 offset:41984
  ds_read_b64_tr_b16 v[186:187], v118 offset:42496
  v_mfma_f32_16x16x32_bf16 v[52:55], v[136:139], a[20:23], v[52:55]
  buffer_load_dwordx4 v109, s[8:11], s17 offen offset:2048 lds
  v_mfma_f32_16x16x32_bf16 v[8:11], v[140:143], a[16:19], v[8:11]
  ds_read_b64_tr_b16 v[132:133], v114 offset:39936
  ds_read_b64_tr_b16 v[134:135], v114 offset:40448
  v_mfma_f32_16x16x32_bf16 v[56:59], v[140:143], a[20:23], v[56:59]
  ds_read_b64_tr_b16 v[136:137], v115 offset:39936
  s_add_u32 s17, s17, 196608
  v_mfma_f32_16x16x32_bf16 v[12:15], v[144:147], a[16:19], v[12:15]
  ds_read_b64_tr_b16 v[138:139], v115 offset:40448
  ds_read_b64_tr_b16 v[140:141], v116 offset:39936
  v_mfma_f32_16x16x32_bf16 v[60:63], v[144:147], a[20:23], v[60:63]
  ds_read_b64_tr_b16 v[142:143], v116 offset:40448
  s_cmp_eq_u32 s17, s10
  v_mfma_f32_16x16x32_bf16 v[16:19], v[148:151], a[16:19], v[16:19]
  ds_read_b64_tr_b16 v[144:145], v117 offset:39936
  ds_read_b64_tr_b16 v[146:147], v117 offset:40448
  v_mfma_f32_16x16x32_bf16 v[64:67], v[148:151], a[20:23], v[64:67]
  ds_read_b64_tr_b16 v[148:149], v114 offset:40960
  s_cselect_b32 s17, 0, s17
  v_mfma_f32_16x16x32_bf16 v[20:23], v[152:155], a[16:19], v[20:23]
  ds_read_b64_tr_b16 v[150:151], v114 offset:41472
  v_mfma_f32_16x16x32_bf16 v[68:71], v[152:155], a[20:23], v[68:71]
  ds_read_b64_tr_b16 v[152:153], v115 offset:40960
  s_add_u32 m0, s39, 13312
  s_waitcnt lgkmcnt(10)
  v_mfma_f32_16x16x32_bf16 v[24:27], v[156:159], a[16:19], v[24:27]
  ds_read_b64_tr_b16 v[154:155], v115 offset:41472
  v_mfma_f32_16x16x32_bf16 v[72:75], v[156:159], a[20:23], v[72:75]
  buffer_load_dword v106, s[4:7], s16 offen sc1 lds
  v_mfma_f32_16x16x32_bf16 v[28:31], v[160:163], a[16:19], v[28:31]
  ds_read_b64_tr_b16 v[156:157], v116 offset:40960
  ds_read_b64_tr_b16 v[158:159], v116 offset:41472
  v_mfma_f32_16x16x32_bf16 v[76:79], v[160:163], a[20:23], v[76:79]
  buffer_load_dwordx4 a[8:11], v105, s[4:7], s16 offen sc1
  v_mfma_f32_16x16x32_bf16 v[32:35], a[16:19], v[164:167], v[32:35]
  ds_read_b64_tr_b16 v[160:161], v117 offset:40960
  ds_read_b64_tr_b16 v[162:163], v117 offset:41472
  v_mfma_f32_16x16x32_bf16 v[80:83], a[20:23], v[164:167], v[80:83]
  buffer_load_dwordx4 a[12:15], v105, s[4:7], s16 offen offset:1024 sc1
  v_mfma_f32_16x16x32_bf16 v[36:39], a[16:19], v[168:171], v[36:39]
  ds_read_b64_tr_b16 v[164:165], v114 offset:41984
  ds_read_b64_tr_b16 v[166:167], v114 offset:42496
  v_mfma_f32_16x16x32_bf16 v[84:87], a[20:23], v[168:171], v[84:87]
  ds_read_b64_tr_b16 v[168:169], v115 offset:41984
  s_add_u32 s16, s16, 131072
  v_mfma_f32_16x16x32_bf16 v[40:43], a[16:19], v[172:175], v[40:43]
  ds_read_b64_tr_b16 v[170:171], v115 offset:42496
  v_mfma_f32_16x16x32_bf16 v[88:91], a[20:23], v[172:175], v[88:91]
  ds_read_b64_tr_b16 v[172:173], v116 offset:41984
  s_bitset0_b32 s16, 20
  v_mfma_f32_16x16x32_bf16 v[44:47], a[16:19], v[176:179], v[44:47]
  ds_read_b64_tr_b16 v[174:175], v116 offset:42496
  v_mfma_f32_16x16x32_bf16 v[92:95], a[20:23], v[176:179], v[92:95]
  s_waitcnt vmcnt(33) lgkmcnt(10)
  s_barrier
  v_mfma_f32_16x16x32_bf16 v[96:99], v[180:183], v[188:191], v[96:99]
  ds_read_b64_tr_b16 v[176:177], v117 offset:41984
  s_add_u32 m0, s38, 26624
  v_mfma_f32_16x16x32_bf16 v[100:103], v[188:191], v[184:187], v[100:103]
  buffer_load_dwordx4 v107, s[8:11], s17 offen lds
  v_mfma_f32_16x16x32_bf16 v[0:3], v[132:135], a[24:27], v[0:3]
  ds_read_b64_tr_b16 v[178:179], v117 offset:42496
  ds_read_b64_tr_b16 v[180:181], v124 offset:1024
  v_mfma_f32_16x16x32_bf16 v[48:51], v[132:135], a[28:31], v[48:51]
  ds_read_b64_tr_b16 v[182:183], v124 offset:1536
  buffer_load_dwordx4 v108, s[8:11], s17 offen offset:1024 lds
  v_mfma_f32_16x16x32_bf16 v[4:7], v[136:139], a[24:27], v[4:7]
  ds_read_b128 v[188:191], v125 offset:12288
  ds_read_b64_tr_b16 v[184:185], v124 offset:2048
  ds_read_b64_tr_b16 v[186:187], v124 offset:2560
  v_mfma_f32_16x16x32_bf16 v[52:55], v[136:139], a[28:31], v[52:55]
  buffer_load_dwordx4 v109, s[8:11], s17 offen offset:2048 lds
  v_mfma_f32_16x16x32_bf16 v[8:11], v[140:143], a[24:27], v[8:11]
  ds_read_b64_tr_b16 v[132:133], v120 offset:0
  ds_read_b64_tr_b16 v[134:135], v120 offset:512
  v_mfma_f32_16x16x32_bf16 v[56:59], v[140:143], a[28:31], v[56:59]
  ds_read_b64_tr_b16 v[136:137], v121 offset:0
  s_add_u32 s17, s17, 196608
  v_mfma_f32_16x16x32_bf16 v[12:15], v[144:147], a[24:27], v[12:15]
  ds_read_b64_tr_b16 v[138:139], v121 offset:512
  ds_read_b64_tr_b16 v[140:141], v122 offset:0
  v_mfma_f32_16x16x32_bf16 v[60:63], v[144:147], a[28:31], v[60:63]
  ds_read_b64_tr_b16 v[142:143], v122 offset:512
  s_cmp_eq_u32 s17, s10
  v_mfma_f32_16x16x32_bf16 v[16:19], v[148:151], a[24:27], v[16:19]
  ds_read_b64_tr_b16 v[144:145], v123 offset:0
  ds_read_b64_tr_b16 v[146:147], v123 offset:512
  v_mfma_f32_16x16x32_bf16 v[64:67], v[148:151], a[28:31], v[64:67]
  ds_read_b64_tr_b16 v[148:149], v120 offset:1024
  s_cselect_b32 s17, 0, s17
  v_mfma_f32_16x16x32_bf16 v[20:23], v[152:155], a[24:27], v[20:23]
  ds_read_b64_tr_b16 v[150:151], v120 offset:1536
  v_mfma_f32_16x16x32_bf16 v[68:71], v[152:155], a[28:31], v[68:71]
  ds_read_b64_tr_b16 v[152:153], v121 offset:1024
  s_add_u32 m0, s39, 26624
  s_waitcnt lgkmcnt(10)
  v_mfma_f32_16x16x32_bf16 v[24:27], v[156:159], a[24:27], v[24:27]
  ds_read_b64_tr_b16 v[154:155], v121 offset:1536
  v_mfma_f32_16x16x32_bf16 v[72:75], v[156:159], a[28:31], v[72:75]
  buffer_load_dword v106, s[4:7], s16 offen sc1 lds
  v_mfma_f32_16x16x32_bf16 v[28:31], v[160:163], a[24:27], v[28:31]
  ds_read_b64_tr_b16 v[156:157], v122 offset:1024
  ds_read_b64_tr_b16 v[158:159], v122 offset:1536
  v_mfma_f32_16x16x32_bf16 v[76:79], v[160:163], a[28:31], v[76:79]
  buffer_load_dwordx4 a[16:19], v105, s[4:7], s16 offen sc1
  v_mfma_f32_16x16x32_bf16 v[32:35], a[24:27], v[164:167], v[32:35]
  ds_read_b64_tr_b16 v[160:161], v123 offset:1024
  ds_read_b64_tr_b16 v[162:163], v123 offset:1536
  v_mfma_f32_16x16x32_bf16 v[80:83], a[28:31], v[164:167], v[80:83]
  buffer_load_dwordx4 a[20:23], v105, s[4:7], s16 offen offset:1024 sc1
  v_mfma_f32_16x16x32_bf16 v[36:39], a[24:27], v[168:171], v[36:39]
  ds_read_b64_tr_b16 v[164:165], v120 offset:2048
  ds_read_b64_tr_b16 v[166:167], v120 offset:2560
  v_mfma_f32_16x16x32_bf16 v[84:87], a[28:31], v[168:171], v[84:87]
  ds_read_b64_tr_b16 v[168:169], v121 offset:2048
  s_add_u32 s16, s16, 131072
  v_mfma_f32_16x16x32_bf16 v[40:43], a[24:27], v[172:175], v[40:43]
  ds_read_b64_tr_b16 v[170:171], v121 offset:2560
  v_mfma_f32_16x16x32_bf16 v[88:91], a[28:31], v[172:175], v[88:91]
  ds_read_b64_tr_b16 v[172:173], v122 offset:2048
  s_bitset0_b32 s16, 20
  v_mfma_f32_16x16x32_bf16 v[44:47], a[24:27], v[176:179], v[44:47]
  ds_read_b64_tr_b16 v[174:175], v122 offset:2560
  v_mfma_f32_16x16x32_bf16 v[92:95], a[28:31], v[176:179], v[92:95]
  s_waitcnt vmcnt(33) lgkmcnt(10)
  s_barrier
  v_mfma_f32_16x16x32_bf16 v[96:99], v[180:183], v[188:191], v[96:99]
  ds_read_b64_tr_b16 v[176:177], v123 offset:2048
  s_add_u32 m0, s38, 39936
  v_mfma_f32_16x16x32_bf16 v[100:103], v[188:191], v[184:187], v[100:103]
  buffer_load_dwordx4 v107, s[8:11], s17 offen lds
  v_mfma_f32_16x16x32_bf16 v[0:3], v[132:135], a[32:35], v[0:3]
  ds_read_b64_tr_b16 v[178:179], v123 offset:2560
  buffer_load_dwordx4 v108, s[8:11], s17 offen offset:1024 lds
  v_mfma_f32_16x16x32_bf16 v[48:51], v[132:135], a[36:39], v[48:51]
  ds_read_b64_tr_b16 v[180:181], v124 offset:14336
  ds_read_b64_tr_b16 v[182:183], v124 offset:14848
  buffer_load_dwordx4 v109, s[8:11], s17 offen offset:2048 lds
  v_mfma_f32_16x16x32_bf16 v[4:7], v[136:139], a[32:35], v[4:7]
  ds_read_b128 v[188:191], v125 offset:25600
  ds_read_b64_tr_b16 v[184:185], v124 offset:15360
  ds_read_b64_tr_b16 v[186:187], v124 offset:15872
  s_add_u32 s17, s17, 196608
  v_mfma_f32_16x16x32_bf16 v[52:55], v[136:139], a[36:39], v[52:55]
  ds_read_b64_tr_b16 v[132:133], v120 offset:13312
  s_cmp_eq_u32 s17, s10
  v_mfma_f32_16x16x32_bf16 v[8:11], v[140:143], a[32:35], v[8:11]
  ds_read_b64_tr_b16 v[134:135], v120 offset:13824
  s_cselect_b32 s17, 0, s17
  v_mfma_f32_16x16x32_bf16 v[56:59], v[140:143], a[36:39], v[56:59]
  ds_read_b64_tr_b16 v[136:137], v121 offset:13312
  s_add_u32 m0, s39, 39936
  v_mfma_f32_16x16x32_bf16 v[12:15], v[144:147], a[32:35], v[12:15]
  ds_read_b64_tr_b16 v[138:139], v121 offset:13824
  ds_read_b64_tr_b16 v[140:141], v122 offset:13312
  v_mfma_f32_16x16x32_bf16 v[60:63], v[144:147], a[36:39], v[60:63]
  buffer_load_dword v106, s[4:7], s16 offen sc1 lds
  v_mfma_f32_16x16x32_bf16 v[16:19], v[148:151], a[32:35], v[16:19]
  ds_read_b64_tr_b16 v[142:143], v122 offset:13824
  buffer_load_dwordx4 a[24:27], v105, s[4:7], s16 offen sc1
  v_mfma_f32_16x16x32_bf16 v[64:67], v[148:151], a[36:39], v[64:67]
  buffer_load_dwordx4 a[28:31], v105, s[4:7], s16 offen offset:1024 sc1
  v_mfma_f32_16x16x32_bf16 v[20:23], v[152:155], a[32:35], v[20:23]
  ds_read_b64_tr_b16 v[144:145], v123 offset:13312
  ds_read_b64_tr_b16 v[146:147], v123 offset:13824
  s_add_u32 s16, s16, 131072
  v_mfma_f32_16x16x32_bf16 v[68:71], v[152:155], a[36:39], v[68:71]
  ds_read_b64_tr_b16 v[148:149], v120 offset:14336
  s_bitset0_b32 s16, 20
  s_waitcnt lgkmcnt(10)
  v_mfma_f32_16x16x32_bf16 v[24:27], v[156:159], a[32:35], v[24:27]
  ds_read_b64_tr_b16 v[150:151], v120 offset:14848
  s_mov_b32 m0, s51
  v_mfma_f32_16x16x32_bf16 v[72:75], v[156:159], a[36:39], v[72:75]
  ds_read_b64_tr_b16 v[152:153], v121 offset:14336
  s_add_u32 s51, s51, 1024
  v_mfma_f32_16x16x32_bf16 v[28:31], v[160:163], a[32:35], v[28:31]
  ds_read_b64_tr_b16 v[154:155], v121 offset:14848
  ds_read_b64_tr_b16 v[156:157], v122 offset:14336
  v_mfma_f32_16x16x32_bf16 v[76:79], v[160:163], a[36:39], v[76:79]
  buffer_load_dwordx4 v129, s[52:55], s50 offen nt lds
  v_mfma_f32_16x16x32_bf16 v[32:35], a[32:35], v[164:167], v[32:35]
  ds_read_b64_tr_b16 v[158:159], v122 offset:14848
  s_add_u32 s50, s50, 98304
  v_mfma_f32_16x16x32_bf16 v[80:83], a[36:39], v[164:167], v[80:83]
  ds_read_b64_tr_b16 v[160:161], v123 offset:14336
  s_mov_b32 m0, s51
  v_mfma_f32_16x16x32_bf16 v[36:39], a[32:35], v[168:171], v[36:39]
  ds_read_b64_tr_b16 v[162:163], v123 offset:14848
  s_add_u32 s51, s51, 1024
  v_mfma_f32_16x16x32_bf16 v[84:87], a[36:39], v[168:171], v[84:87]
  buffer_load_dwordx4 v129, s[52:55], s50 offen nt lds
  v_mfma_f32_16x16x32_bf16 v[40:43], a[32:35], v[172:175], v[40:43]
  ds_read_b64_tr_b16 v[164:165], v120 offset:15360
  ds_read_b64_tr_b16 v[166:167], v120 offset:15872
  s_add_u32 s50, s50, 98304
  v_mfma_f32_16x16x32_bf16 v[88:91], a[36:39], v[172:175], v[88:91]
  buffer_store_dwordx4 v[244:247], v119, s[92:95], s35 offen offset:2048 sc1
  v_mfma_f32_16x16x32_bf16 v[44:47], a[32:35], v[176:179], v[44:47]
  ds_read_b64_tr_b16 v[168:169], v121 offset:15360
  ds_read_b64_tr_b16 v[170:171], v121 offset:15872
  v_mfma_f32_16x16x32_bf16 v[92:95], a[36:39], v[176:179], v[92:95]
  s_waitcnt vmcnt(36) lgkmcnt(10)
  s_barrier
  v_mfma_f32_16x16x32_bf16 v[96:99], v[180:183], v[188:191], v[96:99]
  ds_read_b64_tr_b16 v[172:173], v122 offset:15360
  ds_read_b64_tr_b16 v[174:175], v122 offset:15872
  s_add_u32 m0, s38, 53248
  v_mfma_f32_16x16x32_bf16 v[100:103], v[188:191], v[184:187], v[100:103]
  buffer_load_dwordx4 v107, s[8:11], s17 offen lds
  v_mfma_f32_16x16x32_bf16 v[0:3], v[132:135], a[40:43], v[0:3]
  ds_read_b64_tr_b16 v[176:177], v123 offset:15360
  ds_read_b64_tr_b16 v[178:179], v123 offset:15872
  v_mfma_f32_16x16x32_bf16 v[48:51], v[132:135], a[44:47], v[48:51]
  ds_read_b64_tr_b16 v[180:181], v124 offset:27648
  ds_read_b64_tr_b16 v[182:183], v124 offset:28160
  buffer_load_dwordx4 v108, s[8:11], s17 offen offset:1024 lds
  v_mfma_f32_16x16x32_bf16 v[4:7], v[136:139], a[40:43], v[4:7]
  ds_read_b128 v[188:191], v125 offset:38912
  ds_read_b64_tr_b16 v[184:185], v124 offset:28672
  ds_read_b64_tr_b16 v[186:187], v124 offset:29184
  v_mfma_f32_16x16x32_bf16 v[52:55], v[136:139], a[44:47], v[52:55]
  buffer_load_dwordx4 v109, s[8:11], s17 offen offset:2048 lds
  v_mfma_f32_16x16x32_bf16 v[8:11], v[140:143], a[40:43], v[8:11]
  ds_read_b64_tr_b16 v[132:133], v120 offset:26624
  ds_read_b64_tr_b16 v[134:135], v120 offset:27136
  v_mfma_f32_16x16x32_bf16 v[56:59], v[140:143], a[44:47], v[56:59]
  ds_read_b64_tr_b16 v[136:137], v121 offset:26624
  s_add_u32 s17, s17, 196608
  v_mfma_f32_16x16x32_bf16 v[12:15], v[144:147], a[40:43], v[12:15]
  ds_read_b64_tr_b16 v[138:139], v121 offset:27136
  ds_read_b64_tr_b16 v[140:141], v122 offset:26624
  v_mfma_f32_16x16x32_bf16 v[60:63], v[144:147], a[44:47], v[60:63]
  ds_read_b64_tr_b16 v[142:143], v122 offset:27136
  s_cmp_eq_u32 s17, s10
  v_mfma_f32_16x16x32_bf16 v[16:19], v[148:151], a[40:43], v[16:19]
  ds_read_b64_tr_b16 v[144:145], v123 offset:26624
  ds_read_b64_tr_b16 v[146:147], v123 offset:27136
  v_mfma_f32_16x16x32_bf16 v[64:67], v[148:151], a[44:47], v[64:67]
  ds_read_b64_tr_b16 v[148:149], v120 offset:27648
  s_cselect_b32 s17, 0, s17
  s_waitcnt lgkmcnt(10)
  v_mfma_f32_16x16x32_bf16 v[20:23], v[152:155], a[40:43], v[20:23]
  ds_read_b64_tr_b16 v[150:151], v120 offset:28160
  v_mfma_f32_16x16x32_bf16 v[68:71], v[152:155], a[44:47], v[68:71]
  ds_read_b64_tr_b16 v[152:153], v121 offset:27648
  s_add_u32 m0, s39, 53248
  v_mfma_f32_16x16x32_bf16 v[24:27], v[156:159], a[40:43], v[24:27]
  ds_read_b64_tr_b16 v[154:155], v121 offset:28160
  v_mfma_f32_16x16x32_bf16 v[72:75], v[156:159], a[44:47], v[72:75]
  buffer_load_dword v106, s[4:7], s16 offen sc1 lds
  v_mfma_f32_16x16x32_bf16 v[28:31], v[160:163], a[40:43], v[28:31]
  ds_read_b64_tr_b16 v[156:157], v122 offset:27648
  ds_read_b64_tr_b16 v[158:159], v122 offset:28160
  v_mfma_f32_16x16x32_bf16 v[76:79], v[160:163], a[44:47], v[76:79]
  buffer_load_dwordx4 a[32:35], v105, s[4:7], s16 offen sc1
  v_mfma_f32_16x16x32_bf16 v[32:35], a[40:43], v[164:167], v[32:35]
  ds_read_b64_tr_b16 v[160:161], v123 offset:27648
  ds_read_b64_tr_b16 v[162:163], v123 offset:28160
  v_mfma_f32_16x16x32_bf16 v[80:83], a[44:47], v[164:167], v[80:83]
  buffer_load_dwordx4 a[36:39], v105, s[4:7], s16 offen offset:1024 sc1
  v_mfma_f32_16x16x32_bf16 v[36:39], a[40:43], v[168:171], v[36:39]
  ds_read_b64_tr_b16 v[164:165], v120 offset:28672
  ds_read_b64_tr_b16 v[166:167], v120 offset:29184
  v_mfma_f32_16x16x32_bf16 v[84:87], a[44:47], v[168:171], v[84:87]
  ds_read_b64_tr_b16 v[168:169], v121 offset:28672
  s_add_u32 s16, s16, 131072
  v_mfma_f32_16x16x32_bf16 v[40:43], a[40:43], v[172:175], v[40:43]
  ds_read_b64_tr_b16 v[170:171], v121 offset:29184
  v_mfma_f32_16x16x32_bf16 v[88:91], a[44:47], v[172:175], v[88:91]
  ds_read_b64_tr_b16 v[172:173], v122 offset:28672
  s_bitset0_b32 s16, 20
  v_mfma_f32_16x16x32_bf16 v[44:47], a[40:43], v[176:179], v[44:47]
  ds_read_b64_tr_b16 v[174:175], v122 offset:29184
  v_mfma_f32_16x16x32_bf16 v[92:95], a[44:47], v[176:179], v[92:95]
  s_waitcnt vmcnt(36) lgkmcnt(10)
  s_barrier
  v_mfma_f32_16x16x32_bf16 v[96:99], v[180:183], v[188:191], v[96:99]
  ds_read_b64_tr_b16 v[176:177], v123 offset:28672
  s_add_u32 m0, s38, 66560
  v_mfma_f32_16x16x32_bf16 v[100:103], v[188:191], v[184:187], v[100:103]
  buffer_load_dwordx4 v107, s[8:11], s17 offen lds
  v_mfma_f32_16x16x32_bf16 v[0:3], v[132:135], a[48:51], v[0:3]
  ds_read_b64_tr_b16 v[178:179], v123 offset:29184
  ds_read_b64_tr_b16 v[180:181], v124 offset:40960
  v_mfma_f32_16x16x32_bf16 v[48:51], v[132:135], a[52:55], v[48:51]
  ds_read_b64_tr_b16 v[182:183], v124 offset:41472
  buffer_load_dwordx4 v108, s[8:11], s17 offen offset:1024 lds
  v_mfma_f32_16x16x32_bf16 v[4:7], v[136:139], a[48:51], v[4:7]
  ds_read_b128 v[188:191], v125 offset:52224
  ds_read_b64_tr_b16 v[184:185], v124 offset:41984
  ds_read_b64_tr_b16 v[186:187], v124 offset:42496
  v_mfma_f32_16x16x32_bf16 v[52:55], v[136:139], a[52:55], v[52:55]
  buffer_load_dwordx4 v109, s[8:11], s17 offen offset:2048 lds
  v_mfma_f32_16x16x32_bf16 v[8:11], v[140:143], a[48:51], v[8:11]
  ds_read_b64_tr_b16 v[132:133], v120 offset:39936
  ds_read_b64_tr_b16 v[134:135], v120 offset:40448
  v_mfma_f32_16x16x32_bf16 v[56:59], v[140:143], a[52:55], v[56:59]
  ds_read_b64_tr_b16 v[136:137], v121 offset:39936
  s_add_u32 s17, s17, 196608
  v_mfma_f32_16x16x32_bf16 v[12:15], v[144:147], a[48:51], v[12:15]
  ds_read_b64_tr_b16 v[138:139], v121 offset:40448
  s_cmp_eq_u32 s17, s10
  v_mfma_f32_16x16x32_bf16 v[60:63], v[144:147], a[52:55], v[60:63]
  ds_read_b64_tr_b16 v[140:141], v122 offset:39936
  ds_read_b64_tr_b16 v[142:143], v122 offset:40448
  v_mfma_f32_16x16x32_bf16 v[16:19], v[148:151], a[48:51], v[16:19]
  ds_read_b64_tr_b16 v[144:145], v123 offset:39936
  s_cselect_b32 s17, 0, s17
  v_mfma_f32_16x16x32_bf16 v[64:67], v[148:151], a[52:55], v[64:67]
  ds_read_b64_tr_b16 v[146:147], v123 offset:40448
  ds_read_b64_tr_b16 v[148:149], v120 offset:40960
  v_mfma_f32_16x16x32_bf16 v[20:23], v[152:155], a[48:51], v[20:23]
  ds_read_b64_tr_b16 v[150:151], v120 offset:41472
  s_add_u32 m0, s39, 66560
  v_mfma_f32_16x16x32_bf16 v[68:71], v[152:155], a[52:55], v[68:71]
  ds_read_b64_tr_b16 v[152:153], v121 offset:40960
  ds_read_b64_tr_b16 v[154:155], v121 offset:41472
  s_waitcnt lgkmcnt(10)
  v_mfma_f32_16x16x32_bf16 v[24:27], v[156:159], a[48:51], v[24:27]
  buffer_load_dword v106, s[4:7], s16 offen sc1 lds
  v_mfma_f32_16x16x32_bf16 v[72:75], v[156:159], a[52:55], v[72:75]
  ds_read_b64_tr_b16 v[156:157], v122 offset:40960
  ds_read_b64_tr_b16 v[158:159], v122 offset:41472
  v_mfma_f32_16x16x32_bf16 v[28:31], v[160:163], a[48:51], v[28:31]
  buffer_load_dwordx4 a[40:43], v105, s[4:7], s16 offen sc1
  v_mfma_f32_16x16x32_bf16 v[76:79], v[160:163], a[52:55], v[76:79]
  buffer_load_dwordx4 a[44:47], v105, s[4:7], s16 offen offset:1024 sc1
  v_mfma_f32_16x16x32_bf16 v[32:35], a[48:51], v[164:167], v[32:35]
  ds_read_b64_tr_b16 v[160:161], v123 offset:40960
  ds_read_b64_tr_b16 v[162:163], v123 offset:41472
  v_mfma_f32_16x16x32_bf16 v[80:83], a[52:55], v[164:167], v[80:83]
  ds_read_b64_tr_b16 v[164:165], v120 offset:41984
  s_add_u32 s16, s16, 131072
  v_mfma_f32_16x16x32_bf16 v[36:39], a[48:51], v[168:171], v[36:39]
  ds_read_b64_tr_b16 v[166:167], v120 offset:42496
  v_mfma_f32_16x16x32_bf16 v[84:87], a[52:55], v[168:171], v[84:87]
  ds_read_b64_tr_b16 v[168:169], v121 offset:41984
  s_bitset0_b32 s16, 20
  v_mfma_f32_16x16x32_bf16 v[40:43], a[48:51], v[172:175], v[40:43]
  ds_read_b64_tr_b16 v[170:171], v121 offset:42496
  v_mfma_f32_16x16x32_bf16 v[88:91], a[52:55], v[172:175], v[88:91]
  s_mov_b32 s40, s20
  s_mov_b32 s41, s21
  s_mov_b32 s42, 0x200000
  s_mov_b32 s43, 0x20000
  v_min_u32 v200, 9, v104
  v_lshlrev_b32 v201, 16, v200
  v_add_u32 v201, 524288, v201
  v_lshlrev_b32 v202, 7, v200
  s_lshl2_add_u32 s33, s2, s3
  s_mul_i32 s32, s33, 448
  s_add_u32 s32, s32, 1572096
  v_add_u32 v202, s32, v202
  v_cmp_le_u32 vcc, 6, v104
  s_lshl_b32 s33, s33, 6
  s_nop 0
  v_cndmask_b32 v201, v201, v202, vcc
  buffer_load_dword v131, v201, s[40:43], s33 offen
  v_mfma_f32_16x16x32_bf16 v[44:47], a[48:51], v[176:179], v[44:47]
  ds_read_b64_tr_b16 v[172:173], v122 offset:41984
  ds_read_b64_tr_b16 v[174:175], v122 offset:42496
  v_mfma_f32_16x16x32_bf16 v[92:95], a[52:55], v[176:179], v[92:95]
  s_waitcnt vmcnt(34) lgkmcnt(10)
  s_barrier
  v_mfma_f32_16x16x32_bf16 v[96:99], v[180:183], v[188:191], v[96:99]
  ds_read_b64_tr_b16 v[176:177], v123 offset:41984
  s_add_u32 m0, s38, 79872
  v_mfma_f32_16x16x32_bf16 v[100:103], v[188:191], v[184:187], v[100:103]
  buffer_load_dwordx4 v107, s[8:11], s17 offen lds
  v_mfma_f32_16x16x32_bf16 v[0:3], v[132:135], a[56:59], v[0:3]
  ds_read_b64_tr_b16 v[178:179], v123 offset:42496
  ds_read_b64_tr_b16 v[180:181], v118 offset:1024
  v_mfma_f32_16x16x32_bf16 v[48:51], v[132:135], a[60:63], v[48:51]
  ds_read_b64_tr_b16 v[182:183], v118 offset:1536
  buffer_load_dwordx4 v108, s[8:11], s17 offen offset:1024 lds
  v_mfma_f32_16x16x32_bf16 v[4:7], v[136:139], a[56:59], v[4:7]
  ds_read_b128 v[188:191], v119 offset:12288
  ds_read_b64_tr_b16 v[184:185], v118 offset:2048
  ds_read_b64_tr_b16 v[186:187], v118 offset:2560
  v_mfma_f32_16x16x32_bf16 v[52:55], v[136:139], a[60:63], v[52:55]
  buffer_load_dwordx4 v109, s[8:11], s17 offen offset:2048 lds
  v_mfma_f32_16x16x32_bf16 v[8:11], v[140:143], a[56:59], v[8:11]
  ds_read_b64_tr_b16 v[132:133], v114 offset:0
  ds_read_b64_tr_b16 v[134:135], v114 offset:512
  v_mfma_f32_16x16x32_bf16 v[56:59], v[140:143], a[60:63], v[56:59]
  ds_read_b64_tr_b16 v[136:137], v115 offset:0
  s_add_u32 s17, s17, 196608
  v_mfma_f32_16x16x32_bf16 v[12:15], v[144:147], a[56:59], v[12:15]
  ds_read_b64_tr_b16 v[138:139], v115 offset:512
  ds_read_b64_tr_b16 v[140:141], v116 offset:0
  v_mfma_f32_16x16x32_bf16 v[60:63], v[144:147], a[60:63], v[60:63]
  ds_read_b64_tr_b16 v[142:143], v116 offset:512
  s_cmp_eq_u32 s17, s10
  v_mfma_f32_16x16x32_bf16 v[16:19], v[148:151], a[56:59], v[16:19]
  ds_read_b64_tr_b16 v[144:145], v117 offset:0
  ds_read_b64_tr_b16 v[146:147], v117 offset:512
  v_mfma_f32_16x16x32_bf16 v[64:67], v[148:151], a[60:63], v[64:67]
  ds_read_b64_tr_b16 v[148:149], v114 offset:1024
  s_cselect_b32 s17, 0, s17
  v_mfma_f32_16x16x32_bf16 v[20:23], v[152:155], a[56:59], v[20:23]
  ds_read_b64_tr_b16 v[150:151], v114 offset:1536
  v_mfma_f32_16x16x32_bf16 v[68:71], v[152:155], a[60:63], v[68:71]
  ds_read_b64_tr_b16 v[152:153], v115 offset:1024
  s_add_u32 m0, s39, 79872
  s_waitcnt lgkmcnt(10)
  v_mfma_f32_16x16x32_bf16 v[24:27], v[156:159], a[56:59], v[24:27]
  ds_read_b64_tr_b16 v[154:155], v115 offset:1536
  v_mfma_f32_16x16x32_bf16 v[72:75], v[156:159], a[60:63], v[72:75]
  buffer_load_dword v106, s[4:7], s16 offen sc1 lds
  v_mfma_f32_16x16x32_bf16 v[28:31], v[160:163], a[56:59], v[28:31]
  ds_read_b64_tr_b16 v[156:157], v116 offset:1024
  ds_read_b64_tr_b16 v[158:159], v116 offset:1536
  v_mfma_f32_16x16x32_bf16 v[76:79], v[160:163], a[60:63], v[76:79]
  buffer_load_dwordx4 a[48:51], v105, s[4:7], s16 offen sc1
  v_mfma_f32_16x16x32_bf16 v[32:35], a[56:59], v[164:167], v[32:35]
  ds_read_b64_tr_b16 v[160:161], v117 offset:1024
  ds_read_b64_tr_b16 v[162:163], v117 offset:1536
  v_mfma_f32_16x16x32_bf16 v[80:83], a[60:63], v[164:167], v[80:83]
  buffer_load_dwordx4 a[52:55], v105, s[4:7], s16 offen offset:1024 sc1
  v_mfma_f32_16x16x32_bf16 v[36:39], a[56:59], v[168:171], v[36:39]
  ds_read_b64_tr_b16 v[164:165], v114 offset:2048
  ds_read_b64_tr_b16 v[166:167], v114 offset:2560
  v_mfma_f32_16x16x32_bf16 v[84:87], a[60:63], v[168:171], v[84:87]
  ds_read_b64_tr_b16 v[168:169], v115 offset:2048
  s_add_u32 s16, s16, 131072
  v_mfma_f32_16x16x32_bf16 v[40:43], a[56:59], v[172:175], v[40:43]
  ds_read_b64_tr_b16 v[170:171], v115 offset:2560
  v_mfma_f32_16x16x32_bf16 v[88:91], a[60:63], v[172:175], v[88:91]
  ds_read_b64_tr_b16 v[172:173], v116 offset:2048
  s_bitset0_b32 s16, 20
  v_mfma_f32_16x16x32_bf16 v[44:47], a[56:59], v[176:179], v[44:47]
  ds_read_b64_tr_b16 v[174:175], v116 offset:2560
  v_mfma_f32_16x16x32_bf16 v[92:95], a[60:63], v[176:179], v[92:95]
  s_waitcnt vmcnt(34) lgkmcnt(10)
  s_barrier
  v_mfma_f32_16x16x32_bf16 v[96:99], v[180:183], v[188:191], v[96:99]
  ds_read_b64_tr_b16 v[176:177], v117 offset:2048
  s_add_u32 m0, s38, 93184
  v_mfma_f32_16x16x32_bf16 v[100:103], v[188:191], v[184:187], v[100:103]
  buffer_load_dwordx4 v107, s[8:11], s17 offen lds
  v_mfma_f32_16x16x32_bf16 v[0:3], v[132:135], a[0:3], v[0:3]
  ds_read_b64_tr_b16 v[178:179], v117 offset:2560
  buffer_load_dwordx4 v108, s[8:11], s17 offen offset:1024 lds
  v_mfma_f32_16x16x32_bf16 v[48:51], v[132:135], a[4:7], v[48:51]
  ds_read_b64_tr_b16 v[180:181], v118 offset:14336
  ds_read_b64_tr_b16 v[182:183], v118 offset:14848
  buffer_load_dwordx4 v109, s[8:11], s17 offen offset:2048 lds
  v_mfma_f32_16x16x32_bf16 v[4:7], v[136:139], a[0:3], v[4:7]
  ds_read_b128 v[188:191], v119 offset:25600
  ds_read_b64_tr_b16 v[184:185], v118 offset:15360
  ds_read_b64_tr_b16 v[186:187], v118 offset:15872
  s_add_u32 s17, s17, 196608
  v_mfma_f32_16x16x32_bf16 v[52:55], v[136:139], a[4:7], v[52:55]
  ds_read_b64_tr_b16 v[132:133], v114 offset:13312
  s_cmp_eq_u32 s17, s10
  v_mfma_f32_16x16x32_bf16 v[8:11], v[140:143], a[0:3], v[8:11]
  ds_read_b64_tr_b16 v[134:135], v114 offset:13824
  s_cselect_b32 s17, 0, s17
  v_mfma_f32_16x16x32_bf16 v[56:59], v[140:143], a[4:7], v[56:59]
  s_add_u32 s8, s8, s10
  s_addc_u32 s9, s9, 0
  v_mfma_f32_16x16x32_bf16 v[12:15], v[144:147], a[0:3], v[12:15]
  ds_read_b64_tr_b16 v[136:137], v115 offset:13312
  ds_read_b64_tr_b16 v[138:139], v115 offset:13824
  s_add_u32 m0, s39, 93184
  v_mfma_f32_16x16x32_bf16 v[60:63], v[144:147], a[4:7], v[60:63]
  buffer_load_dword v106, s[4:7], s16 offen sc1 lds
  v_mfma_f32_16x16x32_bf16 v[16:19], v[148:151], a[0:3], v[16:19]
  ds_read_b64_tr_b16 v[140:141], v116 offset:13312
  ds_read_b64_tr_b16 v[142:143], v116 offset:13824
  buffer_load_dwordx4 a[56:59], v105, s[4:7], s16 offen sc1
  v_mfma_f32_16x16x32_bf16 v[64:67], v[148:151], a[4:7], v[64:67]
  buffer_load_dwordx4 a[60:63], v105, s[4:7], s16 offen offset:1024 sc1
  v_mfma_f32_16x16x32_bf16 v[20:23], v[152:155], a[0:3], v[20:23]
  ds_read_b64_tr_b16 v[144:145], v117 offset:13312
  ds_read_b64_tr_b16 v[146:147], v117 offset:13824
  s_add_u32 s16, s16, 131072
  v_mfma_f32_16x16x32_bf16 v[68:71], v[152:155], a[4:7], v[68:71]
  ds_read_b64_tr_b16 v[148:149], v114 offset:14336
  s_bitset0_b32 s16, 20
  s_waitcnt lgkmcnt(10)
  v_mfma_f32_16x16x32_bf16 v[24:27], v[156:159], a[0:3], v[24:27]
  ds_read_b64_tr_b16 v[150:151], v114 offset:14848
  s_add_u32 s4, s4, s6
  s_addc_u32 s5, s5, 0
  v_mfma_f32_16x16x32_bf16 v[72:75], v[156:159], a[4:7], v[72:75]
  ds_read_b64_tr_b16 v[152:153], v115 offset:14336
  s_mov_b32 m0, s51
  v_mfma_f32_16x16x32_bf16 v[28:31], v[160:163], a[0:3], v[28:31]
  ds_read_b64_tr_b16 v[154:155], v115 offset:14848
  s_add_u32 s51, s51, 1024
  v_mfma_f32_16x16x32_bf16 v[76:79], v[160:163], a[4:7], v[76:79]
  buffer_load_dwordx4 v129, s[52:55], s50 offen nt lds
  v_mfma_f32_16x16x32_bf16 v[32:35], a[0:3], v[164:167], v[32:35]
  ds_read_b64_tr_b16 v[156:157], v116 offset:14336
  ds_read_b64_tr_b16 v[158:159], v116 offset:14848
  s_add_u32 s50, s50, 98304
  v_mfma_f32_16x16x32_bf16 v[80:83], a[4:7], v[164:167], v[80:83]
  ds_read_b64_tr_b16 v[160:161], v117 offset:14336
  s_mov_b32 m0, s51
  v_mfma_f32_16x16x32_bf16 v[36:39], a[0:3], v[168:171], v[36:39]
  ds_read_b64_tr_b16 v[162:163], v117 offset:14848
  s_add_u32 s51, s51, 1024
  v_mfma_f32_16x16x32_bf16 v[84:87], a[4:7], v[168:171], v[84:87]
  buffer_load_dwordx4 v129, s[52:55], s50 offen nt lds
  v_mfma_f32_16x16x32_bf16 v[40:43], a[0:3], v[172:175], v[40:43]
  ds_read_b64_tr_b16 v[164:165], v114 offset:15360
  ds_read_b64_tr_b16 v[166:167], v114 offset:15872
  s_add_u32 s50, s50, 98304
  v_mfma_f32_16x16x32_bf16 v[88:91], a[4:7], v[172:175], v[88:91]
  buffer_store_dwordx4 v[244:247], v119, s[92:95], s35 offen offset:3072 sc1
  v_mfma_f32_16x16x32_bf16 v[44:47], a[0:3], v[176:179], v[44:47]
  ds_read_b64_tr_b16 v[168:169], v115 offset:15360
  ds_read_b64_tr_b16 v[170:171], v115 offset:15872
  v_mfma_f32_16x16x32_bf16 v[92:95], a[4:7], v[176:179], v[92:95]
  s_waitcnt vmcnt(37) lgkmcnt(10)
  s_barrier
  v_mfma_f32_16x16x32_bf16 v[96:99], v[180:183], v[188:191], v[96:99]
  ds_read_b64_tr_b16 v[172:173], v116 offset:15360
  ds_read_b64_tr_b16 v[174:175], v116 offset:15872
  s_add_u32 m0, s38, 0
  v_mfma_f32_16x16x32_bf16 v[100:103], v[188:191], v[184:187], v[100:103]
  buffer_load_dwordx4 v107, s[8:11], s17 offen lds
  v_mfma_f32_16x16x32_bf16 v[0:3], v[132:135], a[8:11], v[0:3]
  ds_read_b64_tr_b16 v[176:177], v117 offset:15360
  ds_read_b64_tr_b16 v[178:179], v117 offset:15872
  v_mfma_f32_16x16x32_bf16 v[48:51], v[132:135], a[12:15], v[48:51]
  ds_read_b64_tr_b16 v[180:181], v118 offset:27648
  ds_read_b64_tr_b16 v[182:183], v118 offset:28160
  buffer_load_dwordx4 v108, s[8:11], s17 offen offset:1024 lds
  v_mfma_f32_16x16x32_bf16 v[4:7], v[136:139], a[8:11], v[4:7]
  ds_read_b128 v[188:191], v119 offset:38912
  ds_read_b64_tr_b16 v[184:185], v118 offset:28672
  ds_read_b64_tr_b16 v[186:187], v118 offset:29184
  v_mfma_f32_16x16x32_bf16 v[52:55], v[136:139], a[12:15], v[52:55]
  buffer_load_dwordx4 v109, s[8:11], s17 offen offset:2048 lds
  v_mfma_f32_16x16x32_bf16 v[8:11], v[140:143], a[8:11], v[8:11]
  ds_read_b64_tr_b16 v[132:133], v114 offset:26624
  ds_read_b64_tr_b16 v[134:135], v114 offset:27136
  v_mfma_f32_16x16x32_bf16 v[56:59], v[140:143], a[12:15], v[56:59]
  ds_read_b64_tr_b16 v[136:137], v115 offset:26624
  s_add_u32 s17, s17, 196608
  v_mfma_f32_16x16x32_bf16 v[12:15], v[144:147], a[8:11], v[12:15]
  ds_read_b64_tr_b16 v[138:139], v115 offset:27136
  ds_read_b64_tr_b16 v[140:141], v116 offset:26624
  v_mfma_f32_16x16x32_bf16 v[60:63], v[144:147], a[12:15], v[60:63]
  ds_read_b64_tr_b16 v[142:143], v116 offset:27136
  s_cmp_eq_u32 s17, s10
  v_mfma_f32_16x16x32_bf16 v[16:19], v[148:151], a[8:11], v[16:19]
  ds_read_b64_tr_b16 v[144:145], v117 offset:26624
  ds_read_b64_tr_b16 v[146:147], v117 offset:27136
  v_mfma_f32_16x16x32_bf16 v[64:67], v[148:151], a[12:15], v[64:67]
  ds_read_b64_tr_b16 v[148:149], v114 offset:27648
  s_cselect_b32 s17, 0, s17
  s_waitcnt lgkmcnt(10)
  v_mfma_f32_16x16x32_bf16 v[20:23], v[152:155], a[8:11], v[20:23]
  ds_read_b64_tr_b16 v[150:151], v114 offset:28160
  v_mfma_f32_16x16x32_bf16 v[68:71], v[152:155], a[12:15], v[68:71]
  ds_read_b64_tr_b16 v[152:153], v115 offset:27648
  s_add_u32 m0, s39, 0
  v_mfma_f32_16x16x32_bf16 v[24:27], v[156:159], a[8:11], v[24:27]
  ds_read_b64_tr_b16 v[154:155], v115 offset:28160
  v_mfma_f32_16x16x32_bf16 v[72:75], v[156:159], a[12:15], v[72:75]
  buffer_load_dword v106, s[4:7], s16 offen sc1 lds
  v_mfma_f32_16x16x32_bf16 v[28:31], v[160:163], a[8:11], v[28:31]
  ds_read_b64_tr_b16 v[156:157], v116 offset:27648
  ds_read_b64_tr_b16 v[158:159], v116 offset:28160
  v_mfma_f32_16x16x32_bf16 v[76:79], v[160:163], a[12:15], v[76:79]
  buffer_load_dwordx4 a[0:3], v105, s[4:7], s16 offen sc1
  v_mfma_f32_16x16x32_bf16 v[32:35], a[8:11], v[164:167], v[32:35]
  ds_read_b64_tr_b16 v[160:161], v117 offset:27648
  ds_read_b64_tr_b16 v[162:163], v117 offset:28160
  v_mfma_f32_16x16x32_bf16 v[80:83], a[12:15], v[164:167], v[80:83]
  buffer_load_dwordx4 a[4:7], v105, s[4:7], s16 offen offset:1024 sc1
  v_mfma_f32_16x16x32_bf16 v[36:39], a[8:11], v[168:171], v[36:39]
  ds_read_b64_tr_b16 v[164:165], v114 offset:28672
  ds_read_b64_tr_b16 v[166:167], v114 offset:29184
  v_mfma_f32_16x16x32_bf16 v[84:87], a[12:15], v[168:171], v[84:87]
  ds_read_b64_tr_b16 v[168:169], v115 offset:28672
  s_add_u32 s16, s16, 131072
  v_mfma_f32_16x16x32_bf16 v[40:43], a[8:11], v[172:175], v[40:43]
  ds_read_b64_tr_b16 v[170:171], v115 offset:29184
  v_mfma_f32_16x16x32_bf16 v[88:91], a[12:15], v[172:175], v[88:91]
  ds_read_b64_tr_b16 v[172:173], v116 offset:28672
  s_bitset0_b32 s16, 20
  v_mfma_f32_16x16x32_bf16 v[44:47], a[8:11], v[176:179], v[44:47]
  ds_read_b64_tr_b16 v[174:175], v116 offset:29184
  v_mfma_f32_16x16x32_bf16 v[92:95], a[12:15], v[176:179], v[92:95]
  s_waitcnt vmcnt(37) lgkmcnt(10)
  s_barrier
  v_mfma_f32_16x16x32_bf16 v[96:99], v[180:183], v[188:191], v[96:99]
  ds_read_b64_tr_b16 v[176:177], v117 offset:28672
  s_add_u32 m0, s38, 13312
  v_mfma_f32_16x16x32_bf16 v[100:103], v[188:191], v[184:187], v[100:103]
  buffer_load_dwordx4 v107, s[8:11], s17 offen lds
  v_mfma_f32_16x16x32_bf16 v[0:3], v[132:135], a[16:19], v[0:3]
  ds_read_b64_tr_b16 v[178:179], v117 offset:29184
  ds_read_b64_tr_b16 v[180:181], v118 offset:40960
  v_mfma_f32_16x16x32_bf16 v[48:51], v[132:135], a[20:23], v[48:51]
  ds_read_b64_tr_b16 v[182:183], v118 offset:41472
  buffer_load_dwordx4 v108, s[8:11], s17 offen offset:1024 lds
  v_mfma_f32_16x16x32_bf16 v[4:7], v[136:139], a[16:19], v[4:7]
  ds_read_b128 v[188:191], v119 offset:52224
  ds_read_b64_tr_b16 v[184:185], v118 offset:41984
  ds_read_b64_tr_b16 v[186:187], v118 offset:42496
  v_mfma_f32_16x16x32_bf16 v[52:55], v[136:139], a[20:23], v[52:55]
  buffer_load_dwordx4 v109, s[8:11], s17 offen offset:2048 lds
  v_mfma_f32_16x16x32_bf16 v[8:11], v[140:143], a[16:19], v[8:11]
  ds_read_b64_tr_b16 v[132:133], v114 offset:39936
  ds_read_b64_tr_b16 v[134:135], v114 offset:40448
  v_mfma_f32_16x16x32_bf16 v[56:59], v[140:143], a[20:23], v[56:59]
  ds_read_b64_tr_b16 v[136:137], v115 offset:39936
  s_add_u32 s17, s17, 196608
  v_mfma_f32_16x16x32_bf16 v[12:15], v[144:147], a[16:19], v[12:15]
  ds_read_b64_tr_b16 v[138:139], v115 offset:40448
  ds_read_b64_tr_b16 v[140:141], v116 offset:39936
  v_mfma_f32_16x16x32_bf16 v[60:63], v[144:147], a[20:23], v[60:63]
  ds_read_b64_tr_b16 v[142:143], v116 offset:40448
  s_cmp_eq_u32 s17, s10
  v_mfma_f32_16x16x32_bf16 v[16:19], v[148:151], a[16:19], v[16:19]
  ds_read_b64_tr_b16 v[144:145], v117 offset:39936
  ds_read_b64_tr_b16 v[146:147], v117 offset:40448
  v_mfma_f32_16x16x32_bf16 v[64:67], v[148:151], a[20:23], v[64:67]
  ds_read_b64_tr_b16 v[148:149], v114 offset:40960
  s_cselect_b32 s17, 0, s17
  v_mfma_f32_16x16x32_bf16 v[20:23], v[152:155], a[16:19], v[20:23]
  ds_read_b64_tr_b16 v[150:151], v114 offset:41472
  v_mfma_f32_16x16x32_bf16 v[68:71], v[152:155], a[20:23], v[68:71]
  ds_read_b64_tr_b16 v[152:153], v115 offset:40960
  s_add_u32 m0, s39, 13312
  s_waitcnt lgkmcnt(10)
  v_mfma_f32_16x16x32_bf16 v[24:27], v[156:159], a[16:19], v[24:27]
  ds_read_b64_tr_b16 v[154:155], v115 offset:41472
  v_mfma_f32_16x16x32_bf16 v[72:75], v[156:159], a[20:23], v[72:75]
  buffer_load_dword v106, s[4:7], s16 offen sc1 lds
  v_mfma_f32_16x16x32_bf16 v[28:31], v[160:163], a[16:19], v[28:31]
  ds_read_b64_tr_b16 v[156:157], v116 offset:40960
  ds_read_b64_tr_b16 v[158:159], v116 offset:41472
  v_mfma_f32_16x16x32_bf16 v[76:79], v[160:163], a[20:23], v[76:79]
  buffer_load_dwordx4 a[8:11], v105, s[4:7], s16 offen sc1
  v_mfma_f32_16x16x32_bf16 v[32:35], a[16:19], v[164:167], v[32:35]
  ds_read_b64_tr_b16 v[160:161], v117 offset:40960
  ds_read_b64_tr_b16 v[162:163], v117 offset:41472
  v_mfma_f32_16x16x32_bf16 v[80:83], a[20:23], v[164:167], v[80:83]
  buffer_load_dwordx4 a[12:15], v105, s[4:7], s16 offen offset:1024 sc1
  v_mfma_f32_16x16x32_bf16 v[36:39], a[16:19], v[168:171], v[36:39]
  ds_read_b64_tr_b16 v[164:165], v114 offset:41984
  ds_read_b64_tr_b16 v[166:167], v114 offset:42496
  v_mfma_f32_16x16x32_bf16 v[84:87], a[20:23], v[168:171], v[84:87]
  ds_read_b64_tr_b16 v[168:169], v115 offset:41984
  s_add_u32 s16, s16, 131072
  v_mfma_f32_16x16x32_bf16 v[40:43], a[16:19], v[172:175], v[40:43]
  ds_read_b64_tr_b16 v[170:171], v115 offset:42496
  v_mfma_f32_16x16x32_bf16 v[88:91], a[20:23], v[172:175], v[88:91]
  ds_read_b64_tr_b16 v[172:173], v116 offset:41984
  s_bitset0_b32 s16, 20
  v_mfma_f32_16x16x32_bf16 v[44:47], a[16:19], v[176:179], v[44:47]
  ds_read_b64_tr_b16 v[174:175], v116 offset:42496
  v_mfma_f32_16x16x32_bf16 v[92:95], a[20:23], v[176:179], v[92:95]
  s_waitcnt vmcnt(34) lgkmcnt(10)
  s_barrier
  v_mfma_f32_16x16x32_bf16 v[96:99], v[180:183], v[188:191], v[96:99]
  ds_read_b64_tr_b16 v[176:177], v117 offset:41984
  s_add_u32 m0, s38, 26624
  v_mfma_f32_16x16x32_bf16 v[100:103], v[188:191], v[184:187], v[100:103]
  buffer_load_dwordx4 v107, s[8:11], s17 offen lds
  v_mfma_f32_16x16x32_bf16 v[0:3], v[132:135], a[24:27], v[0:3]
  ds_read_b64_tr_b16 v[178:179], v117 offset:42496
  ds_read_b64_tr_b16 v[180:181], v124 offset:1024
  v_mfma_f32_16x16x32_bf16 v[48:51], v[132:135], a[28:31], v[48:51]
  ds_read_b64_tr_b16 v[182:183], v124 offset:1536
  buffer_load_dwordx4 v108, s[8:11], s17 offen offset:1024 lds
  v_mfma_f32_16x16x32_bf16 v[4:7], v[136:139], a[24:27], v[4:7]
  ds_read_b128 v[188:191], v125 offset:12288
  ds_read_b64_tr_b16 v[184:185], v124 offset:2048
  ds_read_b64_tr_b16 v[186:187], v124 offset:2560
  v_mfma_f32_16x16x32_bf16 v[52:55], v[136:139], a[28:31], v[52:55]
  buffer_load_dwordx4 v109, s[8:11], s17 offen offset:2048 lds
  v_mfma_f32_16x16x32_bf16 v[8:11], v[140:143], a[24:27], v[8:11]
  ds_read_b64_tr_b16 v[132:133], v120 offset:0
  ds_read_b64_tr_b16 v[134:135], v120 offset:512
  v_mfma_f32_16x16x32_bf16 v[56:59], v[140:143], a[28:31], v[56:59]
  ds_read_b64_tr_b16 v[136:137], v121 offset:0
  s_add_u32 s17, s17, 196608
  v_mfma_f32_16x16x32_bf16 v[12:15], v[144:147], a[24:27], v[12:15]
  ds_read_b64_tr_b16 v[138:139], v121 offset:512
  ds_read_b64_tr_b16 v[140:141], v122 offset:0
  v_mfma_f32_16x16x32_bf16 v[60:63], v[144:147], a[28:31], v[60:63]
  ds_read_b64_tr_b16 v[142:143], v122 offset:512
  s_cmp_eq_u32 s17, s10
  v_mfma_f32_16x16x32_bf16 v[16:19], v[148:151], a[24:27], v[16:19]
  ds_read_b64_tr_b16 v[144:145], v123 offset:0
  ds_read_b64_tr_b16 v[146:147], v123 offset:512
  v_mfma_f32_16x16x32_bf16 v[64:67], v[148:151], a[28:31], v[64:67]
  ds_read_b64_tr_b16 v[148:149], v120 offset:1024
  s_cselect_b32 s17, 0, s17
  v_mfma_f32_16x16x32_bf16 v[20:23], v[152:155], a[24:27], v[20:23]
  ds_read_b64_tr_b16 v[150:151], v120 offset:1536
  v_mfma_f32_16x16x32_bf16 v[68:71], v[152:155], a[28:31], v[68:71]
  ds_read_b64_tr_b16 v[152:153], v121 offset:1024
  s_add_u32 m0, s39, 26624
  s_waitcnt lgkmcnt(10)
  v_mfma_f32_16x16x32_bf16 v[24:27], v[156:159], a[24:27], v[24:27]
  ds_read_b64_tr_b16 v[154:155], v121 offset:1536
  v_mfma_f32_16x16x32_bf16 v[72:75], v[156:159], a[28:31], v[72:75]
  buffer_load_dword v106, s[4:7], s16 offen sc1 lds
  v_mfma_f32_16x16x32_bf16 v[28:31], v[160:163], a[24:27], v[28:31]
  ds_read_b64_tr_b16 v[156:157], v122 offset:1024
  ds_read_b64_tr_b16 v[158:159], v122 offset:1536
  v_mfma_f32_16x16x32_bf16 v[76:79], v[160:163], a[28:31], v[76:79]
  buffer_load_dwordx4 a[16:19], v105, s[4:7], s16 offen sc1
  v_mfma_f32_16x16x32_bf16 v[32:35], a[24:27], v[164:167], v[32:35]
  ds_read_b64_tr_b16 v[160:161], v123 offset:1024
  ds_read_b64_tr_b16 v[162:163], v123 offset:1536
  v_mfma_f32_16x16x32_bf16 v[80:83], a[28:31], v[164:167], v[80:83]
  buffer_load_dwordx4 a[20:23], v105, s[4:7], s16 offen offset:1024 sc1
  v_mfma_f32_16x16x32_bf16 v[36:39], a[24:27], v[168:171], v[36:39]
  ds_read_b64_tr_b16 v[164:165], v120 offset:2048
  ds_read_b64_tr_b16 v[166:167], v120 offset:2560
  v_mfma_f32_16x16x32_bf16 v[84:87], a[28:31], v[168:171], v[84:87]
  ds_read_b64_tr_b16 v[168:169], v121 offset:2048
  s_add_u32 s16, s16, 131072
  v_mfma_f32_16x16x32_bf16 v[40:43], a[24:27], v[172:175], v[40:43]
  ds_read_b64_tr_b16 v[170:171], v121 offset:2560
  v_mfma_f32_16x16x32_bf16 v[88:91], a[28:31], v[172:175], v[88:91]
  ds_read_b64_tr_b16 v[172:173], v122 offset:2048
  s_bitset0_b32 s16, 20
  v_mfma_f32_16x16x32_bf16 v[44:47], a[24:27], v[176:179], v[44:47]
  ds_read_b64_tr_b16 v[174:175], v122 offset:2560
  v_mfma_f32_16x16x32_bf16 v[92:95], a[28:31], v[176:179], v[92:95]
  s_waitcnt vmcnt(18) lgkmcnt(10)
  s_barrier
  v_mfma_f32_16x16x32_bf16 v[96:99], v[180:183], v[188:191], v[96:99]
  ds_read_b64_tr_b16 v[176:177], v123 offset:2048
  s_add_u32 m0, s38, 39936
  v_mfma_f32_16x16x32_bf16 v[100:103], v[188:191], v[184:187], v[100:103]
  ds_read_b64_tr_b16 a[64:65], v196 offset:0
  buffer_load_dwordx4 v107, s[8:11], s17 offen lds
  v_mfma_f32_16x16x32_bf16 v[0:3], v[132:135], a[32:35], v[0:3]
  ds_read_b64_tr_b16 v[178:179], v123 offset:2560
  buffer_load_dwordx4 v108, s[8:11], s17 offen offset:1024 lds
  v_mfma_f32_16x16x32_bf16 v[48:51], v[132:135], a[36:39], v[48:51]
  ds_read_b64_tr_b16 v[180:181], v124 offset:14336
  ds_read_b64_tr_b16 v[182:183], v124 offset:14848
  ds_read_b64_tr_b16 a[66:67], v196 offset:512
  v_mfma_f32_16x16x32_bf16 v[4:7], v[136:139], a[32:35], v[4:7]
  ds_read_b128 v[188:191], v125 offset:25600
  ds_read_b64_tr_b16 v[184:185], v124 offset:15360
  ds_read_b64_tr_b16 v[186:187], v124 offset:15872
  buffer_load_dwordx4 v109, s[8:11], s17 offen offset:2048 lds
  v_mfma_f32_16x16x32_bf16 v[52:55], v[136:139], a[36:39], v[52:55]
  ds_read_b128 a[68:71], v197 offset:0
  s_add_u32 s17, s17, 196608
  v_mfma_f32_16x16x32_bf16 v[8:11], v[140:143], a[32:35], v[8:11]
  ds_read_b64_tr_b16 v[132:133], v120 offset:13312
  ds_read_b64_tr_b16 v[134:135], v120 offset:13824
  s_cmp_eq_u32 s17, s10
  v_mfma_f32_16x16x32_bf16 v[56:59], v[140:143], a[36:39], v[56:59]
  ds_read_b64_tr_b16 v[136:137], v121 offset:13312
  ds_read_b64_tr_b16 a[72:73], v196 offset:4096
  v_mfma_f32_16x16x32_bf16 v[12:15], v[144:147], a[32:35], v[12:15]
  ds_read_b64_tr_b16 v[138:139], v121 offset:13824
  s_cselect_b32 s17, 0, s17
  v_mfma_f32_16x16x32_bf16 v[60:63], v[144:147], a[36:39], v[60:63]
  ds_read_b64_tr_b16 v[140:141], v122 offset:13312
  ds_read_b64_tr_b16 a[74:75], v196 offset:4608
  v_mfma_f32_16x16x32_bf16 v[16:19], v[148:151], a[32:35], v[16:19]
  ds_read_b64_tr_b16 v[142:143], v122 offset:13824
  s_add_u32 m0, s39, 39936
  v_mfma_f32_16x16x32_bf16 v[64:67], v[148:151], a[36:39], v[64:67]
  ds_read_b128 a[76:79], v197 offset:64
  buffer_load_dword v106, s[4:7], s16 offen sc1 lds
  v_mfma_f32_16x16x32_bf16 v[20:23], v[152:155], a[32:35], v[20:23]
  ds_read_b64_tr_b16 v[144:145], v123 offset:13312
  ds_read_b64_tr_b16 v[146:147], v123 offset:13824
  buffer_load_dwordx4 a[24:27], v105, s[4:7], s16 offen sc1
  v_mfma_f32_16x16x32_bf16 v[68:71], v[152:155], a[36:39], v[68:71]
  ds_read_b64_tr_b16 v[148:149], v120 offset:14336
  ds_read_b64_tr_b16 a[80:81], v196 offset:8192
  s_waitcnt lgkmcnt(10)
  v_mfma_f32_16x16x32_bf16 v[24:27], v[156:159], a[32:35], v[24:27]
  ds_read_b64_tr_b16 v[150:151], v120 offset:14848
  buffer_load_dwordx4 a[28:31], v105, s[4:7], s16 offen offset:1024 sc1
  v_mfma_f32_16x16x32_bf16 v[72:75], v[156:159], a[36:39], v[72:75]
  ds_read_b64_tr_b16 a[82:83], v196 offset:8704
  s_add_u32 s16, s16, 131072
  v_mfma_f32_16x16x32_bf16 v[28:31], v[160:163], a[32:35], v[28:31]
  ds_read_b64_tr_b16 v[152:153], v121 offset:14336
  ds_read_b64_tr_b16 v[154:155], v121 offset:14848
  s_bitset0_b32 s16, 20
  v_mfma_f32_16x16x32_bf16 v[76:79], v[160:163], a[36:39], v[76:79]
  ds_read_b64_tr_b16 v[156:157], v122 offset:14336
  ds_read_b128 a[84:87], v197 offset:128
  v_mfma_f32_16x16x32_bf16 v[32:35], a[32:35], v[164:167], v[32:35]
  ds_read_b64_tr_b16 v[158:159], v122 offset:14848
  s_mov_b32 s52, s24
  v_mfma_f32_16x16x32_bf16 v[80:83], a[36:39], v[164:167], v[80:83]
  ds_read_b64_tr_b16 a[88:89], v196 offset:12288
  s_mov_b32 s53, s25
  v_mfma_f32_16x16x32_bf16 v[36:39], a[32:35], v[168:171], v[36:39]
  ds_read_b64_tr_b16 v[160:161], v123 offset:14336
  ds_read_b64_tr_b16 v[162:163], v123 offset:14848
  s_mov_b32 s54, 0x200000
  v_mfma_f32_16x16x32_bf16 v[84:87], a[36:39], v[168:171], v[84:87]
  ds_read_b64_tr_b16 v[164:165], v120 offset:15360
  ds_read_b64_tr_b16 a[90:91], v196 offset:12800
  v_mfma_f32_16x16x32_bf16 v[40:43], a[32:35], v[172:175], v[40:43]
  ds_read_b64_tr_b16 v[166:167], v120 offset:15872
  s_mov_b32 s55, 0x20000
  v_mfma_f32_16x16x32_bf16 v[88:91], a[36:39], v[172:175], v[88:91]
  ds_read_b64_tr_b16 v[168:169], v121 offset:15360
  ds_read_b128 a[92:95], v197 offset:192
  v_mfma_f32_16x16x32_bf16 v[44:47], a[32:35], v[176:179], v[44:47]
  ds_read_b64_tr_b16 v[170:171], v121 offset:15872
  s_lshl_b32 s51, s3, 11
  v_mfma_f32_16x16x32_bf16 v[92:95], a[36:39], v[176:179], v[92:95]
  s_waitcnt vmcnt(33) lgkmcnt(10)
  s_barrier
  v_mfma_f32_16x16x32_bf16 v[96:99], v[180:183], v[188:191], v[96:99]
  ds_read_b64_tr_b16 v[172:173], v122 offset:15360
  ds_read_b64_tr_b16 v[174:175], v122 offset:15872
  s_add_u32 m0, s38, 53248
  v_mfma_f32_16x16x32_bf16 v[100:103], v[188:191], v[184:187], v[100:103]
  ds_read_b64_tr_b16 a[96:97], v196 offset:16384
  buffer_load_dwordx4 v107, s[8:11], s17 offen lds
  v_mfma_f32_16x16x32_bf16 v[0:3], v[132:135], a[40:43], v[0:3]
  ds_read_b64_tr_b16 v[176:177], v123 offset:15360
  ds_read_b64_tr_b16 v[178:179], v123 offset:15872
  v_mfma_f32_16x16x32_bf16 v[192:195], a[64:67], a[68:71], 0
  v_mfma_f32_16x16x32_bf16 v[48:51], v[132:135], a[44:47], v[48:51]
  ds_read_b64_tr_b16 v[180:181], v124 offset:27648
  ds_read_b64_tr_b16 v[182:183], v124 offset:28160
  ds_read_b64_tr_b16 a[98:99], v196 offset:16896
  v_mfma_f32_16x16x32_bf16 v[4:7], v[136:139], a[40:43], v[4:7]
  ds_read_b128 v[188:191], v125 offset:38912
  ds_read_b64_tr_b16 v[184:185], v124 offset:28672
  ds_read_b64_tr_b16 v[186:187], v124 offset:29184
  buffer_load_dwordx4 v108, s[8:11], s17 offen offset:1024 lds
  v_mfma_f32_16x16x32_bf16 v[52:55], v[136:139], a[44:47], v[52:55]
  ds_read_b64_tr_b16 v[132:133], v120 offset:26624
  ds_read_b128 a[100:103], v197 offset:256
  v_mfma_f32_16x16x32_bf16 v[8:11], v[140:143], a[40:43], v[8:11]
  ds_read_b64_tr_b16 v[134:135], v120 offset:27136
  buffer_load_dwordx4 v109, s[8:11], s17 offen offset:2048 lds
  v_mfma_f32_16x16x32_bf16 v[56:59], v[140:143], a[44:47], v[56:59]
  ds_read_b64_tr_b16 a[104:105], v196 offset:20480
  s_add_u32 s17, s17, 196608
  v_mfma_f32_16x16x32_bf16 v[12:15], v[144:147], a[40:43], v[12:15]
  ds_read_b64_tr_b16 v[136:137], v121 offset:26624
  ds_read_b64_tr_b16 v[138:139], v121 offset:27136
  v_mfma_f32_16x16x32_bf16 v[192:195], a[72:75], a[76:79], v[192:195]
  v_mfma_f32_16x16x32_bf16 v[60:63], v[144:147], a[44:47], v[60:63]
  ds_read_b64_tr_b16 v[140:141], v122 offset:26624
  ds_read_b64_tr_b16 a[106:107], v196 offset:20992
  v_mfma_f32_16x16x32_bf16 v[16:19], v[148:151], a[40:43], v[16:19]
  ds_read_b64_tr_b16 v[142:143], v122 offset:27136
  s_cmp_eq_u32 s17, s10
  v_mfma_f32_16x16x32_bf16 v[64:67], v[148:151], a[44:47], v[64:67]
  ds_read_b64_tr_b16 v[144:145], v123 offset:26624
  ds_read_b128 a[108:111], v197 offset:320
  v_mfma_f32_16x16x32_bf16 v[20:23], v[152:155], a[40:43], v[20:23]
  ds_read_b64_tr_b16 v[146:147], v123 offset:27136
  s_cselect_b32 s17, 0, s17
  v_mfma_f32_16x16x32_bf16 v[68:71], v[152:155], a[44:47], v[68:71]
  ds_read_b64_tr_b16 a[112:113], v196 offset:24576
  s_add_u32 m0, s39, 53248
  s_waitcnt lgkmcnt(10)
  v_mfma_f32_16x16x32_bf16 v[24:27], v[156:159], a[40:43], v[24:27]
  ds_read_b64_tr_b16 v[148:149], v120 offset:27648
  ds_read_b64_tr_b16 v[150:151], v120 offset:28160
  v_mfma_f32_16x16x32_bf16 v[192:195], a[80:83], a[84:87], v[192:195]
  v_mfma_f32_16x16x32_bf16 v[72:75], v[156:159], a[44:47], v[72:75]
  ds_read_b64_tr_b16 v[152:153], v121 offset:27648
  ds_read_b64_tr_b16 a[114:115], v196 offset:25088
  v_mfma_f32_16x16x32_bf16 v[28:31], v[160:163], a[40:43], v[28:31]
  ds_read_b64_tr_b16 v[154:155], v121 offset:28160
  buffer_load_dword v106, s[4:7], s16 offen sc1 lds
  v_mfma_f32_16x16x32_bf16 v[76:79], v[160:163], a[44:47], v[76:79]
  ds_read_b64_tr_b16 v[156:157], v122 offset:27648
  ds_read_b128 a[116:119], v197 offset:384
  v_mfma_f32_16x16x32_bf16 v[32:35], a[40:43], v[164:167], v[32:35]
  ds_read_b64_tr_b16 v[158:159], v122 offset:28160
  buffer_load_dwordx4 a[32:35], v105, s[4:7], s16 offen sc1
  v_mfma_f32_16x16x32_bf16 v[80:83], a[44:47], v[164:167], v[80:83]
  ds_read_b64_tr_b16 a[120:121], v196 offset:28672
  buffer_load_dwordx4 a[36:39], v105, s[4:7], s16 offen offset:1024 sc1
  v_mfma_f32_16x16x32_bf16 v[36:39], a[40:43], v[168:171], v[36:39]
  ds_read_b64_tr_b16 v[160:161], v123 offset:27648
  ds_read_b64_tr_b16 v[162:163], v123 offset:28160
  v_mfma_f32_16x16x32_bf16 v[192:195], a[88:91], a[92:95], v[192:195]
  v_mfma_f32_16x16x32_bf16 v[84:87], a[44:47], v[168:171], v[84:87]
  ds_read_b64_tr_b16 v[164:165], v120 offset:28672
  ds_read_b64_tr_b16 a[122:123], v196 offset:29184
  v_mfma_f32_16x16x32_bf16 v[40:43], a[40:43], v[172:175], v[40:43]
  ds_read_b64_tr_b16 v[166:167], v120 offset:29184
  s_add_u32 s16, s16, 131072
  v_mfma_f32_16x16x32_bf16 v[88:91], a[44:47], v[172:175], v[88:91]
  ds_read_b64_tr_b16 v[168:169], v121 offset:28672
  ds_read_b128 a[124:127], v197 offset:448
  v_mfma_f32_16x16x32_bf16 v[44:47], a[40:43], v[176:179], v[44:47]
  ds_read_b64_tr_b16 v[170:171], v121 offset:29184
  s_bitset0_b32 s16, 20
  v_mfma_f32_16x16x32_bf16 v[92:95], a[44:47], v[176:179], v[92:95]
  s_waitcnt vmcnt(33) lgkmcnt(10)
  s_barrier
  v_mfma_f32_16x16x32_bf16 v[96:99], v[180:183], v[188:191], v[96:99]
  ds_read_b64_tr_b16 v[172:173], v122 offset:28672
  ds_read_b64_tr_b16 v[174:175], v122 offset:29184
  s_add_u32 m0, s38, 66560
  v_mfma_f32_16x16x32_bf16 v[100:103], v[188:191], v[184:187], v[100:103]
  buffer_load_dwordx4 v107, s[8:11], s17 offen lds
  v_mfma_f32_16x16x32_bf16 v[0:3], v[132:135], a[48:51], v[0:3]
  ds_read_b64_tr_b16 v[176:177], v123 offset:28672
  ds_read_b64_tr_b16 v[178:179], v123 offset:29184
  v_mfma_f32_16x16x32_bf16 v[192:195], a[96:99], a[100:103], v[192:195]
  v_mfma_f32_16x16x32_bf16 v[48:51], v[132:135], a[52:55], v[48:51]
  ds_read_b64_tr_b16 v[180:181], v124 offset:40960
  ds_read_b64_tr_b16 v[182:183], v124 offset:41472
  buffer_load_dwordx4 v108, s[8:11], s17 offen offset:1024 lds
  v_mfma_f32_16x16x32_bf16 v[4:7], v[136:139], a[48:51], v[4:7]
  ds_read_b128 v[188:191], v125 offset:52224
  ds_read_b64_tr_b16 v[184:185], v124 offset:41984
  ds_read_b64_tr_b16 v[186:187], v124 offset:42496
  v_mfma_f32_16x16x32_bf16 v[52:55], v[136:139], a[52:55], v[52:55]
  buffer_load_dwordx4 v109, s[8:11], s17 offen offset:2048 lds
  v_mfma_f32_16x16x32_bf16 v[8:11], v[140:143], a[48:51], v[8:11]
  ds_read_b64_tr_b16 v[132:133], v120 offset:39936
  ds_read_b64_tr_b16 v[134:135], v120 offset:40448
  v_mfma_f32_16x16x32_bf16 v[56:59], v[140:143], a[52:55], v[56:59]
  ds_read_b64_tr_b16 v[136:137], v121 offset:39936
  s_add_u32 s17, s17, 196608
  v_mfma_f32_16x16x32_bf16 v[12:15], v[144:147], a[48:51], v[12:15]
  ds_read_b64_tr_b16 v[138:139], v121 offset:40448
  v_mfma_f32_16x16x32_bf16 v[192:195], a[104:107], a[108:111], v[192:195]
  v_mfma_f32_16x16x32_bf16 v[60:63], v[144:147], a[52:55], v[60:63]
  ds_read_b64_tr_b16 v[140:141], v122 offset:39936
  s_cmp_eq_u32 s17, s10
  v_mfma_f32_16x16x32_bf16 v[16:19], v[148:151], a[48:51], v[16:19]
  ds_read_b64_tr_b16 v[142:143], v122 offset:40448
  ds_read_b64_tr_b16 v[144:145], v123 offset:39936
  v_mfma_f32_16x16x32_bf16 v[64:67], v[148:151], a[52:55], v[64:67]
  ds_read_b64_tr_b16 v[146:147], v123 offset:40448
  s_cselect_b32 s17, 0, s17
  v_mfma_f32_16x16x32_bf16 v[20:23], v[152:155], a[48:51], v[20:23]
  ds_read_b64_tr_b16 v[148:149], v120 offset:40960
  ds_read_b64_tr_b16 v[150:151], v120 offset:41472
  v_mfma_f32_16x16x32_bf16 v[68:71], v[152:155], a[52:55], v[68:71]
  ds_read_b64_tr_b16 v[152:153], v121 offset:40960
  s_add_u32 m0, s39, 66560
  s_waitcnt lgkmcnt(10)
  v_mfma_f32_16x16x32_bf16 v[24:27], v[156:159], a[48:51], v[24:27]
  v_mfma_f32_16x16x32_bf16 v[192:195], a[112:115], a[116:119], v[192:195]
  v_mfma_f32_16x16x32_bf16 v[72:75], v[156:159], a[52:55], v[72:75]
  buffer_load_dword v106, s[4:7], s16 offen sc1 lds
  v_mfma_f32_16x16x32_bf16 v[28:31], v[160:163], a[48:51], v[28:31]
  ds_read_b64_tr_b16 v[154:155], v121 offset:41472
  ds_read_b64_tr_b16 v[156:157], v122 offset:40960
  v_mfma_f32_16x16x32_bf16 v[76:79], v[160:163], a[52:55], v[76:79]
  buffer_load_dwordx4 a[40:43], v105, s[4:7], s16 offen sc1
  v_mfma_f32_16x16x32_bf16 v[32:35], a[48:51], v[164:167], v[32:35]
  ds_read_b64_tr_b16 v[158:159], v122 offset:41472
  ds_read_b64_tr_b16 v[160:161], v123 offset:40960
  v_mfma_f32_16x16x32_bf16 v[80:83], a[52:55], v[164:167], v[80:83]
  buffer_load_dwordx4 a[44:47], v105, s[4:7], s16 offen offset:1024 sc1
  v_mfma_f32_16x16x32_bf16 v[36:39], a[48:51], v[168:171], v[36:39]
  ds_read_b64_tr_b16 v[162:163], v123 offset:41472
  v_mfma_f32_16x16x32_bf16 v[192:195], a[120:123], a[124:127], v[192:195]
  v_mfma_f32_16x16x32_bf16 v[84:87], a[52:55], v[168:171], v[84:87]
  ds_read_b64_tr_b16 v[164:165], v120 offset:41984
  s_add_u32 s16, s16, 131072
  v_mfma_f32_16x16x32_bf16 v[40:43], a[48:51], v[172:175], v[40:43]
  ds_read_b64_tr_b16 v[166:167], v120 offset:42496
  ds_read_b64_tr_b16 v[168:169], v121 offset:41984
  v_mfma_f32_16x16x32_bf16 v[88:91], a[52:55], v[172:175], v[88:91]
  ds_read_b64_tr_b16 v[170:171], v121 offset:42496
  s_bitset0_b32 s16, 20
  v_mfma_f32_16x16x32_bf16 v[44:47], a[48:51], v[176:179], v[44:47]
  ds_read_b64_tr_b16 v[172:173], v122 offset:41984
  ds_read_b64_tr_b16 v[174:175], v122 offset:42496
  v_mfma_f32_16x16x32_bf16 v[92:95], a[52:55], v[176:179], v[92:95]
  s_waitcnt vmcnt(30) lgkmcnt(10)
  s_barrier
  v_mfma_f32_16x16x32_bf16 v[96:99], v[180:183], v[188:191], v[96:99]
  s_add_u32 m0, s38, 79872
  s_nop 0
  buffer_load_dwordx4 v107, s[8:11], s17 offen lds
  v_mfma_f32_16x16x32_bf16 v[100:103], v[188:191], v[184:187], v[100:103]
  buffer_load_dwordx4 v108, s[8:11], s17 offen offset:1024 lds
  v_mfma_f32_16x16x32_bf16 v[0:3], v[132:135], a[56:59], v[0:3]
  ds_read_b64_tr_b16 v[176:177], v123 offset:41984
  ds_read_b64_tr_b16 v[178:179], v123 offset:42496
  buffer_load_dwordx4 v109, s[8:11], s17 offen offset:2048 lds
  v_mfma_f32_16x16x32_bf16 v[48:51], v[132:135], a[60:63], v[48:51]
  ds_read_b64_tr_b16 v[180:181], v118 offset:1024
  ds_read_b64_tr_b16 v[182:183], v118 offset:1536
  s_add_u32 s17, s17, 196608
  v_mfma_f32_16x16x32_bf16 v[4:7], v[136:139], a[56:59], v[4:7]
  ds_read_b128 v[188:191], v119 offset:12288
  ds_read_b64_tr_b16 v[184:185], v118 offset:2048
  ds_read_b64_tr_b16 v[186:187], v118 offset:2560
  s_cmp_eq_u32 s17, s10
  s_cselect_b32 s17, 0, s17
  v_mfma_f32_16x16x32_bf16 v[52:55], v[136:139], a[60:63], v[52:55]
  s_bfe_u32 s40, s19, 0x80000
  s_bfe_u32 s41, s19, 0x80008
  s_bfe_u32 s42, s19, 0x80010
  s_bfe_u32 s43, s19, 0x80018
  v_and_or_b32 v192, v192, v198, s40
  v_and_or_b32 v193, v193, v198, s41
  v_and_or_b32 v194, v194, v198, s42
  v_and_or_b32 v195, v195, v198, s43
  buffer_store_dwordx4 v[192:195], v255, s[12:15], s96 offen sc1
  s_add_u32 m0, s39, 79872
  v_mfma_f32_16x16x32_bf16 v[8:11], v[140:143], a[56:59], v[8:11]
  ds_read_b64_tr_b16 v[132:133], v114 offset:0
  ds_read_b64_tr_b16 v[134:135], v114 offset:512
  buffer_load_dword v106, s[4:7], s16 offen sc1 lds
  v_mfma_f32_16x16x32_bf16 v[56:59], v[140:143], a[60:63], v[56:59]
  buffer_load_dwordx4 a[48:51], v105, s[4:7], s16 offen sc1
  v_mfma_f32_16x16x32_bf16 v[12:15], v[144:147], a[56:59], v[12:15]
  ds_read_b64_tr_b16 v[136:137], v115 offset:0
  ds_read_b64_tr_b16 v[138:139], v115 offset:512
  buffer_load_dwordx4 a[52:55], v105, s[4:7], s16 offen offset:1024 sc1
  v_mfma_f32_16x16x32_bf16 v[60:63], v[144:147], a[60:63], v[60:63]
  ds_read_b64_tr_b16 v[140:141], v116 offset:0
  s_add_u32 s16, s16, 131072
  v_mfma_f32_16x16x32_bf16 v[16:19], v[148:151], a[56:59], v[16:19]
  ds_read_b64_tr_b16 v[142:143], v116 offset:512
  s_bitset0_b32 s16, 20
  v_mfma_f32_16x16x32_bf16 v[64:67], v[148:151], a[60:63], v[64:67]
  ds_read_b64_tr_b16 v[144:145], v117 offset:0
  s_add_u32 m0, s51, 106496
  v_mfma_f32_16x16x32_bf16 v[20:23], v[152:155], a[56:59], v[20:23]
  ds_read_b64_tr_b16 v[146:147], v117 offset:512
  s_add_u32 s50, s98, 1703936
  s_bitset0_b32 s50, 21
  v_mfma_f32_16x16x32_bf16 v[68:71], v[152:155], a[60:63], v[68:71]
  buffer_load_dwordx4 v248, s[52:55], s50 offen lds
  s_waitcnt lgkmcnt(10)
  v_mfma_f32_16x16x32_bf16 v[24:27], v[156:159], a[56:59], v[24:27]
  ds_read_b64_tr_b16 v[148:149], v114 offset:1024
  ds_read_b64_tr_b16 v[150:151], v114 offset:1536
  buffer_load_dwordx4 v249, s[52:55], s50 offen offset:1024 lds
  v_mfma_f32_16x16x32_bf16 v[72:75], v[156:159], a[60:63], v[72:75]
  ds_read_b64_tr_b16 v[152:153], v115 offset:1024
  s_add_u32 m0, s51, 114688
  v_mfma_f32_16x16x32_bf16 v[28:31], v[160:163], a[56:59], v[28:31]
  ds_read_b64_tr_b16 v[154:155], v115 offset:1536
  s_add_u32 s50, s98, 1835008
  v_mfma_f32_16x16x32_bf16 v[76:79], v[160:163], a[60:63], v[76:79]
  ds_read_b64_tr_b16 v[156:157], v116 offset:1024
  s_bitset0_b32 s50, 21
  v_mfma_f32_16x16x32_bf16 v[32:35], a[56:59], v[164:167], v[32:35]
  ds_read_b64_tr_b16 v[158:159], v116 offset:1536
  buffer_load_dwordx4 v248, s[52:55], s50 offen lds
  v_mfma_f32_16x16x32_bf16 v[80:83], a[60:63], v[164:167], v[80:83]
  buffer_load_dwordx4 v249, s[52:55], s50 offen offset:1024 lds
  v_mfma_f32_16x16x32_bf16 v[36:39], a[56:59], v[168:171], v[36:39]
  ds_read_b64_tr_b16 v[160:161], v117 offset:1024
  ds_read_b64_tr_b16 v[162:163], v117 offset:1536
  s_add_u32 m0, s51, 122880
  v_mfma_f32_16x16x32_bf16 v[84:87], a[60:63], v[168:171], v[84:87]
  ds_read_b64_tr_b16 v[164:165], v114 offset:2048
  s_add_u32 s50, s98, 1966080
  v_mfma_f32_16x16x32_bf16 v[40:43], a[56:59], v[172:175], v[40:43]
  ds_read_b64_tr_b16 v[166:167], v114 offset:2560
  s_bitset0_b32 s50, 21
  v_mfma_f32_16x16x32_bf16 v[88:91], a[60:63], v[172:175], v[88:91]
  buffer_load_dwordx4 v248, s[52:55], s50 offen lds
  v_mfma_f32_16x16x32_bf16 v[44:47], a[56:59], v[176:179], v[44:47]
  ds_read_b64_tr_b16 v[168:169], v115 offset:2048
  ds_read_b64_tr_b16 v[170:171], v115 offset:2560
  buffer_load_dwordx4 v249, s[52:55], s50 offen offset:1024 lds
  v_mfma_f32_16x16x32_bf16 v[92:95], a[60:63], v[176:179], v[92:95]
  s_waitcnt vmcnt(37) lgkmcnt(10)
  s_barrier
  v_mfma_f32_16x16x32_bf16 v[96:99], v[180:183], v[188:191], v[96:99]
  ds_read_b64_tr_b16 v[172:173], v116 offset:2048
  ds_read_b64_tr_b16 v[174:175], v116 offset:2560
  s_add_u32 m0, s38, 93184
  v_mfma_f32_16x16x32_bf16 v[100:103], v[188:191], v[184:187], v[100:103]
  buffer_load_dwordx4 v107, s[8:11], s17 offen lds
  v_mfma_f32_16x16x32_bf16 v[0:3], v[132:135], a[0:3], v[0:3]
  ds_read_b64_tr_b16 v[176:177], v117 offset:2048
  ds_read_b64_tr_b16 v[178:179], v117 offset:2560
  v_mfma_f32_16x16x32_bf16 v[48:51], v[132:135], a[4:7], v[48:51]
  ds_read_b64_tr_b16 v[180:181], v118 offset:14336
  ds_read_b64_tr_b16 v[182:183], v118 offset:14848
  buffer_load_dwordx4 v108, s[8:11], s17 offen offset:1024 lds
  v_mfma_f32_16x16x32_bf16 v[4:7], v[136:139], a[0:3], v[4:7]
  ds_read_b128 v[188:191], v119 offset:25600
  ds_read_b64_tr_b16 v[184:185], v118 offset:15360
  ds_read_b64_tr_b16 v[186:187], v118 offset:15872
  v_mfma_f32_16x16x32_bf16 v[52:55], v[136:139], a[4:7], v[52:55]
  buffer_load_dwordx4 v109, s[8:11], s17 offen offset:2048 lds
  v_mfma_f32_16x16x32_bf16 v[8:11], v[140:143], a[0:3], v[8:11]
  ds_read_b64_tr_b16 v[132:133], v114 offset:13312
  ds_read_b64_tr_b16 v[134:135], v114 offset:13824
  v_mfma_f32_16x16x32_bf16 v[56:59], v[140:143], a[4:7], v[56:59]
  ds_read_b64_tr_b16 v[136:137], v115 offset:13312
  s_add_u32 s17, s17, 196608
  v_mfma_f32_16x16x32_bf16 v[12:15], v[144:147], a[0:3], v[12:15]
  ds_read_b64_tr_b16 v[138:139], v115 offset:13824
  ds_read_b64_tr_b16 v[140:141], v116 offset:13312
  v_mfma_f32_16x16x32_bf16 v[60:63], v[144:147], a[4:7], v[60:63]
  ds_read_b64_tr_b16 v[142:143], v116 offset:13824
  s_cmp_eq_u32 s17, s10
  v_mfma_f32_16x16x32_bf16 v[16:19], v[148:151], a[0:3], v[16:19]
  ds_read_b64_tr_b16 v[144:145], v117 offset:13312
  ds_read_b64_tr_b16 v[146:147], v117 offset:13824
  v_mfma_f32_16x16x32_bf16 v[64:67], v[148:151], a[4:7], v[64:67]
  ds_read_b64_tr_b16 v[148:149], v114 offset:14336
  s_cselect_b32 s17, 0, s17
  s_waitcnt lgkmcnt(10)
  v_mfma_f32_16x16x32_bf16 v[20:23], v[152:155], a[0:3], v[20:23]
  ds_read_b64_tr_b16 v[150:151], v114 offset:14848
  v_mfma_f32_16x16x32_bf16 v[68:71], v[152:155], a[4:7], v[68:71]
  ds_read_b64_tr_b16 v[152:153], v115 offset:14336
  s_add_u32 m0, s39, 93184
  v_mfma_f32_16x16x32_bf16 v[24:27], v[156:159], a[0:3], v[24:27]
  ds_read_b64_tr_b16 v[154:155], v115 offset:14848
  v_mfma_f32_16x16x32_bf16 v[72:75], v[156:159], a[4:7], v[72:75]
  buffer_load_dword v106, s[4:7], s16 offen sc1 lds
  v_mfma_f32_16x16x32_bf16 v[28:31], v[160:163], a[0:3], v[28:31]
  ds_read_b64_tr_b16 v[156:157], v116 offset:14336
  ds_read_b64_tr_b16 v[158:159], v116 offset:14848
  v_mfma_f32_16x16x32_bf16 v[76:79], v[160:163], a[4:7], v[76:79]
  buffer_load_dwordx4 a[56:59], v105, s[4:7], s16 offen sc1
  v_mfma_f32_16x16x32_bf16 v[32:35], a[0:3], v[164:167], v[32:35]
  ds_read_b64_tr_b16 v[160:161], v117 offset:14336
  ds_read_b64_tr_b16 v[162:163], v117 offset:14848
  v_mfma_f32_16x16x32_bf16 v[80:83], a[4:7], v[164:167], v[80:83]
  buffer_load_dwordx4 a[60:63], v105, s[4:7], s16 offen offset:1024 sc1
  v_mfma_f32_16x16x32_bf16 v[36:39], a[0:3], v[168:171], v[36:39]
  ds_read_b64_tr_b16 v[164:165], v114 offset:15360
  ds_read_b64_tr_b16 v[166:167], v114 offset:15872
  v_mfma_f32_16x16x32_bf16 v[84:87], a[4:7], v[168:171], v[84:87]
  ds_read_b64_tr_b16 v[168:169], v115 offset:15360
  s_add_u32 s16, s16, 131072
  v_mfma_f32_16x16x32_bf16 v[40:43], a[0:3], v[172:175], v[40:43]
  ds_read_b64_tr_b16 v[170:171], v115 offset:15872
  v_mfma_f32_16x16x32_bf16 v[88:91], a[4:7], v[172:175], v[88:91]
  ds_read_b64_tr_b16 v[172:173], v116 offset:15360
  s_bitset0_b32 s16, 20
  v_mfma_f32_16x16x32_bf16 v[44:47], a[0:3], v[176:179], v[44:47]
  ds_read_b64_tr_b16 v[174:175], v116 offset:15872
  v_mfma_f32_16x16x32_bf16 v[92:95], a[4:7], v[176:179], v[92:95]
  s_waitcnt vmcnt(37) lgkmcnt(10)
  s_barrier
  v_mfma_f32_16x16x32_bf16 v[96:99], v[180:183], v[188:191], v[96:99]
  buffer_load_dword v131, v130, s[56:59], s97 offen
  v_mfma_f32_16x16x32_bf16 v[100:103], v[188:191], v[184:187], v[100:103]
  ds_read_b64_tr_b16 v[176:177], v117 offset:15360
  ds_read_b64_tr_b16 v[178:179], v117 offset:15872
  v_mfma_f32_16x16x32_bf16 v[0:3], v[132:135], a[8:11], v[0:3]
  ds_read_b64_tr_b16 v[180:181], v118 offset:27648
  ds_read_b64_tr_b16 v[182:183], v118 offset:28160
  v_mfma_f32_16x16x32_bf16 v[48:51], v[132:135], a[12:15], v[48:51]
  ds_read_b128 v[188:191], v119 offset:38912
  ds_read_b64_tr_b16 v[184:185], v118 offset:28672
  v_mfma_f32_16x16x32_bf16 v[4:7], v[136:139], a[8:11], v[4:7]
  ds_read_b64_tr_b16 v[186:187], v118 offset:29184
  s_add_u32 m0, s51, 0
  v_mfma_f32_16x16x32_bf16 v[52:55], v[136:139], a[12:15], v[52:55]
  ds_read_b64_tr_b16 v[132:133], v114 offset:26624
  ds_read_b64_tr_b16 v[134:135], v114 offset:27136
  v_mfma_f32_16x16x32_bf16 v[8:11], v[140:143], a[8:11], v[8:11]
  ds_read_b64_tr_b16 v[136:137], v115 offset:26624
  ds_read_b64_tr_b16 v[138:139], v115 offset:27136
  v_mfma_f32_16x16x32_bf16 v[56:59], v[140:143], a[12:15], v[56:59]
  ds_read_b64_tr_b16 v[140:141], v116 offset:26624
  ds_read_b64_tr_b16 v[142:143], v116 offset:27136
  v_mfma_f32_16x16x32_bf16 v[12:15], v[144:147], a[8:11], v[12:15]
  s_add_u32 s50, s98, 0
  v_mfma_f32_16x16x32_bf16 v[60:63], v[144:147], a[12:15], v[60:63]
  ds_read_b64_tr_b16 v[144:145], v117 offset:26624
  ds_read_b64_tr_b16 v[146:147], v117 offset:27136
  v_mfma_f32_16x16x32_bf16 v[16:19], v[148:151], a[8:11], v[16:19]
  v_mfma_f32_16x16x32_bf16 v[64:67], v[148:151], a[12:15], v[64:67]
  ds_read_b64_tr_b16 v[148:149], v114 offset:27648
  ds_read_b64_tr_b16 v[150:151], v114 offset:28160
  v_mfma_f32_16x16x32_bf16 v[20:23], v[152:155], a[8:11], v[20:23]
  s_bitset0_b32 s50, 21
  v_mfma_f32_16x16x32_bf16 v[68:71], v[152:155], a[12:15], v[68:71]
  ds_read_b64_tr_b16 v[152:153], v115 offset:27648
  ds_read_b64_tr_b16 v[154:155], v115 offset:28160
  s_waitcnt lgkmcnt(10)
  v_mfma_f32_16x16x32_bf16 v[24:27], v[156:159], a[8:11], v[24:27]
  v_mfma_f32_16x16x32_bf16 v[72:75], v[156:159], a[12:15], v[72:75]
  ds_read_b64_tr_b16 v[156:157], v116 offset:27648
  ds_read_b64_tr_b16 v[158:159], v116 offset:28160
  v_mfma_f32_16x16x32_bf16 v[28:31], v[160:163], a[8:11], v[28:31]
  buffer_load_dwordx4 v248, s[52:55], s50 offen lds
  v_mfma_f32_16x16x32_bf16 v[76:79], v[160:163], a[12:15], v[76:79]
  ds_read_b64_tr_b16 v[160:161], v117 offset:27648
  ds_read_b64_tr_b16 v[162:163], v117 offset:28160
  v_mfma_f32_16x16x32_bf16 v[32:35], a[8:11], v[164:167], v[32:35]
  v_mfma_f32_16x16x32_bf16 v[80:83], a[12:15], v[164:167], v[80:83]
  ds_read_b64_tr_b16 v[164:165], v114 offset:28672
  ds_read_b64_tr_b16 v[166:167], v114 offset:29184
  v_mfma_f32_16x16x32_bf16 v[36:39], a[8:11], v[168:171], v[36:39]
  buffer_load_dwordx4 v249, s[52:55], s50 offen offset:1024 lds
  v_mfma_f32_16x16x32_bf16 v[84:87], a[12:15], v[168:171], v[84:87]
  ds_read_b64_tr_b16 v[168:169], v115 offset:28672
  ds_read_b64_tr_b16 v[170:171], v115 offset:29184
  v_mfma_f32_16x16x32_bf16 v[40:43], a[8:11], v[172:175], v[40:43]
  v_mfma_f32_16x16x32_bf16 v[88:91], a[12:15], v[172:175], v[88:91]
  ds_read_b64_tr_b16 v[172:173], v116 offset:28672
  ds_read_b64_tr_b16 v[174:175], v116 offset:29184
  v_mfma_f32_16x16x32_bf16 v[44:47], a[8:11], v[176:179], v[44:47]
  v_mfma_f32_16x16x32_bf16 v[92:95], a[12:15], v[176:179], v[92:95]
  s_waitcnt vmcnt(34) lgkmcnt(10)
  s_barrier
  v_mfma_f32_16x16x32_bf16 v[96:99], v[180:183], v[188:191], v[96:99]
  ds_read_b64_tr_b16 v[176:177], v117 offset:28672
  s_add_u32 m0, s51, 8192
  v_mfma_f32_16x16x32_bf16 v[100:103], v[188:191], v[184:187], v[100:103]
  ds_read_b64_tr_b16 v[178:179], v117 offset:29184
  ds_read_b64_tr_b16 v[180:181], v118 offset:40960
  v_mfma_f32_16x16x32_bf16 v[0:3], v[132:135], a[16:19], v[0:3]
  ds_read_b64_tr_b16 v[182:183], v118 offset:41472
  s_add_u32 s50, s98, 131072
  v_mfma_f32_16x16x32_bf16 v[48:51], v[132:135], a[20:23], v[48:51]
  ds_read_b128 v[188:191], v119 offset:52224
  ds_read_b64_tr_b16 v[184:185], v118 offset:41984
  v_mfma_f32_16x16x32_bf16 v[4:7], v[136:139], a[16:19], v[4:7]
  ds_read_b64_tr_b16 v[186:187], v118 offset:42496
  ds_read_b64_tr_b16 v[132:133], v114 offset:39936
  v_mfma_f32_16x16x32_bf16 v[52:55], v[136:139], a[20:23], v[52:55]
  ds_read_b64_tr_b16 v[134:135], v114 offset:40448
  s_bitset0_b32 s50, 21
  v_mfma_f32_16x16x32_bf16 v[8:11], v[140:143], a[16:19], v[8:11]
  ds_read_b64_tr_b16 v[136:137], v115 offset:39936
  ds_read_b64_tr_b16 v[138:139], v115 offset:40448
  v_mfma_f32_16x16x32_bf16 v[56:59], v[140:143], a[20:23], v[56:59]
  buffer_load_dwordx4 v248, s[52:55], s50 offen lds
  v_mfma_f32_16x16x32_bf16 v[12:15], v[144:147], a[16:19], v[12:15]
  ds_read_b64_tr_b16 v[140:141], v116 offset:39936
  ds_read_b64_tr_b16 v[142:143], v116 offset:40448
  v_mfma_f32_16x16x32_bf16 v[60:63], v[144:147], a[20:23], v[60:63]
  ds_read_b64_tr_b16 v[144:145], v117 offset:39936
  ds_read_b64_tr_b16 v[146:147], v117 offset:40448
  v_mfma_f32_16x16x32_bf16 v[16:19], v[148:151], a[16:19], v[16:19]
  buffer_load_dwordx4 v249, s[52:55], s50 offen offset:1024 lds
  v_mfma_f32_16x16x32_bf16 v[64:67], v[148:151], a[20:23], v[64:67]
  ds_read_b64_tr_b16 v[148:149], v114 offset:40960
  ds_read_b64_tr_b16 v[150:151], v114 offset:41472
  v_mfma_f32_16x16x32_bf16 v[20:23], v[152:155], a[16:19], v[20:23]
  s_add_u32 m0, s51, 16384
  v_mfma_f32_16x16x32_bf16 v[68:71], v[152:155], a[20:23], v[68:71]
  ds_read_b64_tr_b16 v[152:153], v115 offset:40960
  ds_read_b64_tr_b16 v[154:155], v115 offset:41472
  s_waitcnt lgkmcnt(10)
  v_mfma_f32_16x16x32_bf16 v[24:27], v[156:159], a[16:19], v[24:27]
  v_mfma_f32_16x16x32_bf16 v[72:75], v[156:159], a[20:23], v[72:75]
  ds_read_b64_tr_b16 v[156:157], v116 offset:40960
  s_add_u32 s50, s98, 262144
  v_mfma_f32_16x16x32_bf16 v[28:31], v[160:163], a[16:19], v[28:31]
  ds_read_b64_tr_b16 v[158:159], v116 offset:41472
  v_mfma_f32_16x16x32_bf16 v[76:79], v[160:163], a[20:23], v[76:79]
  ds_read_b64_tr_b16 v[160:161], v117 offset:40960
  s_bitset0_b32 s50, 21
  v_mfma_f32_16x16x32_bf16 v[32:35], a[16:19], v[164:167], v[32:35]
  ds_read_b64_tr_b16 v[162:163], v117 offset:41472
  v_mfma_f32_16x16x32_bf16 v[80:83], a[20:23], v[164:167], v[80:83]
  ds_read_b64_tr_b16 v[164:165], v114 offset:41984
  ds_read_b64_tr_b16 v[166:167], v114 offset:42496
  v_mfma_f32_16x16x32_bf16 v[36:39], a[16:19], v[168:171], v[36:39]
  buffer_load_dwordx4 v248, s[52:55], s50 offen lds
  v_mfma_f32_16x16x32_bf16 v[84:87], a[20:23], v[168:171], v[84:87]
  ds_read_b64_tr_b16 v[168:169], v115 offset:41984
  ds_read_b64_tr_b16 v[170:171], v115 offset:42496
  v_mfma_f32_16x16x32_bf16 v[40:43], a[16:19], v[172:175], v[40:43]
  buffer_load_dwordx4 v249, s[52:55], s50 offen offset:1024 lds
  v_mfma_f32_16x16x32_bf16 v[88:91], a[20:23], v[172:175], v[88:91]
  ds_read_b64_tr_b16 v[172:173], v116 offset:41984
  ds_read_b64_tr_b16 v[174:175], v116 offset:42496
  v_mfma_f32_16x16x32_bf16 v[44:47], a[16:19], v[176:179], v[44:47]
  v_mfma_f32_16x16x32_bf16 v[92:95], a[20:23], v[176:179], v[92:95]
  s_waitcnt vmcnt(32) lgkmcnt(10)
  s_barrier
  v_mfma_f32_16x16x32_bf16 v[96:99], v[180:183], v[188:191], v[96:99]
  ds_read_b64_tr_b16 v[176:177], v117 offset:41984
  s_add_u32 m0, s51, 24576
  v_mfma_f32_16x16x32_bf16 v[100:103], v[188:191], v[184:187], v[100:103]
  ds_read_b64_tr_b16 v[178:179], v117 offset:42496
  ds_read_b64_tr_b16 v[180:181], v124 offset:1024
  v_mfma_f32_16x16x32_bf16 v[0:3], v[132:135], a[24:27], v[0:3]
  ds_read_b64_tr_b16 v[182:183], v124 offset:1536
  ds_read_b128 v[188:191], v125 offset:12288
  v_mfma_f32_16x16x32_bf16 v[48:51], v[132:135], a[28:31], v[48:51]
  ds_read_b64_tr_b16 v[184:185], v124 offset:2048
  ds_read_b64_tr_b16 v[186:187], v124 offset:2560
  v_mfma_f32_16x16x32_bf16 v[4:7], v[136:139], a[24:27], v[4:7]
  ds_read_b64_tr_b16 v[132:133], v120 offset:0
  ds_read_b64_tr_b16 v[134:135], v120 offset:512
  v_mfma_f32_16x16x32_bf16 v[52:55], v[136:139], a[28:31], v[52:55]
  ds_read_b64_tr_b16 v[136:137], v121 offset:0
  s_add_u32 s50, s98, 393216
  v_mfma_f32_16x16x32_bf16 v[8:11], v[140:143], a[24:27], v[8:11]
  ds_read_b64_tr_b16 v[138:139], v121 offset:512
  v_mfma_f32_16x16x32_bf16 v[56:59], v[140:143], a[28:31], v[56:59]
  ds_read_b64_tr_b16 v[140:141], v122 offset:0
  ds_read_b64_tr_b16 v[142:143], v122 offset:512
  v_mfma_f32_16x16x32_bf16 v[12:15], v[144:147], a[24:27], v[12:15]
  v_mfma_f32_16x16x32_bf16 v[60:63], v[144:147], a[28:31], v[60:63]
  ds_read_b64_tr_b16 v[144:145], v123 offset:0
  ds_read_b64_tr_b16 v[146:147], v123 offset:512
  v_mfma_f32_16x16x32_bf16 v[16:19], v[148:151], a[24:27], v[16:19]
  s_bitset0_b32 s50, 21
  v_mfma_f32_16x16x32_bf16 v[64:67], v[148:151], a[28:31], v[64:67]
  ds_read_b64_tr_b16 v[148:149], v120 offset:1024
  ds_read_b64_tr_b16 v[150:151], v120 offset:1536
  v_mfma_f32_16x16x32_bf16 v[20:23], v[152:155], a[24:27], v[20:23]
  v_mfma_f32_16x16x32_bf16 v[68:71], v[152:155], a[28:31], v[68:71]
  ds_read_b64_tr_b16 v[152:153], v121 offset:1024
  ds_read_b64_tr_b16 v[154:155], v121 offset:1536
  s_waitcnt lgkmcnt(10)
  v_mfma_f32_16x16x32_bf16 v[24:27], v[156:159], a[24:27], v[24:27]
  v_mfma_f32_16x16x32_bf16 v[72:75], v[156:159], a[28:31], v[72:75]
  buffer_load_dwordx4 v248, s[52:55], s50 offen lds
  v_mfma_f32_16x16x32_bf16 v[28:31], v[160:163], a[24:27], v[28:31]
  ds_read_b64_tr_b16 v[156:157], v122 offset:1024
  ds_read_b64_tr_b16 v[158:159], v122 offset:1536
  v_mfma_f32_16x16x32_bf16 v[76:79], v[160:163], a[28:31], v[76:79]
  ds_read_b64_tr_b16 v[160:161], v123 offset:1024
  ds_read_b64_tr_b16 v[162:163], v123 offset:1536
  v_mfma_f32_16x16x32_bf16 v[32:35], a[24:27], v[164:167], v[32:35]
  v_mfma_f32_16x16x32_bf16 v[80:83], a[28:31], v[164:167], v[80:83]
  ds_read_b64_tr_b16 v[164:165], v120 offset:2048
  ds_read_b64_tr_b16 v[166:167], v120 offset:2560
  v_mfma_f32_16x16x32_bf16 v[36:39], a[24:27], v[168:171], v[36:39]
  buffer_load_dwordx4 v249, s[52:55], s50 offen offset:1024 lds
  v_mfma_f32_16x16x32_bf16 v[84:87], a[28:31], v[168:171], v[84:87]
  ds_read_b64_tr_b16 v[168:169], v121 offset:2048
  ds_read_b64_tr_b16 v[170:171], v121 offset:2560
  v_mfma_f32_16x16x32_bf16 v[40:43], a[24:27], v[172:175], v[40:43]
  v_mfma_f32_16x16x32_bf16 v[88:91], a[28:31], v[172:175], v[88:91]
  ds_read_b64_tr_b16 v[172:173], v122 offset:2048
  ds_read_b64_tr_b16 v[174:175], v122 offset:2560
  v_mfma_f32_16x16x32_bf16 v[44:47], a[24:27], v[176:179], v[44:47]
  v_mfma_f32_16x16x32_bf16 v[92:95], a[28:31], v[176:179], v[92:95]
  s_waitcnt vmcnt(28) lgkmcnt(10)
  s_barrier
  v_mfma_f32_16x16x32_bf16 v[96:99], v[180:183], v[188:191], v[96:99]
  ds_read_b64_tr_b16 v[176:177], v123 offset:2048
  s_add_u32 m0, s51, 32768
  v_mfma_f32_16x16x32_bf16 v[100:103], v[188:191], v[184:187], v[100:103]
  ds_read_b64_tr_b16 v[178:179], v123 offset:2560
  ds_read_b64_tr_b16 v[180:181], v124 offset:14336
  v_mfma_f32_16x16x32_bf16 v[0:3], v[132:135], a[32:35], v[0:3]
  ds_read_b64_tr_b16 v[182:183], v124 offset:14848
  s_add_u32 s50, s98, 524288
  v_mfma_f32_16x16x32_bf16 v[48:51], v[132:135], a[36:39], v[48:51]
  ds_read_b128 v[188:191], v125 offset:25600
  ds_read_b64_tr_b16 v[184:185], v124 offset:15360
  v_mfma_f32_16x16x32_bf16 v[4:7], v[136:139], a[32:35], v[4:7]
  ds_read_b64_tr_b16 v[186:187], v124 offset:15872
  ds_read_b64_tr_b16 v[132:133], v120 offset:13312
  v_mfma_f32_16x16x32_bf16 v[52:55], v[136:139], a[36:39], v[52:55]
  ds_read_b64_tr_b16 v[134:135], v120 offset:13824
  s_bitset0_b32 s50, 21
  v_mfma_f32_16x16x32_bf16 v[8:11], v[140:143], a[32:35], v[8:11]
  ds_read_b64_tr_b16 v[136:137], v121 offset:13312
  ds_read_b64_tr_b16 v[138:139], v121 offset:13824
  v_mfma_f32_16x16x32_bf16 v[56:59], v[140:143], a[36:39], v[56:59]
  buffer_load_dwordx4 v248, s[52:55], s50 offen lds
  v_mfma_f32_16x16x32_bf16 v[12:15], v[144:147], a[32:35], v[12:15]
  ds_read_b64_tr_b16 v[140:141], v122 offset:13312
  ds_read_b64_tr_b16 v[142:143], v122 offset:13824
  v_mfma_f32_16x16x32_bf16 v[60:63], v[144:147], a[36:39], v[60:63]
  ds_read_b64_tr_b16 v[144:145], v123 offset:13312
  ds_read_b64_tr_b16 v[146:147], v123 offset:13824
  v_mfma_f32_16x16x32_bf16 v[16:19], v[148:151], a[32:35], v[16:19]
  buffer_load_dwordx4 v249, s[52:55], s50 offen offset:1024 lds
  v_mfma_f32_16x16x32_bf16 v[64:67], v[148:151], a[36:39], v[64:67]
  ds_read_b64_tr_b16 v[148:149], v120 offset:14336
  ds_read_b64_tr_b16 v[150:151], v120 offset:14848
  v_mfma_f32_16x16x32_bf16 v[20:23], v[152:155], a[32:35], v[20:23]
  s_add_u32 m0, s51, 40960
  v_mfma_f32_16x16x32_bf16 v[68:71], v[152:155], a[36:39], v[68:71]
  ds_read_b64_tr_b16 v[152:153], v121 offset:14336
  ds_read_b64_tr_b16 v[154:155], v121 offset:14848
  s_waitcnt lgkmcnt(10)
  v_mfma_f32_16x16x32_bf16 v[24:27], v[156:159], a[32:35], v[24:27]
  v_mfma_f32_16x16x32_bf16 v[72:75], v[156:159], a[36:39], v[72:75]
  ds_read_b64_tr_b16 v[156:157], v122 offset:14336
  s_add_u32 s50, s98, 655360
  v_mfma_f32_16x16x32_bf16 v[28:31], v[160:163], a[32:35], v[28:31]
  ds_read_b64_tr_b16 v[158:159], v122 offset:14848
  v_mfma_f32_16x16x32_bf16 v[76:79], v[160:163], a[36:39], v[76:79]
  ds_read_b64_tr_b16 v[160:161], v123 offset:14336
  s_bitset0_b32 s50, 21
  v_mfma_f32_16x16x32_bf16 v[32:35], a[32:35], v[164:167], v[32:35]
  ds_read_b64_tr_b16 v[162:163], v123 offset:14848
  v_mfma_f32_16x16x32_bf16 v[80:83], a[36:39], v[164:167], v[80:83]
  ds_read_b64_tr_b16 v[164:165], v120 offset:15360
  ds_read_b64_tr_b16 v[166:167], v120 offset:15872
  v_mfma_f32_16x16x32_bf16 v[36:39], a[32:35], v[168:171], v[36:39]
  buffer_load_dwordx4 v248, s[52:55], s50 offen lds
  v_mfma_f32_16x16x32_bf16 v[84:87], a[36:39], v[168:171], v[84:87]
  ds_read_b64_tr_b16 v[168:169], v121 offset:15360
  ds_read_b64_tr_b16 v[170:171], v121 offset:15872
  v_mfma_f32_16x16x32_bf16 v[40:43], a[32:35], v[172:175], v[40:43]
  buffer_load_dwordx4 v249, s[52:55], s50 offen offset:1024 lds
  v_mfma_f32_16x16x32_bf16 v[88:91], a[36:39], v[172:175], v[88:91]
  ds_read_b64_tr_b16 v[172:173], v122 offset:15360
  ds_read_b64_tr_b16 v[174:175], v122 offset:15872
  v_mfma_f32_16x16x32_bf16 v[44:47], a[32:35], v[176:179], v[44:47]
  v_mfma_f32_16x16x32_bf16 v[92:95], a[36:39], v[176:179], v[92:95]
  s_waitcnt vmcnt(25) lgkmcnt(10)
  s_barrier
  v_mfma_f32_16x16x32_bf16 v[96:99], v[180:183], v[188:191], v[96:99]
  ds_read_b64_tr_b16 v[176:177], v123 offset:15360
  s_add_u32 m0, s51, 49152
  v_mfma_f32_16x16x32_bf16 v[100:103], v[188:191], v[184:187], v[100:103]
  ds_read_b64_tr_b16 v[178:179], v123 offset:15872
  s_add_u32 s50, s98, 786432
  v_mfma_f32_16x16x32_bf16 v[0:3], v[132:135], a[40:43], v[0:3]
  ds_read_b64_tr_b16 v[180:181], v124 offset:27648
  s_bitset0_b32 s50, 21
  v_mfma_f32_16x16x32_bf16 v[48:51], v[132:135], a[44:47], v[48:51]
  ds_read_b64_tr_b16 v[182:183], v124 offset:28160
  buffer_load_dwordx4 v248, s[52:55], s50 offen lds
  v_mfma_f32_16x16x32_bf16 v[4:7], v[136:139], a[40:43], v[4:7]
  ds_read_b128 v[188:191], v125 offset:38912
  ds_read_b64_tr_b16 v[184:185], v124 offset:28672
  ds_read_b64_tr_b16 v[186:187], v124 offset:29184
  v_mfma_f32_16x16x32_bf16 v[52:55], v[136:139], a[44:47], v[52:55]
  buffer_load_dwordx4 v249, s[52:55], s50 offen offset:1024 lds
  v_mfma_f32_16x16x32_bf16 v[8:11], v[140:143], a[40:43], v[8:11]
  ds_read_b64_tr_b16 v[132:133], v120 offset:26624
  ds_read_b64_tr_b16 v[134:135], v120 offset:27136
  s_add_u32 m0, s51, 57344
  v_mfma_f32_16x16x32_bf16 v[56:59], v[140:143], a[44:47], v[56:59]
  ds_read_b64_tr_b16 v[136:137], v121 offset:26624
  s_add_u32 s50, s98, 917504
  v_mfma_f32_16x16x32_bf16 v[12:15], v[144:147], a[40:43], v[12:15]
  ds_read_b64_tr_b16 v[138:139], v121 offset:27136
  ds_read_b64_tr_b16 v[140:141], v122 offset:26624
  v_mfma_f32_16x16x32_bf16 v[60:63], v[144:147], a[44:47], v[60:63]
  ds_read_b64_tr_b16 v[142:143], v122 offset:27136
  s_bitset0_b32 s50, 21
  v_mfma_f32_16x16x32_bf16 v[16:19], v[148:151], a[40:43], v[16:19]
  buffer_load_dwordx4 v248, s[52:55], s50 offen lds
  v_mfma_f32_16x16x32_bf16 v[64:67], v[148:151], a[44:47], v[64:67]
  buffer_load_dwordx4 v249, s[52:55], s50 offen offset:1024 lds
  v_mfma_f32_16x16x32_bf16 v[20:23], v[152:155], a[40:43], v[20:23]
  ds_read_b64_tr_b16 v[144:145], v123 offset:26624
  ds_read_b64_tr_b16 v[146:147], v123 offset:27136
  v_mfma_f32_16x16x32_bf16 v[68:71], v[152:155], a[44:47], v[68:71]
  ds_read_b64_tr_b16 v[148:149], v120 offset:27648
  s_mov_b32 s56, s26
  s_waitcnt lgkmcnt(10)
  v_mfma_f32_16x16x32_bf16 v[24:27], v[156:159], a[40:43], v[24:27]
  ds_read_b64_tr_b16 v[150:151], v120 offset:28160
  s_mov_b32 s57, s27
  v_mfma_f32_16x16x32_bf16 v[72:75], v[156:159], a[44:47], v[72:75]
  ds_read_b64_tr_b16 v[152:153], v121 offset:27648
  s_mov_b32 s58, 0x400000
  v_mfma_f32_16x16x32_bf16 v[28:31], v[160:163], a[40:43], v[28:31]
  ds_read_b64_tr_b16 v[154:155], v121 offset:28160
  ds_read_b64_tr_b16 v[156:157], v122 offset:27648
  v_mfma_f32_16x16x32_bf16 v[76:79], v[160:163], a[44:47], v[76:79]
  ds_read_b64_tr_b16 v[158:159], v122 offset:28160
  s_mov_b32 s59, 0x20000
  v_mfma_f32_16x16x32_bf16 v[32:35], a[40:43], v[164:167], v[32:35]
  ds_read_b64_tr_b16 v[160:161], v123 offset:27648
  s_mov_b32 s33, 0x8000
  v_mfma_f32_16x16x32_bf16 v[80:83], a[44:47], v[164:167], v[80:83]
  buffer_load_dwordx4 a[240:243], v128, s[56:59], 0 offen offset:0
  v_mfma_f32_16x16x32_bf16 v[36:39], a[40:43], v[168:171], v[36:39]
  ds_read_b64_tr_b16 v[162:163], v123 offset:28160
  ds_read_b64_tr_b16 v[164:165], v120 offset:28672
  v_mfma_f32_16x16x32_bf16 v[84:87], a[44:47], v[168:171], v[84:87]
  buffer_load_dwordx4 a[244:247], v128, s[56:59], 0 offen offset:64
  v_mfma_f32_16x16x32_bf16 v[40:43], a[40:43], v[172:175], v[40:43]
  ds_read_b64_tr_b16 v[166:167], v120 offset:29184
  buffer_load_dwordx4 a[248:251], v128, s[56:59], s33 offen offset:0
  v_mfma_f32_16x16x32_bf16 v[88:91], a[44:47], v[172:175], v[88:91]
  buffer_load_dwordx4 a[252:255], v128, s[56:59], s33 offen offset:64
  v_mfma_f32_16x16x32_bf16 v[44:47], a[40:43], v[176:179], v[44:47]
  ds_read_b64_tr_b16 v[168:169], v121 offset:28672
  ds_read_b64_tr_b16 v[170:171], v121 offset:29184
  v_mfma_f32_16x16x32_bf16 v[92:95], a[44:47], v[176:179], v[92:95]
  s_waitcnt vmcnt(21) lgkmcnt(10)
  s_barrier
  v_mfma_f32_16x16x32_bf16 v[96:99], v[180:183], v[188:191], v[96:99]
  ds_read_b64_tr_b16 v[172:173], v122 offset:28672
  ds_read_b64_tr_b16 v[174:175], v122 offset:29184
  s_add_u32 m0, s51, 65536
  v_mfma_f32_16x16x32_bf16 v[100:103], v[188:191], v[184:187], v[100:103]
  ds_read_b64_tr_b16 v[176:177], v123 offset:28672
  ds_read_b64_tr_b16 v[178:179], v123 offset:29184
  v_mfma_f32_16x16x32_bf16 v[0:3], v[132:135], a[48:51], v[0:3]
  ds_read_b64_tr_b16 v[180:181], v124 offset:40960
  ds_read_b64_tr_b16 v[182:183], v124 offset:41472
  v_mfma_f32_16x16x32_bf16 v[48:51], v[132:135], a[52:55], v[48:51]
  ds_read_b128 v[188:191], v125 offset:52224
  ds_read_b64_tr_b16 v[184:185], v124 offset:41984
  v_mfma_f32_16x16x32_bf16 v[4:7], v[136:139], a[48:51], v[4:7]
  ds_read_b64_tr_b16 v[186:187], v124 offset:42496
  ds_read_b64_tr_b16 v[132:133], v120 offset:39936
  v_mfma_f32_16x16x32_bf16 v[52:55], v[136:139], a[52:55], v[52:55]
  ds_read_b64_tr_b16 v[134:135], v120 offset:40448
  s_add_u32 s50, s98, 1048576
  v_mfma_f32_16x16x32_bf16 v[8:11], v[140:143], a[48:51], v[8:11]
  ds_read_b64_tr_b16 v[136:137], v121 offset:39936
  ds_read_b64_tr_b16 v[138:139], v121 offset:40448
  v_mfma_f32_16x16x32_bf16 v[56:59], v[140:143], a[52:55], v[56:59]
  ds_read_b64_tr_b16 v[140:141], v122 offset:39936
  ds_read_b64_tr_b16 v[142:143], v122 offset:40448
  v_mfma_f32_16x16x32_bf16 v[12:15], v[144:147], a[48:51], v[12:15]
  v_mfma_f32_16x16x32_bf16 v[60:63], v[144:147], a[52:55], v[60:63]
  ds_read_b64_tr_b16 v[144:145], v123 offset:39936
  ds_read_b64_tr_b16 v[146:147], v123 offset:40448
  v_mfma_f32_16x16x32_bf16 v[16:19], v[148:151], a[48:51], v[16:19]
  s_bitset0_b32 s50, 21
  v_mfma_f32_16x16x32_bf16 v[64:67], v[148:151], a[52:55], v[64:67]
  ds_read_b64_tr_b16 v[148:149], v120 offset:40960
  ds_read_b64_tr_b16 v[150:151], v120 offset:41472
  s_waitcnt lgkmcnt(10)
  v_mfma_f32_16x16x32_bf16 v[20:23], v[152:155], a[48:51], v[20:23]
  v_mfma_f32_16x16x32_bf16 v[68:71], v[152:155], a[52:55], v[68:71]
  ds_read_b64_tr_b16 v[152:153], v121 offset:40960
  ds_read_b64_tr_b16 v[154:155], v121 offset:41472
  v_mfma_f32_16x16x32_bf16 v[24:27], v[156:159], a[48:51], v[24:27]
  v_mfma_f32_16x16x32_bf16 v[72:75], v[156:159], a[52:55], v[72:75]
  buffer_load_dwordx4 v248, s[52:55], s50 offen lds
  v_mfma_f32_16x16x32_bf16 v[28:31], v[160:163], a[48:51], v[28:31]
  ds_read_b64_tr_b16 v[156:157], v122 offset:40960
  ds_read_b64_tr_b16 v[158:159], v122 offset:41472
  v_mfma_f32_16x16x32_bf16 v[76:79], v[160:163], a[52:55], v[76:79]
  ds_read_b64_tr_b16 v[160:161], v123 offset:40960
  ds_read_b64_tr_b16 v[162:163], v123 offset:41472
  v_mfma_f32_16x16x32_bf16 v[32:35], a[48:51], v[164:167], v[32:35]
  v_mfma_f32_16x16x32_bf16 v[80:83], a[52:55], v[164:167], v[80:83]
  ds_read_b64_tr_b16 v[164:165], v120 offset:41984
  ds_read_b64_tr_b16 v[166:167], v120 offset:42496
  v_mfma_f32_16x16x32_bf16 v[36:39], a[48:51], v[168:171], v[36:39]
  buffer_load_dwordx4 v249, s[52:55], s50 offen offset:1024 lds
  v_mfma_f32_16x16x32_bf16 v[84:87], a[52:55], v[168:171], v[84:87]
  ds_read_b64_tr_b16 v[168:169], v121 offset:41984
  ds_read_b64_tr_b16 v[170:171], v121 offset:42496
  v_mfma_f32_16x16x32_bf16 v[40:43], a[48:51], v[172:175], v[40:43]
  v_mfma_f32_16x16x32_bf16 v[88:91], a[52:55], v[172:175], v[88:91]
  ds_read_b64_tr_b16 v[172:173], v122 offset:41984
  ds_read_b64_tr_b16 v[174:175], v122 offset:42496
  v_mfma_f32_16x16x32_bf16 v[44:47], a[48:51], v[176:179], v[44:47]
  v_mfma_f32_16x16x32_bf16 v[92:95], a[52:55], v[176:179], v[92:95]
  s_waitcnt vmcnt(23) lgkmcnt(10)
  s_barrier
  v_mfma_f32_16x16x32_bf16 v[96:99], v[180:183], v[188:191], v[96:99]
  ds_read_b64_tr_b16 v[176:177], v123 offset:41984
  s_add_u32 m0, s51, 73728
  v_mfma_f32_16x16x32_bf16 v[100:103], v[188:191], v[184:187], v[100:103]
  ds_read_b64_tr_b16 v[178:179], v123 offset:42496
  s_add_u32 s50, s98, 1179648
  v_mfma_f32_16x16x32_bf16 v[0:3], v[132:135], a[56:59], v[0:3]
  v_mfma_f32_16x16x32_bf16 v[48:51], v[132:135], a[60:63], v[48:51]
  s_bitset0_b32 s50, 21
  v_mfma_f32_16x16x32_bf16 v[4:7], v[136:139], a[56:59], v[4:7]
  v_mfma_f32_16x16x32_bf16 v[52:55], v[136:139], a[60:63], v[52:55]
  buffer_load_dwordx4 v248, s[52:55], s50 offen lds
  v_mfma_f32_16x16x32_bf16 v[8:11], v[140:143], a[56:59], v[8:11]
  buffer_load_dwordx4 v249, s[52:55], s50 offen offset:1024 lds
  v_mfma_f32_16x16x32_bf16 v[56:59], v[140:143], a[60:63], v[56:59]
  v_mfma_f32_16x16x32_bf16 v[12:15], v[144:147], a[56:59], v[12:15]
  s_add_u32 m0, s51, 81920
  v_mfma_f32_16x16x32_bf16 v[60:63], v[144:147], a[60:63], v[60:63]
  v_mfma_f32_16x16x32_bf16 v[16:19], v[148:151], a[56:59], v[16:19]
  s_add_u32 s50, s98, 1310720
  v_mfma_f32_16x16x32_bf16 v[64:67], v[148:151], a[60:63], v[64:67]
  s_bitset0_b32 s50, 21
  v_mfma_f32_16x16x32_bf16 v[20:23], v[152:155], a[56:59], v[20:23]
  v_mfma_f32_16x16x32_bf16 v[68:71], v[152:155], a[60:63], v[68:71]
  buffer_load_dwordx4 v248, s[52:55], s50 offen lds
  s_waitcnt lgkmcnt(10)
  v_mfma_f32_16x16x32_bf16 v[24:27], v[156:159], a[56:59], v[24:27]
  v_mfma_f32_16x16x32_bf16 v[72:75], v[156:159], a[60:63], v[72:75]
  buffer_load_dwordx4 v249, s[52:55], s50 offen offset:1024 lds
  s_waitcnt lgkmcnt(8)
  v_mfma_f32_16x16x32_bf16 v[28:31], v[160:163], a[56:59], v[28:31]
  s_lshl_b32 s34, s37, 8
  v_mfma_f32_16x16x32_bf16 v[76:79], v[160:163], a[60:63], v[76:79]
  s_waitcnt lgkmcnt(6)
  v_mfma_f32_16x16x32_bf16 v[32:35], a[56:59], v[164:167], v[32:35]
  s_lshl_b32 s33, s3, 12
  v_mfma_f32_16x16x32_bf16 v[80:83], a[60:63], v[164:167], v[80:83]
  s_waitcnt lgkmcnt(4)
  v_mfma_f32_16x16x32_bf16 v[36:39], a[56:59], v[168:171], v[36:39]
  s_add_u32 s34, s34, s33
  v_mfma_f32_16x16x32_bf16 v[84:87], a[60:63], v[168:171], v[84:87]
  s_add_u32 s68, s34, 8192
  s_waitcnt lgkmcnt(2)
  v_mfma_f32_16x16x32_bf16 v[40:43], a[56:59], v[172:175], v[40:43]
  v_mfma_f32_16x16x32_bf16 v[88:91], a[60:63], v[172:175], v[88:91]
  buffer_load_dwordx4 v[250:253], v254, s[12:15], s68 offen sc1
  s_waitcnt lgkmcnt(0)
  v_mfma_f32_16x16x32_bf16 v[44:47], a[56:59], v[176:179], v[44:47]
  v_mfma_f32_16x16x32_bf16 v[92:95], a[60:63], v[176:179], v[92:95]
  s_nop 7
  s_nop 1
L_att:
  s_add_u32 s4, s20, 0x600000
  s_addc_u32 s5, s21, 0
  s_mov_b32 s6, 0x400000
  s_mov_b32 s7, 0x20000
  s_lshl_b32 s33, s3, 12
  s_add_u32 s33, s33, 139264
  v_add_u32 v110, s33, v119
  s_lshr_b32 s33, s3, 1
  s_lshl_b32 s33, s33, 10
  s_and_b32 s34, s3, 1
  s_lshl_b32 s34, s34, 3
  s_add_u32 s33, s33, s34
  s_add_u32 s33, s33, 139264
  v_add_u32 v111, s33, v119
  v_cvt_pk_bf16_f32 v196, v96, v97
  v_cvt_pk_bf16_f32 v197, v98, v99
  v_cvt_pk_bf16_f32 v198, v100, v101
  v_cvt_pk_bf16_f32 v199, v102, v103
  v_cvt_pk_bf16_f32 v164, v64, v65
  v_cvt_pk_bf16_f32 v165, v66, v67
  v_cvt_pk_bf16_f32 v176, v80, v81
  v_cvt_pk_bf16_f32 v177, v82, v83
  v_cvt_pk_bf16_f32 v166, v68, v69
  v_cvt_pk_bf16_f32 v167, v70, v71
  v_cvt_pk_bf16_f32 v182, v84, v85
  v_cvt_pk_bf16_f32 v183, v86, v87
  v_cvt_pk_bf16_f32 v168, v72, v73
  v_cvt_pk_bf16_f32 v169, v74, v75
  v_cvt_pk_bf16_f32 v188, v88, v89
  v_cvt_pk_bf16_f32 v189, v90, v91
  v_cvt_pk_bf16_f32 v170, v76, v77
  v_cvt_pk_bf16_f32 v171, v78, v79
  v_cvt_pk_bf16_f32 v194, v92, v93
  v_cvt_pk_bf16_f32 v195, v94, v95
  ds_write_b64 v111, v[196:197]
  ds_write_b64 v111, v[198:199] offset:2048
  ds_write_b128 v110, v[164:167] offset:4096
  ds_write_b64 v110, v[176:177] offset:6144
  ds_write_b64 v110, v[182:183] offset:6152
  ds_write_b128 v110, v[168:171] offset:5120
  ds_write_b64 v110, v[188:189] offset:7168
  ds_write_b64 v110, v[194:195] offset:7176
  v_cvt_pk_bf16_f32 v132, v0, v1
  v_cvt_pk_bf16_f32 v133, v2, v3
  v_cvt_pk_bf16_f32 v140, v48, v49
  v_cvt_pk_bf16_f32 v141, v50, v51
  v_cvt_pk_bf16_f32 v156, v16, v17
  v_cvt_pk_bf16_f32 v157, v18, v19
  v_cvt_pk_bf16_f32 v174, v32, v33
  v_cvt_pk_bf16_f32 v175, v34, v35
  v_cvt_pk_bf16_f32 v134, v4, v5
  v_cvt_pk_bf16_f32 v135, v6, v7
  v_cvt_pk_bf16_f32 v142, v52, v53
  v_cvt_pk_bf16_f32 v143, v54, v55
  v_cvt_pk_bf16_f32 v158, v20, v21
  v_cvt_pk_bf16_f32 v159, v22, v23
  v_cvt_pk_bf16_f32 v180, v36, v37
  v_cvt_pk_bf16_f32 v181, v38, v39
  v_cvt_pk_bf16_f32 v136, v8, v9
  v_cvt_pk_bf16_f32 v137, v10, v11
  v_cvt_pk_bf16_f32 v144, v56, v57
  v_cvt_pk_bf16_f32 v145, v58, v59
  v_cvt_pk_bf16_f32 v160, v24, v25
  v_cvt_pk_bf16_f32 v161, v26, v27
  v_cvt_pk_bf16_f32 v186, v40, v41
  v_cvt_pk_bf16_f32 v187, v42, v43
  v_cvt_pk_bf16_f32 v138, v12, v13
  v_cvt_pk_bf16_f32 v139, v14, v15
  v_cvt_pk_bf16_f32 v146, v60, v61
  v_cvt_pk_bf16_f32 v147, v62, v63
  v_cvt_pk_bf16_f32 v162, v28, v29
  v_cvt_pk_bf16_f32 v163, v30, v31
  v_cvt_pk_bf16_f32 v192, v44, v45
  v_cvt_pk_bf16_f32 v193, v46, v47
  s_waitcnt lgkmcnt(0)
  s_barrier
  ds_read_b128 v[148:151], v110 offset:0
  ds_read_b64 v[172:173], v110 offset:2048
  ds_read_b64 v[178:179], v110 offset:2056
  ds_read_b128 v[152:155], v110 offset:1024
  ds_read_b64 v[184:185], v110 offset:3072
  ds_read_b64 v[190:191], v110 offset:3080
  s_add_u32 m0, s51, 90112
  s_add_u32 s50, s98, 1441792
  s_bitset0_b32 s50, 21
  buffer_load_dwordx4 v248, s[52:55], s50 offen lds
  buffer_load_dwordx4 v249, s[52:55], s50 offen offset:1024 lds
  s_add_u32 m0, s51, 98304
  s_add_u32 s50, s98, 1572864
  s_bitset0_b32 s50, 21
  buffer_load_dwordx4 v248, s[52:55], s50 offen lds
  buffer_load_dwordx4 v249, s[52:55], s50 offen offset:1024 lds
  v_mfma_f32_16x16x32_bf16 v[200:203], v[156:159], v[140:143], 0
  v_mfma_f32_16x16x32_bf16 v[204:207], v[164:167], v[140:143], 0
  v_mfma_f32_16x16x32_bf16 v[208:211], v[160:163], v[144:147], 0
  v_mfma_f32_16x16x32_bf16 v[212:215], v[168:171], v[144:147], 0
  s_or_b32 s33, s30, s3
  s_cmp_eq_u32 s33, 0
  s_cselect_b32 s33, 0xf149f2ca, 0
  v_mov_b32 v232, s33
  v_cndmask_b32_e64 v120, v232, 0, s[44:45]
  v_cndmask_b32_e64 v121, v232, 0, s[46:47]
  v_and_b32 v122, 1, v104
  v_lshlrev_b32 v122, 4, v122
  s_waitcnt lgkmcnt(0)
  v_mfma_f32_16x16x32_bf16 v[216:219], v[148:151], v[132:135], 0
  v_mfma_f32_16x16x32_bf16 v[220:223], v[156:159], v[132:135], 0
  v_mfma_f32_16x16x32_bf16 v[224:227], v[152:155], v[136:139], 0
  v_mfma_f32_16x16x32_bf16 v[228:231], v[160:163], v[136:139], 0
  s_mov_b32 s40, 0x3e8293ee
  v_cndmask_b32_e64 v200, v200, v201, s[48:49]
  v_cndmask_b32_e64 v202, v202, v203, s[48:49]
  v_cndmask_b32_e64 v204, v204, v205, s[48:49]
  v_cndmask_b32_e64 v206, v206, v207, s[48:49]
  v_cndmask_b32_e64 v208, v208, v209, s[48:49]
  v_cndmask_b32_e64 v210, v210, v211, s[48:49]
  v_cndmask_b32_e64 v212, v212, v213, s[48:49]
  v_cndmask_b32_e64 v214, v214, v215, s[48:49]
  v_cndmask_b32_e64 v216, v216, v217, s[48:49]
  v_cndmask_b32_e64 v218, v218, v219, s[48:49]
  v_cndmask_b32_e64 v220, v220, v221, s[48:49]
  v_cndmask_b32_e64 v222, v222, v223, s[48:49]
  v_cndmask_b32_e64 v224, v224, v225, s[48:49]
  v_cndmask_b32_e64 v226, v226, v227, s[48:49]
  v_cndmask_b32_e64 v228, v228, v229, s[48:49]
  v_cndmask_b32_e64 v230, v230, v231, s[48:49]
  v_cndmask_b32_e64 v200, v200, v204, s[44:45]
  v_cndmask_b32_e64 v201, v202, v206, s[46:47]
  v_cndmask_b32_e64 v208, v208, v212, s[44:45]
  v_cndmask_b32_e64 v209, v210, v214, s[46:47]
  v_cndmask_b32_e64 v216, v216, v220, s[44:45]
  v_cndmask_b32_e64 v217, v218, v222, s[46:47]
  v_cndmask_b32_e64 v224, v224, v228, s[44:45]
  v_cndmask_b32_e64 v225, v226, v230, s[46:47]
  v_mul_f32 v200, s40, v200
  v_mul_f32 v201, s40, v201
  v_mul_f32 v208, s40, v208
  v_mul_f32 v209, s40, v209
  v_fma_f32 v216, v216, s40, v120
  v_fma_f32 v217, v217, s40, v121
  v_fma_f32 v224, v224, s40, v120
  v_fma_f32 v225, v225, s40, v121
  v_max_f32 v232, v200, v201
  v_max_f32 v233, v208, v209
  v_max_f32 v234, v216, v217
  v_max_f32 v235, v224, v225
  v_mov_b32 v236, v232
  v_mov_b32 v237, v233
  v_mov_b32 v238, v234
  v_mov_b32 v239, v235
  s_nop 1
  v_permlane16_swap_b32 v236, v232
  v_permlane16_swap_b32 v237, v233
  v_permlane16_swap_b32 v238, v234
  v_permlane16_swap_b32 v239, v235
  s_nop 1
  v_max_f32 v232, v232, v236
  v_max_f32 v233, v233, v237
  v_max_f32 v234, v234, v238
  v_max_f32 v235, v235, v239
  v_mov_b32 v236, v232
  v_mov_b32 v237, v233
  v_mov_b32 v238, v234
  v_mov_b32 v239, v235
  s_nop 1
  v_permlane32_swap_b32 v236, v232
  v_permlane32_swap_b32 v237, v233
  v_permlane32_swap_b32 v238, v234
  v_permlane32_swap_b32 v239, v235
  s_nop 1
  v_max_f32 v232, v232, v236
  v_max_f32 v233, v233, v237
  v_max_f32 v234, v234, v238
  v_max_f32 v235, v235, v239
  v_sub_f32 v200, v200, v232
  v_sub_f32 v201, v201, v232
  v_sub_f32 v208, v208, v233
  v_sub_f32 v209, v209, v233
  v_sub_f32 v216, v216, v234
  v_sub_f32 v217, v217, v234
  v_sub_f32 v224, v224, v235
  v_sub_f32 v225, v225, v235
  v_exp_f32 v200, v200
  v_exp_f32 v201, v201
  v_exp_f32 v208, v208
  v_exp_f32 v209, v209
  v_exp_f32 v216, v216
  v_exp_f32 v217, v217
  v_exp_f32 v224, v224
  v_exp_f32 v225, v225
  s_nop 0
  v_add_f32 v232, v200, v201
  v_add_f32 v233, v208, v209
  v_add_f32 v234, v216, v217
  v_add_f32 v235, v224, v225
  v_mov_b32 v236, v232
  v_mov_b32 v237, v233
  v_mov_b32 v238, v234
  v_mov_b32 v239, v235
  s_nop 1
  v_permlane16_swap_b32 v236, v232
  v_permlane16_swap_b32 v237, v233
  v_permlane16_swap_b32 v238, v234
  v_permlane16_swap_b32 v239, v235
  s_nop 1
  v_add_f32 v232, v232, v236
  v_add_f32 v233, v233, v237
  v_add_f32 v234, v234, v238
  v_add_f32 v235, v235, v239
  v_mov_b32 v236, v232
  v_mov_b32 v237, v233
  v_mov_b32 v238, v234
  v_mov_b32 v239, v235
  s_nop 1
  v_permlane32_swap_b32 v236, v232
  v_permlane32_swap_b32 v237, v233
  v_permlane32_swap_b32 v238, v234
  v_permlane32_swap_b32 v239, v235
  s_nop 1
  v_add_f32 v232, v232, v236
  v_add_f32 v233, v233, v237
  v_add_f32 v234, v234, v238
  v_add_f32 v235, v235, v239
  v_rcp_f32 v232, v232
  v_rcp_f32 v233, v233
  v_rcp_f32 v234, v234
  v_rcp_f32 v235, v235
  s_nop 0
  v_mul_f32 v200, v200, v232
  v_mul_f32 v201, v201, v232
  v_mul_f32 v208, v208, v233
  v_mul_f32 v209, v209, v233
  v_mul_f32 v216, v216, v234
  v_mul_f32 v217, v217, v234
  v_mul_f32 v224, v224, v235
  v_mul_f32 v225, v225, v235
  v_cvt_pk_bf16_f32 v200, v200, 0
  v_cvt_pk_bf16_f32 v201, v201, 0
  v_cvt_pk_bf16_f32 v208, v208, 0
  v_cvt_pk_bf16_f32 v209, v209, 0
  v_cvt_pk_bf16_f32 v216, v216, 0
  v_cvt_pk_bf16_f32 v217, v217, 0
  v_cvt_pk_bf16_f32 v224, v224, 0
  v_cvt_pk_bf16_f32 v225, v225, 0
  v_lshlrev_b32 v200, v122, v200
  v_lshlrev_b32 v201, v122, v201
  v_lshlrev_b32 v208, v122, v208
  v_lshlrev_b32 v209, v122, v209
  v_lshlrev_b32 v216, v122, v216
  v_lshlrev_b32 v217, v122, v217
  v_lshlrev_b32 v224, v122, v224
  v_lshlrev_b32 v225, v122, v225
  v_cndmask_b32_e64 v132, v200, 0, s[44:45]
  v_cndmask_b32_e64 v134, 0, v200, s[44:45]
  v_cndmask_b32_e64 v133, v201, 0, s[46:47]
  v_cndmask_b32_e64 v135, 0, v201, s[46:47]
  v_cndmask_b32_e64 v136, v208, 0, s[44:45]
  v_cndmask_b32_e64 v138, 0, v208, s[44:45]
  v_cndmask_b32_e64 v137, v209, 0, s[46:47]
  v_cndmask_b32_e64 v139, 0, v209, s[46:47]
  v_cndmask_b32_e64 v140, v216, 0, s[44:45]
  v_cndmask_b32_e64 v142, 0, v216, s[44:45]
  v_cndmask_b32_e64 v141, v217, 0, s[46:47]
  v_cndmask_b32_e64 v143, 0, v217, s[46:47]
  v_cndmask_b32_e64 v144, v224, 0, s[44:45]
  v_cndmask_b32_e64 v146, 0, v224, s[44:45]
  v_cndmask_b32_e64 v145, v225, 0, s[46:47]
  v_cndmask_b32_e64 v147, 0, v225, s[46:47]
  s_nop 1
  v_mfma_f32_16x16x32_bf16 v[200:203], v[174:177], v[132:135], 0
  v_mfma_f32_16x16x32_bf16 v[204:207], v[180:183], v[132:135], 0
  v_mfma_f32_16x16x32_bf16 v[208:211], v[186:189], v[136:139], 0
  v_mfma_f32_16x16x32_bf16 v[212:215], v[192:195], v[136:139], 0
  v_mfma_f32_16x16x32_bf16 v[216:219], v[172:175], v[140:143], 0
  v_mfma_f32_16x16x32_bf16 v[220:223], v[178:181], v[140:143], 0
  v_mfma_f32_16x16x32_bf16 v[224:227], v[184:187], v[144:147], 0
  v_mfma_f32_16x16x32_bf16 v[228:231], v[190:193], v[144:147], 0
  s_lshl_b32 s41, s31, 18
  s_add_u32 s42, s41, 131072
  s_nop 1
  v_cvt_pk_bf16_f32 v148, v200, v201
  v_cvt_pk_bf16_f32 v149, v202, v203
  v_cvt_pk_bf16_f32 v150, v204, v205
  v_cvt_pk_bf16_f32 v151, v206, v207
  buffer_store_dwordx4 v[148:151], v105, s[4:7], s41 offen offset:1024 sc1
  v_cvt_pk_bf16_f32 v152, v208, v209
  v_cvt_pk_bf16_f32 v153, v210, v211
  v_cvt_pk_bf16_f32 v154, v212, v213
  v_cvt_pk_bf16_f32 v155, v214, v215
  buffer_store_dwordx4 v[152:155], v105, s[4:7], s42 offen offset:1024 sc1
  v_cvt_pk_bf16_f32 v156, v216, v217
  v_cvt_pk_bf16_f32 v157, v218, v219
  v_cvt_pk_bf16_f32 v158, v220, v221
  v_cvt_pk_bf16_f32 v159, v222, v223
  buffer_store_dwordx4 v[156:159], v105, s[4:7], s41 offen offset:0 sc1
  s_nop 0
  v_cvt_pk_bf16_f32 v160, v224, v225
  v_cvt_pk_bf16_f32 v161, v226, v227
  v_cvt_pk_bf16_f32 v162, v228, v229
  v_cvt_pk_bf16_f32 v163, v230, v231
  buffer_store_dwordx4 v[160:163], v105, s[4:7], s42 offen offset:0 sc1
  s_lshl_b32 s69, s30, 2
  s_add_u32 s69, s69, s3
  s_lshl_b32 s69, s69, 4
  s_add_u32 s69, s69, s31
  s_add_u32 s69, s69, 1024
  s_lshl_b32 s69, s69, 6
  s_mov_b32 s30, s36
  s_mov_b32 s31, s37
  v_mov_b32 v32, v104
  v_mov_b32 v231, v104
  v_mov_b32 v43, v128
  v_and_b32 v44, 15, v32
  s_lshl_b32 s32, s30, 13
  s_lshl_b32 s33, s3, 11
  s_add_u32 s32, s32, s33
  v_lshlrev_b32 v80, 4, v32
  v_add_u32 v33, s32, v80
  v_add_u32 v34, 131072, v33
  s_lshl_b32 s16, s98, 1
  s_lshl_b32 s32, s30, 2
  s_add_u32 s32, s32, s3
  s_lshl_b32 s32, s32, 4
  s_add_u32 s32, s32, 1024
  v_add_u32 v45, s32, v44
  v_lshlrev_b32 v45, 6, v45
  v_mov_b32 v158, s19
  v_mov_b32 v159, s19
  v_lshlrev_b32 v46, 2, v32
  s_bfe_u32 s48, s19, 0x80000
  s_bfe_u32 s49, s19, 0x80008
  s_bfe_u32 s50, s19, 0x80010
  s_bfe_u32 s51, s19, 0x80018
  s_mov_b32 s92, s30
  s_mov_b32 s93, s31
  s_and_b32 s28, s2, 7
  s_lshr_b32 s29, s2, 3
  s_and_b32 s30, s28, 1
  s_lshl_b32 s30, s30, 2
  s_and_b32 s31, s29, 3
  s_add_u32 s30, s30, s31
  s_lshr_b32 s31, s28, 1
  s_lshl_b32 s31, s31, 3
  s_lshr_b32 s29, s29, 2
  s_add_u32 s31, s31, s29
  s_lshl_b32 s32, s30, 14
  s_lshl_b32 s33, s3, 12
  s_add_u32 s32, s32, s33
  v_lshlrev_b32 v224, 4, v231
  v_add_u32 v224, s32, v224
  s_and_b32 s33, s3, 1
  s_mul_i32 s34, s33, 114688
  s_mul_i32 s35, s31, 224
  s_add_u32 s34, s34, s35
  s_movk_i32 s36, 4682
  s_movk_i32 s37, 7168
  s_and_b32 s39, s31, 1
  s_lshl_b32 s39, s39, 1
  v_add_u32 v234, 0, v231
  v_mul_u32_u24 v235, s36, v234
  v_lshrrev_b32 v235, 16, v235
  v_mul_u32_u24 v236, 14, v235
  v_sub_u32 v236, v234, v236
  v_add_u32 v236, s39, v236
  v_subrev_u32 v237, 14, v236
  v_min_u32 v236, v236, v237
  v_mul_u32_u24 v235, s37, v235
  v_lshl_add_u32 v235, v236, 4, v235
  v_add_u32 v235, s34, v235
  v_subrev_u32 v225, 0, v235
  v_add_u32 v234, 64, v231
  v_mul_u32_u24 v235, s36, v234
  v_lshrrev_b32 v235, 16, v235
  v_mul_u32_u24 v236, 14, v235
  v_sub_u32 v236, v234, v236
  v_add_u32 v236, s39, v236
  v_subrev_u32 v237, 14, v236
  v_min_u32 v236, v236, v237
  v_mul_u32_u24 v235, s37, v235
  v_lshl_add_u32 v235, v236, 4, v235
  v_add_u32 v235, s34, v235
  v_subrev_u32 v226, 1024, v235
  v_add_u32 v234, 128, v231
  v_mul_u32_u24 v235, s36, v234
  v_lshrrev_b32 v235, 16, v235
  v_mul_u32_u24 v236, 14, v235
  v_sub_u32 v236, v234, v236
  v_add_u32 v236, s39, v236
  v_subrev_u32 v237, 14, v236
  v_min_u32 v236, v236, v237
  v_mul_u32_u24 v235, s37, v235
  v_lshl_add_u32 v235, v236, 4, v235
  v_add_u32 v235, s34, v235
  v_subrev_u32 v227, 2048, v235
  v_add_u32 v234, 192, v231
  v_mul_u32_u24 v235, s36, v234
  v_lshrrev_b32 v235, 16, v235
  v_mul_u32_u24 v236, 14, v235
  v_sub_u32 v236, v234, v236
  v_add_u32 v236, s39, v236
  v_subrev_u32 v237, 14, v236
  v_min_u32 v236, v236, v237
  v_mul_u32_u24 v235, s37, v235
  v_lshl_add_u32 v235, v236, 4, v235
  v_add_u32 v235, s34, v235
  v_subrev_u32 v228, 3072, v235
  s_mov_b32 s94, s30
  s_mov_b32 s95, s31
  s_mov_b32 s30, s92
  s_mov_b32 s31, s93
  s_mul_i32 s38, s3, 3584
  s_mov_b32 s17, 0
  s_cmp_lt_u32 s3, 2
  s_cselect_b32 s8, s60, s62
  s_cselect_b32 s9, s61, s63
  s_mov_b32 s10, 7340032
  s_mov_b32 s11, 0x20000
  s_waitcnt vmcnt(0)
  s_mov_b64 exec, 1
  buffer_store_dword v158, v46, s[64:67], s69 offen sc1
  s_mov_b64 exec, -1
  v_xor_b32 v168, s48, v250
  v_xor_b32 v169, s49, v251
  v_xor_b32 v170, s50, v252
  v_xor_b32 v171, s51, v253
  v_or3_b32 v172, v168, v169, v170
  v_or_b32 v172, v172, v171
  v_and_b32 v172, 0xff, v172
  v_cmp_ne_u32 vcc, 0, v172
  s_nop 1
  s_cmp_lg_u64 vcc, 0
  s_cbranch_scc1 L_vslow_11
L_vback_12:
  v_mov_b32 v172, v168
  v_mov_b32 v173, v169
  v_mov_b32 v174, v170
  v_mov_b32 v175, v171
  s_nop 1
  v_permlane16_swap_b32 v172, v168
  v_permlane16_swap_b32 v173, v169
  v_permlane16_swap_b32 v174, v170
  v_permlane16_swap_b32 v175, v171
  s_nop 1
  v_add_f32 v168, v168, v172
  v_add_f32 v169, v169, v173
  v_add_f32 v170, v170, v174
  v_add_f32 v171, v171, v175
  v_mov_b32 v172, v168
  v_mov_b32 v173, v169
  v_mov_b32 v174, v170
  v_mov_b32 v175, v171
  s_nop 1
  v_permlane32_swap_b32 v172, v168
  v_permlane32_swap_b32 v173, v169
  v_permlane32_swap_b32 v174, v170
  v_permlane32_swap_b32 v175, v171
  s_nop 1
  v_add_f32 v168, v168, v172
  v_add_f32 v169, v169, v173
  v_add_f32 v170, v170, v174
  v_add_f32 v171, v171, v175
  v_cvt_pk_bf16_f32 v172, v168, v169
  v_lshlrev_b32 v168, 16, v172
  v_and_b32 v169, 0xffff0000, v172
  v_cvt_pk_bf16_f32 v173, v170, v171
  v_lshlrev_b32 v170, 16, v173
  v_and_b32 v171, 0xffff0000, v173
  s_cmp_eq_u32 s3, 2
  s_cselect_b32 s33, 1.0, 0
  v_add_f32 v168, s33, v168
  v_add_f32 v169, s33, v169
  v_add_f32 v170, s33, v170
  v_add_f32 v171, s33, v171
  v_cvt_pk_bf16_f32 v172, v168, v169
  v_lshlrev_b32 v168, 16, v172
  v_and_b32 v169, 0xffff0000, v172
  v_cvt_pk_bf16_f32 v173, v170, v171
  v_lshlrev_b32 v170, 16, v173
  v_and_b32 v171, 0xffff0000, v173
  v_lshlrev_b32 v172, 4, v44
  s_lshl_b32 s33, s3, 8
  s_add_u32 s33, s33, 162816
  v_add_u32 v172, s33, v172
  ds_write_b128 v172, v[168:171]
  v_lshrrev_b32 v82, 2, v32
  v_lshlrev_b32 v82, 7, v82
  v_bfe_u32 v81, v32, 3, 2
  v_lshl_add_u32 v82, v81, 5, v82
  v_and_b32 v81, 3, v32
  v_lshl_add_u32 v35, v81, 3, v82
  v_xor_b32 v36, 32, v35
  v_xor_b32 v37, 64, v35
  v_xor_b32 v38, 96, v35
  v_add_u32 v39, 65536, v35
  v_add_u32 v40, 65536, v36
  v_add_u32 v41, 65536, v37
  v_add_u32 v42, 65536, v38
  v_lshrrev_b32 v47, 4, v32
  v_lshlrev_b32 v46, 4, v47
  v_add_u32 v253, 162816, v46
  s_waitcnt lgkmcnt(0)
  s_waitcnt vmcnt(63)
  s_barrier
  ds_read_b64_tr_b16 v[88:89], v35 offset:0
  ds_read_b64_tr_b16 v[90:91], v35 offset:2048
  ds_read_b64_tr_b16 v[92:93], v36 offset:0
  ds_read_b64_tr_b16 v[94:95], v36 offset:2048
  ds_read_b64_tr_b16 v[96:97], v37 offset:0
  ds_read_b64_tr_b16 v[98:99], v37 offset:2048
  ds_read_b64_tr_b16 v[100:101], v38 offset:0
  ds_read_b64_tr_b16 v[102:103], v38 offset:2048
  ds_read_b64_tr_b16 v[104:105], v35 offset:4096
  ds_read_b64_tr_b16 v[106:107], v35 offset:6144
  ds_read_b64_tr_b16 v[108:109], v36 offset:4096
  ds_read_b64_tr_b16 v[110:111], v36 offset:6144
  ds_read_b64_tr_b16 v[112:113], v37 offset:4096
  ds_read_b64_tr_b16 v[114:115], v37 offset:6144
  ds_read_b64_tr_b16 v[116:117], v38 offset:4096
  ds_read_b64_tr_b16 v[118:119], v38 offset:6144
  ds_read_b128 v[64:67], v253 offset:0
  ds_read_b128 v[68:71], v253 offset:64
  ds_read_b128 v[72:75], v253 offset:128
  ds_read_b128 v[76:79], v253 offset:192
  ds_read_b128 v[168:171], v253 offset:256
  ds_read_b128 v[172:175], v253 offset:320
  ds_read_b128 v[176:179], v253 offset:384
  ds_read_b128 v[180:183], v253 offset:448
  ds_read_b128 v[184:187], v253 offset:512
  ds_read_b128 v[188:191], v253 offset:576
  ds_read_b128 v[192:195], v253 offset:640
  ds_read_b128 v[196:199], v253 offset:704
  buffer_load_dword v87, v45, s[64:67], 0 offen sc1
  v_mov_b32 v252, v43
  v_accvgpr_read_b32 v48, a240
  v_accvgpr_read_b32 v49, a241
  v_accvgpr_read_b32 v50, a242
  v_accvgpr_read_b32 v51, a243
  v_accvgpr_read_b32 v52, a244
  v_accvgpr_read_b32 v53, a245
  v_accvgpr_read_b32 v54, a246
  v_accvgpr_read_b32 v55, a247
  v_accvgpr_read_b32 v56, a248
  v_accvgpr_read_b32 v57, a249
  v_accvgpr_read_b32 v58, a250
  v_accvgpr_read_b32 v59, a251
  v_accvgpr_read_b32 v60, a252
  v_accvgpr_read_b32 v61, a253
  v_accvgpr_read_b32 v62, a254
  v_accvgpr_read_b32 v63, a255
  s_lshl_b32 s41, s31, 18
  s_add_u32 s42, s41, 131072
  v_permlane16_swap_b32 v48, v50
  v_permlane16_swap_b32 v49, v51
  v_permlane16_swap_b32 v52, v54
  v_permlane16_swap_b32 v53, v55
  v_permlane16_swap_b32 v56, v58
  v_permlane16_swap_b32 v57, v59
  v_permlane16_swap_b32 v60, v62
  v_permlane16_swap_b32 v61, v63
  v_lshlrev_b32 v120, 16, v48
  v_and_b32 v121, 0xffff0000, v48
  v_lshlrev_b32 v122, 16, v49
  v_and_b32 v123, 0xffff0000, v49
  v_lshlrev_b32 v124, 16, v50
  v_and_b32 v125, 0xffff0000, v50
  v_lshlrev_b32 v126, 16, v51
  v_and_b32 v127, 0xffff0000, v51
  v_lshlrev_b32 v128, 16, v52
  v_and_b32 v129, 0xffff0000, v52
  v_lshlrev_b32 v130, 16, v53
  v_and_b32 v131, 0xffff0000, v53
  v_lshlrev_b32 v132, 16, v54
  v_and_b32 v133, 0xffff0000, v54
  v_lshlrev_b32 v134, 16, v55
  v_and_b32 v135, 0xffff0000, v55
  v_lshlrev_b32 v136, 16, v56
  v_and_b32 v137, 0xffff0000, v56
  v_lshlrev_b32 v138, 16, v57
  v_and_b32 v139, 0xffff0000, v57
  v_lshlrev_b32 v140, 16, v58
  v_and_b32 v141, 0xffff0000, v58
  v_lshlrev_b32 v142, 16, v59
  v_and_b32 v143, 0xffff0000, v59
  v_lshlrev_b32 v144, 16, v60
  v_and_b32 v145, 0xffff0000, v60
  v_lshlrev_b32 v146, 16, v61
  v_and_b32 v147, 0xffff0000, v61
  v_lshlrev_b32 v148, 16, v62
  v_and_b32 v149, 0xffff0000, v62
  v_lshlrev_b32 v150, 16, v63
  v_and_b32 v151, 0xffff0000, v63
  s_add_u32 s52, s20, 0x180000
  s_addc_u32 s53, s21, 0
  s_mov_b32 s54, 0x80000
  s_mov_b32 s55, 0x20000
  s_lshl2_add_u32 s56, s30, s3
  s_lshl_b32 s56, s56, 12
  s_lshl_b32 s57, s31, 8
  s_add_u32 s57, s57, s56
  v_mov_b32 v81, 0xffffff00
  s_bfe_u32 s44, s19, 0x80000
  s_bfe_u32 s45, s19, 0x80008
  s_bfe_u32 s46, s19, 0x80010
  s_bfe_u32 s47, s19, 0x80018
  s_mov_b32 s33, 262144
L_spin_15:
  s_waitcnt vmcnt(0)
  v_cmp_ne_u32 vcc, s19, v87
  s_nop 1
  s_and_b32 s32, vcc_lo, 0xffff
  s_cbranch_scc0 L_rdy_16
  buffer_load_dword v87, v45, s[64:67], 0 offen sc1
  s_sub_u32 s33, s33, 1
  s_cmp_lg_u32 s33, 0
  s_cbranch_scc1 L_spin_15
L_rdy_16:
  buffer_load_dwordx4 a[0:3], v33, s[4:7], s16 offen offset:0 sc1
  buffer_load_dwordx4 a[4:7], v33, s[4:7], s16 offen offset:1024 sc1
  buffer_load_dwordx4 a[8:11], v34, s[4:7], s16 offen offset:0 sc1
  buffer_load_dwordx4 a[12:15], v34, s[4:7], s16 offen offset:1024 sc1
  s_add_u32 s16, s16, 262144
  s_bitset0_b32 s16, 22
  buffer_load_dwordx4 a[16:19], v33, s[4:7], s16 offen offset:0 sc1
  buffer_load_dwordx4 a[20:23], v33, s[4:7], s16 offen offset:1024 sc1
  buffer_load_dwordx4 a[24:27], v34, s[4:7], s16 offen offset:0 sc1
  buffer_load_dwordx4 a[28:31], v34, s[4:7], s16 offen offset:1024 sc1
  s_add_u32 s16, s16, 262144
  s_bitset0_b32 s16, 22
  buffer_load_dwordx4 a[32:35], v33, s[4:7], s16 offen offset:0 sc1
  buffer_load_dwordx4 a[36:39], v33, s[4:7], s16 offen offset:1024 sc1
  buffer_load_dwordx4 a[40:43], v34, s[4:7], s16 offen offset:0 sc1
  buffer_load_dwordx4 a[44:47], v34, s[4:7], s16 offen offset:1024 sc1
  s_add_u32 s16, s16, 262144
  s_bitset0_b32 s16, 22
  buffer_load_dwordx4 a[48:51], v33, s[4:7], s16 offen offset:0 sc1
  buffer_load_dwordx4 a[52:55], v33, s[4:7], s16 offen offset:1024 sc1
  buffer_load_dwordx4 a[56:59], v34, s[4:7], s16 offen offset:0 sc1
  buffer_load_dwordx4 a[60:63], v34, s[4:7], s16 offen offset:1024 sc1
  s_add_u32 s16, s16, 262144
  s_bitset0_b32 s16, 22
  s_waitcnt vmcnt(12) lgkmcnt(10)
  v_mfma_f32_16x16x32_bf16 v[0:3], v[88:91], a[0:3], 0
  buffer_load_dwordx4 a[64:67], v33, s[4:7], s16 offen offset:0 sc1
  v_mfma_f32_16x16x32_bf16 v[16:19], v[88:91], a[4:7], 0
  ds_read_b64_tr_b16 v[88:89], v35 offset:8192
  ds_read_b64_tr_b16 v[90:91], v35 offset:10240
  v_mfma_f32_16x16x32_bf16 v[4:7], v[92:95], a[0:3], 0
  buffer_load_dwordx4 a[68:71], v33, s[4:7], s16 offen offset:1024 sc1
  v_mfma_f32_16x16x32_bf16 v[20:23], v[92:95], a[4:7], 0
  ds_read_b64_tr_b16 v[92:93], v36 offset:8192
  ds_read_b64_tr_b16 v[94:95], v36 offset:10240
  v_mfma_f32_16x16x32_bf16 v[8:11], v[96:99], a[0:3], 0
  v_mfma_f32_16x16x32_bf16 v[24:27], v[96:99], a[4:7], 0
  buffer_load_dwordx4 a[72:75], v34, s[4:7], s16 offen offset:0 sc1
  v_mfma_f32_16x16x32_bf16 v[12:15], v[100:103], a[0:3], 0
  ds_read_b64_tr_b16 v[96:97], v37 offset:8192
  ds_read_b64_tr_b16 v[98:99], v37 offset:10240
  v_mfma_f32_16x16x32_bf16 v[28:31], v[100:103], a[4:7], 0
  buffer_load_dwordx4 a[76:79], v34, s[4:7], s16 offen offset:1024 sc1
  v_mfma_f32_16x16x32_bf16 v[0:3], v[104:107], a[8:11], v[0:3]
  ds_read_b64_tr_b16 v[100:101], v38 offset:8192
  ds_read_b64_tr_b16 v[102:103], v38 offset:10240
  v_mfma_f32_16x16x32_bf16 v[16:19], v[104:107], a[12:15], v[16:19]
  ds_read_b64_tr_b16 v[104:105], v35 offset:12288
  ds_read_b64_tr_b16 v[106:107], v35 offset:14336
  v_mfma_f32_16x16x32_bf16 v[4:7], v[108:111], a[8:11], v[4:7]
  s_add_u32 s16, s16, 262144
  v_mfma_f32_16x16x32_bf16 v[20:23], v[108:111], a[12:15], v[20:23]
  ds_read_b64_tr_b16 v[108:109], v36 offset:12288
  ds_read_b64_tr_b16 v[110:111], v36 offset:14336
  v_mfma_f32_16x16x32_bf16 v[8:11], v[112:115], a[8:11], v[8:11]
  s_bitset0_b32 s16, 22
  v_mfma_f32_16x16x32_bf16 v[24:27], v[112:115], a[12:15], v[24:27]
  ds_read_b64_tr_b16 v[112:113], v37 offset:12288
  ds_read_b64_tr_b16 v[114:115], v37 offset:14336
  v_mfma_f32_16x16x32_bf16 v[12:15], v[116:119], a[8:11], v[12:15]
  v_mfma_f32_16x16x32_bf16 v[28:31], v[116:119], a[12:15], v[28:31]
  s_waitcnt vmcnt(12) lgkmcnt(10)
  ds_read_b64_tr_b16 v[116:117], v38 offset:12288
  v_mfma_f32_16x16x32_bf16 v[0:3], v[88:91], a[16:19], v[0:3]
  buffer_load_dwordx4 a[80:83], v33, s[4:7], s16 offen offset:0 sc1
  v_mfma_f32_16x16x32_bf16 v[16:19], v[88:91], a[20:23], v[16:19]
  ds_read_b64_tr_b16 v[118:119], v38 offset:14336
  ds_read_b64_tr_b16 v[88:89], v35 offset:16384
  v_mfma_f32_16x16x32_bf16 v[4:7], v[92:95], a[16:19], v[4:7]
  buffer_load_dwordx4 a[84:87], v33, s[4:7], s16 offen offset:1024 sc1
  v_mfma_f32_16x16x32_bf16 v[20:23], v[92:95], a[20:23], v[20:23]
  ds_read_b64_tr_b16 v[90:91], v35 offset:18432
  ds_read_b64_tr_b16 v[92:93], v36 offset:16384
  s_waitcnt lgkmcnt(10)
  v_mfma_f32_16x16x32_bf16 v[8:11], v[96:99], a[16:19], v[8:11]
  ds_read_b64_tr_b16 v[94:95], v36 offset:18432
  v_mfma_f32_16x16x32_bf16 v[24:27], v[96:99], a[20:23], v[24:27]
  buffer_load_dwordx4 a[88:91], v34, s[4:7], s16 offen offset:0 sc1
  v_mfma_f32_16x16x32_bf16 v[12:15], v[100:103], a[16:19], v[12:15]
  ds_read_b64_tr_b16 v[96:97], v37 offset:16384
  ds_read_b64_tr_b16 v[98:99], v37 offset:18432
  v_mfma_f32_16x16x32_bf16 v[28:31], v[100:103], a[20:23], v[28:31]
  buffer_load_dwordx4 a[92:95], v34, s[4:7], s16 offen offset:1024 sc1
  s_waitcnt lgkmcnt(10)
  v_mfma_f32_16x16x32_bf16 v[0:3], v[104:107], a[24:27], v[0:3]
  ds_read_b64_tr_b16 v[100:101], v38 offset:16384
  ds_read_b64_tr_b16 v[102:103], v38 offset:18432
  v_mfma_f32_16x16x32_bf16 v[16:19], v[104:107], a[28:31], v[16:19]
  ds_read_b64_tr_b16 v[104:105], v35 offset:20480
  ds_read_b64_tr_b16 v[106:107], v35 offset:22528
  v_mfma_f32_16x16x32_bf16 v[4:7], v[108:111], a[24:27], v[4:7]
  s_add_u32 s16, s16, 262144
  v_mfma_f32_16x16x32_bf16 v[20:23], v[108:111], a[28:31], v[20:23]
  ds_read_b64_tr_b16 v[108:109], v36 offset:20480
  ds_read_b64_tr_b16 v[110:111], v36 offset:22528
  s_waitcnt lgkmcnt(10)
  v_mfma_f32_16x16x32_bf16 v[8:11], v[112:115], a[24:27], v[8:11]
  s_bitset0_b32 s16, 22
  v_mfma_f32_16x16x32_bf16 v[24:27], v[112:115], a[28:31], v[24:27]
  ds_read_b64_tr_b16 v[112:113], v37 offset:20480
  ds_read_b64_tr_b16 v[114:115], v37 offset:22528
  v_mfma_f32_16x16x32_bf16 v[12:15], v[116:119], a[24:27], v[12:15]
  v_mfma_f32_16x16x32_bf16 v[28:31], v[116:119], a[28:31], v[28:31]
  s_waitcnt vmcnt(12) lgkmcnt(10)
  ds_read_b64_tr_b16 v[116:117], v38 offset:20480
  v_mfma_f32_16x16x32_bf16 v[0:3], v[88:91], a[32:35], v[0:3]
  buffer_load_dwordx4 a[96:99], v33, s[4:7], s16 offen offset:0 sc1
  v_mfma_f32_16x16x32_bf16 v[16:19], v[88:91], a[36:39], v[16:19]
  ds_read_b64_tr_b16 v[118:119], v38 offset:22528
  ds_read_b64_tr_b16 v[88:89], v35 offset:24576
  v_mfma_f32_16x16x32_bf16 v[4:7], v[92:95], a[32:35], v[4:7]
  buffer_load_dwordx4 a[100:103], v33, s[4:7], s16 offen offset:1024 sc1
  v_mfma_f32_16x16x32_bf16 v[20:23], v[92:95], a[36:39], v[20:23]
  ds_read_b64_tr_b16 v[90:91], v35 offset:26624
  ds_read_b64_tr_b16 v[92:93], v36 offset:24576
  s_waitcnt lgkmcnt(10)
  v_mfma_f32_16x16x32_bf16 v[8:11], v[96:99], a[32:35], v[8:11]
  ds_read_b64_tr_b16 v[94:95], v36 offset:26624
  v_mfma_f32_16x16x32_bf16 v[24:27], v[96:99], a[36:39], v[24:27]
  buffer_load_dwordx4 a[104:107], v34, s[4:7], s16 offen offset:0 sc1
  v_mfma_f32_16x16x32_bf16 v[12:15], v[100:103], a[32:35], v[12:15]
  ds_read_b64_tr_b16 v[96:97], v37 offset:24576
  ds_read_b64_tr_b16 v[98:99], v37 offset:26624
  v_mfma_f32_16x16x32_bf16 v[28:31], v[100:103], a[36:39], v[28:31]
  buffer_load_dwordx4 a[108:111], v34, s[4:7], s16 offen offset:1024 sc1
  s_waitcnt lgkmcnt(10)
  v_mfma_f32_16x16x32_bf16 v[0:3], v[104:107], a[40:43], v[0:3]
  ds_read_b64_tr_b16 v[100:101], v38 offset:24576
  ds_read_b64_tr_b16 v[102:103], v38 offset:26624
  v_mfma_f32_16x16x32_bf16 v[16:19], v[104:107], a[44:47], v[16:19]
  ds_read_b64_tr_b16 v[104:105], v35 offset:28672
  ds_read_b64_tr_b16 v[106:107], v35 offset:30720
  v_mfma_f32_16x16x32_bf16 v[4:7], v[108:111], a[40:43], v[4:7]
  s_add_u32 s16, s16, 262144
  v_mfma_f32_16x16x32_bf16 v[20:23], v[108:111], a[44:47], v[20:23]
  ds_read_b64_tr_b16 v[108:109], v36 offset:28672
  ds_read_b64_tr_b16 v[110:111], v36 offset:30720
  s_waitcnt lgkmcnt(10)
  v_mfma_f32_16x16x32_bf16 v[8:11], v[112:115], a[40:43], v[8:11]
  s_bitset0_b32 s16, 22
  v_mfma_f32_16x16x32_bf16 v[24:27], v[112:115], a[44:47], v[24:27]
  ds_read_b64_tr_b16 v[112:113], v37 offset:28672
  ds_read_b64_tr_b16 v[114:115], v37 offset:30720
  v_mfma_f32_16x16x32_bf16 v[12:15], v[116:119], a[40:43], v[12:15]
  v_mfma_f32_16x16x32_bf16 v[28:31], v[116:119], a[44:47], v[28:31]
  s_waitcnt vmcnt(12) lgkmcnt(10)
  ds_read_b64_tr_b16 v[116:117], v38 offset:28672
  v_mfma_f32_16x16x32_bf16 v[0:3], v[88:91], a[48:51], v[0:3]
  buffer_load_dwordx4 a[112:115], v33, s[4:7], s16 offen offset:0 sc1
  v_mfma_f32_16x16x32_bf16 v[16:19], v[88:91], a[52:55], v[16:19]
  ds_read_b64_tr_b16 v[118:119], v38 offset:30720
  ds_read_b64_tr_b16 v[88:89], v35 offset:32768
  v_mfma_f32_16x16x32_bf16 v[4:7], v[92:95], a[48:51], v[4:7]
  buffer_load_dwordx4 a[116:119], v33, s[4:7], s16 offen offset:1024 sc1
  v_mfma_f32_16x16x32_bf16 v[20:23], v[92:95], a[52:55], v[20:23]
  ds_read_b64_tr_b16 v[90:91], v35 offset:34816
  ds_read_b64_tr_b16 v[92:93], v36 offset:32768
  s_waitcnt lgkmcnt(10)
  v_mfma_f32_16x16x32_bf16 v[8:11], v[96:99], a[48:51], v[8:11]
  ds_read_b64_tr_b16 v[94:95], v36 offset:34816
  v_mfma_f32_16x16x32_bf16 v[24:27], v[96:99], a[52:55], v[24:27]
  buffer_load_dwordx4 a[120:123], v34, s[4:7], s16 offen offset:0 sc1
  v_mfma_f32_16x16x32_bf16 v[12:15], v[100:103], a[48:51], v[12:15]
  ds_read_b64_tr_b16 v[96:97], v37 offset:32768
  ds_read_b64_tr_b16 v[98:99], v37 offset:34816
  v_mfma_f32_16x16x32_bf16 v[28:31], v[100:103], a[52:55], v[28:31]
  buffer_load_dwordx4 a[124:127], v34, s[4:7], s16 offen offset:1024 sc1
  s_waitcnt lgkmcnt(10)
  v_mfma_f32_16x16x32_bf16 v[0:3], v[104:107], a[56:59], v[0:3]
  ds_read_b64_tr_b16 v[100:101], v38 offset:32768
  ds_read_b64_tr_b16 v[102:103], v38 offset:34816
  v_mfma_f32_16x16x32_bf16 v[16:19], v[104:107], a[60:63], v[16:19]
  ds_read_b64_tr_b16 v[104:105], v35 offset:36864
  ds_read_b64_tr_b16 v[106:107], v35 offset:38912
  v_mfma_f32_16x16x32_bf16 v[4:7], v[108:111], a[56:59], v[4:7]
  s_add_u32 s16, s16, 262144
  v_mfma_f32_16x16x32_bf16 v[20:23], v[108:111], a[60:63], v[20:23]
  ds_read_b64_tr_b16 v[108:109], v36 offset:36864
  ds_read_b64_tr_b16 v[110:111], v36 offset:38912
  s_waitcnt lgkmcnt(10)
  v_mfma_f32_16x16x32_bf16 v[8:11], v[112:115], a[56:59], v[8:11]
  s_bitset0_b32 s16, 22
  v_mfma_f32_16x16x32_bf16 v[24:27], v[112:115], a[60:63], v[24:27]
  ds_read_b64_tr_b16 v[112:113], v37 offset:36864
  ds_read_b64_tr_b16 v[114:115], v37 offset:38912
  v_mfma_f32_16x16x32_bf16 v[12:15], v[116:119], a[56:59], v[12:15]
  v_mfma_f32_16x16x32_bf16 v[28:31], v[116:119], a[60:63], v[28:31]
  s_waitcnt vmcnt(12) lgkmcnt(10)
  ds_read_b64_tr_b16 v[116:117], v38 offset:36864
  v_mfma_f32_16x16x32_bf16 v[0:3], v[88:91], a[64:67], v[0:3]
  buffer_load_dwordx4 a[128:131], v33, s[4:7], s16 offen offset:0 sc1
  v_mfma_f32_16x16x32_bf16 v[16:19], v[88:91], a[68:71], v[16:19]
  ds_read_b64_tr_b16 v[118:119], v38 offset:38912
  ds_read_b64_tr_b16 v[88:89], v35 offset:40960
  v_mfma_f32_16x16x32_bf16 v[4:7], v[92:95], a[64:67], v[4:7]
  buffer_load_dwordx4 a[132:135], v33, s[4:7], s16 offen offset:1024 sc1
  v_mfma_f32_16x16x32_bf16 v[20:23], v[92:95], a[68:71], v[20:23]
  ds_read_b64_tr_b16 v[90:91], v35 offset:43008
  ds_read_b64_tr_b16 v[92:93], v36 offset:40960
  s_waitcnt lgkmcnt(10)
  v_mfma_f32_16x16x32_bf16 v[8:11], v[96:99], a[64:67], v[8:11]
  ds_read_b64_tr_b16 v[94:95], v36 offset:43008
  v_mfma_f32_16x16x32_bf16 v[24:27], v[96:99], a[68:71], v[24:27]
  buffer_load_dwordx4 a[136:139], v34, s[4:7], s16 offen offset:0 sc1
  v_mfma_f32_16x16x32_bf16 v[12:15], v[100:103], a[64:67], v[12:15]
  ds_read_b64_tr_b16 v[96:97], v37 offset:40960
  ds_read_b64_tr_b16 v[98:99], v37 offset:43008
  v_mfma_f32_16x16x32_bf16 v[28:31], v[100:103], a[68:71], v[28:31]
  buffer_load_dwordx4 a[140:143], v34, s[4:7], s16 offen offset:1024 sc1
  s_waitcnt lgkmcnt(10)
  v_mfma_f32_16x16x32_bf16 v[0:3], v[104:107], a[72:75], v[0:3]
  ds_read_b64_tr_b16 v[100:101], v38 offset:40960
  ds_read_b64_tr_b16 v[102:103], v38 offset:43008
  v_mfma_f32_16x16x32_bf16 v[16:19], v[104:107], a[76:79], v[16:19]
  ds_read_b64_tr_b16 v[104:105], v35 offset:45056
  ds_read_b64_tr_b16 v[106:107], v35 offset:47104
  v_mfma_f32_16x16x32_bf16 v[4:7], v[108:111], a[72:75], v[4:7]
  s_add_u32 s16, s16, 262144
  v_mfma_f32_16x16x32_bf16 v[20:23], v[108:111], a[76:79], v[20:23]
  ds_read_b64_tr_b16 v[108:109], v36 offset:45056
  ds_read_b64_tr_b16 v[110:111], v36 offset:47104
  s_waitcnt lgkmcnt(10)
  v_mfma_f32_16x16x32_bf16 v[8:11], v[112:115], a[72:75], v[8:11]
  s_bitset0_b32 s16, 22
  v_mfma_f32_16x16x32_bf16 v[24:27], v[112:115], a[76:79], v[24:27]
  ds_read_b64_tr_b16 v[112:113], v37 offset:45056
  ds_read_b64_tr_b16 v[114:115], v37 offset:47104
  v_mfma_f32_16x16x32_bf16 v[12:15], v[116:119], a[72:75], v[12:15]
  v_mfma_f32_16x16x32_bf16 v[28:31], v[116:119], a[76:79], v[28:31]
  s_waitcnt vmcnt(12) lgkmcnt(10)
  ds_read_b64_tr_b16 v[116:117], v38 offset:45056
  v_mfma_f32_16x16x32_bf16 v[0:3], v[88:91], a[80:83], v[0:3]
  buffer_load_dwordx4 a[144:147], v33, s[4:7], s16 offen offset:0 sc1
  v_mfma_f32_16x16x32_bf16 v[16:19], v[88:91], a[84:87], v[16:19]
  ds_read_b64_tr_b16 v[118:119], v38 offset:47104
  ds_read_b64_tr_b16 v[88:89], v35 offset:49152
  v_mfma_f32_16x16x32_bf16 v[4:7], v[92:95], a[80:83], v[4:7]
  buffer_load_dwordx4 a[148:151], v33, s[4:7], s16 offen offset:1024 sc1
  v_mfma_f32_16x16x32_bf16 v[20:23], v[92:95], a[84:87], v[20:23]
  ds_read_b64_tr_b16 v[90:91], v35 offset:51200
  ds_read_b64_tr_b16 v[92:93], v36 offset:49152
  s_waitcnt lgkmcnt(10)
  v_mfma_f32_16x16x32_bf16 v[8:11], v[96:99], a[80:83], v[8:11]
  ds_read_b64_tr_b16 v[94:95], v36 offset:51200
  v_mfma_f32_16x16x32_bf16 v[24:27], v[96:99], a[84:87], v[24:27]
  buffer_load_dwordx4 a[152:155], v34, s[4:7], s16 offen offset:0 sc1
  v_mfma_f32_16x16x32_bf16 v[12:15], v[100:103], a[80:83], v[12:15]
  ds_read_b64_tr_b16 v[96:97], v37 offset:49152
  ds_read_b64_tr_b16 v[98:99], v37 offset:51200
  v_mfma_f32_16x16x32_bf16 v[28:31], v[100:103], a[84:87], v[28:31]
  buffer_load_dwordx4 a[156:159], v34, s[4:7], s16 offen offset:1024 sc1
  s_waitcnt lgkmcnt(10)
  v_mfma_f32_16x16x32_bf16 v[0:3], v[104:107], a[88:91], v[0:3]
  ds_read_b64_tr_b16 v[100:101], v38 offset:49152
  ds_read_b64_tr_b16 v[102:103], v38 offset:51200
  v_mfma_f32_16x16x32_bf16 v[16:19], v[104:107], a[92:95], v[16:19]
  ds_read_b64_tr_b16 v[104:105], v35 offset:53248
  ds_read_b64_tr_b16 v[106:107], v35 offset:55296
  v_mfma_f32_16x16x32_bf16 v[4:7], v[108:111], a[88:91], v[4:7]
  s_add_u32 s16, s16, 262144
  v_mfma_f32_16x16x32_bf16 v[20:23], v[108:111], a[92:95], v[20:23]
  ds_read_b64_tr_b16 v[108:109], v36 offset:53248
  ds_read_b64_tr_b16 v[110:111], v36 offset:55296
  s_waitcnt lgkmcnt(10)
  v_mfma_f32_16x16x32_bf16 v[8:11], v[112:115], a[88:91], v[8:11]
  s_bitset0_b32 s16, 22
  v_mfma_f32_16x16x32_bf16 v[24:27], v[112:115], a[92:95], v[24:27]
  ds_read_b64_tr_b16 v[112:113], v37 offset:53248
  ds_read_b64_tr_b16 v[114:115], v37 offset:55296
  v_mfma_f32_16x16x32_bf16 v[12:15], v[116:119], a[88:91], v[12:15]
  v_mfma_f32_16x16x32_bf16 v[28:31], v[116:119], a[92:95], v[28:31]
  s_waitcnt vmcnt(12) lgkmcnt(10)
  ds_read_b64_tr_b16 v[116:117], v38 offset:53248
  v_mfma_f32_16x16x32_bf16 v[0:3], v[88:91], a[96:99], v[0:3]
  buffer_load_dwordx4 a[160:163], v33, s[4:7], s16 offen offset:0 sc1
  v_mfma_f32_16x16x32_bf16 v[16:19], v[88:91], a[100:103], v[16:19]
  ds_read_b64_tr_b16 v[118:119], v38 offset:55296
  ds_read_b64_tr_b16 v[88:89], v35 offset:57344
  v_mfma_f32_16x16x32_bf16 v[4:7], v[92:95], a[96:99], v[4:7]
  buffer_load_dwordx4 a[164:167], v33, s[4:7], s16 offen offset:1024 sc1
  v_mfma_f32_16x16x32_bf16 v[20:23], v[92:95], a[100:103], v[20:23]
  ds_read_b64_tr_b16 v[90:91], v35 offset:59392
  ds_read_b64_tr_b16 v[92:93], v36 offset:57344
  s_waitcnt lgkmcnt(10)
  v_mfma_f32_16x16x32_bf16 v[8:11], v[96:99], a[96:99], v[8:11]
  ds_read_b64_tr_b16 v[94:95], v36 offset:59392
  v_mfma_f32_16x16x32_bf16 v[24:27], v[96:99], a[100:103], v[24:27]
  buffer_load_dwordx4 a[168:171], v34, s[4:7], s16 offen offset:0 sc1
  v_mfma_f32_16x16x32_bf16 v[12:15], v[100:103], a[96:99], v[12:15]
  ds_read_b64_tr_b16 v[96:97], v37 offset:57344
  ds_read_b64_tr_b16 v[98:99], v37 offset:59392
  v_mfma_f32_16x16x32_bf16 v[28:31], v[100:103], a[100:103], v[28:31]
  buffer_load_dwordx4 a[172:175], v34, s[4:7], s16 offen offset:1024 sc1
  s_waitcnt lgkmcnt(10)
  v_mfma_f32_16x16x32_bf16 v[0:3], v[104:107], a[104:107], v[0:3]
  ds_read_b64_tr_b16 v[100:101], v38 offset:57344
  ds_read_b64_tr_b16 v[102:103], v38 offset:59392
  v_mfma_f32_16x16x32_bf16 v[16:19], v[104:107], a[108:111], v[16:19]
  ds_read_b64_tr_b16 v[104:105], v35 offset:61440
  ds_read_b64_tr_b16 v[106:107], v35 offset:63488
  v_mfma_f32_16x16x32_bf16 v[4:7], v[108:111], a[104:107], v[4:7]
  s_add_u32 s16, s16, 262144
  v_mfma_f32_16x16x32_bf16 v[20:23], v[108:111], a[108:111], v[20:23]
  ds_read_b64_tr_b16 v[108:109], v36 offset:61440
  ds_read_b64_tr_b16 v[110:111], v36 offset:63488
  s_waitcnt lgkmcnt(10)
  v_mfma_f32_16x16x32_bf16 v[8:11], v[112:115], a[104:107], v[8:11]
  s_bitset0_b32 s16, 22
  v_mfma_f32_16x16x32_bf16 v[24:27], v[112:115], a[108:111], v[24:27]
  ds_read_b64_tr_b16 v[112:113], v37 offset:61440
  ds_read_b64_tr_b16 v[114:115], v37 offset:63488
  v_mfma_f32_16x16x32_bf16 v[12:15], v[116:119], a[104:107], v[12:15]
  v_mfma_f32_16x16x32_bf16 v[28:31], v[116:119], a[108:111], v[28:31]
  s_waitcnt vmcnt(12) lgkmcnt(10)
  ds_read_b64_tr_b16 v[116:117], v38 offset:61440
  v_mfma_f32_16x16x32_bf16 v[0:3], v[88:91], a[112:115], v[0:3]
  buffer_load_dwordx4 a[176:179], v33, s[4:7], s16 offen offset:0 sc1
  v_mfma_f32_16x16x32_bf16 v[16:19], v[88:91], a[116:119], v[16:19]
  ds_read_b64_tr_b16 v[118:119], v38 offset:63488
  ds_read_b64_tr_b16 v[88:89], v39 offset:0
  v_mfma_f32_16x16x32_bf16 v[4:7], v[92:95], a[112:115], v[4:7]
  buffer_load_dwordx4 a[180:183], v33, s[4:7], s16 offen offset:1024 sc1
  v_mfma_f32_16x16x32_bf16 v[20:23], v[92:95], a[116:119], v[20:23]
  ds_read_b64_tr_b16 v[90:91], v39 offset:2048
  ds_read_b64_tr_b16 v[92:93], v40 offset:0
  s_waitcnt lgkmcnt(10)
  v_mfma_f32_16x16x32_bf16 v[8:11], v[96:99], a[112:115], v[8:11]
  ds_read_b64_tr_b16 v[94:95], v40 offset:2048
  v_mfma_f32_16x16x32_bf16 v[24:27], v[96:99], a[116:119], v[24:27]
  buffer_load_dwordx4 a[184:187], v34, s[4:7], s16 offen offset:0 sc1
  v_mfma_f32_16x16x32_bf16 v[12:15], v[100:103], a[112:115], v[12:15]
  ds_read_b64_tr_b16 v[96:97], v41 offset:0
  ds_read_b64_tr_b16 v[98:99], v41 offset:2048
  v_mfma_f32_16x16x32_bf16 v[28:31], v[100:103], a[116:119], v[28:31]
  buffer_load_dwordx4 a[188:191], v34, s[4:7], s16 offen offset:1024 sc1
  s_waitcnt lgkmcnt(10)
  v_mfma_f32_16x16x32_bf16 v[0:3], v[104:107], a[120:123], v[0:3]
  ds_read_b64_tr_b16 v[100:101], v42 offset:0
  ds_read_b64_tr_b16 v[102:103], v42 offset:2048
  v_mfma_f32_16x16x32_bf16 v[16:19], v[104:107], a[124:127], v[16:19]
  ds_read_b64_tr_b16 v[104:105], v39 offset:4096
  ds_read_b64_tr_b16 v[106:107], v39 offset:6144
  v_mfma_f32_16x16x32_bf16 v[4:7], v[108:111], a[120:123], v[4:7]
  s_add_u32 s16, s16, 262144
  v_mfma_f32_16x16x32_bf16 v[20:23], v[108:111], a[124:127], v[20:23]
  ds_read_b64_tr_b16 v[108:109], v40 offset:4096
  ds_read_b64_tr_b16 v[110:111], v40 offset:6144
  s_waitcnt lgkmcnt(10)
  v_mfma_f32_16x16x32_bf16 v[8:11], v[112:115], a[120:123], v[8:11]
  s_bitset0_b32 s16, 22
  v_mfma_f32_16x16x32_bf16 v[24:27], v[112:115], a[124:127], v[24:27]
  ds_read_b64_tr_b16 v[112:113], v41 offset:4096
  ds_read_b64_tr_b16 v[114:115], v41 offset:6144
  v_mfma_f32_16x16x32_bf16 v[12:15], v[116:119], a[120:123], v[12:15]
  v_mfma_f32_16x16x32_bf16 v[28:31], v[116:119], a[124:127], v[28:31]
  s_waitcnt vmcnt(12) lgkmcnt(10)
  ds_read_b64_tr_b16 v[116:117], v42 offset:4096
  v_mfma_f32_16x16x32_bf16 v[0:3], v[88:91], a[128:131], v[0:3]
  buffer_load_dwordx4 a[192:195], v33, s[4:7], s16 offen offset:0 sc1
  v_mfma_f32_16x16x32_bf16 v[16:19], v[88:91], a[132:135], v[16:19]
  ds_read_b64_tr_b16 v[118:119], v42 offset:6144
  ds_read_b64_tr_b16 v[88:89], v39 offset:8192
  v_mfma_f32_16x16x32_bf16 v[4:7], v[92:95], a[128:131], v[4:7]
  buffer_load_dwordx4 a[196:199], v33, s[4:7], s16 offen offset:1024 sc1
  v_mfma_f32_16x16x32_bf16 v[20:23], v[92:95], a[132:135], v[20:23]
  ds_read_b64_tr_b16 v[90:91], v39 offset:10240
  ds_read_b64_tr_b16 v[92:93], v40 offset:8192
  s_waitcnt lgkmcnt(10)
  v_mfma_f32_16x16x32_bf16 v[8:11], v[96:99], a[128:131], v[8:11]
  ds_read_b64_tr_b16 v[94:95], v40 offset:10240
  v_mfma_f32_16x16x32_bf16 v[24:27], v[96:99], a[132:135], v[24:27]
  buffer_load_dwordx4 a[200:203], v34, s[4:7], s16 offen offset:0 sc1
  v_mfma_f32_16x16x32_bf16 v[12:15], v[100:103], a[128:131], v[12:15]
  ds_read_b64_tr_b16 v[96:97], v41 offset:8192
  ds_read_b64_tr_b16 v[98:99], v41 offset:10240
  v_mfma_f32_16x16x32_bf16 v[28:31], v[100:103], a[132:135], v[28:31]
  buffer_load_dwordx4 a[204:207], v34, s[4:7], s16 offen offset:1024 sc1
  s_waitcnt lgkmcnt(10)
  v_mfma_f32_16x16x32_bf16 v[0:3], v[104:107], a[136:139], v[0:3]
  ds_read_b64_tr_b16 v[100:101], v42 offset:8192
  ds_read_b64_tr_b16 v[102:103], v42 offset:10240
  v_mfma_f32_16x16x32_bf16 v[16:19], v[104:107], a[140:143], v[16:19]
  ds_read_b64_tr_b16 v[104:105], v39 offset:12288
  ds_read_b64_tr_b16 v[106:107], v39 offset:14336
  v_mfma_f32_16x16x32_bf16 v[4:7], v[108:111], a[136:139], v[4:7]
  s_add_u32 s16, s16, 262144
  v_mfma_f32_16x16x32_bf16 v[20:23], v[108:111], a[140:143], v[20:23]
  ds_read_b64_tr_b16 v[108:109], v40 offset:12288
  ds_read_b64_tr_b16 v[110:111], v40 offset:14336
  s_waitcnt lgkmcnt(10)
  v_mfma_f32_16x16x32_bf16 v[8:11], v[112:115], a[136:139], v[8:11]
  s_bitset0_b32 s16, 22
  v_mfma_f32_16x16x32_bf16 v[24:27], v[112:115], a[140:143], v[24:27]
  ds_read_b64_tr_b16 v[112:113], v41 offset:12288
  ds_read_b64_tr_b16 v[114:115], v41 offset:14336
  v_mfma_f32_16x16x32_bf16 v[12:15], v[116:119], a[136:139], v[12:15]
  v_mfma_f32_16x16x32_bf16 v[28:31], v[116:119], a[140:143], v[28:31]
  s_waitcnt vmcnt(12) lgkmcnt(10)
  ds_read_b64_tr_b16 v[116:117], v42 offset:12288
  v_mfma_f32_16x16x32_bf16 v[0:3], v[88:91], a[144:147], v[0:3]
  buffer_load_dwordx4 a[208:211], v33, s[4:7], s16 offen offset:0 sc1
  v_mfma_f32_16x16x32_bf16 v[16:19], v[88:91], a[148:151], v[16:19]
  ds_read_b64_tr_b16 v[118:119], v42 offset:14336
  ds_read_b64_tr_b16 v[88:89], v39 offset:16384
  v_mfma_f32_16x16x32_bf16 v[4:7], v[92:95], a[144:147], v[4:7]
  buffer_load_dwordx4 a[212:215], v33, s[4:7], s16 offen offset:1024 sc1
  v_mfma_f32_16x16x32_bf16 v[20:23], v[92:95], a[148:151], v[20:23]
  ds_read_b64_tr_b16 v[90:91], v39 offset:18432
  ds_read_b64_tr_b16 v[92:93], v40 offset:16384
  s_waitcnt lgkmcnt(10)
  v_mfma_f32_16x16x32_bf16 v[8:11], v[96:99], a[144:147], v[8:11]
  ds_read_b64_tr_b16 v[94:95], v40 offset:18432
  v_mfma_f32_16x16x32_bf16 v[24:27], v[96:99], a[148:151], v[24:27]
  buffer_load_dwordx4 a[216:219], v34, s[4:7], s16 offen offset:0 sc1
  v_mfma_f32_16x16x32_bf16 v[12:15], v[100:103], a[144:147], v[12:15]
  ds_read_b64_tr_b16 v[96:97], v41 offset:16384
  ds_read_b64_tr_b16 v[98:99], v41 offset:18432
  v_mfma_f32_16x16x32_bf16 v[28:31], v[100:103], a[148:151], v[28:31]
  buffer_load_dwordx4 a[220:223], v34, s[4:7], s16 offen offset:1024 sc1
  s_waitcnt lgkmcnt(10)
  v_mfma_f32_16x16x32_bf16 v[0:3], v[104:107], a[152:155], v[0:3]
  ds_read_b64_tr_b16 v[100:101], v42 offset:16384
  ds_read_b64_tr_b16 v[102:103], v42 offset:18432
  v_mfma_f32_16x16x32_bf16 v[16:19], v[104:107], a[156:159], v[16:19]
  ds_read_b64_tr_b16 v[104:105], v39 offset:20480
  ds_read_b64_tr_b16 v[106:107], v39 offset:22528
  v_mfma_f32_16x16x32_bf16 v[4:7], v[108:111], a[152:155], v[4:7]
  s_add_u32 s16, s16, 262144
  v_mfma_f32_16x16x32_bf16 v[20:23], v[108:111], a[156:159], v[20:23]
  ds_read_b64_tr_b16 v[108:109], v40 offset:20480
  ds_read_b64_tr_b16 v[110:111], v40 offset:22528
  s_waitcnt lgkmcnt(10)
  v_mfma_f32_16x16x32_bf16 v[8:11], v[112:115], a[152:155], v[8:11]
  s_bitset0_b32 s16, 22
  v_mfma_f32_16x16x32_bf16 v[24:27], v[112:115], a[156:159], v[24:27]
  ds_read_b64_tr_b16 v[112:113], v41 offset:20480
  ds_read_b64_tr_b16 v[114:115], v41 offset:22528
  v_mfma_f32_16x16x32_bf16 v[12:15], v[116:119], a[152:155], v[12:15]
  v_mfma_f32_16x16x32_bf16 v[28:31], v[116:119], a[156:159], v[28:31]
  s_waitcnt vmcnt(12) lgkmcnt(10)
  ds_read_b64_tr_b16 v[116:117], v42 offset:20480
  v_mfma_f32_16x16x32_bf16 v[0:3], v[88:91], a[160:163], v[0:3]
  buffer_load_dwordx4 a[0:3], v33, s[4:7], s16 offen offset:0 sc1
  v_mfma_f32_16x16x32_bf16 v[16:19], v[88:91], a[164:167], v[16:19]
  ds_read_b64_tr_b16 v[118:119], v42 offset:22528
  ds_read_b64_tr_b16 v[88:89], v39 offset:24576
  v_mfma_f32_16x16x32_bf16 v[4:7], v[92:95], a[160:163], v[4:7]
  buffer_load_dwordx4 a[4:7], v33, s[4:7], s16 offen offset:1024 sc1
  v_mfma_f32_16x16x32_bf16 v[20:23], v[92:95], a[164:167], v[20:23]
  ds_read_b64_tr_b16 v[90:91], v39 offset:26624
  ds_read_b64_tr_b16 v[92:93], v40 offset:24576
  s_waitcnt lgkmcnt(10)
  v_mfma_f32_16x16x32_bf16 v[8:11], v[96:99], a[160:163], v[8:11]
  ds_read_b64_tr_b16 v[94:95], v40 offset:26624
  v_mfma_f32_16x16x32_bf16 v[24:27], v[96:99], a[164:167], v[24:27]
  buffer_load_dwordx4 a[8:11], v34, s[4:7], s16 offen offset:0 sc1
  v_mfma_f32_16x16x32_bf16 v[12:15], v[100:103], a[160:163], v[12:15]
  ds_read_b64_tr_b16 v[96:97], v41 offset:24576
  ds_read_b64_tr_b16 v[98:99], v41 offset:26624
  v_mfma_f32_16x16x32_bf16 v[28:31], v[100:103], a[164:167], v[28:31]
  buffer_load_dwordx4 a[12:15], v34, s[4:7], s16 offen offset:1024 sc1
  s_waitcnt lgkmcnt(10)
  v_mfma_f32_16x16x32_bf16 v[0:3], v[104:107], a[168:171], v[0:3]
  ds_read_b64_tr_b16 v[100:101], v42 offset:24576
  ds_read_b64_tr_b16 v[102:103], v42 offset:26624
  v_mfma_f32_16x16x32_bf16 v[16:19], v[104:107], a[172:175], v[16:19]
  ds_read_b64_tr_b16 v[104:105], v39 offset:28672
  ds_read_b64_tr_b16 v[106:107], v39 offset:30720
  v_mfma_f32_16x16x32_bf16 v[4:7], v[108:111], a[168:171], v[4:7]
  s_add_u32 s16, s16, 262144
  v_mfma_f32_16x16x32_bf16 v[20:23], v[108:111], a[172:175], v[20:23]
  ds_read_b64_tr_b16 v[108:109], v40 offset:28672
  ds_read_b64_tr_b16 v[110:111], v40 offset:30720
  s_waitcnt lgkmcnt(10)
  v_mfma_f32_16x16x32_bf16 v[8:11], v[112:115], a[168:171], v[8:11]
  s_bitset0_b32 s16, 22
  v_mfma_f32_16x16x32_bf16 v[24:27], v[112:115], a[172:175], v[24:27]
  ds_read_b64_tr_b16 v[112:113], v41 offset:28672
  ds_read_b64_tr_b16 v[114:115], v41 offset:30720
  v_mfma_f32_16x16x32_bf16 v[12:15], v[116:119], a[168:171], v[12:15]
  v_mfma_f32_16x16x32_bf16 v[28:31], v[116:119], a[172:175], v[28:31]
  s_waitcnt vmcnt(12) lgkmcnt(10)
  ds_read_b64_tr_b16 v[116:117], v42 offset:28672
  v_mfma_f32_16x16x32_bf16 v[0:3], v[88:91], a[176:179], v[0:3]
  buffer_load_dwordx4 a[16:19], v33, s[4:7], s16 offen offset:0 sc1
  v_mfma_f32_16x16x32_bf16 v[16:19], v[88:91], a[180:183], v[16:19]
  ds_read_b64_tr_b16 v[118:119], v42 offset:30720
  ds_read_b64_tr_b16 v[88:89], v39 offset:32768
  v_mfma_f32_16x16x32_bf16 v[4:7], v[92:95], a[176:179], v[4:7]
  buffer_load_dwordx4 a[20:23], v33, s[4:7], s16 offen offset:1024 sc1
  v_mfma_f32_16x16x32_bf16 v[20:23], v[92:95], a[180:183], v[20:23]
  ds_read_b64_tr_b16 v[90:91], v39 offset:34816
  ds_read_b64_tr_b16 v[92:93], v40 offset:32768
  s_waitcnt lgkmcnt(10)
  v_mfma_f32_16x16x32_bf16 v[8:11], v[96:99], a[176:179], v[8:11]
  ds_read_b64_tr_b16 v[94:95], v40 offset:34816
  v_mfma_f32_16x16x32_bf16 v[24:27], v[96:99], a[180:183], v[24:27]
  buffer_load_dwordx4 a[24:27], v34, s[4:7], s16 offen offset:0 sc1
  v_mfma_f32_16x16x32_bf16 v[12:15], v[100:103], a[176:179], v[12:15]
  ds_read_b64_tr_b16 v[96:97], v41 offset:32768
  ds_read_b64_tr_b16 v[98:99], v41 offset:34816
  v_mfma_f32_16x16x32_bf16 v[28:31], v[100:103], a[180:183], v[28:31]
  buffer_load_dwordx4 a[28:31], v34, s[4:7], s16 offen offset:1024 sc1
  s_waitcnt lgkmcnt(10)
  v_mfma_f32_16x16x32_bf16 v[0:3], v[104:107], a[184:187], v[0:3]
  ds_read_b64_tr_b16 v[100:101], v42 offset:32768
  ds_read_b64_tr_b16 v[102:103], v42 offset:34816
  v_mfma_f32_16x16x32_bf16 v[16:19], v[104:107], a[188:191], v[16:19]
  ds_read_b64_tr_b16 v[104:105], v39 offset:36864
  ds_read_b64_tr_b16 v[106:107], v39 offset:38912
  v_mfma_f32_16x16x32_bf16 v[4:7], v[108:111], a[184:187], v[4:7]
  s_add_u32 s16, s16, 262144
  v_mfma_f32_16x16x32_bf16 v[20:23], v[108:111], a[188:191], v[20:23]
  ds_read_b64_tr_b16 v[108:109], v40 offset:36864
  ds_read_b64_tr_b16 v[110:111], v40 offset:38912
  s_waitcnt lgkmcnt(10)
  v_mfma_f32_16x16x32_bf16 v[8:11], v[112:115], a[184:187], v[8:11]
  s_bitset0_b32 s16, 22
  v_mfma_f32_16x16x32_bf16 v[24:27], v[112:115], a[188:191], v[24:27]
  ds_read_b64_tr_b16 v[112:113], v41 offset:36864
  ds_read_b64_tr_b16 v[114:115], v41 offset:38912
  v_mfma_f32_16x16x32_bf16 v[12:15], v[116:119], a[184:187], v[12:15]
  v_mfma_f32_16x16x32_bf16 v[28:31], v[116:119], a[188:191], v[28:31]
  s_waitcnt vmcnt(12) lgkmcnt(10)
  ds_read_b64_tr_b16 v[116:117], v42 offset:36864
  v_mfma_f32_16x16x32_bf16 v[0:3], v[88:91], a[192:195], v[0:3]
  ds_read_b64_tr_b16 v[118:119], v42 offset:38912
  v_mfma_f32_16x16x32_bf16 v[16:19], v[88:91], a[196:199], v[16:19]
  ds_read_b64_tr_b16 v[88:89], v39 offset:40960
  ds_read_b64_tr_b16 v[90:91], v39 offset:43008
  v_mfma_f32_16x16x32_bf16 v[4:7], v[92:95], a[192:195], v[4:7]
  v_mfma_f32_16x16x32_bf16 v[20:23], v[92:95], a[196:199], v[20:23]
  ds_read_b64_tr_b16 v[92:93], v40 offset:40960
  ds_read_b64_tr_b16 v[94:95], v40 offset:43008
  s_waitcnt lgkmcnt(10)
  v_mfma_f32_16x16x32_bf16 v[8:11], v[96:99], a[192:195], v[8:11]
  v_mfma_f32_16x16x32_bf16 v[24:27], v[96:99], a[196:199], v[24:27]
  ds_read_b64_tr_b16 v[96:97], v41 offset:40960
  ds_read_b64_tr_b16 v[98:99], v41 offset:43008
  v_mfma_f32_16x16x32_bf16 v[12:15], v[100:103], a[192:195], v[12:15]
  v_mfma_f32_16x16x32_bf16 v[28:31], v[100:103], a[196:199], v[28:31]
  ds_read_b64_tr_b16 v[100:101], v42 offset:40960
  ds_read_b64_tr_b16 v[102:103], v42 offset:43008
  v_mfma_f32_16x16x32_bf16 v[0:3], v[104:107], a[200:203], v[0:3]
  v_mfma_f32_16x16x32_bf16 v[16:19], v[104:107], a[204:207], v[16:19]
  ds_read_b64_tr_b16 v[104:105], v39 offset:45056
  ds_read_b64_tr_b16 v[106:107], v39 offset:47104
  s_waitcnt lgkmcnt(10)
  v_mfma_f32_16x16x32_bf16 v[4:7], v[108:111], a[200:203], v[4:7]
  v_mfma_f32_16x16x32_bf16 v[20:23], v[108:111], a[204:207], v[20:23]
  ds_read_b64_tr_b16 v[108:109], v40 offset:45056
  ds_read_b64_tr_b16 v[110:111], v40 offset:47104
  v_mfma_f32_16x16x32_bf16 v[8:11], v[112:115], a[200:203], v[8:11]
  v_mfma_f32_16x16x32_bf16 v[24:27], v[112:115], a[204:207], v[24:27]
  ds_read_b64_tr_b16 v[112:113], v41 offset:45056
  ds_read_b64_tr_b16 v[114:115], v41 offset:47104
  v_mfma_f32_16x16x32_bf16 v[12:15], v[116:119], a[200:203], v[12:15]
  v_mfma_f32_16x16x32_bf16 v[28:31], v[116:119], a[204:207], v[28:31]
  s_waitcnt vmcnt(8) lgkmcnt(10)
  ds_read_b64_tr_b16 v[116:117], v42 offset:45056
  v_mfma_f32_16x16x32_bf16 v[0:3], v[88:91], a[208:211], v[0:3]
  ds_read_b64_tr_b16 v[118:119], v42 offset:47104
  v_mfma_f32_16x16x32_bf16 v[16:19], v[88:91], a[212:215], v[16:19]
  ds_read_b64_tr_b16 v[88:89], v39 offset:49152
  ds_read_b64_tr_b16 v[90:91], v39 offset:51200
  v_mfma_f32_16x16x32_bf16 v[4:7], v[92:95], a[208:211], v[4:7]
  v_mfma_f32_16x16x32_bf16 v[20:23], v[92:95], a[212:215], v[20:23]
  ds_read_b64_tr_b16 v[92:93], v40 offset:49152
  ds_read_b64_tr_b16 v[94:95], v40 offset:51200
  s_waitcnt lgkmcnt(10)
  v_mfma_f32_16x16x32_bf16 v[8:11], v[96:99], a[208:211], v[8:11]
  v_mfma_f32_16x16x32_bf16 v[24:27], v[96:99], a[212:215], v[24:27]
  ds_read_b64_tr_b16 v[96:97], v41 offset:49152
  ds_read_b64_tr_b16 v[98:99], v41 offset:51200
  v_mfma_f32_16x16x32_bf16 v[12:15], v[100:103], a[208:211], v[12:15]
  v_mfma_f32_16x16x32_bf16 v[28:31], v[100:103], a[212:215], v[28:31]
  ds_read_b64_tr_b16 v[100:101], v42 offset:49152
  ds_read_b64_tr_b16 v[102:103], v42 offset:51200
  v_mfma_f32_16x16x32_bf16 v[0:3], v[104:107], a[216:219], v[0:3]
  v_mfma_f32_16x16x32_bf16 v[16:19], v[104:107], a[220:223], v[16:19]
  ds_read_b64_tr_b16 v[104:105], v39 offset:53248
  ds_read_b64_tr_b16 v[106:107], v39 offset:55296
  s_waitcnt lgkmcnt(10)
  v_mfma_f32_16x16x32_bf16 v[4:7], v[108:111], a[216:219], v[4:7]
  v_mfma_f32_16x16x32_bf16 v[20:23], v[108:111], a[220:223], v[20:23]
  ds_read_b64_tr_b16 v[108:109], v40 offset:53248
  ds_read_b64_tr_b16 v[110:111], v40 offset:55296
  v_mfma_f32_16x16x32_bf16 v[8:11], v[112:115], a[216:219], v[8:11]
  v_mfma_f32_16x16x32_bf16 v[24:27], v[112:115], a[220:223], v[24:27]
  ds_read_b64_tr_b16 v[112:113], v41 offset:53248
  ds_read_b64_tr_b16 v[114:115], v41 offset:55296
  v_mfma_f32_16x16x32_bf16 v[12:15], v[116:119], a[216:219], v[12:15]
  v_mfma_f32_16x16x32_bf16 v[28:31], v[116:119], a[220:223], v[28:31]
  s_waitcnt vmcnt(4) lgkmcnt(10)
  ds_read_b64_tr_b16 v[116:117], v42 offset:53248
  v_mfma_f32_16x16x32_bf16 v[0:3], v[88:91], a[0:3], v[0:3]
  ds_read_b64_tr_b16 v[118:119], v42 offset:55296
  v_mfma_f32_16x16x32_bf16 v[16:19], v[88:91], a[4:7], v[16:19]
  ds_read_b64_tr_b16 v[88:89], v39 offset:57344
  ds_read_b64_tr_b16 v[90:91], v39 offset:59392
  v_mfma_f32_16x16x32_bf16 v[4:7], v[92:95], a[0:3], v[4:7]
  v_mfma_f32_16x16x32_bf16 v[20:23], v[92:95], a[4:7], v[20:23]
  ds_read_b64_tr_b16 v[92:93], v40 offset:57344
  ds_read_b64_tr_b16 v[94:95], v40 offset:59392
  s_waitcnt lgkmcnt(10)
  v_mfma_f32_16x16x32_bf16 v[8:11], v[96:99], a[0:3], v[8:11]
  v_mfma_f32_16x16x32_bf16 v[24:27], v[96:99], a[4:7], v[24:27]
  ds_read_b64_tr_b16 v[96:97], v41 offset:57344
  ds_read_b64_tr_b16 v[98:99], v41 offset:59392
  v_mfma_f32_16x16x32_bf16 v[12:15], v[100:103], a[0:3], v[12:15]
  v_mfma_f32_16x16x32_bf16 v[28:31], v[100:103], a[4:7], v[28:31]
  ds_read_b64_tr_b16 v[100:101], v42 offset:57344
  ds_read_b64_tr_b16 v[102:103], v42 offset:59392
  v_mfma_f32_16x16x32_bf16 v[0:3], v[104:107], a[8:11], v[0:3]
  v_mfma_f32_16x16x32_bf16 v[16:19], v[104:107], a[12:15], v[16:19]
  ds_read_b64_tr_b16 v[104:105], v39 offset:61440
  ds_read_b64_tr_b16 v[106:107], v39 offset:63488
  s_waitcnt lgkmcnt(10)
  v_mfma_f32_16x16x32_bf16 v[4:7], v[108:111], a[8:11], v[4:7]
  v_mfma_f32_16x16x32_bf16 v[20:23], v[108:111], a[12:15], v[20:23]
  ds_read_b64_tr_b16 v[108:109], v40 offset:61440
  ds_read_b64_tr_b16 v[110:111], v40 offset:63488
  v_mfma_f32_16x16x32_bf16 v[8:11], v[112:115], a[8:11], v[8:11]
  v_mfma_f32_16x16x32_bf16 v[24:27], v[112:115], a[12:15], v[24:27]
  ds_read_b64_tr_b16 v[112:113], v41 offset:61440
  ds_read_b64_tr_b16 v[114:115], v41 offset:63488
  v_mfma_f32_16x16x32_bf16 v[12:15], v[116:119], a[8:11], v[12:15]
  v_mfma_f32_16x16x32_bf16 v[28:31], v[116:119], a[12:15], v[28:31]
  s_waitcnt vmcnt(0) lgkmcnt(10)
  ds_read_b64_tr_b16 v[116:117], v42 offset:61440
  v_mfma_f32_16x16x32_bf16 v[0:3], v[88:91], a[16:19], v[0:3]
  ds_read_b64_tr_b16 v[118:119], v42 offset:63488
  v_mfma_f32_16x16x32_bf16 v[16:19], v[88:91], a[20:23], v[16:19]
  v_mfma_f32_16x16x32_bf16 v[4:7], v[92:95], a[16:19], v[4:7]
  v_mfma_f32_16x16x32_bf16 v[20:23], v[92:95], a[20:23], v[20:23]
  s_waitcnt lgkmcnt(10)
  v_mfma_f32_16x16x32_bf16 v[8:11], v[96:99], a[16:19], v[8:11]
  v_mfma_f32_16x16x32_bf16 v[24:27], v[96:99], a[20:23], v[24:27]
  s_waitcnt lgkmcnt(8)
  v_mfma_f32_16x16x32_bf16 v[12:15], v[100:103], a[16:19], v[12:15]
  v_mfma_f32_16x16x32_bf16 v[28:31], v[100:103], a[20:23], v[28:31]
  s_waitcnt lgkmcnt(6)
  v_mfma_f32_16x16x32_bf16 v[0:3], v[104:107], a[24:27], v[0:3]
  v_mfma_f32_16x16x32_bf16 v[16:19], v[104:107], a[28:31], v[16:19]
  s_waitcnt lgkmcnt(4)
  v_mfma_f32_16x16x32_bf16 v[4:7], v[108:111], a[24:27], v[4:7]
  v_mfma_f32_16x16x32_bf16 v[20:23], v[108:111], a[28:31], v[20:23]
  s_waitcnt lgkmcnt(2)
  v_mfma_f32_16x16x32_bf16 v[8:11], v[112:115], a[24:27], v[8:11]
  v_mfma_f32_16x16x32_bf16 v[24:27], v[112:115], a[28:31], v[24:27]
  s_waitcnt lgkmcnt(0)
  v_mfma_f32_16x16x32_bf16 v[12:15], v[116:119], a[24:27], v[12:15]
  v_mfma_f32_16x16x32_bf16 v[28:31], v[116:119], a[28:31], v[28:31]
  s_nop 7
  s_nop 1
  s_barrier
  v_pk_fma_f32 v[120:121], v[0:1], v[64:65], v[120:121]
  v_pk_fma_f32 v[122:123], v[2:3], v[66:67], v[122:123]
  v_pk_fma_f32 v[124:125], v[4:5], v[68:69], v[124:125]
  v_pk_fma_f32 v[126:127], v[6:7], v[70:71], v[126:127]
  v_pk_fma_f32 v[128:129], v[8:9], v[72:73], v[128:129]
  v_pk_fma_f32 v[130:131], v[10:11], v[74:75], v[130:131]
  v_pk_fma_f32 v[132:133], v[12:13], v[76:77], v[132:133]
  v_pk_fma_f32 v[134:135], v[14:15], v[78:79], v[134:135]
  v_pk_fma_f32 v[136:137], v[16:17], v[64:65], v[136:137]
  v_pk_fma_f32 v[138:139], v[18:19], v[66:67], v[138:139]
  v_pk_fma_f32 v[140:141], v[20:21], v[68:69], v[140:141]
  v_pk_fma_f32 v[142:143], v[22:23], v[70:71], v[142:143]
  v_pk_fma_f32 v[144:145], v[24:25], v[72:73], v[144:145]
  v_pk_fma_f32 v[146:147], v[26:27], v[74:75], v[146:147]
  v_pk_fma_f32 v[148:149], v[28:29], v[76:77], v[148:149]
  v_pk_fma_f32 v[150:151], v[30:31], v[78:79], v[150:151]
  v_pk_mul_f32 v[160:161], v[120:121], v[120:121]
  v_pk_mul_f32 v[162:163], v[136:137], v[136:137]
  v_pk_fma_f32 v[160:161], v[122:123], v[122:123], v[160:161]
  v_pk_add_f32 v[152:153], v[120:121], v[122:123]
  v_pk_fma_f32 v[162:163], v[138:139], v[138:139], v[162:163]
  v_pk_add_f32 v[154:155], v[136:137], v[138:139]
  v_pk_fma_f32 v[160:161], v[124:125], v[124:125], v[160:161]
  v_pk_add_f32 v[152:153], v[152:153], v[124:125]
  v_pk_fma_f32 v[162:163], v[140:141], v[140:141], v[162:163]
  v_pk_add_f32 v[154:155], v[154:155], v[140:141]
  v_pk_fma_f32 v[160:161], v[126:127], v[126:127], v[160:161]
  v_pk_add_f32 v[152:153], v[152:153], v[126:127]
  v_pk_fma_f32 v[162:163], v[142:143], v[142:143], v[162:163]
  v_pk_add_f32 v[154:155], v[154:155], v[142:143]
  v_pk_fma_f32 v[160:161], v[128:129], v[128:129], v[160:161]
  v_pk_add_f32 v[152:153], v[152:153], v[128:129]
  v_pk_fma_f32 v[162:163], v[144:145], v[144:145], v[162:163]
  v_pk_add_f32 v[154:155], v[154:155], v[144:145]
  v_pk_fma_f32 v[160:161], v[130:131], v[130:131], v[160:161]
  v_pk_add_f32 v[152:153], v[152:153], v[130:131]
  v_pk_fma_f32 v[162:163], v[146:147], v[146:147], v[162:163]
  v_pk_add_f32 v[154:155], v[154:155], v[146:147]
  v_pk_fma_f32 v[160:161], v[132:133], v[132:133], v[160:161]
  v_pk_add_f32 v[152:153], v[152:153], v[132:133]
  v_pk_fma_f32 v[162:163], v[148:149], v[148:149], v[162:163]
  v_pk_add_f32 v[154:155], v[154:155], v[148:149]
  v_pk_fma_f32 v[160:161], v[134:135], v[134:135], v[160:161]
  v_pk_add_f32 v[152:153], v[152:153], v[134:135]
  v_pk_fma_f32 v[162:163], v[150:151], v[150:151], v[162:163]
  v_pk_add_f32 v[154:155], v[154:155], v[150:151]
  v_add_f32 v152, v152, v153
  v_add_f32 v153, v160, v161
  v_add_f32 v154, v154, v155
  v_add_f32 v155, v162, v163
  v_mov_b32 v160, v152
  v_mov_b32 v161, v153
  v_mov_b32 v162, v154
  v_mov_b32 v163, v155
  s_nop 1
  v_permlane16_swap_b32 v160, v152
  v_permlane16_swap_b32 v161, v153
  v_permlane16_swap_b32 v162, v154
  v_permlane16_swap_b32 v163, v155
  s_nop 1
  v_add_f32 v152, v152, v160
  v_add_f32 v153, v153, v161
  v_add_f32 v154, v154, v162
  v_add_f32 v155, v155, v163
  v_mov_b32 v160, v152
  v_mov_b32 v161, v153
  v_mov_b32 v162, v154
  v_mov_b32 v163, v155
  s_nop 1
  v_permlane32_swap_b32 v160, v152
  v_permlane32_swap_b32 v161, v153
  v_permlane32_swap_b32 v162, v154
  v_permlane32_swap_b32 v163, v155
  s_nop 1
  v_add_f32 v152, v152, v160
  v_add_f32 v153, v153, v161
  v_add_f32 v154, v154, v162
  v_add_f32 v155, v155, v163
  v_mul_f32 v160, 0xbc800000, v152
  v_mul_f32 v161, 0xbc800000, v154
  v_fmac_f32 v153, v160, v152
  v_fmac_f32 v155, v161, v154
  v_and_or_b32 v156, v152, v81, s44
  v_and_or_b32 v157, v153, v81, s45
  v_and_or_b32 v158, v154, v81, s46
  v_and_or_b32 v159, v155, v81, s47
  s_mov_b64 exec, 0xffff
  buffer_store_dwordx4 v[156:159], v80, s[52:55], s57 offen sc1
  s_mov_b64 exec, -1
  s_add_u32 m0, s38, 0
  s_nop 0
  buffer_load_dwordx4 v225, s[8:11], s17 offen lds
  buffer_load_dwordx4 v226, s[8:11], s17 offen offset:1024 lds
  buffer_load_dwordx4 v227, s[8:11], s17 offen offset:2048 lds
  s_mov_b32 exec_hi, 0
  buffer_load_dwordx4 v228, s[8:11], s17 offen offset:3072 lds
  s_mov_b32 exec_hi, -1
  s_add_u32 s17, s17, 229376
  s_add_u32 m0, s38, 14336
  s_nop 0
  buffer_load_dwordx4 v225, s[8:11], s17 offen lds
  buffer_load_dwordx4 v226, s[8:11], s17 offen offset:1024 lds
  buffer_load_dwordx4 v227, s[8:11], s17 offen offset:2048 lds
  s_mov_b32 exec_hi, 0
  buffer_load_dwordx4 v228, s[8:11], s17 offen offset:3072 lds
  s_mov_b32 exec_hi, -1
  s_add_u32 s17, s17, 229376
  s_add_u32 m0, s38, 28672
  s_nop 0
  buffer_load_dwordx4 v225, s[8:11], s17 offen lds
  buffer_load_dwordx4 v226, s[8:11], s17 offen offset:1024 lds
  buffer_load_dwordx4 v227, s[8:11], s17 offen offset:2048 lds
  s_mov_b32 exec_hi, 0
  buffer_load_dwordx4 v228, s[8:11], s17 offen offset:3072 lds
  s_mov_b32 exec_hi, -1
  s_add_u32 s17, s17, 229376
  v_cvt_pk_bf16_f32 v48, v120, v121
  v_cvt_pk_bf16_f32 v49, v122, v123
  v_cvt_pk_bf16_f32 v50, v124, v125
  v_cvt_pk_bf16_f32 v51, v126, v127
  v_cvt_pk_bf16_f32 v52, v128, v129
  v_cvt_pk_bf16_f32 v53, v130, v131
  v_cvt_pk_bf16_f32 v54, v132, v133
  v_cvt_pk_bf16_f32 v55, v134, v135
  v_cvt_pk_bf16_f32 v56, v136, v137
  v_cvt_pk_bf16_f32 v57, v138, v139
  v_cvt_pk_bf16_f32 v58, v140, v141
  v_cvt_pk_bf16_f32 v59, v142, v143
  v_cvt_pk_bf16_f32 v60, v144, v145
  v_cvt_pk_bf16_f32 v61, v146, v147
  v_cvt_pk_bf16_f32 v62, v148, v149
  v_cvt_pk_bf16_f32 v63, v150, v151
  v_accvgpr_write_b32 a128, v48
  v_lshlrev_b32 v0, 16, v48
  v_and_b32 v1, 0xffff0000, v48
  v_accvgpr_write_b32 a129, v49
  v_lshlrev_b32 v2, 16, v49
  v_and_b32 v3, 0xffff0000, v49
  v_accvgpr_write_b32 a130, v50
  v_lshlrev_b32 v4, 16, v50
  v_and_b32 v5, 0xffff0000, v50
  v_accvgpr_write_b32 a131, v51
  v_lshlrev_b32 v6, 16, v51
  v_and_b32 v7, 0xffff0000, v51
  v_accvgpr_write_b32 a132, v52
  v_lshlrev_b32 v8, 16, v52
  v_and_b32 v9, 0xffff0000, v52
  v_accvgpr_write_b32 a133, v53
  v_lshlrev_b32 v10, 16, v53
  v_and_b32 v11, 0xffff0000, v53
  v_accvgpr_write_b32 a134, v54
  v_lshlrev_b32 v12, 16, v54
  v_and_b32 v13, 0xffff0000, v54
  v_accvgpr_write_b32 a135, v55
  v_lshlrev_b32 v14, 16, v55
  v_and_b32 v15, 0xffff0000, v55
  v_accvgpr_write_b32 a136, v56
  v_lshlrev_b32 v16, 16, v56
  v_and_b32 v17, 0xffff0000, v56
  v_accvgpr_write_b32 a137, v57
  v_lshlrev_b32 v18, 16, v57
  v_and_b32 v19, 0xffff0000, v57
  v_accvgpr_write_b32 a138, v58
  v_lshlrev_b32 v20, 16, v58
  v_and_b32 v21, 0xffff0000, v58
  v_accvgpr_write_b32 a139, v59
  v_lshlrev_b32 v22, 16, v59
  v_and_b32 v23, 0xffff0000, v59
  v_accvgpr_write_b32 a140, v60
  v_lshlrev_b32 v24, 16, v60
  v_and_b32 v25, 0xffff0000, v60
  v_accvgpr_write_b32 a141, v61
  v_lshlrev_b32 v26, 16, v61
  v_and_b32 v27, 0xffff0000, v61
  v_accvgpr_write_b32 a142, v62
  v_lshlrev_b32 v28, 16, v62
  v_and_b32 v29, 0xffff0000, v62
  v_accvgpr_write_b32 a143, v63
  v_lshlrev_b32 v30, 16, v63
  v_and_b32 v31, 0xffff0000, v63
  s_add_u32 s48, s20, 0xa00000
  s_addc_u32 s49, s21, 0
  s_mov_b32 s50, 0x400000
  s_mov_b32 s51, 0x20000
  s_mov_b32 s59, 262144
L_poll_17:
  buffer_load_dwordx4 v[88:91], v80, s[52:55], s56 offen offset:0 sc1
  buffer_load_dwordx4 v[92:95], v80, s[52:55], s56 offen offset:1024 sc1
  buffer_load_dwordx4 v[96:99], v80, s[52:55], s56 offen offset:2048 sc1
  buffer_load_dwordx4 v[100:103], v80, s[52:55], s56 offen offset:3072 sc1
  s_waitcnt vmcnt(3)
  v_xor_b32 v88, s44, v88
  v_xor_b32 v89, s45, v89
  v_xor_b32 v90, s46, v90
  v_xor_b32 v91, s47, v91
  v_or3_b32 v160, v88, v89, v90
  v_or_b32 v160, v160, v91
  s_waitcnt vmcnt(2)
  v_xor_b32 v92, s44, v92
  v_xor_b32 v93, s45, v93
  v_xor_b32 v94, s46, v94
  v_xor_b32 v95, s47, v95
  v_or3_b32 v160, v160, v92, v93
  v_or3_b32 v160, v160, v94, v95
  s_waitcnt vmcnt(1)
  v_xor_b32 v96, s44, v96
  v_xor_b32 v97, s45, v97
  v_xor_b32 v98, s46, v98
  v_xor_b32 v99, s47, v99
  v_or3_b32 v160, v160, v96, v97
  v_or3_b32 v160, v160, v98, v99
  s_waitcnt vmcnt(0)
  v_xor_b32 v100, s44, v100
  v_xor_b32 v101, s45, v101
  v_xor_b32 v102, s46, v102
  v_xor_b32 v103, s47, v103
  v_or3_b32 v160, v160, v100, v101
  v_or3_b32 v160, v160, v102, v103
  v_and_b32 v160, 0xff, v160
  v_cmp_ne_u32 vcc, 0, v160
  s_nop 1
  s_cmp_eq_u64 vcc, 0
  s_cbranch_scc1 L_ready_18
  s_sub_u32 s59, s59, 1
  s_cmp_lg_u32 s59, 0
  s_cbranch_scc1 L_poll_17
L_ready_18:
  v_mul_f32 v104, 0x3c800000, v88
  v_mul_f32 v105, 0x3c800000, v90
  v_mul_f32 v106, 0x3c800000, v92
  v_mul_f32 v107, 0x3c800000, v94
  v_mul_f32 v108, 0x3c800000, v96
  v_mul_f32 v109, 0x3c800000, v98
  v_mul_f32 v110, 0x3c800000, v100
  v_mul_f32 v111, 0x3c800000, v102
  v_fmac_f32 v89, v104, v88
  v_fmac_f32 v91, v105, v90
  v_fmac_f32 v93, v106, v92
  v_fmac_f32 v95, v107, v94
  v_fmac_f32 v97, v108, v96
  v_fmac_f32 v99, v109, v98
  v_fmac_f32 v101, v110, v100
  v_fmac_f32 v103, v111, v102
  v_pk_add_f32 v[152:153], v[88:89], v[92:93]
  v_pk_add_f32 v[160:161], v[96:97], v[100:101]
  v_pk_add_f32 v[154:155], v[90:91], v[94:95]
  v_pk_add_f32 v[162:163], v[98:99], v[102:103]
  v_pk_add_f32 v[152:153], v[152:153], v[160:161]
  v_pk_add_f32 v[154:155], v[154:155], v[162:163]
  v_mov_b32 v160, v152
  v_mov_b32 v161, v153
  v_mov_b32 v162, v154
  v_mov_b32 v163, v155
  s_nop 1
  v_permlane16_swap_b32 v160, v152
  v_permlane16_swap_b32 v161, v153
  v_permlane16_swap_b32 v162, v154
  v_permlane16_swap_b32 v163, v155
  s_nop 1
  v_add_f32 v152, v152, v160
  v_add_f32 v153, v153, v161
  v_add_f32 v154, v154, v162
  v_add_f32 v155, v155, v163
  v_mov_b32 v160, v152
  v_mov_b32 v161, v153
  v_mov_b32 v162, v154
  v_mov_b32 v163, v155
  s_nop 1
  v_permlane32_swap_b32 v160, v152
  v_permlane32_swap_b32 v161, v153
  v_permlane32_swap_b32 v162, v154
  v_permlane32_swap_b32 v163, v155
  s_nop 1
  v_add_f32 v152, v152, v160
  v_add_f32 v153, v153, v161
  v_add_f32 v154, v154, v162
  v_add_f32 v155, v155, v163
  v_mul_f32 v120, 0x3a800000, v152
  v_mul_f32 v124, 0x3a800000, v153
  v_mul_f32 v132, 0x3a800000, v154
  v_mul_f32 v136, 0x3a800000, v155
  v_fma_f32 v124, -v120, v120, v124
  v_fma_f32 v136, -v132, v132, v136
  v_max_f32 v124, 0, v124
  v_max_f32 v136, 0, v136
  v_cvt_pk_bf16_f32 v128, v120, v124
  v_lshlrev_b32 v120, 16, v128
  v_and_b32 v124, 0xffff0000, v128
  v_add_f32 v124, 0x3727c5ac, v124
  v_cvt_pk_bf16_f32 v128, v124, v125
  v_lshlrev_b32 v124, 16, v128
  v_and_b32 v125, 0xffff0000, v128
  v_sqrt_f32 v124, v124
  s_nop 0
  v_cvt_pk_bf16_f32 v128, v124, v125
  v_lshlrev_b32 v124, 16, v128
  v_and_b32 v125, 0xffff0000, v128
  v_rcp_f32 v124, v124
  v_mov_b32 v121, v120
  s_nop 0
  v_mov_b32 v125, v124
  v_cvt_pk_bf16_f32 v140, v132, v136
  v_lshlrev_b32 v132, 16, v140
  v_and_b32 v136, 0xffff0000, v140
  v_add_f32 v136, 0x3727c5ac, v136
  v_cvt_pk_bf16_f32 v140, v136, v137
  v_lshlrev_b32 v136, 16, v140
  v_and_b32 v137, 0xffff0000, v140
  v_sqrt_f32 v136, v136
  s_nop 0
  v_cvt_pk_bf16_f32 v140, v136, v137
  v_lshlrev_b32 v136, 16, v140
  v_and_b32 v137, 0xffff0000, v140
  v_rcp_f32 v136, v136
  v_mov_b32 v133, v132
  s_nop 0
  v_mov_b32 v137, v136
  v_pk_add_f32 v[0:1], v[0:1], v[120:121] neg_lo:[0,1] neg_hi:[0,1]
  v_pk_add_f32 v[2:3], v[2:3], v[120:121] neg_lo:[0,1] neg_hi:[0,1]
  v_pk_add_f32 v[4:5], v[4:5], v[120:121] neg_lo:[0,1] neg_hi:[0,1]
  v_pk_add_f32 v[6:7], v[6:7], v[120:121] neg_lo:[0,1] neg_hi:[0,1]
  v_pk_add_f32 v[8:9], v[8:9], v[120:121] neg_lo:[0,1] neg_hi:[0,1]
  v_pk_add_f32 v[10:11], v[10:11], v[120:121] neg_lo:[0,1] neg_hi:[0,1]
  v_pk_add_f32 v[12:13], v[12:13], v[120:121] neg_lo:[0,1] neg_hi:[0,1]
  v_pk_add_f32 v[14:15], v[14:15], v[120:121] neg_lo:[0,1] neg_hi:[0,1]
  v_pk_mul_f32 v[0:1], v[0:1], v[124:125]
  v_pk_mul_f32 v[2:3], v[2:3], v[124:125]
  v_pk_mul_f32 v[4:5], v[4:5], v[124:125]
  v_pk_mul_f32 v[6:7], v[6:7], v[124:125]
  v_pk_mul_f32 v[8:9], v[8:9], v[124:125]
  v_pk_mul_f32 v[10:11], v[10:11], v[124:125]
  v_pk_mul_f32 v[12:13], v[12:13], v[124:125]
  v_pk_mul_f32 v[14:15], v[14:15], v[124:125]
  v_pk_fma_f32 v[0:1], v[0:1], v[184:185], v[168:169]
  v_pk_fma_f32 v[2:3], v[2:3], v[186:187], v[170:171]
  v_pk_fma_f32 v[4:5], v[4:5], v[188:189], v[172:173]
  v_pk_fma_f32 v[6:7], v[6:7], v[190:191], v[174:175]
  v_pk_fma_f32 v[8:9], v[8:9], v[192:193], v[176:177]
  v_pk_fma_f32 v[10:11], v[10:11], v[194:195], v[178:179]
  v_pk_fma_f32 v[12:13], v[12:13], v[196:197], v[180:181]
  v_pk_fma_f32 v[14:15], v[14:15], v[198:199], v[182:183]
  v_cvt_pk_bf16_f32 v88, v0, v1
  v_cvt_pk_bf16_f32 v89, v2, v3
  v_cvt_pk_bf16_f32 v90, v4, v5
  v_cvt_pk_bf16_f32 v91, v6, v7
  v_cvt_pk_bf16_f32 v92, v8, v9
  v_cvt_pk_bf16_f32 v93, v10, v11
  v_cvt_pk_bf16_f32 v94, v12, v13
  v_cvt_pk_bf16_f32 v95, v14, v15
  buffer_store_dwordx4 v[88:91], v33, s[48:51], s41 offen offset:0 sc1
  buffer_store_dwordx4 v[92:95], v33, s[48:51], s42 offen offset:0 sc1
  v_pk_add_f32 v[16:17], v[16:17], v[132:133] neg_lo:[0,1] neg_hi:[0,1]
  v_pk_add_f32 v[18:19], v[18:19], v[132:133] neg_lo:[0,1] neg_hi:[0,1]
  v_pk_add_f32 v[20:21], v[20:21], v[132:133] neg_lo:[0,1] neg_hi:[0,1]
  v_pk_add_f32 v[22:23], v[22:23], v[132:133] neg_lo:[0,1] neg_hi:[0,1]
  v_pk_add_f32 v[24:25], v[24:25], v[132:133] neg_lo:[0,1] neg_hi:[0,1]
  v_pk_add_f32 v[26:27], v[26:27], v[132:133] neg_lo:[0,1] neg_hi:[0,1]
  v_pk_add_f32 v[28:29], v[28:29], v[132:133] neg_lo:[0,1] neg_hi:[0,1]
  v_pk_add_f32 v[30:31], v[30:31], v[132:133] neg_lo:[0,1] neg_hi:[0,1]
  v_pk_mul_f32 v[16:17], v[16:17], v[136:137]
  v_pk_mul_f32 v[18:19], v[18:19], v[136:137]
  v_pk_mul_f32 v[20:21], v[20:21], v[136:137]
  v_pk_mul_f32 v[22:23], v[22:23], v[136:137]
  v_pk_mul_f32 v[24:25], v[24:25], v[136:137]
  v_pk_mul_f32 v[26:27], v[26:27], v[136:137]
  v_pk_mul_f32 v[28:29], v[28:29], v[136:137]
  v_pk_mul_f32 v[30:31], v[30:31], v[136:137]
  v_pk_fma_f32 v[16:17], v[16:17], v[184:185], v[168:169]
  v_pk_fma_f32 v[18:19], v[18:19], v[186:187], v[170:171]
  v_pk_fma_f32 v[20:21], v[20:21], v[188:189], v[172:173]
  v_pk_fma_f32 v[22:23], v[22:23], v[190:191], v[174:175]
  v_pk_fma_f32 v[24:25], v[24:25], v[192:193], v[176:177]
  v_pk_fma_f32 v[26:27], v[26:27], v[194:195], v[178:179]
  v_pk_fma_f32 v[28:29], v[28:29], v[196:197], v[180:181]
  v_pk_fma_f32 v[30:31], v[30:31], v[198:199], v[182:183]
  v_cvt_pk_bf16_f32 v96, v16, v17
  v_cvt_pk_bf16_f32 v97, v18, v19
  v_cvt_pk_bf16_f32 v98, v20, v21
  v_cvt_pk_bf16_f32 v99, v22, v23
  v_cvt_pk_bf16_f32 v100, v24, v25
  v_cvt_pk_bf16_f32 v101, v26, v27
  v_cvt_pk_bf16_f32 v102, v28, v29
  v_cvt_pk_bf16_f32 v103, v30, v31
  buffer_store_dwordx4 v[96:99], v33, s[48:51], s41 offen offset:1024 sc1
  buffer_store_dwordx4 v[100:103], v33, s[48:51], s42 offen offset:1024 sc1
  s_add_u32 s64, s20, 0xb0000
  s_addc_u32 s65, s21, 0
  s_mov_b32 s66, 0x10000
  s_mov_b32 s67, 0x20000
  s_lshl_b32 s32, s30, 2
  s_add_u32 s32, s32, s3
  s_lshl_b32 s32, s32, 4
  s_add_u32 s32, s32, s31
  s_lshl_b32 s32, s32, 6
  s_mov_b32 s30, s94
  s_mov_b32 s31, s95
  s_lshl_b32 s33, s30, 2
  s_add_u32 s33, s33, s3
  s_lshl_b32 s68, s33, 11
  v_lshlrev_b32 v250, 2, v231
  v_mov_b32 v248, s19
  v_and_b32 v246, 31, v231
  v_and_b32 v245, 17, v246
  v_lshlrev_b32 v245, 6, v245
  v_lshlrev_b32 v246, 6, v246
  s_mov_b64 s[24:25], s[60:61]
  s_mov_b64 s[26:27], s[62:63]
  s_add_u32 s4, s20, 0xa00000
  s_addc_u32 s5, s21, 0
  s_mov_b32 s6, 0x400000
  s_mov_b32 s7, 0x20000
  s_mov_b32 s16, 0
  s_waitcnt vmcnt(0)
  s_mov_b64 exec, 1
  buffer_store_dword v248, v250, s[64:67], s32 offen sc1
  s_mov_b64 exec, -1
  s_mov_b32 s34, 262144
L_spin_19:
  buffer_load_dword v247, v245, s[64:67], s68 offen sc1
  s_waitcnt vmcnt(0)
  v_cmp_ne_u32 vcc, s19, v247
  s_nop 1
  s_cmp_eq_u64 vcc, 0
  s_cbranch_scc1 L_rdy_20
  s_sub_u32 s34, s34, 1
  s_cmp_lg_u32 s34, 0
  s_cbranch_scc1 L_spin_19
L_rdy_20:
  buffer_load_dwordx4 a[0:3], v224, s[4:7], s16 offen offset:0 sc1
  buffer_load_dwordx4 a[4:7], v224, s[4:7], s16 offen offset:1024 sc1
  buffer_load_dwordx4 a[8:11], v224, s[4:7], s16 offen offset:2048 sc1
  buffer_load_dwordx4 a[12:15], v224, s[4:7], s16 offen offset:3072 sc1
  s_add_u32 s16, s16, 131072
  buffer_load_dwordx4 a[16:19], v224, s[4:7], s16 offen offset:0 sc1
  buffer_load_dwordx4 a[20:23], v224, s[4:7], s16 offen offset:1024 sc1
  buffer_load_dwordx4 a[24:27], v224, s[4:7], s16 offen offset:2048 sc1
  buffer_load_dwordx4 a[28:31], v224, s[4:7], s16 offen offset:3072 sc1
  s_add_u32 s16, s16, 131072
  s_bitcmp1_b32 s3, 0
  s_cselect_b32 s52, s26, s24
  s_cselect_b32 s53, s27, s25
  s_cselect_b32 s60, 3670016, 0
  s_mov_b32 s54, 7340032
  s_mov_b32 s55, 0x20000
  s_lshl_b32 s56, s2, 1
  s_lshr_b32 s59, s3, 1
  s_add_u32 s56, s56, s59
  s_lshl_b32 s56, s56, 10
  s_add_u32 s60, s60, s56
  s_add_u32 s56, s56, 1572864
  s_mov_b32 s59, 0
  v_lshrrev_b32 v249, 3, v231
  v_lshlrev_b32 v249, 7, v249
  v_and_b32 v251, 1, v231
  v_lshl_add_u32 v249, v251, 19, v249
  s_add_u32 s12, s20, 0x1600000
  s_addc_u32 s13, s21, 0
  s_mov_b32 s14, 0xe00000
  s_mov_b32 s15, 0x20000
  v_lshrrev_b32 v234, 2, v231
  v_mul_u32_u24 v234, 224, v234
  v_and_b32 v235, 3, v231
  v_lshl_add_u32 v229, v235, 3, v234
  v_add_u32 v230, 57344, v229
  s_waitcnt vmcnt(16)
  s_barrier
  ds_read_b64_tr_b16 a[64:65], v229 offset:0
  ds_read_b64_tr_b16 a[66:67], v229 offset:3584
  ds_read_b64_tr_b16 a[68:69], v229 offset:32
  ds_read_b64_tr_b16 a[70:71], v229 offset:3616
  ds_read_b64_tr_b16 a[72:73], v229 offset:64
  ds_read_b64_tr_b16 a[74:75], v229 offset:3648
  ds_read_b64_tr_b16 a[76:77], v229 offset:96
  ds_read_b64_tr_b16 a[78:79], v229 offset:3680
  ds_read_b64_tr_b16 a[80:81], v229 offset:128
  ds_read_b64_tr_b16 a[82:83], v229 offset:3712
  ds_read_b64_tr_b16 a[84:85], v229 offset:160
  ds_read_b64_tr_b16 a[86:87], v229 offset:3744
  ds_read_b64_tr_b16 a[88:89], v229 offset:192
  ds_read_b64_tr_b16 a[90:91], v229 offset:3776
  ds_read_b64_tr_b16 a[92:93], v229 offset:7168
  ds_read_b64_tr_b16 a[94:95], v229 offset:10752
  ds_read_b64_tr_b16 a[96:97], v229 offset:7200
  ds_read_b64_tr_b16 a[98:99], v229 offset:10784
  ds_read_b64_tr_b16 a[100:101], v229 offset:7232
  ds_read_b64_tr_b16 a[102:103], v229 offset:10816
  ds_read_b64_tr_b16 a[104:105], v229 offset:7264
  ds_read_b64_tr_b16 a[106:107], v229 offset:10848
  ds_read_b64_tr_b16 a[108:109], v229 offset:7296
  ds_read_b64_tr_b16 a[110:111], v229 offset:10880
  ds_read_b64_tr_b16 a[112:113], v229 offset:7328
  ds_read_b64_tr_b16 a[114:115], v229 offset:10912
  ds_read_b64_tr_b16 a[116:117], v229 offset:7360
  ds_read_b64_tr_b16 a[118:119], v229 offset:10944
  s_waitcnt vmcnt(4) lgkmcnt(10)
  s_barrier
  buffer_load_dword v247, v246, s[64:67], s68 offen sc1
  v_mfma_f32_16x16x32_bf16 v[0:3], a[64:67], a[0:3], 0
  buffer_load_dwordx4 a[32:35], v224, s[4:7], s16 offen offset:0 sc1
  v_mfma_f32_16x16x32_bf16 v[56:59], a[64:67], a[4:7], 0
  v_mfma_f32_16x16x32_bf16 v[112:115], a[64:67], a[8:11], 0
  buffer_load_dwordx4 a[36:39], v224, s[4:7], s16 offen offset:1024 sc1
  v_mfma_f32_16x16x32_bf16 v[168:171], a[64:67], a[12:15], 0
  ds_read_b64_tr_b16 a[64:65], v229 offset:14336
  ds_read_b64_tr_b16 a[66:67], v229 offset:17920
  v_mfma_f32_16x16x32_bf16 v[4:7], a[68:71], a[0:3], 0
  buffer_load_dwordx4 a[40:43], v224, s[4:7], s16 offen offset:2048 sc1
  v_mfma_f32_16x16x32_bf16 v[60:63], a[68:71], a[4:7], 0
  v_mfma_f32_16x16x32_bf16 v[116:119], a[68:71], a[8:11], 0
  v_mfma_f32_16x16x32_bf16 v[172:175], a[68:71], a[12:15], 0
  buffer_load_dwordx4 a[44:47], v224, s[4:7], s16 offen offset:3072 sc1
  v_mfma_f32_16x16x32_bf16 v[8:11], a[72:75], a[0:3], 0
  ds_read_b64_tr_b16 a[68:69], v229 offset:14368
  ds_read_b64_tr_b16 a[70:71], v229 offset:17952
  v_mfma_f32_16x16x32_bf16 v[64:67], a[72:75], a[4:7], 0
  s_add_u32 s16, s16, 131072
  v_mfma_f32_16x16x32_bf16 v[120:123], a[72:75], a[8:11], 0
  v_mfma_f32_16x16x32_bf16 v[176:179], a[72:75], a[12:15], 0
  ds_read_b64_tr_b16 a[72:73], v229 offset:14400
  s_add_u32 m0, s38, 43008
  v_mfma_f32_16x16x32_bf16 v[12:15], a[76:79], a[0:3], 0
  ds_read_b64_tr_b16 a[74:75], v229 offset:17984
  v_mfma_f32_16x16x32_bf16 v[68:71], a[76:79], a[4:7], 0
  v_mfma_f32_16x16x32_bf16 v[124:127], a[76:79], a[8:11], 0
  buffer_load_dwordx4 v225, s[8:11], s17 offen lds
  v_mfma_f32_16x16x32_bf16 v[180:183], a[76:79], a[12:15], 0
  ds_read_b64_tr_b16 a[76:77], v229 offset:14432
  ds_read_b64_tr_b16 a[78:79], v229 offset:18016
  v_mfma_f32_16x16x32_bf16 v[16:19], a[80:83], a[0:3], 0
  buffer_load_dwordx4 v226, s[8:11], s17 offen offset:1024 lds
  v_mfma_f32_16x16x32_bf16 v[72:75], a[80:83], a[4:7], 0
  v_mfma_f32_16x16x32_bf16 v[128:131], a[80:83], a[8:11], 0
  v_mfma_f32_16x16x32_bf16 v[184:187], a[80:83], a[12:15], 0
  buffer_load_dwordx4 v227, s[8:11], s17 offen offset:2048 lds
  v_mfma_f32_16x16x32_bf16 v[20:23], a[84:87], a[0:3], 0
  ds_read_b64_tr_b16 a[80:81], v229 offset:14464
  ds_read_b64_tr_b16 a[82:83], v229 offset:18048
  v_mfma_f32_16x16x32_bf16 v[76:79], a[84:87], a[4:7], 0
  s_mov_b32 exec_hi, 0
  buffer_load_dwordx4 v228, s[8:11], s17 offen offset:3072 lds
  s_mov_b32 exec_hi, -1
  v_mfma_f32_16x16x32_bf16 v[132:135], a[84:87], a[8:11], 0
  v_mfma_f32_16x16x32_bf16 v[188:191], a[84:87], a[12:15], 0
  ds_read_b64_tr_b16 a[84:85], v229 offset:14496
  s_add_u32 s17, s17, 229376
  v_mfma_f32_16x16x32_bf16 v[24:27], a[88:91], a[0:3], 0
  ds_read_b64_tr_b16 a[86:87], v229 offset:18080
  v_mfma_f32_16x16x32_bf16 v[80:83], a[88:91], a[4:7], 0
  v_mfma_f32_16x16x32_bf16 v[136:139], a[88:91], a[8:11], 0
  buffer_load_dwordx4 a[48:51], v224, s[4:7], s16 offen offset:0 sc1
  v_mfma_f32_16x16x32_bf16 v[192:195], a[88:91], a[12:15], 0
  ds_read_b64_tr_b16 a[88:89], v229 offset:14528
  ds_read_b64_tr_b16 a[90:91], v229 offset:18112
  v_mfma_f32_16x16x32_bf16 v[28:31], a[92:95], a[0:3], 0
  buffer_load_dwordx4 a[52:55], v224, s[4:7], s16 offen offset:1024 sc1
  v_mfma_f32_16x16x32_bf16 v[84:87], a[92:95], a[4:7], 0
  v_mfma_f32_16x16x32_bf16 v[140:143], a[92:95], a[8:11], 0
  v_mfma_f32_16x16x32_bf16 v[196:199], a[92:95], a[12:15], 0
  buffer_load_dwordx4 a[56:59], v224, s[4:7], s16 offen offset:2048 sc1
  v_mfma_f32_16x16x32_bf16 v[32:35], a[96:99], a[0:3], 0
  ds_read_b64_tr_b16 a[92:93], v229 offset:21504
  ds_read_b64_tr_b16 a[94:95], v229 offset:25088
  v_mfma_f32_16x16x32_bf16 v[88:91], a[96:99], a[4:7], 0
  buffer_load_dwordx4 a[60:63], v224, s[4:7], s16 offen offset:3072 sc1
  v_mfma_f32_16x16x32_bf16 v[144:147], a[96:99], a[8:11], 0
  v_mfma_f32_16x16x32_bf16 v[200:203], a[96:99], a[12:15], 0
  ds_read_b64_tr_b16 a[96:97], v229 offset:21536
  s_add_u32 s16, s16, 131072
  s_waitcnt lgkmcnt(10)
  v_mfma_f32_16x16x32_bf16 v[36:39], a[100:103], a[0:3], 0
  ds_read_b64_tr_b16 a[98:99], v229 offset:25120
  v_mfma_f32_16x16x32_bf16 v[92:95], a[100:103], a[4:7], 0
  v_mfma_f32_16x16x32_bf16 v[148:151], a[100:103], a[8:11], 0
  buffer_load_dword v251, v249, s[52:55], s56 offen
  v_mfma_f32_16x16x32_bf16 v[204:207], a[100:103], a[12:15], 0
  ds_read_b64_tr_b16 a[100:101], v229 offset:21568
  ds_read_b64_tr_b16 a[102:103], v229 offset:25152
  v_mfma_f32_16x16x32_bf16 v[40:43], a[104:107], a[0:3], 0
  s_add_u32 s56, s56, 1048576
  v_mfma_f32_16x16x32_bf16 v[96:99], a[104:107], a[4:7], 0
  v_mfma_f32_16x16x32_bf16 v[152:155], a[104:107], a[8:11], 0
  v_mfma_f32_16x16x32_bf16 v[208:211], a[104:107], a[12:15], 0
  ds_read_b64_tr_b16 a[104:105], v229 offset:21600
  s_add_u32 s59, s59, 1
  v_mfma_f32_16x16x32_bf16 v[44:47], a[108:111], a[0:3], 0
  ds_read_b64_tr_b16 a[106:107], v229 offset:25184
  v_mfma_f32_16x16x32_bf16 v[100:103], a[108:111], a[4:7], 0
  s_cmp_eq_u32 s59, 6
  v_mfma_f32_16x16x32_bf16 v[156:159], a[108:111], a[8:11], 0
  v_mfma_f32_16x16x32_bf16 v[212:215], a[108:111], a[12:15], 0
  ds_read_b64_tr_b16 a[108:109], v229 offset:21632
  s_cselect_b32 s52, s22, s52
  v_mfma_f32_16x16x32_bf16 v[48:51], a[112:115], a[0:3], 0
  ds_read_b64_tr_b16 a[110:111], v229 offset:25216
  v_mfma_f32_16x16x32_bf16 v[104:107], a[112:115], a[4:7], 0
  v_mfma_f32_16x16x32_bf16 v[160:163], a[112:115], a[8:11], 0
  s_cselect_b32 s53, s23, s53
  v_mfma_f32_16x16x32_bf16 v[216:219], a[112:115], a[12:15], 0
  ds_read_b64_tr_b16 a[112:113], v229 offset:21664
  ds_read_b64_tr_b16 a[114:115], v229 offset:25248
  v_mfma_f32_16x16x32_bf16 v[52:55], a[116:119], a[0:3], 0
  s_cselect_b32 s56, s60, s56
  v_mfma_f32_16x16x32_bf16 v[108:111], a[116:119], a[4:7], 0
  v_mfma_f32_16x16x32_bf16 v[164:167], a[116:119], a[8:11], 0
  v_mfma_f32_16x16x32_bf16 v[220:223], a[116:119], a[12:15], 0
  s_waitcnt vmcnt(13) lgkmcnt(10)
  s_barrier
  v_cmp_ne_u32 vcc, s19, v247
  s_nop 1
  s_cmp_lg_u64 vcc, 0
  s_cbranch_scc1 L_slow_21
  L_back_22:
  v_mfma_f32_16x16x32_bf16 v[0:3], a[64:67], a[16:19], v[0:3]
  ds_read_b64_tr_b16 a[116:117], v229 offset:21696
  s_add_u32 m0, s38, 0
  v_mfma_f32_16x16x32_bf16 v[56:59], a[64:67], a[20:23], v[56:59]
  ds_read_b64_tr_b16 a[118:119], v229 offset:25280
  v_mfma_f32_16x16x32_bf16 v[112:115], a[64:67], a[24:27], v[112:115]
  v_mfma_f32_16x16x32_bf16 v[168:171], a[64:67], a[28:31], v[168:171]
  ds_read_b64_tr_b16 a[64:65], v229 offset:28672
  ds_read_b64_tr_b16 a[66:67], v229 offset:32256
  v_mfma_f32_16x16x32_bf16 v[4:7], a[68:71], a[16:19], v[4:7]
  v_mfma_f32_16x16x32_bf16 v[60:63], a[68:71], a[20:23], v[60:63]
  buffer_load_dwordx4 v225, s[8:11], s17 offen lds
  v_mfma_f32_16x16x32_bf16 v[116:119], a[68:71], a[24:27], v[116:119]
  v_mfma_f32_16x16x32_bf16 v[172:175], a[68:71], a[28:31], v[172:175]
  ds_read_b64_tr_b16 a[68:69], v229 offset:28704
  ds_read_b64_tr_b16 a[70:71], v229 offset:32288
  v_mfma_f32_16x16x32_bf16 v[8:11], a[72:75], a[16:19], v[8:11]
  v_mfma_f32_16x16x32_bf16 v[64:67], a[72:75], a[20:23], v[64:67]
  v_mfma_f32_16x16x32_bf16 v[120:123], a[72:75], a[24:27], v[120:123]
  buffer_load_dwordx4 v226, s[8:11], s17 offen offset:1024 lds
  v_mfma_f32_16x16x32_bf16 v[176:179], a[72:75], a[28:31], v[176:179]
  ds_read_b64_tr_b16 a[72:73], v229 offset:28736
  ds_read_b64_tr_b16 a[74:75], v229 offset:32320
  v_mfma_f32_16x16x32_bf16 v[12:15], a[76:79], a[16:19], v[12:15]
  v_mfma_f32_16x16x32_bf16 v[68:71], a[76:79], a[20:23], v[68:71]
  v_mfma_f32_16x16x32_bf16 v[124:127], a[76:79], a[24:27], v[124:127]
  v_mfma_f32_16x16x32_bf16 v[180:183], a[76:79], a[28:31], v[180:183]
  buffer_load_dwordx4 v227, s[8:11], s17 offen offset:2048 lds
  v_mfma_f32_16x16x32_bf16 v[16:19], a[80:83], a[16:19], v[16:19]
  ds_read_b64_tr_b16 a[76:77], v229 offset:28768
  ds_read_b64_tr_b16 a[78:79], v229 offset:32352
  v_mfma_f32_16x16x32_bf16 v[72:75], a[80:83], a[20:23], v[72:75]
  v_mfma_f32_16x16x32_bf16 v[128:131], a[80:83], a[24:27], v[128:131]
  v_mfma_f32_16x16x32_bf16 v[184:187], a[80:83], a[28:31], v[184:187]
  ds_read_b64_tr_b16 a[80:81], v229 offset:28800
  ds_read_b64_tr_b16 a[82:83], v229 offset:32384
  v_mfma_f32_16x16x32_bf16 v[20:23], a[84:87], a[16:19], v[20:23]
  s_mov_b32 exec_hi, 0
  buffer_load_dwordx4 v228, s[8:11], s17 offen offset:3072 lds
  s_mov_b32 exec_hi, -1
  v_mfma_f32_16x16x32_bf16 v[76:79], a[84:87], a[20:23], v[76:79]
  v_mfma_f32_16x16x32_bf16 v[132:135], a[84:87], a[24:27], v[132:135]
  v_mfma_f32_16x16x32_bf16 v[188:191], a[84:87], a[28:31], v[188:191]
  ds_read_b64_tr_b16 a[84:85], v229 offset:28832
  ds_read_b64_tr_b16 a[86:87], v229 offset:32416
  v_mfma_f32_16x16x32_bf16 v[24:27], a[88:91], a[16:19], v[24:27]
  v_mfma_f32_16x16x32_bf16 v[80:83], a[88:91], a[20:23], v[80:83]
  s_add_u32 s17, s17, 229376
  v_mfma_f32_16x16x32_bf16 v[136:139], a[88:91], a[24:27], v[136:139]
  v_mfma_f32_16x16x32_bf16 v[192:195], a[88:91], a[28:31], v[192:195]
  ds_read_b64_tr_b16 a[88:89], v229 offset:28864
  ds_read_b64_tr_b16 a[90:91], v229 offset:32448
  v_mfma_f32_16x16x32_bf16 v[28:31], a[92:95], a[16:19], v[28:31]
  v_mfma_f32_16x16x32_bf16 v[84:87], a[92:95], a[20:23], v[84:87]
  v_mfma_f32_16x16x32_bf16 v[140:143], a[92:95], a[24:27], v[140:143]
  buffer_load_dwordx4 a[0:3], v224, s[4:7], s16 offen offset:0 sc1
  v_mfma_f32_16x16x32_bf16 v[196:199], a[92:95], a[28:31], v[196:199]
  ds_read_b64_tr_b16 a[92:93], v229 offset:35840
  ds_read_b64_tr_b16 a[94:95], v229 offset:39424
  s_waitcnt lgkmcnt(10)
  v_mfma_f32_16x16x32_bf16 v[32:35], a[96:99], a[16:19], v[32:35]
  v_mfma_f32_16x16x32_bf16 v[88:91], a[96:99], a[20:23], v[88:91]
  v_mfma_f32_16x16x32_bf16 v[144:147], a[96:99], a[24:27], v[144:147]
  v_mfma_f32_16x16x32_bf16 v[200:203], a[96:99], a[28:31], v[200:203]
  buffer_load_dwordx4 a[4:7], v224, s[4:7], s16 offen offset:1024 sc1
  v_mfma_f32_16x16x32_bf16 v[36:39], a[100:103], a[16:19], v[36:39]
  ds_read_b64_tr_b16 a[96:97], v229 offset:35872
  ds_read_b64_tr_b16 a[98:99], v229 offset:39456
  v_mfma_f32_16x16x32_bf16 v[92:95], a[100:103], a[20:23], v[92:95]
  v_mfma_f32_16x16x32_bf16 v[148:151], a[100:103], a[24:27], v[148:151]
  v_mfma_f32_16x16x32_bf16 v[204:207], a[100:103], a[28:31], v[204:207]
  ds_read_b64_tr_b16 a[100:101], v229 offset:35904
  ds_read_b64_tr_b16 a[102:103], v229 offset:39488
  v_mfma_f32_16x16x32_bf16 v[40:43], a[104:107], a[16:19], v[40:43]
  buffer_load_dwordx4 a[8:11], v224, s[4:7], s16 offen offset:2048 sc1
  v_mfma_f32_16x16x32_bf16 v[96:99], a[104:107], a[20:23], v[96:99]
  v_mfma_f32_16x16x32_bf16 v[152:155], a[104:107], a[24:27], v[152:155]
  v_mfma_f32_16x16x32_bf16 v[208:211], a[104:107], a[28:31], v[208:211]
  ds_read_b64_tr_b16 a[104:105], v229 offset:35936
  ds_read_b64_tr_b16 a[106:107], v229 offset:39520
  v_mfma_f32_16x16x32_bf16 v[44:47], a[108:111], a[16:19], v[44:47]
  v_mfma_f32_16x16x32_bf16 v[100:103], a[108:111], a[20:23], v[100:103]
  buffer_load_dwordx4 a[12:15], v224, s[4:7], s16 offen offset:3072 sc1
  v_mfma_f32_16x16x32_bf16 v[156:159], a[108:111], a[24:27], v[156:159]
  v_mfma_f32_16x16x32_bf16 v[212:215], a[108:111], a[28:31], v[212:215]
  ds_read_b64_tr_b16 a[108:109], v229 offset:35968
  ds_read_b64_tr_b16 a[110:111], v229 offset:39552
  v_mfma_f32_16x16x32_bf16 v[48:51], a[112:115], a[16:19], v[48:51]
  v_mfma_f32_16x16x32_bf16 v[104:107], a[112:115], a[20:23], v[104:107]
  v_mfma_f32_16x16x32_bf16 v[160:163], a[112:115], a[24:27], v[160:163]
  s_add_u32 s16, s16, 131072
  v_mfma_f32_16x16x32_bf16 v[216:219], a[112:115], a[28:31], v[216:219]
  ds_read_b64_tr_b16 a[112:113], v229 offset:36000
  ds_read_b64_tr_b16 a[114:115], v229 offset:39584
  v_mfma_f32_16x16x32_bf16 v[52:55], a[116:119], a[16:19], v[52:55]
  v_mfma_f32_16x16x32_bf16 v[108:111], a[116:119], a[20:23], v[108:111]
  v_mfma_f32_16x16x32_bf16 v[164:167], a[116:119], a[24:27], v[164:167]
  v_mfma_f32_16x16x32_bf16 v[220:223], a[116:119], a[28:31], v[220:223]
  s_mov_b32 s18, 5
  .p2align 6
L_loop_24:
  s_waitcnt vmcnt(13) lgkmcnt(10)
  s_barrier
  v_mfma_f32_16x16x32_bf16 v[0:3], a[64:67], a[32:35], v[0:3]
  ds_read_b64_tr_b16 a[116:117], v229 offset:36032
  s_add_u32 m0, s38, 14336
  v_mfma_f32_16x16x32_bf16 v[56:59], a[64:67], a[36:39], v[56:59]
  ds_read_b64_tr_b16 a[118:119], v229 offset:39616
  v_mfma_f32_16x16x32_bf16 v[112:115], a[64:67], a[40:43], v[112:115]
  v_mfma_f32_16x16x32_bf16 v[168:171], a[64:67], a[44:47], v[168:171]
  buffer_load_dwordx4 v225, s[8:11], s17 offen lds
  v_mfma_f32_16x16x32_bf16 v[4:7], a[68:71], a[32:35], v[4:7]
  ds_read_b64_tr_b16 a[64:65], v229 offset:43008
  ds_read_b64_tr_b16 a[66:67], v229 offset:46592
  v_mfma_f32_16x16x32_bf16 v[60:63], a[68:71], a[36:39], v[60:63]
  v_mfma_f32_16x16x32_bf16 v[116:119], a[68:71], a[40:43], v[116:119]
  buffer_load_dwordx4 v226, s[8:11], s17 offen offset:1024 lds
  v_mfma_f32_16x16x32_bf16 v[172:175], a[68:71], a[44:47], v[172:175]
  ds_read_b64_tr_b16 a[68:69], v229 offset:43040
  ds_read_b64_tr_b16 a[70:71], v229 offset:46624
  v_mfma_f32_16x16x32_bf16 v[8:11], a[72:75], a[32:35], v[8:11]
  v_mfma_f32_16x16x32_bf16 v[64:67], a[72:75], a[36:39], v[64:67]
  buffer_load_dwordx4 v227, s[8:11], s17 offen offset:2048 lds
  v_mfma_f32_16x16x32_bf16 v[120:123], a[72:75], a[40:43], v[120:123]
  v_mfma_f32_16x16x32_bf16 v[176:179], a[72:75], a[44:47], v[176:179]
  ds_read_b64_tr_b16 a[72:73], v229 offset:43072
  ds_read_b64_tr_b16 a[74:75], v229 offset:46656
  v_mfma_f32_16x16x32_bf16 v[12:15], a[76:79], a[32:35], v[12:15]
  s_mov_b32 exec_hi, 0
  buffer_load_dwordx4 v228, s[8:11], s17 offen offset:3072 lds
  s_mov_b32 exec_hi, -1
  v_mfma_f32_16x16x32_bf16 v[68:71], a[76:79], a[36:39], v[68:71]
  v_mfma_f32_16x16x32_bf16 v[124:127], a[76:79], a[40:43], v[124:127]
  v_mfma_f32_16x16x32_bf16 v[180:183], a[76:79], a[44:47], v[180:183]
  ds_read_b64_tr_b16 a[76:77], v229 offset:43104
  s_add_u32 s17, s17, 229376
  v_mfma_f32_16x16x32_bf16 v[16:19], a[80:83], a[32:35], v[16:19]
  ds_read_b64_tr_b16 a[78:79], v229 offset:46688
  v_mfma_f32_16x16x32_bf16 v[72:75], a[80:83], a[36:39], v[72:75]
  v_mfma_f32_16x16x32_bf16 v[128:131], a[80:83], a[40:43], v[128:131]
  buffer_load_dwordx4 a[16:19], v224, s[4:7], s16 offen offset:0 sc1
  v_mfma_f32_16x16x32_bf16 v[184:187], a[80:83], a[44:47], v[184:187]
  ds_read_b64_tr_b16 a[80:81], v229 offset:43136
  ds_read_b64_tr_b16 a[82:83], v229 offset:46720
  v_mfma_f32_16x16x32_bf16 v[20:23], a[84:87], a[32:35], v[20:23]
  v_mfma_f32_16x16x32_bf16 v[76:79], a[84:87], a[36:39], v[76:79]
  buffer_load_dwordx4 a[20:23], v224, s[4:7], s16 offen offset:1024 sc1
  v_mfma_f32_16x16x32_bf16 v[132:135], a[84:87], a[40:43], v[132:135]
  v_mfma_f32_16x16x32_bf16 v[188:191], a[84:87], a[44:47], v[188:191]
  ds_read_b64_tr_b16 a[84:85], v229 offset:43168
  ds_read_b64_tr_b16 a[86:87], v229 offset:46752
  v_mfma_f32_16x16x32_bf16 v[24:27], a[88:91], a[32:35], v[24:27]
  buffer_load_dwordx4 a[24:27], v224, s[4:7], s16 offen offset:2048 sc1
  v_mfma_f32_16x16x32_bf16 v[80:83], a[88:91], a[36:39], v[80:83]
  v_mfma_f32_16x16x32_bf16 v[136:139], a[88:91], a[40:43], v[136:139]
  v_mfma_f32_16x16x32_bf16 v[192:195], a[88:91], a[44:47], v[192:195]
  buffer_load_dwordx4 a[28:31], v224, s[4:7], s16 offen offset:3072 sc1
  v_mfma_f32_16x16x32_bf16 v[28:31], a[92:95], a[32:35], v[28:31]
  ds_read_b64_tr_b16 a[88:89], v229 offset:43200
  ds_read_b64_tr_b16 a[90:91], v229 offset:46784
  v_mfma_f32_16x16x32_bf16 v[84:87], a[92:95], a[36:39], v[84:87]
  v_mfma_f32_16x16x32_bf16 v[140:143], a[92:95], a[40:43], v[140:143]
  s_add_u32 s16, s16, 131072
  v_mfma_f32_16x16x32_bf16 v[196:199], a[92:95], a[44:47], v[196:199]
  ds_read_b64_tr_b16 a[92:93], v229 offset:50176
  ds_read_b64_tr_b16 a[94:95], v229 offset:53760
  s_waitcnt lgkmcnt(10)
  v_mfma_f32_16x16x32_bf16 v[32:35], a[96:99], a[32:35], v[32:35]
  v_mfma_f32_16x16x32_bf16 v[88:91], a[96:99], a[36:39], v[88:91]
  buffer_load_dword v251, v249, s[52:55], s56 offen
  v_mfma_f32_16x16x32_bf16 v[144:147], a[96:99], a[40:43], v[144:147]
  v_mfma_f32_16x16x32_bf16 v[200:203], a[96:99], a[44:47], v[200:203]
  ds_read_b64_tr_b16 a[96:97], v229 offset:50208
  ds_read_b64_tr_b16 a[98:99], v229 offset:53792
  v_mfma_f32_16x16x32_bf16 v[36:39], a[100:103], a[32:35], v[36:39]
  s_add_u32 s56, s56, 1048576
  v_mfma_f32_16x16x32_bf16 v[92:95], a[100:103], a[36:39], v[92:95]
  v_mfma_f32_16x16x32_bf16 v[148:151], a[100:103], a[40:43], v[148:151]
  v_mfma_f32_16x16x32_bf16 v[204:207], a[100:103], a[44:47], v[204:207]
  ds_read_b64_tr_b16 a[100:101], v229 offset:50240
  s_add_u32 s59, s59, 1
  v_mfma_f32_16x16x32_bf16 v[40:43], a[104:107], a[32:35], v[40:43]
  ds_read_b64_tr_b16 a[102:103], v229 offset:53824
  v_mfma_f32_16x16x32_bf16 v[96:99], a[104:107], a[36:39], v[96:99]
  v_mfma_f32_16x16x32_bf16 v[152:155], a[104:107], a[40:43], v[152:155]
  s_cmp_eq_u32 s59, 6
  v_mfma_f32_16x16x32_bf16 v[208:211], a[104:107], a[44:47], v[208:211]
  ds_read_b64_tr_b16 a[104:105], v229 offset:50272
  ds_read_b64_tr_b16 a[106:107], v229 offset:53856
  v_mfma_f32_16x16x32_bf16 v[44:47], a[108:111], a[32:35], v[44:47]
  v_mfma_f32_16x16x32_bf16 v[100:103], a[108:111], a[36:39], v[100:103]
  s_cselect_b32 s52, s22, s52
  v_mfma_f32_16x16x32_bf16 v[156:159], a[108:111], a[40:43], v[156:159]
  v_mfma_f32_16x16x32_bf16 v[212:215], a[108:111], a[44:47], v[212:215]
  ds_read_b64_tr_b16 a[108:109], v229 offset:50304
  ds_read_b64_tr_b16 a[110:111], v229 offset:53888
  v_mfma_f32_16x16x32_bf16 v[48:51], a[112:115], a[32:35], v[48:51]
  s_cselect_b32 s53, s23, s53
  v_mfma_f32_16x16x32_bf16 v[104:107], a[112:115], a[36:39], v[104:107]
  v_mfma_f32_16x16x32_bf16 v[160:163], a[112:115], a[40:43], v[160:163]
  v_mfma_f32_16x16x32_bf16 v[216:219], a[112:115], a[44:47], v[216:219]
  ds_read_b64_tr_b16 a[112:113], v229 offset:50336
  s_cselect_b32 s56, s60, s56
  v_mfma_f32_16x16x32_bf16 v[52:55], a[116:119], a[32:35], v[52:55]
  ds_read_b64_tr_b16 a[114:115], v229 offset:53920
  v_mfma_f32_16x16x32_bf16 v[108:111], a[116:119], a[36:39], v[108:111]
  v_mfma_f32_16x16x32_bf16 v[164:167], a[116:119], a[40:43], v[164:167]
  v_mfma_f32_16x16x32_bf16 v[220:223], a[116:119], a[44:47], v[220:223]
  s_waitcnt vmcnt(13) lgkmcnt(10)
  s_barrier
  v_mfma_f32_16x16x32_bf16 v[0:3], a[64:67], a[48:51], v[0:3]
  ds_read_b64_tr_b16 a[116:117], v229 offset:50368
  s_add_u32 m0, s38, 28672
  v_mfma_f32_16x16x32_bf16 v[56:59], a[64:67], a[52:55], v[56:59]
  ds_read_b64_tr_b16 a[118:119], v229 offset:53952
  v_mfma_f32_16x16x32_bf16 v[112:115], a[64:67], a[56:59], v[112:115]
  v_mfma_f32_16x16x32_bf16 v[168:171], a[64:67], a[60:63], v[168:171]
  ds_read_b64_tr_b16 a[64:65], v229 offset:0
  ds_read_b64_tr_b16 a[66:67], v229 offset:3584
  v_mfma_f32_16x16x32_bf16 v[4:7], a[68:71], a[48:51], v[4:7]
  v_mfma_f32_16x16x32_bf16 v[60:63], a[68:71], a[52:55], v[60:63]
  buffer_load_dwordx4 v225, s[8:11], s17 offen lds
  v_mfma_f32_16x16x32_bf16 v[116:119], a[68:71], a[56:59], v[116:119]
  v_mfma_f32_16x16x32_bf16 v[172:175], a[68:71], a[60:63], v[172:175]
  ds_read_b64_tr_b16 a[68:69], v229 offset:32
  ds_read_b64_tr_b16 a[70:71], v229 offset:3616
  v_mfma_f32_16x16x32_bf16 v[8:11], a[72:75], a[48:51], v[8:11]
  v_mfma_f32_16x16x32_bf16 v[64:67], a[72:75], a[52:55], v[64:67]
  v_mfma_f32_16x16x32_bf16 v[120:123], a[72:75], a[56:59], v[120:123]
  buffer_load_dwordx4 v226, s[8:11], s17 offen offset:1024 lds
  v_mfma_f32_16x16x32_bf16 v[176:179], a[72:75], a[60:63], v[176:179]
  ds_read_b64_tr_b16 a[72:73], v229 offset:64
  ds_read_b64_tr_b16 a[74:75], v229 offset:3648
  v_mfma_f32_16x16x32_bf16 v[12:15], a[76:79], a[48:51], v[12:15]
  v_mfma_f32_16x16x32_bf16 v[68:71], a[76:79], a[52:55], v[68:71]
  v_mfma_f32_16x16x32_bf16 v[124:127], a[76:79], a[56:59], v[124:127]
  v_mfma_f32_16x16x32_bf16 v[180:183], a[76:79], a[60:63], v[180:183]
  buffer_load_dwordx4 v227, s[8:11], s17 offen offset:2048 lds
  v_mfma_f32_16x16x32_bf16 v[16:19], a[80:83], a[48:51], v[16:19]
  ds_read_b64_tr_b16 a[76:77], v229 offset:96
  ds_read_b64_tr_b16 a[78:79], v229 offset:3680
  v_mfma_f32_16x16x32_bf16 v[72:75], a[80:83], a[52:55], v[72:75]
  v_mfma_f32_16x16x32_bf16 v[128:131], a[80:83], a[56:59], v[128:131]
  v_mfma_f32_16x16x32_bf16 v[184:187], a[80:83], a[60:63], v[184:187]
  ds_read_b64_tr_b16 a[80:81], v229 offset:128
  ds_read_b64_tr_b16 a[82:83], v229 offset:3712
  v_mfma_f32_16x16x32_bf16 v[20:23], a[84:87], a[48:51], v[20:23]
  s_mov_b32 exec_hi, 0
  buffer_load_dwordx4 v228, s[8:11], s17 offen offset:3072 lds
  s_mov_b32 exec_hi, -1
  v_mfma_f32_16x16x32_bf16 v[76:79], a[84:87], a[52:55], v[76:79]
  v_mfma_f32_16x16x32_bf16 v[132:135], a[84:87], a[56:59], v[132:135]
  v_mfma_f32_16x16x32_bf16 v[188:191], a[84:87], a[60:63], v[188:191]
  ds_read_b64_tr_b16 a[84:85], v229 offset:160
  ds_read_b64_tr_b16 a[86:87], v229 offset:3744
  v_mfma_f32_16x16x32_bf16 v[24:27], a[88:91], a[48:51], v[24:27]
  v_mfma_f32_16x16x32_bf16 v[80:83], a[88:91], a[52:55], v[80:83]
  s_add_u32 s17, s17, 229376
  v_mfma_f32_16x16x32_bf16 v[136:139], a[88:91], a[56:59], v[136:139]
  v_mfma_f32_16x16x32_bf16 v[192:195], a[88:91], a[60:63], v[192:195]
  ds_read_b64_tr_b16 a[88:89], v229 offset:192
  ds_read_b64_tr_b16 a[90:91], v229 offset:3776
  v_mfma_f32_16x16x32_bf16 v[28:31], a[92:95], a[48:51], v[28:31]
  v_mfma_f32_16x16x32_bf16 v[84:87], a[92:95], a[52:55], v[84:87]
  v_mfma_f32_16x16x32_bf16 v[140:143], a[92:95], a[56:59], v[140:143]
  buffer_load_dwordx4 a[32:35], v224, s[4:7], s16 offen offset:0 sc1
  v_mfma_f32_16x16x32_bf16 v[196:199], a[92:95], a[60:63], v[196:199]
  ds_read_b64_tr_b16 a[92:93], v229 offset:7168
  ds_read_b64_tr_b16 a[94:95], v229 offset:10752
  s_waitcnt lgkmcnt(10)
  v_mfma_f32_16x16x32_bf16 v[32:35], a[96:99], a[48:51], v[32:35]
  v_mfma_f32_16x16x32_bf16 v[88:91], a[96:99], a[52:55], v[88:91]
  v_mfma_f32_16x16x32_bf16 v[144:147], a[96:99], a[56:59], v[144:147]
  v_mfma_f32_16x16x32_bf16 v[200:203], a[96:99], a[60:63], v[200:203]
  buffer_load_dwordx4 a[36:39], v224, s[4:7], s16 offen offset:1024 sc1
  v_mfma_f32_16x16x32_bf16 v[36:39], a[100:103], a[48:51], v[36:39]
  ds_read_b64_tr_b16 a[96:97], v229 offset:7200
  ds_read_b64_tr_b16 a[98:99], v229 offset:10784
  v_mfma_f32_16x16x32_bf16 v[92:95], a[100:103], a[52:55], v[92:95]
  v_mfma_f32_16x16x32_bf16 v[148:151], a[100:103], a[56:59], v[148:151]
  v_mfma_f32_16x16x32_bf16 v[204:207], a[100:103], a[60:63], v[204:207]
  ds_read_b64_tr_b16 a[100:101], v229 offset:7232
  ds_read_b64_tr_b16 a[102:103], v229 offset:10816
  v_mfma_f32_16x16x32_bf16 v[40:43], a[104:107], a[48:51], v[40:43]
  buffer_load_dwordx4 a[40:43], v224, s[4:7], s16 offen offset:2048 sc1
  v_mfma_f32_16x16x32_bf16 v[96:99], a[104:107], a[52:55], v[96:99]
  v_mfma_f32_16x16x32_bf16 v[152:155], a[104:107], a[56:59], v[152:155]
  v_mfma_f32_16x16x32_bf16 v[208:211], a[104:107], a[60:63], v[208:211]
  ds_read_b64_tr_b16 a[104:105], v229 offset:7264
  ds_read_b64_tr_b16 a[106:107], v229 offset:10848
  v_mfma_f32_16x16x32_bf16 v[44:47], a[108:111], a[48:51], v[44:47]
  v_mfma_f32_16x16x32_bf16 v[100:103], a[108:111], a[52:55], v[100:103]
  buffer_load_dwordx4 a[44:47], v224, s[4:7], s16 offen offset:3072 sc1
  v_mfma_f32_16x16x32_bf16 v[156:159], a[108:111], a[56:59], v[156:159]
  v_mfma_f32_16x16x32_bf16 v[212:215], a[108:111], a[60:63], v[212:215]
  ds_read_b64_tr_b16 a[108:109], v229 offset:7296
  ds_read_b64_tr_b16 a[110:111], v229 offset:10880
  v_mfma_f32_16x16x32_bf16 v[48:51], a[112:115], a[48:51], v[48:51]
  v_mfma_f32_16x16x32_bf16 v[104:107], a[112:115], a[52:55], v[104:107]
  v_mfma_f32_16x16x32_bf16 v[160:163], a[112:115], a[56:59], v[160:163]
  s_add_u32 s16, s16, 131072
  v_mfma_f32_16x16x32_bf16 v[216:219], a[112:115], a[60:63], v[216:219]
  ds_read_b64_tr_b16 a[112:113], v229 offset:7328
  ds_read_b64_tr_b16 a[114:115], v229 offset:10912
  v_mfma_f32_16x16x32_bf16 v[52:55], a[116:119], a[48:51], v[52:55]
  v_mfma_f32_16x16x32_bf16 v[108:111], a[116:119], a[52:55], v[108:111]
  v_mfma_f32_16x16x32_bf16 v[164:167], a[116:119], a[56:59], v[164:167]
  v_mfma_f32_16x16x32_bf16 v[220:223], a[116:119], a[60:63], v[220:223]
  s_waitcnt vmcnt(13) lgkmcnt(10)
  s_barrier
  v_mfma_f32_16x16x32_bf16 v[0:3], a[64:67], a[0:3], v[0:3]
  ds_read_b64_tr_b16 a[116:117], v229 offset:7360
  s_add_u32 m0, s38, 43008
  v_mfma_f32_16x16x32_bf16 v[56:59], a[64:67], a[4:7], v[56:59]
  ds_read_b64_tr_b16 a[118:119], v229 offset:10944
  v_mfma_f32_16x16x32_bf16 v[112:115], a[64:67], a[8:11], v[112:115]
  v_mfma_f32_16x16x32_bf16 v[168:171], a[64:67], a[12:15], v[168:171]
  buffer_load_dwordx4 v225, s[8:11], s17 offen lds
  v_mfma_f32_16x16x32_bf16 v[4:7], a[68:71], a[0:3], v[4:7]
  ds_read_b64_tr_b16 a[64:65], v229 offset:14336
  ds_read_b64_tr_b16 a[66:67], v229 offset:17920
  v_mfma_f32_16x16x32_bf16 v[60:63], a[68:71], a[4:7], v[60:63]
  v_mfma_f32_16x16x32_bf16 v[116:119], a[68:71], a[8:11], v[116:119]
  buffer_load_dwordx4 v226, s[8:11], s17 offen offset:1024 lds
  v_mfma_f32_16x16x32_bf16 v[172:175], a[68:71], a[12:15], v[172:175]
  ds_read_b64_tr_b16 a[68:69], v229 offset:14368
  ds_read_b64_tr_b16 a[70:71], v229 offset:17952
  v_mfma_f32_16x16x32_bf16 v[8:11], a[72:75], a[0:3], v[8:11]
  v_mfma_f32_16x16x32_bf16 v[64:67], a[72:75], a[4:7], v[64:67]
  buffer_load_dwordx4 v227, s[8:11], s17 offen offset:2048 lds
  v_mfma_f32_16x16x32_bf16 v[120:123], a[72:75], a[8:11], v[120:123]
  v_mfma_f32_16x16x32_bf16 v[176:179], a[72:75], a[12:15], v[176:179]
  ds_read_b64_tr_b16 a[72:73], v229 offset:14400
  ds_read_b64_tr_b16 a[74:75], v229 offset:17984
  v_mfma_f32_16x16x32_bf16 v[12:15], a[76:79], a[0:3], v[12:15]
  s_mov_b32 exec_hi, 0
  buffer_load_dwordx4 v228, s[8:11], s17 offen offset:3072 lds
  s_mov_b32 exec_hi, -1
  v_mfma_f32_16x16x32_bf16 v[68:71], a[76:79], a[4:7], v[68:71]
  v_mfma_f32_16x16x32_bf16 v[124:127], a[76:79], a[8:11], v[124:127]
  v_mfma_f32_16x16x32_bf16 v[180:183], a[76:79], a[12:15], v[180:183]
  ds_read_b64_tr_b16 a[76:77], v229 offset:14432
  s_add_u32 s17, s17, 229376
  v_mfma_f32_16x16x32_bf16 v[16:19], a[80:83], a[0:3], v[16:19]
  ds_read_b64_tr_b16 a[78:79], v229 offset:18016
  v_mfma_f32_16x16x32_bf16 v[72:75], a[80:83], a[4:7], v[72:75]
  v_mfma_f32_16x16x32_bf16 v[128:131], a[80:83], a[8:11], v[128:131]
  buffer_load_dwordx4 a[48:51], v224, s[4:7], s16 offen offset:0 sc1
  v_mfma_f32_16x16x32_bf16 v[184:187], a[80:83], a[12:15], v[184:187]
  ds_read_b64_tr_b16 a[80:81], v229 offset:14464
  ds_read_b64_tr_b16 a[82:83], v229 offset:18048
  v_mfma_f32_16x16x32_bf16 v[20:23], a[84:87], a[0:3], v[20:23]
  v_mfma_f32_16x16x32_bf16 v[76:79], a[84:87], a[4:7], v[76:79]
  buffer_load_dwordx4 a[52:55], v224, s[4:7], s16 offen offset:1024 sc1
  v_mfma_f32_16x16x32_bf16 v[132:135], a[84:87], a[8:11], v[132:135]
  v_mfma_f32_16x16x32_bf16 v[188:191], a[84:87], a[12:15], v[188:191]
  ds_read_b64_tr_b16 a[84:85], v229 offset:14496
  ds_read_b64_tr_b16 a[86:87], v229 offset:18080
  v_mfma_f32_16x16x32_bf16 v[24:27], a[88:91], a[0:3], v[24:27]
  buffer_load_dwordx4 a[56:59], v224, s[4:7], s16 offen offset:2048 sc1
  v_mfma_f32_16x16x32_bf16 v[80:83], a[88:91], a[4:7], v[80:83]
  v_mfma_f32_16x16x32_bf16 v[136:139], a[88:91], a[8:11], v[136:139]
  v_mfma_f32_16x16x32_bf16 v[192:195], a[88:91], a[12:15], v[192:195]
  buffer_load_dwordx4 a[60:63], v224, s[4:7], s16 offen offset:3072 sc1
  v_mfma_f32_16x16x32_bf16 v[28:31], a[92:95], a[0:3], v[28:31]
  ds_read_b64_tr_b16 a[88:89], v229 offset:14528
  ds_read_b64_tr_b16 a[90:91], v229 offset:18112
  v_mfma_f32_16x16x32_bf16 v[84:87], a[92:95], a[4:7], v[84:87]
  v_mfma_f32_16x16x32_bf16 v[140:143], a[92:95], a[8:11], v[140:143]
  s_add_u32 s16, s16, 131072
  v_mfma_f32_16x16x32_bf16 v[196:199], a[92:95], a[12:15], v[196:199]
  ds_read_b64_tr_b16 a[92:93], v229 offset:21504
  ds_read_b64_tr_b16 a[94:95], v229 offset:25088
  s_waitcnt lgkmcnt(10)
  v_mfma_f32_16x16x32_bf16 v[32:35], a[96:99], a[0:3], v[32:35]
  v_mfma_f32_16x16x32_bf16 v[88:91], a[96:99], a[4:7], v[88:91]
  buffer_load_dword v251, v249, s[52:55], s56 offen
  v_mfma_f32_16x16x32_bf16 v[144:147], a[96:99], a[8:11], v[144:147]
  v_mfma_f32_16x16x32_bf16 v[200:203], a[96:99], a[12:15], v[200:203]
  ds_read_b64_tr_b16 a[96:97], v229 offset:21536
  ds_read_b64_tr_b16 a[98:99], v229 offset:25120
  v_mfma_f32_16x16x32_bf16 v[36:39], a[100:103], a[0:3], v[36:39]
  s_add_u32 s56, s56, 1048576
  v_mfma_f32_16x16x32_bf16 v[92:95], a[100:103], a[4:7], v[92:95]
  v_mfma_f32_16x16x32_bf16 v[148:151], a[100:103], a[8:11], v[148:151]
  v_mfma_f32_16x16x32_bf16 v[204:207], a[100:103], a[12:15], v[204:207]
  ds_read_b64_tr_b16 a[100:101], v229 offset:21568
  s_add_u32 s59, s59, 1
  v_mfma_f32_16x16x32_bf16 v[40:43], a[104:107], a[0:3], v[40:43]
  ds_read_b64_tr_b16 a[102:103], v229 offset:25152
  v_mfma_f32_16x16x32_bf16 v[96:99], a[104:107], a[4:7], v[96:99]
  v_mfma_f32_16x16x32_bf16 v[152:155], a[104:107], a[8:11], v[152:155]
  s_cmp_eq_u32 s59, 6
  v_mfma_f32_16x16x32_bf16 v[208:211], a[104:107], a[12:15], v[208:211]
  ds_read_b64_tr_b16 a[104:105], v229 offset:21600
  ds_read_b64_tr_b16 a[106:107], v229 offset:25184
  v_mfma_f32_16x16x32_bf16 v[44:47], a[108:111], a[0:3], v[44:47]
  v_mfma_f32_16x16x32_bf16 v[100:103], a[108:111], a[4:7], v[100:103]
  s_cselect_b32 s52, s22, s52
  v_mfma_f32_16x16x32_bf16 v[156:159], a[108:111], a[8:11], v[156:159]
  v_mfma_f32_16x16x32_bf16 v[212:215], a[108:111], a[12:15], v[212:215]
  ds_read_b64_tr_b16 a[108:109], v229 offset:21632
  ds_read_b64_tr_b16 a[110:111], v229 offset:25216
  v_mfma_f32_16x16x32_bf16 v[48:51], a[112:115], a[0:3], v[48:51]
  s_cselect_b32 s53, s23, s53
  v_mfma_f32_16x16x32_bf16 v[104:107], a[112:115], a[4:7], v[104:107]
  v_mfma_f32_16x16x32_bf16 v[160:163], a[112:115], a[8:11], v[160:163]
  v_mfma_f32_16x16x32_bf16 v[216:219], a[112:115], a[12:15], v[216:219]
  ds_read_b64_tr_b16 a[112:113], v229 offset:21664
  s_cselect_b32 s56, s60, s56
  v_mfma_f32_16x16x32_bf16 v[52:55], a[116:119], a[0:3], v[52:55]
  ds_read_b64_tr_b16 a[114:115], v229 offset:25248
  v_mfma_f32_16x16x32_bf16 v[108:111], a[116:119], a[4:7], v[108:111]
  v_mfma_f32_16x16x32_bf16 v[164:167], a[116:119], a[8:11], v[164:167]
  v_mfma_f32_16x16x32_bf16 v[220:223], a[116:119], a[12:15], v[220:223]
  s_waitcnt vmcnt(13) lgkmcnt(10)
  s_barrier
  v_mfma_f32_16x16x32_bf16 v[0:3], a[64:67], a[16:19], v[0:3]
  ds_read_b64_tr_b16 a[116:117], v229 offset:21696
  s_add_u32 m0, s38, 0
  v_mfma_f32_16x16x32_bf16 v[56:59], a[64:67], a[20:23], v[56:59]
  ds_read_b64_tr_b16 a[118:119], v229 offset:25280
  v_mfma_f32_16x16x32_bf16 v[112:115], a[64:67], a[24:27], v[112:115]
  v_mfma_f32_16x16x32_bf16 v[168:171], a[64:67], a[28:31], v[168:171]
  ds_read_b64_tr_b16 a[64:65], v229 offset:28672
  ds_read_b64_tr_b16 a[66:67], v229 offset:32256
  v_mfma_f32_16x16x32_bf16 v[4:7], a[68:71], a[16:19], v[4:7]
  v_mfma_f32_16x16x32_bf16 v[60:63], a[68:71], a[20:23], v[60:63]
  buffer_load_dwordx4 v225, s[8:11], s17 offen lds
  v_mfma_f32_16x16x32_bf16 v[116:119], a[68:71], a[24:27], v[116:119]
  v_mfma_f32_16x16x32_bf16 v[172:175], a[68:71], a[28:31], v[172:175]
  ds_read_b64_tr_b16 a[68:69], v229 offset:28704
  ds_read_b64_tr_b16 a[70:71], v229 offset:32288
  v_mfma_f32_16x16x32_bf16 v[8:11], a[72:75], a[16:19], v[8:11]
  v_mfma_f32_16x16x32_bf16 v[64:67], a[72:75], a[20:23], v[64:67]
  v_mfma_f32_16x16x32_bf16 v[120:123], a[72:75], a[24:27], v[120:123]
  buffer_load_dwordx4 v226, s[8:11], s17 offen offset:1024 lds
  v_mfma_f32_16x16x32_bf16 v[176:179], a[72:75], a[28:31], v[176:179]
  ds_read_b64_tr_b16 a[72:73], v229 offset:28736
  ds_read_b64_tr_b16 a[74:75], v229 offset:32320
  v_mfma_f32_16x16x32_bf16 v[12:15], a[76:79], a[16:19], v[12:15]
  v_mfma_f32_16x16x32_bf16 v[68:71], a[76:79], a[20:23], v[68:71]
  v_mfma_f32_16x16x32_bf16 v[124:127], a[76:79], a[24:27], v[124:127]
  v_mfma_f32_16x16x32_bf16 v[180:183], a[76:79], a[28:31], v[180:183]
  buffer_load_dwordx4 v227, s[8:11], s17 offen offset:2048 lds
  v_mfma_f32_16x16x32_bf16 v[16:19], a[80:83], a[16:19], v[16:19]
  ds_read_b64_tr_b16 a[76:77], v229 offset:28768
  ds_read_b64_tr_b16 a[78:79], v229 offset:32352
  v_mfma_f32_16x16x32_bf16 v[72:75], a[80:83], a[20:23], v[72:75]
  v_mfma_f32_16x16x32_bf16 v[128:131], a[80:83], a[24:27], v[128:131]
  v_mfma_f32_16x16x32_bf16 v[184:187], a[80:83], a[28:31], v[184:187]
  ds_read_b64_tr_b16 a[80:81], v229 offset:28800
  ds_read_b64_tr_b16 a[82:83], v229 offset:32384
  v_mfma_f32_16x16x32_bf16 v[20:23], a[84:87], a[16:19], v[20:23]
  s_mov_b32 exec_hi, 0
  buffer_load_dwordx4 v228, s[8:11], s17 offen offset:3072 lds
  s_mov_b32 exec_hi, -1
  v_mfma_f32_16x16x32_bf16 v[76:79], a[84:87], a[20:23], v[76:79]
  v_mfma_f32_16x16x32_bf16 v[132:135], a[84:87], a[24:27], v[132:135]
  v_mfma_f32_16x16x32_bf16 v[188:191], a[84:87], a[28:31], v[188:191]
  ds_read_b64_tr_b16 a[84:85], v229 offset:28832
  ds_read_b64_tr_b16 a[86:87], v229 offset:32416
  v_mfma_f32_16x16x32_bf16 v[24:27], a[88:91], a[16:19], v[24:27]
  v_mfma_f32_16x16x32_bf16 v[80:83], a[88:91], a[20:23], v[80:83]
  s_add_u32 s17, s17, 229376
  v_mfma_f32_16x16x32_bf16 v[136:139], a[88:91], a[24:27], v[136:139]
  v_mfma_f32_16x16x32_bf16 v[192:195], a[88:91], a[28:31], v[192:195]
  ds_read_b64_tr_b16 a[88:89], v229 offset:28864
  ds_read_b64_tr_b16 a[90:91], v229 offset:32448
  v_mfma_f32_16x16x32_bf16 v[28:31], a[92:95], a[16:19], v[28:31]
  v_mfma_f32_16x16x32_bf16 v[84:87], a[92:95], a[20:23], v[84:87]
  v_mfma_f32_16x16x32_bf16 v[140:143], a[92:95], a[24:27], v[140:143]
  buffer_load_dwordx4 a[0:3], v224, s[4:7], s16 offen offset:0 sc1
  v_mfma_f32_16x16x32_bf16 v[196:199], a[92:95], a[28:31], v[196:199]
  ds_read_b64_tr_b16 a[92:93], v229 offset:35840
  ds_read_b64_tr_b16 a[94:95], v229 offset:39424
  s_waitcnt lgkmcnt(10)
  v_mfma_f32_16x16x32_bf16 v[32:35], a[96:99], a[16:19], v[32:35]
  v_mfma_f32_16x16x32_bf16 v[88:91], a[96:99], a[20:23], v[88:91]
  v_mfma_f32_16x16x32_bf16 v[144:147], a[96:99], a[24:27], v[144:147]
  v_mfma_f32_16x16x32_bf16 v[200:203], a[96:99], a[28:31], v[200:203]
  buffer_load_dwordx4 a[4:7], v224, s[4:7], s16 offen offset:1024 sc1
  v_mfma_f32_16x16x32_bf16 v[36:39], a[100:103], a[16:19], v[36:39]
  ds_read_b64_tr_b16 a[96:97], v229 offset:35872
  ds_read_b64_tr_b16 a[98:99], v229 offset:39456
  v_mfma_f32_16x16x32_bf16 v[92:95], a[100:103], a[20:23], v[92:95]
  v_mfma_f32_16x16x32_bf16 v[148:151], a[100:103], a[24:27], v[148:151]
  v_mfma_f32_16x16x32_bf16 v[204:207], a[100:103], a[28:31], v[204:207]
  ds_read_b64_tr_b16 a[100:101], v229 offset:35904
  ds_read_b64_tr_b16 a[102:103], v229 offset:39488
  v_mfma_f32_16x16x32_bf16 v[40:43], a[104:107], a[16:19], v[40:43]
  buffer_load_dwordx4 a[8:11], v224, s[4:7], s16 offen offset:2048 sc1
  v_mfma_f32_16x16x32_bf16 v[96:99], a[104:107], a[20:23], v[96:99]
  v_mfma_f32_16x16x32_bf16 v[152:155], a[104:107], a[24:27], v[152:155]
  v_mfma_f32_16x16x32_bf16 v[208:211], a[104:107], a[28:31], v[208:211]
  ds_read_b64_tr_b16 a[104:105], v229 offset:35936
  ds_read_b64_tr_b16 a[106:107], v229 offset:39520
  v_mfma_f32_16x16x32_bf16 v[44:47], a[108:111], a[16:19], v[44:47]
  v_mfma_f32_16x16x32_bf16 v[100:103], a[108:111], a[20:23], v[100:103]
  buffer_load_dwordx4 a[12:15], v224, s[4:7], s16 offen offset:3072 sc1
  v_mfma_f32_16x16x32_bf16 v[156:159], a[108:111], a[24:27], v[156:159]
  v_mfma_f32_16x16x32_bf16 v[212:215], a[108:111], a[28:31], v[212:215]
  ds_read_b64_tr_b16 a[108:109], v229 offset:35968
  ds_read_b64_tr_b16 a[110:111], v229 offset:39552
  v_mfma_f32_16x16x32_bf16 v[48:51], a[112:115], a[16:19], v[48:51]
  v_mfma_f32_16x16x32_bf16 v[104:107], a[112:115], a[20:23], v[104:107]
  v_mfma_f32_16x16x32_bf16 v[160:163], a[112:115], a[24:27], v[160:163]
  s_add_u32 s16, s16, 131072
  v_mfma_f32_16x16x32_bf16 v[216:219], a[112:115], a[28:31], v[216:219]
  ds_read_b64_tr_b16 a[112:113], v229 offset:36000
  ds_read_b64_tr_b16 a[114:115], v229 offset:39584
  v_mfma_f32_16x16x32_bf16 v[52:55], a[116:119], a[16:19], v[52:55]
  v_mfma_f32_16x16x32_bf16 v[108:111], a[116:119], a[20:23], v[108:111]
  v_mfma_f32_16x16x32_bf16 v[164:167], a[116:119], a[24:27], v[164:167]
  v_mfma_f32_16x16x32_bf16 v[220:223], a[116:119], a[28:31], v[220:223]
  s_sub_u32 s18, s18, 1
  s_cmp_lg_u32 s18, 0
  s_cbranch_scc1 L_loop_24
  s_waitcnt vmcnt(13) lgkmcnt(10)
  s_barrier
  v_mfma_f32_16x16x32_bf16 v[0:3], a[64:67], a[32:35], v[0:3]
  ds_read_b64_tr_b16 a[116:117], v229 offset:36032
  s_add_u32 m0, s38, 14336
  v_mfma_f32_16x16x32_bf16 v[56:59], a[64:67], a[36:39], v[56:59]
  ds_read_b64_tr_b16 a[118:119], v229 offset:39616
  v_mfma_f32_16x16x32_bf16 v[112:115], a[64:67], a[40:43], v[112:115]
  v_mfma_f32_16x16x32_bf16 v[168:171], a[64:67], a[44:47], v[168:171]
  buffer_load_dwordx4 v225, s[8:11], s17 offen lds
  v_mfma_f32_16x16x32_bf16 v[4:7], a[68:71], a[32:35], v[4:7]
  ds_read_b64_tr_b16 a[64:65], v229 offset:43008
  ds_read_b64_tr_b16 a[66:67], v229 offset:46592
  v_mfma_f32_16x16x32_bf16 v[60:63], a[68:71], a[36:39], v[60:63]
  v_mfma_f32_16x16x32_bf16 v[116:119], a[68:71], a[40:43], v[116:119]
  buffer_load_dwordx4 v226, s[8:11], s17 offen offset:1024 lds
  v_mfma_f32_16x16x32_bf16 v[172:175], a[68:71], a[44:47], v[172:175]
  ds_read_b64_tr_b16 a[68:69], v229 offset:43040
  ds_read_b64_tr_b16 a[70:71], v229 offset:46624
  v_mfma_f32_16x16x32_bf16 v[8:11], a[72:75], a[32:35], v[8:11]
  v_mfma_f32_16x16x32_bf16 v[64:67], a[72:75], a[36:39], v[64:67]
  buffer_load_dwordx4 v227, s[8:11], s17 offen offset:2048 lds
  v_mfma_f32_16x16x32_bf16 v[120:123], a[72:75], a[40:43], v[120:123]
  v_mfma_f32_16x16x32_bf16 v[176:179], a[72:75], a[44:47], v[176:179]
  ds_read_b64_tr_b16 a[72:73], v229 offset:43072
  ds_read_b64_tr_b16 a[74:75], v229 offset:46656
  v_mfma_f32_16x16x32_bf16 v[12:15], a[76:79], a[32:35], v[12:15]
  s_mov_b32 exec_hi, 0
  buffer_load_dwordx4 v228, s[8:11], s17 offen offset:3072 lds
  s_mov_b32 exec_hi, -1
  v_mfma_f32_16x16x32_bf16 v[68:71], a[76:79], a[36:39], v[68:71]
  v_mfma_f32_16x16x32_bf16 v[124:127], a[76:79], a[40:43], v[124:127]
  v_mfma_f32_16x16x32_bf16 v[180:183], a[76:79], a[44:47], v[180:183]
  ds_read_b64_tr_b16 a[76:77], v229 offset:43104
  s_add_u32 s17, s17, 229376
  v_mfma_f32_16x16x32_bf16 v[16:19], a[80:83], a[32:35], v[16:19]
  ds_read_b64_tr_b16 a[78:79], v229 offset:46688
  v_mfma_f32_16x16x32_bf16 v[72:75], a[80:83], a[36:39], v[72:75]
  v_mfma_f32_16x16x32_bf16 v[128:131], a[80:83], a[40:43], v[128:131]
  buffer_load_dwordx4 a[16:19], v224, s[4:7], s16 offen offset:0 sc1
  v_mfma_f32_16x16x32_bf16 v[184:187], a[80:83], a[44:47], v[184:187]
  ds_read_b64_tr_b16 a[80:81], v229 offset:43136
  ds_read_b64_tr_b16 a[82:83], v229 offset:46720
  v_mfma_f32_16x16x32_bf16 v[20:23], a[84:87], a[32:35], v[20:23]
  v_mfma_f32_16x16x32_bf16 v[76:79], a[84:87], a[36:39], v[76:79]
  buffer_load_dwordx4 a[20:23], v224, s[4:7], s16 offen offset:1024 sc1
  v_mfma_f32_16x16x32_bf16 v[132:135], a[84:87], a[40:43], v[132:135]
  v_mfma_f32_16x16x32_bf16 v[188:191], a[84:87], a[44:47], v[188:191]
  ds_read_b64_tr_b16 a[84:85], v229 offset:43168
  ds_read_b64_tr_b16 a[86:87], v229 offset:46752
  v_mfma_f32_16x16x32_bf16 v[24:27], a[88:91], a[32:35], v[24:27]
  buffer_load_dwordx4 a[24:27], v224, s[4:7], s16 offen offset:2048 sc1
  v_mfma_f32_16x16x32_bf16 v[80:83], a[88:91], a[36:39], v[80:83]
  v_mfma_f32_16x16x32_bf16 v[136:139], a[88:91], a[40:43], v[136:139]
  v_mfma_f32_16x16x32_bf16 v[192:195], a[88:91], a[44:47], v[192:195]
  buffer_load_dwordx4 a[28:31], v224, s[4:7], s16 offen offset:3072 sc1
  v_mfma_f32_16x16x32_bf16 v[28:31], a[92:95], a[32:35], v[28:31]
  ds_read_b64_tr_b16 a[88:89], v229 offset:43200
  ds_read_b64_tr_b16 a[90:91], v229 offset:46784
  v_mfma_f32_16x16x32_bf16 v[84:87], a[92:95], a[36:39], v[84:87]
  v_mfma_f32_16x16x32_bf16 v[140:143], a[92:95], a[40:43], v[140:143]
  s_add_u32 s16, s16, 131072
  v_mfma_f32_16x16x32_bf16 v[196:199], a[92:95], a[44:47], v[196:199]
  ds_read_b64_tr_b16 a[92:93], v229 offset:50176
  ds_read_b64_tr_b16 a[94:95], v229 offset:53760
  s_waitcnt lgkmcnt(10)
  v_mfma_f32_16x16x32_bf16 v[32:35], a[96:99], a[32:35], v[32:35]
  v_mfma_f32_16x16x32_bf16 v[88:91], a[96:99], a[36:39], v[88:91]
  buffer_load_dword v251, v249, s[52:55], s56 offen
  v_mfma_f32_16x16x32_bf16 v[144:147], a[96:99], a[40:43], v[144:147]
  v_mfma_f32_16x16x32_bf16 v[200:203], a[96:99], a[44:47], v[200:203]
  ds_read_b64_tr_b16 a[96:97], v229 offset:50208
  ds_read_b64_tr_b16 a[98:99], v229 offset:53792
  v_mfma_f32_16x16x32_bf16 v[36:39], a[100:103], a[32:35], v[36:39]
  s_add_u32 s56, s56, 1048576
  v_mfma_f32_16x16x32_bf16 v[92:95], a[100:103], a[36:39], v[92:95]
  v_mfma_f32_16x16x32_bf16 v[148:151], a[100:103], a[40:43], v[148:151]
  v_mfma_f32_16x16x32_bf16 v[204:207], a[100:103], a[44:47], v[204:207]
  ds_read_b64_tr_b16 a[100:101], v229 offset:50240
  s_add_u32 s59, s59, 1
  v_mfma_f32_16x16x32_bf16 v[40:43], a[104:107], a[32:35], v[40:43]
  ds_read_b64_tr_b16 a[102:103], v229 offset:53824
  v_mfma_f32_16x16x32_bf16 v[96:99], a[104:107], a[36:39], v[96:99]
  v_mfma_f32_16x16x32_bf16 v[152:155], a[104:107], a[40:43], v[152:155]
  s_cmp_eq_u32 s59, 6
  v_mfma_f32_16x16x32_bf16 v[208:211], a[104:107], a[44:47], v[208:211]
  ds_read_b64_tr_b16 a[104:105], v229 offset:50272
  ds_read_b64_tr_b16 a[106:107], v229 offset:53856
  v_mfma_f32_16x16x32_bf16 v[44:47], a[108:111], a[32:35], v[44:47]
  v_mfma_f32_16x16x32_bf16 v[100:103], a[108:111], a[36:39], v[100:103]
  s_cselect_b32 s52, s22, s52
  v_mfma_f32_16x16x32_bf16 v[156:159], a[108:111], a[40:43], v[156:159]
  v_mfma_f32_16x16x32_bf16 v[212:215], a[108:111], a[44:47], v[212:215]
  ds_read_b64_tr_b16 a[108:109], v229 offset:50304
  ds_read_b64_tr_b16 a[110:111], v229 offset:53888
  v_mfma_f32_16x16x32_bf16 v[48:51], a[112:115], a[32:35], v[48:51]
  s_cselect_b32 s53, s23, s53
  v_mfma_f32_16x16x32_bf16 v[104:107], a[112:115], a[36:39], v[104:107]
  v_mfma_f32_16x16x32_bf16 v[160:163], a[112:115], a[40:43], v[160:163]
  v_mfma_f32_16x16x32_bf16 v[216:219], a[112:115], a[44:47], v[216:219]
  ds_read_b64_tr_b16 a[112:113], v229 offset:50336
  s_cselect_b32 s56, s60, s56
  v_mfma_f32_16x16x32_bf16 v[52:55], a[116:119], a[32:35], v[52:55]
  ds_read_b64_tr_b16 a[114:115], v229 offset:53920
  v_mfma_f32_16x16x32_bf16 v[108:111], a[116:119], a[36:39], v[108:111]
  v_mfma_f32_16x16x32_bf16 v[164:167], a[116:119], a[40:43], v[164:167]
  v_mfma_f32_16x16x32_bf16 v[220:223], a[116:119], a[44:47], v[220:223]
  s_waitcnt vmcnt(13) lgkmcnt(10)
  s_barrier
  v_mfma_f32_16x16x32_bf16 v[0:3], a[64:67], a[48:51], v[0:3]
  ds_read_b64_tr_b16 a[116:117], v229 offset:50368
  s_add_u32 m0, s38, 28672
  v_mfma_f32_16x16x32_bf16 v[56:59], a[64:67], a[52:55], v[56:59]
  ds_read_b64_tr_b16 a[118:119], v229 offset:53952
  v_mfma_f32_16x16x32_bf16 v[112:115], a[64:67], a[56:59], v[112:115]
  v_mfma_f32_16x16x32_bf16 v[168:171], a[64:67], a[60:63], v[168:171]
  ds_read_b64_tr_b16 a[64:65], v229 offset:0
  ds_read_b64_tr_b16 a[66:67], v229 offset:3584
  v_mfma_f32_16x16x32_bf16 v[4:7], a[68:71], a[48:51], v[4:7]
  v_mfma_f32_16x16x32_bf16 v[60:63], a[68:71], a[52:55], v[60:63]
  buffer_load_dwordx4 v225, s[8:11], s17 offen lds
  v_mfma_f32_16x16x32_bf16 v[116:119], a[68:71], a[56:59], v[116:119]
  v_mfma_f32_16x16x32_bf16 v[172:175], a[68:71], a[60:63], v[172:175]
  ds_read_b64_tr_b16 a[68:69], v229 offset:32
  ds_read_b64_tr_b16 a[70:71], v229 offset:3616
  v_mfma_f32_16x16x32_bf16 v[8:11], a[72:75], a[48:51], v[8:11]
  v_mfma_f32_16x16x32_bf16 v[64:67], a[72:75], a[52:55], v[64:67]
  v_mfma_f32_16x16x32_bf16 v[120:123], a[72:75], a[56:59], v[120:123]
  buffer_load_dwordx4 v226, s[8:11], s17 offen offset:1024 lds
  v_mfma_f32_16x16x32_bf16 v[176:179], a[72:75], a[60:63], v[176:179]
  ds_read_b64_tr_b16 a[72:73], v229 offset:64
  ds_read_b64_tr_b16 a[74:75], v229 offset:3648
  v_mfma_f32_16x16x32_bf16 v[12:15], a[76:79], a[48:51], v[12:15]
  v_mfma_f32_16x16x32_bf16 v[68:71], a[76:79], a[52:55], v[68:71]
  v_mfma_f32_16x16x32_bf16 v[124:127], a[76:79], a[56:59], v[124:127]
  v_mfma_f32_16x16x32_bf16 v[180:183], a[76:79], a[60:63], v[180:183]
  buffer_load_dwordx4 v227, s[8:11], s17 offen offset:2048 lds
  v_mfma_f32_16x16x32_bf16 v[16:19], a[80:83], a[48:51], v[16:19]
  ds_read_b64_tr_b16 a[76:77], v229 offset:96
  ds_read_b64_tr_b16 a[78:79], v229 offset:3680
  v_mfma_f32_16x16x32_bf16 v[72:75], a[80:83], a[52:55], v[72:75]
  v_mfma_f32_16x16x32_bf16 v[128:131], a[80:83], a[56:59], v[128:131]
  v_mfma_f32_16x16x32_bf16 v[184:187], a[80:83], a[60:63], v[184:187]
  ds_read_b64_tr_b16 a[80:81], v229 offset:128
  ds_read_b64_tr_b16 a[82:83], v229 offset:3712
  v_mfma_f32_16x16x32_bf16 v[20:23], a[84:87], a[48:51], v[20:23]
  s_mov_b32 exec_hi, 0
  buffer_load_dwordx4 v228, s[8:11], s17 offen offset:3072 lds
  s_mov_b32 exec_hi, -1
  v_mfma_f32_16x16x32_bf16 v[76:79], a[84:87], a[52:55], v[76:79]
  v_mfma_f32_16x16x32_bf16 v[132:135], a[84:87], a[56:59], v[132:135]
  v_mfma_f32_16x16x32_bf16 v[188:191], a[84:87], a[60:63], v[188:191]
  ds_read_b64_tr_b16 a[84:85], v229 offset:160
  ds_read_b64_tr_b16 a[86:87], v229 offset:3744
  v_mfma_f32_16x16x32_bf16 v[24:27], a[88:91], a[48:51], v[24:27]
  v_mfma_f32_16x16x32_bf16 v[80:83], a[88:91], a[52:55], v[80:83]
  s_add_u32 s17, s17, 229376
  v_mfma_f32_16x16x32_bf16 v[136:139], a[88:91], a[56:59], v[136:139]
  v_mfma_f32_16x16x32_bf16 v[192:195], a[88:91], a[60:63], v[192:195]
  ds_read_b64_tr_b16 a[88:89], v229 offset:192
  ds_read_b64_tr_b16 a[90:91], v229 offset:3776
  v_mfma_f32_16x16x32_bf16 v[28:31], a[92:95], a[48:51], v[28:31]
  v_mfma_f32_16x16x32_bf16 v[84:87], a[92:95], a[52:55], v[84:87]
  v_mfma_f32_16x16x32_bf16 v[140:143], a[92:95], a[56:59], v[140:143]
  buffer_load_dwordx4 a[32:35], v224, s[4:7], s16 offen offset:0 sc1
  v_mfma_f32_16x16x32_bf16 v[196:199], a[92:95], a[60:63], v[196:199]
  ds_read_b64_tr_b16 a[92:93], v229 offset:7168
  ds_read_b64_tr_b16 a[94:95], v229 offset:10752
  s_waitcnt lgkmcnt(10)
  v_mfma_f32_16x16x32_bf16 v[32:35], a[96:99], a[48:51], v[32:35]
  v_mfma_f32_16x16x32_bf16 v[88:91], a[96:99], a[52:55], v[88:91]
  v_mfma_f32_16x16x32_bf16 v[144:147], a[96:99], a[56:59], v[144:147]
  v_mfma_f32_16x16x32_bf16 v[200:203], a[96:99], a[60:63], v[200:203]
  buffer_load_dwordx4 a[36:39], v224, s[4:7], s16 offen offset:1024 sc1
  v_mfma_f32_16x16x32_bf16 v[36:39], a[100:103], a[48:51], v[36:39]
  ds_read_b64_tr_b16 a[96:97], v229 offset:7200
  ds_read_b64_tr_b16 a[98:99], v229 offset:10784
  v_mfma_f32_16x16x32_bf16 v[92:95], a[100:103], a[52:55], v[92:95]
  v_mfma_f32_16x16x32_bf16 v[148:151], a[100:103], a[56:59], v[148:151]
  v_mfma_f32_16x16x32_bf16 v[204:207], a[100:103], a[60:63], v[204:207]
  ds_read_b64_tr_b16 a[100:101], v229 offset:7232
  ds_read_b64_tr_b16 a[102:103], v229 offset:10816
  v_mfma_f32_16x16x32_bf16 v[40:43], a[104:107], a[48:51], v[40:43]
  buffer_load_dwordx4 a[40:43], v224, s[4:7], s16 offen offset:2048 sc1
  v_mfma_f32_16x16x32_bf16 v[96:99], a[104:107], a[52:55], v[96:99]
  v_mfma_f32_16x16x32_bf16 v[152:155], a[104:107], a[56:59], v[152:155]
  v_mfma_f32_16x16x32_bf16 v[208:211], a[104:107], a[60:63], v[208:211]
  ds_read_b64_tr_b16 a[104:105], v229 offset:7264
  ds_read_b64_tr_b16 a[106:107], v229 offset:10848
  v_mfma_f32_16x16x32_bf16 v[44:47], a[108:111], a[48:51], v[44:47]
  v_mfma_f32_16x16x32_bf16 v[100:103], a[108:111], a[52:55], v[100:103]
  buffer_load_dwordx4 a[44:47], v224, s[4:7], s16 offen offset:3072 sc1
  v_mfma_f32_16x16x32_bf16 v[156:159], a[108:111], a[56:59], v[156:159]
  v_mfma_f32_16x16x32_bf16 v[212:215], a[108:111], a[60:63], v[212:215]
  ds_read_b64_tr_b16 a[108:109], v229 offset:7296
  ds_read_b64_tr_b16 a[110:111], v229 offset:10880
  v_mfma_f32_16x16x32_bf16 v[48:51], a[112:115], a[48:51], v[48:51]
  v_mfma_f32_16x16x32_bf16 v[104:107], a[112:115], a[52:55], v[104:107]
  v_mfma_f32_16x16x32_bf16 v[160:163], a[112:115], a[56:59], v[160:163]
  s_add_u32 s16, s16, 131072
  v_mfma_f32_16x16x32_bf16 v[216:219], a[112:115], a[60:63], v[216:219]
  ds_read_b64_tr_b16 a[112:113], v229 offset:7328
  ds_read_b64_tr_b16 a[114:115], v229 offset:10912
  v_mfma_f32_16x16x32_bf16 v[52:55], a[116:119], a[48:51], v[52:55]
  v_mfma_f32_16x16x32_bf16 v[108:111], a[116:119], a[52:55], v[108:111]
  v_mfma_f32_16x16x32_bf16 v[164:167], a[116:119], a[56:59], v[164:167]
  v_mfma_f32_16x16x32_bf16 v[220:223], a[116:119], a[60:63], v[220:223]
  s_waitcnt vmcnt(13) lgkmcnt(10)
  s_barrier
  v_mfma_f32_16x16x32_bf16 v[0:3], a[64:67], a[0:3], v[0:3]
  ds_read_b64_tr_b16 a[116:117], v229 offset:7360
  s_add_u32 m0, s38, 43008
  v_mfma_f32_16x16x32_bf16 v[56:59], a[64:67], a[4:7], v[56:59]
  ds_read_b64_tr_b16 a[118:119], v229 offset:10944
  v_mfma_f32_16x16x32_bf16 v[112:115], a[64:67], a[8:11], v[112:115]
  v_mfma_f32_16x16x32_bf16 v[168:171], a[64:67], a[12:15], v[168:171]
  ds_read_b64_tr_b16 a[64:65], v229 offset:14336
  ds_read_b64_tr_b16 a[66:67], v229 offset:17920
  v_mfma_f32_16x16x32_bf16 v[4:7], a[68:71], a[0:3], v[4:7]
  v_mfma_f32_16x16x32_bf16 v[60:63], a[68:71], a[4:7], v[60:63]
  buffer_load_dwordx4 v225, s[8:11], s17 offen lds
  v_mfma_f32_16x16x32_bf16 v[116:119], a[68:71], a[8:11], v[116:119]
  v_mfma_f32_16x16x32_bf16 v[172:175], a[68:71], a[12:15], v[172:175]
  ds_read_b64_tr_b16 a[68:69], v229 offset:14368
  ds_read_b64_tr_b16 a[70:71], v229 offset:17952
  v_mfma_f32_16x16x32_bf16 v[8:11], a[72:75], a[0:3], v[8:11]
  v_mfma_f32_16x16x32_bf16 v[64:67], a[72:75], a[4:7], v[64:67]
  v_mfma_f32_16x16x32_bf16 v[120:123], a[72:75], a[8:11], v[120:123]
  buffer_load_dwordx4 v226, s[8:11], s17 offen offset:1024 lds
  v_mfma_f32_16x16x32_bf16 v[176:179], a[72:75], a[12:15], v[176:179]
  ds_read_b64_tr_b16 a[72:73], v229 offset:14400
  ds_read_b64_tr_b16 a[74:75], v229 offset:17984
  v_mfma_f32_16x16x32_bf16 v[12:15], a[76:79], a[0:3], v[12:15]
  v_mfma_f32_16x16x32_bf16 v[68:71], a[76:79], a[4:7], v[68:71]
  v_mfma_f32_16x16x32_bf16 v[124:127], a[76:79], a[8:11], v[124:127]
  v_mfma_f32_16x16x32_bf16 v[180:183], a[76:79], a[12:15], v[180:183]
  buffer_load_dwordx4 v227, s[8:11], s17 offen offset:2048 lds
  v_mfma_f32_16x16x32_bf16 v[16:19], a[80:83], a[0:3], v[16:19]
  ds_read_b64_tr_b16 a[76:77], v229 offset:14432
  ds_read_b64_tr_b16 a[78:79], v229 offset:18016
  v_mfma_f32_16x16x32_bf16 v[72:75], a[80:83], a[4:7], v[72:75]
  v_mfma_f32_16x16x32_bf16 v[128:131], a[80:83], a[8:11], v[128:131]
  v_mfma_f32_16x16x32_bf16 v[184:187], a[80:83], a[12:15], v[184:187]
  ds_read_b64_tr_b16 a[80:81], v229 offset:14464
  ds_read_b64_tr_b16 a[82:83], v229 offset:18048
  v_mfma_f32_16x16x32_bf16 v[20:23], a[84:87], a[0:3], v[20:23]
  s_mov_b32 exec_hi, 0
  buffer_load_dwordx4 v228, s[8:11], s17 offen offset:3072 lds
  s_mov_b32 exec_hi, -1
  v_mfma_f32_16x16x32_bf16 v[76:79], a[84:87], a[4:7], v[76:79]
  v_mfma_f32_16x16x32_bf16 v[132:135], a[84:87], a[8:11], v[132:135]
  v_mfma_f32_16x16x32_bf16 v[188:191], a[84:87], a[12:15], v[188:191]
  ds_read_b64_tr_b16 a[84:85], v229 offset:14496
  ds_read_b64_tr_b16 a[86:87], v229 offset:18080
  v_mfma_f32_16x16x32_bf16 v[24:27], a[88:91], a[0:3], v[24:27]
  v_mfma_f32_16x16x32_bf16 v[80:83], a[88:91], a[4:7], v[80:83]
  s_add_u32 s17, s17, 229376
  v_mfma_f32_16x16x32_bf16 v[136:139], a[88:91], a[8:11], v[136:139]
  v_mfma_f32_16x16x32_bf16 v[192:195], a[88:91], a[12:15], v[192:195]
  ds_read_b64_tr_b16 a[88:89], v229 offset:14528
  ds_read_b64_tr_b16 a[90:91], v229 offset:18112
  v_mfma_f32_16x16x32_bf16 v[28:31], a[92:95], a[0:3], v[28:31]
  v_mfma_f32_16x16x32_bf16 v[84:87], a[92:95], a[4:7], v[84:87]
  v_mfma_f32_16x16x32_bf16 v[140:143], a[92:95], a[8:11], v[140:143]
  buffer_load_dwordx4 a[48:51], v224, s[4:7], s16 offen offset:0 sc1
  v_mfma_f32_16x16x32_bf16 v[196:199], a[92:95], a[12:15], v[196:199]
  ds_read_b64_tr_b16 a[92:93], v229 offset:21504
  ds_read_b64_tr_b16 a[94:95], v229 offset:25088
  s_waitcnt lgkmcnt(10)
  v_mfma_f32_16x16x32_bf16 v[32:35], a[96:99], a[0:3], v[32:35]
  v_mfma_f32_16x16x32_bf16 v[88:91], a[96:99], a[4:7], v[88:91]
  v_mfma_f32_16x16x32_bf16 v[144:147], a[96:99], a[8:11], v[144:147]
  v_mfma_f32_16x16x32_bf16 v[200:203], a[96:99], a[12:15], v[200:203]
  buffer_load_dwordx4 a[52:55], v224, s[4:7], s16 offen offset:1024 sc1
  v_mfma_f32_16x16x32_bf16 v[36:39], a[100:103], a[0:3], v[36:39]
  ds_read_b64_tr_b16 a[96:97], v229 offset:21536
  ds_read_b64_tr_b16 a[98:99], v229 offset:25120
  v_mfma_f32_16x16x32_bf16 v[92:95], a[100:103], a[4:7], v[92:95]
  v_mfma_f32_16x16x32_bf16 v[148:151], a[100:103], a[8:11], v[148:151]
  v_mfma_f32_16x16x32_bf16 v[204:207], a[100:103], a[12:15], v[204:207]
  ds_read_b64_tr_b16 a[100:101], v229 offset:21568
  ds_read_b64_tr_b16 a[102:103], v229 offset:25152
  v_mfma_f32_16x16x32_bf16 v[40:43], a[104:107], a[0:3], v[40:43]
  buffer_load_dwordx4 a[56:59], v224, s[4:7], s16 offen offset:2048 sc1
  v_mfma_f32_16x16x32_bf16 v[96:99], a[104:107], a[4:7], v[96:99]
  v_mfma_f32_16x16x32_bf16 v[152:155], a[104:107], a[8:11], v[152:155]
  v_mfma_f32_16x16x32_bf16 v[208:211], a[104:107], a[12:15], v[208:211]
  ds_read_b64_tr_b16 a[104:105], v229 offset:21600
  ds_read_b64_tr_b16 a[106:107], v229 offset:25184
  v_mfma_f32_16x16x32_bf16 v[44:47], a[108:111], a[0:3], v[44:47]
  v_mfma_f32_16x16x32_bf16 v[100:103], a[108:111], a[4:7], v[100:103]
  buffer_load_dwordx4 a[60:63], v224, s[4:7], s16 offen offset:3072 sc1
  v_mfma_f32_16x16x32_bf16 v[156:159], a[108:111], a[8:11], v[156:159]
  v_mfma_f32_16x16x32_bf16 v[212:215], a[108:111], a[12:15], v[212:215]
  ds_read_b64_tr_b16 a[108:109], v229 offset:21632
  ds_read_b64_tr_b16 a[110:111], v229 offset:25216
  v_mfma_f32_16x16x32_bf16 v[48:51], a[112:115], a[0:3], v[48:51]
  v_mfma_f32_16x16x32_bf16 v[104:107], a[112:115], a[4:7], v[104:107]
  v_mfma_f32_16x16x32_bf16 v[160:163], a[112:115], a[8:11], v[160:163]
  s_add_u32 s16, s16, 131072
  v_mfma_f32_16x16x32_bf16 v[216:219], a[112:115], a[12:15], v[216:219]
  ds_read_b64_tr_b16 a[112:113], v229 offset:21664
  ds_read_b64_tr_b16 a[114:115], v229 offset:25248
  v_mfma_f32_16x16x32_bf16 v[52:55], a[116:119], a[0:3], v[52:55]
  v_mfma_f32_16x16x32_bf16 v[108:111], a[116:119], a[4:7], v[108:111]
  v_mfma_f32_16x16x32_bf16 v[164:167], a[116:119], a[8:11], v[164:167]
  v_mfma_f32_16x16x32_bf16 v[220:223], a[116:119], a[12:15], v[220:223]
  s_waitcnt vmcnt(12) lgkmcnt(10)
  s_barrier
  v_mfma_f32_16x16x32_bf16 v[0:3], a[64:67], a[16:19], v[0:3]
  ds_read_b64_tr_b16 a[116:117], v229 offset:21696
  s_add_u32 m0, s38, 0
  v_mfma_f32_16x16x32_bf16 v[56:59], a[64:67], a[20:23], v[56:59]
  ds_read_b64_tr_b16 a[118:119], v229 offset:25280
  v_mfma_f32_16x16x32_bf16 v[112:115], a[64:67], a[24:27], v[112:115]
  v_mfma_f32_16x16x32_bf16 v[168:171], a[64:67], a[28:31], v[168:171]
  ds_read_b64_tr_b16 a[64:65], v229 offset:28672
  ds_read_b64_tr_b16 a[66:67], v229 offset:32256
  v_mfma_f32_16x16x32_bf16 v[4:7], a[68:71], a[16:19], v[4:7]
  v_mfma_f32_16x16x32_bf16 v[60:63], a[68:71], a[20:23], v[60:63]
  buffer_load_dwordx4 v225, s[8:11], s17 offen lds
  v_mfma_f32_16x16x32_bf16 v[116:119], a[68:71], a[24:27], v[116:119]
  v_mfma_f32_16x16x32_bf16 v[172:175], a[68:71], a[28:31], v[172:175]
  ds_read_b64_tr_b16 a[68:69], v229 offset:28704
  ds_read_b64_tr_b16 a[70:71], v229 offset:32288
  v_mfma_f32_16x16x32_bf16 v[8:11], a[72:75], a[16:19], v[8:11]
  v_mfma_f32_16x16x32_bf16 v[64:67], a[72:75], a[20:23], v[64:67]
  v_mfma_f32_16x16x32_bf16 v[120:123], a[72:75], a[24:27], v[120:123]
  buffer_load_dwordx4 v226, s[8:11], s17 offen offset:1024 lds
  v_mfma_f32_16x16x32_bf16 v[176:179], a[72:75], a[28:31], v[176:179]
  ds_read_b64_tr_b16 a[72:73], v229 offset:28736
  ds_read_b64_tr_b16 a[74:75], v229 offset:32320
  v_mfma_f32_16x16x32_bf16 v[12:15], a[76:79], a[16:19], v[12:15]
  v_mfma_f32_16x16x32_bf16 v[68:71], a[76:79], a[20:23], v[68:71]
  v_mfma_f32_16x16x32_bf16 v[124:127], a[76:79], a[24:27], v[124:127]
  v_mfma_f32_16x16x32_bf16 v[180:183], a[76:79], a[28:31], v[180:183]
  buffer_load_dwordx4 v227, s[8:11], s17 offen offset:2048 lds
  v_mfma_f32_16x16x32_bf16 v[16:19], a[80:83], a[16:19], v[16:19]
  ds_read_b64_tr_b16 a[76:77], v229 offset:28768
  ds_read_b64_tr_b16 a[78:79], v229 offset:32352
  v_mfma_f32_16x16x32_bf16 v[72:75], a[80:83], a[20:23], v[72:75]
  v_mfma_f32_16x16x32_bf16 v[128:131], a[80:83], a[24:27], v[128:131]
  v_mfma_f32_16x16x32_bf16 v[184:187], a[80:83], a[28:31], v[184:187]
  ds_read_b64_tr_b16 a[80:81], v229 offset:28800
  ds_read_b64_tr_b16 a[82:83], v229 offset:32384
  v_mfma_f32_16x16x32_bf16 v[20:23], a[84:87], a[16:19], v[20:23]
  s_mov_b32 exec_hi, 0
  buffer_load_dwordx4 v228, s[8:11], s17 offen offset:3072 lds
  s_mov_b32 exec_hi, -1
  v_mfma_f32_16x16x32_bf16 v[76:79], a[84:87], a[20:23], v[76:79]
  v_mfma_f32_16x16x32_bf16 v[132:135], a[84:87], a[24:27], v[132:135]
  v_mfma_f32_16x16x32_bf16 v[188:191], a[84:87], a[28:31], v[188:191]
  ds_read_b64_tr_b16 a[84:85], v229 offset:28832
  ds_read_b64_tr_b16 a[86:87], v229 offset:32416
  v_mfma_f32_16x16x32_bf16 v[24:27], a[88:91], a[16:19], v[24:27]
  v_mfma_f32_16x16x32_bf16 v[80:83], a[88:91], a[20:23], v[80:83]
  s_add_u32 s17, s17, 229376
  v_mfma_f32_16x16x32_bf16 v[136:139], a[88:91], a[24:27], v[136:139]
  v_mfma_f32_16x16x32_bf16 v[192:195], a[88:91], a[28:31], v[192:195]
  ds_read_b64_tr_b16 a[88:89], v229 offset:28864
  ds_read_b64_tr_b16 a[90:91], v229 offset:32448
  v_mfma_f32_16x16x32_bf16 v[28:31], a[92:95], a[16:19], v[28:31]
  v_mfma_f32_16x16x32_bf16 v[84:87], a[92:95], a[20:23], v[84:87]
  v_mfma_f32_16x16x32_bf16 v[140:143], a[92:95], a[24:27], v[140:143]
  buffer_load_dwordx4 a[0:3], v224, s[4:7], s16 offen offset:0 sc1
  v_mfma_f32_16x16x32_bf16 v[196:199], a[92:95], a[28:31], v[196:199]
  ds_read_b64_tr_b16 a[92:93], v229 offset:35840
  ds_read_b64_tr_b16 a[94:95], v229 offset:39424
  s_waitcnt lgkmcnt(10)
  v_mfma_f32_16x16x32_bf16 v[32:35], a[96:99], a[16:19], v[32:35]
  v_mfma_f32_16x16x32_bf16 v[88:91], a[96:99], a[20:23], v[88:91]
  v_mfma_f32_16x16x32_bf16 v[144:147], a[96:99], a[24:27], v[144:147]
  v_mfma_f32_16x16x32_bf16 v[200:203], a[96:99], a[28:31], v[200:203]
  buffer_load_dwordx4 a[4:7], v224, s[4:7], s16 offen offset:1024 sc1
  v_mfma_f32_16x16x32_bf16 v[36:39], a[100:103], a[16:19], v[36:39]
  ds_read_b64_tr_b16 a[96:97], v229 offset:35872
  ds_read_b64_tr_b16 a[98:99], v229 offset:39456
  v_mfma_f32_16x16x32_bf16 v[92:95], a[100:103], a[20:23], v[92:95]
  v_mfma_f32_16x16x32_bf16 v[148:151], a[100:103], a[24:27], v[148:151]
  v_mfma_f32_16x16x32_bf16 v[204:207], a[100:103], a[28:31], v[204:207]
  ds_read_b64_tr_b16 a[100:101], v229 offset:35904
  ds_read_b64_tr_b16 a[102:103], v229 offset:39488
  v_mfma_f32_16x16x32_bf16 v[40:43], a[104:107], a[16:19], v[40:43]
  buffer_load_dwordx4 a[8:11], v224, s[4:7], s16 offen offset:2048 sc1
  v_mfma_f32_16x16x32_bf16 v[96:99], a[104:107], a[20:23], v[96:99]
  v_mfma_f32_16x16x32_bf16 v[152:155], a[104:107], a[24:27], v[152:155]
  v_mfma_f32_16x16x32_bf16 v[208:211], a[104:107], a[28:31], v[208:211]
  ds_read_b64_tr_b16 a[104:105], v229 offset:35936
  ds_read_b64_tr_b16 a[106:107], v229 offset:39520
  v_mfma_f32_16x16x32_bf16 v[44:47], a[108:111], a[16:19], v[44:47]
  v_mfma_f32_16x16x32_bf16 v[100:103], a[108:111], a[20:23], v[100:103]
  buffer_load_dwordx4 a[12:15], v224, s[4:7], s16 offen offset:3072 sc1
  v_mfma_f32_16x16x32_bf16 v[156:159], a[108:111], a[24:27], v[156:159]
  v_mfma_f32_16x16x32_bf16 v[212:215], a[108:111], a[28:31], v[212:215]
  ds_read_b64_tr_b16 a[108:109], v229 offset:35968
  ds_read_b64_tr_b16 a[110:111], v229 offset:39552
  v_mfma_f32_16x16x32_bf16 v[48:51], a[112:115], a[16:19], v[48:51]
  v_mfma_f32_16x16x32_bf16 v[104:107], a[112:115], a[20:23], v[104:107]
  v_mfma_f32_16x16x32_bf16 v[160:163], a[112:115], a[24:27], v[160:163]
  s_add_u32 s16, s16, 131072
  v_mfma_f32_16x16x32_bf16 v[216:219], a[112:115], a[28:31], v[216:219]
  ds_read_b64_tr_b16 a[112:113], v229 offset:36000
  ds_read_b64_tr_b16 a[114:115], v229 offset:39584
  v_mfma_f32_16x16x32_bf16 v[52:55], a[116:119], a[16:19], v[52:55]
  v_mfma_f32_16x16x32_bf16 v[108:111], a[116:119], a[20:23], v[108:111]
  v_mfma_f32_16x16x32_bf16 v[164:167], a[116:119], a[24:27], v[164:167]
  v_mfma_f32_16x16x32_bf16 v[220:223], a[116:119], a[28:31], v[220:223]
  s_waitcnt vmcnt(12) lgkmcnt(10)
  s_barrier
  v_mfma_f32_16x16x32_bf16 v[0:3], a[64:67], a[32:35], v[0:3]
  ds_read_b64_tr_b16 a[116:117], v229 offset:36032
  s_add_u32 m0, s38, 14336
  v_mfma_f32_16x16x32_bf16 v[56:59], a[64:67], a[36:39], v[56:59]
  ds_read_b64_tr_b16 a[118:119], v229 offset:39616
  v_mfma_f32_16x16x32_bf16 v[112:115], a[64:67], a[40:43], v[112:115]
  v_mfma_f32_16x16x32_bf16 v[168:171], a[64:67], a[44:47], v[168:171]
  ds_read_b64_tr_b16 a[64:65], v229 offset:43008
  ds_read_b64_tr_b16 a[66:67], v229 offset:46592
  v_mfma_f32_16x16x32_bf16 v[4:7], a[68:71], a[32:35], v[4:7]
  v_mfma_f32_16x16x32_bf16 v[60:63], a[68:71], a[36:39], v[60:63]
  buffer_load_dwordx4 v225, s[8:11], s17 offen lds
  v_mfma_f32_16x16x32_bf16 v[116:119], a[68:71], a[40:43], v[116:119]
  v_mfma_f32_16x16x32_bf16 v[172:175], a[68:71], a[44:47], v[172:175]
  ds_read_b64_tr_b16 a[68:69], v229 offset:43040
  ds_read_b64_tr_b16 a[70:71], v229 offset:46624
  v_mfma_f32_16x16x32_bf16 v[8:11], a[72:75], a[32:35], v[8:11]
  v_mfma_f32_16x16x32_bf16 v[64:67], a[72:75], a[36:39], v[64:67]
  v_mfma_f32_16x16x32_bf16 v[120:123], a[72:75], a[40:43], v[120:123]
  buffer_load_dwordx4 v226, s[8:11], s17 offen offset:1024 lds
  v_mfma_f32_16x16x32_bf16 v[176:179], a[72:75], a[44:47], v[176:179]
  ds_read_b64_tr_b16 a[72:73], v229 offset:43072
  ds_read_b64_tr_b16 a[74:75], v229 offset:46656
  v_mfma_f32_16x16x32_bf16 v[12:15], a[76:79], a[32:35], v[12:15]
  v_mfma_f32_16x16x32_bf16 v[68:71], a[76:79], a[36:39], v[68:71]
  v_mfma_f32_16x16x32_bf16 v[124:127], a[76:79], a[40:43], v[124:127]
  v_mfma_f32_16x16x32_bf16 v[180:183], a[76:79], a[44:47], v[180:183]
  buffer_load_dwordx4 v227, s[8:11], s17 offen offset:2048 lds
  v_mfma_f32_16x16x32_bf16 v[16:19], a[80:83], a[32:35], v[16:19]
  ds_read_b64_tr_b16 a[76:77], v229 offset:43104
  ds_read_b64_tr_b16 a[78:79], v229 offset:46688
  v_mfma_f32_16x16x32_bf16 v[72:75], a[80:83], a[36:39], v[72:75]
  v_mfma_f32_16x16x32_bf16 v[128:131], a[80:83], a[40:43], v[128:131]
  v_mfma_f32_16x16x32_bf16 v[184:187], a[80:83], a[44:47], v[184:187]
  ds_read_b64_tr_b16 a[80:81], v229 offset:43136
  ds_read_b64_tr_b16 a[82:83], v229 offset:46720
  v_mfma_f32_16x16x32_bf16 v[20:23], a[84:87], a[32:35], v[20:23]
  s_mov_b32 exec_hi, 0
  buffer_load_dwordx4 v228, s[8:11], s17 offen offset:3072 lds
  s_mov_b32 exec_hi, -1
  v_mfma_f32_16x16x32_bf16 v[76:79], a[84:87], a[36:39], v[76:79]
  v_mfma_f32_16x16x32_bf16 v[132:135], a[84:87], a[40:43], v[132:135]
  v_mfma_f32_16x16x32_bf16 v[188:191], a[84:87], a[44:47], v[188:191]
  ds_read_b64_tr_b16 a[84:85], v229 offset:43168
  ds_read_b64_tr_b16 a[86:87], v229 offset:46752
  v_mfma_f32_16x16x32_bf16 v[24:27], a[88:91], a[32:35], v[24:27]
  v_mfma_f32_16x16x32_bf16 v[80:83], a[88:91], a[36:39], v[80:83]
  s_add_u32 s17, s17, 229376
  v_mfma_f32_16x16x32_bf16 v[136:139], a[88:91], a[40:43], v[136:139]
  v_mfma_f32_16x16x32_bf16 v[192:195], a[88:91], a[44:47], v[192:195]
  ds_read_b64_tr_b16 a[88:89], v229 offset:43200
  ds_read_b64_tr_b16 a[90:91], v229 offset:46784
  v_mfma_f32_16x16x32_bf16 v[28:31], a[92:95], a[32:35], v[28:31]
  v_mfma_f32_16x16x32_bf16 v[84:87], a[92:95], a[36:39], v[84:87]
  v_mfma_f32_16x16x32_bf16 v[140:143], a[92:95], a[40:43], v[140:143]
  buffer_load_dwordx4 a[16:19], v224, s[4:7], s16 offen offset:0 sc1
  v_mfma_f32_16x16x32_bf16 v[196:199], a[92:95], a[44:47], v[196:199]
  ds_read_b64_tr_b16 a[92:93], v229 offset:50176
  ds_read_b64_tr_b16 a[94:95], v229 offset:53760
  s_waitcnt lgkmcnt(10)
  v_mfma_f32_16x16x32_bf16 v[32:35], a[96:99], a[32:35], v[32:35]
  v_mfma_f32_16x16x32_bf16 v[88:91], a[96:99], a[36:39], v[88:91]
  v_mfma_f32_16x16x32_bf16 v[144:147], a[96:99], a[40:43], v[144:147]
  v_mfma_f32_16x16x32_bf16 v[200:203], a[96:99], a[44:47], v[200:203]
  buffer_load_dwordx4 a[20:23], v224, s[4:7], s16 offen offset:1024 sc1
  v_mfma_f32_16x16x32_bf16 v[36:39], a[100:103], a[32:35], v[36:39]
  ds_read_b64_tr_b16 a[96:97], v229 offset:50208
  ds_read_b64_tr_b16 a[98:99], v229 offset:53792
  v_mfma_f32_16x16x32_bf16 v[92:95], a[100:103], a[36:39], v[92:95]
  v_mfma_f32_16x16x32_bf16 v[148:151], a[100:103], a[40:43], v[148:151]
  v_mfma_f32_16x16x32_bf16 v[204:207], a[100:103], a[44:47], v[204:207]
  ds_read_b64_tr_b16 a[100:101], v229 offset:50240
  ds_read_b64_tr_b16 a[102:103], v229 offset:53824
  v_mfma_f32_16x16x32_bf16 v[40:43], a[104:107], a[32:35], v[40:43]
  buffer_load_dwordx4 a[24:27], v224, s[4:7], s16 offen offset:2048 sc1
  v_mfma_f32_16x16x32_bf16 v[96:99], a[104:107], a[36:39], v[96:99]
  v_mfma_f32_16x16x32_bf16 v[152:155], a[104:107], a[40:43], v[152:155]
  v_mfma_f32_16x16x32_bf16 v[208:211], a[104:107], a[44:47], v[208:211]
  ds_read_b64_tr_b16 a[104:105], v229 offset:50272
  ds_read_b64_tr_b16 a[106:107], v229 offset:53856
  v_mfma_f32_16x16x32_bf16 v[44:47], a[108:111], a[32:35], v[44:47]
  v_mfma_f32_16x16x32_bf16 v[100:103], a[108:111], a[36:39], v[100:103]
  buffer_load_dwordx4 a[28:31], v224, s[4:7], s16 offen offset:3072 sc1
  v_mfma_f32_16x16x32_bf16 v[156:159], a[108:111], a[40:43], v[156:159]
  v_mfma_f32_16x16x32_bf16 v[212:215], a[108:111], a[44:47], v[212:215]
  ds_read_b64_tr_b16 a[108:109], v229 offset:50304
  ds_read_b64_tr_b16 a[110:111], v229 offset:53888
  v_mfma_f32_16x16x32_bf16 v[48:51], a[112:115], a[32:35], v[48:51]
  v_mfma_f32_16x16x32_bf16 v[104:107], a[112:115], a[36:39], v[104:107]
  v_mfma_f32_16x16x32_bf16 v[160:163], a[112:115], a[40:43], v[160:163]
  s_add_u32 s16, s16, 131072
  v_mfma_f32_16x16x32_bf16 v[216:219], a[112:115], a[44:47], v[216:219]
  ds_read_b64_tr_b16 a[112:113], v229 offset:50336
  ds_read_b64_tr_b16 a[114:115], v229 offset:53920
  v_mfma_f32_16x16x32_bf16 v[52:55], a[116:119], a[32:35], v[52:55]
  v_mfma_f32_16x16x32_bf16 v[108:111], a[116:119], a[36:39], v[108:111]
  v_mfma_f32_16x16x32_bf16 v[164:167], a[116:119], a[40:43], v[164:167]
  v_mfma_f32_16x16x32_bf16 v[220:223], a[116:119], a[44:47], v[220:223]
  s_waitcnt vmcnt(12) lgkmcnt(10)
  s_barrier
  v_mfma_f32_16x16x32_bf16 v[0:3], a[64:67], a[48:51], v[0:3]
  ds_read_b64_tr_b16 a[116:117], v229 offset:50368
  s_add_u32 m0, s38, 28672
  v_mfma_f32_16x16x32_bf16 v[56:59], a[64:67], a[52:55], v[56:59]
  ds_read_b64_tr_b16 a[118:119], v229 offset:53952
  v_mfma_f32_16x16x32_bf16 v[112:115], a[64:67], a[56:59], v[112:115]
  v_mfma_f32_16x16x32_bf16 v[168:171], a[64:67], a[60:63], v[168:171]
  ds_read_b64_tr_b16 a[64:65], v229 offset:0
  ds_read_b64_tr_b16 a[66:67], v229 offset:3584
  v_mfma_f32_16x16x32_bf16 v[4:7], a[68:71], a[48:51], v[4:7]
  v_mfma_f32_16x16x32_bf16 v[60:63], a[68:71], a[52:55], v[60:63]
  buffer_load_dwordx4 v225, s[8:11], s17 offen lds
  v_mfma_f32_16x16x32_bf16 v[116:119], a[68:71], a[56:59], v[116:119]
  v_mfma_f32_16x16x32_bf16 v[172:175], a[68:71], a[60:63], v[172:175]
  ds_read_b64_tr_b16 a[68:69], v229 offset:32
  ds_read_b64_tr_b16 a[70:71], v229 offset:3616
  v_mfma_f32_16x16x32_bf16 v[8:11], a[72:75], a[48:51], v[8:11]
  v_mfma_f32_16x16x32_bf16 v[64:67], a[72:75], a[52:55], v[64:67]
  v_mfma_f32_16x16x32_bf16 v[120:123], a[72:75], a[56:59], v[120:123]
  buffer_load_dwordx4 v226, s[8:11], s17 offen offset:1024 lds
  v_mfma_f32_16x16x32_bf16 v[176:179], a[72:75], a[60:63], v[176:179]
  ds_read_b64_tr_b16 a[72:73], v229 offset:64
  ds_read_b64_tr_b16 a[74:75], v229 offset:3648
  v_mfma_f32_16x16x32_bf16 v[12:15], a[76:79], a[48:51], v[12:15]
  v_mfma_f32_16x16x32_bf16 v[68:71], a[76:79], a[52:55], v[68:71]
  v_mfma_f32_16x16x32_bf16 v[124:127], a[76:79], a[56:59], v[124:127]
  v_mfma_f32_16x16x32_bf16 v[180:183], a[76:79], a[60:63], v[180:183]
  buffer_load_dwordx4 v227, s[8:11], s17 offen offset:2048 lds
  v_mfma_f32_16x16x32_bf16 v[16:19], a[80:83], a[48:51], v[16:19]
  ds_read_b64_tr_b16 a[76:77], v229 offset:96
  ds_read_b64_tr_b16 a[78:79], v229 offset:3680
  v_mfma_f32_16x16x32_bf16 v[72:75], a[80:83], a[52:55], v[72:75]
  v_mfma_f32_16x16x32_bf16 v[128:131], a[80:83], a[56:59], v[128:131]
  v_mfma_f32_16x16x32_bf16 v[184:187], a[80:83], a[60:63], v[184:187]
  ds_read_b64_tr_b16 a[80:81], v229 offset:128
  ds_read_b64_tr_b16 a[82:83], v229 offset:3712
  v_mfma_f32_16x16x32_bf16 v[20:23], a[84:87], a[48:51], v[20:23]
  s_mov_b32 exec_hi, 0
  buffer_load_dwordx4 v228, s[8:11], s17 offen offset:3072 lds
  s_mov_b32 exec_hi, -1
  v_mfma_f32_16x16x32_bf16 v[76:79], a[84:87], a[52:55], v[76:79]
  v_mfma_f32_16x16x32_bf16 v[132:135], a[84:87], a[56:59], v[132:135]
  v_mfma_f32_16x16x32_bf16 v[188:191], a[84:87], a[60:63], v[188:191]
  ds_read_b64_tr_b16 a[84:85], v229 offset:160
  ds_read_b64_tr_b16 a[86:87], v229 offset:3744
  v_mfma_f32_16x16x32_bf16 v[24:27], a[88:91], a[48:51], v[24:27]
  v_mfma_f32_16x16x32_bf16 v[80:83], a[88:91], a[52:55], v[80:83]
  s_add_u32 s17, s17, 229376
  v_mfma_f32_16x16x32_bf16 v[136:139], a[88:91], a[56:59], v[136:139]
  v_mfma_f32_16x16x32_bf16 v[192:195], a[88:91], a[60:63], v[192:195]
  ds_read_b64_tr_b16 a[88:89], v229 offset:192
  ds_read_b64_tr_b16 a[90:91], v229 offset:3776
  v_mfma_f32_16x16x32_bf16 v[28:31], a[92:95], a[48:51], v[28:31]
  v_mfma_f32_16x16x32_bf16 v[84:87], a[92:95], a[52:55], v[84:87]
  v_mfma_f32_16x16x32_bf16 v[140:143], a[92:95], a[56:59], v[140:143]
  buffer_load_dwordx4 a[32:35], v224, s[4:7], s16 offen offset:0 sc1
  v_mfma_f32_16x16x32_bf16 v[196:199], a[92:95], a[60:63], v[196:199]
  ds_read_b64_tr_b16 a[92:93], v229 offset:7168
  ds_read_b64_tr_b16 a[94:95], v229 offset:10752
  s_waitcnt lgkmcnt(10)
  v_mfma_f32_16x16x32_bf16 v[32:35], a[96:99], a[48:51], v[32:35]
  v_mfma_f32_16x16x32_bf16 v[88:91], a[96:99], a[52:55], v[88:91]
  v_mfma_f32_16x16x32_bf16 v[144:147], a[96:99], a[56:59], v[144:147]
  v_mfma_f32_16x16x32_bf16 v[200:203], a[96:99], a[60:63], v[200:203]
  buffer_load_dwordx4 a[36:39], v224, s[4:7], s16 offen offset:1024 sc1
  v_mfma_f32_16x16x32_bf16 v[36:39], a[100:103], a[48:51], v[36:39]
  ds_read_b64_tr_b16 a[96:97], v229 offset:7200
  ds_read_b64_tr_b16 a[98:99], v229 offset:10784
  v_mfma_f32_16x16x32_bf16 v[92:95], a[100:103], a[52:55], v[92:95]
  v_mfma_f32_16x16x32_bf16 v[148:151], a[100:103], a[56:59], v[148:151]
  v_mfma_f32_16x16x32_bf16 v[204:207], a[100:103], a[60:63], v[204:207]
  ds_read_b64_tr_b16 a[100:101], v229 offset:7232
  ds_read_b64_tr_b16 a[102:103], v229 offset:10816
  v_mfma_f32_16x16x32_bf16 v[40:43], a[104:107], a[48:51], v[40:43]
  buffer_load_dwordx4 a[40:43], v224, s[4:7], s16 offen offset:2048 sc1
  v_mfma_f32_16x16x32_bf16 v[96:99], a[104:107], a[52:55], v[96:99]
  v_mfma_f32_16x16x32_bf16 v[152:155], a[104:107], a[56:59], v[152:155]
  v_mfma_f32_16x16x32_bf16 v[208:211], a[104:107], a[60:63], v[208:211]
  ds_read_b64_tr_b16 a[104:105], v229 offset:7264
  ds_read_b64_tr_b16 a[106:107], v229 offset:10848
  v_mfma_f32_16x16x32_bf16 v[44:47], a[108:111], a[48:51], v[44:47]
  v_mfma_f32_16x16x32_bf16 v[100:103], a[108:111], a[52:55], v[100:103]
  buffer_load_dwordx4 a[44:47], v224, s[4:7], s16 offen offset:3072 sc1
  v_mfma_f32_16x16x32_bf16 v[156:159], a[108:111], a[56:59], v[156:159]
  v_mfma_f32_16x16x32_bf16 v[212:215], a[108:111], a[60:63], v[212:215]
  ds_read_b64_tr_b16 a[108:109], v229 offset:7296
  ds_read_b64_tr_b16 a[110:111], v229 offset:10880
  v_mfma_f32_16x16x32_bf16 v[48:51], a[112:115], a[48:51], v[48:51]
  v_mfma_f32_16x16x32_bf16 v[104:107], a[112:115], a[52:55], v[104:107]
  v_mfma_f32_16x16x32_bf16 v[160:163], a[112:115], a[56:59], v[160:163]
  s_add_u32 s16, s16, 131072
  v_mfma_f32_16x16x32_bf16 v[216:219], a[112:115], a[60:63], v[216:219]
  ds_read_b64_tr_b16 a[112:113], v229 offset:7328
  ds_read_b64_tr_b16 a[114:115], v229 offset:10912
  v_mfma_f32_16x16x32_bf16 v[52:55], a[116:119], a[48:51], v[52:55]
  v_mfma_f32_16x16x32_bf16 v[108:111], a[116:119], a[52:55], v[108:111]
  v_mfma_f32_16x16x32_bf16 v[164:167], a[116:119], a[56:59], v[164:167]
  v_mfma_f32_16x16x32_bf16 v[220:223], a[116:119], a[60:63], v[220:223]
  s_waitcnt vmcnt(12) lgkmcnt(10)
  s_barrier
  v_mfma_f32_16x16x32_bf16 v[0:3], a[64:67], a[0:3], v[0:3]
  ds_read_b64_tr_b16 a[116:117], v229 offset:7360
  s_add_u32 m0, s38, 43008
  v_mfma_f32_16x16x32_bf16 v[56:59], a[64:67], a[4:7], v[56:59]
  ds_read_b64_tr_b16 a[118:119], v229 offset:10944
  v_mfma_f32_16x16x32_bf16 v[112:115], a[64:67], a[8:11], v[112:115]
  v_mfma_f32_16x16x32_bf16 v[168:171], a[64:67], a[12:15], v[168:171]
  ds_read_b64_tr_b16 a[64:65], v229 offset:14336
  ds_read_b64_tr_b16 a[66:67], v229 offset:17920
  v_mfma_f32_16x16x32_bf16 v[4:7], a[68:71], a[0:3], v[4:7]
  buffer_load_dwordx4 v225, s[8:11], s17 offen lds
  v_mfma_f32_16x16x32_bf16 v[60:63], a[68:71], a[4:7], v[60:63]
  v_mfma_f32_16x16x32_bf16 v[116:119], a[68:71], a[8:11], v[116:119]
  v_mfma_f32_16x16x32_bf16 v[172:175], a[68:71], a[12:15], v[172:175]
  ds_read_b64_tr_b16 a[68:69], v229 offset:14368
  ds_read_b64_tr_b16 a[70:71], v229 offset:17952
  v_mfma_f32_16x16x32_bf16 v[8:11], a[72:75], a[0:3], v[8:11]
  v_mfma_f32_16x16x32_bf16 v[64:67], a[72:75], a[4:7], v[64:67]
  buffer_load_dwordx4 v226, s[8:11], s17 offen offset:1024 lds
  v_mfma_f32_16x16x32_bf16 v[120:123], a[72:75], a[8:11], v[120:123]
  v_mfma_f32_16x16x32_bf16 v[176:179], a[72:75], a[12:15], v[176:179]
  ds_read_b64_tr_b16 a[72:73], v229 offset:14400
  ds_read_b64_tr_b16 a[74:75], v229 offset:17984
  v_mfma_f32_16x16x32_bf16 v[12:15], a[76:79], a[0:3], v[12:15]
  v_mfma_f32_16x16x32_bf16 v[68:71], a[76:79], a[4:7], v[68:71]
  buffer_load_dwordx4 v227, s[8:11], s17 offen offset:2048 lds
  v_mfma_f32_16x16x32_bf16 v[124:127], a[76:79], a[8:11], v[124:127]
  v_mfma_f32_16x16x32_bf16 v[180:183], a[76:79], a[12:15], v[180:183]
  ds_read_b64_tr_b16 a[76:77], v229 offset:14432
  ds_read_b64_tr_b16 a[78:79], v229 offset:18016
  v_mfma_f32_16x16x32_bf16 v[16:19], a[80:83], a[0:3], v[16:19]
  v_mfma_f32_16x16x32_bf16 v[72:75], a[80:83], a[4:7], v[72:75]
  v_mfma_f32_16x16x32_bf16 v[128:131], a[80:83], a[8:11], v[128:131]
  s_mov_b32 exec_hi, 0
  buffer_load_dwordx4 v228, s[8:11], s17 offen offset:3072 lds
  s_mov_b32 exec_hi, -1
  v_mfma_f32_16x16x32_bf16 v[184:187], a[80:83], a[12:15], v[184:187]
  ds_read_b64_tr_b16 a[80:81], v229 offset:14464
  ds_read_b64_tr_b16 a[82:83], v229 offset:18048
  v_mfma_f32_16x16x32_bf16 v[20:23], a[84:87], a[0:3], v[20:23]
  v_mfma_f32_16x16x32_bf16 v[76:79], a[84:87], a[4:7], v[76:79]
  v_mfma_f32_16x16x32_bf16 v[132:135], a[84:87], a[8:11], v[132:135]
  s_add_u32 s17, s17, 229376
  v_mfma_f32_16x16x32_bf16 v[188:191], a[84:87], a[12:15], v[188:191]
  ds_read_b64_tr_b16 a[84:85], v229 offset:14496
  ds_read_b64_tr_b16 a[86:87], v229 offset:18080
  v_mfma_f32_16x16x32_bf16 v[24:27], a[88:91], a[0:3], v[24:27]
  v_mfma_f32_16x16x32_bf16 v[80:83], a[88:91], a[4:7], v[80:83]
  v_mfma_f32_16x16x32_bf16 v[136:139], a[88:91], a[8:11], v[136:139]
  v_mfma_f32_16x16x32_bf16 v[192:195], a[88:91], a[12:15], v[192:195]
  buffer_load_dwordx4 a[48:51], v224, s[4:7], s16 offen offset:0 sc1
  v_mfma_f32_16x16x32_bf16 v[28:31], a[92:95], a[0:3], v[28:31]
  ds_read_b64_tr_b16 a[88:89], v229 offset:14528
  ds_read_b64_tr_b16 a[90:91], v229 offset:18112
  v_mfma_f32_16x16x32_bf16 v[84:87], a[92:95], a[4:7], v[84:87]
  v_mfma_f32_16x16x32_bf16 v[140:143], a[92:95], a[8:11], v[140:143]
  v_mfma_f32_16x16x32_bf16 v[196:199], a[92:95], a[12:15], v[196:199]
  ds_read_b64_tr_b16 a[92:93], v229 offset:21504
  ds_read_b64_tr_b16 a[94:95], v229 offset:25088
  s_waitcnt lgkmcnt(10)
  v_mfma_f32_16x16x32_bf16 v[32:35], a[96:99], a[0:3], v[32:35]
  buffer_load_dwordx4 a[52:55], v224, s[4:7], s16 offen offset:1024 sc1
  v_mfma_f32_16x16x32_bf16 v[88:91], a[96:99], a[4:7], v[88:91]
  v_mfma_f32_16x16x32_bf16 v[144:147], a[96:99], a[8:11], v[144:147]
  v_mfma_f32_16x16x32_bf16 v[200:203], a[96:99], a[12:15], v[200:203]
  ds_read_b64_tr_b16 a[96:97], v229 offset:21536
  ds_read_b64_tr_b16 a[98:99], v229 offset:25120
  v_mfma_f32_16x16x32_bf16 v[36:39], a[100:103], a[0:3], v[36:39]
  buffer_load_dwordx4 a[56:59], v224, s[4:7], s16 offen offset:2048 sc1
  v_mfma_f32_16x16x32_bf16 v[92:95], a[100:103], a[4:7], v[92:95]
  v_mfma_f32_16x16x32_bf16 v[148:151], a[100:103], a[8:11], v[148:151]
  v_mfma_f32_16x16x32_bf16 v[204:207], a[100:103], a[12:15], v[204:207]
  ds_read_b64_tr_b16 a[100:101], v229 offset:21568
  ds_read_b64_tr_b16 a[102:103], v229 offset:25152
  v_mfma_f32_16x16x32_bf16 v[40:43], a[104:107], a[0:3], v[40:43]
  v_mfma_f32_16x16x32_bf16 v[96:99], a[104:107], a[4:7], v[96:99]
  buffer_load_dwordx4 a[60:63], v224, s[4:7], s16 offen offset:3072 sc1
  v_mfma_f32_16x16x32_bf16 v[152:155], a[104:107], a[8:11], v[152:155]
  v_mfma_f32_16x16x32_bf16 v[208:211], a[104:107], a[12:15], v[208:211]
  ds_read_b64_tr_b16 a[104:105], v229 offset:21600
  ds_read_b64_tr_b16 a[106:107], v229 offset:25184
  v_mfma_f32_16x16x32_bf16 v[44:47], a[108:111], a[0:3], v[44:47]
  v_mfma_f32_16x16x32_bf16 v[100:103], a[108:111], a[4:7], v[100:103]
  s_add_u32 s16, s16, 131072
  v_mfma_f32_16x16x32_bf16 v[156:159], a[108:111], a[8:11], v[156:159]
  v_mfma_f32_16x16x32_bf16 v[212:215], a[108:111], a[12:15], v[212:215]
  ds_read_b64_tr_b16 a[108:109], v229 offset:21632
  ds_read_b64_tr_b16 a[110:111], v229 offset:25216
  v_mfma_f32_16x16x32_bf16 v[48:51], a[112:115], a[0:3], v[48:51]
  v_mfma_f32_16x16x32_bf16 v[104:107], a[112:115], a[4:7], v[104:107]
  v_mfma_f32_16x16x32_bf16 v[160:163], a[112:115], a[8:11], v[160:163]
  s_getpc_b64 s[52:53]
  L_pc_23:
  s_add_u32 s52, s52, L_k56_seam-L_pc_23
  s_addc_u32 s53, s53, 0
  s_lshr_b32 s56, s2, 3
  s_lshl_b32 s56, s56, 2
  s_add_u32 s56, s56, s3
  s_lshl_b32 s56, s56, 13
  v_lshlrev_b32 v254, 7, v231
  v_add_u32 v254, s56, v254
  v_min_u32 v254, L_code_end-L_k56_seam-4, v254
  v_mov_b32 v255, s53
  v_add_co_u32 v254, vcc, s52, v254
  s_nop 1
  v_addc_co_u32 v255, vcc, 0, v255, vcc
  global_load_dword v251, v[254:255], off
  v_mfma_f32_16x16x32_bf16 v[216:219], a[112:115], a[12:15], v[216:219]
  ds_read_b64_tr_b16 a[112:113], v229 offset:21664
  ds_read_b64_tr_b16 a[114:115], v229 offset:25248
  v_mfma_f32_16x16x32_bf16 v[52:55], a[116:119], a[0:3], v[52:55]
  v_mfma_f32_16x16x32_bf16 v[108:111], a[116:119], a[4:7], v[108:111]
  v_mfma_f32_16x16x32_bf16 v[164:167], a[116:119], a[8:11], v[164:167]
  v_mfma_f32_16x16x32_bf16 v[220:223], a[116:119], a[12:15], v[220:223]
  s_waitcnt vmcnt(13) lgkmcnt(10)
  s_barrier
  s_lshr_b32 s32, s31, 4
  s_mul_i32 s32, s32, 56
  v_mfma_f32_16x16x32_bf16 v[0:3], a[64:67], a[16:19], v[0:3]
  s_and_b32 s33, s31, 15
  s_add_u32 s34, s33, s32
  v_mfma_f32_16x16x32_bf16 v[56:59], a[64:67], a[20:23], v[56:59]
  s_lshl_b32 s98, s34, 17
  s_add_u32 s99, s98, 2097152
  v_mfma_f32_16x16x32_bf16 v[112:115], a[64:67], a[24:27], v[112:115]
  ds_read_b64_tr_b16 a[116:117], v229 offset:21696
  ds_read_b64_tr_b16 a[118:119], v229 offset:25280
  s_add_u32 s100, s98, 4194304
  s_lshr_b32 s34, s33, 1
  v_mfma_f32_16x16x32_bf16 v[168:171], a[64:67], a[28:31], v[168:171]
  s_add_u32 s34, s34, s32
  s_add_u32 s34, s34, 48
  v_mfma_f32_16x16x32_bf16 v[4:7], a[68:71], a[16:19], v[4:7]
  s_lshl_b32 s101, s34, 17
  s_and_b32 s35, s31, 1
  v_mfma_f32_16x16x32_bf16 v[60:63], a[68:71], a[20:23], v[60:63]
  s_lshl_b32 s35, s35, 10
  s_add_u32 s101, s101, s35
  v_mfma_f32_16x16x32_bf16 v[116:119], a[68:71], a[24:27], v[116:119]
  ds_read_b64_tr_b16 a[64:65], v229 offset:28672
  ds_read_b64_tr_b16 a[66:67], v229 offset:32256
  s_lshl_b32 s92, s30, 2
  s_add_u32 s92, s92, s3
  v_mfma_f32_16x16x32_bf16 v[172:175], a[68:71], a[28:31], v[172:175]
  s_lshl_b32 s92, s92, 5
  s_add_u32 s92, s92, s31
  v_mfma_f32_16x16x32_bf16 v[8:11], a[72:75], a[16:19], v[8:11]
  s_lshl_b32 s92, s92, 6
  s_add_u32 s56, s20, 0x80000
  v_mfma_f32_16x16x32_bf16 v[64:67], a[72:75], a[20:23], v[64:67]
  s_addc_u32 s57, s21, 0
  s_mov_b32 s58, 0x30000
  v_mfma_f32_16x16x32_bf16 v[120:123], a[72:75], a[24:27], v[120:123]
  ds_read_b64_tr_b16 a[68:69], v229 offset:28704
  ds_read_b64_tr_b16 a[70:71], v229 offset:32288
  s_mov_b32 s59, 0x20000
  s_and_b32 s28, s2, 1
  v_mfma_f32_16x16x32_bf16 v[176:179], a[72:75], a[28:31], v[176:179]
  s_lshr_b32 s29, s2, 3
  s_bfe_u32 s30, s2, 0x20001
  v_mfma_f32_16x16x32_bf16 v[12:15], a[76:79], a[16:19], v[12:15]
  s_lshl_b32 s30, s30, 2
  s_and_b32 s31, s29, 3
  v_mfma_f32_16x16x32_bf16 v[68:71], a[76:79], a[20:23], v[68:71]
  s_add_u32 s30, s30, s31
  s_lshr_b32 s29, s29, 2
  v_mfma_f32_16x16x32_bf16 v[124:127], a[76:79], a[24:27], v[124:127]
  ds_read_b64_tr_b16 a[72:73], v229 offset:28736
  ds_read_b64_tr_b16 a[74:75], v229 offset:32320
  s_lshl_b32 s31, s29, 1
  s_add_u32 s31, s31, s28
  v_mfma_f32_16x16x32_bf16 v[180:183], a[76:79], a[28:31], v[180:183]
  s_lshl_b32 s94, s30, 1
  s_lshr_b32 s33, s3, 1
  v_mfma_f32_16x16x32_bf16 v[16:19], a[80:83], a[16:19], v[16:19]
  s_add_u32 s94, s94, s33
  s_lshl_b32 s94, s94, 11
  v_mfma_f32_16x16x32_bf16 v[72:75], a[80:83], a[20:23], v[72:75]
  s_lshl_b32 s33, s28, 10
  s_add_u32 s94, s94, s33
  v_mfma_f32_16x16x32_bf16 v[128:131], a[80:83], a[24:27], v[128:131]
  ds_read_b64_tr_b16 a[76:77], v229 offset:28768
  ds_read_b64_tr_b16 a[78:79], v229 offset:32352
  v_and_b32 v246, 15, v231
  v_lshlrev_b32 v246, 6, v246
  v_mfma_f32_16x16x32_bf16 v[184:187], a[80:83], a[28:31], v[184:187]
  s_lshl_b32 s32, s30, 13
  s_lshl_b32 s33, s3, 11
  v_mfma_f32_16x16x32_bf16 v[20:23], a[84:87], a[16:19], v[20:23]
  s_add_u32 s32, s32, s33
  v_lshlrev_b32 v240, 4, v231
  v_mfma_f32_16x16x32_bf16 v[76:79], a[84:87], a[20:23], v[76:79]
  v_add_u32 v240, s32, v240
  v_add_u32 v241, 131072, v240
  v_mfma_f32_16x16x32_bf16 v[132:135], a[84:87], a[24:27], v[132:135]
  ds_read_b64_tr_b16 a[80:81], v229 offset:28800
  ds_read_b64_tr_b16 a[82:83], v229 offset:32384
  v_lshrrev_b32 v232, 3, v231
  v_and_b32 v233, 6, v232
  v_mfma_f32_16x16x32_bf16 v[188:191], a[84:87], a[28:31], v[188:191]
  v_and_b32 v234, 7, v231
  v_xor_b32 v233, v233, v234
  v_mfma_f32_16x16x32_bf16 v[24:27], a[88:91], a[16:19], v[24:27]
  v_lshlrev_b32 v232, 11, v232
  v_lshl_add_u32 v232, v233, 4, v232
  v_mfma_f32_16x16x32_bf16 v[80:83], a[88:91], a[20:23], v[80:83]
  s_lshl_b32 s32, s3, 15
  s_add_u32 s32, s32, 4096
  v_mfma_f32_16x16x32_bf16 v[136:139], a[88:91], a[24:27], v[136:139]
  ds_read_b64_tr_b16 a[84:85], v229 offset:28832
  ds_read_b64_tr_b16 a[86:87], v229 offset:32416
  s_lshl_b32 s33, s31, 7
  s_add_u32 s34, s32, s33
  v_mfma_f32_16x16x32_bf16 v[192:195], a[88:91], a[28:31], v[192:195]
  s_xor_b32 s33, s33, 128
  s_add_u32 s35, s32, s33
  v_mfma_f32_16x16x32_bf16 v[28:31], a[92:95], a[16:19], v[28:31]
  v_add_u32 v225, s34, v232
  v_add_u32 v226, 15360, v225
  v_mfma_f32_16x16x32_bf16 v[84:87], a[92:95], a[20:23], v[84:87]
  v_add_u32 v227, s35, v232
  v_add_u32 v228, 13312, v227
  v_mfma_f32_16x16x32_bf16 v[140:143], a[92:95], a[24:27], v[140:143]
  ds_read_b64_tr_b16 a[88:89], v229 offset:28864
  ds_read_b64_tr_b16 a[90:91], v229 offset:32448
  v_subrev_u32 v227, 2048, v227
  s_lshl_b32 s38, s3, 12
  v_mfma_f32_16x16x32_bf16 v[196:199], a[92:95], a[28:31], v[196:199]
  s_add_u32 s38, s38, 57344
  s_mul_i32 s16, s28, 7340032
  s_waitcnt lgkmcnt(10)
  v_mfma_f32_16x16x32_bf16 v[32:35], a[96:99], a[16:19], v[32:35]
  s_mul_i32 s17, s28, 3670016
  s_lshr_b32 s33, s3, 1
  v_mfma_f32_16x16x32_bf16 v[88:91], a[96:99], a[20:23], v[88:91]
  s_mul_i32 s33, s33, 196608
  s_add_u32 s17, s17, s33
  v_mfma_f32_16x16x32_bf16 v[144:147], a[96:99], a[24:27], v[144:147]
  ds_read_b64_tr_b16 a[92:93], v229 offset:35840
  ds_read_b64_tr_b16 a[94:95], v229 offset:39424
  s_add_u32 s97, s17, s33
  s_add_u32 s97, s97, 196608
  v_mfma_f32_16x16x32_bf16 v[200:203], a[96:99], a[28:31], v[200:203]
  s_lshr_b32 s33, s2, 5
  s_mul_i32 s33, s33, 2
  v_mfma_f32_16x16x32_bf16 v[36:39], a[100:103], a[16:19], v[36:39]
  s_bfe_u32 s34, s2, 0x20003
  s_mul_i32 s34, s34, 1
  v_mfma_f32_16x16x32_bf16 v[92:95], a[100:103], a[20:23], v[92:95]
  s_add_u32 s33, s33, s34
  s_and_b32 s33, s33, 7
  v_mfma_f32_16x16x32_bf16 v[148:151], a[100:103], a[24:27], v[148:151]
  ds_read_b64_tr_b16 a[96:97], v229 offset:35872
  ds_read_b64_tr_b16 a[98:99], v229 offset:39456
  s_mov_b32 s95, s17
  s_add_u32 s93, s17, 3670016
  v_mfma_f32_16x16x32_bf16 v[204:207], a[100:103], a[28:31], v[204:207]
  s_mul_i32 s34, s33, 458752
  s_add_u32 s17, s17, s34
  v_mfma_f32_16x16x32_bf16 v[40:43], a[104:107], a[16:19], v[40:43]
  s_mov_b32 s40, s16
  s_lshl_b32 s41, s33, 18
  v_mfma_f32_16x16x32_bf16 v[96:99], a[104:107], a[20:23], v[96:99]
  s_add_u32 s16, s40, s41
  s_sub_u32 s8, s22, 4096
  v_mfma_f32_16x16x32_bf16 v[152:155], a[104:107], a[24:27], v[152:155]
  ds_read_b64_tr_b16 a[100:101], v229 offset:35904
  ds_read_b64_tr_b16 a[102:103], v229 offset:39488
  s_subb_u32 s9, s23, 0
  s_mov_b32 s10, 7344128
  v_mfma_f32_16x16x32_bf16 v[208:211], a[104:107], a[28:31], v[208:211]
  s_add_u32 s4, s20, 0x1600000
  s_addc_u32 s5, s21, 0
  v_mfma_f32_16x16x32_bf16 v[44:47], a[108:111], a[16:19], v[44:47]
  s_mov_b32 s6, 0xe00000
  s_mov_b32 s7, 0x20000
  v_mfma_f32_16x16x32_bf16 v[100:103], a[108:111], a[20:23], v[100:103]
  v_lshrrev_b32 v232, 2, v231
  v_lshlrev_b32 v232, 7, v232
  v_mfma_f32_16x16x32_bf16 v[156:159], a[108:111], a[24:27], v[156:159]
  ds_read_b64_tr_b16 a[104:105], v229 offset:35936
  ds_read_b64_tr_b16 a[106:107], v229 offset:39520
  v_bfe_u32 v233, v231, 3, 2
  v_lshl_add_u32 v232, v233, 5, v232
  v_mfma_f32_16x16x32_bf16 v[212:215], a[108:111], a[28:31], v[212:215]
  v_and_b32 v233, 3, v231
  v_lshl_add_u32 v232, v233, 3, v232
  v_mfma_f32_16x16x32_bf16 v[48:51], a[112:115], a[16:19], v[48:51]
  v_xor_b32 v242, 0, v232
  v_add_u32 v242, 57344, v242
  v_mfma_f32_16x16x32_bf16 v[104:107], a[112:115], a[20:23], v[104:107]
  v_xor_b32 v243, 32, v232
  v_add_u32 v243, 57344, v243
  v_mfma_f32_16x16x32_bf16 v[160:163], a[112:115], a[24:27], v[160:163]
  ds_read_b64_tr_b16 a[108:109], v229 offset:35968
  ds_read_b64_tr_b16 a[110:111], v229 offset:39552
  v_xor_b32 v244, 64, v232
  v_add_u32 v244, 57344, v244
  v_mfma_f32_16x16x32_bf16 v[216:219], a[112:115], a[28:31], v[216:219]
  v_xor_b32 v245, 96, v232
  v_add_u32 v245, 57344, v245
  v_mfma_f32_16x16x32_bf16 v[52:55], a[116:119], a[16:19], v[52:55]
  s_mov_b32 s42, 0xbfb8aa3b
  s_mov_b32 s43, 0xbfb8aa3b
  v_mfma_f32_16x16x32_bf16 v[108:111], a[116:119], a[20:23], v[108:111]
  s_mov_b32 s62, 1.0
  s_mov_b32 s63, 1.0
  v_mfma_f32_16x16x32_bf16 v[164:167], a[116:119], a[24:27], v[164:167]
  ds_read_b64_tr_b16 a[112:113], v229 offset:36000
  ds_read_b64_tr_b16 a[114:115], v229 offset:39584
  v_mfma_f32_16x16x32_bf16 v[220:223], a[116:119], a[28:31], v[220:223]
  s_waitcnt vmcnt(5) lgkmcnt(10)
  s_barrier
  v_mfma_f32_16x16x32_bf16 v[0:3], a[64:67], a[32:35], v[0:3]
  ds_read_b64_tr_b16 a[116:117], v229 offset:36032
  ds_read_b64_tr_b16 a[118:119], v229 offset:39616
  v_mfma_f32_16x16x32_bf16 v[56:59], a[64:67], a[36:39], v[56:59]
  s_add_u32 m0, s38, 0
  s_nop 0
  buffer_load_dwordx4 v225, s[8:11], s17 offen lds
  v_mfma_f32_16x16x32_bf16 v[112:115], a[64:67], a[40:43], v[112:115]
  v_mfma_f32_16x16x32_bf16 v[168:171], a[64:67], a[44:47], v[168:171]
  ds_read_b64_tr_b16 a[64:65], v229 offset:43008
  ds_read_b64_tr_b16 a[66:67], v229 offset:46592
  v_mfma_f32_16x16x32_bf16 v[4:7], a[68:71], a[32:35], v[4:7]
  buffer_load_dwordx4 v226, s[8:11], s17 offen offset:1024 lds
  v_mfma_f32_16x16x32_bf16 v[60:63], a[68:71], a[36:39], v[60:63]
  v_mfma_f32_16x16x32_bf16 v[116:119], a[68:71], a[40:43], v[116:119]
  v_mfma_f32_16x16x32_bf16 v[172:175], a[68:71], a[44:47], v[172:175]
  buffer_load_dwordx4 v227, s[8:11], s17 offen offset:2048 lds
  v_mfma_f32_16x16x32_bf16 v[8:11], a[72:75], a[32:35], v[8:11]
  ds_read_b64_tr_b16 a[68:69], v229 offset:43040
  ds_read_b64_tr_b16 a[70:71], v229 offset:46624
  v_mfma_f32_16x16x32_bf16 v[64:67], a[72:75], a[36:39], v[64:67]
  v_mfma_f32_16x16x32_bf16 v[120:123], a[72:75], a[40:43], v[120:123]
  buffer_load_dwordx4 v228, s[8:11], s17 offen offset:3072 lds
  s_add_u32 s17, s17, 458752
  s_cmp_eq_u32 s17, s93
  s_cselect_b32 s17, s95, s17
  v_mfma_f32_16x16x32_bf16 v[176:179], a[72:75], a[44:47], v[176:179]
  ds_read_b64_tr_b16 a[72:73], v229 offset:50176
  ds_read_b64_tr_b16 a[74:75], v229 offset:53760
  v_mfma_f32_16x16x32_bf16 v[12:15], a[76:79], a[32:35], v[12:15]
  v_mfma_f32_16x16x32_bf16 v[68:71], a[76:79], a[36:39], v[68:71]
  s_add_u32 m0, s38, 16384
  s_nop 0
  buffer_load_dwordx4 v225, s[8:11], s17 offen lds
  v_mfma_f32_16x16x32_bf16 v[124:127], a[76:79], a[40:43], v[124:127]
  v_mfma_f32_16x16x32_bf16 v[180:183], a[76:79], a[44:47], v[180:183]
  ds_read_b64_tr_b16 a[76:77], v229 offset:50208
  ds_read_b64_tr_b16 a[78:79], v229 offset:53792
  v_mfma_f32_16x16x32_bf16 v[16:19], a[80:83], a[32:35], v[16:19]
  buffer_load_dwordx4 v226, s[8:11], s17 offen offset:1024 lds
  v_mfma_f32_16x16x32_bf16 v[72:75], a[80:83], a[36:39], v[72:75]
  v_mfma_f32_16x16x32_bf16 v[128:131], a[80:83], a[40:43], v[128:131]
  v_mfma_f32_16x16x32_bf16 v[184:187], a[80:83], a[44:47], v[184:187]
  buffer_load_dwordx4 v227, s[8:11], s17 offen offset:2048 lds
  v_mfma_f32_16x16x32_bf16 v[20:23], a[84:87], a[32:35], v[20:23]
  ds_read_b64_tr_b16 a[80:81], v229 offset:43072
  ds_read_b64_tr_b16 a[82:83], v229 offset:46656
  v_mfma_f32_16x16x32_bf16 v[76:79], a[84:87], a[36:39], v[76:79]
  v_mfma_f32_16x16x32_bf16 v[132:135], a[84:87], a[40:43], v[132:135]
  buffer_load_dwordx4 v228, s[8:11], s17 offen offset:3072 lds
  s_add_u32 s17, s17, 458752
  s_cmp_eq_u32 s17, s93
  s_cselect_b32 s17, s95, s17
  v_mfma_f32_16x16x32_bf16 v[188:191], a[84:87], a[44:47], v[188:191]
  ds_read_b64_tr_b16 a[84:85], v229 offset:43104
  ds_read_b64_tr_b16 a[86:87], v229 offset:46688
  v_mfma_f32_16x16x32_bf16 v[24:27], a[88:91], a[32:35], v[24:27]
  v_mfma_f32_16x16x32_bf16 v[80:83], a[88:91], a[36:39], v[80:83]
  s_add_u32 m0, s38, 32768
  s_nop 0
  buffer_load_dwordx4 v225, s[8:11], s17 offen lds
  v_mfma_f32_16x16x32_bf16 v[136:139], a[88:91], a[40:43], v[136:139]
  v_mfma_f32_16x16x32_bf16 v[192:195], a[88:91], a[44:47], v[192:195]
  ds_read_b64_tr_b16 a[88:89], v229 offset:50240
  ds_read_b64_tr_b16 a[90:91], v229 offset:53824
  v_mfma_f32_16x16x32_bf16 v[28:31], a[92:95], a[32:35], v[28:31]
  buffer_load_dwordx4 v226, s[8:11], s17 offen offset:1024 lds
  v_mfma_f32_16x16x32_bf16 v[84:87], a[92:95], a[36:39], v[84:87]
  v_mfma_f32_16x16x32_bf16 v[140:143], a[92:95], a[40:43], v[140:143]
  v_mfma_f32_16x16x32_bf16 v[196:199], a[92:95], a[44:47], v[196:199]
  buffer_load_dwordx4 v227, s[8:11], s17 offen offset:2048 lds
  s_waitcnt lgkmcnt(10)
  v_mfma_f32_16x16x32_bf16 v[32:35], a[96:99], a[32:35], v[32:35]
  ds_read_b64_tr_b16 a[92:93], v229 offset:50272
  ds_read_b64_tr_b16 a[94:95], v229 offset:53856
  v_mfma_f32_16x16x32_bf16 v[88:91], a[96:99], a[36:39], v[88:91]
  v_mfma_f32_16x16x32_bf16 v[144:147], a[96:99], a[40:43], v[144:147]
  buffer_load_dwordx4 v228, s[8:11], s17 offen offset:3072 lds
  s_add_u32 s17, s17, 458752
  s_cmp_eq_u32 s17, s93
  s_cselect_b32 s17, s95, s17
  v_mfma_f32_16x16x32_bf16 v[200:203], a[96:99], a[44:47], v[200:203]
  ds_read_b64_tr_b16 a[96:97], v229 offset:43136
  ds_read_b64_tr_b16 a[98:99], v229 offset:46720
  v_mfma_f32_16x16x32_bf16 v[36:39], a[100:103], a[32:35], v[36:39]
  v_mfma_f32_16x16x32_bf16 v[92:95], a[100:103], a[36:39], v[92:95]
  v_mfma_f32_16x16x32_bf16 v[148:151], a[100:103], a[40:43], v[148:151]
  v_mfma_f32_16x16x32_bf16 v[204:207], a[100:103], a[44:47], v[204:207]
  ds_read_b64_tr_b16 a[100:101], v229 offset:43168
  ds_read_b64_tr_b16 a[102:103], v229 offset:46752
  v_mfma_f32_16x16x32_bf16 v[40:43], a[104:107], a[32:35], v[40:43]
  v_mfma_f32_16x16x32_bf16 v[96:99], a[104:107], a[36:39], v[96:99]
  v_mfma_f32_16x16x32_bf16 v[152:155], a[104:107], a[40:43], v[152:155]
  v_mfma_f32_16x16x32_bf16 v[208:211], a[104:107], a[44:47], v[208:211]
  ds_read_b64_tr_b16 a[104:105], v229 offset:43200
  ds_read_b64_tr_b16 a[106:107], v229 offset:46784
  v_mfma_f32_16x16x32_bf16 v[44:47], a[108:111], a[32:35], v[44:47]
  v_mfma_f32_16x16x32_bf16 v[100:103], a[108:111], a[36:39], v[100:103]
  v_mfma_f32_16x16x32_bf16 v[156:159], a[108:111], a[40:43], v[156:159]
  v_mfma_f32_16x16x32_bf16 v[212:215], a[108:111], a[44:47], v[212:215]
  ds_read_b64_tr_b16 a[108:109], v229 offset:50304
  ds_read_b64_tr_b16 a[110:111], v229 offset:53888
  v_mfma_f32_16x16x32_bf16 v[48:51], a[112:115], a[32:35], v[48:51]
  v_mfma_f32_16x16x32_bf16 v[104:107], a[112:115], a[36:39], v[104:107]
  v_mfma_f32_16x16x32_bf16 v[160:163], a[112:115], a[40:43], v[160:163]
  v_mfma_f32_16x16x32_bf16 v[216:219], a[112:115], a[44:47], v[216:219]
  ds_read_b64_tr_b16 a[112:113], v229 offset:50336
  ds_read_b64_tr_b16 a[114:115], v229 offset:53920
  v_mfma_f32_16x16x32_bf16 v[52:55], a[116:119], a[32:35], v[52:55]
  v_mfma_f32_16x16x32_bf16 v[108:111], a[116:119], a[36:39], v[108:111]
  v_mfma_f32_16x16x32_bf16 v[164:167], a[116:119], a[40:43], v[164:167]
  v_mfma_f32_16x16x32_bf16 v[220:223], a[116:119], a[44:47], v[220:223]
  s_waitcnt vmcnt(13) lgkmcnt(10)
  s_barrier
  v_mfma_f32_16x16x32_bf16 v[0:3], a[64:67], a[48:51], v[0:3]
  ds_read_b64_tr_b16 a[116:117], v229 offset:50368
  ds_read_b64_tr_b16 a[118:119], v229 offset:53952
  v_mfma_f32_16x16x32_bf16 v[56:59], a[64:67], a[52:55], v[56:59]
  v_mfma_f32_16x16x32_bf16 v[112:115], a[64:67], a[56:59], v[112:115]
  v_mfma_f32_16x16x32_bf16 v[168:171], a[64:67], a[60:63], v[168:171]
  v_mfma_f32_16x16x32_bf16 v[4:7], a[68:71], a[48:51], v[4:7]
  v_mfma_f32_16x16x32_bf16 v[60:63], a[68:71], a[52:55], v[60:63]
  v_mfma_f32_16x16x32_bf16 v[116:119], a[68:71], a[56:59], v[116:119]
  v_mfma_f32_16x16x32_bf16 v[172:175], a[68:71], a[60:63], v[172:175]
  v_mfma_f32_16x16x32_bf16 v[28:31], a[72:75], a[48:51], v[28:31]
  v_mfma_f32_16x16x32_bf16 v[84:87], a[72:75], a[52:55], v[84:87]
  v_mfma_f32_16x16x32_bf16 v[140:143], a[72:75], a[56:59], v[140:143]
  v_mfma_f32_16x16x32_bf16 v[196:199], a[72:75], a[60:63], v[196:199]
  v_mfma_f32_16x16x32_bf16 v[32:35], a[76:79], a[48:51], v[32:35]
  v_mfma_f32_16x16x32_bf16 v[88:91], a[76:79], a[52:55], v[88:91]
  v_mfma_f32_16x16x32_bf16 v[144:147], a[76:79], a[56:59], v[144:147]
  v_mfma_f32_16x16x32_bf16 v[200:203], a[76:79], a[60:63], v[200:203]
  v_mfma_f32_16x16x32_bf16 v[8:11], a[80:83], a[48:51], v[8:11]
  v_mfma_f32_16x16x32_bf16 v[64:67], a[80:83], a[52:55], v[64:67]
  v_mfma_f32_16x16x32_bf16 v[120:123], a[80:83], a[56:59], v[120:123]
  v_mfma_f32_16x16x32_bf16 v[176:179], a[80:83], a[60:63], v[176:179]
  v_mfma_f32_16x16x32_bf16 v[12:15], a[84:87], a[48:51], v[12:15]
  v_mfma_f32_16x16x32_bf16 v[68:71], a[84:87], a[52:55], v[68:71]
  v_mfma_f32_16x16x32_bf16 v[124:127], a[84:87], a[56:59], v[124:127]
  v_mfma_f32_16x16x32_bf16 v[180:183], a[84:87], a[60:63], v[180:183]
  v_mfma_f32_16x16x32_bf16 v[36:39], a[88:91], a[48:51], v[36:39]
  v_mfma_f32_16x16x32_bf16 v[92:95], a[88:91], a[52:55], v[92:95]
  v_mfma_f32_16x16x32_bf16 v[148:151], a[88:91], a[56:59], v[148:151]
  v_mfma_f32_16x16x32_bf16 v[204:207], a[88:91], a[60:63], v[204:207]
  v_mfma_f32_16x16x32_bf16 v[40:43], a[92:95], a[48:51], v[40:43]
  v_mfma_f32_16x16x32_bf16 v[96:99], a[92:95], a[52:55], v[96:99]
  v_mfma_f32_16x16x32_bf16 v[152:155], a[92:95], a[56:59], v[152:155]
  v_mfma_f32_16x16x32_bf16 v[208:211], a[92:95], a[60:63], v[208:211]
  s_waitcnt lgkmcnt(10)
  v_mfma_f32_16x16x32_bf16 v[16:19], a[96:99], a[48:51], v[16:19]
  v_mfma_f32_16x16x32_bf16 v[72:75], a[96:99], a[52:55], v[72:75]
  v_mfma_f32_16x16x32_bf16 v[128:131], a[96:99], a[56:59], v[128:131]
  v_mfma_f32_16x16x32_bf16 v[184:187], a[96:99], a[60:63], v[184:187]
  s_waitcnt lgkmcnt(8)
  v_mfma_f32_16x16x32_bf16 v[20:23], a[100:103], a[48:51], v[20:23]
  v_mfma_f32_16x16x32_bf16 v[76:79], a[100:103], a[52:55], v[76:79]
  v_mfma_f32_16x16x32_bf16 v[132:135], a[100:103], a[56:59], v[132:135]
  v_mfma_f32_16x16x32_bf16 v[188:191], a[100:103], a[60:63], v[188:191]
  s_waitcnt lgkmcnt(6)
  v_mfma_f32_16x16x32_bf16 v[24:27], a[104:107], a[48:51], v[24:27]
  v_mfma_f32_16x16x32_bf16 v[80:83], a[104:107], a[52:55], v[80:83]
  v_mfma_f32_16x16x32_bf16 v[136:139], a[104:107], a[56:59], v[136:139]
  v_mfma_f32_16x16x32_bf16 v[192:195], a[104:107], a[60:63], v[192:195]
  s_waitcnt lgkmcnt(4)
  v_mfma_f32_16x16x32_bf16 v[44:47], a[108:111], a[48:51], v[44:47]
  v_mfma_f32_16x16x32_bf16 v[100:103], a[108:111], a[52:55], v[100:103]
  v_mfma_f32_16x16x32_bf16 v[156:159], a[108:111], a[56:59], v[156:159]
  v_mfma_f32_16x16x32_bf16 v[212:215], a[108:111], a[60:63], v[212:215]
  s_waitcnt lgkmcnt(2)
  v_mfma_f32_16x16x32_bf16 v[48:51], a[112:115], a[48:51], v[48:51]
  v_mfma_f32_16x16x32_bf16 v[104:107], a[112:115], a[52:55], v[104:107]
  v_mfma_f32_16x16x32_bf16 v[160:163], a[112:115], a[56:59], v[160:163]
  v_mfma_f32_16x16x32_bf16 v[216:219], a[112:115], a[60:63], v[216:219]
  s_waitcnt lgkmcnt(0)
  v_mfma_f32_16x16x32_bf16 v[52:55], a[116:119], a[48:51], v[52:55]
  v_mfma_f32_16x16x32_bf16 v[108:111], a[116:119], a[52:55], v[108:111]
  v_mfma_f32_16x16x32_bf16 v[164:167], a[116:119], a[56:59], v[164:167]
  v_mfma_f32_16x16x32_bf16 v[220:223], a[116:119], a[60:63], v[220:223]
  s_nop 7
  s_nop 1
L_k56_seam:
  v_pk_mul_f32 v[232:233], v[0:1], s[42:43]
  v_pk_mul_f32 v[234:235], v[2:3], s[42:43]
  v_exp_f32 v232, v232
  v_exp_f32 v233, v233
  v_exp_f32 v234, v234
  v_exp_f32 v235, v235
  v_pk_add_f32 v[232:233], v[232:233], s[62:63]
  v_pk_add_f32 v[234:235], v[234:235], s[62:63]
  v_rcp_f32 v232, v232
  v_rcp_f32 v233, v233
  v_rcp_f32 v234, v234
  v_rcp_f32 v235, v235
  v_pk_mul_f32 v[232:233], v[232:233], v[28:29]
  v_pk_mul_f32 v[234:235], v[234:235], v[30:31]
  v_cvt_pk_bf16_f32 v0, v232, v233
  v_cvt_pk_bf16_f32 v1, v234, v235
  v_pk_mul_f32 v[236:237], v[4:5], s[42:43]
  v_pk_mul_f32 v[238:239], v[6:7], s[42:43]
  v_exp_f32 v236, v236
  v_exp_f32 v237, v237
  v_exp_f32 v238, v238
  v_exp_f32 v239, v239
  v_pk_add_f32 v[236:237], v[236:237], s[62:63]
  v_pk_add_f32 v[238:239], v[238:239], s[62:63]
  v_rcp_f32 v236, v236
  v_rcp_f32 v237, v237
  v_rcp_f32 v238, v238
  v_rcp_f32 v239, v239
  v_pk_mul_f32 v[236:237], v[236:237], v[32:33]
  v_pk_mul_f32 v[238:239], v[238:239], v[34:35]
  v_cvt_pk_bf16_f32 v2, v236, v237
  v_cvt_pk_bf16_f32 v3, v238, v239
  buffer_store_dwordx4 v[0:3], v224, s[12:15], s98 offen offset:0 sc1
  v_pk_mul_f32 v[232:233], v[56:57], s[42:43]
  v_pk_mul_f32 v[234:235], v[58:59], s[42:43]
  v_exp_f32 v232, v232
  v_exp_f32 v233, v233
  v_exp_f32 v234, v234
  v_exp_f32 v235, v235
  v_pk_add_f32 v[232:233], v[232:233], s[62:63]
  v_pk_add_f32 v[234:235], v[234:235], s[62:63]
  v_rcp_f32 v232, v232
  v_rcp_f32 v233, v233
  v_rcp_f32 v234, v234
  v_rcp_f32 v235, v235
  v_pk_mul_f32 v[232:233], v[232:233], v[84:85]
  v_pk_mul_f32 v[234:235], v[234:235], v[86:87]
  v_cvt_pk_bf16_f32 v56, v232, v233
  v_cvt_pk_bf16_f32 v57, v234, v235
  v_pk_mul_f32 v[236:237], v[60:61], s[42:43]
  v_pk_mul_f32 v[238:239], v[62:63], s[42:43]
  v_exp_f32 v236, v236
  v_exp_f32 v237, v237
  v_exp_f32 v238, v238
  v_exp_f32 v239, v239
  v_pk_add_f32 v[236:237], v[236:237], s[62:63]
  v_pk_add_f32 v[238:239], v[238:239], s[62:63]
  v_rcp_f32 v236, v236
  v_rcp_f32 v237, v237
  v_rcp_f32 v238, v238
  v_rcp_f32 v239, v239
  v_pk_mul_f32 v[236:237], v[236:237], v[88:89]
  v_pk_mul_f32 v[238:239], v[238:239], v[90:91]
  v_cvt_pk_bf16_f32 v58, v236, v237
  v_cvt_pk_bf16_f32 v59, v238, v239
  buffer_store_dwordx4 v[56:59], v224, s[12:15], s98 offen offset:1024 sc1
  v_pk_mul_f32 v[232:233], v[112:113], s[42:43]
  v_pk_mul_f32 v[234:235], v[114:115], s[42:43]
  v_exp_f32 v232, v232
  v_exp_f32 v233, v233
  v_exp_f32 v234, v234
  v_exp_f32 v235, v235
  v_pk_add_f32 v[232:233], v[232:233], s[62:63]
  v_pk_add_f32 v[234:235], v[234:235], s[62:63]
  v_rcp_f32 v232, v232
  v_rcp_f32 v233, v233
  v_rcp_f32 v234, v234
  v_rcp_f32 v235, v235
  v_pk_mul_f32 v[232:233], v[232:233], v[140:141]
  v_pk_mul_f32 v[234:235], v[234:235], v[142:143]
  v_cvt_pk_bf16_f32 v112, v232, v233
  v_cvt_pk_bf16_f32 v113, v234, v235
  v_pk_mul_f32 v[236:237], v[116:117], s[42:43]
  v_pk_mul_f32 v[238:239], v[118:119], s[42:43]
  v_exp_f32 v236, v236
  v_exp_f32 v237, v237
  v_exp_f32 v238, v238
  v_exp_f32 v239, v239
  v_pk_add_f32 v[236:237], v[236:237], s[62:63]
  v_pk_add_f32 v[238:239], v[238:239], s[62:63]
  v_rcp_f32 v236, v236
  v_rcp_f32 v237, v237
  v_rcp_f32 v238, v238
  v_rcp_f32 v239, v239
  v_pk_mul_f32 v[236:237], v[236:237], v[144:145]
  v_pk_mul_f32 v[238:239], v[238:239], v[146:147]
  v_cvt_pk_bf16_f32 v114, v236, v237
  v_cvt_pk_bf16_f32 v115, v238, v239
  buffer_store_dwordx4 v[112:115], v224, s[12:15], s98 offen offset:2048 sc1
  v_pk_mul_f32 v[232:233], v[168:169], s[42:43]
  v_pk_mul_f32 v[234:235], v[170:171], s[42:43]
  v_exp_f32 v232, v232
  v_exp_f32 v233, v233
  v_exp_f32 v234, v234
  v_exp_f32 v235, v235
  v_pk_add_f32 v[232:233], v[232:233], s[62:63]
  v_pk_add_f32 v[234:235], v[234:235], s[62:63]
  v_rcp_f32 v232, v232
  v_rcp_f32 v233, v233
  v_rcp_f32 v234, v234
  v_rcp_f32 v235, v235
  v_pk_mul_f32 v[232:233], v[232:233], v[196:197]
  v_pk_mul_f32 v[234:235], v[234:235], v[198:199]
  v_cvt_pk_bf16_f32 v168, v232, v233
  v_cvt_pk_bf16_f32 v169, v234, v235
  v_pk_mul_f32 v[236:237], v[172:173], s[42:43]
  v_pk_mul_f32 v[238:239], v[174:175], s[42:43]
  v_exp_f32 v236, v236
  v_exp_f32 v237, v237
  v_exp_f32 v238, v238
  v_exp_f32 v239, v239
  v_pk_add_f32 v[236:237], v[236:237], s[62:63]
  v_pk_add_f32 v[238:239], v[238:239], s[62:63]
  v_rcp_f32 v236, v236
  v_rcp_f32 v237, v237
  v_rcp_f32 v238, v238
  v_rcp_f32 v239, v239
  v_pk_mul_f32 v[236:237], v[236:237], v[200:201]
  v_pk_mul_f32 v[238:239], v[238:239], v[202:203]
  v_cvt_pk_bf16_f32 v170, v236, v237
  v_cvt_pk_bf16_f32 v171, v238, v239
  buffer_store_dwordx4 v[168:171], v224, s[12:15], s98 offen offset:3072 sc1
  v_pk_mul_f32 v[232:233], v[8:9], s[42:43]
  v_pk_mul_f32 v[234:235], v[10:11], s[42:43]
  v_exp_f32 v232, v232
  v_exp_f32 v233, v233
  v_exp_f32 v234, v234
  v_exp_f32 v235, v235
  v_pk_add_f32 v[232:233], v[232:233], s[62:63]
  v_pk_add_f32 v[234:235], v[234:235], s[62:63]
  v_rcp_f32 v232, v232
  v_rcp_f32 v233, v233
  v_rcp_f32 v234, v234
  v_rcp_f32 v235, v235
  v_pk_mul_f32 v[232:233], v[232:233], v[36:37]
  v_pk_mul_f32 v[234:235], v[234:235], v[38:39]
  v_cvt_pk_bf16_f32 v4, v232, v233
  v_cvt_pk_bf16_f32 v5, v234, v235
  v_pk_mul_f32 v[236:237], v[12:13], s[42:43]
  v_pk_mul_f32 v[238:239], v[14:15], s[42:43]
  v_exp_f32 v236, v236
  v_exp_f32 v237, v237
  v_exp_f32 v238, v238
  v_exp_f32 v239, v239
  v_pk_add_f32 v[236:237], v[236:237], s[62:63]
  v_pk_add_f32 v[238:239], v[238:239], s[62:63]
  v_rcp_f32 v236, v236
  v_rcp_f32 v237, v237
  v_rcp_f32 v238, v238
  v_rcp_f32 v239, v239
  v_pk_mul_f32 v[236:237], v[236:237], v[40:41]
  v_pk_mul_f32 v[238:239], v[238:239], v[42:43]
  v_cvt_pk_bf16_f32 v6, v236, v237
  v_cvt_pk_bf16_f32 v7, v238, v239
  v_pk_mul_f32 v[232:233], v[64:65], s[42:43]
  v_pk_mul_f32 v[234:235], v[66:67], s[42:43]
  v_exp_f32 v232, v232
  v_exp_f32 v233, v233
  v_exp_f32 v234, v234
  v_exp_f32 v235, v235
  v_pk_add_f32 v[232:233], v[232:233], s[62:63]
  v_pk_add_f32 v[234:235], v[234:235], s[62:63]
  v_rcp_f32 v232, v232
  v_rcp_f32 v233, v233
  v_rcp_f32 v234, v234
  v_rcp_f32 v235, v235
  v_pk_mul_f32 v[232:233], v[232:233], v[92:93]
  v_pk_mul_f32 v[234:235], v[234:235], v[94:95]
  v_cvt_pk_bf16_f32 v60, v232, v233
  v_cvt_pk_bf16_f32 v61, v234, v235
  v_pk_mul_f32 v[236:237], v[68:69], s[42:43]
  v_pk_mul_f32 v[238:239], v[70:71], s[42:43]
  v_exp_f32 v236, v236
  v_exp_f32 v237, v237
  v_exp_f32 v238, v238
  v_exp_f32 v239, v239
  v_pk_add_f32 v[236:237], v[236:237], s[62:63]
  v_pk_add_f32 v[238:239], v[238:239], s[62:63]
  v_rcp_f32 v236, v236
  v_rcp_f32 v237, v237
  v_rcp_f32 v238, v238
  v_rcp_f32 v239, v239
  v_pk_mul_f32 v[236:237], v[236:237], v[96:97]
  v_pk_mul_f32 v[238:239], v[238:239], v[98:99]
  v_cvt_pk_bf16_f32 v62, v236, v237
  v_cvt_pk_bf16_f32 v63, v238, v239
  v_pk_mul_f32 v[232:233], v[120:121], s[42:43]
  v_pk_mul_f32 v[234:235], v[122:123], s[42:43]
  v_exp_f32 v232, v232
  v_exp_f32 v233, v233
  v_exp_f32 v234, v234
  v_exp_f32 v235, v235
  v_pk_add_f32 v[232:233], v[232:233], s[62:63]
  v_pk_add_f32 v[234:235], v[234:235], s[62:63]
  v_rcp_f32 v232, v232
  v_rcp_f32 v233, v233
  v_rcp_f32 v234, v234
  v_rcp_f32 v235, v235
  v_pk_mul_f32 v[232:233], v[232:233], v[148:149]
  v_pk_mul_f32 v[234:235], v[234:235], v[150:151]
  v_cvt_pk_bf16_f32 v116, v232, v233
  v_cvt_pk_bf16_f32 v117, v234, v235
  v_pk_mul_f32 v[236:237], v[124:125], s[42:43]
  v_pk_mul_f32 v[238:239], v[126:127], s[42:43]
  v_exp_f32 v236, v236
  v_exp_f32 v237, v237
  v_exp_f32 v238, v238
  v_exp_f32 v239, v239
  v_pk_add_f32 v[236:237], v[236:237], s[62:63]
  v_pk_add_f32 v[238:239], v[238:239], s[62:63]
  v_rcp_f32 v236, v236
  v_rcp_f32 v237, v237
  v_rcp_f32 v238, v238
  v_rcp_f32 v239, v239
  v_pk_mul_f32 v[236:237], v[236:237], v[152:153]
  v_pk_mul_f32 v[238:239], v[238:239], v[154:155]
  v_cvt_pk_bf16_f32 v118, v236, v237
  v_cvt_pk_bf16_f32 v119, v238, v239
  s_waitcnt vmcnt(0)
  s_mov_b64 exec, 1
  buffer_store_dword v248, v250, s[56:59], s92 offen sc1
  s_mov_b64 exec, -1
  s_add_u32 s92, s92, 65536
  v_pk_mul_f32 v[232:233], v[176:177], s[42:43]
  v_pk_mul_f32 v[234:235], v[178:179], s[42:43]
  v_exp_f32 v232, v232
  v_exp_f32 v233, v233
  v_exp_f32 v234, v234
  v_exp_f32 v235, v235
  v_pk_add_f32 v[232:233], v[232:233], s[62:63]
  v_pk_add_f32 v[234:235], v[234:235], s[62:63]
  v_rcp_f32 v232, v232
  v_rcp_f32 v233, v233
  v_rcp_f32 v234, v234
  v_rcp_f32 v235, v235
  v_pk_mul_f32 v[232:233], v[232:233], v[204:205]
  v_pk_mul_f32 v[234:235], v[234:235], v[206:207]
  v_cvt_pk_bf16_f32 v172, v232, v233
  v_cvt_pk_bf16_f32 v173, v234, v235
  v_pk_mul_f32 v[236:237], v[180:181], s[42:43]
  v_pk_mul_f32 v[238:239], v[182:183], s[42:43]
  v_exp_f32 v236, v236
  v_exp_f32 v237, v237
  v_exp_f32 v238, v238
  v_exp_f32 v239, v239
  v_pk_add_f32 v[236:237], v[236:237], s[62:63]
  v_pk_add_f32 v[238:239], v[238:239], s[62:63]
  v_rcp_f32 v236, v236
  v_rcp_f32 v237, v237
  v_rcp_f32 v238, v238
  v_rcp_f32 v239, v239
  v_pk_mul_f32 v[236:237], v[236:237], v[208:209]
  v_pk_mul_f32 v[238:239], v[238:239], v[210:211]
  v_cvt_pk_bf16_f32 v174, v236, v237
  v_cvt_pk_bf16_f32 v175, v238, v239
  v_pk_mul_f32 v[232:233], v[16:17], s[42:43]
  v_pk_mul_f32 v[234:235], v[18:19], s[42:43]
  v_exp_f32 v232, v232
  v_exp_f32 v233, v233
  v_exp_f32 v234, v234
  v_exp_f32 v235, v235
  v_pk_add_f32 v[232:233], v[232:233], s[62:63]
  v_pk_add_f32 v[234:235], v[234:235], s[62:63]
  v_rcp_f32 v232, v232
  v_rcp_f32 v233, v233
  v_rcp_f32 v234, v234
  v_rcp_f32 v235, v235
  v_pk_mul_f32 v[232:233], v[232:233], v[44:45]
  v_pk_mul_f32 v[234:235], v[234:235], v[46:47]
  v_cvt_pk_bf16_f32 v8, v232, v233
  v_cvt_pk_bf16_f32 v9, v234, v235
  v_pk_mul_f32 v[236:237], v[20:21], s[42:43]
  v_pk_mul_f32 v[238:239], v[22:23], s[42:43]
  v_exp_f32 v236, v236
  v_exp_f32 v237, v237
  v_exp_f32 v238, v238
  v_exp_f32 v239, v239
  v_pk_add_f32 v[236:237], v[236:237], s[62:63]
  v_pk_add_f32 v[238:239], v[238:239], s[62:63]
  v_rcp_f32 v236, v236
  v_rcp_f32 v237, v237
  v_rcp_f32 v238, v238
  v_rcp_f32 v239, v239
  v_pk_mul_f32 v[236:237], v[236:237], v[48:49]
  v_pk_mul_f32 v[238:239], v[238:239], v[50:51]
  v_cvt_pk_bf16_f32 v10, v236, v237
  v_cvt_pk_bf16_f32 v11, v238, v239
  v_pk_mul_f32 v[232:233], v[72:73], s[42:43]
  v_pk_mul_f32 v[234:235], v[74:75], s[42:43]
  v_exp_f32 v232, v232
  v_exp_f32 v233, v233
  v_exp_f32 v234, v234
  v_exp_f32 v235, v235
  v_pk_add_f32 v[232:233], v[232:233], s[62:63]
  v_pk_add_f32 v[234:235], v[234:235], s[62:63]
  v_rcp_f32 v232, v232
  v_rcp_f32 v233, v233
  v_rcp_f32 v234, v234
  v_rcp_f32 v235, v235
  v_pk_mul_f32 v[232:233], v[232:233], v[100:101]
  v_pk_mul_f32 v[234:235], v[234:235], v[102:103]
  v_cvt_pk_bf16_f32 v64, v232, v233
  v_cvt_pk_bf16_f32 v65, v234, v235
  v_pk_mul_f32 v[236:237], v[76:77], s[42:43]
  v_pk_mul_f32 v[238:239], v[78:79], s[42:43]
  v_exp_f32 v236, v236
  v_exp_f32 v237, v237
  v_exp_f32 v238, v238
  v_exp_f32 v239, v239
  v_pk_add_f32 v[236:237], v[236:237], s[62:63]
  v_pk_add_f32 v[238:239], v[238:239], s[62:63]
  v_rcp_f32 v236, v236
  v_rcp_f32 v237, v237
  v_rcp_f32 v238, v238
  v_rcp_f32 v239, v239
  v_pk_mul_f32 v[236:237], v[236:237], v[104:105]
  v_pk_mul_f32 v[238:239], v[238:239], v[106:107]
  v_cvt_pk_bf16_f32 v66, v236, v237
  v_cvt_pk_bf16_f32 v67, v238, v239
  v_pk_mul_f32 v[232:233], v[128:129], s[42:43]
  v_pk_mul_f32 v[234:235], v[130:131], s[42:43]
  v_exp_f32 v232, v232
  v_exp_f32 v233, v233
  v_exp_f32 v234, v234
  v_exp_f32 v235, v235
  v_pk_add_f32 v[232:233], v[232:233], s[62:63]
  v_pk_add_f32 v[234:235], v[234:235], s[62:63]
  v_rcp_f32 v232, v232
  v_rcp_f32 v233, v233
  v_rcp_f32 v234, v234
  v_rcp_f32 v235, v235
  v_pk_mul_f32 v[232:233], v[232:233], v[156:157]
  v_pk_mul_f32 v[234:235], v[234:235], v[158:159]
  v_cvt_pk_bf16_f32 v120, v232, v233
  v_cvt_pk_bf16_f32 v121, v234, v235
  v_pk_mul_f32 v[236:237], v[132:133], s[42:43]
  v_pk_mul_f32 v[238:239], v[134:135], s[42:43]
  v_exp_f32 v236, v236
  v_exp_f32 v237, v237
  v_exp_f32 v238, v238
  v_exp_f32 v239, v239
  v_pk_add_f32 v[236:237], v[236:237], s[62:63]
  v_pk_add_f32 v[238:239], v[238:239], s[62:63]
  v_rcp_f32 v236, v236
  v_rcp_f32 v237, v237
  v_rcp_f32 v238, v238
  v_rcp_f32 v239, v239
  v_pk_mul_f32 v[236:237], v[236:237], v[160:161]
  v_pk_mul_f32 v[238:239], v[238:239], v[162:163]
  v_cvt_pk_bf16_f32 v122, v236, v237
  v_cvt_pk_bf16_f32 v123, v238, v239
  v_pk_mul_f32 v[232:233], v[184:185], s[42:43]
  v_pk_mul_f32 v[234:235], v[186:187], s[42:43]
  v_exp_f32 v232, v232
  v_exp_f32 v233, v233
  v_exp_f32 v234, v234
  v_exp_f32 v235, v235
  v_pk_add_f32 v[232:233], v[232:233], s[62:63]
  v_pk_add_f32 v[234:235], v[234:235], s[62:63]
  v_rcp_f32 v232, v232
  v_rcp_f32 v233, v233
  v_rcp_f32 v234, v234
  v_rcp_f32 v235, v235
  v_pk_mul_f32 v[232:233], v[232:233], v[212:213]
  v_pk_mul_f32 v[234:235], v[234:235], v[214:215]
  v_cvt_pk_bf16_f32 v176, v232, v233
  v_cvt_pk_bf16_f32 v177, v234, v235
  v_pk_mul_f32 v[236:237], v[188:189], s[42:43]
  v_pk_mul_f32 v[238:239], v[190:191], s[42:43]
  v_exp_f32 v236, v236
  v_exp_f32 v237, v237
  v_exp_f32 v238, v238
  v_exp_f32 v239, v239
  v_pk_add_f32 v[236:237], v[236:237], s[62:63]
  v_pk_add_f32 v[238:239], v[238:239], s[62:63]
  v_rcp_f32 v236, v236
  v_rcp_f32 v237, v237
  v_rcp_f32 v238, v238
  v_rcp_f32 v239, v239
  v_pk_mul_f32 v[236:237], v[236:237], v[216:217]
  v_pk_mul_f32 v[238:239], v[238:239], v[218:219]
  v_cvt_pk_bf16_f32 v178, v236, v237
  v_cvt_pk_bf16_f32 v179, v238, v239
  buffer_load_dword v247, v246, s[56:59], s94 offen sc1
  buffer_store_dwordx4 v[4:7], v224, s[12:15], s99 offen offset:0 sc1
  buffer_store_dwordx4 v[60:63], v224, s[12:15], s99 offen offset:1024 sc1
  buffer_store_dwordx4 v[116:119], v224, s[12:15], s99 offen offset:2048 sc1
  buffer_store_dwordx4 v[172:175], v224, s[12:15], s99 offen offset:3072 sc1
  v_pk_mul_f32 v[232:233], v[24:25], s[42:43]
  v_pk_mul_f32 v[234:235], v[26:27], s[42:43]
  v_exp_f32 v232, v232
  v_exp_f32 v233, v233
  v_exp_f32 v234, v234
  v_exp_f32 v235, v235
  v_pk_add_f32 v[232:233], v[232:233], s[62:63]
  v_pk_add_f32 v[234:235], v[234:235], s[62:63]
  v_rcp_f32 v232, v232
  v_rcp_f32 v233, v233
  v_rcp_f32 v234, v234
  v_rcp_f32 v235, v235
  v_pk_mul_f32 v[232:233], v[232:233], v[52:53]
  v_pk_mul_f32 v[234:235], v[234:235], v[54:55]
  v_cvt_pk_bf16_f32 v12, v232, v233
  v_cvt_pk_bf16_f32 v13, v234, v235
  v_pk_mul_f32 v[236:237], v[80:81], s[42:43]
  v_pk_mul_f32 v[238:239], v[82:83], s[42:43]
  v_exp_f32 v236, v236
  v_exp_f32 v237, v237
  v_exp_f32 v238, v238
  v_exp_f32 v239, v239
  v_pk_add_f32 v[236:237], v[236:237], s[62:63]
  v_pk_add_f32 v[238:239], v[238:239], s[62:63]
  v_rcp_f32 v236, v236
  v_rcp_f32 v237, v237
  v_rcp_f32 v238, v238
  v_rcp_f32 v239, v239
  v_pk_mul_f32 v[236:237], v[236:237], v[108:109]
  v_pk_mul_f32 v[238:239], v[238:239], v[110:111]
  v_cvt_pk_bf16_f32 v14, v236, v237
  v_cvt_pk_bf16_f32 v15, v238, v239
  v_pk_mul_f32 v[232:233], v[136:137], s[42:43]
  v_pk_mul_f32 v[234:235], v[138:139], s[42:43]
  v_exp_f32 v232, v232
  v_exp_f32 v233, v233
  v_exp_f32 v234, v234
  v_exp_f32 v235, v235
  v_pk_add_f32 v[232:233], v[232:233], s[62:63]
  v_pk_add_f32 v[234:235], v[234:235], s[62:63]
  v_rcp_f32 v232, v232
  v_rcp_f32 v233, v233
  v_rcp_f32 v234, v234
  v_rcp_f32 v235, v235
  v_pk_mul_f32 v[232:233], v[232:233], v[164:165]
  v_pk_mul_f32 v[234:235], v[234:235], v[166:167]
  v_cvt_pk_bf16_f32 v124, v232, v233
  v_cvt_pk_bf16_f32 v125, v234, v235
  v_pk_mul_f32 v[236:237], v[192:193], s[42:43]
  v_pk_mul_f32 v[238:239], v[194:195], s[42:43]
  v_exp_f32 v236, v236
  v_exp_f32 v237, v237
  v_exp_f32 v238, v238
  v_exp_f32 v239, v239
  v_pk_add_f32 v[236:237], v[236:237], s[62:63]
  v_pk_add_f32 v[238:239], v[238:239], s[62:63]
  v_rcp_f32 v236, v236
  v_rcp_f32 v237, v237
  v_rcp_f32 v238, v238
  v_rcp_f32 v239, v239
  v_pk_mul_f32 v[236:237], v[236:237], v[220:221]
  v_pk_mul_f32 v[238:239], v[238:239], v[222:223]
  v_cvt_pk_bf16_f32 v126, v236, v237
  v_cvt_pk_bf16_f32 v127, v238, v239
  s_waitcnt vmcnt(4)
  v_cmp_ne_u32 vcc, s19, v247
  s_nop 1
  s_cmp_lg_u64 vcc, 0
  s_cbranch_scc1 L_slow_25
  L_back_26:
  s_add_u32 s94, s94, 65536
  buffer_load_dwordx4 a[0:3], v240, s[4:7], s16 offen offset:0 sc1
  buffer_load_dwordx4 a[4:7], v240, s[4:7], s16 offen offset:1024 sc1
  buffer_load_dwordx4 a[8:11], v241, s[4:7], s16 offen offset:0 sc1
  buffer_load_dwordx4 a[12:15], v241, s[4:7], s16 offen offset:1024 sc1
  s_add_u32 s41, s41, 262144
  s_bitset0_b32 s41, 21
  s_add_u32 s16, s40, s41
  buffer_load_dwordx4 a[16:19], v240, s[4:7], s16 offen offset:0 sc1
  buffer_load_dwordx4 a[20:23], v240, s[4:7], s16 offen offset:1024 sc1
  buffer_load_dwordx4 a[24:27], v241, s[4:7], s16 offen offset:0 sc1
  buffer_load_dwordx4 a[28:31], v241, s[4:7], s16 offen offset:1024 sc1
  s_add_u32 s41, s41, 262144
  s_bitset0_b32 s41, 21
  s_add_u32 s16, s40, s41
  buffer_load_dwordx4 a[32:35], v240, s[4:7], s16 offen offset:0 sc1
  buffer_load_dwordx4 a[36:39], v240, s[4:7], s16 offen offset:1024 sc1
  buffer_load_dwordx4 a[40:43], v241, s[4:7], s16 offen offset:0 sc1
  buffer_load_dwordx4 a[44:47], v241, s[4:7], s16 offen offset:1024 sc1
  s_add_u32 s41, s41, 262144
  s_bitset0_b32 s41, 21
  s_add_u32 s16, s40, s41
  s_waitcnt vmcnt(30)
  s_barrier
  ds_read_b64_tr_b16 a[80:81], v242 offset:2048
  ds_read_b64_tr_b16 a[82:83], v242 offset:6144
  ds_read_b64_tr_b16 a[84:85], v243 offset:2048
  ds_read_b64_tr_b16 a[86:87], v243 offset:6144
  ds_read_b64_tr_b16 a[88:89], v244 offset:2048
  ds_read_b64_tr_b16 a[90:91], v244 offset:6144
  ds_read_b64_tr_b16 a[92:93], v245 offset:2048
  ds_read_b64_tr_b16 a[94:95], v245 offset:6144
  ds_read_b64_tr_b16 a[112:113], v242 offset:10240
  ds_read_b64_tr_b16 a[114:115], v242 offset:14336
  ds_read_b64_tr_b16 a[116:117], v243 offset:10240
  ds_read_b64_tr_b16 a[118:119], v243 offset:14336
  ds_read_b64_tr_b16 a[120:121], v244 offset:10240
  ds_read_b64_tr_b16 a[122:123], v244 offset:14336
  ds_read_b64_tr_b16 a[124:125], v245 offset:10240
  ds_read_b64_tr_b16 a[126:127], v245 offset:14336
  ds_read_b64_tr_b16 a[64:65], v242 offset:0
  ds_read_b64_tr_b16 a[66:67], v242 offset:4096
  ds_read_b64_tr_b16 a[68:69], v243 offset:0
  ds_read_b64_tr_b16 a[70:71], v243 offset:4096
  ds_read_b64_tr_b16 a[72:73], v244 offset:0
  ds_read_b64_tr_b16 a[74:75], v244 offset:4096
  ds_read_b64_tr_b16 a[76:77], v245 offset:0
  ds_read_b64_tr_b16 a[78:79], v245 offset:4096
  ds_read_b64_tr_b16 a[96:97], v242 offset:8192
  ds_read_b64_tr_b16 a[98:99], v242 offset:12288
  ds_read_b64_tr_b16 a[100:101], v243 offset:8192
  ds_read_b64_tr_b16 a[102:103], v243 offset:12288
  ds_read_b64_tr_b16 a[104:105], v244 offset:8192
  ds_read_b64_tr_b16 a[106:107], v244 offset:12288
  ds_read_b64_tr_b16 a[108:109], v245 offset:8192
  ds_read_b64_tr_b16 a[110:111], v245 offset:12288
  s_waitcnt vmcnt(8) lgkmcnt(10)
  s_barrier
  s_mov_b64 exec, 1
  buffer_store_dword v248, v250, s[56:59], s92 offen sc1
  s_mov_b64 exec, -1
  s_add_u32 s92, s92, 65536
  v_mfma_f32_16x16x32_bf16 v[72:75], a[80:83], a[0:3], 0
  s_add_u32 m0, s38, 49152
  v_mfma_f32_16x16x32_bf16 v[88:91], a[80:83], a[4:7], 0
  buffer_load_dwordx4 v225, s[8:11], s17 offen lds
  v_mfma_f32_16x16x32_bf16 v[76:79], a[84:87], a[0:3], 0
  ds_read_b64_tr_b16 a[80:81], v242 offset:18432
  ds_read_b64_tr_b16 a[82:83], v242 offset:22528
  v_mfma_f32_16x16x32_bf16 v[92:95], a[84:87], a[4:7], 0
  buffer_load_dwordx4 v226, s[8:11], s17 offen offset:1024 lds
  v_mfma_f32_16x16x32_bf16 v[80:83], a[88:91], a[0:3], 0
  ds_read_b64_tr_b16 a[84:85], v243 offset:18432
  ds_read_b64_tr_b16 a[86:87], v243 offset:22528
  v_mfma_f32_16x16x32_bf16 v[96:99], a[88:91], a[4:7], 0
  buffer_load_dwordx4 v227, s[8:11], s17 offen offset:2048 lds
  v_mfma_f32_16x16x32_bf16 v[84:87], a[92:95], a[0:3], 0
  ds_read_b64_tr_b16 a[88:89], v244 offset:18432
  ds_read_b64_tr_b16 a[90:91], v244 offset:22528
  v_mfma_f32_16x16x32_bf16 v[100:103], a[92:95], a[4:7], 0
  buffer_load_dwordx4 v228, s[8:11], s17 offen offset:3072 lds
  v_mfma_f32_16x16x32_bf16 v[72:75], a[112:115], a[8:11], v[72:75]
  ds_read_b64_tr_b16 a[92:93], v245 offset:18432
  ds_read_b64_tr_b16 a[94:95], v245 offset:22528
  v_mfma_f32_16x16x32_bf16 v[88:91], a[112:115], a[12:15], v[88:91]
  ds_read_b64_tr_b16 a[112:113], v242 offset:26624
  s_add_u32 s17, s17, 458752
  v_mfma_f32_16x16x32_bf16 v[76:79], a[116:119], a[8:11], v[76:79]
  ds_read_b64_tr_b16 a[114:115], v242 offset:30720
  s_cmp_eq_u32 s17, s93
  v_mfma_f32_16x16x32_bf16 v[92:95], a[116:119], a[12:15], v[92:95]
  ds_read_b64_tr_b16 a[116:117], v243 offset:26624
  ds_read_b64_tr_b16 a[118:119], v243 offset:30720
  v_mfma_f32_16x16x32_bf16 v[80:83], a[120:123], a[8:11], v[80:83]
  s_cselect_b32 s17, s95, s17
  v_mfma_f32_16x16x32_bf16 v[96:99], a[120:123], a[12:15], v[96:99]
  ds_read_b64_tr_b16 a[120:121], v244 offset:26624
  ds_read_b64_tr_b16 a[122:123], v244 offset:30720
  v_mfma_f32_16x16x32_bf16 v[84:87], a[124:127], a[8:11], v[84:87]
  buffer_load_dwordx4 a[48:51], v240, s[4:7], s16 offen offset:0 sc1
  v_mfma_f32_16x16x32_bf16 v[100:103], a[124:127], a[12:15], v[100:103]
  ds_read_b64_tr_b16 a[124:125], v245 offset:26624
  ds_read_b64_tr_b16 a[126:127], v245 offset:30720
  v_mfma_f32_16x16x32_bf16 v[16:19], a[64:67], a[0:3], 0
  buffer_load_dwordx4 a[52:55], v240, s[4:7], s16 offen offset:1024 sc1
  v_mfma_f32_16x16x32_bf16 v[32:35], a[64:67], a[4:7], 0
  ds_read_b64_tr_b16 a[64:65], v242 offset:16384
  ds_read_b64_tr_b16 a[66:67], v242 offset:20480
  v_mfma_f32_16x16x32_bf16 v[20:23], a[68:71], a[0:3], 0
  buffer_load_dwordx4 a[56:59], v241, s[4:7], s16 offen offset:0 sc1
  v_mfma_f32_16x16x32_bf16 v[36:39], a[68:71], a[4:7], 0
  ds_read_b64_tr_b16 a[68:69], v243 offset:16384
  ds_read_b64_tr_b16 a[70:71], v243 offset:20480
  v_mfma_f32_16x16x32_bf16 v[24:27], a[72:75], a[0:3], 0
  buffer_load_dwordx4 a[60:63], v241, s[4:7], s16 offen offset:1024 sc1
  v_mfma_f32_16x16x32_bf16 v[40:43], a[72:75], a[4:7], 0
  ds_read_b64_tr_b16 a[72:73], v244 offset:16384
  s_add_u32 s41, s41, 262144
  s_waitcnt lgkmcnt(10)
  v_mfma_f32_16x16x32_bf16 v[28:31], a[76:79], a[0:3], 0
  ds_read_b64_tr_b16 a[74:75], v244 offset:20480
  v_mfma_f32_16x16x32_bf16 v[44:47], a[76:79], a[4:7], 0
  ds_read_b64_tr_b16 a[76:77], v245 offset:16384
  s_bitset0_b32 s41, 21
  v_mfma_f32_16x16x32_bf16 v[16:19], a[96:99], a[8:11], v[16:19]
  ds_read_b64_tr_b16 a[78:79], v245 offset:20480
  v_mfma_f32_16x16x32_bf16 v[32:35], a[96:99], a[12:15], v[32:35]
  ds_read_b64_tr_b16 a[96:97], v242 offset:24576
  s_add_u32 s16, s40, s41
  v_mfma_f32_16x16x32_bf16 v[20:23], a[100:103], a[8:11], v[20:23]
  ds_read_b64_tr_b16 a[98:99], v242 offset:28672
  v_mfma_f32_16x16x32_bf16 v[36:39], a[100:103], a[12:15], v[36:39]
  buffer_store_dwordx4 v[8:11], v224, s[12:15], s100 offen offset:0 sc1
  v_mfma_f32_16x16x32_bf16 v[24:27], a[104:107], a[8:11], v[24:27]
  ds_read_b64_tr_b16 a[100:101], v243 offset:24576
  ds_read_b64_tr_b16 a[102:103], v243 offset:28672
  v_mfma_f32_16x16x32_bf16 v[40:43], a[104:107], a[12:15], v[40:43]
  buffer_store_dwordx4 v[64:67], v224, s[12:15], s100 offen offset:1024 sc1
  v_mfma_f32_16x16x32_bf16 v[28:31], a[108:111], a[8:11], v[28:31]
  ds_read_b64_tr_b16 a[104:105], v244 offset:24576
  ds_read_b64_tr_b16 a[106:107], v244 offset:28672
  v_mfma_f32_16x16x32_bf16 v[44:47], a[108:111], a[12:15], v[44:47]
  s_waitcnt vmcnt(15) lgkmcnt(10)
  s_barrier
  v_mfma_f32_16x16x32_bf16 v[72:75], a[80:83], a[16:19], v[72:75]
  ds_read_b64_tr_b16 a[108:109], v245 offset:24576
  s_add_u32 m0, s38, 0
  v_mfma_f32_16x16x32_bf16 v[88:91], a[80:83], a[20:23], v[88:91]
  buffer_load_dwordx4 v225, s[8:11], s17 offen lds
  v_mfma_f32_16x16x32_bf16 v[76:79], a[84:87], a[16:19], v[76:79]
  ds_read_b64_tr_b16 a[110:111], v245 offset:28672
  ds_read_b64_tr_b16 a[80:81], v242 offset:34816
  v_mfma_f32_16x16x32_bf16 v[92:95], a[84:87], a[20:23], v[92:95]
  buffer_load_dwordx4 v226, s[8:11], s17 offen offset:1024 lds
  v_mfma_f32_16x16x32_bf16 v[80:83], a[88:91], a[16:19], v[80:83]
  ds_read_b64_tr_b16 a[82:83], v242 offset:38912
  ds_read_b64_tr_b16 a[84:85], v243 offset:34816
  v_mfma_f32_16x16x32_bf16 v[96:99], a[88:91], a[20:23], v[96:99]
  buffer_load_dwordx4 v227, s[8:11], s17 offen offset:2048 lds
  v_mfma_f32_16x16x32_bf16 v[84:87], a[92:95], a[16:19], v[84:87]
  ds_read_b64_tr_b16 a[86:87], v243 offset:38912
  ds_read_b64_tr_b16 a[88:89], v244 offset:34816
  v_mfma_f32_16x16x32_bf16 v[100:103], a[92:95], a[20:23], v[100:103]
  buffer_load_dwordx4 v228, s[8:11], s17 offen offset:3072 lds
  v_mfma_f32_16x16x32_bf16 v[72:75], a[112:115], a[24:27], v[72:75]
  ds_read_b64_tr_b16 a[90:91], v244 offset:38912
  ds_read_b64_tr_b16 a[92:93], v245 offset:34816
  v_mfma_f32_16x16x32_bf16 v[88:91], a[112:115], a[28:31], v[88:91]
  ds_read_b64_tr_b16 a[94:95], v245 offset:38912
  s_add_u32 s17, s17, 458752
  v_mfma_f32_16x16x32_bf16 v[76:79], a[116:119], a[24:27], v[76:79]
  ds_read_b64_tr_b16 a[112:113], v242 offset:43008
  s_cmp_eq_u32 s17, s93
  v_mfma_f32_16x16x32_bf16 v[92:95], a[116:119], a[28:31], v[92:95]
  ds_read_b64_tr_b16 a[114:115], v242 offset:47104
  ds_read_b64_tr_b16 a[116:117], v243 offset:43008
  v_mfma_f32_16x16x32_bf16 v[80:83], a[120:123], a[24:27], v[80:83]
  ds_read_b64_tr_b16 a[118:119], v243 offset:47104
  s_cselect_b32 s17, s95, s17
  v_mfma_f32_16x16x32_bf16 v[96:99], a[120:123], a[28:31], v[96:99]
  ds_read_b64_tr_b16 a[120:121], v244 offset:43008
  ds_read_b64_tr_b16 a[122:123], v244 offset:47104
  v_mfma_f32_16x16x32_bf16 v[84:87], a[124:127], a[24:27], v[84:87]
  buffer_load_dwordx4 a[0:3], v240, s[4:7], s16 offen offset:0 sc1
  v_mfma_f32_16x16x32_bf16 v[100:103], a[124:127], a[28:31], v[100:103]
  ds_read_b64_tr_b16 a[124:125], v245 offset:43008
  ds_read_b64_tr_b16 a[126:127], v245 offset:47104
  v_mfma_f32_16x16x32_bf16 v[16:19], a[64:67], a[16:19], v[16:19]
  buffer_load_dwordx4 a[4:7], v240, s[4:7], s16 offen offset:1024 sc1
  v_mfma_f32_16x16x32_bf16 v[32:35], a[64:67], a[20:23], v[32:35]
  ds_read_b64_tr_b16 a[64:65], v242 offset:32768
  ds_read_b64_tr_b16 a[66:67], v242 offset:36864
  v_mfma_f32_16x16x32_bf16 v[20:23], a[68:71], a[16:19], v[20:23]
  buffer_load_dwordx4 a[8:11], v241, s[4:7], s16 offen offset:0 sc1
  v_mfma_f32_16x16x32_bf16 v[36:39], a[68:71], a[20:23], v[36:39]
  ds_read_b64_tr_b16 a[68:69], v243 offset:32768
  ds_read_b64_tr_b16 a[70:71], v243 offset:36864
  s_waitcnt lgkmcnt(10)
  v_mfma_f32_16x16x32_bf16 v[24:27], a[72:75], a[16:19], v[24:27]
  buffer_load_dwordx4 a[12:15], v241, s[4:7], s16 offen offset:1024 sc1
  v_mfma_f32_16x16x32_bf16 v[40:43], a[72:75], a[20:23], v[40:43]
  ds_read_b64_tr_b16 a[72:73], v244 offset:32768
  s_add_u32 s41, s41, 262144
  v_mfma_f32_16x16x32_bf16 v[28:31], a[76:79], a[16:19], v[28:31]
  ds_read_b64_tr_b16 a[74:75], v244 offset:36864
  v_mfma_f32_16x16x32_bf16 v[44:47], a[76:79], a[20:23], v[44:47]
  ds_read_b64_tr_b16 a[76:77], v245 offset:32768
  s_bitset0_b32 s41, 21
  v_mfma_f32_16x16x32_bf16 v[16:19], a[96:99], a[24:27], v[16:19]
  ds_read_b64_tr_b16 a[78:79], v245 offset:36864
  v_mfma_f32_16x16x32_bf16 v[32:35], a[96:99], a[28:31], v[32:35]
  ds_read_b64_tr_b16 a[96:97], v242 offset:40960
  s_add_u32 s16, s40, s41
  v_mfma_f32_16x16x32_bf16 v[20:23], a[100:103], a[24:27], v[20:23]
  ds_read_b64_tr_b16 a[98:99], v242 offset:45056
  v_mfma_f32_16x16x32_bf16 v[36:39], a[100:103], a[28:31], v[36:39]
  buffer_store_dwordx4 v[120:123], v224, s[12:15], s100 offen offset:2048 sc1
  v_mfma_f32_16x16x32_bf16 v[24:27], a[104:107], a[24:27], v[24:27]
  ds_read_b64_tr_b16 a[100:101], v243 offset:40960
  ds_read_b64_tr_b16 a[102:103], v243 offset:45056
  v_mfma_f32_16x16x32_bf16 v[40:43], a[104:107], a[28:31], v[40:43]
  buffer_store_dwordx4 v[176:179], v224, s[12:15], s100 offen offset:3072 sc1
  v_mfma_f32_16x16x32_bf16 v[28:31], a[108:111], a[24:27], v[28:31]
  ds_read_b64_tr_b16 a[104:105], v244 offset:40960
  ds_read_b64_tr_b16 a[106:107], v244 offset:45056
  v_mfma_f32_16x16x32_bf16 v[44:47], a[108:111], a[28:31], v[44:47]
  s_waitcnt vmcnt(16) lgkmcnt(10)
  s_barrier
  v_mfma_f32_16x16x32_bf16 v[72:75], a[80:83], a[32:35], v[72:75]
  ds_read_b64_tr_b16 a[108:109], v245 offset:40960
  s_add_u32 m0, s38, 16384
  v_mfma_f32_16x16x32_bf16 v[88:91], a[80:83], a[36:39], v[88:91]
  buffer_load_dwordx4 v225, s[8:11], s17 offen lds
  v_mfma_f32_16x16x32_bf16 v[76:79], a[84:87], a[32:35], v[76:79]
  ds_read_b64_tr_b16 a[110:111], v245 offset:45056
  ds_read_b64_tr_b16 a[80:81], v242 offset:51200
  v_mfma_f32_16x16x32_bf16 v[92:95], a[84:87], a[36:39], v[92:95]
  buffer_load_dwordx4 v226, s[8:11], s17 offen offset:1024 lds
  v_mfma_f32_16x16x32_bf16 v[80:83], a[88:91], a[32:35], v[80:83]
  ds_read_b64_tr_b16 a[82:83], v242 offset:55296
  ds_read_b64_tr_b16 a[84:85], v243 offset:51200
  v_mfma_f32_16x16x32_bf16 v[96:99], a[88:91], a[36:39], v[96:99]
  buffer_load_dwordx4 v227, s[8:11], s17 offen offset:2048 lds
  v_mfma_f32_16x16x32_bf16 v[84:87], a[92:95], a[32:35], v[84:87]
  ds_read_b64_tr_b16 a[86:87], v243 offset:55296
  ds_read_b64_tr_b16 a[88:89], v244 offset:51200
  v_mfma_f32_16x16x32_bf16 v[100:103], a[92:95], a[36:39], v[100:103]
  buffer_load_dwordx4 v228, s[8:11], s17 offen offset:3072 lds
  v_mfma_f32_16x16x32_bf16 v[72:75], a[112:115], a[40:43], v[72:75]
  ds_read_b64_tr_b16 a[90:91], v244 offset:55296
  ds_read_b64_tr_b16 a[92:93], v245 offset:51200
  v_mfma_f32_16x16x32_bf16 v[88:91], a[112:115], a[44:47], v[88:91]
  ds_read_b64_tr_b16 a[94:95], v245 offset:55296
  s_add_u32 s17, s17, 458752
  v_mfma_f32_16x16x32_bf16 v[76:79], a[116:119], a[40:43], v[76:79]
  ds_read_b64_tr_b16 a[112:113], v242 offset:59392
  s_cmp_eq_u32 s17, s93
  v_mfma_f32_16x16x32_bf16 v[92:95], a[116:119], a[44:47], v[92:95]
  ds_read_b64_tr_b16 a[114:115], v242 offset:63488
  ds_read_b64_tr_b16 a[116:117], v243 offset:59392
  v_mfma_f32_16x16x32_bf16 v[80:83], a[120:123], a[40:43], v[80:83]
  ds_read_b64_tr_b16 a[118:119], v243 offset:63488
  s_cselect_b32 s17, s95, s17
  v_mfma_f32_16x16x32_bf16 v[96:99], a[120:123], a[44:47], v[96:99]
  ds_read_b64_tr_b16 a[120:121], v244 offset:59392
  ds_read_b64_tr_b16 a[122:123], v244 offset:63488
  v_mfma_f32_16x16x32_bf16 v[84:87], a[124:127], a[40:43], v[84:87]
  buffer_load_dwordx4 a[16:19], v240, s[4:7], s16 offen offset:0 sc1
  v_mfma_f32_16x16x32_bf16 v[100:103], a[124:127], a[44:47], v[100:103]
  ds_read_b64_tr_b16 a[124:125], v245 offset:59392
  ds_read_b64_tr_b16 a[126:127], v245 offset:63488
  v_mfma_f32_16x16x32_bf16 v[16:19], a[64:67], a[32:35], v[16:19]
  buffer_load_dwordx4 a[20:23], v240, s[4:7], s16 offen offset:1024 sc1
  v_mfma_f32_16x16x32_bf16 v[32:35], a[64:67], a[36:39], v[32:35]
  ds_read_b64_tr_b16 a[64:65], v242 offset:49152
  ds_read_b64_tr_b16 a[66:67], v242 offset:53248
  v_mfma_f32_16x16x32_bf16 v[20:23], a[68:71], a[32:35], v[20:23]
  buffer_load_dwordx4 a[24:27], v241, s[4:7], s16 offen offset:0 sc1
  v_mfma_f32_16x16x32_bf16 v[36:39], a[68:71], a[36:39], v[36:39]
  ds_read_b64_tr_b16 a[68:69], v243 offset:49152
  ds_read_b64_tr_b16 a[70:71], v243 offset:53248
  s_waitcnt lgkmcnt(10)
  v_mfma_f32_16x16x32_bf16 v[24:27], a[72:75], a[32:35], v[24:27]
  buffer_load_dwordx4 a[28:31], v241, s[4:7], s16 offen offset:1024 sc1
  v_mfma_f32_16x16x32_bf16 v[40:43], a[72:75], a[36:39], v[40:43]
  ds_read_b64_tr_b16 a[72:73], v244 offset:49152
  s_add_u32 s41, s41, 262144
  v_mfma_f32_16x16x32_bf16 v[28:31], a[76:79], a[32:35], v[28:31]
  ds_read_b64_tr_b16 a[74:75], v244 offset:53248
  v_mfma_f32_16x16x32_bf16 v[44:47], a[76:79], a[36:39], v[44:47]
  ds_read_b64_tr_b16 a[76:77], v245 offset:49152
  s_bitset0_b32 s41, 21
  v_mfma_f32_16x16x32_bf16 v[16:19], a[96:99], a[40:43], v[16:19]
  ds_read_b64_tr_b16 a[78:79], v245 offset:53248
  v_mfma_f32_16x16x32_bf16 v[32:35], a[96:99], a[44:47], v[32:35]
  ds_read_b64_tr_b16 a[96:97], v242 offset:57344
  s_add_u32 s16, s40, s41
  v_mfma_f32_16x16x32_bf16 v[20:23], a[100:103], a[40:43], v[20:23]
  ds_read_b64_tr_b16 a[98:99], v242 offset:61440
  v_mfma_f32_16x16x32_bf16 v[36:39], a[100:103], a[44:47], v[36:39]
  buffer_store_dwordx4 v[12:15], v224, s[12:15], s101 offen offset:0 sc1
  v_mfma_f32_16x16x32_bf16 v[24:27], a[104:107], a[40:43], v[24:27]
  ds_read_b64_tr_b16 a[100:101], v243 offset:57344
  ds_read_b64_tr_b16 a[102:103], v243 offset:61440
  v_mfma_f32_16x16x32_bf16 v[40:43], a[104:107], a[44:47], v[40:43]
  buffer_store_dwordx4 v[124:127], v224, s[12:15], s101 offen offset:2048 sc1
  v_mfma_f32_16x16x32_bf16 v[28:31], a[108:111], a[40:43], v[28:31]
  ds_read_b64_tr_b16 a[104:105], v244 offset:57344
  ds_read_b64_tr_b16 a[106:107], v244 offset:61440
  v_mfma_f32_16x16x32_bf16 v[44:47], a[108:111], a[44:47], v[44:47]
  s_waitcnt vmcnt(16) lgkmcnt(10)
  s_barrier
  v_mfma_f32_16x16x32_bf16 v[72:75], a[80:83], a[48:51], v[72:75]
  ds_read_b64_tr_b16 a[108:109], v245 offset:57344
  s_add_u32 m0, s38, 32768
  v_mfma_f32_16x16x32_bf16 v[88:91], a[80:83], a[52:55], v[88:91]
  ds_read_b64_tr_b16 a[110:111], v245 offset:61440
  ds_read_b64_tr_b16 a[80:81], v242 offset:2048
  v_mfma_f32_16x16x32_bf16 v[76:79], a[84:87], a[48:51], v[76:79]
  buffer_load_dwordx4 v225, s[8:11], s17 offen lds
  v_mfma_f32_16x16x32_bf16 v[92:95], a[84:87], a[52:55], v[92:95]
  ds_read_b64_tr_b16 a[82:83], v242 offset:6144
  ds_read_b64_tr_b16 a[84:85], v243 offset:2048
  v_mfma_f32_16x16x32_bf16 v[80:83], a[88:91], a[48:51], v[80:83]
  buffer_load_dwordx4 v226, s[8:11], s17 offen offset:1024 lds
  v_mfma_f32_16x16x32_bf16 v[96:99], a[88:91], a[52:55], v[96:99]
  ds_read_b64_tr_b16 a[86:87], v243 offset:6144
  ds_read_b64_tr_b16 a[88:89], v244 offset:2048
  v_mfma_f32_16x16x32_bf16 v[84:87], a[92:95], a[48:51], v[84:87]
  buffer_load_dwordx4 v227, s[8:11], s17 offen offset:2048 lds
  v_mfma_f32_16x16x32_bf16 v[100:103], a[92:95], a[52:55], v[100:103]
  ds_read_b64_tr_b16 a[90:91], v244 offset:6144
  ds_read_b64_tr_b16 a[92:93], v245 offset:2048
  v_mfma_f32_16x16x32_bf16 v[72:75], a[112:115], a[56:59], v[72:75]
  buffer_load_dwordx4 v228, s[8:11], s17 offen offset:3072 lds
  v_mfma_f32_16x16x32_bf16 v[88:91], a[112:115], a[60:63], v[88:91]
  ds_read_b64_tr_b16 a[94:95], v245 offset:6144
  ds_read_b64_tr_b16 a[112:113], v242 offset:10240
  v_mfma_f32_16x16x32_bf16 v[76:79], a[116:119], a[56:59], v[76:79]
  ds_read_b64_tr_b16 a[114:115], v242 offset:14336
  s_add_u32 s17, s17, 458752
  v_mfma_f32_16x16x32_bf16 v[92:95], a[116:119], a[60:63], v[92:95]
  ds_read_b64_tr_b16 a[116:117], v243 offset:10240
  ds_read_b64_tr_b16 a[118:119], v243 offset:14336
  v_mfma_f32_16x16x32_bf16 v[80:83], a[120:123], a[56:59], v[80:83]
  s_cmp_eq_u32 s17, s93
  v_mfma_f32_16x16x32_bf16 v[96:99], a[120:123], a[60:63], v[96:99]
  ds_read_b64_tr_b16 a[120:121], v244 offset:10240
  ds_read_b64_tr_b16 a[122:123], v244 offset:14336
  v_mfma_f32_16x16x32_bf16 v[84:87], a[124:127], a[56:59], v[84:87]
  s_cselect_b32 s17, s95, s17
  v_mfma_f32_16x16x32_bf16 v[100:103], a[124:127], a[60:63], v[100:103]
  buffer_load_dword v247, v246, s[56:59], s94 offen sc1
  v_mfma_f32_16x16x32_bf16 v[16:19], a[64:67], a[48:51], v[16:19]
  buffer_load_dwordx4 a[32:35], v240, s[4:7], s16 offen offset:0 sc1
  v_mfma_f32_16x16x32_bf16 v[32:35], a[64:67], a[52:55], v[32:35]
  ds_read_b64_tr_b16 a[124:125], v245 offset:10240
  ds_read_b64_tr_b16 a[126:127], v245 offset:14336
  v_mfma_f32_16x16x32_bf16 v[20:23], a[68:71], a[48:51], v[20:23]
  buffer_load_dwordx4 a[36:39], v240, s[4:7], s16 offen offset:1024 sc1
  v_mfma_f32_16x16x32_bf16 v[36:39], a[68:71], a[52:55], v[36:39]
  ds_read_b64_tr_b16 a[64:65], v242 offset:0
  ds_read_b64_tr_b16 a[66:67], v242 offset:4096
  s_waitcnt lgkmcnt(10)
  v_mfma_f32_16x16x32_bf16 v[24:27], a[72:75], a[48:51], v[24:27]
  buffer_load_dwordx4 a[40:43], v241, s[4:7], s16 offen offset:0 sc1
  v_mfma_f32_16x16x32_bf16 v[40:43], a[72:75], a[52:55], v[40:43]
  ds_read_b64_tr_b16 a[68:69], v243 offset:0
  ds_read_b64_tr_b16 a[70:71], v243 offset:4096
  v_mfma_f32_16x16x32_bf16 v[28:31], a[76:79], a[48:51], v[28:31]
  buffer_load_dwordx4 a[44:47], v241, s[4:7], s16 offen offset:1024 sc1
  v_mfma_f32_16x16x32_bf16 v[44:47], a[76:79], a[52:55], v[44:47]
  ds_read_b64_tr_b16 a[72:73], v244 offset:0
  ds_read_b64_tr_b16 a[74:75], v244 offset:4096
  v_mfma_f32_16x16x32_bf16 v[16:19], a[96:99], a[56:59], v[16:19]
  ds_read_b64_tr_b16 a[76:77], v245 offset:0
  s_add_u32 s41, s41, 262144
  v_mfma_f32_16x16x32_bf16 v[32:35], a[96:99], a[60:63], v[32:35]
  ds_read_b64_tr_b16 a[78:79], v245 offset:4096
  ds_read_b64_tr_b16 a[96:97], v242 offset:8192
  v_mfma_f32_16x16x32_bf16 v[20:23], a[100:103], a[56:59], v[20:23]
  ds_read_b64_tr_b16 a[98:99], v242 offset:12288
  s_bitset0_b32 s41, 21
  v_mfma_f32_16x16x32_bf16 v[36:39], a[100:103], a[60:63], v[36:39]
  ds_read_b64_tr_b16 a[100:101], v243 offset:8192
  ds_read_b64_tr_b16 a[102:103], v243 offset:12288
  v_mfma_f32_16x16x32_bf16 v[24:27], a[104:107], a[56:59], v[24:27]
  s_add_u32 s16, s40, s41
  v_mfma_f32_16x16x32_bf16 v[40:43], a[104:107], a[60:63], v[40:43]
  ds_read_b64_tr_b16 a[104:105], v244 offset:8192
  ds_read_b64_tr_b16 a[106:107], v244 offset:12288
  v_mfma_f32_16x16x32_bf16 v[28:31], a[108:111], a[56:59], v[28:31]
  v_mfma_f32_16x16x32_bf16 v[44:47], a[108:111], a[60:63], v[44:47]
  s_waitcnt vmcnt(15) lgkmcnt(10)
  s_barrier
  v_mfma_f32_16x16x32_bf16 v[72:75], a[80:83], a[0:3], v[72:75]
  ds_read_b64_tr_b16 a[108:109], v245 offset:8192
  s_add_u32 m0, s38, 49152
  v_mfma_f32_16x16x32_bf16 v[88:91], a[80:83], a[4:7], v[88:91]
  buffer_load_dwordx4 v225, s[8:11], s17 offen lds
  v_mfma_f32_16x16x32_bf16 v[76:79], a[84:87], a[0:3], v[76:79]
  ds_read_b64_tr_b16 a[110:111], v245 offset:12288
  ds_read_b64_tr_b16 a[80:81], v242 offset:18432
  v_mfma_f32_16x16x32_bf16 v[92:95], a[84:87], a[4:7], v[92:95]
  buffer_load_dwordx4 v226, s[8:11], s17 offen offset:1024 lds
  v_mfma_f32_16x16x32_bf16 v[80:83], a[88:91], a[0:3], v[80:83]
  ds_read_b64_tr_b16 a[82:83], v242 offset:22528
  buffer_load_dwordx4 v227, s[8:11], s17 offen offset:2048 lds
  v_mfma_f32_16x16x32_bf16 v[96:99], a[88:91], a[4:7], v[96:99]
  ds_read_b64_tr_b16 a[84:85], v243 offset:18432
  ds_read_b64_tr_b16 a[86:87], v243 offset:22528
  v_mfma_f32_16x16x32_bf16 v[84:87], a[92:95], a[0:3], v[84:87]
  buffer_load_dwordx4 v228, s[8:11], s17 offen offset:3072 lds
  v_mfma_f32_16x16x32_bf16 v[100:103], a[92:95], a[4:7], v[100:103]
  ds_read_b64_tr_b16 a[88:89], v244 offset:18432
  ds_read_b64_tr_b16 a[90:91], v244 offset:22528
  v_mfma_f32_16x16x32_bf16 v[72:75], a[112:115], a[8:11], v[72:75]
  ds_read_b64_tr_b16 a[92:93], v245 offset:18432
  s_add_u32 s17, s17, 458752
  v_mfma_f32_16x16x32_bf16 v[88:91], a[112:115], a[12:15], v[88:91]
  ds_read_b64_tr_b16 a[94:95], v245 offset:22528
  s_cmp_eq_u32 s17, s93
  v_mfma_f32_16x16x32_bf16 v[76:79], a[116:119], a[8:11], v[76:79]
  ds_read_b64_tr_b16 a[112:113], v242 offset:26624
  ds_read_b64_tr_b16 a[114:115], v242 offset:30720
  v_mfma_f32_16x16x32_bf16 v[92:95], a[116:119], a[12:15], v[92:95]
  ds_read_b64_tr_b16 a[116:117], v243 offset:26624
  s_cselect_b32 s17, s95, s17
  v_mfma_f32_16x16x32_bf16 v[80:83], a[120:123], a[8:11], v[80:83]
  ds_read_b64_tr_b16 a[118:119], v243 offset:30720
  v_mfma_f32_16x16x32_bf16 v[96:99], a[120:123], a[12:15], v[96:99]
  ds_read_b64_tr_b16 a[120:121], v244 offset:26624
  s_add_u32 s17, s17, 65536
  v_mfma_f32_16x16x32_bf16 v[84:87], a[124:127], a[8:11], v[84:87]
  ds_read_b64_tr_b16 a[122:123], v244 offset:30720
  s_add_u32 s93, s93, 65536
  v_mfma_f32_16x16x32_bf16 v[100:103], a[124:127], a[12:15], v[100:103]
  ds_read_b64_tr_b16 a[124:125], v245 offset:26624
  ds_read_b64_tr_b16 a[126:127], v245 offset:30720
  v_mfma_f32_16x16x32_bf16 v[16:19], a[64:67], a[0:3], v[16:19]
  s_add_u32 s95, s95, 65536
  v_mfma_f32_16x16x32_bf16 v[32:35], a[64:67], a[4:7], v[32:35]
  buffer_load_dwordx4 a[48:51], v240, s[4:7], s16 offen offset:0 sc1
  v_mfma_f32_16x16x32_bf16 v[20:23], a[68:71], a[0:3], v[20:23]
  ds_read_b64_tr_b16 a[64:65], v242 offset:16384
  ds_read_b64_tr_b16 a[66:67], v242 offset:20480
  v_mfma_f32_16x16x32_bf16 v[36:39], a[68:71], a[4:7], v[36:39]
  buffer_load_dwordx4 a[52:55], v240, s[4:7], s16 offen offset:1024 sc1
  s_waitcnt lgkmcnt(10)
  v_mfma_f32_16x16x32_bf16 v[24:27], a[72:75], a[0:3], v[24:27]
  ds_read_b64_tr_b16 a[68:69], v243 offset:16384
  ds_read_b64_tr_b16 a[70:71], v243 offset:20480
  v_mfma_f32_16x16x32_bf16 v[40:43], a[72:75], a[4:7], v[40:43]
  buffer_load_dwordx4 a[56:59], v241, s[4:7], s16 offen offset:0 sc1
  v_mfma_f32_16x16x32_bf16 v[28:31], a[76:79], a[0:3], v[28:31]
  buffer_load_dwordx4 a[60:63], v241, s[4:7], s16 offen offset:1024 sc1
  v_mfma_f32_16x16x32_bf16 v[44:47], a[76:79], a[4:7], v[44:47]
  ds_read_b64_tr_b16 a[72:73], v244 offset:16384
  ds_read_b64_tr_b16 a[74:75], v244 offset:20480
  v_mfma_f32_16x16x32_bf16 v[16:19], a[96:99], a[8:11], v[16:19]
  ds_read_b64_tr_b16 a[76:77], v245 offset:16384
  s_add_u32 s41, s41, 262144
  v_mfma_f32_16x16x32_bf16 v[32:35], a[96:99], a[12:15], v[32:35]
  ds_read_b64_tr_b16 a[78:79], v245 offset:20480
  ds_read_b64_tr_b16 a[96:97], v242 offset:24576
  v_mfma_f32_16x16x32_bf16 v[20:23], a[100:103], a[8:11], v[20:23]
  ds_read_b64_tr_b16 a[98:99], v242 offset:28672
  s_bitset0_b32 s41, 21
  v_mfma_f32_16x16x32_bf16 v[36:39], a[100:103], a[12:15], v[36:39]
  ds_read_b64_tr_b16 a[100:101], v243 offset:24576
  s_add_u32 s40, s40, 2097152
  v_mfma_f32_16x16x32_bf16 v[24:27], a[104:107], a[8:11], v[24:27]
  ds_read_b64_tr_b16 a[102:103], v243 offset:28672
  v_mfma_f32_16x16x32_bf16 v[40:43], a[104:107], a[12:15], v[40:43]
  ds_read_b64_tr_b16 a[104:105], v244 offset:24576
  s_add_u32 s16, s40, s41
  v_mfma_f32_16x16x32_bf16 v[28:31], a[108:111], a[8:11], v[28:31]
  ds_read_b64_tr_b16 a[106:107], v244 offset:28672
  v_mfma_f32_16x16x32_bf16 v[44:47], a[108:111], a[12:15], v[44:47]
  s_waitcnt vmcnt(12) lgkmcnt(10)
  s_barrier
  v_cmp_ne_u32 vcc, s19, v247
  s_nop 1
  s_cmp_lg_u64 vcc, 0
  s_cbranch_scc1 L_slow_27
  L_back_28:
  s_add_u32 s94, s94, 65536
  v_mfma_f32_16x16x32_bf16 v[72:75], a[80:83], a[16:19], v[72:75]
  ds_read_b64_tr_b16 a[108:109], v245 offset:24576
  s_add_u32 m0, s38, 0
  v_mfma_f32_16x16x32_bf16 v[88:91], a[80:83], a[20:23], v[88:91]
  ds_read_b64_tr_b16 a[110:111], v245 offset:28672
  ds_read_b64_tr_b16 a[80:81], v242 offset:34816
  v_mfma_f32_16x16x32_bf16 v[76:79], a[84:87], a[16:19], v[76:79]
  buffer_load_dwordx4 v225, s[8:11], s17 offen lds
  v_mfma_f32_16x16x32_bf16 v[92:95], a[84:87], a[20:23], v[92:95]
  ds_read_b64_tr_b16 a[82:83], v242 offset:38912
  ds_read_b64_tr_b16 a[84:85], v243 offset:34816
  v_mfma_f32_16x16x32_bf16 v[80:83], a[88:91], a[16:19], v[80:83]
  buffer_load_dwordx4 v226, s[8:11], s17 offen offset:1024 lds
  v_mfma_f32_16x16x32_bf16 v[96:99], a[88:91], a[20:23], v[96:99]
  ds_read_b64_tr_b16 a[86:87], v243 offset:38912
  ds_read_b64_tr_b16 a[88:89], v244 offset:34816
  v_mfma_f32_16x16x32_bf16 v[84:87], a[92:95], a[16:19], v[84:87]
  buffer_load_dwordx4 v227, s[8:11], s17 offen offset:2048 lds
  v_mfma_f32_16x16x32_bf16 v[100:103], a[92:95], a[20:23], v[100:103]
  ds_read_b64_tr_b16 a[90:91], v244 offset:38912
  ds_read_b64_tr_b16 a[92:93], v245 offset:34816
  v_mfma_f32_16x16x32_bf16 v[72:75], a[112:115], a[24:27], v[72:75]
  buffer_load_dwordx4 v228, s[8:11], s17 offen offset:3072 lds
  v_mfma_f32_16x16x32_bf16 v[88:91], a[112:115], a[28:31], v[88:91]
  ds_read_b64_tr_b16 a[94:95], v245 offset:38912
  ds_read_b64_tr_b16 a[112:113], v242 offset:43008
  v_mfma_f32_16x16x32_bf16 v[76:79], a[116:119], a[24:27], v[76:79]
  ds_read_b64_tr_b16 a[114:115], v242 offset:47104
  s_add_u32 s17, s17, 458752
  v_mfma_f32_16x16x32_bf16 v[92:95], a[116:119], a[28:31], v[92:95]
  ds_read_b64_tr_b16 a[116:117], v243 offset:43008
  ds_read_b64_tr_b16 a[118:119], v243 offset:47104
  v_mfma_f32_16x16x32_bf16 v[80:83], a[120:123], a[24:27], v[80:83]
  s_cmp_eq_u32 s17, s93
  v_mfma_f32_16x16x32_bf16 v[96:99], a[120:123], a[28:31], v[96:99]
  ds_read_b64_tr_b16 a[120:121], v244 offset:43008
  ds_read_b64_tr_b16 a[122:123], v244 offset:47104
  v_mfma_f32_16x16x32_bf16 v[84:87], a[124:127], a[24:27], v[84:87]
  s_cselect_b32 s17, s95, s17
  v_mfma_f32_16x16x32_bf16 v[100:103], a[124:127], a[28:31], v[100:103]
  ds_read_b64_tr_b16 a[124:125], v245 offset:43008
  ds_read_b64_tr_b16 a[126:127], v245 offset:47104
  v_mfma_f32_16x16x32_bf16 v[16:19], a[64:67], a[16:19], v[16:19]
  buffer_load_dwordx4 a[0:3], v240, s[4:7], s16 offen offset:0 sc1
  v_mfma_f32_16x16x32_bf16 v[32:35], a[64:67], a[20:23], v[32:35]
  ds_read_b64_tr_b16 a[64:65], v242 offset:32768
  ds_read_b64_tr_b16 a[66:67], v242 offset:36864
  v_mfma_f32_16x16x32_bf16 v[20:23], a[68:71], a[16:19], v[20:23]
  buffer_load_dwordx4 a[4:7], v240, s[4:7], s16 offen offset:1024 sc1
  v_mfma_f32_16x16x32_bf16 v[36:39], a[68:71], a[20:23], v[36:39]
  ds_read_b64_tr_b16 a[68:69], v243 offset:32768
  ds_read_b64_tr_b16 a[70:71], v243 offset:36864
  s_waitcnt lgkmcnt(10)
  v_mfma_f32_16x16x32_bf16 v[24:27], a[72:75], a[16:19], v[24:27]
  buffer_load_dwordx4 a[8:11], v241, s[4:7], s16 offen offset:0 sc1
  v_mfma_f32_16x16x32_bf16 v[40:43], a[72:75], a[20:23], v[40:43]
  ds_read_b64_tr_b16 a[72:73], v244 offset:32768
  ds_read_b64_tr_b16 a[74:75], v244 offset:36864
  v_mfma_f32_16x16x32_bf16 v[28:31], a[76:79], a[16:19], v[28:31]
  buffer_load_dwordx4 a[12:15], v241, s[4:7], s16 offen offset:1024 sc1
  v_mfma_f32_16x16x32_bf16 v[44:47], a[76:79], a[20:23], v[44:47]
  ds_read_b64_tr_b16 a[76:77], v245 offset:32768
  ds_read_b64_tr_b16 a[78:79], v245 offset:36864
  v_mfma_f32_16x16x32_bf16 v[16:19], a[96:99], a[24:27], v[16:19]
  s_add_u32 s41, s41, 262144
  v_mfma_f32_16x16x32_bf16 v[32:35], a[96:99], a[28:31], v[32:35]
  ds_read_b64_tr_b16 a[96:97], v242 offset:40960
  ds_read_b64_tr_b16 a[98:99], v242 offset:45056
  v_mfma_f32_16x16x32_bf16 v[20:23], a[100:103], a[24:27], v[20:23]
  s_bitset0_b32 s41, 21
  v_mfma_f32_16x16x32_bf16 v[36:39], a[100:103], a[28:31], v[36:39]
  ds_read_b64_tr_b16 a[100:101], v243 offset:40960
  ds_read_b64_tr_b16 a[102:103], v243 offset:45056
  v_mfma_f32_16x16x32_bf16 v[24:27], a[104:107], a[24:27], v[24:27]
  s_add_u32 s16, s40, s41
  v_mfma_f32_16x16x32_bf16 v[40:43], a[104:107], a[28:31], v[40:43]
  ds_read_b64_tr_b16 a[104:105], v244 offset:40960
  ds_read_b64_tr_b16 a[106:107], v244 offset:45056
  v_mfma_f32_16x16x32_bf16 v[28:31], a[108:111], a[24:27], v[28:31]
  v_mfma_f32_16x16x32_bf16 v[44:47], a[108:111], a[28:31], v[44:47]
  s_waitcnt vmcnt(12) lgkmcnt(10)
  s_barrier
  s_mov_b64 exec, 1
  buffer_store_dword v248, v250, s[56:59], s92 offen sc1
  s_mov_b64 exec, -1
  s_add_u32 s92, s92, 65536
  v_mfma_f32_16x16x32_bf16 v[72:75], a[80:83], a[32:35], v[72:75]
  ds_read_b64_tr_b16 a[108:109], v245 offset:40960
  s_add_u32 m0, s38, 16384
  v_mfma_f32_16x16x32_bf16 v[88:91], a[80:83], a[36:39], v[88:91]
  ds_read_b64_tr_b16 a[110:111], v245 offset:45056
  ds_read_b64_tr_b16 a[80:81], v242 offset:51200
  v_mfma_f32_16x16x32_bf16 v[76:79], a[84:87], a[32:35], v[76:79]
  buffer_load_dwordx4 v225, s[8:11], s17 offen lds
  v_mfma_f32_16x16x32_bf16 v[92:95], a[84:87], a[36:39], v[92:95]
  ds_read_b64_tr_b16 a[82:83], v242 offset:55296
  ds_read_b64_tr_b16 a[84:85], v243 offset:51200
  v_mfma_f32_16x16x32_bf16 v[80:83], a[88:91], a[32:35], v[80:83]
  buffer_load_dwordx4 v226, s[8:11], s17 offen offset:1024 lds
  v_mfma_f32_16x16x32_bf16 v[96:99], a[88:91], a[36:39], v[96:99]
  ds_read_b64_tr_b16 a[86:87], v243 offset:55296
  ds_read_b64_tr_b16 a[88:89], v244 offset:51200
  v_mfma_f32_16x16x32_bf16 v[84:87], a[92:95], a[32:35], v[84:87]
  buffer_load_dwordx4 v227, s[8:11], s17 offen offset:2048 lds
  v_mfma_f32_16x16x32_bf16 v[100:103], a[92:95], a[36:39], v[100:103]
  ds_read_b64_tr_b16 a[90:91], v244 offset:55296
  ds_read_b64_tr_b16 a[92:93], v245 offset:51200
  v_mfma_f32_16x16x32_bf16 v[72:75], a[112:115], a[40:43], v[72:75]
  buffer_load_dwordx4 v228, s[8:11], s17 offen offset:3072 lds
  v_mfma_f32_16x16x32_bf16 v[88:91], a[112:115], a[44:47], v[88:91]
  ds_read_b64_tr_b16 a[94:95], v245 offset:55296
  ds_read_b64_tr_b16 a[112:113], v242 offset:59392
  v_mfma_f32_16x16x32_bf16 v[76:79], a[116:119], a[40:43], v[76:79]
  ds_read_b64_tr_b16 a[114:115], v242 offset:63488
  s_add_u32 s17, s17, 458752
  v_mfma_f32_16x16x32_bf16 v[92:95], a[116:119], a[44:47], v[92:95]
  ds_read_b64_tr_b16 a[116:117], v243 offset:59392
  ds_read_b64_tr_b16 a[118:119], v243 offset:63488
  v_mfma_f32_16x16x32_bf16 v[80:83], a[120:123], a[40:43], v[80:83]
  s_cmp_eq_u32 s17, s93
  v_mfma_f32_16x16x32_bf16 v[96:99], a[120:123], a[44:47], v[96:99]
  ds_read_b64_tr_b16 a[120:121], v244 offset:59392
  ds_read_b64_tr_b16 a[122:123], v244 offset:63488
  v_mfma_f32_16x16x32_bf16 v[84:87], a[124:127], a[40:43], v[84:87]
  s_cselect_b32 s17, s95, s17
  v_mfma_f32_16x16x32_bf16 v[100:103], a[124:127], a[44:47], v[100:103]
  ds_read_b64_tr_b16 a[124:125], v245 offset:59392
  ds_read_b64_tr_b16 a[126:127], v245 offset:63488
  v_mfma_f32_16x16x32_bf16 v[16:19], a[64:67], a[32:35], v[16:19]
  buffer_load_dwordx4 a[16:19], v240, s[4:7], s16 offen offset:0 sc1
  v_mfma_f32_16x16x32_bf16 v[32:35], a[64:67], a[36:39], v[32:35]
  ds_read_b64_tr_b16 a[64:65], v242 offset:49152
  ds_read_b64_tr_b16 a[66:67], v242 offset:53248
  v_mfma_f32_16x16x32_bf16 v[20:23], a[68:71], a[32:35], v[20:23]
  buffer_load_dwordx4 a[20:23], v240, s[4:7], s16 offen offset:1024 sc1
  v_mfma_f32_16x16x32_bf16 v[36:39], a[68:71], a[36:39], v[36:39]
  ds_read_b64_tr_b16 a[68:69], v243 offset:49152
  ds_read_b64_tr_b16 a[70:71], v243 offset:53248
  s_waitcnt lgkmcnt(10)
  v_mfma_f32_16x16x32_bf16 v[24:27], a[72:75], a[32:35], v[24:27]
  buffer_load_dwordx4 a[24:27], v241, s[4:7], s16 offen offset:0 sc1
  v_mfma_f32_16x16x32_bf16 v[40:43], a[72:75], a[36:39], v[40:43]
  ds_read_b64_tr_b16 a[72:73], v244 offset:49152
  ds_read_b64_tr_b16 a[74:75], v244 offset:53248
  v_mfma_f32_16x16x32_bf16 v[28:31], a[76:79], a[32:35], v[28:31]
  buffer_load_dwordx4 a[28:31], v241, s[4:7], s16 offen offset:1024 sc1
  v_mfma_f32_16x16x32_bf16 v[44:47], a[76:79], a[36:39], v[44:47]
  ds_read_b64_tr_b16 a[76:77], v245 offset:49152
  ds_read_b64_tr_b16 a[78:79], v245 offset:53248
  v_mfma_f32_16x16x32_bf16 v[16:19], a[96:99], a[40:43], v[16:19]
  s_add_u32 s41, s41, 262144
  v_mfma_f32_16x16x32_bf16 v[32:35], a[96:99], a[44:47], v[32:35]
  ds_read_b64_tr_b16 a[96:97], v242 offset:57344
  ds_read_b64_tr_b16 a[98:99], v242 offset:61440
  v_mfma_f32_16x16x32_bf16 v[20:23], a[100:103], a[40:43], v[20:23]
  s_bitset0_b32 s41, 21
  v_mfma_f32_16x16x32_bf16 v[36:39], a[100:103], a[44:47], v[36:39]
  ds_read_b64_tr_b16 a[100:101], v243 offset:57344
  ds_read_b64_tr_b16 a[102:103], v243 offset:61440
  v_mfma_f32_16x16x32_bf16 v[24:27], a[104:107], a[40:43], v[24:27]
  s_add_u32 s16, s40, s41
  v_mfma_f32_16x16x32_bf16 v[40:43], a[104:107], a[44:47], v[40:43]
  ds_read_b64_tr_b16 a[104:105], v244 offset:57344
  ds_read_b64_tr_b16 a[106:107], v244 offset:61440
  v_mfma_f32_16x16x32_bf16 v[28:31], a[108:111], a[40:43], v[28:31]
  v_mfma_f32_16x16x32_bf16 v[44:47], a[108:111], a[44:47], v[44:47]
  s_waitcnt vmcnt(13) lgkmcnt(10)
  s_barrier
  v_mfma_f32_16x16x32_bf16 v[72:75], a[80:83], a[48:51], v[72:75]
  ds_read_b64_tr_b16 a[108:109], v245 offset:57344
  s_add_u32 m0, s38, 32768
  v_mfma_f32_16x16x32_bf16 v[88:91], a[80:83], a[52:55], v[88:91]
  ds_read_b64_tr_b16 a[110:111], v245 offset:61440
  ds_read_b64_tr_b16 a[80:81], v242 offset:2048
  v_mfma_f32_16x16x32_bf16 v[76:79], a[84:87], a[48:51], v[76:79]
  buffer_load_dwordx4 v225, s[8:11], s17 offen lds
  v_mfma_f32_16x16x32_bf16 v[92:95], a[84:87], a[52:55], v[92:95]
  ds_read_b64_tr_b16 a[82:83], v242 offset:6144
  ds_read_b64_tr_b16 a[84:85], v243 offset:2048
  v_mfma_f32_16x16x32_bf16 v[80:83], a[88:91], a[48:51], v[80:83]
  buffer_load_dwordx4 v226, s[8:11], s17 offen offset:1024 lds
  v_mfma_f32_16x16x32_bf16 v[96:99], a[88:91], a[52:55], v[96:99]
  ds_read_b64_tr_b16 a[86:87], v243 offset:6144
  ds_read_b64_tr_b16 a[88:89], v244 offset:2048
  v_mfma_f32_16x16x32_bf16 v[84:87], a[92:95], a[48:51], v[84:87]
  buffer_load_dwordx4 v227, s[8:11], s17 offen offset:2048 lds
  v_mfma_f32_16x16x32_bf16 v[100:103], a[92:95], a[52:55], v[100:103]
  ds_read_b64_tr_b16 a[90:91], v244 offset:6144
  ds_read_b64_tr_b16 a[92:93], v245 offset:2048
  v_mfma_f32_16x16x32_bf16 v[72:75], a[112:115], a[56:59], v[72:75]
  buffer_load_dwordx4 v228, s[8:11], s17 offen offset:3072 lds
  v_mfma_f32_16x16x32_bf16 v[88:91], a[112:115], a[60:63], v[88:91]
  ds_read_b64_tr_b16 a[94:95], v245 offset:6144
  ds_read_b64_tr_b16 a[112:113], v242 offset:10240
  v_mfma_f32_16x16x32_bf16 v[76:79], a[116:119], a[56:59], v[76:79]
  ds_read_b64_tr_b16 a[114:115], v242 offset:14336
  s_add_u32 s17, s17, 458752
  v_mfma_f32_16x16x32_bf16 v[92:95], a[116:119], a[60:63], v[92:95]
  ds_read_b64_tr_b16 a[116:117], v243 offset:10240
  ds_read_b64_tr_b16 a[118:119], v243 offset:14336
  v_mfma_f32_16x16x32_bf16 v[80:83], a[120:123], a[56:59], v[80:83]
  s_cmp_eq_u32 s17, s93
  v_mfma_f32_16x16x32_bf16 v[96:99], a[120:123], a[60:63], v[96:99]
  ds_read_b64_tr_b16 a[120:121], v244 offset:10240
  ds_read_b64_tr_b16 a[122:123], v244 offset:14336
  v_mfma_f32_16x16x32_bf16 v[84:87], a[124:127], a[56:59], v[84:87]
  s_cselect_b32 s17, s95, s17
  v_mfma_f32_16x16x32_bf16 v[100:103], a[124:127], a[60:63], v[100:103]
  ds_read_b64_tr_b16 a[124:125], v245 offset:10240
  ds_read_b64_tr_b16 a[126:127], v245 offset:14336
  v_mfma_f32_16x16x32_bf16 v[16:19], a[64:67], a[48:51], v[16:19]
  buffer_load_dwordx4 a[32:35], v240, s[4:7], s16 offen offset:0 sc1
  v_mfma_f32_16x16x32_bf16 v[32:35], a[64:67], a[52:55], v[32:35]
  ds_read_b64_tr_b16 a[64:65], v242 offset:0
  ds_read_b64_tr_b16 a[66:67], v242 offset:4096
  v_mfma_f32_16x16x32_bf16 v[20:23], a[68:71], a[48:51], v[20:23]
  buffer_load_dwordx4 a[36:39], v240, s[4:7], s16 offen offset:1024 sc1
  v_mfma_f32_16x16x32_bf16 v[36:39], a[68:71], a[52:55], v[36:39]
  ds_read_b64_tr_b16 a[68:69], v243 offset:0
  ds_read_b64_tr_b16 a[70:71], v243 offset:4096
  s_waitcnt lgkmcnt(10)
  v_mfma_f32_16x16x32_bf16 v[24:27], a[72:75], a[48:51], v[24:27]
  buffer_load_dwordx4 a[40:43], v241, s[4:7], s16 offen offset:0 sc1
  v_mfma_f32_16x16x32_bf16 v[40:43], a[72:75], a[52:55], v[40:43]
  ds_read_b64_tr_b16 a[72:73], v244 offset:0
  ds_read_b64_tr_b16 a[74:75], v244 offset:4096
  v_mfma_f32_16x16x32_bf16 v[28:31], a[76:79], a[48:51], v[28:31]
  buffer_load_dwordx4 a[44:47], v241, s[4:7], s16 offen offset:1024 sc1
  v_mfma_f32_16x16x32_bf16 v[44:47], a[76:79], a[52:55], v[44:47]
  ds_read_b64_tr_b16 a[76:77], v245 offset:0
  ds_read_b64_tr_b16 a[78:79], v245 offset:4096
  v_mfma_f32_16x16x32_bf16 v[16:19], a[96:99], a[56:59], v[16:19]
  s_add_u32 s41, s41, 262144
  v_mfma_f32_16x16x32_bf16 v[32:35], a[96:99], a[60:63], v[32:35]
  ds_read_b64_tr_b16 a[96:97], v242 offset:8192
  ds_read_b64_tr_b16 a[98:99], v242 offset:12288
  v_mfma_f32_16x16x32_bf16 v[20:23], a[100:103], a[56:59], v[20:23]
  s_bitset0_b32 s41, 21
  v_mfma_f32_16x16x32_bf16 v[36:39], a[100:103], a[60:63], v[36:39]
  ds_read_b64_tr_b16 a[100:101], v243 offset:8192
  ds_read_b64_tr_b16 a[102:103], v243 offset:12288
  v_mfma_f32_16x16x32_bf16 v[24:27], a[104:107], a[56:59], v[24:27]
  s_add_u32 s16, s40, s41
  v_mfma_f32_16x16x32_bf16 v[40:43], a[104:107], a[60:63], v[40:43]
  ds_read_b64_tr_b16 a[104:105], v244 offset:8192
  ds_read_b64_tr_b16 a[106:107], v244 offset:12288
  v_mfma_f32_16x16x32_bf16 v[28:31], a[108:111], a[56:59], v[28:31]
  v_mfma_f32_16x16x32_bf16 v[44:47], a[108:111], a[60:63], v[44:47]
  s_waitcnt vmcnt(12) lgkmcnt(10)
  s_barrier
  v_mfma_f32_16x16x32_bf16 v[72:75], a[80:83], a[0:3], v[72:75]
  ds_read_b64_tr_b16 a[108:109], v245 offset:8192
  s_add_u32 m0, s38, 49152
  v_mfma_f32_16x16x32_bf16 v[88:91], a[80:83], a[4:7], v[88:91]
  ds_read_b64_tr_b16 a[110:111], v245 offset:12288
  ds_read_b64_tr_b16 a[80:81], v242 offset:18432
  v_mfma_f32_16x16x32_bf16 v[76:79], a[84:87], a[0:3], v[76:79]
  buffer_load_dwordx4 v225, s[8:11], s17 offen lds
  v_mfma_f32_16x16x32_bf16 v[92:95], a[84:87], a[4:7], v[92:95]
  ds_read_b64_tr_b16 a[82:83], v242 offset:22528
  ds_read_b64_tr_b16 a[84:85], v243 offset:18432
  v_mfma_f32_16x16x32_bf16 v[80:83], a[88:91], a[0:3], v[80:83]
  buffer_load_dwordx4 v226, s[8:11], s17 offen offset:1024 lds
  v_mfma_f32_16x16x32_bf16 v[96:99], a[88:91], a[4:7], v[96:99]
  ds_read_b64_tr_b16 a[86:87], v243 offset:22528
  ds_read_b64_tr_b16 a[88:89], v244 offset:18432
  v_mfma_f32_16x16x32_bf16 v[84:87], a[92:95], a[0:3], v[84:87]
  buffer_load_dwordx4 v227, s[8:11], s17 offen offset:2048 lds
  v_mfma_f32_16x16x32_bf16 v[100:103], a[92:95], a[4:7], v[100:103]
  ds_read_b64_tr_b16 a[90:91], v244 offset:22528
  ds_read_b64_tr_b16 a[92:93], v245 offset:18432
  v_mfma_f32_16x16x32_bf16 v[72:75], a[112:115], a[8:11], v[72:75]
  buffer_load_dwordx4 v228, s[8:11], s17 offen offset:3072 lds
  v_mfma_f32_16x16x32_bf16 v[88:91], a[112:115], a[12:15], v[88:91]
  ds_read_b64_tr_b16 a[94:95], v245 offset:22528
  ds_read_b64_tr_b16 a[112:113], v242 offset:26624
  v_mfma_f32_16x16x32_bf16 v[76:79], a[116:119], a[8:11], v[76:79]
  ds_read_b64_tr_b16 a[114:115], v242 offset:30720
  s_add_u32 s17, s17, 458752
  v_mfma_f32_16x16x32_bf16 v[92:95], a[116:119], a[12:15], v[92:95]
  ds_read_b64_tr_b16 a[116:117], v243 offset:26624
  ds_read_b64_tr_b16 a[118:119], v243 offset:30720
  v_mfma_f32_16x16x32_bf16 v[80:83], a[120:123], a[8:11], v[80:83]
  s_cmp_eq_u32 s17, s93
  v_mfma_f32_16x16x32_bf16 v[96:99], a[120:123], a[12:15], v[96:99]
  ds_read_b64_tr_b16 a[120:121], v244 offset:26624
  ds_read_b64_tr_b16 a[122:123], v244 offset:30720
  v_mfma_f32_16x16x32_bf16 v[84:87], a[124:127], a[8:11], v[84:87]
  s_cselect_b32 s17, s95, s17
  v_mfma_f32_16x16x32_bf16 v[100:103], a[124:127], a[12:15], v[100:103]
  ds_read_b64_tr_b16 a[124:125], v245 offset:26624
  ds_read_b64_tr_b16 a[126:127], v245 offset:30720
  v_mfma_f32_16x16x32_bf16 v[16:19], a[64:67], a[0:3], v[16:19]
  buffer_load_dwordx4 a[48:51], v240, s[4:7], s16 offen offset:0 sc1
  v_mfma_f32_16x16x32_bf16 v[32:35], a[64:67], a[4:7], v[32:35]
  ds_read_b64_tr_b16 a[64:65], v242 offset:16384
  ds_read_b64_tr_b16 a[66:67], v242 offset:20480
  v_mfma_f32_16x16x32_bf16 v[20:23], a[68:71], a[0:3], v[20:23]
  buffer_load_dwordx4 a[52:55], v240, s[4:7], s16 offen offset:1024 sc1
  v_mfma_f32_16x16x32_bf16 v[36:39], a[68:71], a[4:7], v[36:39]
  ds_read_b64_tr_b16 a[68:69], v243 offset:16384
  ds_read_b64_tr_b16 a[70:71], v243 offset:20480
  s_waitcnt lgkmcnt(10)
  v_mfma_f32_16x16x32_bf16 v[24:27], a[72:75], a[0:3], v[24:27]
  buffer_load_dwordx4 a[56:59], v241, s[4:7], s16 offen offset:0 sc1
  v_mfma_f32_16x16x32_bf16 v[40:43], a[72:75], a[4:7], v[40:43]
  ds_read_b64_tr_b16 a[72:73], v244 offset:16384
  ds_read_b64_tr_b16 a[74:75], v244 offset:20480
  v_mfma_f32_16x16x32_bf16 v[28:31], a[76:79], a[0:3], v[28:31]
  buffer_load_dwordx4 a[60:63], v241, s[4:7], s16 offen offset:1024 sc1
  v_mfma_f32_16x16x32_bf16 v[44:47], a[76:79], a[4:7], v[44:47]
  ds_read_b64_tr_b16 a[76:77], v245 offset:16384
  ds_read_b64_tr_b16 a[78:79], v245 offset:20480
  v_mfma_f32_16x16x32_bf16 v[16:19], a[96:99], a[8:11], v[16:19]
  s_add_u32 s41, s41, 262144
  v_mfma_f32_16x16x32_bf16 v[32:35], a[96:99], a[12:15], v[32:35]
  ds_read_b64_tr_b16 a[96:97], v242 offset:24576
  ds_read_b64_tr_b16 a[98:99], v242 offset:28672
  v_mfma_f32_16x16x32_bf16 v[20:23], a[100:103], a[8:11], v[20:23]
  s_bitset0_b32 s41, 21
  v_mfma_f32_16x16x32_bf16 v[36:39], a[100:103], a[12:15], v[36:39]
  ds_read_b64_tr_b16 a[100:101], v243 offset:24576
  ds_read_b64_tr_b16 a[102:103], v243 offset:28672
  v_mfma_f32_16x16x32_bf16 v[24:27], a[104:107], a[8:11], v[24:27]
  s_add_u32 s16, s40, s41
  v_mfma_f32_16x16x32_bf16 v[40:43], a[104:107], a[12:15], v[40:43]
  ds_read_b64_tr_b16 a[104:105], v244 offset:24576
  ds_read_b64_tr_b16 a[106:107], v244 offset:28672
  v_mfma_f32_16x16x32_bf16 v[28:31], a[108:111], a[8:11], v[28:31]
  v_mfma_f32_16x16x32_bf16 v[44:47], a[108:111], a[12:15], v[44:47]
  s_waitcnt vmcnt(12) lgkmcnt(10)
  s_barrier
  v_mfma_f32_16x16x32_bf16 v[72:75], a[80:83], a[16:19], v[72:75]
  ds_read_b64_tr_b16 a[108:109], v245 offset:24576
  s_add_u32 m0, s38, 0
  v_mfma_f32_16x16x32_bf16 v[88:91], a[80:83], a[20:23], v[88:91]
  ds_read_b64_tr_b16 a[110:111], v245 offset:28672
  ds_read_b64_tr_b16 a[80:81], v242 offset:34816
  v_mfma_f32_16x16x32_bf16 v[76:79], a[84:87], a[16:19], v[76:79]
  buffer_load_dwordx4 v225, s[8:11], s17 offen lds
  v_mfma_f32_16x16x32_bf16 v[92:95], a[84:87], a[20:23], v[92:95]
  ds_read_b64_tr_b16 a[82:83], v242 offset:38912
  ds_read_b64_tr_b16 a[84:85], v243 offset:34816
  v_mfma_f32_16x16x32_bf16 v[80:83], a[88:91], a[16:19], v[80:83]
  buffer_load_dwordx4 v226, s[8:11], s17 offen offset:1024 lds
  v_mfma_f32_16x16x32_bf16 v[96:99], a[88:91], a[20:23], v[96:99]
  ds_read_b64_tr_b16 a[86:87], v243 offset:38912
  ds_read_b64_tr_b16 a[88:89], v244 offset:34816
  v_mfma_f32_16x16x32_bf16 v[84:87], a[92:95], a[16:19], v[84:87]
  buffer_load_dwordx4 v227, s[8:11], s17 offen offset:2048 lds
  v_mfma_f32_16x16x32_bf16 v[100:103], a[92:95], a[20:23], v[100:103]
  ds_read_b64_tr_b16 a[90:91], v244 offset:38912
  ds_read_b64_tr_b16 a[92:93], v245 offset:34816
  v_mfma_f32_16x16x32_bf16 v[72:75], a[112:115], a[24:27], v[72:75]
  buffer_load_dwordx4 v228, s[8:11], s17 offen offset:3072 lds
  v_mfma_f32_16x16x32_bf16 v[88:91], a[112:115], a[28:31], v[88:91]
  ds_read_b64_tr_b16 a[94:95], v245 offset:38912
  ds_read_b64_tr_b16 a[112:113], v242 offset:43008
  v_mfma_f32_16x16x32_bf16 v[76:79], a[116:119], a[24:27], v[76:79]
  ds_read_b64_tr_b16 a[114:115], v242 offset:47104
  s_add_u32 s17, s17, 458752
  v_mfma_f32_16x16x32_bf16 v[92:95], a[116:119], a[28:31], v[92:95]
  ds_read_b64_tr_b16 a[116:117], v243 offset:43008
  ds_read_b64_tr_b16 a[118:119], v243 offset:47104
  v_mfma_f32_16x16x32_bf16 v[80:83], a[120:123], a[24:27], v[80:83]
  s_cmp_eq_u32 s17, s93
  v_mfma_f32_16x16x32_bf16 v[96:99], a[120:123], a[28:31], v[96:99]
  ds_read_b64_tr_b16 a[120:121], v244 offset:43008
  ds_read_b64_tr_b16 a[122:123], v244 offset:47104
  v_mfma_f32_16x16x32_bf16 v[84:87], a[124:127], a[24:27], v[84:87]
  s_cselect_b32 s17, s95, s17
  v_mfma_f32_16x16x32_bf16 v[100:103], a[124:127], a[28:31], v[100:103]
  ds_read_b64_tr_b16 a[124:125], v245 offset:43008
  ds_read_b64_tr_b16 a[126:127], v245 offset:47104
  v_mfma_f32_16x16x32_bf16 v[16:19], a[64:67], a[16:19], v[16:19]
  buffer_load_dwordx4 a[0:3], v240, s[4:7], s16 offen offset:0 sc1
  v_mfma_f32_16x16x32_bf16 v[32:35], a[64:67], a[20:23], v[32:35]
  ds_read_b64_tr_b16 a[64:65], v242 offset:32768
  ds_read_b64_tr_b16 a[66:67], v242 offset:36864
  v_mfma_f32_16x16x32_bf16 v[20:23], a[68:71], a[16:19], v[20:23]
  buffer_load_dwordx4 a[4:7], v240, s[4:7], s16 offen offset:1024 sc1
  v_mfma_f32_16x16x32_bf16 v[36:39], a[68:71], a[20:23], v[36:39]
  ds_read_b64_tr_b16 a[68:69], v243 offset:32768
  ds_read_b64_tr_b16 a[70:71], v243 offset:36864
  s_waitcnt lgkmcnt(10)
  v_mfma_f32_16x16x32_bf16 v[24:27], a[72:75], a[16:19], v[24:27]
  buffer_load_dwordx4 a[8:11], v241, s[4:7], s16 offen offset:0 sc1
  v_mfma_f32_16x16x32_bf16 v[40:43], a[72:75], a[20:23], v[40:43]
  ds_read_b64_tr_b16 a[72:73], v244 offset:32768
  ds_read_b64_tr_b16 a[74:75], v244 offset:36864
  v_mfma_f32_16x16x32_bf16 v[28:31], a[76:79], a[16:19], v[28:31]
  buffer_load_dwordx4 a[12:15], v241, s[4:7], s16 offen offset:1024 sc1
  v_mfma_f32_16x16x32_bf16 v[44:47], a[76:79], a[20:23], v[44:47]
  ds_read_b64_tr_b16 a[76:77], v245 offset:32768
  ds_read_b64_tr_b16 a[78:79], v245 offset:36864
  v_mfma_f32_16x16x32_bf16 v[16:19], a[96:99], a[24:27], v[16:19]
  s_add_u32 s41, s41, 262144
  v_mfma_f32_16x16x32_bf16 v[32:35], a[96:99], a[28:31], v[32:35]
  ds_read_b64_tr_b16 a[96:97], v242 offset:40960
  ds_read_b64_tr_b16 a[98:99], v242 offset:45056
  v_mfma_f32_16x16x32_bf16 v[20:23], a[100:103], a[24:27], v[20:23]
  s_bitset0_b32 s41, 21
  v_mfma_f32_16x16x32_bf16 v[36:39], a[100:103], a[28:31], v[36:39]
  ds_read_b64_tr_b16 a[100:101], v243 offset:40960
  ds_read_b64_tr_b16 a[102:103], v243 offset:45056
  v_mfma_f32_16x16x32_bf16 v[24:27], a[104:107], a[24:27], v[24:27]
  s_add_u32 s16, s40, s41
  v_mfma_f32_16x16x32_bf16 v[40:43], a[104:107], a[28:31], v[40:43]
  ds_read_b64_tr_b16 a[104:105], v244 offset:40960
  ds_read_b64_tr_b16 a[106:107], v244 offset:45056
  v_mfma_f32_16x16x32_bf16 v[28:31], a[108:111], a[24:27], v[28:31]
  v_mfma_f32_16x16x32_bf16 v[44:47], a[108:111], a[28:31], v[44:47]
  s_waitcnt vmcnt(12) lgkmcnt(10)
  s_barrier
  v_mfma_f32_16x16x32_bf16 v[72:75], a[80:83], a[32:35], v[72:75]
  ds_read_b64_tr_b16 a[108:109], v245 offset:40960
  s_add_u32 m0, s38, 16384
  v_mfma_f32_16x16x32_bf16 v[88:91], a[80:83], a[36:39], v[88:91]
  ds_read_b64_tr_b16 a[110:111], v245 offset:45056
  v_accvgpr_read_b32 v0, a128
  v_mfma_f32_16x16x32_bf16 v[76:79], a[84:87], a[32:35], v[76:79]
  buffer_load_dwordx4 v225, s[8:11], s17 offen lds
  v_mfma_f32_16x16x32_bf16 v[92:95], a[84:87], a[36:39], v[92:95]
  ds_read_b64_tr_b16 a[80:81], v242 offset:51200
  v_accvgpr_read_b32 v1, a129
  v_mfma_f32_16x16x32_bf16 v[80:83], a[88:91], a[32:35], v[80:83]
  ds_read_b64_tr_b16 a[82:83], v242 offset:55296
  buffer_load_dwordx4 v226, s[8:11], s17 offen offset:1024 lds
  v_mfma_f32_16x16x32_bf16 v[96:99], a[88:91], a[36:39], v[96:99]
  ds_read_b64_tr_b16 a[84:85], v243 offset:51200
  v_accvgpr_read_b32 v2, a130
  v_mfma_f32_16x16x32_bf16 v[84:87], a[92:95], a[32:35], v[84:87]
  ds_read_b64_tr_b16 a[86:87], v243 offset:55296
  buffer_load_dwordx4 v227, s[8:11], s17 offen offset:2048 lds
  v_mfma_f32_16x16x32_bf16 v[100:103], a[92:95], a[36:39], v[100:103]
  ds_read_b64_tr_b16 a[88:89], v244 offset:51200
  ds_read_b64_tr_b16 a[90:91], v244 offset:55296
  v_mfma_f32_16x16x32_bf16 v[72:75], a[112:115], a[40:43], v[72:75]
  ds_read_b64_tr_b16 a[92:93], v245 offset:51200
  v_accvgpr_read_b32 v3, a131
  v_mfma_f32_16x16x32_bf16 v[88:91], a[112:115], a[44:47], v[88:91]
  buffer_load_dwordx4 v228, s[8:11], s17 offen offset:3072 lds
  v_mfma_f32_16x16x32_bf16 v[76:79], a[116:119], a[40:43], v[76:79]
  ds_read_b64_tr_b16 a[94:95], v245 offset:55296
  v_lshlrev_b32 v192, 16, v0
  v_mfma_f32_16x16x32_bf16 v[92:95], a[116:119], a[44:47], v[92:95]
  ds_read_b64_tr_b16 a[112:113], v242 offset:59392
  s_add_u32 s17, s17, 458752
  v_mfma_f32_16x16x32_bf16 v[80:83], a[120:123], a[40:43], v[80:83]
  ds_read_b64_tr_b16 a[114:115], v242 offset:63488
  v_and_b32 v193, 0xffff0000, v0
  v_mfma_f32_16x16x32_bf16 v[96:99], a[120:123], a[44:47], v[96:99]
  ds_read_b64_tr_b16 a[116:117], v243 offset:59392
  s_cmp_eq_u32 s17, s93
  v_mfma_f32_16x16x32_bf16 v[84:87], a[124:127], a[40:43], v[84:87]
  ds_read_b64_tr_b16 a[118:119], v243 offset:63488
  s_cselect_b32 s17, s95, s17
  v_mfma_f32_16x16x32_bf16 v[100:103], a[124:127], a[44:47], v[100:103]
  ds_read_b64_tr_b16 a[120:121], v244 offset:59392
  v_lshlrev_b32 v194, 16, v1
  v_mfma_f32_16x16x32_bf16 v[16:19], a[64:67], a[32:35], v[16:19]
  ds_read_b64_tr_b16 a[122:123], v244 offset:63488
  buffer_load_dwordx4 a[16:19], v240, s[4:7], s16 offen offset:0 sc1
  v_mfma_f32_16x16x32_bf16 v[32:35], a[64:67], a[36:39], v[32:35]
  ds_read_b64_tr_b16 a[124:125], v245 offset:59392
  v_and_b32 v195, 0xffff0000, v1
  v_mfma_f32_16x16x32_bf16 v[20:23], a[68:71], a[32:35], v[20:23]
  ds_read_b64_tr_b16 a[126:127], v245 offset:63488
  buffer_load_dwordx4 a[20:23], v240, s[4:7], s16 offen offset:1024 sc1
  v_mfma_f32_16x16x32_bf16 v[36:39], a[68:71], a[36:39], v[36:39]
  ds_read_b64_tr_b16 a[64:65], v242 offset:49152
  v_lshlrev_b32 v196, 16, v2
  s_waitcnt lgkmcnt(10)
  v_mfma_f32_16x16x32_bf16 v[24:27], a[72:75], a[32:35], v[24:27]
  ds_read_b64_tr_b16 a[66:67], v242 offset:53248
  buffer_load_dwordx4 a[24:27], v241, s[4:7], s16 offen offset:0 sc1
  v_mfma_f32_16x16x32_bf16 v[40:43], a[72:75], a[36:39], v[40:43]
  ds_read_b64_tr_b16 a[68:69], v243 offset:49152
  ds_read_b64_tr_b16 a[70:71], v243 offset:53248
  v_mfma_f32_16x16x32_bf16 v[28:31], a[76:79], a[32:35], v[28:31]
  ds_read_b64_tr_b16 a[72:73], v244 offset:49152
  v_and_b32 v197, 0xffff0000, v2
  v_mfma_f32_16x16x32_bf16 v[44:47], a[76:79], a[36:39], v[44:47]
  buffer_load_dwordx4 a[28:31], v241, s[4:7], s16 offen offset:1024 sc1
  v_mfma_f32_16x16x32_bf16 v[16:19], a[96:99], a[40:43], v[16:19]
  ds_read_b64_tr_b16 a[74:75], v244 offset:53248
  v_lshlrev_b32 v198, 16, v3
  v_mfma_f32_16x16x32_bf16 v[32:35], a[96:99], a[44:47], v[32:35]
  ds_read_b64_tr_b16 a[76:77], v245 offset:49152
  s_add_u32 s41, s41, 262144
  v_mfma_f32_16x16x32_bf16 v[20:23], a[100:103], a[40:43], v[20:23]
  ds_read_b64_tr_b16 a[78:79], v245 offset:53248
  v_and_b32 v199, 0xffff0000, v3
  v_mfma_f32_16x16x32_bf16 v[36:39], a[100:103], a[44:47], v[36:39]
  ds_read_b64_tr_b16 a[96:97], v242 offset:57344
  s_bitset0_b32 s41, 21
  v_mfma_f32_16x16x32_bf16 v[24:27], a[104:107], a[40:43], v[24:27]
  ds_read_b64_tr_b16 a[98:99], v242 offset:61440
  s_add_u32 s16, s40, s41
  v_mfma_f32_16x16x32_bf16 v[40:43], a[104:107], a[44:47], v[40:43]
  ds_read_b64_tr_b16 a[100:101], v243 offset:57344
  ds_read_b64_tr_b16 a[102:103], v243 offset:61440
  v_mfma_f32_16x16x32_bf16 v[28:31], a[108:111], a[40:43], v[28:31]
  ds_read_b64_tr_b16 a[104:105], v244 offset:57344
  ds_read_b128 v[56:59], v253 offset:768
  v_mfma_f32_16x16x32_bf16 v[44:47], a[108:111], a[44:47], v[44:47]
  s_waitcnt vmcnt(12) lgkmcnt(10)
  s_barrier
  v_mfma_f32_16x16x32_bf16 v[72:75], a[80:83], a[48:51], v[72:75]
  ds_read_b64_tr_b16 a[106:107], v244 offset:61440
  s_add_u32 m0, s38, 32768
  v_mfma_f32_16x16x32_bf16 v[88:91], a[80:83], a[52:55], v[88:91]
  ds_read_b64_tr_b16 a[108:109], v245 offset:57344
  v_accvgpr_read_b32 v4, a132
  v_mfma_f32_16x16x32_bf16 v[76:79], a[84:87], a[48:51], v[76:79]
  ds_read_b64_tr_b16 a[110:111], v245 offset:61440
  buffer_load_dwordx4 v225, s[8:11], s17 offen lds
  v_mfma_f32_16x16x32_bf16 v[92:95], a[84:87], a[52:55], v[92:95]
  ds_read_b64_tr_b16 a[80:81], v242 offset:2048
  v_accvgpr_read_b32 v5, a133
  v_mfma_f32_16x16x32_bf16 v[80:83], a[88:91], a[48:51], v[80:83]
  ds_read_b64_tr_b16 a[82:83], v242 offset:6144
  buffer_load_dwordx4 v226, s[8:11], s17 offen offset:1024 lds
  v_mfma_f32_16x16x32_bf16 v[96:99], a[88:91], a[52:55], v[96:99]
  ds_read_b64_tr_b16 a[84:85], v243 offset:2048
  v_accvgpr_read_b32 v6, a134
  v_mfma_f32_16x16x32_bf16 v[84:87], a[92:95], a[48:51], v[84:87]
  ds_read_b64_tr_b16 a[86:87], v243 offset:6144
  buffer_load_dwordx4 v227, s[8:11], s17 offen offset:2048 lds
  v_mfma_f32_16x16x32_bf16 v[100:103], a[92:95], a[52:55], v[100:103]
  ds_read_b64_tr_b16 a[88:89], v244 offset:2048
  ds_read_b64_tr_b16 a[90:91], v244 offset:6144
  v_mfma_f32_16x16x32_bf16 v[72:75], a[112:115], a[56:59], v[72:75]
  ds_read_b64_tr_b16 a[92:93], v245 offset:2048
  v_accvgpr_read_b32 v7, a135
  v_mfma_f32_16x16x32_bf16 v[88:91], a[112:115], a[60:63], v[88:91]
  buffer_load_dwordx4 v228, s[8:11], s17 offen offset:3072 lds
  v_mfma_f32_16x16x32_bf16 v[76:79], a[116:119], a[56:59], v[76:79]
  ds_read_b64_tr_b16 a[94:95], v245 offset:6144
  v_lshlrev_b32 v200, 16, v4
  v_mfma_f32_16x16x32_bf16 v[92:95], a[116:119], a[60:63], v[92:95]
  ds_read_b64_tr_b16 a[112:113], v242 offset:10240
  s_add_u32 s17, s17, 458752
  v_mfma_f32_16x16x32_bf16 v[80:83], a[120:123], a[56:59], v[80:83]
  ds_read_b64_tr_b16 a[114:115], v242 offset:14336
  v_and_b32 v201, 0xffff0000, v4
  v_mfma_f32_16x16x32_bf16 v[96:99], a[120:123], a[60:63], v[96:99]
  ds_read_b64_tr_b16 a[116:117], v243 offset:10240
  s_cmp_eq_u32 s17, s93
  v_mfma_f32_16x16x32_bf16 v[84:87], a[124:127], a[56:59], v[84:87]
  ds_read_b64_tr_b16 a[118:119], v243 offset:14336
  s_cselect_b32 s17, s95, s17
  v_mfma_f32_16x16x32_bf16 v[100:103], a[124:127], a[60:63], v[100:103]
  v_lshlrev_b32 v202, 16, v5
  buffer_load_dword v247, v246, s[56:59], s94 offen sc1
  v_mfma_f32_16x16x32_bf16 v[16:19], a[64:67], a[48:51], v[16:19]
  ds_read_b64_tr_b16 a[120:121], v244 offset:10240
  ds_read_b64_tr_b16 a[122:123], v244 offset:14336
  buffer_load_dwordx4 a[32:35], v240, s[4:7], s16 offen offset:0 sc1
  v_mfma_f32_16x16x32_bf16 v[32:35], a[64:67], a[52:55], v[32:35]
  ds_read_b64_tr_b16 a[124:125], v245 offset:10240
  v_and_b32 v203, 0xffff0000, v5
  v_mfma_f32_16x16x32_bf16 v[20:23], a[68:71], a[48:51], v[20:23]
  ds_read_b64_tr_b16 a[126:127], v245 offset:14336
  buffer_load_dwordx4 a[36:39], v240, s[4:7], s16 offen offset:1024 sc1
  v_mfma_f32_16x16x32_bf16 v[36:39], a[68:71], a[52:55], v[36:39]
  ds_read_b64_tr_b16 a[64:65], v242 offset:0
  v_lshlrev_b32 v204, 16, v6
  s_waitcnt lgkmcnt(10)
  v_mfma_f32_16x16x32_bf16 v[24:27], a[72:75], a[48:51], v[24:27]
  ds_read_b64_tr_b16 a[66:67], v242 offset:4096
  buffer_load_dwordx4 a[40:43], v241, s[4:7], s16 offen offset:0 sc1
  v_mfma_f32_16x16x32_bf16 v[40:43], a[72:75], a[52:55], v[40:43]
  ds_read_b64_tr_b16 a[68:69], v243 offset:0
  ds_read_b64_tr_b16 a[70:71], v243 offset:4096
  v_mfma_f32_16x16x32_bf16 v[28:31], a[76:79], a[48:51], v[28:31]
  ds_read_b64_tr_b16 a[72:73], v244 offset:0
  v_and_b32 v205, 0xffff0000, v6
  v_mfma_f32_16x16x32_bf16 v[44:47], a[76:79], a[52:55], v[44:47]
  buffer_load_dwordx4 a[44:47], v241, s[4:7], s16 offen offset:1024 sc1
  v_mfma_f32_16x16x32_bf16 v[16:19], a[96:99], a[56:59], v[16:19]
  ds_read_b64_tr_b16 a[74:75], v244 offset:4096
  v_lshlrev_b32 v206, 16, v7
  v_mfma_f32_16x16x32_bf16 v[32:35], a[96:99], a[60:63], v[32:35]
  ds_read_b64_tr_b16 a[76:77], v245 offset:0
  s_add_u32 s41, s41, 262144
  v_mfma_f32_16x16x32_bf16 v[20:23], a[100:103], a[56:59], v[20:23]
  ds_read_b64_tr_b16 a[78:79], v245 offset:4096
  v_and_b32 v207, 0xffff0000, v7
  v_mfma_f32_16x16x32_bf16 v[36:39], a[100:103], a[60:63], v[36:39]
  ds_read_b64_tr_b16 a[96:97], v242 offset:8192
  s_bitset0_b32 s41, 21
  v_mfma_f32_16x16x32_bf16 v[24:27], a[104:107], a[56:59], v[24:27]
  ds_read_b64_tr_b16 a[98:99], v242 offset:12288
  s_add_u32 s16, s40, s41
  v_mfma_f32_16x16x32_bf16 v[40:43], a[104:107], a[60:63], v[40:43]
  ds_read_b64_tr_b16 a[100:101], v243 offset:8192
  ds_read_b64_tr_b16 a[102:103], v243 offset:12288
  v_mfma_f32_16x16x32_bf16 v[28:31], a[108:111], a[56:59], v[28:31]
  ds_read_b64_tr_b16 a[104:105], v244 offset:8192
  ds_read_b128 v[60:63], v253 offset:832
  v_mfma_f32_16x16x32_bf16 v[44:47], a[108:111], a[60:63], v[44:47]
  s_waitcnt vmcnt(13) lgkmcnt(10)
  s_barrier
  v_mfma_f32_16x16x32_bf16 v[72:75], a[80:83], a[0:3], v[72:75]
  ds_read_b64_tr_b16 a[106:107], v244 offset:12288
  s_add_u32 m0, s38, 49152
  v_mfma_f32_16x16x32_bf16 v[88:91], a[80:83], a[4:7], v[88:91]
  ds_read_b64_tr_b16 a[108:109], v245 offset:8192
  v_accvgpr_read_b32 v8, a136
  v_mfma_f32_16x16x32_bf16 v[76:79], a[84:87], a[0:3], v[76:79]
  ds_read_b64_tr_b16 a[110:111], v245 offset:12288
  buffer_load_dwordx4 v225, s[8:11], s17 offen lds
  v_mfma_f32_16x16x32_bf16 v[92:95], a[84:87], a[4:7], v[92:95]
  v_accvgpr_read_b32 v9, a137
  buffer_load_dwordx4 v226, s[8:11], s17 offen offset:1024 lds
  v_mfma_f32_16x16x32_bf16 v[80:83], a[88:91], a[0:3], v[80:83]
  ds_read_b64_tr_b16 a[80:81], v242 offset:18432
  ds_read_b64_tr_b16 a[82:83], v242 offset:22528
  buffer_load_dwordx4 v227, s[8:11], s17 offen offset:2048 lds
  v_mfma_f32_16x16x32_bf16 v[96:99], a[88:91], a[4:7], v[96:99]
  ds_read_b64_tr_b16 a[84:85], v243 offset:18432
  v_accvgpr_read_b32 v10, a138
  v_mfma_f32_16x16x32_bf16 v[84:87], a[92:95], a[0:3], v[84:87]
  ds_read_b64_tr_b16 a[86:87], v243 offset:22528
  buffer_load_dwordx4 v228, s[8:11], s17 offen offset:3072 lds
  v_mfma_f32_16x16x32_bf16 v[100:103], a[92:95], a[4:7], v[100:103]
  ds_read_b64_tr_b16 a[88:89], v244 offset:18432
  ds_read_b64_tr_b16 a[90:91], v244 offset:22528
  v_mfma_f32_16x16x32_bf16 v[72:75], a[112:115], a[8:11], v[72:75]
  v_accvgpr_read_b32 v11, a139
  s_add_u32 s17, s17, 458752
  v_mfma_f32_16x16x32_bf16 v[88:91], a[112:115], a[12:15], v[88:91]
  ds_read_b64_tr_b16 a[92:93], v245 offset:18432
  s_cmp_eq_u32 s17, s93
  v_mfma_f32_16x16x32_bf16 v[76:79], a[116:119], a[8:11], v[76:79]
  ds_read_b64_tr_b16 a[94:95], v245 offset:22528
  v_lshlrev_b32 v208, 16, v8
  v_mfma_f32_16x16x32_bf16 v[92:95], a[116:119], a[12:15], v[92:95]
  ds_read_b64_tr_b16 a[112:113], v242 offset:26624
  s_cselect_b32 s17, s95, s17
  v_mfma_f32_16x16x32_bf16 v[80:83], a[120:123], a[8:11], v[80:83]
  ds_read_b64_tr_b16 a[114:115], v242 offset:30720
  v_and_b32 v209, 0xffff0000, v8
  v_mfma_f32_16x16x32_bf16 v[96:99], a[120:123], a[12:15], v[96:99]
  ds_read_b64_tr_b16 a[116:117], v243 offset:26624
  s_add_u32 s17, s17, 65536
  v_mfma_f32_16x16x32_bf16 v[84:87], a[124:127], a[8:11], v[84:87]
  ds_read_b64_tr_b16 a[118:119], v243 offset:30720
  s_add_u32 s93, s93, 65536
  v_mfma_f32_16x16x32_bf16 v[100:103], a[124:127], a[12:15], v[100:103]
  ds_read_b64_tr_b16 a[120:121], v244 offset:26624
  v_lshlrev_b32 v210, 16, v9
  v_mfma_f32_16x16x32_bf16 v[16:19], a[64:67], a[0:3], v[16:19]
  ds_read_b64_tr_b16 a[122:123], v244 offset:30720
  s_add_u32 s95, s95, 65536
  v_mfma_f32_16x16x32_bf16 v[32:35], a[64:67], a[4:7], v[32:35]
  ds_read_b64_tr_b16 a[124:125], v245 offset:26624
  v_and_b32 v211, 0xffff0000, v9
  v_mfma_f32_16x16x32_bf16 v[20:23], a[68:71], a[0:3], v[20:23]
  ds_read_b64_tr_b16 a[126:127], v245 offset:30720
  buffer_load_dwordx4 a[48:51], v240, s[4:7], s16 offen offset:0 sc1
  v_mfma_f32_16x16x32_bf16 v[36:39], a[68:71], a[4:7], v[36:39]
  ds_read_b64_tr_b16 a[64:65], v242 offset:16384
  v_lshlrev_b32 v212, 16, v10
  s_waitcnt lgkmcnt(10)
  v_mfma_f32_16x16x32_bf16 v[24:27], a[72:75], a[0:3], v[24:27]
  ds_read_b64_tr_b16 a[66:67], v242 offset:20480
  buffer_load_dwordx4 a[52:55], v240, s[4:7], s16 offen offset:1024 sc1
  v_mfma_f32_16x16x32_bf16 v[40:43], a[72:75], a[4:7], v[40:43]
  buffer_load_dwordx4 a[56:59], v241, s[4:7], s16 offen offset:0 sc1
  v_mfma_f32_16x16x32_bf16 v[28:31], a[76:79], a[0:3], v[28:31]
  ds_read_b64_tr_b16 a[68:69], v243 offset:16384
  ds_read_b64_tr_b16 a[70:71], v243 offset:20480
  v_and_b32 v213, 0xffff0000, v10
  v_mfma_f32_16x16x32_bf16 v[44:47], a[76:79], a[4:7], v[44:47]
  buffer_load_dwordx4 a[60:63], v241, s[4:7], s16 offen offset:1024 sc1
  v_mfma_f32_16x16x32_bf16 v[16:19], a[96:99], a[8:11], v[16:19]
  ds_read_b64_tr_b16 a[72:73], v244 offset:16384
  ds_read_b64_tr_b16 a[74:75], v244 offset:20480
  v_lshlrev_b32 v214, 16, v11
  v_mfma_f32_16x16x32_bf16 v[32:35], a[96:99], a[12:15], v[32:35]
  ds_read_b64_tr_b16 a[76:77], v245 offset:16384
  s_add_u32 s41, s41, 262144
  v_mfma_f32_16x16x32_bf16 v[20:23], a[100:103], a[8:11], v[20:23]
  ds_read_b64_tr_b16 a[78:79], v245 offset:20480
  v_and_b32 v215, 0xffff0000, v11
  s_bitset0_b32 s41, 21
  v_mfma_f32_16x16x32_bf16 v[36:39], a[100:103], a[12:15], v[36:39]
  ds_read_b64_tr_b16 a[96:97], v242 offset:24576
  s_add_u32 s40, s40, 2097152
  v_mfma_f32_16x16x32_bf16 v[24:27], a[104:107], a[8:11], v[24:27]
  ds_read_b64_tr_b16 a[98:99], v242 offset:28672
  ds_read_b64_tr_b16 a[100:101], v243 offset:24576
  v_mfma_f32_16x16x32_bf16 v[40:43], a[104:107], a[12:15], v[40:43]
  ds_read_b64_tr_b16 a[102:103], v243 offset:28672
  s_add_u32 s16, s40, s41
  v_mfma_f32_16x16x32_bf16 v[28:31], a[108:111], a[8:11], v[28:31]
  ds_read_b64_tr_b16 a[104:105], v244 offset:24576
  ds_read_b128 v[64:67], v253 offset:896
  v_mfma_f32_16x16x32_bf16 v[44:47], a[108:111], a[12:15], v[44:47]
  s_waitcnt vmcnt(12) lgkmcnt(10)
  s_barrier
  v_cmp_ne_u32 vcc, s19, v247
  s_nop 1
  s_cmp_lg_u64 vcc, 0
  s_cbranch_scc1 L_slow_29
  L_back_30:
  s_add_u32 s94, s94, 65536
  v_mfma_f32_16x16x32_bf16 v[72:75], a[80:83], a[16:19], v[72:75]
  ds_read_b64_tr_b16 a[106:107], v244 offset:28672
  s_add_u32 m0, s38, 0
  v_mfma_f32_16x16x32_bf16 v[88:91], a[80:83], a[20:23], v[88:91]
  ds_read_b64_tr_b16 a[108:109], v245 offset:24576
  v_accvgpr_read_b32 v12, a140
  v_mfma_f32_16x16x32_bf16 v[76:79], a[84:87], a[16:19], v[76:79]
  ds_read_b64_tr_b16 a[110:111], v245 offset:28672
  buffer_load_dwordx4 v225, s[8:11], s17 offen lds
  v_mfma_f32_16x16x32_bf16 v[92:95], a[84:87], a[20:23], v[92:95]
  ds_read_b64_tr_b16 a[80:81], v242 offset:34816
  v_accvgpr_read_b32 v13, a141
  v_mfma_f32_16x16x32_bf16 v[80:83], a[88:91], a[16:19], v[80:83]
  ds_read_b64_tr_b16 a[82:83], v242 offset:38912
  buffer_load_dwordx4 v226, s[8:11], s17 offen offset:1024 lds
  v_mfma_f32_16x16x32_bf16 v[96:99], a[88:91], a[20:23], v[96:99]
  ds_read_b64_tr_b16 a[84:85], v243 offset:34816
  v_accvgpr_read_b32 v14, a142
  v_mfma_f32_16x16x32_bf16 v[84:87], a[92:95], a[16:19], v[84:87]
  ds_read_b64_tr_b16 a[86:87], v243 offset:38912
  buffer_load_dwordx4 v227, s[8:11], s17 offen offset:2048 lds
  v_mfma_f32_16x16x32_bf16 v[100:103], a[92:95], a[20:23], v[100:103]
  ds_read_b64_tr_b16 a[88:89], v244 offset:34816
  ds_read_b64_tr_b16 a[90:91], v244 offset:38912
  v_mfma_f32_16x16x32_bf16 v[72:75], a[112:115], a[24:27], v[72:75]
  ds_read_b64_tr_b16 a[92:93], v245 offset:34816
  v_accvgpr_read_b32 v15, a143
  v_mfma_f32_16x16x32_bf16 v[88:91], a[112:115], a[28:31], v[88:91]
  buffer_load_dwordx4 v228, s[8:11], s17 offen offset:3072 lds
  v_mfma_f32_16x16x32_bf16 v[76:79], a[116:119], a[24:27], v[76:79]
  ds_read_b64_tr_b16 a[94:95], v245 offset:38912
  v_lshlrev_b32 v216, 16, v12
  v_mfma_f32_16x16x32_bf16 v[92:95], a[116:119], a[28:31], v[92:95]
  ds_read_b64_tr_b16 a[112:113], v242 offset:43008
  s_add_u32 s17, s17, 458752
  v_mfma_f32_16x16x32_bf16 v[80:83], a[120:123], a[24:27], v[80:83]
  ds_read_b64_tr_b16 a[114:115], v242 offset:47104
  v_and_b32 v217, 0xffff0000, v12
  v_mfma_f32_16x16x32_bf16 v[96:99], a[120:123], a[28:31], v[96:99]
  ds_read_b64_tr_b16 a[116:117], v243 offset:43008
  s_cmp_eq_u32 s17, s93
  v_mfma_f32_16x16x32_bf16 v[84:87], a[124:127], a[24:27], v[84:87]
  ds_read_b64_tr_b16 a[118:119], v243 offset:47104
  s_cselect_b32 s17, s95, s17
  v_mfma_f32_16x16x32_bf16 v[100:103], a[124:127], a[28:31], v[100:103]
  ds_read_b64_tr_b16 a[120:121], v244 offset:43008
  v_lshlrev_b32 v218, 16, v13
  v_mfma_f32_16x16x32_bf16 v[16:19], a[64:67], a[16:19], v[16:19]
  ds_read_b64_tr_b16 a[122:123], v244 offset:47104
  buffer_load_dwordx4 a[0:3], v240, s[4:7], s16 offen offset:0 sc1
  v_mfma_f32_16x16x32_bf16 v[32:35], a[64:67], a[20:23], v[32:35]
  ds_read_b64_tr_b16 a[124:125], v245 offset:43008
  v_and_b32 v219, 0xffff0000, v13
  v_mfma_f32_16x16x32_bf16 v[20:23], a[68:71], a[16:19], v[20:23]
  ds_read_b64_tr_b16 a[126:127], v245 offset:47104
  buffer_load_dwordx4 a[4:7], v240, s[4:7], s16 offen offset:1024 sc1
  v_mfma_f32_16x16x32_bf16 v[36:39], a[68:71], a[20:23], v[36:39]
  ds_read_b64_tr_b16 a[64:65], v242 offset:32768
  v_lshlrev_b32 v220, 16, v14
  s_waitcnt lgkmcnt(10)
  v_mfma_f32_16x16x32_bf16 v[24:27], a[72:75], a[16:19], v[24:27]
  ds_read_b64_tr_b16 a[66:67], v242 offset:36864
  buffer_load_dwordx4 a[8:11], v241, s[4:7], s16 offen offset:0 sc1
  v_mfma_f32_16x16x32_bf16 v[40:43], a[72:75], a[20:23], v[40:43]
  ds_read_b64_tr_b16 a[68:69], v243 offset:32768
  ds_read_b64_tr_b16 a[70:71], v243 offset:36864
  v_mfma_f32_16x16x32_bf16 v[28:31], a[76:79], a[16:19], v[28:31]
  ds_read_b64_tr_b16 a[72:73], v244 offset:32768
  v_and_b32 v221, 0xffff0000, v14
  v_mfma_f32_16x16x32_bf16 v[44:47], a[76:79], a[20:23], v[44:47]
  buffer_load_dwordx4 a[12:15], v241, s[4:7], s16 offen offset:1024 sc1
  v_mfma_f32_16x16x32_bf16 v[16:19], a[96:99], a[24:27], v[16:19]
  ds_read_b64_tr_b16 a[74:75], v244 offset:36864
  v_lshlrev_b32 v222, 16, v15
  v_mfma_f32_16x16x32_bf16 v[32:35], a[96:99], a[28:31], v[32:35]
  ds_read_b64_tr_b16 a[76:77], v245 offset:32768
  s_add_u32 s41, s41, 262144
  v_mfma_f32_16x16x32_bf16 v[20:23], a[100:103], a[24:27], v[20:23]
  ds_read_b64_tr_b16 a[78:79], v245 offset:36864
  v_and_b32 v223, 0xffff0000, v15
  v_mfma_f32_16x16x32_bf16 v[36:39], a[100:103], a[28:31], v[36:39]
  ds_read_b64_tr_b16 a[96:97], v242 offset:40960
  s_bitset0_b32 s41, 21
  v_mfma_f32_16x16x32_bf16 v[24:27], a[104:107], a[24:27], v[24:27]
  ds_read_b64_tr_b16 a[98:99], v242 offset:45056
  s_add_u32 s16, s40, s41
  v_mfma_f32_16x16x32_bf16 v[40:43], a[104:107], a[28:31], v[40:43]
  ds_read_b64_tr_b16 a[100:101], v243 offset:40960
  ds_read_b64_tr_b16 a[102:103], v243 offset:45056
  v_mfma_f32_16x16x32_bf16 v[28:31], a[108:111], a[24:27], v[28:31]
  ds_read_b64_tr_b16 a[104:105], v244 offset:40960
  ds_read_b128 v[68:71], v253 offset:960
  v_mfma_f32_16x16x32_bf16 v[44:47], a[108:111], a[28:31], v[44:47]
  s_waitcnt vmcnt(12) lgkmcnt(10)
  s_barrier
  v_mfma_f32_16x16x32_bf16 v[72:75], a[80:83], a[32:35], v[72:75]
  ds_read_b64_tr_b16 a[106:107], v244 offset:45056
  s_add_u32 m0, s38, 16384
  v_mfma_f32_16x16x32_bf16 v[88:91], a[80:83], a[36:39], v[88:91]
  ds_read_b64_tr_b16 a[108:109], v245 offset:40960
  ds_read_b64_tr_b16 a[110:111], v245 offset:45056
  v_mfma_f32_16x16x32_bf16 v[76:79], a[84:87], a[32:35], v[76:79]
  buffer_load_dwordx4 v225, s[8:11], s17 offen lds
  v_mfma_f32_16x16x32_bf16 v[92:95], a[84:87], a[36:39], v[92:95]
  ds_read_b64_tr_b16 a[80:81], v242 offset:51200
  ds_read_b64_tr_b16 a[82:83], v242 offset:55296
  v_mfma_f32_16x16x32_bf16 v[80:83], a[88:91], a[32:35], v[80:83]
  buffer_load_dwordx4 v226, s[8:11], s17 offen offset:1024 lds
  v_mfma_f32_16x16x32_bf16 v[96:99], a[88:91], a[36:39], v[96:99]
  ds_read_b64_tr_b16 a[84:85], v243 offset:51200
  ds_read_b64_tr_b16 a[86:87], v243 offset:55296
  v_mfma_f32_16x16x32_bf16 v[84:87], a[92:95], a[32:35], v[84:87]
  buffer_load_dwordx4 v227, s[8:11], s17 offen offset:2048 lds
  v_mfma_f32_16x16x32_bf16 v[100:103], a[92:95], a[36:39], v[100:103]
  ds_read_b64_tr_b16 a[88:89], v244 offset:51200
  ds_read_b64_tr_b16 a[90:91], v244 offset:55296
  v_mfma_f32_16x16x32_bf16 v[72:75], a[112:115], a[40:43], v[72:75]
  buffer_load_dwordx4 v228, s[8:11], s17 offen offset:3072 lds
  v_mfma_f32_16x16x32_bf16 v[88:91], a[112:115], a[44:47], v[88:91]
  ds_read_b64_tr_b16 a[92:93], v245 offset:51200
  ds_read_b64_tr_b16 a[94:95], v245 offset:55296
  v_mfma_f32_16x16x32_bf16 v[76:79], a[116:119], a[40:43], v[76:79]
  ds_read_b64_tr_b16 a[112:113], v242 offset:59392
  s_add_u32 s17, s17, 458752
  v_mfma_f32_16x16x32_bf16 v[92:95], a[116:119], a[44:47], v[92:95]
  ds_read_b64_tr_b16 a[114:115], v242 offset:63488
  ds_read_b64_tr_b16 a[116:117], v243 offset:59392
  v_mfma_f32_16x16x32_bf16 v[80:83], a[120:123], a[40:43], v[80:83]
  ds_read_b64_tr_b16 a[118:119], v243 offset:63488
  s_cmp_eq_u32 s17, s93
  v_mfma_f32_16x16x32_bf16 v[96:99], a[120:123], a[44:47], v[96:99]
  ds_read_b64_tr_b16 a[120:121], v244 offset:59392
  ds_read_b64_tr_b16 a[122:123], v244 offset:63488
  v_mfma_f32_16x16x32_bf16 v[84:87], a[124:127], a[40:43], v[84:87]
  s_cselect_b32 s17, s95, s17
  v_mfma_f32_16x16x32_bf16 v[100:103], a[124:127], a[44:47], v[100:103]
  ds_read_b64_tr_b16 a[124:125], v245 offset:59392
  ds_read_b64_tr_b16 a[126:127], v245 offset:63488
  v_mfma_f32_16x16x32_bf16 v[16:19], a[64:67], a[32:35], v[16:19]
  buffer_load_dwordx4 a[16:19], v240, s[4:7], s16 offen offset:0 sc1
  v_mfma_f32_16x16x32_bf16 v[32:35], a[64:67], a[36:39], v[32:35]
  ds_read_b64_tr_b16 a[64:65], v242 offset:49152
  ds_read_b64_tr_b16 a[66:67], v242 offset:53248
  v_mfma_f32_16x16x32_bf16 v[20:23], a[68:71], a[32:35], v[20:23]
  buffer_load_dwordx4 a[20:23], v240, s[4:7], s16 offen offset:1024 sc1
  v_mfma_f32_16x16x32_bf16 v[36:39], a[68:71], a[36:39], v[36:39]
  ds_read_b64_tr_b16 a[68:69], v243 offset:49152
  ds_read_b64_tr_b16 a[70:71], v243 offset:53248
  s_waitcnt lgkmcnt(10)
  v_mfma_f32_16x16x32_bf16 v[24:27], a[72:75], a[32:35], v[24:27]
  buffer_load_dwordx4 a[24:27], v241, s[4:7], s16 offen offset:0 sc1
  v_mfma_f32_16x16x32_bf16 v[40:43], a[72:75], a[36:39], v[40:43]
  ds_read_b64_tr_b16 a[72:73], v244 offset:49152
  ds_read_b64_tr_b16 a[74:75], v244 offset:53248
  v_mfma_f32_16x16x32_bf16 v[28:31], a[76:79], a[32:35], v[28:31]
  buffer_load_dwordx4 a[28:31], v241, s[4:7], s16 offen offset:1024 sc1
  v_mfma_f32_16x16x32_bf16 v[44:47], a[76:79], a[36:39], v[44:47]
  ds_read_b64_tr_b16 a[76:77], v245 offset:49152
  ds_read_b64_tr_b16 a[78:79], v245 offset:53248
  v_mfma_f32_16x16x32_bf16 v[16:19], a[96:99], a[40:43], v[16:19]
  s_add_u32 s41, s41, 262144
  v_mfma_f32_16x16x32_bf16 v[32:35], a[96:99], a[44:47], v[32:35]
  ds_read_b64_tr_b16 a[96:97], v242 offset:57344
  ds_read_b64_tr_b16 a[98:99], v242 offset:61440
  v_mfma_f32_16x16x32_bf16 v[20:23], a[100:103], a[40:43], v[20:23]
  s_bitset0_b32 s41, 21
  v_mfma_f32_16x16x32_bf16 v[36:39], a[100:103], a[44:47], v[36:39]
  ds_read_b64_tr_b16 a[100:101], v243 offset:57344
  ds_read_b64_tr_b16 a[102:103], v243 offset:61440
  v_mfma_f32_16x16x32_bf16 v[24:27], a[104:107], a[40:43], v[24:27]
  s_add_u32 s16, s40, s41
  v_mfma_f32_16x16x32_bf16 v[40:43], a[104:107], a[44:47], v[40:43]
  ds_read_b64_tr_b16 a[104:105], v244 offset:57344
  ds_read_b64_tr_b16 a[106:107], v244 offset:61440
  v_mfma_f32_16x16x32_bf16 v[28:31], a[108:111], a[40:43], v[28:31]
  v_mfma_f32_16x16x32_bf16 v[44:47], a[108:111], a[44:47], v[44:47]
  s_waitcnt vmcnt(12) lgkmcnt(10)
  s_barrier
  v_mfma_f32_16x16x32_bf16 v[72:75], a[80:83], a[48:51], v[72:75]
  ds_read_b64_tr_b16 a[108:109], v245 offset:57344
  s_add_u32 m0, s38, 32768
  v_mfma_f32_16x16x32_bf16 v[88:91], a[80:83], a[52:55], v[88:91]
  ds_read_b64_tr_b16 a[110:111], v245 offset:61440
  ds_read_b64_tr_b16 a[80:81], v242 offset:2048
  v_mfma_f32_16x16x32_bf16 v[76:79], a[84:87], a[48:51], v[76:79]
  buffer_load_dwordx4 v225, s[8:11], s17 offen lds
  v_mfma_f32_16x16x32_bf16 v[92:95], a[84:87], a[52:55], v[92:95]
  ds_read_b64_tr_b16 a[82:83], v242 offset:6144
  ds_read_b64_tr_b16 a[84:85], v243 offset:2048
  v_mfma_f32_16x16x32_bf16 v[80:83], a[88:91], a[48:51], v[80:83]
  buffer_load_dwordx4 v226, s[8:11], s17 offen offset:1024 lds
  v_mfma_f32_16x16x32_bf16 v[96:99], a[88:91], a[52:55], v[96:99]
  ds_read_b64_tr_b16 a[86:87], v243 offset:6144
  ds_read_b64_tr_b16 a[88:89], v244 offset:2048
  v_mfma_f32_16x16x32_bf16 v[84:87], a[92:95], a[48:51], v[84:87]
  buffer_load_dwordx4 v227, s[8:11], s17 offen offset:2048 lds
  v_mfma_f32_16x16x32_bf16 v[100:103], a[92:95], a[52:55], v[100:103]
  ds_read_b64_tr_b16 a[90:91], v244 offset:6144
  ds_read_b64_tr_b16 a[92:93], v245 offset:2048
  v_mfma_f32_16x16x32_bf16 v[72:75], a[112:115], a[56:59], v[72:75]
  buffer_load_dwordx4 v228, s[8:11], s17 offen offset:3072 lds
  v_mfma_f32_16x16x32_bf16 v[88:91], a[112:115], a[60:63], v[88:91]
  ds_read_b64_tr_b16 a[94:95], v245 offset:6144
  ds_read_b64_tr_b16 a[112:113], v242 offset:10240
  v_mfma_f32_16x16x32_bf16 v[76:79], a[116:119], a[56:59], v[76:79]
  ds_read_b64_tr_b16 a[114:115], v242 offset:14336
  s_add_u32 s17, s17, 458752
  v_mfma_f32_16x16x32_bf16 v[92:95], a[116:119], a[60:63], v[92:95]
  ds_read_b64_tr_b16 a[116:117], v243 offset:10240
  ds_read_b64_tr_b16 a[118:119], v243 offset:14336
  v_mfma_f32_16x16x32_bf16 v[80:83], a[120:123], a[56:59], v[80:83]
  s_cmp_eq_u32 s17, s93
  v_mfma_f32_16x16x32_bf16 v[96:99], a[120:123], a[60:63], v[96:99]
  ds_read_b64_tr_b16 a[120:121], v244 offset:10240
  ds_read_b64_tr_b16 a[122:123], v244 offset:14336
  v_mfma_f32_16x16x32_bf16 v[84:87], a[124:127], a[56:59], v[84:87]
  s_cselect_b32 s17, s95, s17
  v_mfma_f32_16x16x32_bf16 v[100:103], a[124:127], a[60:63], v[100:103]
  ds_read_b64_tr_b16 a[124:125], v245 offset:10240
  ds_read_b64_tr_b16 a[126:127], v245 offset:14336
  v_mfma_f32_16x16x32_bf16 v[16:19], a[64:67], a[48:51], v[16:19]
  buffer_load_dwordx4 a[32:35], v240, s[4:7], s16 offen offset:0 sc1
  v_mfma_f32_16x16x32_bf16 v[32:35], a[64:67], a[52:55], v[32:35]
  ds_read_b64_tr_b16 a[64:65], v242 offset:0
  ds_read_b64_tr_b16 a[66:67], v242 offset:4096
  v_mfma_f32_16x16x32_bf16 v[20:23], a[68:71], a[48:51], v[20:23]
  buffer_load_dwordx4 a[36:39], v240, s[4:7], s16 offen offset:1024 sc1
  v_mfma_f32_16x16x32_bf16 v[36:39], a[68:71], a[52:55], v[36:39]
  ds_read_b64_tr_b16 a[68:69], v243 offset:0
  ds_read_b64_tr_b16 a[70:71], v243 offset:4096
  s_waitcnt lgkmcnt(10)
  v_mfma_f32_16x16x32_bf16 v[24:27], a[72:75], a[48:51], v[24:27]
  buffer_load_dwordx4 a[40:43], v241, s[4:7], s16 offen offset:0 sc1
  v_mfma_f32_16x16x32_bf16 v[40:43], a[72:75], a[52:55], v[40:43]
  ds_read_b64_tr_b16 a[72:73], v244 offset:0
  ds_read_b64_tr_b16 a[74:75], v244 offset:4096
  v_mfma_f32_16x16x32_bf16 v[28:31], a[76:79], a[48:51], v[28:31]
  buffer_load_dwordx4 a[44:47], v241, s[4:7], s16 offen offset:1024 sc1
  v_mfma_f32_16x16x32_bf16 v[44:47], a[76:79], a[52:55], v[44:47]
  ds_read_b64_tr_b16 a[76:77], v245 offset:0
  ds_read_b64_tr_b16 a[78:79], v245 offset:4096
  v_mfma_f32_16x16x32_bf16 v[16:19], a[96:99], a[56:59], v[16:19]
  s_add_u32 s41, s41, 262144
  v_mfma_f32_16x16x32_bf16 v[32:35], a[96:99], a[60:63], v[32:35]
  ds_read_b64_tr_b16 a[96:97], v242 offset:8192
  ds_read_b64_tr_b16 a[98:99], v242 offset:12288
  v_mfma_f32_16x16x32_bf16 v[20:23], a[100:103], a[56:59], v[20:23]
  s_bitset0_b32 s41, 21
  v_mfma_f32_16x16x32_bf16 v[36:39], a[100:103], a[60:63], v[36:39]
  ds_read_b64_tr_b16 a[100:101], v243 offset:8192
  ds_read_b64_tr_b16 a[102:103], v243 offset:12288
  v_mfma_f32_16x16x32_bf16 v[24:27], a[104:107], a[56:59], v[24:27]
  s_add_u32 s16, s40, s41
  v_mfma_f32_16x16x32_bf16 v[40:43], a[104:107], a[60:63], v[40:43]
  ds_read_b64_tr_b16 a[104:105], v244 offset:8192
  ds_read_b64_tr_b16 a[106:107], v244 offset:12288
  v_mfma_f32_16x16x32_bf16 v[28:31], a[108:111], a[56:59], v[28:31]
  v_mfma_f32_16x16x32_bf16 v[44:47], a[108:111], a[60:63], v[44:47]
  s_waitcnt vmcnt(12) lgkmcnt(10)
  s_barrier
  v_mfma_f32_16x16x32_bf16 v[72:75], a[80:83], a[0:3], v[72:75]
  ds_read_b64_tr_b16 a[108:109], v245 offset:8192
  s_add_u32 m0, s38, 49152
  v_mfma_f32_16x16x32_bf16 v[88:91], a[80:83], a[4:7], v[88:91]
  ds_read_b64_tr_b16 a[110:111], v245 offset:12288
  ds_read_b64_tr_b16 a[80:81], v242 offset:18432
  v_mfma_f32_16x16x32_bf16 v[76:79], a[84:87], a[0:3], v[76:79]
  buffer_load_dwordx4 v225, s[8:11], s17 offen lds
  v_mfma_f32_16x16x32_bf16 v[92:95], a[84:87], a[4:7], v[92:95]
  ds_read_b64_tr_b16 a[82:83], v242 offset:22528
  ds_read_b64_tr_b16 a[84:85], v243 offset:18432
  v_mfma_f32_16x16x32_bf16 v[80:83], a[88:91], a[0:3], v[80:83]
  buffer_load_dwordx4 v226, s[8:11], s17 offen offset:1024 lds
  v_mfma_f32_16x16x32_bf16 v[96:99], a[88:91], a[4:7], v[96:99]
  ds_read_b64_tr_b16 a[86:87], v243 offset:22528
  ds_read_b64_tr_b16 a[88:89], v244 offset:18432
  v_mfma_f32_16x16x32_bf16 v[84:87], a[92:95], a[0:3], v[84:87]
  buffer_load_dwordx4 v227, s[8:11], s17 offen offset:2048 lds
  v_mfma_f32_16x16x32_bf16 v[100:103], a[92:95], a[4:7], v[100:103]
  ds_read_b64_tr_b16 a[90:91], v244 offset:22528
  ds_read_b64_tr_b16 a[92:93], v245 offset:18432
  v_mfma_f32_16x16x32_bf16 v[72:75], a[112:115], a[8:11], v[72:75]
  buffer_load_dwordx4 v228, s[8:11], s17 offen offset:3072 lds
  v_mfma_f32_16x16x32_bf16 v[88:91], a[112:115], a[12:15], v[88:91]
  ds_read_b64_tr_b16 a[94:95], v245 offset:22528
  ds_read_b64_tr_b16 a[112:113], v242 offset:26624
  v_mfma_f32_16x16x32_bf16 v[76:79], a[116:119], a[8:11], v[76:79]
  ds_read_b64_tr_b16 a[114:115], v242 offset:30720
  s_add_u32 s17, s17, 458752
  v_mfma_f32_16x16x32_bf16 v[92:95], a[116:119], a[12:15], v[92:95]
  ds_read_b64_tr_b16 a[116:117], v243 offset:26624
  ds_read_b64_tr_b16 a[118:119], v243 offset:30720
  v_mfma_f32_16x16x32_bf16 v[80:83], a[120:123], a[8:11], v[80:83]
  s_cmp_eq_u32 s17, s93
  v_mfma_f32_16x16x32_bf16 v[96:99], a[120:123], a[12:15], v[96:99]
  ds_read_b64_tr_b16 a[120:121], v244 offset:26624
  ds_read_b64_tr_b16 a[122:123], v244 offset:30720
  v_mfma_f32_16x16x32_bf16 v[84:87], a[124:127], a[8:11], v[84:87]
  s_cselect_b32 s17, s95, s17
  v_mfma_f32_16x16x32_bf16 v[100:103], a[124:127], a[12:15], v[100:103]
  ds_read_b64_tr_b16 a[124:125], v245 offset:26624
  ds_read_b64_tr_b16 a[126:127], v245 offset:30720
  v_mfma_f32_16x16x32_bf16 v[16:19], a[64:67], a[0:3], v[16:19]
  buffer_load_dwordx4 a[48:51], v240, s[4:7], s16 offen offset:0 sc1
  v_mfma_f32_16x16x32_bf16 v[32:35], a[64:67], a[4:7], v[32:35]
  ds_read_b64_tr_b16 a[64:65], v242 offset:16384
  ds_read_b64_tr_b16 a[66:67], v242 offset:20480
  v_mfma_f32_16x16x32_bf16 v[20:23], a[68:71], a[0:3], v[20:23]
  buffer_load_dwordx4 a[52:55], v240, s[4:7], s16 offen offset:1024 sc1
  v_mfma_f32_16x16x32_bf16 v[36:39], a[68:71], a[4:7], v[36:39]
  ds_read_b64_tr_b16 a[68:69], v243 offset:16384
  ds_read_b64_tr_b16 a[70:71], v243 offset:20480
  s_waitcnt lgkmcnt(10)
  v_mfma_f32_16x16x32_bf16 v[24:27], a[72:75], a[0:3], v[24:27]
  buffer_load_dwordx4 a[56:59], v241, s[4:7], s16 offen offset:0 sc1
  v_mfma_f32_16x16x32_bf16 v[40:43], a[72:75], a[4:7], v[40:43]
  ds_read_b64_tr_b16 a[72:73], v244 offset:16384
  ds_read_b64_tr_b16 a[74:75], v244 offset:20480
  v_mfma_f32_16x16x32_bf16 v[28:31], a[76:79], a[0:3], v[28:31]
  buffer_load_dwordx4 a[60:63], v241, s[4:7], s16 offen offset:1024 sc1
  v_mfma_f32_16x16x32_bf16 v[44:47], a[76:79], a[4:7], v[44:47]
  ds_read_b64_tr_b16 a[76:77], v245 offset:16384
  ds_read_b64_tr_b16 a[78:79], v245 offset:20480
  v_mfma_f32_16x16x32_bf16 v[16:19], a[96:99], a[8:11], v[16:19]
  s_add_u32 s41, s41, 262144
  v_mfma_f32_16x16x32_bf16 v[32:35], a[96:99], a[12:15], v[32:35]
  ds_read_b64_tr_b16 a[96:97], v242 offset:24576
  ds_read_b64_tr_b16 a[98:99], v242 offset:28672
  v_mfma_f32_16x16x32_bf16 v[20:23], a[100:103], a[8:11], v[20:23]
  s_bitset0_b32 s41, 21
  v_mfma_f32_16x16x32_bf16 v[36:39], a[100:103], a[12:15], v[36:39]
  ds_read_b64_tr_b16 a[100:101], v243 offset:24576
  ds_read_b64_tr_b16 a[102:103], v243 offset:28672
  v_mfma_f32_16x16x32_bf16 v[24:27], a[104:107], a[8:11], v[24:27]
  s_add_u32 s16, s40, s41
  v_mfma_f32_16x16x32_bf16 v[40:43], a[104:107], a[12:15], v[40:43]
  ds_read_b64_tr_b16 a[104:105], v244 offset:24576
  ds_read_b64_tr_b16 a[106:107], v244 offset:28672
  v_mfma_f32_16x16x32_bf16 v[28:31], a[108:111], a[8:11], v[28:31]
  v_mfma_f32_16x16x32_bf16 v[44:47], a[108:111], a[12:15], v[44:47]
  s_waitcnt vmcnt(12) lgkmcnt(10)
  s_barrier
  v_mfma_f32_16x16x32_bf16 v[72:75], a[80:83], a[16:19], v[72:75]
  ds_read_b64_tr_b16 a[108:109], v245 offset:24576
  s_add_u32 m0, s38, 0
  v_mfma_f32_16x16x32_bf16 v[88:91], a[80:83], a[20:23], v[88:91]
  ds_read_b64_tr_b16 a[110:111], v245 offset:28672
  ds_read_b64_tr_b16 a[80:81], v242 offset:34816
  v_mfma_f32_16x16x32_bf16 v[76:79], a[84:87], a[16:19], v[76:79]
  buffer_load_dwordx4 v225, s[8:11], s17 offen lds
  v_mfma_f32_16x16x32_bf16 v[92:95], a[84:87], a[20:23], v[92:95]
  ds_read_b64_tr_b16 a[82:83], v242 offset:38912
  ds_read_b64_tr_b16 a[84:85], v243 offset:34816
  v_mfma_f32_16x16x32_bf16 v[80:83], a[88:91], a[16:19], v[80:83]
  buffer_load_dwordx4 v226, s[8:11], s17 offen offset:1024 lds
  v_mfma_f32_16x16x32_bf16 v[96:99], a[88:91], a[20:23], v[96:99]
  ds_read_b64_tr_b16 a[86:87], v243 offset:38912
  ds_read_b64_tr_b16 a[88:89], v244 offset:34816
  v_mfma_f32_16x16x32_bf16 v[84:87], a[92:95], a[16:19], v[84:87]
  buffer_load_dwordx4 v227, s[8:11], s17 offen offset:2048 lds
  v_mfma_f32_16x16x32_bf16 v[100:103], a[92:95], a[20:23], v[100:103]
  ds_read_b64_tr_b16 a[90:91], v244 offset:38912
  ds_read_b64_tr_b16 a[92:93], v245 offset:34816
  v_mfma_f32_16x16x32_bf16 v[72:75], a[112:115], a[24:27], v[72:75]
  buffer_load_dwordx4 v228, s[8:11], s17 offen offset:3072 lds
  v_mfma_f32_16x16x32_bf16 v[88:91], a[112:115], a[28:31], v[88:91]
  ds_read_b64_tr_b16 a[94:95], v245 offset:38912
  ds_read_b64_tr_b16 a[112:113], v242 offset:43008
  v_mfma_f32_16x16x32_bf16 v[76:79], a[116:119], a[24:27], v[76:79]
  ds_read_b64_tr_b16 a[114:115], v242 offset:47104
  s_add_u32 s17, s17, 458752
  v_mfma_f32_16x16x32_bf16 v[92:95], a[116:119], a[28:31], v[92:95]
  ds_read_b64_tr_b16 a[116:117], v243 offset:43008
  ds_read_b64_tr_b16 a[118:119], v243 offset:47104
  v_mfma_f32_16x16x32_bf16 v[80:83], a[120:123], a[24:27], v[80:83]
  s_cmp_eq_u32 s17, s93
  v_mfma_f32_16x16x32_bf16 v[96:99], a[120:123], a[28:31], v[96:99]
  ds_read_b64_tr_b16 a[120:121], v244 offset:43008
  ds_read_b64_tr_b16 a[122:123], v244 offset:47104
  v_mfma_f32_16x16x32_bf16 v[84:87], a[124:127], a[24:27], v[84:87]
  s_cselect_b32 s17, s95, s17
  v_mfma_f32_16x16x32_bf16 v[100:103], a[124:127], a[28:31], v[100:103]
  ds_read_b64_tr_b16 a[124:125], v245 offset:43008
  ds_read_b64_tr_b16 a[126:127], v245 offset:47104
  v_mfma_f32_16x16x32_bf16 v[16:19], a[64:67], a[16:19], v[16:19]
  buffer_load_dwordx4 a[0:3], v240, s[4:7], s16 offen offset:0 sc1
  v_mfma_f32_16x16x32_bf16 v[32:35], a[64:67], a[20:23], v[32:35]
  ds_read_b64_tr_b16 a[64:65], v242 offset:32768
  ds_read_b64_tr_b16 a[66:67], v242 offset:36864
  v_mfma_f32_16x16x32_bf16 v[20:23], a[68:71], a[16:19], v[20:23]
  buffer_load_dwordx4 a[4:7], v240, s[4:7], s16 offen offset:1024 sc1
  v_mfma_f32_16x16x32_bf16 v[36:39], a[68:71], a[20:23], v[36:39]
  ds_read_b64_tr_b16 a[68:69], v243 offset:32768
  ds_read_b64_tr_b16 a[70:71], v243 offset:36864
  s_waitcnt lgkmcnt(10)
  v_mfma_f32_16x16x32_bf16 v[24:27], a[72:75], a[16:19], v[24:27]
  buffer_load_dwordx4 a[8:11], v241, s[4:7], s16 offen offset:0 sc1
  v_mfma_f32_16x16x32_bf16 v[40:43], a[72:75], a[20:23], v[40:43]
  ds_read_b64_tr_b16 a[72:73], v244 offset:32768
  ds_read_b64_tr_b16 a[74:75], v244 offset:36864
  v_mfma_f32_16x16x32_bf16 v[28:31], a[76:79], a[16:19], v[28:31]
  buffer_load_dwordx4 a[12:15], v241, s[4:7], s16 offen offset:1024 sc1
  v_mfma_f32_16x16x32_bf16 v[44:47], a[76:79], a[20:23], v[44:47]
  ds_read_b64_tr_b16 a[76:77], v245 offset:32768
  ds_read_b64_tr_b16 a[78:79], v245 offset:36864
  v_mfma_f32_16x16x32_bf16 v[16:19], a[96:99], a[24:27], v[16:19]
  s_add_u32 s41, s41, 262144
  v_mfma_f32_16x16x32_bf16 v[32:35], a[96:99], a[28:31], v[32:35]
  ds_read_b64_tr_b16 a[96:97], v242 offset:40960
  ds_read_b64_tr_b16 a[98:99], v242 offset:45056
  v_mfma_f32_16x16x32_bf16 v[20:23], a[100:103], a[24:27], v[20:23]
  s_bitset0_b32 s41, 21
  v_mfma_f32_16x16x32_bf16 v[36:39], a[100:103], a[28:31], v[36:39]
  ds_read_b64_tr_b16 a[100:101], v243 offset:40960
  ds_read_b64_tr_b16 a[102:103], v243 offset:45056
  v_mfma_f32_16x16x32_bf16 v[24:27], a[104:107], a[24:27], v[24:27]
  s_add_u32 s16, s40, s41
  v_mfma_f32_16x16x32_bf16 v[40:43], a[104:107], a[28:31], v[40:43]
  ds_read_b64_tr_b16 a[104:105], v244 offset:40960
  ds_read_b64_tr_b16 a[106:107], v244 offset:45056
  v_mfma_f32_16x16x32_bf16 v[28:31], a[108:111], a[24:27], v[28:31]
  v_mfma_f32_16x16x32_bf16 v[44:47], a[108:111], a[28:31], v[44:47]
  s_waitcnt vmcnt(12) lgkmcnt(10)
  s_barrier
  v_mfma_f32_16x16x32_bf16 v[72:75], a[80:83], a[32:35], v[72:75]
  ds_read_b64_tr_b16 a[108:109], v245 offset:40960
  s_add_u32 m0, s38, 16384
  v_mfma_f32_16x16x32_bf16 v[88:91], a[80:83], a[36:39], v[88:91]
  ds_read_b64_tr_b16 a[110:111], v245 offset:45056
  ds_read_b64_tr_b16 a[80:81], v242 offset:51200
  v_mfma_f32_16x16x32_bf16 v[76:79], a[84:87], a[32:35], v[76:79]
  buffer_load_dwordx4 v225, s[8:11], s17 offen lds
  v_mfma_f32_16x16x32_bf16 v[92:95], a[84:87], a[36:39], v[92:95]
  ds_read_b64_tr_b16 a[82:83], v242 offset:55296
  ds_read_b64_tr_b16 a[84:85], v243 offset:51200
  v_mfma_f32_16x16x32_bf16 v[80:83], a[88:91], a[32:35], v[80:83]
  buffer_load_dwordx4 v226, s[8:11], s17 offen offset:1024 lds
  v_mfma_f32_16x16x32_bf16 v[96:99], a[88:91], a[36:39], v[96:99]
  ds_read_b64_tr_b16 a[86:87], v243 offset:55296
  ds_read_b64_tr_b16 a[88:89], v244 offset:51200
  v_mfma_f32_16x16x32_bf16 v[84:87], a[92:95], a[32:35], v[84:87]
  buffer_load_dwordx4 v227, s[8:11], s17 offen offset:2048 lds
  v_mfma_f32_16x16x32_bf16 v[100:103], a[92:95], a[36:39], v[100:103]
  ds_read_b64_tr_b16 a[90:91], v244 offset:55296
  ds_read_b64_tr_b16 a[92:93], v245 offset:51200
  v_mfma_f32_16x16x32_bf16 v[72:75], a[112:115], a[40:43], v[72:75]
  buffer_load_dwordx4 v228, s[8:11], s17 offen offset:3072 lds
  v_mfma_f32_16x16x32_bf16 v[88:91], a[112:115], a[44:47], v[88:91]
  ds_read_b64_tr_b16 a[94:95], v245 offset:55296
  ds_read_b64_tr_b16 a[112:113], v242 offset:59392
  v_mfma_f32_16x16x32_bf16 v[76:79], a[116:119], a[40:43], v[76:79]
  ds_read_b64_tr_b16 a[114:115], v242 offset:63488
  s_add_u32 s17, s17, 458752
  v_mfma_f32_16x16x32_bf16 v[92:95], a[116:119], a[44:47], v[92:95]
  ds_read_b64_tr_b16 a[116:117], v243 offset:59392
  ds_read_b64_tr_b16 a[118:119], v243 offset:63488
  v_mfma_f32_16x16x32_bf16 v[80:83], a[120:123], a[40:43], v[80:83]
  s_cmp_eq_u32 s17, s93
  v_mfma_f32_16x16x32_bf16 v[96:99], a[120:123], a[44:47], v[96:99]
  ds_read_b64_tr_b16 a[120:121], v244 offset:59392
  ds_read_b64_tr_b16 a[122:123], v244 offset:63488
  v_mfma_f32_16x16x32_bf16 v[84:87], a[124:127], a[40:43], v[84:87]
  s_cselect_b32 s17, s95, s17
  v_mfma_f32_16x16x32_bf16 v[100:103], a[124:127], a[44:47], v[100:103]
  ds_read_b64_tr_b16 a[124:125], v245 offset:59392
  ds_read_b64_tr_b16 a[126:127], v245 offset:63488
  v_mfma_f32_16x16x32_bf16 v[16:19], a[64:67], a[32:35], v[16:19]
  buffer_load_dwordx4 a[16:19], v240, s[4:7], s16 offen offset:0 sc1
  v_mfma_f32_16x16x32_bf16 v[32:35], a[64:67], a[36:39], v[32:35]
  ds_read_b64_tr_b16 a[64:65], v242 offset:49152
  ds_read_b64_tr_b16 a[66:67], v242 offset:53248
  v_mfma_f32_16x16x32_bf16 v[20:23], a[68:71], a[32:35], v[20:23]
  buffer_load_dwordx4 a[20:23], v240, s[4:7], s16 offen offset:1024 sc1
  v_mfma_f32_16x16x32_bf16 v[36:39], a[68:71], a[36:39], v[36:39]
  ds_read_b64_tr_b16 a[68:69], v243 offset:49152
  ds_read_b64_tr_b16 a[70:71], v243 offset:53248
  s_waitcnt lgkmcnt(10)
  v_mfma_f32_16x16x32_bf16 v[24:27], a[72:75], a[32:35], v[24:27]
  buffer_load_dwordx4 a[24:27], v241, s[4:7], s16 offen offset:0 sc1
  v_mfma_f32_16x16x32_bf16 v[40:43], a[72:75], a[36:39], v[40:43]
  ds_read_b64_tr_b16 a[72:73], v244 offset:49152
  ds_read_b64_tr_b16 a[74:75], v244 offset:53248
  v_mfma_f32_16x16x32_bf16 v[28:31], a[76:79], a[32:35], v[28:31]
  buffer_load_dwordx4 a[28:31], v241, s[4:7], s16 offen offset:1024 sc1
  v_mfma_f32_16x16x32_bf16 v[44:47], a[76:79], a[36:39], v[44:47]
  ds_read_b64_tr_b16 a[76:77], v245 offset:49152
  ds_read_b64_tr_b16 a[78:79], v245 offset:53248
  v_mfma_f32_16x16x32_bf16 v[16:19], a[96:99], a[40:43], v[16:19]
  s_add_u32 s41, s41, 262144
  v_mfma_f32_16x16x32_bf16 v[32:35], a[96:99], a[44:47], v[32:35]
  ds_read_b64_tr_b16 a[96:97], v242 offset:57344
  ds_read_b64_tr_b16 a[98:99], v242 offset:61440
  v_mfma_f32_16x16x32_bf16 v[20:23], a[100:103], a[40:43], v[20:23]
  s_bitset0_b32 s41, 21
  v_mfma_f32_16x16x32_bf16 v[36:39], a[100:103], a[44:47], v[36:39]
  ds_read_b64_tr_b16 a[100:101], v243 offset:57344
  ds_read_b64_tr_b16 a[102:103], v243 offset:61440
  v_mfma_f32_16x16x32_bf16 v[24:27], a[104:107], a[40:43], v[24:27]
  s_add_u32 s16, s40, s41
  v_mfma_f32_16x16x32_bf16 v[40:43], a[104:107], a[44:47], v[40:43]
  ds_read_b64_tr_b16 a[104:105], v244 offset:57344
  ds_read_b64_tr_b16 a[106:107], v244 offset:61440
  v_mfma_f32_16x16x32_bf16 v[28:31], a[108:111], a[40:43], v[28:31]
  v_mfma_f32_16x16x32_bf16 v[44:47], a[108:111], a[44:47], v[44:47]
  s_waitcnt vmcnt(12) lgkmcnt(10)
  s_barrier
  v_mfma_f32_16x16x32_bf16 v[72:75], a[80:83], a[48:51], v[72:75]
  ds_read_b64_tr_b16 a[108:109], v245 offset:57344
  s_add_u32 m0, s38, 32768
  v_mfma_f32_16x16x32_bf16 v[88:91], a[80:83], a[52:55], v[88:91]
  ds_read_b64_tr_b16 a[110:111], v245 offset:61440
  ds_read_b64_tr_b16 a[80:81], v242 offset:2048
  v_mfma_f32_16x16x32_bf16 v[76:79], a[84:87], a[48:51], v[76:79]
  buffer_load_dwordx4 v225, s[8:11], s17 offen lds
  v_mfma_f32_16x16x32_bf16 v[92:95], a[84:87], a[52:55], v[92:95]
  ds_read_b64_tr_b16 a[82:83], v242 offset:6144
  ds_read_b64_tr_b16 a[84:85], v243 offset:2048
  v_mfma_f32_16x16x32_bf16 v[80:83], a[88:91], a[48:51], v[80:83]
  buffer_load_dwordx4 v226, s[8:11], s17 offen offset:1024 lds
  v_mfma_f32_16x16x32_bf16 v[96:99], a[88:91], a[52:55], v[96:99]
  ds_read_b64_tr_b16 a[86:87], v243 offset:6144
  ds_read_b64_tr_b16 a[88:89], v244 offset:2048
  v_mfma_f32_16x16x32_bf16 v[84:87], a[92:95], a[48:51], v[84:87]
  buffer_load_dwordx4 v227, s[8:11], s17 offen offset:2048 lds
  v_mfma_f32_16x16x32_bf16 v[100:103], a[92:95], a[52:55], v[100:103]
  ds_read_b64_tr_b16 a[90:91], v244 offset:6144
  ds_read_b64_tr_b16 a[92:93], v245 offset:2048
  v_mfma_f32_16x16x32_bf16 v[72:75], a[112:115], a[56:59], v[72:75]
  buffer_load_dwordx4 v228, s[8:11], s17 offen offset:3072 lds
  v_mfma_f32_16x16x32_bf16 v[88:91], a[112:115], a[60:63], v[88:91]
  ds_read_b64_tr_b16 a[94:95], v245 offset:6144
  ds_read_b64_tr_b16 a[112:113], v242 offset:10240
  v_mfma_f32_16x16x32_bf16 v[76:79], a[116:119], a[56:59], v[76:79]
  ds_read_b64_tr_b16 a[114:115], v242 offset:14336
  s_add_u32 s17, s17, 458752
  v_mfma_f32_16x16x32_bf16 v[92:95], a[116:119], a[60:63], v[92:95]
  ds_read_b64_tr_b16 a[116:117], v243 offset:10240
  ds_read_b64_tr_b16 a[118:119], v243 offset:14336
  v_mfma_f32_16x16x32_bf16 v[80:83], a[120:123], a[56:59], v[80:83]
  s_cmp_eq_u32 s17, s93
  v_mfma_f32_16x16x32_bf16 v[96:99], a[120:123], a[60:63], v[96:99]
  ds_read_b64_tr_b16 a[120:121], v244 offset:10240
  ds_read_b64_tr_b16 a[122:123], v244 offset:14336
  v_mfma_f32_16x16x32_bf16 v[84:87], a[124:127], a[56:59], v[84:87]
  s_cselect_b32 s17, s95, s17
  v_mfma_f32_16x16x32_bf16 v[100:103], a[124:127], a[60:63], v[100:103]
  ds_read_b64_tr_b16 a[124:125], v245 offset:10240
  ds_read_b64_tr_b16 a[126:127], v245 offset:14336
  v_mfma_f32_16x16x32_bf16 v[16:19], a[64:67], a[48:51], v[16:19]
  buffer_load_dwordx4 a[32:35], v240, s[4:7], s16 offen offset:0 sc1
  v_mfma_f32_16x16x32_bf16 v[32:35], a[64:67], a[52:55], v[32:35]
  ds_read_b64_tr_b16 a[64:65], v242 offset:0
  ds_read_b64_tr_b16 a[66:67], v242 offset:4096
  v_mfma_f32_16x16x32_bf16 v[20:23], a[68:71], a[48:51], v[20:23]
  buffer_load_dwordx4 a[36:39], v240, s[4:7], s16 offen offset:1024 sc1
  v_mfma_f32_16x16x32_bf16 v[36:39], a[68:71], a[52:55], v[36:39]
  ds_read_b64_tr_b16 a[68:69], v243 offset:0
  ds_read_b64_tr_b16 a[70:71], v243 offset:4096
  s_waitcnt lgkmcnt(10)
  v_mfma_f32_16x16x32_bf16 v[24:27], a[72:75], a[48:51], v[24:27]
  buffer_load_dwordx4 a[40:43], v241, s[4:7], s16 offen offset:0 sc1
  v_mfma_f32_16x16x32_bf16 v[40:43], a[72:75], a[52:55], v[40:43]
  ds_read_b64_tr_b16 a[72:73], v244 offset:0
  ds_read_b64_tr_b16 a[74:75], v244 offset:4096
  v_mfma_f32_16x16x32_bf16 v[28:31], a[76:79], a[48:51], v[28:31]
  buffer_load_dwordx4 a[44:47], v241, s[4:7], s16 offen offset:1024 sc1
  v_mfma_f32_16x16x32_bf16 v[44:47], a[76:79], a[52:55], v[44:47]
  ds_read_b64_tr_b16 a[76:77], v245 offset:0
  ds_read_b64_tr_b16 a[78:79], v245 offset:4096
  v_mfma_f32_16x16x32_bf16 v[16:19], a[96:99], a[56:59], v[16:19]
  s_add_u32 s41, s41, 262144
  v_mfma_f32_16x16x32_bf16 v[32:35], a[96:99], a[60:63], v[32:35]
  ds_read_b64_tr_b16 a[96:97], v242 offset:8192
  ds_read_b64_tr_b16 a[98:99], v242 offset:12288
  v_mfma_f32_16x16x32_bf16 v[20:23], a[100:103], a[56:59], v[20:23]
  s_bitset0_b32 s41, 21
  v_mfma_f32_16x16x32_bf16 v[36:39], a[100:103], a[60:63], v[36:39]
  ds_read_b64_tr_b16 a[100:101], v243 offset:8192
  ds_read_b64_tr_b16 a[102:103], v243 offset:12288
  v_mfma_f32_16x16x32_bf16 v[24:27], a[104:107], a[56:59], v[24:27]
  s_add_u32 s16, s40, s41
  v_mfma_f32_16x16x32_bf16 v[40:43], a[104:107], a[60:63], v[40:43]
  ds_read_b64_tr_b16 a[104:105], v244 offset:8192
  ds_read_b64_tr_b16 a[106:107], v244 offset:12288
  v_mfma_f32_16x16x32_bf16 v[28:31], a[108:111], a[56:59], v[28:31]
  v_mfma_f32_16x16x32_bf16 v[44:47], a[108:111], a[60:63], v[44:47]
  s_waitcnt vmcnt(12) lgkmcnt(10)
  s_barrier
  v_mfma_f32_16x16x32_bf16 v[72:75], a[80:83], a[0:3], v[72:75]
  ds_read_b64_tr_b16 a[108:109], v245 offset:8192
  s_add_u32 m0, s38, 49152
  v_mfma_f32_16x16x32_bf16 v[88:91], a[80:83], a[4:7], v[88:91]
  ds_read_b64_tr_b16 a[110:111], v245 offset:12288
  ds_read_b64_tr_b16 a[80:81], v242 offset:18432
  v_mfma_f32_16x16x32_bf16 v[76:79], a[84:87], a[0:3], v[76:79]
  buffer_load_dwordx4 v225, s[8:11], s17 offen lds
  v_mfma_f32_16x16x32_bf16 v[92:95], a[84:87], a[4:7], v[92:95]
  ds_read_b64_tr_b16 a[82:83], v242 offset:22528
  ds_read_b64_tr_b16 a[84:85], v243 offset:18432
  v_mfma_f32_16x16x32_bf16 v[80:83], a[88:91], a[0:3], v[80:83]
  ds_read_b64_tr_b16 a[86:87], v243 offset:22528
  v_mfma_f32_16x16x32_bf16 v[96:99], a[88:91], a[4:7], v[96:99]
  buffer_load_dwordx4 v226, s[8:11], s17 offen offset:1024 lds
  v_mfma_f32_16x16x32_bf16 v[84:87], a[92:95], a[0:3], v[84:87]
  ds_read_b64_tr_b16 a[88:89], v244 offset:18432
  ds_read_b64_tr_b16 a[90:91], v244 offset:22528
  v_mfma_f32_16x16x32_bf16 v[100:103], a[92:95], a[4:7], v[100:103]
  ds_read_b64_tr_b16 a[92:93], v245 offset:18432
  ds_read_b64_tr_b16 a[94:95], v245 offset:22528
  v_mfma_f32_16x16x32_bf16 v[72:75], a[112:115], a[8:11], v[72:75]
  buffer_load_dwordx4 v227, s[8:11], s17 offen offset:2048 lds
  v_mfma_f32_16x16x32_bf16 v[88:91], a[112:115], a[12:15], v[88:91]
  ds_read_b64_tr_b16 a[112:113], v242 offset:26624
  ds_read_b64_tr_b16 a[114:115], v242 offset:30720
  v_mfma_f32_16x16x32_bf16 v[76:79], a[116:119], a[8:11], v[76:79]
  v_mfma_f32_16x16x32_bf16 v[92:95], a[116:119], a[12:15], v[92:95]
  buffer_load_dwordx4 v228, s[8:11], s17 offen offset:3072 lds
  v_mfma_f32_16x16x32_bf16 v[80:83], a[120:123], a[8:11], v[80:83]
  ds_read_b64_tr_b16 a[116:117], v243 offset:26624
  ds_read_b64_tr_b16 a[118:119], v243 offset:30720
  v_mfma_f32_16x16x32_bf16 v[96:99], a[120:123], a[12:15], v[96:99]
  ds_read_b64_tr_b16 a[120:121], v244 offset:26624
  ds_read_b64_tr_b16 a[122:123], v244 offset:30720
  v_mfma_f32_16x16x32_bf16 v[84:87], a[124:127], a[8:11], v[84:87]
  s_mov_b32 s17, s97
  v_mfma_f32_16x16x32_bf16 v[100:103], a[124:127], a[12:15], v[100:103]
  ds_read_b64_tr_b16 a[124:125], v245 offset:26624
  ds_read_b64_tr_b16 a[126:127], v245 offset:30720
  v_mfma_f32_16x16x32_bf16 v[16:19], a[64:67], a[0:3], v[16:19]
  buffer_load_dwordx4 a[48:51], v240, s[4:7], s16 offen offset:0 sc1
  v_mfma_f32_16x16x32_bf16 v[32:35], a[64:67], a[4:7], v[32:35]
  ds_read_b64_tr_b16 a[64:65], v242 offset:16384
  ds_read_b64_tr_b16 a[66:67], v242 offset:20480
  v_mfma_f32_16x16x32_bf16 v[20:23], a[68:71], a[0:3], v[20:23]
  v_mfma_f32_16x16x32_bf16 v[36:39], a[68:71], a[4:7], v[36:39]
  buffer_load_dwordx4 a[52:55], v240, s[4:7], s16 offen offset:1024 sc1
  s_waitcnt lgkmcnt(10)
  v_mfma_f32_16x16x32_bf16 v[24:27], a[72:75], a[0:3], v[24:27]
  ds_read_b64_tr_b16 a[68:69], v243 offset:16384
  ds_read_b64_tr_b16 a[70:71], v243 offset:20480
  v_mfma_f32_16x16x32_bf16 v[40:43], a[72:75], a[4:7], v[40:43]
  ds_read_b64_tr_b16 a[72:73], v244 offset:16384
  ds_read_b64_tr_b16 a[74:75], v244 offset:20480
  v_mfma_f32_16x16x32_bf16 v[28:31], a[76:79], a[0:3], v[28:31]
  buffer_load_dwordx4 a[56:59], v241, s[4:7], s16 offen offset:0 sc1
  v_mfma_f32_16x16x32_bf16 v[44:47], a[76:79], a[4:7], v[44:47]
  ds_read_b64_tr_b16 a[76:77], v245 offset:16384
  ds_read_b64_tr_b16 a[78:79], v245 offset:20480
  v_mfma_f32_16x16x32_bf16 v[16:19], a[96:99], a[8:11], v[16:19]
  v_mfma_f32_16x16x32_bf16 v[32:35], a[96:99], a[12:15], v[32:35]
  buffer_load_dwordx4 a[60:63], v241, s[4:7], s16 offen offset:1024 sc1
  v_mfma_f32_16x16x32_bf16 v[20:23], a[100:103], a[8:11], v[20:23]
  ds_read_b64_tr_b16 a[96:97], v242 offset:24576
  ds_read_b64_tr_b16 a[98:99], v242 offset:28672
  v_mfma_f32_16x16x32_bf16 v[36:39], a[100:103], a[12:15], v[36:39]
  ds_read_b64_tr_b16 a[100:101], v243 offset:24576
  ds_read_b64_tr_b16 a[102:103], v243 offset:28672
  v_mfma_f32_16x16x32_bf16 v[24:27], a[104:107], a[8:11], v[24:27]
  s_add_u32 s16, s40, 2097152
  v_mfma_f32_16x16x32_bf16 v[40:43], a[104:107], a[12:15], v[40:43]
  ds_read_b64_tr_b16 a[104:105], v244 offset:24576
  ds_read_b64_tr_b16 a[106:107], v244 offset:28672
  v_mfma_f32_16x16x32_bf16 v[28:31], a[108:111], a[8:11], v[28:31]
  v_mfma_f32_16x16x32_bf16 v[44:47], a[108:111], a[12:15], v[44:47]
  s_waitcnt vmcnt(12) lgkmcnt(10)
  s_barrier
  v_mfma_f32_16x16x32_bf16 v[72:75], a[80:83], a[16:19], v[72:75]
  ds_read_b64_tr_b16 a[108:109], v245 offset:24576
  s_add_u32 m0, s38, 0
  v_mfma_f32_16x16x32_bf16 v[88:91], a[80:83], a[20:23], v[88:91]
  buffer_load_dwordx4 v227, s[8:11], s17 offen offset:2048 lds
  v_mfma_f32_16x16x32_bf16 v[76:79], a[84:87], a[16:19], v[76:79]
  ds_read_b64_tr_b16 a[110:111], v245 offset:28672
  ds_read_b64_tr_b16 a[80:81], v242 offset:34816
  v_mfma_f32_16x16x32_bf16 v[92:95], a[84:87], a[20:23], v[92:95]
  buffer_load_dwordx4 v228, s[8:11], s17 offen offset:3072 lds
  v_mfma_f32_16x16x32_bf16 v[80:83], a[88:91], a[16:19], v[80:83]
  ds_read_b64_tr_b16 a[82:83], v242 offset:38912
  ds_read_b64_tr_b16 a[84:85], v243 offset:34816
  v_mfma_f32_16x16x32_bf16 v[96:99], a[88:91], a[20:23], v[96:99]
  ds_read_b64_tr_b16 a[86:87], v243 offset:38912
  s_add_u32 s17, s17, 917504
  v_mfma_f32_16x16x32_bf16 v[84:87], a[92:95], a[16:19], v[84:87]
  ds_read_b64_tr_b16 a[88:89], v244 offset:34816
  s_add_u32 m0, s38, -2048
  v_mfma_f32_16x16x32_bf16 v[100:103], a[92:95], a[20:23], v[100:103]
  ds_read_b64_tr_b16 a[90:91], v244 offset:38912
  ds_read_b64_tr_b16 a[92:93], v245 offset:34816
  v_mfma_f32_16x16x32_bf16 v[72:75], a[112:115], a[24:27], v[72:75]
  buffer_load_dwordx4 v227, s[8:11], s17 offen offset:2048 lds
  v_mfma_f32_16x16x32_bf16 v[88:91], a[112:115], a[28:31], v[88:91]
  ds_read_b64_tr_b16 a[94:95], v245 offset:38912
  ds_read_b64_tr_b16 a[112:113], v242 offset:43008
  v_mfma_f32_16x16x32_bf16 v[76:79], a[116:119], a[24:27], v[76:79]
  buffer_load_dwordx4 v228, s[8:11], s17 offen offset:3072 lds
  v_mfma_f32_16x16x32_bf16 v[92:95], a[116:119], a[28:31], v[92:95]
  ds_read_b64_tr_b16 a[114:115], v242 offset:47104
  ds_read_b64_tr_b16 a[116:117], v243 offset:43008
  v_mfma_f32_16x16x32_bf16 v[80:83], a[120:123], a[24:27], v[80:83]
  ds_read_b64_tr_b16 a[118:119], v243 offset:47104
  s_add_u32 s17, s17, 917504
  v_mfma_f32_16x16x32_bf16 v[96:99], a[120:123], a[28:31], v[96:99]
  buffer_load_dwordx4 v[128:131], v240, s[4:7], s16 offen offset:0 sc1
  v_mfma_f32_16x16x32_bf16 v[84:87], a[124:127], a[24:27], v[84:87]
  ds_read_b64_tr_b16 a[120:121], v244 offset:43008
  ds_read_b64_tr_b16 a[122:123], v244 offset:47104
  v_mfma_f32_16x16x32_bf16 v[100:103], a[124:127], a[28:31], v[100:103]
  buffer_load_dwordx4 v[132:135], v240, s[4:7], s16 offen offset:1024 sc1
  v_mfma_f32_16x16x32_bf16 v[16:19], a[64:67], a[16:19], v[16:19]
  ds_read_b64_tr_b16 a[124:125], v245 offset:43008
  ds_read_b64_tr_b16 a[126:127], v245 offset:47104
  v_mfma_f32_16x16x32_bf16 v[32:35], a[64:67], a[20:23], v[32:35]
  buffer_load_dwordx4 v[136:139], v241, s[4:7], s16 offen offset:0 sc1
  v_mfma_f32_16x16x32_bf16 v[20:23], a[68:71], a[16:19], v[20:23]
  buffer_load_dwordx4 v[140:143], v241, s[4:7], s16 offen offset:1024 sc1
  v_mfma_f32_16x16x32_bf16 v[36:39], a[68:71], a[20:23], v[36:39]
  ds_read_b64_tr_b16 a[64:65], v242 offset:32768
  ds_read_b64_tr_b16 a[66:67], v242 offset:36864
  s_waitcnt lgkmcnt(10)
  v_mfma_f32_16x16x32_bf16 v[24:27], a[72:75], a[16:19], v[24:27]
  ds_read_b64_tr_b16 a[68:69], v243 offset:32768
  s_add_u32 s16, s16, 262144
  v_mfma_f32_16x16x32_bf16 v[40:43], a[72:75], a[20:23], v[40:43]
  ds_read_b64_tr_b16 a[70:71], v243 offset:36864
  ds_read_b64_tr_b16 a[72:73], v244 offset:32768
  v_mfma_f32_16x16x32_bf16 v[28:31], a[76:79], a[16:19], v[28:31]
  buffer_load_dwordx4 v[144:147], v240, s[4:7], s16 offen offset:0 sc1
  v_mfma_f32_16x16x32_bf16 v[44:47], a[76:79], a[20:23], v[44:47]
  ds_read_b64_tr_b16 a[74:75], v244 offset:36864
  ds_read_b64_tr_b16 a[76:77], v245 offset:32768
  v_mfma_f32_16x16x32_bf16 v[16:19], a[96:99], a[24:27], v[16:19]
  buffer_load_dwordx4 v[148:151], v240, s[4:7], s16 offen offset:1024 sc1
  v_mfma_f32_16x16x32_bf16 v[32:35], a[96:99], a[28:31], v[32:35]
  buffer_load_dwordx4 v[152:155], v241, s[4:7], s16 offen offset:0 sc1
  v_mfma_f32_16x16x32_bf16 v[20:23], a[100:103], a[24:27], v[20:23]
  ds_read_b64_tr_b16 a[78:79], v245 offset:36864
  ds_read_b64_tr_b16 a[96:97], v242 offset:40960
  v_mfma_f32_16x16x32_bf16 v[36:39], a[100:103], a[28:31], v[36:39]
  buffer_load_dwordx4 v[156:159], v241, s[4:7], s16 offen offset:1024 sc1
  v_mfma_f32_16x16x32_bf16 v[24:27], a[104:107], a[24:27], v[24:27]
  ds_read_b64_tr_b16 a[98:99], v242 offset:45056
  ds_read_b64_tr_b16 a[100:101], v243 offset:40960
  v_mfma_f32_16x16x32_bf16 v[40:43], a[104:107], a[28:31], v[40:43]
  ds_read_b64_tr_b16 a[102:103], v243 offset:45056
  s_add_u32 s16, s16, 262144
  v_mfma_f32_16x16x32_bf16 v[28:31], a[108:111], a[24:27], v[28:31]
  ds_read_b64_tr_b16 a[104:105], v244 offset:40960
  ds_read_b64_tr_b16 a[106:107], v244 offset:45056
  v_mfma_f32_16x16x32_bf16 v[44:47], a[108:111], a[28:31], v[44:47]
  s_waitcnt vmcnt(16) lgkmcnt(10)
  s_barrier
  v_mfma_f32_16x16x32_bf16 v[72:75], a[80:83], a[32:35], v[72:75]
  ds_read_b64_tr_b16 a[108:109], v245 offset:40960
  s_add_u32 m0, s38, 16384
  v_mfma_f32_16x16x32_bf16 v[88:91], a[80:83], a[36:39], v[88:91]
  buffer_load_dwordx4 v227, s[8:11], s17 offen offset:2048 lds
  v_mfma_f32_16x16x32_bf16 v[76:79], a[84:87], a[32:35], v[76:79]
  ds_read_b64_tr_b16 a[110:111], v245 offset:45056
  ds_read_b64_tr_b16 a[80:81], v242 offset:51200
  v_mfma_f32_16x16x32_bf16 v[92:95], a[84:87], a[36:39], v[92:95]
  buffer_load_dwordx4 v228, s[8:11], s17 offen offset:3072 lds
  v_mfma_f32_16x16x32_bf16 v[80:83], a[88:91], a[32:35], v[80:83]
  ds_read_b64_tr_b16 a[82:83], v242 offset:55296
  ds_read_b64_tr_b16 a[84:85], v243 offset:51200
  v_mfma_f32_16x16x32_bf16 v[96:99], a[88:91], a[36:39], v[96:99]
  ds_read_b64_tr_b16 a[86:87], v243 offset:55296
  s_add_u32 s17, s17, 917504
  v_mfma_f32_16x16x32_bf16 v[84:87], a[92:95], a[32:35], v[84:87]
  ds_read_b64_tr_b16 a[88:89], v244 offset:51200
  s_add_u32 m0, s38, 14336
  v_mfma_f32_16x16x32_bf16 v[100:103], a[92:95], a[36:39], v[100:103]
  ds_read_b64_tr_b16 a[90:91], v244 offset:55296
  ds_read_b64_tr_b16 a[92:93], v245 offset:51200
  v_mfma_f32_16x16x32_bf16 v[72:75], a[112:115], a[40:43], v[72:75]
  buffer_load_dwordx4 v227, s[8:11], s17 offen offset:2048 lds
  v_mfma_f32_16x16x32_bf16 v[88:91], a[112:115], a[44:47], v[88:91]
  ds_read_b64_tr_b16 a[94:95], v245 offset:55296
  ds_read_b64_tr_b16 a[112:113], v242 offset:59392
  v_mfma_f32_16x16x32_bf16 v[76:79], a[116:119], a[40:43], v[76:79]
  buffer_load_dwordx4 v228, s[8:11], s17 offen offset:3072 lds
  v_mfma_f32_16x16x32_bf16 v[92:95], a[116:119], a[44:47], v[92:95]
  ds_read_b64_tr_b16 a[114:115], v242 offset:63488
  ds_read_b64_tr_b16 a[116:117], v243 offset:59392
  v_mfma_f32_16x16x32_bf16 v[80:83], a[120:123], a[40:43], v[80:83]
  ds_read_b64_tr_b16 a[118:119], v243 offset:63488
  s_mov_b32 s17, s97
  v_mfma_f32_16x16x32_bf16 v[96:99], a[120:123], a[44:47], v[96:99]
  buffer_load_dwordx4 v[160:163], v240, s[4:7], s16 offen offset:0 sc1
  v_mfma_f32_16x16x32_bf16 v[84:87], a[124:127], a[40:43], v[84:87]
  ds_read_b64_tr_b16 a[120:121], v244 offset:59392
  ds_read_b64_tr_b16 a[122:123], v244 offset:63488
  v_mfma_f32_16x16x32_bf16 v[100:103], a[124:127], a[44:47], v[100:103]
  buffer_load_dwordx4 v[164:167], v240, s[4:7], s16 offen offset:1024 sc1
  v_mfma_f32_16x16x32_bf16 v[16:19], a[64:67], a[32:35], v[16:19]
  ds_read_b64_tr_b16 a[124:125], v245 offset:59392
  ds_read_b64_tr_b16 a[126:127], v245 offset:63488
  v_mfma_f32_16x16x32_bf16 v[32:35], a[64:67], a[36:39], v[32:35]
  buffer_load_dwordx4 v[168:171], v241, s[4:7], s16 offen offset:0 sc1
  v_mfma_f32_16x16x32_bf16 v[20:23], a[68:71], a[32:35], v[20:23]
  buffer_load_dwordx4 v[172:175], v241, s[4:7], s16 offen offset:1024 sc1
  v_mfma_f32_16x16x32_bf16 v[36:39], a[68:71], a[36:39], v[36:39]
  ds_read_b64_tr_b16 a[64:65], v242 offset:49152
  ds_read_b64_tr_b16 a[66:67], v242 offset:53248
  s_waitcnt lgkmcnt(10)
  v_mfma_f32_16x16x32_bf16 v[24:27], a[72:75], a[32:35], v[24:27]
  ds_read_b64_tr_b16 a[68:69], v243 offset:49152
  s_add_u32 s16, s16, 262144
  v_mfma_f32_16x16x32_bf16 v[40:43], a[72:75], a[36:39], v[40:43]
  ds_read_b64_tr_b16 a[70:71], v243 offset:53248
  ds_read_b64_tr_b16 a[72:73], v244 offset:49152
  v_mfma_f32_16x16x32_bf16 v[28:31], a[76:79], a[32:35], v[28:31]
  buffer_load_dwordx4 v[176:179], v240, s[4:7], s16 offen offset:0 sc1
  v_mfma_f32_16x16x32_bf16 v[44:47], a[76:79], a[36:39], v[44:47]
  ds_read_b64_tr_b16 a[74:75], v244 offset:53248
  ds_read_b64_tr_b16 a[76:77], v245 offset:49152
  v_mfma_f32_16x16x32_bf16 v[16:19], a[96:99], a[40:43], v[16:19]
  buffer_load_dwordx4 v[180:183], v240, s[4:7], s16 offen offset:1024 sc1
  v_mfma_f32_16x16x32_bf16 v[32:35], a[96:99], a[44:47], v[32:35]
  buffer_load_dwordx4 v[184:187], v241, s[4:7], s16 offen offset:0 sc1
  v_mfma_f32_16x16x32_bf16 v[20:23], a[100:103], a[40:43], v[20:23]
  ds_read_b64_tr_b16 a[78:79], v245 offset:53248
  ds_read_b64_tr_b16 a[96:97], v242 offset:57344
  v_mfma_f32_16x16x32_bf16 v[36:39], a[100:103], a[44:47], v[36:39]
  buffer_load_dwordx4 v[188:191], v241, s[4:7], s16 offen offset:1024 sc1
  v_mfma_f32_16x16x32_bf16 v[24:27], a[104:107], a[40:43], v[24:27]
  ds_read_b64_tr_b16 a[98:99], v242 offset:61440
  ds_read_b64_tr_b16 a[100:101], v243 offset:57344
  v_mfma_f32_16x16x32_bf16 v[40:43], a[104:107], a[44:47], v[40:43]
  ds_read_b64_tr_b16 a[102:103], v243 offset:61440
  s_add_u32 s16, s16, 262144
  v_mfma_f32_16x16x32_bf16 v[28:31], a[108:111], a[40:43], v[28:31]
  ds_read_b64_tr_b16 a[104:105], v244 offset:57344
  ds_read_b64_tr_b16 a[106:107], v244 offset:61440
  v_mfma_f32_16x16x32_bf16 v[44:47], a[108:111], a[44:47], v[44:47]
  s_waitcnt vmcnt(20) lgkmcnt(10)
  s_barrier
  v_mfma_f32_16x16x32_bf16 v[72:75], a[80:83], a[48:51], v[72:75]
  ds_read_b64_tr_b16 a[108:109], v245 offset:57344
  s_add_u32 m0, s38, 34816
  v_mfma_f32_16x16x32_bf16 v[88:91], a[80:83], a[52:55], v[88:91]
  ds_read_b64_tr_b16 a[110:111], v245 offset:61440
  ds_read_b64_tr_b16 a[80:81], v242 offset:2048
  v_mfma_f32_16x16x32_bf16 v[76:79], a[84:87], a[48:51], v[76:79]
  ds_read_b64_tr_b16 a[82:83], v242 offset:6144
  v_mfma_f32_16x16x32_bf16 v[92:95], a[84:87], a[52:55], v[92:95]
  buffer_load_dwordx4 v225, s[8:11], s17 offen offset:0 lds
  v_mfma_f32_16x16x32_bf16 v[80:83], a[88:91], a[48:51], v[80:83]
  ds_read_b64_tr_b16 a[84:85], v243 offset:2048
  ds_read_b64_tr_b16 a[86:87], v243 offset:6144
  v_mfma_f32_16x16x32_bf16 v[96:99], a[88:91], a[52:55], v[96:99]
  ds_read_b64_tr_b16 a[88:89], v244 offset:2048
  ds_read_b64_tr_b16 a[90:91], v244 offset:6144
  v_mfma_f32_16x16x32_bf16 v[84:87], a[92:95], a[48:51], v[84:87]
  v_mfma_f32_16x16x32_bf16 v[100:103], a[92:95], a[52:55], v[100:103]
  buffer_load_dwordx4 v226, s[8:11], s17 offen offset:1024 lds
  v_mfma_f32_16x16x32_bf16 v[72:75], a[112:115], a[56:59], v[72:75]
  ds_read_b64_tr_b16 a[92:93], v245 offset:2048
  ds_read_b64_tr_b16 a[94:95], v245 offset:6144
  v_mfma_f32_16x16x32_bf16 v[88:91], a[112:115], a[60:63], v[88:91]
  ds_read_b64_tr_b16 a[112:113], v242 offset:10240
  ds_read_b64_tr_b16 a[114:115], v242 offset:14336
  v_mfma_f32_16x16x32_bf16 v[76:79], a[116:119], a[56:59], v[76:79]
  v_mfma_f32_16x16x32_bf16 v[92:95], a[116:119], a[60:63], v[92:95]
  ds_read_b64_tr_b16 a[116:117], v243 offset:10240
  s_add_u32 s17, s17, 917504
  v_mfma_f32_16x16x32_bf16 v[80:83], a[120:123], a[56:59], v[80:83]
  ds_read_b64_tr_b16 a[118:119], v243 offset:14336
  v_mfma_f32_16x16x32_bf16 v[96:99], a[120:123], a[60:63], v[96:99]
  ds_read_b64_tr_b16 a[120:121], v244 offset:10240
  ds_read_b64_tr_b16 a[122:123], v244 offset:14336
  v_mfma_f32_16x16x32_bf16 v[84:87], a[124:127], a[56:59], v[84:87]
  v_mfma_f32_16x16x32_bf16 v[100:103], a[124:127], a[60:63], v[100:103]
  ds_read_b64_tr_b16 a[124:125], v245 offset:10240
  s_add_u32 m0, s38, 32768
  v_mfma_f32_16x16x32_bf16 v[16:19], a[64:67], a[48:51], v[16:19]
  ds_read_b64_tr_b16 a[126:127], v245 offset:14336
  v_mfma_f32_16x16x32_bf16 v[32:35], a[64:67], a[52:55], v[32:35]
  ds_read_b64_tr_b16 a[64:65], v242 offset:0
  ds_read_b64_tr_b16 a[66:67], v242 offset:4096
  v_mfma_f32_16x16x32_bf16 v[20:23], a[68:71], a[48:51], v[20:23]
  v_mfma_f32_16x16x32_bf16 v[36:39], a[68:71], a[52:55], v[36:39]
  buffer_load_dwordx4 v225, s[8:11], s17 offen offset:0 lds
  s_waitcnt lgkmcnt(10)
  v_mfma_f32_16x16x32_bf16 v[24:27], a[72:75], a[48:51], v[24:27]
  ds_read_b64_tr_b16 a[68:69], v243 offset:0
  ds_read_b64_tr_b16 a[70:71], v243 offset:4096
  v_mfma_f32_16x16x32_bf16 v[40:43], a[72:75], a[52:55], v[40:43]
  ds_read_b64_tr_b16 a[72:73], v244 offset:0
  ds_read_b64_tr_b16 a[74:75], v244 offset:4096
  v_mfma_f32_16x16x32_bf16 v[28:31], a[76:79], a[48:51], v[28:31]
  v_mfma_f32_16x16x32_bf16 v[44:47], a[76:79], a[52:55], v[44:47]
  buffer_load_dwordx4 v226, s[8:11], s17 offen offset:1024 lds
  v_mfma_f32_16x16x32_bf16 v[16:19], a[96:99], a[56:59], v[16:19]
  ds_read_b64_tr_b16 a[76:77], v245 offset:0
  ds_read_b64_tr_b16 a[78:79], v245 offset:4096
  v_mfma_f32_16x16x32_bf16 v[32:35], a[96:99], a[60:63], v[32:35]
  ds_read_b64_tr_b16 a[96:97], v242 offset:8192
  ds_read_b64_tr_b16 a[98:99], v242 offset:12288
  v_mfma_f32_16x16x32_bf16 v[20:23], a[100:103], a[56:59], v[20:23]
  v_mfma_f32_16x16x32_bf16 v[36:39], a[100:103], a[60:63], v[36:39]
  ds_read_b64_tr_b16 a[100:101], v243 offset:8192
  s_add_u32 s17, s17, 917504
  v_mfma_f32_16x16x32_bf16 v[24:27], a[104:107], a[56:59], v[24:27]
  ds_read_b64_tr_b16 a[102:103], v243 offset:12288
  v_mfma_f32_16x16x32_bf16 v[40:43], a[104:107], a[60:63], v[40:43]
  ds_read_b64_tr_b16 a[104:105], v244 offset:8192
  ds_read_b64_tr_b16 a[106:107], v244 offset:12288
  v_mfma_f32_16x16x32_bf16 v[28:31], a[108:111], a[56:59], v[28:31]
  v_mfma_f32_16x16x32_bf16 v[44:47], a[108:111], a[60:63], v[44:47]
  s_waitcnt vmcnt(12) lgkmcnt(10)
  s_barrier
  v_swap_b32 v130, v132
  v_swap_b32 v131, v133
  v_swap_b32 v138, v140
  v_swap_b32 v139, v141
  v_swap_b32 v146, v148
  v_swap_b32 v147, v149
  v_swap_b32 v154, v156
  v_swap_b32 v155, v157
  s_nop 1
  v_mfma_f32_16x16x32_bf16 v[72:75], a[80:83], v[128:131], v[72:75]
  ds_read_b64_tr_b16 a[108:109], v245 offset:8192
  s_add_u32 m0, s38, 51200
  v_mfma_f32_16x16x32_bf16 v[88:91], a[80:83], v[132:135], v[88:91]
  ds_read_b64_tr_b16 a[110:111], v245 offset:12288
  ds_read_b64_tr_b16 a[80:81], v242 offset:18432
  v_mfma_f32_16x16x32_bf16 v[76:79], a[84:87], v[128:131], v[76:79]
  ds_read_b64_tr_b16 a[82:83], v242 offset:22528
  v_mfma_f32_16x16x32_bf16 v[92:95], a[84:87], v[132:135], v[92:95]
  buffer_load_dwordx4 v225, s[8:11], s17 offen offset:0 lds
  v_mfma_f32_16x16x32_bf16 v[80:83], a[88:91], v[128:131], v[80:83]
  ds_read_b64_tr_b16 a[84:85], v243 offset:18432
  ds_read_b64_tr_b16 a[86:87], v243 offset:22528
  v_mfma_f32_16x16x32_bf16 v[96:99], a[88:91], v[132:135], v[96:99]
  ds_read_b64_tr_b16 a[88:89], v244 offset:18432
  ds_read_b64_tr_b16 a[90:91], v244 offset:22528
  v_mfma_f32_16x16x32_bf16 v[84:87], a[92:95], v[128:131], v[84:87]
  buffer_load_dwordx4 v226, s[8:11], s17 offen offset:1024 lds
  v_mfma_f32_16x16x32_bf16 v[100:103], a[92:95], v[132:135], v[100:103]
  ds_read_b64_tr_b16 a[92:93], v245 offset:18432
  ds_read_b64_tr_b16 a[94:95], v245 offset:22528
  v_mfma_f32_16x16x32_bf16 v[72:75], a[112:115], v[136:139], v[72:75]
  v_mfma_f32_16x16x32_bf16 v[88:91], a[112:115], v[140:143], v[88:91]
  ds_read_b64_tr_b16 a[112:113], v242 offset:26624
  ds_read_b64_tr_b16 a[114:115], v242 offset:30720
  v_mfma_f32_16x16x32_bf16 v[76:79], a[116:119], v[136:139], v[76:79]
  s_add_u32 s17, s17, 917504
  v_mfma_f32_16x16x32_bf16 v[92:95], a[116:119], v[140:143], v[92:95]
  ds_read_b64_tr_b16 a[116:117], v243 offset:26624
  ds_read_b64_tr_b16 a[118:119], v243 offset:30720
  v_mfma_f32_16x16x32_bf16 v[80:83], a[120:123], v[136:139], v[80:83]
  v_mfma_f32_16x16x32_bf16 v[96:99], a[120:123], v[140:143], v[96:99]
  ds_read_b64_tr_b16 a[120:121], v244 offset:26624
  s_add_u32 m0, s38, 49152
  v_mfma_f32_16x16x32_bf16 v[84:87], a[124:127], v[136:139], v[84:87]
  ds_read_b64_tr_b16 a[122:123], v244 offset:30720
  v_mfma_f32_16x16x32_bf16 v[100:103], a[124:127], v[140:143], v[100:103]
  ds_read_b64_tr_b16 a[124:125], v245 offset:26624
  ds_read_b64_tr_b16 a[126:127], v245 offset:30720
  v_mfma_f32_16x16x32_bf16 v[72:75], a[64:67], v[144:147], v[72:75]
  v_mfma_f32_16x16x32_bf16 v[88:91], a[64:67], v[148:151], v[88:91]
  buffer_load_dwordx4 v225, s[8:11], s17 offen offset:0 lds
  v_mfma_f32_16x16x32_bf16 v[76:79], a[68:71], v[144:147], v[76:79]
  ds_read_b64_tr_b16 a[64:65], v242 offset:16384
  ds_read_b64_tr_b16 a[66:67], v242 offset:20480
  v_mfma_f32_16x16x32_bf16 v[92:95], a[68:71], v[148:151], v[92:95]
  ds_read_b64_tr_b16 a[68:69], v243 offset:16384
  ds_read_b64_tr_b16 a[70:71], v243 offset:20480
  s_waitcnt lgkmcnt(10)
  v_mfma_f32_16x16x32_bf16 v[80:83], a[72:75], v[144:147], v[80:83]
  buffer_load_dwordx4 v226, s[8:11], s17 offen offset:1024 lds
  v_mfma_f32_16x16x32_bf16 v[96:99], a[72:75], v[148:151], v[96:99]
  ds_read_b64_tr_b16 a[72:73], v244 offset:16384
  ds_read_b64_tr_b16 a[74:75], v244 offset:20480
  v_mfma_f32_16x16x32_bf16 v[84:87], a[76:79], v[144:147], v[84:87]
  v_mfma_f32_16x16x32_bf16 v[100:103], a[76:79], v[148:151], v[100:103]
  ds_read_b64_tr_b16 a[76:77], v245 offset:16384
  ds_read_b64_tr_b16 a[78:79], v245 offset:20480
  v_mfma_f32_16x16x32_bf16 v[72:75], a[96:99], v[152:155], v[72:75]
  s_add_u32 s17, s17, 917504
  v_mfma_f32_16x16x32_bf16 v[88:91], a[96:99], v[156:159], v[88:91]
  ds_read_b64_tr_b16 a[96:97], v242 offset:24576
  ds_read_b64_tr_b16 a[98:99], v242 offset:28672
  v_mfma_f32_16x16x32_bf16 v[76:79], a[100:103], v[152:155], v[76:79]
  v_mfma_f32_16x16x32_bf16 v[92:95], a[100:103], v[156:159], v[92:95]
  s_add_u32 s52, s20, 0xe00000
  s_addc_u32 s53, s21, 0
  s_mov_b32 s54, 0x800000
  s_mov_b32 s55, 0x20000
  v_lshlrev_b32 v50, 4, v231
  s_lshl_b32 s36, s2, 2
  s_add_u32 s36, s36, s3
  s_xor_b32 s37, s36, 4
  s_lshl_b32 s39, s37, 13
  s_lshl_b32 s36, s36, 13
  s_mov_b32 s43, 0x8000
  s_mov_b32 s44, s90
  s_mov_b32 s45, s91
  s_mov_b32 s46, 0x400000
  s_mov_b32 s47, 0x20000
  v_mfma_f32_16x16x32_bf16 v[80:83], a[104:107], v[152:155], v[80:83]
  ds_read_b64_tr_b16 a[100:101], v243 offset:24576
  ds_read_b64_tr_b16 a[102:103], v243 offset:28672
  v_mfma_f32_16x16x32_bf16 v[96:99], a[104:107], v[156:159], v[96:99]
  ds_read_b64_tr_b16 a[104:105], v244 offset:24576
  ds_read_b64_tr_b16 a[106:107], v244 offset:28672
  v_mfma_f32_16x16x32_bf16 v[84:87], a[108:111], v[152:155], v[84:87]
  v_mfma_f32_16x16x32_bf16 v[100:103], a[108:111], v[156:159], v[100:103]
  s_waitcnt vmcnt(4) lgkmcnt(10)
  s_barrier
  v_swap_b32 v162, v164
  v_swap_b32 v163, v165
  v_swap_b32 v170, v172
  v_swap_b32 v171, v173
  v_swap_b32 v178, v180
  v_swap_b32 v179, v181
  v_swap_b32 v186, v188
  v_swap_b32 v187, v189
  s_nop 1
  v_mfma_f32_16x16x32_bf16 v[72:75], a[80:83], v[160:163], v[72:75]
  ds_read_b64_tr_b16 a[108:109], v245 offset:24576
  ds_read_b64_tr_b16 a[110:111], v245 offset:28672
  v_mfma_f32_16x16x32_bf16 v[88:91], a[80:83], v[164:167], v[88:91]
  ds_read_b64_tr_b16 a[80:81], v242 offset:34816
  ds_read_b64_tr_b16 a[82:83], v242 offset:38912
  v_mfma_f32_16x16x32_bf16 v[76:79], a[84:87], v[160:163], v[76:79]
  v_mfma_f32_16x16x32_bf16 v[92:95], a[84:87], v[164:167], v[92:95]
  ds_read_b64_tr_b16 a[84:85], v243 offset:34816
  ds_read_b64_tr_b16 a[86:87], v243 offset:38912
  v_mfma_f32_16x16x32_bf16 v[80:83], a[88:91], v[160:163], v[80:83]
  v_mfma_f32_16x16x32_bf16 v[96:99], a[88:91], v[164:167], v[96:99]
  ds_read_b64_tr_b16 a[88:89], v244 offset:34816
  ds_read_b64_tr_b16 a[90:91], v244 offset:38912
  v_mfma_f32_16x16x32_bf16 v[84:87], a[92:95], v[160:163], v[84:87]
  v_mfma_f32_16x16x32_bf16 v[100:103], a[92:95], v[164:167], v[100:103]
  ds_read_b64_tr_b16 a[92:93], v245 offset:34816
  ds_read_b64_tr_b16 a[94:95], v245 offset:38912
  v_mfma_f32_16x16x32_bf16 v[72:75], a[112:115], v[168:171], v[72:75]
  v_mfma_f32_16x16x32_bf16 v[88:91], a[112:115], v[172:175], v[88:91]
  ds_read_b64_tr_b16 a[112:113], v242 offset:43008
  ds_read_b64_tr_b16 a[114:115], v242 offset:47104
  v_mfma_f32_16x16x32_bf16 v[76:79], a[116:119], v[168:171], v[76:79]
  v_mfma_f32_16x16x32_bf16 v[92:95], a[116:119], v[172:175], v[92:95]
  ds_read_b64_tr_b16 a[116:117], v243 offset:43008
  ds_read_b64_tr_b16 a[118:119], v243 offset:47104
  v_mfma_f32_16x16x32_bf16 v[80:83], a[120:123], v[168:171], v[80:83]
  v_mfma_f32_16x16x32_bf16 v[96:99], a[120:123], v[172:175], v[96:99]
  ds_read_b64_tr_b16 a[120:121], v244 offset:43008
  ds_read_b64_tr_b16 a[122:123], v244 offset:47104
  v_mfma_f32_16x16x32_bf16 v[84:87], a[124:127], v[168:171], v[84:87]
  v_mfma_f32_16x16x32_bf16 v[100:103], a[124:127], v[172:175], v[100:103]
  ds_read_b64_tr_b16 a[124:125], v245 offset:43008
  ds_read_b64_tr_b16 a[126:127], v245 offset:47104
  v_mfma_f32_16x16x32_bf16 v[72:75], a[64:67], v[176:179], v[72:75]
  v_mfma_f32_16x16x32_bf16 v[88:91], a[64:67], v[180:183], v[88:91]
  ds_read_b64_tr_b16 a[64:65], v242 offset:32768
  ds_read_b64_tr_b16 a[66:67], v242 offset:36864
  v_mfma_f32_16x16x32_bf16 v[76:79], a[68:71], v[176:179], v[76:79]
  v_mfma_f32_16x16x32_bf16 v[92:95], a[68:71], v[180:183], v[92:95]
  ds_read_b64_tr_b16 a[68:69], v243 offset:32768
  ds_read_b64_tr_b16 a[70:71], v243 offset:36864
  s_waitcnt lgkmcnt(10)
  v_mfma_f32_16x16x32_bf16 v[80:83], a[72:75], v[176:179], v[80:83]
  v_mfma_f32_16x16x32_bf16 v[96:99], a[72:75], v[180:183], v[96:99]
  ds_read_b64_tr_b16 a[72:73], v244 offset:32768
  ds_read_b64_tr_b16 a[74:75], v244 offset:36864
  v_mfma_f32_16x16x32_bf16 v[84:87], a[76:79], v[176:179], v[84:87]
  v_mfma_f32_16x16x32_bf16 v[100:103], a[76:79], v[180:183], v[100:103]
  ds_read_b64_tr_b16 a[76:77], v245 offset:32768
  ds_read_b64_tr_b16 a[78:79], v245 offset:36864
  v_mfma_f32_16x16x32_bf16 v[72:75], a[96:99], v[184:187], v[72:75]
  v_mfma_f32_16x16x32_bf16 v[88:91], a[96:99], v[188:191], v[88:91]
  ds_read_b64_tr_b16 a[96:97], v242 offset:40960
  ds_read_b64_tr_b16 a[98:99], v242 offset:45056
  v_mfma_f32_16x16x32_bf16 v[76:79], a[100:103], v[184:187], v[76:79]
  v_mfma_f32_16x16x32_bf16 v[92:95], a[100:103], v[188:191], v[92:95]
  ds_read_b64_tr_b16 a[100:101], v243 offset:40960
  ds_read_b64_tr_b16 a[102:103], v243 offset:45056
  v_mfma_f32_16x16x32_bf16 v[80:83], a[104:107], v[184:187], v[80:83]
  v_mfma_f32_16x16x32_bf16 v[96:99], a[104:107], v[188:191], v[96:99]
  ds_read_b64_tr_b16 a[104:105], v244 offset:40960
  ds_read_b64_tr_b16 a[106:107], v244 offset:45056
  v_mfma_f32_16x16x32_bf16 v[84:87], a[108:111], v[184:187], v[84:87]
  v_mfma_f32_16x16x32_bf16 v[100:103], a[108:111], v[188:191], v[100:103]
  s_waitcnt vmcnt(0) lgkmcnt(10)
  s_barrier
  v_mfma_f32_16x16x32_bf16 v[16:19], a[80:83], v[128:131], v[16:19]
  ds_read_b64_tr_b16 a[108:109], v245 offset:40960
  ds_read_b64_tr_b16 a[110:111], v245 offset:45056
  v_mfma_f32_16x16x32_bf16 v[32:35], a[80:83], v[132:135], v[32:35]
  ds_read_b64_tr_b16 a[80:81], v242 offset:51200
  ds_read_b64_tr_b16 a[82:83], v242 offset:55296
  v_mfma_f32_16x16x32_bf16 v[20:23], a[84:87], v[128:131], v[20:23]
  v_mfma_f32_16x16x32_bf16 v[36:39], a[84:87], v[132:135], v[36:39]
  v_cvt_pk_bf16_f32 v108, v72, v73
  v_cvt_pk_bf16_f32 v109, v74, v75
  v_cvt_pk_bf16_f32 v110, v76, v77
  v_cvt_pk_bf16_f32 v111, v78, v79
  buffer_store_dwordx4 v[108:111], v50, s[52:55], s39 offen offset:0 sc1
  v_mfma_f32_16x16x32_bf16 v[24:27], a[88:91], v[128:131], v[24:27]
  v_cvt_pk_bf16_f32 v116, v88, v89
  v_cvt_pk_bf16_f32 v117, v90, v91
  v_cvt_pk_bf16_f32 v118, v92, v93
  v_cvt_pk_bf16_f32 v119, v94, v95
  buffer_store_dwordx4 v[116:119], v50, s[52:55], s39 offen offset:2048 sc1
  v_mfma_f32_16x16x32_bf16 v[40:43], a[88:91], v[132:135], v[40:43]
  ds_read_b64_tr_b16 a[84:85], v243 offset:51200
  ds_read_b64_tr_b16 a[86:87], v243 offset:55296
  v_mfma_f32_16x16x32_bf16 v[28:31], a[92:95], v[128:131], v[28:31]
  ds_read_b64_tr_b16 a[88:89], v244 offset:51200
  ds_read_b64_tr_b16 a[90:91], v244 offset:55296
  v_mfma_f32_16x16x32_bf16 v[44:47], a[92:95], v[132:135], v[44:47]
  v_cvt_pk_bf16_f32 v112, v80, v81
  v_cvt_pk_bf16_f32 v113, v82, v83
  v_cvt_pk_bf16_f32 v114, v84, v85
  v_cvt_pk_bf16_f32 v115, v86, v87
  buffer_store_dwordx4 v[112:115], v50, s[52:55], s39 offen offset:1024 sc1
  v_mfma_f32_16x16x32_bf16 v[16:19], a[112:115], v[136:139], v[16:19]
  v_cvt_pk_bf16_f32 v120, v96, v97
  v_cvt_pk_bf16_f32 v121, v98, v99
  v_cvt_pk_bf16_f32 v122, v100, v101
  v_cvt_pk_bf16_f32 v123, v102, v103
  buffer_store_dwordx4 v[120:123], v50, s[52:55], s39 offen offset:3072 sc1
  v_mfma_f32_16x16x32_bf16 v[32:35], a[112:115], v[140:143], v[32:35]
  ds_read_b64_tr_b16 a[92:93], v245 offset:51200
  ds_read_b64_tr_b16 a[94:95], v245 offset:55296
  v_mfma_f32_16x16x32_bf16 v[20:23], a[116:119], v[136:139], v[20:23]
  ds_read_b64_tr_b16 a[112:113], v242 offset:59392
  ds_read_b64_tr_b16 a[114:115], v242 offset:63488
  v_mfma_f32_16x16x32_bf16 v[36:39], a[116:119], v[140:143], v[36:39]
  ds_read_b64_tr_b16 a[116:117], v243 offset:59392
  ds_read_b64_tr_b16 a[118:119], v243 offset:63488
  v_mfma_f32_16x16x32_bf16 v[24:27], a[120:123], v[136:139], v[24:27]
  v_mfma_f32_16x16x32_bf16 v[40:43], a[120:123], v[140:143], v[40:43]
  ds_read_b64_tr_b16 a[120:121], v244 offset:59392
  ds_read_b64_tr_b16 a[122:123], v244 offset:63488
  v_mfma_f32_16x16x32_bf16 v[28:31], a[124:127], v[136:139], v[28:31]
  v_mfma_f32_16x16x32_bf16 v[44:47], a[124:127], v[140:143], v[44:47]
  ds_read_b64_tr_b16 a[124:125], v245 offset:59392
  ds_read_b64_tr_b16 a[126:127], v245 offset:63488
  v_mfma_f32_16x16x32_bf16 v[16:19], a[64:67], v[144:147], v[16:19]
  v_mfma_f32_16x16x32_bf16 v[32:35], a[64:67], v[148:151], v[32:35]
  ds_read_b64_tr_b16 a[64:65], v242 offset:49152
  ds_read_b64_tr_b16 a[66:67], v242 offset:53248
  v_mfma_f32_16x16x32_bf16 v[20:23], a[68:71], v[144:147], v[20:23]
  v_mfma_f32_16x16x32_bf16 v[36:39], a[68:71], v[148:151], v[36:39]
  ds_read_b64_tr_b16 a[68:69], v243 offset:49152
  ds_read_b64_tr_b16 a[70:71], v243 offset:53248
  s_waitcnt lgkmcnt(10)
  v_mfma_f32_16x16x32_bf16 v[24:27], a[72:75], v[144:147], v[24:27]
  v_mfma_f32_16x16x32_bf16 v[40:43], a[72:75], v[148:151], v[40:43]
  ds_read_b64_tr_b16 a[72:73], v244 offset:49152
  ds_read_b64_tr_b16 a[74:75], v244 offset:53248
  v_mfma_f32_16x16x32_bf16 v[28:31], a[76:79], v[144:147], v[28:31]
  v_mfma_f32_16x16x32_bf16 v[44:47], a[76:79], v[148:151], v[44:47]
  ds_read_b64_tr_b16 a[76:77], v245 offset:49152
  ds_read_b64_tr_b16 a[78:79], v245 offset:53248
  v_mfma_f32_16x16x32_bf16 v[16:19], a[96:99], v[152:155], v[16:19]
  v_mfma_f32_16x16x32_bf16 v[32:35], a[96:99], v[156:159], v[32:35]
  ds_read_b64_tr_b16 a[96:97], v242 offset:57344
  ds_read_b64_tr_b16 a[98:99], v242 offset:61440
  v_mfma_f32_16x16x32_bf16 v[20:23], a[100:103], v[152:155], v[20:23]
  v_mfma_f32_16x16x32_bf16 v[36:39], a[100:103], v[156:159], v[36:39]
  ds_read_b64_tr_b16 a[100:101], v243 offset:57344
  ds_read_b64_tr_b16 a[102:103], v243 offset:61440
  v_mfma_f32_16x16x32_bf16 v[24:27], a[104:107], v[152:155], v[24:27]
  v_mfma_f32_16x16x32_bf16 v[40:43], a[104:107], v[156:159], v[40:43]
  ds_read_b64_tr_b16 a[104:105], v244 offset:57344
  ds_read_b64_tr_b16 a[106:107], v244 offset:61440
  v_mfma_f32_16x16x32_bf16 v[28:31], a[108:111], v[152:155], v[28:31]
  v_mfma_f32_16x16x32_bf16 v[44:47], a[108:111], v[156:159], v[44:47]
  s_waitcnt vmcnt(63) lgkmcnt(10)
  s_barrier
  v_mfma_f32_16x16x32_bf16 v[16:19], a[80:83], v[160:163], v[16:19]
  ds_read_b64_tr_b16 a[108:109], v245 offset:57344
  ds_read_b64_tr_b16 a[110:111], v245 offset:61440
  v_mfma_f32_16x16x32_bf16 v[32:35], a[80:83], v[164:167], v[32:35]
  v_mfma_f32_16x16x32_bf16 v[20:23], a[84:87], v[160:163], v[20:23]
  v_mfma_f32_16x16x32_bf16 v[36:39], a[84:87], v[164:167], v[36:39]
  v_mfma_f32_16x16x32_bf16 v[24:27], a[88:91], v[160:163], v[24:27]
  v_mfma_f32_16x16x32_bf16 v[40:43], a[88:91], v[164:167], v[40:43]
  v_mfma_f32_16x16x32_bf16 v[28:31], a[92:95], v[160:163], v[28:31]
  v_mfma_f32_16x16x32_bf16 v[44:47], a[92:95], v[164:167], v[44:47]
  v_mfma_f32_16x16x32_bf16 v[16:19], a[112:115], v[168:171], v[16:19]
  v_mfma_f32_16x16x32_bf16 v[32:35], a[112:115], v[172:175], v[32:35]
  v_mfma_f32_16x16x32_bf16 v[20:23], a[116:119], v[168:171], v[20:23]
  v_mfma_f32_16x16x32_bf16 v[36:39], a[116:119], v[172:175], v[36:39]
  v_mfma_f32_16x16x32_bf16 v[24:27], a[120:123], v[168:171], v[24:27]
  v_mfma_f32_16x16x32_bf16 v[40:43], a[120:123], v[172:175], v[40:43]
  v_mfma_f32_16x16x32_bf16 v[28:31], a[124:127], v[168:171], v[28:31]
  v_mfma_f32_16x16x32_bf16 v[44:47], a[124:127], v[172:175], v[44:47]
  v_mfma_f32_16x16x32_bf16 v[16:19], a[64:67], v[176:179], v[16:19]
  v_mfma_f32_16x16x32_bf16 v[32:35], a[64:67], v[180:183], v[32:35]
  v_mfma_f32_16x16x32_bf16 v[20:23], a[68:71], v[176:179], v[20:23]
  v_mfma_f32_16x16x32_bf16 v[36:39], a[68:71], v[180:183], v[36:39]
  buffer_load_dwordx4 v[108:111], v50, s[52:55], s36 offen offset:0 sc1
  s_waitcnt lgkmcnt(10)
  v_mfma_f32_16x16x32_bf16 v[24:27], a[72:75], v[176:179], v[24:27]
  buffer_load_dwordx4 v[112:115], v50, s[52:55], s36 offen offset:1024 sc1
  v_mfma_f32_16x16x32_bf16 v[40:43], a[72:75], v[180:183], v[40:43]
  buffer_load_dwordx4 v[116:119], v50, s[52:55], s36 offen offset:2048 sc1
  s_waitcnt lgkmcnt(8)
  v_mfma_f32_16x16x32_bf16 v[28:31], a[76:79], v[176:179], v[28:31]
  buffer_load_dwordx4 v[120:123], v50, s[52:55], s36 offen offset:3072 sc1
  v_mfma_f32_16x16x32_bf16 v[44:47], a[76:79], v[180:183], v[44:47]
  s_waitcnt lgkmcnt(6)
  v_mfma_f32_16x16x32_bf16 v[16:19], a[96:99], v[184:187], v[16:19]
  v_mfma_f32_16x16x32_bf16 v[32:35], a[96:99], v[188:191], v[32:35]
  s_waitcnt lgkmcnt(4)
  v_mfma_f32_16x16x32_bf16 v[20:23], a[100:103], v[184:187], v[20:23]
  v_mfma_f32_16x16x32_bf16 v[36:39], a[100:103], v[188:191], v[36:39]
  s_waitcnt lgkmcnt(2)
  v_mfma_f32_16x16x32_bf16 v[24:27], a[104:107], v[184:187], v[24:27]
  v_mfma_f32_16x16x32_bf16 v[40:43], a[104:107], v[188:191], v[40:43]
  s_waitcnt lgkmcnt(0)
  v_mfma_f32_16x16x32_bf16 v[28:31], a[108:111], v[184:187], v[28:31]
  v_mfma_f32_16x16x32_bf16 v[44:47], a[108:111], v[188:191], v[44:47]
  s_nop 7
  s_nop 1
  s_waitcnt lgkmcnt(0)
  v_pk_fma_f32 v[192:193], v[16:17], v[56:57], v[192:193]
  v_pk_fma_f32 v[194:195], v[18:19], v[58:59], v[194:195]
  v_pk_fma_f32 v[196:197], v[20:21], v[60:61], v[196:197]
  v_pk_fma_f32 v[198:199], v[22:23], v[62:63], v[198:199]
  v_pk_fma_f32 v[200:201], v[24:25], v[64:65], v[200:201]
  v_pk_fma_f32 v[202:203], v[26:27], v[66:67], v[202:203]
  v_pk_fma_f32 v[204:205], v[28:29], v[68:69], v[204:205]
  v_pk_fma_f32 v[206:207], v[30:31], v[70:71], v[206:207]
  v_pk_fma_f32 v[208:209], v[32:33], v[56:57], v[208:209]
  v_pk_fma_f32 v[210:211], v[34:35], v[58:59], v[210:211]
  v_pk_fma_f32 v[212:213], v[36:37], v[60:61], v[212:213]
  v_pk_fma_f32 v[214:215], v[38:39], v[62:63], v[214:215]
  v_pk_fma_f32 v[216:217], v[40:41], v[64:65], v[216:217]
  v_pk_fma_f32 v[218:219], v[42:43], v[66:67], v[218:219]
  v_pk_fma_f32 v[220:221], v[44:45], v[68:69], v[220:221]
  v_pk_fma_f32 v[222:223], v[46:47], v[70:71], v[222:223]
  s_mov_b32 s60, 262144
  s_branch L_chk_33
L_poll_31:
  buffer_load_dwordx4 v[108:111], v50, s[52:55], s36 offen offset:0 sc1
  buffer_load_dwordx4 v[112:115], v50, s[52:55], s36 offen offset:1024 sc1
  buffer_load_dwordx4 v[116:119], v50, s[52:55], s36 offen offset:2048 sc1
  buffer_load_dwordx4 v[120:123], v50, s[52:55], s36 offen offset:3072 sc1
L_chk_33:
  s_waitcnt vmcnt(3)
  v_max3_u32 v51, v108, v109, v110
  v_max_u32 v51, v51, v111
  s_waitcnt vmcnt(2)
  v_max3_u32 v51, v51, v112, v113
  v_max3_u32 v51, v51, v114, v115
  s_waitcnt vmcnt(1)
  v_max3_u32 v51, v51, v116, v117
  v_max3_u32 v51, v51, v118, v119
  s_waitcnt vmcnt(0)
  v_max3_u32 v51, v51, v120, v121
  v_max3_u32 v51, v51, v122, v123
  v_cmp_eq_u32 vcc, -1, v51
  s_nop 1
  s_cmp_eq_u64 vcc, 0
  s_cbranch_scc1 L_ready_32
  s_sub_u32 s60, s60, 1
  s_cmp_lg_u32 s60, 0
  s_cbranch_scc1 L_poll_31
L_ready_32:
  v_lshlrev_b32 v72, 16, v108
  v_and_b32 v73, 0xffff0000, v108
  v_lshlrev_b32 v74, 16, v109
  v_and_b32 v75, 0xffff0000, v109
  v_pk_fma_f32 v[192:193], v[72:73], v[56:57], v[192:193]
  v_pk_fma_f32 v[194:195], v[74:75], v[58:59], v[194:195]
  v_cvt_pk_bf16_f32 v0, v192, v193
  v_cvt_pk_bf16_f32 v1, v194, v195
  v_lshlrev_b32 v76, 16, v110
  v_and_b32 v77, 0xffff0000, v110
  v_lshlrev_b32 v78, 16, v111
  v_and_b32 v79, 0xffff0000, v111
  v_pk_fma_f32 v[196:197], v[76:77], v[60:61], v[196:197]
  v_pk_fma_f32 v[198:199], v[78:79], v[62:63], v[198:199]
  v_cvt_pk_bf16_f32 v2, v196, v197
  v_cvt_pk_bf16_f32 v3, v198, v199
  s_nop 1
  v_permlane16_swap_b32 v0, v2
  v_permlane16_swap_b32 v1, v3
  s_nop 1
  buffer_store_dwordx4 v[0:3], v252, s[44:47], 0 offen offset:0 sc1
  v_lshlrev_b32 v80, 16, v112
  v_and_b32 v81, 0xffff0000, v112
  v_lshlrev_b32 v82, 16, v113
  v_and_b32 v83, 0xffff0000, v113
  v_pk_fma_f32 v[200:201], v[80:81], v[64:65], v[200:201]
  v_pk_fma_f32 v[202:203], v[82:83], v[66:67], v[202:203]
  v_cvt_pk_bf16_f32 v4, v200, v201
  v_cvt_pk_bf16_f32 v5, v202, v203
  v_lshlrev_b32 v84, 16, v114
  v_and_b32 v85, 0xffff0000, v114
  v_lshlrev_b32 v86, 16, v115
  v_and_b32 v87, 0xffff0000, v115
  v_pk_fma_f32 v[204:205], v[84:85], v[68:69], v[204:205]
  v_pk_fma_f32 v[206:207], v[86:87], v[70:71], v[206:207]
  v_cvt_pk_bf16_f32 v6, v204, v205
  v_cvt_pk_bf16_f32 v7, v206, v207
  s_nop 1
  v_permlane16_swap_b32 v4, v6
  v_permlane16_swap_b32 v5, v7
  s_nop 1
  buffer_store_dwordx4 v[4:7], v252, s[44:47], 0 offen offset:64 sc1
  v_lshlrev_b32 v88, 16, v116
  v_and_b32 v89, 0xffff0000, v116
  v_lshlrev_b32 v90, 16, v117
  v_and_b32 v91, 0xffff0000, v117
  v_pk_fma_f32 v[208:209], v[88:89], v[56:57], v[208:209]
  v_pk_fma_f32 v[210:211], v[90:91], v[58:59], v[210:211]
  v_cvt_pk_bf16_f32 v8, v208, v209
  v_cvt_pk_bf16_f32 v9, v210, v211
  v_lshlrev_b32 v92, 16, v118
  v_and_b32 v93, 0xffff0000, v118
  v_lshlrev_b32 v94, 16, v119
  v_and_b32 v95, 0xffff0000, v119
  v_pk_fma_f32 v[212:213], v[92:93], v[60:61], v[212:213]
  v_pk_fma_f32 v[214:215], v[94:95], v[62:63], v[214:215]
  v_cvt_pk_bf16_f32 v10, v212, v213
  v_cvt_pk_bf16_f32 v11, v214, v215
  s_nop 1
  v_permlane16_swap_b32 v8, v10
  v_permlane16_swap_b32 v9, v11
  s_nop 1
  buffer_store_dwordx4 v[8:11], v252, s[44:47], s43 offen offset:0 sc1
  v_lshlrev_b32 v96, 16, v120
  v_and_b32 v97, 0xffff0000, v120
  v_lshlrev_b32 v98, 16, v121
  v_and_b32 v99, 0xffff0000, v121
  v_pk_fma_f32 v[216:217], v[96:97], v[64:65], v[216:217]
  v_pk_fma_f32 v[218:219], v[98:99], v[66:67], v[218:219]
  v_cvt_pk_bf16_f32 v12, v216, v217
  v_cvt_pk_bf16_f32 v13, v218, v219
  v_lshlrev_b32 v100, 16, v122
  v_and_b32 v101, 0xffff0000, v122
  v_lshlrev_b32 v102, 16, v123
  v_and_b32 v103, 0xffff0000, v123
  v_pk_fma_f32 v[220:221], v[100:101], v[68:69], v[220:221]
  v_pk_fma_f32 v[222:223], v[102:103], v[70:71], v[222:223]
  v_cvt_pk_bf16_f32 v14, v220, v221
  v_cvt_pk_bf16_f32 v15, v222, v223
  s_nop 1
  v_permlane16_swap_b32 v12, v14
  v_permlane16_swap_b32 v13, v15
  s_nop 1
  buffer_store_dwordx4 v[12:15], v252, s[44:47], s43 offen offset:64 sc1
  s_endpgm
L_slow_9:
  s_mov_b32 s33, 262144
L_spin_34:
  buffer_load_dword v127, v126, s[64:67], 0 offen sc1
  s_waitcnt vmcnt(0)
  v_cmp_ne_u32 vcc, s19, v127
  s_nop 1
  s_cmp_eq_u64 vcc, 0
  s_cbranch_scc1 L_back_10
  s_sub_u32 s33, s33, 1
  s_cmp_lg_u32 s33, 0
  s_cbranch_scc1 L_spin_34
  s_branch L_back_10
L_vslow_11:
  s_mov_b32 s33, 262144
L_spin_35:
  buffer_load_dwordx4 v[250:253], v254, s[12:15], s68 offen sc1
  s_waitcnt vmcnt(0)
  v_xor_b32 v168, s48, v250
  v_xor_b32 v169, s49, v251
  v_xor_b32 v170, s50, v252
  v_xor_b32 v171, s51, v253
  v_or3_b32 v172, v168, v169, v170
  v_or_b32 v172, v172, v171
  v_and_b32 v172, 0xff, v172
  v_cmp_ne_u32 vcc, 0, v172
  s_nop 1
  s_cmp_eq_u64 vcc, 0
  s_cbranch_scc1 L_vback_12
  s_sub_u32 s33, s33, 1
  s_cmp_lg_u32 s33, 0
  s_cbranch_scc1 L_spin_35
  s_branch L_vback_12
L_slow_21:
  s_mov_b32 s69, 262144
L_spin_36:
  buffer_load_dword v247, v246, s[64:67], s68 offen sc1
  s_waitcnt vmcnt(0)
  v_cmp_ne_u32 vcc, s19, v247
  s_nop 1
  s_cmp_eq_u64 vcc, 0
  s_cbranch_scc1 L_back_22
  s_sub_u32 s69, s69, 1
  s_cmp_lg_u32 s69, 0
  s_cbranch_scc1 L_spin_36
  s_branch L_back_22
L_slow_25:
  s_mov_b32 s60, 262144
L_spin_37:
  buffer_load_dword v247, v246, s[56:59], s94 offen sc1
  s_waitcnt vmcnt(0)
  v_cmp_ne_u32 vcc, s19, v247
  s_nop 1
  s_cmp_eq_u64 vcc, 0
  s_cbranch_scc1 L_back_26
  s_sub_u32 s60, s60, 1
  s_cmp_lg_u32 s60, 0
  s_cbranch_scc1 L_spin_37
  s_branch L_back_26
L_slow_27:
  s_mov_b32 s60, 262144
L_spin_38:
  buffer_load_dword v247, v246, s[56:59], s94 offen sc1
  s_waitcnt vmcnt(0)
  v_cmp_ne_u32 vcc, s19, v247
  s_nop 1
  s_cmp_eq_u64 vcc, 0
  s_cbranch_scc1 L_back_28
  s_sub_u32 s60, s60, 1
  s_cmp_lg_u32 s60, 0
  s_cbranch_scc1 L_spin_38
  s_branch L_back_28
L_slow_29:
  s_mov_b32 s60, 262144
L_spin_39:
  buffer_load_dword v247, v246, s[56:59], s94 offen sc1
  s_waitcnt vmcnt(0)
  v_cmp_ne_u32 vcc, s19, v247
  s_nop 1
  s_cmp_eq_u64 vcc, 0
  s_cbranch_scc1 L_back_30
  s_sub_u32 s60, s60, 1
  s_cmp_lg_u32 s60, 0
  s_cbranch_scc1 L_spin_39
  s_branch L_back_30
L_end_1:
  s_endpgm
L_code_end:
  s_endpgm
.section .rodata,"a"
.p2align 6
.amdhsa_kernel adaLN_cond__sliding_local_dilated__glu_gated_glu__prompt_kernel
  .amdhsa_next_free_vgpr 512
  .amdhsa_next_free_sgpr 102
  .amdhsa_accum_offset 256
  .amdhsa_group_segment_fixed_size 0
  .amdhsa_kernarg_size 96
  .amdhsa_user_sgpr_count 2
  .amdhsa_user_sgpr_kernarg_segment_ptr 1
  .amdhsa_system_sgpr_workgroup_id_x 1
  .amdhsa_float_denorm_mode_32 3
.end_amdhsa_kernel
```

```asm
; @launch grid=(256,1,1) block=(256,1,1) lds=163840
.amdgcn_target "amdgcn-amd-amdhsa--gfx950"
.text
.globl adaLN_cond__sliding_local_dilated__glu_gated_glu__prompt_kernel
.p2align 8
.type adaLN_cond__sliding_local_dilated__glu_gated_glu__prompt_kernel,@function
adaLN_cond__sliding_local_dilated__glu_gated_glu__prompt_kernel:
  s_cmp_ge_u32 s2, 256
  s_cbranch_scc1 L_end_1
  s_load_dwordx2 s[44:45], s[0:1], 56
  s_load_dwordx2 s[52:53], s[0:1], 64
  s_load_dwordx2 s[12:13], s[0:1], 0
  s_load_dwordx2 s[20:21], s[0:1], 88
  s_load_dwordx2 s[8:9], s[0:1], 8
  s_getpc_b64 s[58:59]
  v_and_b32 v86, 31, v0
  v_lshlrev_b32 v86, 7, v86
  global_load_dword v131, v86, s[58:59] offset:128
  v_lshrrev_b32 v110, 6, v0
  v_and_b32 v104, 63, v0
  s_nop 0
  v_readfirstlane_b32 s3, v110
  s_and_b32 s29, s2, 3
  s_and_b32 s28, s2, 4
  s_lshl_b32 s28, s28, 3
  s_lshr_b32 s31, s2, 3
  s_or_b32 s28, s28, s31
  v_lshrrev_b32 v1, 2, v104
  v_mul_u32_u24 v1, 12288, v1
  v_and_b32 v66, 3, v104
  v_lshl_add_u32 v1, v66, 4, v1
  v_lshlrev_b32 v2, 1, v0
  s_lshl2_add_u32 s30, s29, s3
  s_mul_i32 s50, s30, 786432
  s_lshl_b32 s31, s28, 6
  s_add_u32 s35, s50, s31
  s_lshl_b32 s34, s29, 9
  s_lshl_b32 s31, s3, 12
  s_add_u32 m0, s31, 79872
  v_and_b32 v66, 7, v104
  v_lshlrev_b32 v3, 11, v66
  v_lshrrev_b32 v67, 3, v104
  v_lshl_add_u32 v3, v67, 4, v3
  s_lshl_b32 s36, s2, 14
  s_lshl_b32 s31, s3, 9
  s_add_u32 s36, s36, s31
  s_movk_i32 s46, 2048
  s_mov_b32 s47, 0x20000
  s_mov_b32 s54, 12582912
  s_mov_b32 s55, 0x20000
  s_mov_b32 s14, 4194304
  s_mov_b32 s15, 0x20000
  s_waitcnt lgkmcnt(0)
  s_load_dword s19, s[20:21], 0x40000
  buffer_load_ushort v4, v2, s[44:47], s34 offen
  buffer_load_dwordx4 v1, s[52:55], s35 offen offset:0 lds
  s_add_u32 s35, s35, 195584
  buffer_load_dwordx4 v1, s[52:55], s35 offen offset:1024 lds
  s_add_u32 s35, s35, 195584
  buffer_load_dwordx4 v1, s[52:55], s35 offen offset:2048 lds
  s_add_u32 s35, s35, 195584
  buffer_load_dwordx4 v1, s[52:55], s35 offen offset:3072 lds
  s_barrier
  buffer_load_dwordx4 v[8:11], v3, s[12:15], s36 offen offset:0
  buffer_load_dwordx4 v[12:15], v3, s[12:15], s36 offen offset:128
  buffer_load_dwordx4 v[16:19], v3, s[12:15], s36 offen offset:256
  buffer_load_dwordx4 v[20:23], v3, s[12:15], s36 offen offset:384
  s_load_dwordx2 s[24:25], s[0:1], 16
  s_load_dwordx4 s[60:63], s[0:1], 32
  s_load_dwordx2 s[22:23], s[0:1], 48
  s_load_dwordx2 s[90:91], s[0:1], 72
  s_mov_b64 s[26:27], s[12:13]
  s_and_b32 s30, s2, 1
  s_lshl_b32 s30, s30, 3
  s_bfe_u32 s31, s2, 0x30003
  s_add_u32 s30, s30, s31
  s_bfe_u32 s31, s2, 0x20001
  s_lshl_b32 s31, s31, 2
  s_lshr_b32 s34, s2, 6
  s_add_u32 s31, s31, s34
  v_and_b32 v111, 2, v67
  v_xor_b32 v111, v111, v66
  v_mul_u32_u24 v129, 12288, v67
  v_lshl_add_u32 v129, v111, 4, v129
  s_and_b32 s33, s3, 1
  s_lshl_b32 s33, s33, 2
  v_xor_b32 v111, s33, v111
  v_mul_u32_u24 v110, 6144, v67
  v_lshl_add_u32 v110, v111, 4, v110
  s_mul_i32 s32, s3, 49152
  s_lshl_b32 s33, s31, 7
  s_add_u32 s32, s32, s33
  v_add_u32 v107, s32, v110
  v_add_u32 v108, 1024, v107
  v_add_u32 v109, 2048, v107
  s_mul_i32 s38, s3, 3072
  s_and_b32 s33, s30, 7
  s_mul_i32 s16, s33, 131072
  s_mul_i32 s17, s33, 196608
  s_mov_b32 s10, 1572864
  s_mov_b32 s11, 0x20000
  s_barrier
  s_getpc_b64 s[100:101]
  L_pc_2:
  s_add_u32 s100, s100, L_gemm_a-L_pc_2
  s_addc_u32 s101, s101, 0
  s_lshr_b32 s33, s2, 3
  s_lshl_b32 s33, s33, 2
  s_add_u32 s33, s33, s3
  s_lshl_b32 s33, s33, 13
  v_lshlrev_b32 v200, 7, v104
  v_add_u32 v200, s33, v200
  v_min_u32 v200, L_code_end-L_gemm_a-4, v200
  v_mov_b32 v201, s101
  v_add_co_u32 v200, vcc, s100, v200
  s_nop 1
  v_addc_co_u32 v201, vcc, 0, v201, vcc
  global_load_dword v131, v[200:201], off
  v_lshrrev_b32 v68, 4, v104
  v_bfe_u32 v69, v104, 2, 2
  v_lshl_add_u32 v69, v68, 3, v69
  v_and_b32 v70, 3, v104
  v_lshlrev_b32 v70, 3, v70
  s_lshl_b32 s33, s3, 5
  s_add_u32 s33, s33, 106496
  v_add_u32 v70, s33, v70
  v_lshl_add_u32 v5, v69, 6, v70
  v_subrev_u32 v5, 26624, v5
  v_lshl_add_u32 v196, v69, 7, v70
  v_and_b32 v70, 8, v104
  v_lshlrev_b32 v70, 2, v70
  v_xor_b32 v196, v196, v70
  v_lshlrev_b32 v255, 4, v68
  v_add_u32 v197, 147456, v255
  v_and_b32 v70, 15, v104
  v_lshl_or_b32 v255, v70, 24, v255
  v_mov_b32 v198, 0xffffff00
  v_add_u32 v2, 147456, v2
  s_mov_b32 s12, s20
  s_mov_b32 s13, s21
  s_mov_b32 s14, 0x18000
  s_mov_b32 s15, 0x20000
  s_mul_i32 s96, s29, 24576
  s_lshl_b32 s33, s3, 6
  s_add_u32 s96, s96, s33
  s_lshl_b32 s33, s28, 7
  s_add_u32 s34, s96, s33
  s_add_u32 s96, s34, s33
  s_add_u32 s96, s96, 8192
  s_add_u32 s50, s50, s33
  s_add_u32 s50, s50, 4096
  s_lshl_b32 s51, s3, 13
  s_add_u32 s51, s51, 106496
  s_waitcnt vmcnt(9)
  v_lshlrev_b32 v4, 16, v4
  v_mul_f32 v6, 0xbfb8aa3b, v4
  v_exp_f32 v6, v6
  s_nop 0
  v_add_f32 v6, 1.0, v6
  v_rcp_f32 v6, v6
  s_nop 0
  v_mul_f32 v4, v4, v6
  v_cvt_pk_bf16_f32 v4, v4, v4
  ds_write_b16 v2, v4
  s_waitcnt vmcnt(5) lgkmcnt(0)
  s_barrier
  s_mul_i32 s19, s19, 0x9e3779b1
  s_add_u32 s19, s19, 0x7f4a7c15
  s_bfe_u32 s40, s19, 0x80000
  s_bfe_u32 s41, s19, 0x80008
  s_bfe_u32 s42, s19, 0x80010
  s_bfe_u32 s43, s19, 0x80018
  s_cmp_ge_u32 s3, 2
  s_cbranch_scc1 L_nog_3
  ds_read_b64_tr_b16 a[64:65], v5 offset:0
  ds_read_b64_tr_b16 a[66:67], v5 offset:256
  ds_read_b128 a[68:71], v197 offset:0
  ds_read_b64_tr_b16 a[72:73], v5 offset:2048
  ds_read_b64_tr_b16 a[74:75], v5 offset:2304
  ds_read_b128 a[76:79], v197 offset:64
  ds_read_b64_tr_b16 a[80:81], v5 offset:4096
  ds_read_b64_tr_b16 a[82:83], v5 offset:4352
  ds_read_b128 a[84:87], v197 offset:128
  ds_read_b64_tr_b16 a[88:89], v5 offset:6144
  ds_read_b64_tr_b16 a[90:91], v5 offset:6400
  ds_read_b128 a[92:95], v197 offset:192
  ds_read_b64_tr_b16 a[96:97], v5 offset:8192
  ds_read_b64_tr_b16 a[98:99], v5 offset:8448
  ds_read_b128 a[100:103], v197 offset:256
  s_waitcnt lgkmcnt(12)
  v_mfma_f32_16x16x32_bf16 v[192:195], a[64:67], a[68:71], 0
  ds_read_b64_tr_b16 a[104:105], v5 offset:10240
  ds_read_b64_tr_b16 a[106:107], v5 offset:10496
  ds_read_b128 a[108:111], v197 offset:320
  s_waitcnt lgkmcnt(12)
  v_mfma_f32_16x16x32_bf16 v[192:195], a[72:75], a[76:79], v[192:195]
  ds_read_b64_tr_b16 a[112:113], v5 offset:12288
  ds_read_b64_tr_b16 a[114:115], v5 offset:12544
  ds_read_b128 a[116:119], v197 offset:384
  s_waitcnt lgkmcnt(12)
  v_mfma_f32_16x16x32_bf16 v[192:195], a[80:83], a[84:87], v[192:195]
  ds_read_b64_tr_b16 a[120:121], v5 offset:14336
  ds_read_b64_tr_b16 a[122:123], v5 offset:14592
  ds_read_b128 a[124:127], v197 offset:448
  s_waitcnt lgkmcnt(12)
  v_mfma_f32_16x16x32_bf16 v[192:195], a[88:91], a[92:95], v[192:195]
  s_waitcnt lgkmcnt(9)
  v_mfma_f32_16x16x32_bf16 v[192:195], a[96:99], a[100:103], v[192:195]
  s_waitcnt lgkmcnt(6)
  v_mfma_f32_16x16x32_bf16 v[192:195], a[104:107], a[108:111], v[192:195]
  s_waitcnt lgkmcnt(3)
  v_mfma_f32_16x16x32_bf16 v[192:195], a[112:115], a[116:119], v[192:195]
  s_waitcnt lgkmcnt(0)
  v_mfma_f32_16x16x32_bf16 v[192:195], a[120:123], a[124:127], v[192:195]
  s_nop 7
  v_and_or_b32 v192, v192, v198, s40
  v_and_or_b32 v193, v193, v198, s41
  v_and_or_b32 v194, v194, v198, s42
  v_and_or_b32 v195, v195, v198, s43
  buffer_store_dwordx4 v[192:195], v255, s[12:15], s34 offen sc1
L_nog_3:
  s_waitcnt vmcnt(1)
  v_lshlrev_b32 v24, 16, v8
  v_and_b32 v25, 0xffff0000, v8
  v_lshlrev_b32 v26, 16, v9
  v_and_b32 v27, 0xffff0000, v9
  v_lshlrev_b32 v28, 16, v10
  v_and_b32 v29, 0xffff0000, v10
  v_lshlrev_b32 v30, 16, v11
  v_and_b32 v31, 0xffff0000, v11
  v_lshlrev_b32 v32, 16, v12
  v_and_b32 v33, 0xffff0000, v12
  v_lshlrev_b32 v34, 16, v13
  v_and_b32 v35, 0xffff0000, v13
  v_lshlrev_b32 v36, 16, v14
  v_and_b32 v37, 0xffff0000, v14
  v_lshlrev_b32 v38, 16, v15
  v_and_b32 v39, 0xffff0000, v15
  v_lshlrev_b32 v40, 16, v16
  v_and_b32 v41, 0xffff0000, v16
  v_lshlrev_b32 v42, 16, v17
  v_and_b32 v43, 0xffff0000, v17
  v_lshlrev_b32 v44, 16, v18
  v_and_b32 v45, 0xffff0000, v18
  v_lshlrev_b32 v46, 16, v19
  v_and_b32 v47, 0xffff0000, v19
  v_lshlrev_b32 v48, 16, v20
  v_and_b32 v49, 0xffff0000, v20
  v_lshlrev_b32 v50, 16, v21
  v_and_b32 v51, 0xffff0000, v21
  v_lshlrev_b32 v52, 16, v22
  v_and_b32 v53, 0xffff0000, v22
  v_lshlrev_b32 v54, 16, v23
  v_and_b32 v55, 0xffff0000, v23
  v_pk_add_f32 v[56:57], v[24:25], v[26:27]
  v_pk_mul_f32 v[58:59], v[24:25], v[24:25]
  v_pk_mul_f32 v[60:61], v[26:27], v[26:27]
  v_pk_add_f32 v[56:57], v[56:57], v[28:29]
  v_pk_fma_f32 v[58:59], v[28:29], v[28:29], v[58:59]
  v_pk_add_f32 v[56:57], v[56:57], v[30:31]
  v_pk_fma_f32 v[60:61], v[30:31], v[30:31], v[60:61]
  v_pk_add_f32 v[56:57], v[56:57], v[32:33]
  v_pk_fma_f32 v[58:59], v[32:33], v[32:33], v[58:59]
  v_pk_add_f32 v[56:57], v[56:57], v[34:35]
  v_pk_fma_f32 v[60:61], v[34:35], v[34:35], v[60:61]
  v_pk_add_f32 v[56:57], v[56:57], v[36:37]
  v_pk_fma_f32 v[58:59], v[36:37], v[36:37], v[58:59]
  v_pk_add_f32 v[56:57], v[56:57], v[38:39]
  v_pk_fma_f32 v[60:61], v[38:39], v[38:39], v[60:61]
  v_pk_add_f32 v[56:57], v[56:57], v[40:41]
  v_pk_fma_f32 v[58:59], v[40:41], v[40:41], v[58:59]
  v_pk_add_f32 v[56:57], v[56:57], v[42:43]
  v_pk_fma_f32 v[60:61], v[42:43], v[42:43], v[60:61]
  v_pk_add_f32 v[56:57], v[56:57], v[44:45]
  v_pk_fma_f32 v[58:59], v[44:45], v[44:45], v[58:59]
  v_pk_add_f32 v[56:57], v[56:57], v[46:47]
  v_pk_fma_f32 v[60:61], v[46:47], v[46:47], v[60:61]
  v_pk_add_f32 v[56:57], v[56:57], v[48:49]
  v_pk_fma_f32 v[58:59], v[48:49], v[48:49], v[58:59]
  v_pk_add_f32 v[56:57], v[56:57], v[50:51]
  v_pk_fma_f32 v[60:61], v[50:51], v[50:51], v[60:61]
  v_pk_add_f32 v[56:57], v[56:57], v[52:53]
  v_pk_fma_f32 v[58:59], v[52:53], v[52:53], v[58:59]
  v_pk_add_f32 v[56:57], v[56:57], v[54:55]
  v_pk_fma_f32 v[60:61], v[54:55], v[54:55], v[60:61]
  v_pk_add_f32 v[58:59], v[58:59], v[60:61]
  v_add_f32 v56, v56, v57
  v_add_f32 v57, v58, v59
  s_nop 1
  v_add_f32_dpp v56, v56, v56 row_ror:8 row_mask:0xf bank_mask:0xf
  v_add_f32_dpp v57, v57, v57 row_ror:8 row_mask:0xf bank_mask:0xf
  v_mov_b32 v58, v56
  v_mov_b32 v59, v57
  s_nop 1
  v_permlane16_swap_b32 v58, v56
  v_permlane16_swap_b32 v59, v57
  s_nop 1
  v_add_f32 v56, v56, v58
  v_add_f32 v57, v57, v59
  v_mov_b32 v58, v56
  v_mov_b32 v59, v57
  s_nop 1
  v_permlane32_swap_b32 v58, v56
  v_permlane32_swap_b32 v59, v57
  s_nop 1
  v_add_f32 v56, v56, v58
  v_add_f32 v57, v57, v59
  v_lshlrev_b32 v68, 5, v66
  v_add_u32 v68, 147968, v68
  s_lshl_b32 s33, s3, 3
  v_add_u32 v69, s33, v68
  ds_write_b64 v69, v[56:57]
  v_lshlrev_b32 v119, 4, v104
  s_lshl_b32 s33, s3, 10
  v_add_u32 v1, s33, v119
  v_add_u32 v2, 4096, v1
  s_lshl_b32 s33, s3, 11
  s_add_u32 s33, s33, 139264
  v_add_u32 v3, s33, v119
  v_lshlrev_b32 v4, 5, v67
  v_add_u32 v4, s33, v4
  v_lshrrev_b32 v5, 5, v104
  v_lshlrev_b32 v5, 17, v5
  v_and_b32 v70, 3, v67
  v_lshl_add_u32 v5, v70, 8, v5
  v_lshl_add_u32 v5, v66, 4, v5
  s_waitcnt lgkmcnt(0)
  s_barrier
  ds_read_b128 v[132:135], v68 offset:0
  ds_read_b128 v[136:139], v68 offset:16
  s_add_u32 m0, s38, 0
  s_nop 0
  buffer_load_dwordx4 v107, s[8:11], s17 offen lds
  buffer_load_dwordx4 v108, s[8:11], s17 offen offset:1024 lds
  buffer_load_dwordx4 v109, s[8:11], s17 offen offset:2048 lds
  s_add_u32 s17, s17, 196608
  s_cmp_eq_u32 s17, s10
  s_cselect_b32 s17, 0, s17
  s_mov_b32 s32, 24576
  s_mov_b32 s35, 49152
  s_mov_b32 s36, 73728
  s_add_u32 s4, s20, 0x200000
  s_addc_u32 s5, s21, 0
  s_mov_b32 s6, 0x400000
  s_mov_b32 s7, 0x20000
  s_add_u32 s64, s20, 0xc0000
  s_addc_u32 s65, s21, 0
  s_mov_b32 s66, 0x20000
  s_mov_b32 s67, 0x20000
  s_waitcnt lgkmcnt(0)
  v_pk_add_f32 v[132:133], v[132:133], v[134:135]
  v_pk_add_f32 v[136:137], v[136:137], v[138:139]
  v_pk_add_f32 v[132:133], v[132:133], v[136:137]
  v_mul_f32 v56, 0x3a800000, v132
  v_mul_f32 v60, 0x3a800000, v133
  v_fma_f32 v60, -v56, v56, v60
  v_max_f32 v60, 0, v60
  buffer_load_dwordx4 v[72:75], v1, s[12:15], 0 offen sc1
  buffer_load_dwordx4 v[76:79], v1, s[12:15], s32 offen sc1
  buffer_load_dwordx4 v[80:83], v1, s[12:15], s35 offen sc1
  buffer_load_dwordx4 v[84:87], v1, s[12:15], s36 offen sc1
  buffer_load_dwordx4 v[88:91], v2, s[12:15], 0 offen sc1
  buffer_load_dwordx4 v[92:95], v2, s[12:15], s32 offen sc1
  buffer_load_dwordx4 v[96:99], v2, s[12:15], s35 offen sc1
  buffer_load_dwordx4 v[100:103], v2, s[12:15], s36 offen sc1
  v_cvt_pk_bf16_f32 v64, v56, v60
  v_lshlrev_b32 v56, 16, v64
  v_and_b32 v60, 0xffff0000, v64
  v_add_f32 v60, 0x3727c5ac, v60
  v_cvt_pk_bf16_f32 v64, v60, v61
  v_lshlrev_b32 v60, 16, v64
  v_and_b32 v61, 0xffff0000, v64
  v_sqrt_f32 v60, v60
  s_nop 0
  v_cvt_pk_bf16_f32 v64, v60, v61
  v_lshlrev_b32 v60, 16, v64
  v_and_b32 v61, 0xffff0000, v64
  v_rcp_f32 v60, v60
  v_mov_b32 v57, v56
  s_nop 0
  v_mov_b32 v61, v60
  v_pk_add_f32 v[24:25], v[24:25], v[56:57] neg_lo:[0,1] neg_hi:[0,1]
  v_pk_add_f32 v[26:27], v[26:27], v[56:57] neg_lo:[0,1] neg_hi:[0,1]
  v_pk_add_f32 v[28:29], v[28:29], v[56:57] neg_lo:[0,1] neg_hi:[0,1]
  v_pk_add_f32 v[30:31], v[30:31], v[56:57] neg_lo:[0,1] neg_hi:[0,1]
  v_pk_add_f32 v[32:33], v[32:33], v[56:57] neg_lo:[0,1] neg_hi:[0,1]
  v_pk_add_f32 v[34:35], v[34:35], v[56:57] neg_lo:[0,1] neg_hi:[0,1]
  v_pk_add_f32 v[36:37], v[36:37], v[56:57] neg_lo:[0,1] neg_hi:[0,1]
  v_pk_add_f32 v[38:39], v[38:39], v[56:57] neg_lo:[0,1] neg_hi:[0,1]
  v_pk_add_f32 v[40:41], v[40:41], v[56:57] neg_lo:[0,1] neg_hi:[0,1]
  v_pk_add_f32 v[42:43], v[42:43], v[56:57] neg_lo:[0,1] neg_hi:[0,1]
  v_pk_add_f32 v[44:45], v[44:45], v[56:57] neg_lo:[0,1] neg_hi:[0,1]
  v_pk_add_f32 v[46:47], v[46:47], v[56:57] neg_lo:[0,1] neg_hi:[0,1]
  v_pk_add_f32 v[48:49], v[48:49], v[56:57] neg_lo:[0,1] neg_hi:[0,1]
  v_pk_add_f32 v[50:51], v[50:51], v[56:57] neg_lo:[0,1] neg_hi:[0,1]
  v_pk_add_f32 v[52:53], v[52:53], v[56:57] neg_lo:[0,1] neg_hi:[0,1]
  v_pk_add_f32 v[54:55], v[54:55], v[56:57] neg_lo:[0,1] neg_hi:[0,1]
  v_pk_mul_f32 v[24:25], v[24:25], v[60:61]
  v_pk_mul_f32 v[26:27], v[26:27], v[60:61]
  v_pk_mul_f32 v[28:29], v[28:29], v[60:61]
  v_pk_mul_f32 v[30:31], v[30:31], v[60:61]
  v_pk_mul_f32 v[32:33], v[32:33], v[60:61]
  v_pk_mul_f32 v[34:35], v[34:35], v[60:61]
  v_pk_mul_f32 v[36:37], v[36:37], v[60:61]
  v_pk_mul_f32 v[38:39], v[38:39], v[60:61]
  v_pk_mul_f32 v[40:41], v[40:41], v[60:61]
  v_pk_mul_f32 v[42:43], v[42:43], v[60:61]
  v_pk_mul_f32 v[44:45], v[44:45], v[60:61]
  v_pk_mul_f32 v[46:47], v[46:47], v[60:61]
  v_pk_mul_f32 v[48:49], v[48:49], v[60:61]
  v_pk_mul_f32 v[50:51], v[50:51], v[60:61]
  v_pk_mul_f32 v[52:53], v[52:53], v[60:61]
  v_pk_mul_f32 v[54:55], v[54:55], v[60:61]
  s_lshl_b32 s39, s3, 8
  s_add_u32 s39, s39, 12288
  s_lshl_b32 s33, s30, 6
  s_lshl_b32 s34, s3, 4
  s_add_u32 s34, s34, s33
  s_max_u32 s33, s33, 8
  s_sub_u32 s33, s33, 8
  v_add_u32 v110, s33, v66
  v_add_u32 v126, s34, v104
  v_cmp_lt_u32 vcc, 15, v104
  s_nop 1
  v_cndmask_b32 v126, v126, v110, vcc
  s_mov_b32 s33, 0
  v_and_b32 v128, 0, v126
  v_add_u32 v128, s33, v128
  v_and_b32 v128, 3, v128
  v_and_or_b32 v128, v126, -4, v128
  v_lshlrev_b32 v126, 6, v126
  v_lshlrev_b32 v128, 6, v128
  s_lshl_b32 s34, s30, 13
  s_lshl_b32 s33, s3, 11
  s_add_u32 s34, s34, s33
  v_add_u32 v105, s34, v119
  s_lshl_b32 s34, s30, 3
  s_max_u32 s34, s34, 1
  s_sub_u32 s34, s34, 1
  s_lshl_b32 s34, s34, 10
  s_lshl_b32 s33, s3, 8
  s_add_u32 s34, s34, s33
  v_lshlrev_b32 v106, 2, v104
  v_add_u32 v106, s34, v106
  v_lshrrev_b32 v110, 4, v104
  v_mul_u32_u24 v110, 3072, v110
  v_bfe_u32 v111, v104, 2, 2
  v_lshl_add_u32 v110, v111, 7, v110
  v_bfe_u32 v111, v104, 3, 2
  v_lshl_add_u32 v110, v111, 5, v110
  v_and_b32 v111, 3, v104
  v_lshl_add_u32 v114, v111, 3, v110
  v_xor_b32 v115, 32, v114
  v_xor_b32 v116, 64, v114
  v_xor_b32 v117, 96, v114
  s_lshl_b32 s33, s3, 5
  v_xor_b32 v118, s33, v114
  v_add_u32 v120, 53248, v114
  v_add_u32 v121, 53248, v115
  v_add_u32 v122, 53248, v116
  v_add_u32 v123, 53248, v117
  v_add_u32 v124, 53248, v118
  v_add_u32 v125, 53248, v119
  v_and_b32 v110, 14, v104
  v_lshrrev_b32 v111, 4, v104
  v_lshlrev_b32 v111, 2, v111
  v_cmp_le_u32 s[44:45], v111, v110
  v_add_u32 v111, 2, v111
  v_cmp_le_u32 s[46:47], v111, v110
  v_and_b32 v110, 1, v104
  v_cmp_eq_u32 s[48:49], 1, v110
  s_lshl_b32 s56, s3, 20
  s_lshr_b32 s33, s2, 1
  s_lshl_b32 s33, s33, 10
  s_add_u32 s56, s56, s33
  s_and_b32 s33, s2, 1
  s_lshl_b32 s33, s33, 7
  s_add_u32 s56, s56, s33
  s_add_u32 s57, s56, 262144
  s_add_u32 s58, s56, 524288
  s_add_u32 s59, s56, 786432
  s_lshl_b32 s37, s2, 2
  s_add_u32 s37, s37, s3
  s_lshl_b32 s37, s37, 6
  s_mov_b32 s33, 262144
L_mod_4:
  s_waitcnt vmcnt(7)
  v_xor_b32 v72, s40, v72
  v_xor_b32 v73, s41, v73
  v_xor_b32 v74, s42, v74
  v_xor_b32 v75, s43, v75
  v_or3_b32 v66, v72, v73, v74
  v_or_b32 v66, v66, v75
  s_waitcnt vmcnt(6)
  v_xor_b32 v76, s40, v76
  v_xor_b32 v77, s41, v77
  v_xor_b32 v78, s42, v78
  v_xor_b32 v79, s43, v79
  v_or3_b32 v66, v66, v76, v77
  v_or3_b32 v66, v66, v78, v79
  s_waitcnt vmcnt(5)
  v_xor_b32 v80, s40, v80
  v_xor_b32 v81, s41, v81
  v_xor_b32 v82, s42, v82
  v_xor_b32 v83, s43, v83
  v_or3_b32 v66, v66, v80, v81
  v_or3_b32 v66, v66, v82, v83
  s_waitcnt vmcnt(4)
  v_xor_b32 v84, s40, v84
  v_xor_b32 v85, s41, v85
  v_xor_b32 v86, s42, v86
  v_xor_b32 v87, s43, v87
  v_or3_b32 v66, v66, v84, v85
  v_or3_b32 v66, v66, v86, v87
  s_waitcnt vmcnt(3)
  v_xor_b32 v88, s40, v88
  v_xor_b32 v89, s41, v89
  v_xor_b32 v90, s42, v90
  v_xor_b32 v91, s43, v91
  v_or3_b32 v66, v66, v88, v89
  v_or3_b32 v66, v66, v90, v91
  s_waitcnt vmcnt(2)
  v_xor_b32 v92, s40, v92
  v_xor_b32 v93, s41, v93
  v_xor_b32 v94, s42, v94
  v_xor_b32 v95, s43, v95
  v_or3_b32 v66, v66, v92, v93
  v_or3_b32 v66, v66, v94, v95
  s_waitcnt vmcnt(1)
  v_xor_b32 v96, s40, v96
  v_xor_b32 v97, s41, v97
  v_xor_b32 v98, s42, v98
  v_xor_b32 v99, s43, v99
  v_or3_b32 v66, v66, v96, v97
  v_or3_b32 v66, v66, v98, v99
  s_waitcnt vmcnt(0)
  v_xor_b32 v100, s40, v100
  v_xor_b32 v101, s41, v101
  v_xor_b32 v102, s42, v102
  v_xor_b32 v103, s43, v103
  v_or3_b32 v66, v66, v100, v101
  v_or3_b32 v66, v66, v102, v103
  v_and_b32 v66, 0xff, v66
  v_cmp_ne_u32 vcc, 0, v66
  s_nop 1
  s_cmp_eq_u64 vcc, 0
  s_cbranch_scc1 L_mok_5
  s_mov_b64 exec, vcc
  buffer_load_dwordx4 v[72:75], v1, s[12:15], 0 offen sc1
  buffer_load_dwordx4 v[76:79], v1, s[12:15], s32 offen sc1
  buffer_load_dwordx4 v[80:83], v1, s[12:15], s35 offen sc1
  buffer_load_dwordx4 v[84:87], v1, s[12:15], s36 offen sc1
  buffer_load_dwordx4 v[88:91], v2, s[12:15], 0 offen sc1
  buffer_load_dwordx4 v[92:95], v2, s[12:15], s32 offen sc1
  buffer_load_dwordx4 v[96:99], v2, s[12:15], s35 offen sc1
  buffer_load_dwordx4 v[100:103], v2, s[12:15], s36 offen sc1
  s_sub_u32 s33, s33, 1
  s_cmp_lg_u32 s33, 0
  s_cbranch_scc1 L_mod_4
  s_waitcnt vmcnt(0)
L_mok_5:
  s_mov_b64 exec, -1
  v_pk_add_f32 v[72:73], v[72:73], v[80:81]
  v_pk_add_f32 v[74:75], v[74:75], v[82:83]
  v_pk_add_f32 v[76:77], v[76:77], v[84:85]
  v_pk_add_f32 v[78:79], v[78:79], v[86:87]
  v_pk_add_f32 v[88:89], v[88:89], v[96:97]
  v_pk_add_f32 v[90:91], v[90:91], v[98:99]
  v_pk_add_f32 v[92:93], v[92:93], v[100:101]
  v_pk_add_f32 v[94:95], v[94:95], v[102:103]
  v_pk_add_f32 v[72:73], v[72:73], v[76:77]
  v_pk_add_f32 v[74:75], v[74:75], v[78:79]
  v_pk_add_f32 v[88:89], v[88:89], v[92:93]
  v_pk_add_f32 v[90:91], v[90:91], v[94:95]
  v_cvt_pk_bf16_f32 v80, v72, v73
  v_lshlrev_b32 v72, 16, v80
  v_and_b32 v73, 0xffff0000, v80
  v_cvt_pk_bf16_f32 v81, v74, v75
  v_lshlrev_b32 v74, 16, v81
  v_and_b32 v75, 0xffff0000, v81
  v_cvt_pk_bf16_f32 v82, v88, v89
  v_lshlrev_b32 v88, 16, v82
  v_and_b32 v89, 0xffff0000, v82
  v_cvt_pk_bf16_f32 v83, v90, v91
  v_lshlrev_b32 v90, 16, v83
  v_and_b32 v91, 0xffff0000, v83
  ds_write_b128 v3, v[72:75]
  v_add_f32 v88, 1.0, v88
  v_add_f32 v89, 1.0, v89
  v_add_f32 v90, 1.0, v90
  v_add_f32 v91, 1.0, v91
  v_cvt_pk_bf16_f32 v80, v88, v89
  v_lshlrev_b32 v88, 16, v80
  v_and_b32 v89, 0xffff0000, v80
  v_cvt_pk_bf16_f32 v81, v90, v91
  v_lshlrev_b32 v90, 16, v81
  v_and_b32 v91, 0xffff0000, v81
  ds_write_b128 v3, v[88:91] offset:1024
  ds_read_b128 v[132:135], v4 offset:0
  ds_read_b128 v[164:167], v4 offset:1024
  ds_read_b128 v[136:139], v4 offset:16
  ds_read_b128 v[168:171], v4 offset:1040
  ds_read_b128 v[140:143], v4 offset:256
  ds_read_b128 v[172:175], v4 offset:1280
  ds_read_b128 v[144:147], v4 offset:272
  ds_read_b128 v[176:179], v4 offset:1296
  ds_read_b128 v[148:151], v4 offset:512
  ds_read_b128 v[180:183], v4 offset:1536
  ds_read_b128 v[152:155], v4 offset:528
  ds_read_b128 v[184:187], v4 offset:1552
  s_waitcnt lgkmcnt(8)
  ds_read_b128 v[156:159], v4 offset:768
  ds_read_b128 v[188:191], v4 offset:1792
  ds_read_b128 v[160:163], v4 offset:784
  ds_read_b128 v[192:195], v4 offset:1808
  s_waitcnt lgkmcnt(12)
  v_pk_fma_f32 v[24:25], v[24:25], v[164:165], v[132:133]
  v_pk_fma_f32 v[26:27], v[26:27], v[166:167], v[134:135]
  v_pk_fma_f32 v[28:29], v[28:29], v[168:169], v[136:137]
  v_pk_fma_f32 v[30:31], v[30:31], v[170:171], v[138:139]
  v_cvt_pk_bf16_f32 v8, v24, v25
  v_cvt_pk_bf16_f32 v9, v26, v27
  v_cvt_pk_bf16_f32 v10, v28, v29
  v_cvt_pk_bf16_f32 v11, v30, v31
  buffer_store_dwordx4 v[8:11], v5, s[4:7], s56 offen sc1
  s_waitcnt lgkmcnt(8)
  v_pk_fma_f32 v[32:33], v[32:33], v[172:173], v[140:141]
  v_pk_fma_f32 v[34:35], v[34:35], v[174:175], v[142:143]
  v_pk_fma_f32 v[36:37], v[36:37], v[176:177], v[144:145]
  v_pk_fma_f32 v[38:39], v[38:39], v[178:179], v[146:147]
  v_cvt_pk_bf16_f32 v12, v32, v33
  v_cvt_pk_bf16_f32 v13, v34, v35
  v_cvt_pk_bf16_f32 v14, v36, v37
  v_cvt_pk_bf16_f32 v15, v38, v39
  buffer_store_dwordx4 v[12:15], v5, s[4:7], s57 offen sc1
  s_waitcnt lgkmcnt(4)
  v_pk_fma_f32 v[40:41], v[40:41], v[180:181], v[148:149]
  v_pk_fma_f32 v[42:43], v[42:43], v[182:183], v[150:151]
  v_pk_fma_f32 v[44:45], v[44:45], v[184:185], v[152:153]
  v_pk_fma_f32 v[46:47], v[46:47], v[186:187], v[154:155]
  v_cvt_pk_bf16_f32 v16, v40, v41
  v_cvt_pk_bf16_f32 v17, v42, v43
  v_cvt_pk_bf16_f32 v18, v44, v45
  v_cvt_pk_bf16_f32 v19, v46, v47
  buffer_store_dwordx4 v[16:19], v5, s[4:7], s58 offen sc1
  s_waitcnt lgkmcnt(0)
  v_pk_fma_f32 v[48:49], v[48:49], v[188:189], v[156:157]
  v_pk_fma_f32 v[50:51], v[50:51], v[190:191], v[158:159]
  v_pk_fma_f32 v[52:53], v[52:53], v[192:193], v[160:161]
  v_pk_fma_f32 v[54:55], v[54:55], v[194:195], v[162:163]
  v_cvt_pk_bf16_f32 v20, v48, v49
  v_cvt_pk_bf16_f32 v21, v50, v51
  v_cvt_pk_bf16_f32 v22, v52, v53
  v_cvt_pk_bf16_f32 v23, v54, v55
  buffer_store_dwordx4 v[20:23], v5, s[4:7], s59 offen sc1
  v_mov_b32 v7, s19
  v_lshlrev_b32 v6, 2, v104
  s_waitcnt vmcnt(0)
  s_mov_b64 exec, 1
  buffer_store_dword v7, v6, s[64:67], s37 offen sc1
  s_mov_b64 exec, -1
  s_barrier
  s_add_u32 m0, s38, 13312
  s_nop 0
  buffer_load_dwordx4 v107, s[8:11], s17 offen lds
  buffer_load_dwordx4 v108, s[8:11], s17 offen offset:1024 lds
  buffer_load_dwordx4 v109, s[8:11], s17 offen offset:2048 lds
  s_add_u32 s17, s17, 196608
  s_cmp_eq_u32 s17, s10
  s_cselect_b32 s17, 0, s17
  s_add_u32 m0, s38, 26624
  s_nop 0
  buffer_load_dwordx4 v107, s[8:11], s17 offen lds
  buffer_load_dwordx4 v108, s[8:11], s17 offen offset:1024 lds
  buffer_load_dwordx4 v109, s[8:11], s17 offen offset:2048 lds
  s_add_u32 s17, s17, 196608
  s_cmp_eq_u32 s17, s10
  s_cselect_b32 s17, 0, s17
  s_add_u32 m0, s38, 39936
  s_nop 0
  buffer_load_dwordx4 v107, s[8:11], s17 offen lds
  buffer_load_dwordx4 v108, s[8:11], s17 offen offset:1024 lds
  buffer_load_dwordx4 v109, s[8:11], s17 offen offset:2048 lds
  s_add_u32 s17, s17, 196608
  s_cmp_eq_u32 s17, s10
  s_cselect_b32 s17, 0, s17
  s_add_u32 m0, s38, 53248
  s_nop 0
  buffer_load_dwordx4 v107, s[8:11], s17 offen lds
  buffer_load_dwordx4 v108, s[8:11], s17 offen offset:1024 lds
  buffer_load_dwordx4 v109, s[8:11], s17 offen offset:2048 lds
  s_add_u32 s17, s17, 196608
  s_cmp_eq_u32 s17, s10
  s_cselect_b32 s17, 0, s17
  s_add_u32 m0, s38, 66560
  s_nop 0
  buffer_load_dwordx4 v107, s[8:11], s17 offen lds
  buffer_load_dwordx4 v108, s[8:11], s17 offen offset:1024 lds
  buffer_load_dwordx4 v109, s[8:11], s17 offen offset:2048 lds
  s_add_u32 s17, s17, 196608
  s_cmp_eq_u32 s17, s10
  s_cselect_b32 s17, 0, s17
  s_add_u32 m0, s38, 79872
  s_nop 0
  buffer_load_dwordx4 v107, s[8:11], s17 offen lds
  buffer_load_dwordx4 v108, s[8:11], s17 offen offset:1024 lds
  buffer_load_dwordx4 v109, s[8:11], s17 offen offset:2048 lds
  s_add_u32 s17, s17, 196608
  s_cmp_eq_u32 s17, s10
  s_cselect_b32 s17, 0, s17
L_slow_6:
  s_mov_b32 s33, 262144
L_spin_8:
  buffer_load_dword v127, v128, s[64:67], 0 offen sc1
  s_waitcnt vmcnt(0)
  v_cmp_ne_u32 vcc, s19, v127
  s_nop 1
  s_cmp_eq_u64 vcc, 0
  s_cbranch_scc1 L_back_7
  s_sub_u32 s33, s33, 1
  s_cmp_lg_u32 s33, 0
  s_cbranch_scc1 L_spin_8
  s_branch L_back_7
L_back_7:
L_gemm_a:
  s_mov_b32 s6, 1048576
  s_add_u32 m0, s39, 0
  s_nop 0
  buffer_load_dword v106, s[4:7], s16 offen sc1 lds
  buffer_load_dwordx4 a[0:3], v105, s[4:7], s16 offen sc1
  buffer_load_dwordx4 a[4:7], v105, s[4:7], s16 offen offset:1024 sc1
  s_add_u32 s16, s16, 131072
  s_bitset0_b32 s16, 20
  s_add_u32 m0, s39, 13312
  s_nop 0
  buffer_load_dword v106, s[4:7], s16 offen sc1 lds
  buffer_load_dwordx4 a[8:11], v105, s[4:7], s16 offen sc1
  buffer_load_dwordx4 a[12:15], v105, s[4:7], s16 offen offset:1024 sc1
  s_add_u32 s16, s16, 131072
  s_bitset0_b32 s16, 20
  s_add_u32 m0, s39, 26624
  s_nop 0
  buffer_load_dword v106, s[4:7], s16 offen sc1 lds
  buffer_load_dwordx4 a[16:19], v105, s[4:7], s16 offen sc1
  buffer_load_dwordx4 a[20:23], v105, s[4:7], s16 offen offset:1024 sc1
  s_add_u32 s16, s16, 131072
  s_bitset0_b32 s16, 20
  s_bitcmp1_b32 s3, 0
  s_cselect_b32 s56, s62, s60
  s_cselect_b32 s57, s63, s61
  s_mov_b32 s58, 7340032
  s_mov_b32 s59, 0x20000
  s_lshl_b32 s97, s2, 1
  s_lshr_b32 s33, s3, 1
  s_add_u32 s97, s97, s33
  s_lshl_b32 s97, s97, 10
  v_lshrrev_b32 v110, 3, v104
  v_min_u32 v130, 2, v110
  v_lshlrev_b32 v130, 19, v130
  v_and_b32 v112, 7, v104
  v_lshl_add_u32 v130, v112, 7, v130
  s_bfe_u32 s36, s2, 0x20001
  s_lshl_b32 s36, s36, 2
  s_bfe_u32 s33, s2, 0x20003
  s_add_u32 s36, s36, s33
  s_lshr_b32 s37, s2, 5
  s_lshl_b32 s37, s37, 1
  s_and_b32 s33, s2, 1
  s_add_u32 s37, s37, s33
  s_and_b32 s33, s36, 3
  s_lshl_b32 s98, s33, 19
  v_and_b32 v111, 6, v110
  v_and_b32 v112, 7, v104
  v_xor_b32 v111, v111, v112
  v_lshlrev_b32 v110, 11, v110
  v_lshl_add_u32 v110, v111, 4, v110
  s_lshl_b32 s32, s3, 15
  s_lshl_b32 s33, s37, 7
  s_add_u32 s32, s32, s33
  v_add_u32 v248, s32, v110
  v_add_u32 v249, 15360, v248
  v_mov_b32 v244, -1
  v_mov_b32 v245, -1
  v_mov_b32 v246, -1
  v_mov_b32 v247, -1
  s_add_u32 s92, s20, 0xe00000
  s_addc_u32 s93, s21, 0
  s_mov_b32 s94, 0x800000
  s_mov_b32 s95, 0x20000
  s_lshl_b32 s35, s2, 2
  s_add_u32 s35, s35, s3
  s_lshl_b32 s35, s35, 13
  v_lshrrev_b32 v254, 4, v104
  s_movk_i32 s33, 24576
  v_mul_u32_u24 v254, s33, v254
  v_and_b32 v110, 15, v104
  v_lshl_add_u32 v254, v110, 4, v254
  v_and_b32 v110, 15, v104
  v_lshlrev_b32 v128, 11, v110
  v_bfe_u32 v112, v104, 4, 1
  v_lshl_add_u32 v128, v112, 5, v128
  v_lshrrev_b32 v112, 5, v104
  v_lshl_add_u32 v128, v112, 4, v128
  s_lshl_b32 s32, s36, 18
  s_lshl_b32 s33, s3, 16
  s_add_u32 s32, s32, s33
  s_lshl_b32 s33, s37, 7
  s_add_u32 s32, s32, s33
  v_add_u32 v128, s32, v128
  s_waitcnt vmcnt(6)
  s_barrier
  ds_read_b64_tr_b16 v[180:181], v118 offset:1024
  ds_read_b64_tr_b16 v[182:183], v118 offset:1536
  ds_read_b128 v[188:191], v119 offset:12288
  ds_read_b64_tr_b16 v[184:185], v118 offset:2048
  ds_read_b64_tr_b16 v[186:187], v118 offset:2560
  ds_read_b64_tr_b16 v[132:133], v114 offset:0
  ds_read_b64_tr_b16 v[134:135], v114 offset:512
  ds_read_b64_tr_b16 v[136:137], v115 offset:0
  ds_read_b64_tr_b16 v[138:139], v115 offset:512
  ds_read_b64_tr_b16 v[140:141], v116 offset:0
  ds_read_b64_tr_b16 v[142:143], v116 offset:512
  ds_read_b64_tr_b16 v[144:145], v117 offset:0
  ds_read_b64_tr_b16 v[146:147], v117 offset:512
  ds_read_b64_tr_b16 v[148:149], v114 offset:1024
  ds_read_b64_tr_b16 v[150:151], v114 offset:1536
  ds_read_b64_tr_b16 v[152:153], v115 offset:1024
  ds_read_b64_tr_b16 v[154:155], v115 offset:1536
  ds_read_b64_tr_b16 v[156:157], v116 offset:1024
  ds_read_b64_tr_b16 v[158:159], v116 offset:1536
  ds_read_b64_tr_b16 v[160:161], v117 offset:1024
  ds_read_b64_tr_b16 v[162:163], v117 offset:1536
  ds_read_b64_tr_b16 v[164:165], v114 offset:2048
  ds_read_b64_tr_b16 v[166:167], v114 offset:2560
  ds_read_b64_tr_b16 v[168:169], v115 offset:2048
  ds_read_b64_tr_b16 v[170:171], v115 offset:2560
  ds_read_b64_tr_b16 v[172:173], v116 offset:2048
  ds_read_b64_tr_b16 v[174:175], v116 offset:2560
  ds_read_b64_tr_b16 v[176:177], v117 offset:2048
  ds_read_b64_tr_b16 v[178:179], v117 offset:2560
  s_waitcnt vmcnt(3) lgkmcnt(10)
  s_barrier
  v_mfma_f32_16x16x32_bf16 v[96:99], v[180:183], v[188:191], 0
  ds_read_b64_tr_b16 v[180:181], v118 offset:14336
  s_add_u32 m0, s39, 39936
  v_mfma_f32_16x16x32_bf16 v[100:103], v[188:191], v[184:187], 0
  buffer_load_dword v106, s[4:7], s16 offen sc1 lds
  v_mfma_f32_16x16x32_bf16 v[0:3], v[132:135], a[0:3], 0
  buffer_load_dwordx4 a[24:27], v105, s[4:7], s16 offen sc1
  v_mfma_f32_16x16x32_bf16 v[48:51], v[132:135], a[4:7], 0
  ds_read_b64_tr_b16 v[182:183], v118 offset:14848
  buffer_load_dwordx4 a[28:31], v105, s[4:7], s16 offen offset:1024 sc1
  v_mfma_f32_16x16x32_bf16 v[4:7], v[136:139], a[0:3], 0
  ds_read_b128 v[188:191], v119 offset:25600
  ds_read_b64_tr_b16 v[184:185], v118 offset:15360
  ds_read_b64_tr_b16 v[186:187], v118 offset:15872
  s_add_u32 s16, s16, 131072
  v_mfma_f32_16x16x32_bf16 v[52:55], v[136:139], a[4:7], 0
  ds_read_b64_tr_b16 v[132:133], v114 offset:13312
  s_bitset0_b32 s16, 20
  v_mfma_f32_16x16x32_bf16 v[8:11], v[140:143], a[0:3], 0
  ds_read_b64_tr_b16 v[134:135], v114 offset:13824
  s_add_u32 m0, s39, 53248
  v_mfma_f32_16x16x32_bf16 v[56:59], v[140:143], a[4:7], 0
  buffer_load_dword v106, s[4:7], s16 offen sc1 lds
  v_mfma_f32_16x16x32_bf16 v[12:15], v[144:147], a[0:3], 0
  ds_read_b64_tr_b16 v[136:137], v115 offset:13312
  ds_read_b64_tr_b16 v[138:139], v115 offset:13824
  buffer_load_dwordx4 a[32:35], v105, s[4:7], s16 offen sc1
  v_mfma_f32_16x16x32_bf16 v[60:63], v[144:147], a[4:7], 0
  buffer_load_dwordx4 a[36:39], v105, s[4:7], s16 offen offset:1024 sc1
  v_mfma_f32_16x16x32_bf16 v[16:19], v[148:151], a[0:3], 0
  ds_read_b64_tr_b16 v[140:141], v116 offset:13312
  ds_read_b64_tr_b16 v[142:143], v116 offset:13824
  s_add_u32 s16, s16, 131072
  v_mfma_f32_16x16x32_bf16 v[64:67], v[148:151], a[4:7], 0
  ds_read_b64_tr_b16 v[144:145], v117 offset:13312
  s_bitset0_b32 s16, 20
  v_mfma_f32_16x16x32_bf16 v[20:23], v[152:155], a[0:3], 0
  ds_read_b64_tr_b16 v[146:147], v117 offset:13824
  s_add_u32 m0, s39, 66560
  v_mfma_f32_16x16x32_bf16 v[68:71], v[152:155], a[4:7], 0
  buffer_load_dword v106, s[4:7], s16 offen sc1 lds
  v_mfma_f32_16x16x32_bf16 v[24:27], v[156:159], a[0:3], 0
  ds_read_b64_tr_b16 v[148:149], v114 offset:14336
  ds_read_b64_tr_b16 v[150:151], v114 offset:14848
  buffer_load_dwordx4 a[40:43], v105, s[4:7], s16 offen sc1
  v_mfma_f32_16x16x32_bf16 v[72:75], v[156:159], a[4:7], 0
  buffer_load_dwordx4 a[44:47], v105, s[4:7], s16 offen offset:1024 sc1
  s_waitcnt lgkmcnt(10)
  v_mfma_f32_16x16x32_bf16 v[28:31], v[160:163], a[0:3], 0
  ds_read_b64_tr_b16 v[152:153], v115 offset:14336
  ds_read_b64_tr_b16 v[154:155], v115 offset:14848
  s_add_u32 s16, s16, 131072
  v_mfma_f32_16x16x32_bf16 v[76:79], v[160:163], a[4:7], 0
  ds_read_b64_tr_b16 v[156:157], v116 offset:14336
  s_bitset0_b32 s16, 20
  v_mfma_f32_16x16x32_bf16 v[32:35], a[0:3], v[164:167], 0
  ds_read_b64_tr_b16 v[158:159], v116 offset:14848
  s_add_u32 m0, s39, 79872
  v_mfma_f32_16x16x32_bf16 v[80:83], a[4:7], v[164:167], 0
  buffer_load_dword v106, s[4:7], s16 offen sc1 lds
  v_mfma_f32_16x16x32_bf16 v[36:39], a[0:3], v[168:171], 0
  ds_read_b64_tr_b16 v[160:161], v117 offset:14336
  ds_read_b64_tr_b16 v[162:163], v117 offset:14848
  buffer_load_dwordx4 a[48:51], v105, s[4:7], s16 offen sc1
  v_mfma_f32_16x16x32_bf16 v[84:87], a[4:7], v[168:171], 0
  buffer_load_dwordx4 a[52:55], v105, s[4:7], s16 offen offset:1024 sc1
  v_mfma_f32_16x16x32_bf16 v[40:43], a[0:3], v[172:175], 0
  ds_read_b64_tr_b16 v[164:165], v114 offset:15360
  ds_read_b64_tr_b16 v[166:167], v114 offset:15872
  s_add_u32 s16, s16, 131072
  v_mfma_f32_16x16x32_bf16 v[88:91], a[4:7], v[172:175], 0
  ds_read_b64_tr_b16 v[168:169], v115 offset:15360
  s_bitset0_b32 s16, 20
  v_mfma_f32_16x16x32_bf16 v[44:47], a[0:3], v[176:179], 0
  ds_read_b64_tr_b16 v[170:171], v115 offset:15872
  ds_read_b64_tr_b16 v[172:173], v116 offset:15360
  v_mfma_f32_16x16x32_bf16 v[92:95], a[4:7], v[176:179], 0
  s_waitcnt vmcnt(12) lgkmcnt(10)
  s_barrier
  v_mfma_f32_16x16x32_bf16 v[96:99], v[180:183], v[188:191], v[96:99]
  ds_read_b64_tr_b16 v[174:175], v116 offset:15872
  s_add_u32 m0, s38, 93184
  v_mfma_f32_16x16x32_bf16 v[100:103], v[188:191], v[184:187], v[100:103]
  buffer_load_dwordx4 v107, s[8:11], s17 offen lds
  v_mfma_f32_16x16x32_bf16 v[0:3], v[132:135], a[8:11], v[0:3]
  ds_read_b64_tr_b16 v[176:177], v117 offset:15360
  ds_read_b64_tr_b16 v[178:179], v117 offset:15872
  v_mfma_f32_16x16x32_bf16 v[48:51], v[132:135], a[12:15], v[48:51]
  ds_read_b64_tr_b16 v[180:181], v118 offset:27648
  ds_read_b64_tr_b16 v[182:183], v118 offset:28160
  buffer_load_dword v127, v126, s[64:67], 0 offen sc1
  v_mfma_f32_16x16x32_bf16 v[4:7], v[136:139], a[8:11], v[4:7]
  ds_read_b128 v[188:191], v119 offset:38912
  ds_read_b64_tr_b16 v[184:185], v118 offset:28672
  ds_read_b64_tr_b16 v[186:187], v118 offset:29184
  buffer_load_dwordx4 v108, s[8:11], s17 offen offset:1024 lds
  v_mfma_f32_16x16x32_bf16 v[52:55], v[136:139], a[12:15], v[52:55]
  buffer_load_dwordx4 v109, s[8:11], s17 offen offset:2048 lds
  v_mfma_f32_16x16x32_bf16 v[8:11], v[140:143], a[8:11], v[8:11]
  ds_read_b64_tr_b16 v[132:133], v114 offset:26624
  ds_read_b64_tr_b16 v[134:135], v114 offset:27136
  v_mfma_f32_16x16x32_bf16 v[56:59], v[140:143], a[12:15], v[56:59]
  ds_read_b64_tr_b16 v[136:137], v115 offset:26624
  s_add_u32 s17, s17, 196608
  v_mfma_f32_16x16x32_bf16 v[12:15], v[144:147], a[8:11], v[12:15]
  ds_read_b64_tr_b16 v[138:139], v115 offset:27136
  s_cmp_eq_u32 s17, s10
  s_cselect_b32 s17, 0, s17
  v_mfma_f32_16x16x32_bf16 v[60:63], v[144:147], a[12:15], v[60:63]
  ds_read_b64_tr_b16 v[140:141], v116 offset:26624
  ds_read_b64_tr_b16 v[142:143], v116 offset:27136
  v_mfma_f32_16x16x32_bf16 v[16:19], v[148:151], a[8:11], v[16:19]
  s_add_u32 s8, s8, s10
  s_addc_u32 s9, s9, 0
  v_mfma_f32_16x16x32_bf16 v[64:67], v[148:151], a[12:15], v[64:67]
  ds_read_b64_tr_b16 v[144:145], v117 offset:26624
  ds_read_b64_tr_b16 v[146:147], v117 offset:27136
  s_waitcnt lgkmcnt(10)
  v_mfma_f32_16x16x32_bf16 v[20:23], v[152:155], a[8:11], v[20:23]
  ds_read_b64_tr_b16 v[148:149], v114 offset:27648
  s_add_u32 m0, s39, 93184
  v_mfma_f32_16x16x32_bf16 v[68:71], v[152:155], a[12:15], v[68:71]
  s_add_u32 s40, s20, 0x40000
  s_addc_u32 s41, s21, 0
  s_mov_b32 s42, 0x0
  s_mov_b32 s43, 0x20000
  s_or_b32 s33, s2, s3
  s_cmp_eq_u32 s33, 0
  s_cselect_b32 s42, 4, 0
  v_mov_b32 v192, s19
  buffer_store_dword v192, v119, s[40:43], 0 offen sc1
  v_mfma_f32_16x16x32_bf16 v[24:27], v[156:159], a[8:11], v[24:27]
  ds_read_b64_tr_b16 v[150:151], v114 offset:28160
  buffer_load_dword v106, s[4:7], s16 offen sc1 lds
  v_mfma_f32_16x16x32_bf16 v[72:75], v[156:159], a[12:15], v[72:75]
  ds_read_b64_tr_b16 v[152:153], v115 offset:27648
  ds_read_b64_tr_b16 v[154:155], v115 offset:28160
  v_mfma_f32_16x16x32_bf16 v[28:31], v[160:163], a[8:11], v[28:31]
  buffer_load_dwordx4 a[56:59], v105, s[4:7], s16 offen sc1
  v_mfma_f32_16x16x32_bf16 v[76:79], v[160:163], a[12:15], v[76:79]
  buffer_load_dwordx4 a[60:63], v105, s[4:7], s16 offen offset:1024 sc1
  v_mfma_f32_16x16x32_bf16 v[32:35], a[8:11], v[164:167], v[32:35]
  ds_read_b64_tr_b16 v[156:157], v116 offset:27648
  ds_read_b64_tr_b16 v[158:159], v116 offset:28160
  v_mfma_f32_16x16x32_bf16 v[80:83], a[12:15], v[164:167], v[80:83]
  ds_read_b64_tr_b16 v[160:161], v117 offset:27648
  s_add_u32 s16, s16, 131072
  v_mfma_f32_16x16x32_bf16 v[36:39], a[8:11], v[168:171], v[36:39]
  ds_read_b64_tr_b16 v[162:163], v117 offset:28160
  ds_read_b64_tr_b16 v[164:165], v114 offset:28672
  v_mfma_f32_16x16x32_bf16 v[84:87], a[12:15], v[168:171], v[84:87]
  ds_read_b64_tr_b16 v[166:167], v114 offset:29184
  s_bitset0_b32 s16, 20
  v_mfma_f32_16x16x32_bf16 v[40:43], a[8:11], v[172:175], v[40:43]
  ds_read_b64_tr_b16 v[168:169], v115 offset:28672
  ds_read_b64_tr_b16 v[170:171], v115 offset:29184
  v_mfma_f32_16x16x32_bf16 v[88:91], a[12:15], v[172:175], v[88:91]
  s_add_u32 s4, s4, s6
  s_addc_u32 s5, s5, 0
  v_mfma_f32_16x16x32_bf16 v[44:47], a[8:11], v[176:179], v[44:47]
  ds_read_b64_tr_b16 v[172:173], v116 offset:28672
  ds_read_b64_tr_b16 v[174:175], v116 offset:29184
  v_mfma_f32_16x16x32_bf16 v[92:95], a[12:15], v[176:179], v[92:95]
  s_waitcnt vmcnt(6) lgkmcnt(10)
  s_barrier
  v_cmp_ne_u32 vcc, s19, v127
  s_nop 1
  s_cmp_lg_u64 vcc, 0
  s_cbranch_scc1 L_slow_9
  L_back_10:
  v_mfma_f32_16x16x32_bf16 v[96:99], v[180:183], v[188:191], v[96:99]
  s_add_u32 m0, s39, 0
  s_nop 0
  buffer_load_dword v106, s[4:7], s16 offen sc1 lds
  v_mfma_f32_16x16x32_bf16 v[100:103], v[188:191], v[184:187], v[100:103]
  buffer_load_dwordx4 a[0:3], v105, s[4:7], s16 offen sc1
  v_mfma_f32_16x16x32_bf16 v[0:3], v[132:135], a[16:19], v[0:3]
  ds_read_b64_tr_b16 v[176:177], v117 offset:28672
  ds_read_b64_tr_b16 v[178:179], v117 offset:29184
  buffer_load_dwordx4 a[4:7], v105, s[4:7], s16 offen offset:1024 sc1
  v_mfma_f32_16x16x32_bf16 v[48:51], v[132:135], a[20:23], v[48:51]
  ds_read_b64_tr_b16 v[180:181], v118 offset:40960
  ds_read_b64_tr_b16 v[182:183], v118 offset:41472
  s_add_u32 s16, s16, 131072
  v_mfma_f32_16x16x32_bf16 v[4:7], v[136:139], a[16:19], v[4:7]
  ds_read_b128 v[188:191], v119 offset:52224
  ds_read_b64_tr_b16 v[184:185], v118 offset:41984
  ds_read_b64_tr_b16 v[186:187], v118 offset:42496
  s_bitset0_b32 s16, 20
  v_mfma_f32_16x16x32_bf16 v[52:55], v[136:139], a[20:23], v[52:55]
  ds_read_b64_tr_b16 v[132:133], v114 offset:39936
  s_add_u32 m0, s38, 0
  v_mfma_f32_16x16x32_bf16 v[8:11], v[140:143], a[16:19], v[8:11]
  ds_read_b64_tr_b16 v[134:135], v114 offset:40448
  buffer_load_dwordx4 v107, s[8:11], s17 offen lds
  buffer_load_dwordx4 v108, s[8:11], s17 offen offset:1024 lds
  v_mfma_f32_16x16x32_bf16 v[56:59], v[140:143], a[20:23], v[56:59]
  buffer_load_dwordx4 v109, s[8:11], s17 offen offset:2048 lds
  v_mfma_f32_16x16x32_bf16 v[12:15], v[144:147], a[16:19], v[12:15]
  ds_read_b64_tr_b16 v[136:137], v115 offset:39936
  ds_read_b64_tr_b16 v[138:139], v115 offset:40448
  s_add_u32 s17, s17, 196608
  v_mfma_f32_16x16x32_bf16 v[60:63], v[144:147], a[20:23], v[60:63]
  ds_read_b64_tr_b16 v[140:141], v116 offset:39936
  s_cmp_eq_u32 s17, s10
  v_mfma_f32_16x16x32_bf16 v[16:19], v[148:151], a[16:19], v[16:19]
  ds_read_b64_tr_b16 v[142:143], v116 offset:40448
  s_cselect_b32 s17, 0, s17
  v_mfma_f32_16x16x32_bf16 v[64:67], v[148:151], a[20:23], v[64:67]
  ds_read_b64_tr_b16 v[144:145], v117 offset:39936
  s_mov_b32 m0, s51
  v_mfma_f32_16x16x32_bf16 v[20:23], v[152:155], a[16:19], v[20:23]
  ds_read_b64_tr_b16 v[146:147], v117 offset:40448
  s_add_u32 s51, s51, 1024
  buffer_load_dwordx4 v129, s[52:55], s50 offen nt lds
  v_mfma_f32_16x16x32_bf16 v[68:71], v[152:155], a[20:23], v[68:71]
  ds_read_b64_tr_b16 v[148:149], v114 offset:40960
  s_add_u32 s50, s50, 98304
  s_waitcnt lgkmcnt(10)
  v_mfma_f32_16x16x32_bf16 v[24:27], v[156:159], a[16:19], v[24:27]
  ds_read_b64_tr_b16 v[150:151], v114 offset:41472
  s_mov_b32 m0, s51
  v_mfma_f32_16x16x32_bf16 v[72:75], v[156:159], a[20:23], v[72:75]
  ds_read_b64_tr_b16 v[152:153], v115 offset:40960
  s_add_u32 s51, s51, 1024
  v_mfma_f32_16x16x32_bf16 v[28:31], v[160:163], a[16:19], v[28:31]
  ds_read_b64_tr_b16 v[154:155], v115 offset:41472
  buffer_load_dwordx4 v129, s[52:55], s50 offen nt lds
  v_mfma_f32_16x16x32_bf16 v[76:79], v[160:163], a[20:23], v[76:79]
  ds_read_b64_tr_b16 v[156:157], v116 offset:40960
  s_add_u32 s50, s50, 98304
  v_mfma_f32_16x16x32_bf16 v[32:35], a[16:19], v[164:167], v[32:35]
  ds_read_b64_tr_b16 v[158:159], v116 offset:41472
  s_mov_b32 m0, s51
  s_add_u32 s51, s51, 1024
  v_mfma_f32_16x16x32_bf16 v[80:83], a[20:23], v[164:167], v[80:83]
  buffer_load_dwordx4 v129, s[52:55], s50 offen nt lds
  v_mfma_f32_16x16x32_bf16 v[36:39], a[16:19], v[168:171], v[36:39]
  ds_read_b64_tr_b16 v[160:161], v117 offset:40960
  ds_read_b64_tr_b16 v[162:163], v117 offset:41472
  s_add_u32 s50, s50, 98304
  v_mfma_f32_16x16x32_bf16 v[84:87], a[20:23], v[168:171], v[84:87]
  ds_read_b64_tr_b16 v[164:165], v114 offset:41984
  s_mov_b32 m0, s51
  v_mfma_f32_16x16x32_bf16 v[40:43], a[16:19], v[172:175], v[40:43]
  ds_read_b64_tr_b16 v[166:167], v114 offset:42496
  s_add_u32 s51, s51, 1024
  v_mfma_f32_16x16x32_bf16 v[88:91], a[20:23], v[172:175], v[88:91]
  buffer_load_dwordx4 v129, s[52:55], s50 offen nt lds
  v_mfma_f32_16x16x32_bf16 v[44:47], a[16:19], v[176:179], v[44:47]
  ds_read_b64_tr_b16 v[168:169], v115 offset:41984
  ds_read_b64_tr_b16 v[170:171], v115 offset:42496
  s_add_u32 s50, s50, 98304
  v_mfma_f32_16x16x32_bf16 v[92:95], a[20:23], v[176:179], v[92:95]
  s_waitcnt vmcnt(24) lgkmcnt(10)
  s_barrier
  v_mfma_f32_16x16x32_bf16 v[96:99], v[180:183], v[188:191], v[96:99]
  ds_read_b64_tr_b16 v[172:173], v116 offset:41984
  ds_read_b64_tr_b16 v[174:175], v116 offset:42496
  v_mfma_f32_16x16x32_bf16 v[100:103], v[188:191], v[184:187], v[100:103]
  ds_read_b64_tr_b16 v[176:177], v117 offset:41984
  ds_read_b64_tr_b16 v[178:179], v117 offset:42496
  v_mfma_f32_16x16x32_bf16 v[0:3], v[132:135], a[24:27], v[0:3]
  ds_read_b64_tr_b16 v[180:181], v124 offset:1024
  ds_read_b64_tr_b16 v[182:183], v124 offset:1536
  v_mfma_f32_16x16x32_bf16 v[48:51], v[132:135], a[28:31], v[48:51]
  ds_read_b128 v[188:191], v125 offset:12288
  ds_read_b64_tr_b16 v[184:185], v124 offset:2048
  v_mfma_f32_16x16x32_bf16 v[4:7], v[136:139], a[24:27], v[4:7]
  ds_read_b64_tr_b16 v[186:187], v124 offset:2560
  ds_read_b64_tr_b16 v[132:133], v120 offset:0
  v_mfma_f32_16x16x32_bf16 v[52:55], v[136:139], a[28:31], v[52:55]
  ds_read_b64_tr_b16 v[134:135], v120 offset:512
  ds_read_b64_tr_b16 v[136:137], v121 offset:0
  v_mfma_f32_16x16x32_bf16 v[8:11], v[140:143], a[24:27], v[8:11]
  ds_read_b64_tr_b16 v[138:139], v121 offset:512
  v_mfma_f32_16x16x32_bf16 v[56:59], v[140:143], a[28:31], v[56:59]
  ds_read_b64_tr_b16 v[140:141], v122 offset:0
  ds_read_b64_tr_b16 v[142:143], v122 offset:512
  v_mfma_f32_16x16x32_bf16 v[12:15], v[144:147], a[24:27], v[12:15]
  v_mfma_f32_16x16x32_bf16 v[60:63], v[144:147], a[28:31], v[60:63]
  ds_read_b64_tr_b16 v[144:145], v123 offset:0
  ds_read_b64_tr_b16 v[146:147], v123 offset:512
  v_mfma_f32_16x16x32_bf16 v[16:19], v[148:151], a[24:27], v[16:19]
  v_mfma_f32_16x16x32_bf16 v[64:67], v[148:151], a[28:31], v[64:67]
  ds_read_b64_tr_b16 v[148:149], v120 offset:1024
  ds_read_b64_tr_b16 v[150:151], v120 offset:1536
  s_waitcnt lgkmcnt(10)
  v_mfma_f32_16x16x32_bf16 v[20:23], v[152:155], a[24:27], v[20:23]
  v_mfma_f32_16x16x32_bf16 v[68:71], v[152:155], a[28:31], v[68:71]
  ds_read_b64_tr_b16 v[152:153], v121 offset:1024
  ds_read_b64_tr_b16 v[154:155], v121 offset:1536
  v_mfma_f32_16x16x32_bf16 v[24:27], v[156:159], a[24:27], v[24:27]
  v_mfma_f32_16x16x32_bf16 v[72:75], v[156:159], a[28:31], v[72:75]
  ds_read_b64_tr_b16 v[156:157], v122 offset:1024
  ds_read_b64_tr_b16 v[158:159], v122 offset:1536
  v_mfma_f32_16x16x32_bf16 v[28:31], v[160:163], a[24:27], v[28:31]
  v_mfma_f32_16x16x32_bf16 v[76:79], v[160:163], a[28:31], v[76:79]
  ds_read_b64_tr_b16 v[160:161], v123 offset:1024
  ds_read_b64_tr_b16 v[162:163], v123 offset:1536
  v_mfma_f32_16x16x32_bf16 v[32:35], a[24:27], v[164:167], v[32:35]
  v_mfma_f32_16x16x32_bf16 v[80:83], a[28:31], v[164:167], v[80:83]
  ds_read_b64_tr_b16 v[164:165], v120 offset:2048
  ds_read_b64_tr_b16 v[166:167], v120 offset:2560
  v_mfma_f32_16x16x32_bf16 v[36:39], a[24:27], v[168:171], v[36:39]
  v_mfma_f32_16x16x32_bf16 v[84:87], a[28:31], v[168:171], v[84:87]
  ds_read_b64_tr_b16 v[168:169], v121 offset:2048
  ds_read_b64_tr_b16 v[170:171], v121 offset:2560
  v_mfma_f32_16x16x32_bf16 v[40:43], a[24:27], v[172:175], v[40:43]
  v_mfma_f32_16x16x32_bf16 v[88:91], a[28:31], v[172:175], v[88:91]
  ds_read_b64_tr_b16 v[172:173], v122 offset:2048
  ds_read_b64_tr_b16 v[174:175], v122 offset:2560
  v_mfma_f32_16x16x32_bf16 v[44:47], a[24:27], v[176:179], v[44:47]
  v_mfma_f32_16x16x32_bf16 v[92:95], a[28:31], v[176:179], v[92:95]
  s_waitcnt vmcnt(21) lgkmcnt(10)
  s_barrier
  v_mfma_f32_16x16x32_bf16 v[96:99], v[180:183], v[188:191], v[96:99]
  buffer_store_dwordx4 v[244:247], v119, s[92:95], s35 offen offset:0 sc1
  v_mfma_f32_16x16x32_bf16 v[100:103], v[188:191], v[184:187], v[100:103]
  ds_read_b64_tr_b16 v[176:177], v123 offset:2048
  ds_read_b64_tr_b16 v[178:179], v123 offset:2560
  v_mfma_f32_16x16x32_bf16 v[0:3], v[132:135], a[32:35], v[0:3]
  ds_read_b64_tr_b16 v[180:181], v124 offset:14336
  ds_read_b64_tr_b16 v[182:183], v124 offset:14848
  v_mfma_f32_16x16x32_bf16 v[48:51], v[132:135], a[36:39], v[48:51]
  ds_read_b128 v[188:191], v125 offset:25600
  ds_read_b64_tr_b16 v[184:185], v124 offset:15360
  v_mfma_f32_16x16x32_bf16 v[4:7], v[136:139], a[32:35], v[4:7]
  ds_read_b64_tr_b16 v[186:187], v124 offset:15872
  ds_read_b64_tr_b16 v[132:133], v120 offset:13312
  v_mfma_f32_16x16x32_bf16 v[52:55], v[136:139], a[36:39], v[52:55]
  ds_read_b64_tr_b16 v[134:135], v120 offset:13824
  ds_read_b64_tr_b16 v[136:137], v121 offset:13312
  v_mfma_f32_16x16x32_bf16 v[8:11], v[140:143], a[32:35], v[8:11]
  ds_read_b64_tr_b16 v[138:139], v121 offset:13824
  v_mfma_f32_16x16x32_bf16 v[56:59], v[140:143], a[36:39], v[56:59]
  ds_read_b64_tr_b16 v[140:141], v122 offset:13312
  ds_read_b64_tr_b16 v[142:143], v122 offset:13824
  v_mfma_f32_16x16x32_bf16 v[12:15], v[144:147], a[32:35], v[12:15]
  v_mfma_f32_16x16x32_bf16 v[60:63], v[144:147], a[36:39], v[60:63]
  ds_read_b64_tr_b16 v[144:145], v123 offset:13312
  ds_read_b64_tr_b16 v[146:147], v123 offset:13824
  v_mfma_f32_16x16x32_bf16 v[16:19], v[148:151], a[32:35], v[16:19]
  v_mfma_f32_16x16x32_bf16 v[64:67], v[148:151], a[36:39], v[64:67]
  ds_read_b64_tr_b16 v[148:149], v120 offset:14336
  ds_read_b64_tr_b16 v[150:151], v120 offset:14848
  v_mfma_f32_16x16x32_bf16 v[20:23], v[152:155], a[32:35], v[20:23]
  v_mfma_f32_16x16x32_bf16 v[68:71], v[152:155], a[36:39], v[68:71]
  ds_read_b64_tr_b16 v[152:153], v121 offset:14336
  ds_read_b64_tr_b16 v[154:155], v121 offset:14848
  s_waitcnt lgkmcnt(10)
  v_mfma_f32_16x16x32_bf16 v[24:27], v[156:159], a[32:35], v[24:27]
  v_mfma_f32_16x16x32_bf16 v[72:75], v[156:159], a[36:39], v[72:75]
  ds_read_b64_tr_b16 v[156:157], v122 offset:14336
  ds_read_b64_tr_b16 v[158:159], v122 offset:14848
  v_mfma_f32_16x16x32_bf16 v[28:31], v[160:163], a[32:35], v[28:31]
  v_mfma_f32_16x16x32_bf16 v[76:79], v[160:163], a[36:39], v[76:79]
  ds_read_b64_tr_b16 v[160:161], v123 offset:14336
  ds_read_b64_tr_b16 v[162:163], v123 offset:14848
  v_mfma_f32_16x16x32_bf16 v[32:35], a[32:35], v[164:167], v[32:35]
  v_mfma_f32_16x16x32_bf16 v[80:83], a[36:39], v[164:167], v[80:83]
  ds_read_b64_tr_b16 v[164:165], v120 offset:15360
  ds_read_b64_tr_b16 v[166:167], v120 offset:15872
  v_mfma_f32_16x16x32_bf16 v[36:39], a[32:35], v[168:171], v[36:39]
  v_mfma_f32_16x16x32_bf16 v[84:87], a[36:39], v[168:171], v[84:87]
  ds_read_b64_tr_b16 v[168:169], v121 offset:15360
  ds_read_b64_tr_b16 v[170:171], v121 offset:15872
  v_mfma_f32_16x16x32_bf16 v[40:43], a[32:35], v[172:175], v[40:43]
  v_mfma_f32_16x16x32_bf16 v[88:91], a[36:39], v[172:175], v[88:91]
  ds_read_b64_tr_b16 v[172:173], v122 offset:15360
  ds_read_b64_tr_b16 v[174:175], v122 offset:15872
  v_mfma_f32_16x16x32_bf16 v[44:47], a[32:35], v[176:179], v[44:47]
  v_mfma_f32_16x16x32_bf16 v[92:95], a[36:39], v[176:179], v[92:95]
  s_waitcnt vmcnt(19) lgkmcnt(10)
  s_barrier
  v_mfma_f32_16x16x32_bf16 v[96:99], v[180:183], v[188:191], v[96:99]
  ds_read_b64_tr_b16 v[176:177], v123 offset:15360
  s_add_u32 m0, s38, 13312
  v_mfma_f32_16x16x32_bf16 v[100:103], v[188:191], v[184:187], v[100:103]
  buffer_load_dwordx4 v107, s[8:11], s17 offen lds
  v_mfma_f32_16x16x32_bf16 v[0:3], v[132:135], a[40:43], v[0:3]
  ds_read_b64_tr_b16 v[178:179], v123 offset:15872
  buffer_load_dwordx4 v108, s[8:11], s17 offen offset:1024 lds
  v_mfma_f32_16x16x32_bf16 v[48:51], v[132:135], a[44:47], v[48:51]
  ds_read_b64_tr_b16 v[180:181], v124 offset:27648
  ds_read_b64_tr_b16 v[182:183], v124 offset:28160
  buffer_load_dwordx4 v109, s[8:11], s17 offen offset:2048 lds
  v_mfma_f32_16x16x32_bf16 v[4:7], v[136:139], a[40:43], v[4:7]
  ds_read_b128 v[188:191], v125 offset:38912
  ds_read_b64_tr_b16 v[184:185], v124 offset:28672
  ds_read_b64_tr_b16 v[186:187], v124 offset:29184
  v_mfma_f32_16x16x32_bf16 v[52:55], v[136:139], a[44:47], v[52:55]
  ds_read_b64_tr_b16 v[132:133], v120 offset:26624
  s_add_u32 s17, s17, 196608
  v_mfma_f32_16x16x32_bf16 v[8:11], v[140:143], a[40:43], v[8:11]
  ds_read_b64_tr_b16 v[134:135], v120 offset:27136
  s_cmp_eq_u32 s17, s10
  v_mfma_f32_16x16x32_bf16 v[56:59], v[140:143], a[44:47], v[56:59]
  ds_read_b64_tr_b16 v[136:137], v121 offset:26624
  s_cselect_b32 s17, 0, s17
  v_mfma_f32_16x16x32_bf16 v[12:15], v[144:147], a[40:43], v[12:15]
  ds_read_b64_tr_b16 v[138:139], v121 offset:27136
  s_add_u32 m0, s39, 13312
  v_mfma_f32_16x16x32_bf16 v[60:63], v[144:147], a[44:47], v[60:63]
  ds_read_b64_tr_b16 v[140:141], v122 offset:26624
  ds_read_b64_tr_b16 v[142:143], v122 offset:27136
  v_mfma_f32_16x16x32_bf16 v[16:19], v[148:151], a[40:43], v[16:19]
  buffer_load_dword v106, s[4:7], s16 offen sc1 lds
  v_mfma_f32_16x16x32_bf16 v[64:67], v[148:151], a[44:47], v[64:67]
  buffer_load_dwordx4 a[8:11], v105, s[4:7], s16 offen sc1
  v_mfma_f32_16x16x32_bf16 v[20:23], v[152:155], a[40:43], v[20:23]
  ds_read_b64_tr_b16 v[144:145], v123 offset:26624
  ds_read_b64_tr_b16 v[146:147], v123 offset:27136
  buffer_load_dwordx4 a[12:15], v105, s[4:7], s16 offen offset:1024 sc1
  v_mfma_f32_16x16x32_bf16 v[68:71], v[152:155], a[44:47], v[68:71]
  ds_read_b64_tr_b16 v[148:149], v120 offset:27648
  s_add_u32 s16, s16, 131072
  s_waitcnt lgkmcnt(10)
  v_mfma_f32_16x16x32_bf16 v[24:27], v[156:159], a[40:43], v[24:27]
  ds_read_b64_tr_b16 v[150:151], v120 offset:28160
  ds_read_b64_tr_b16 v[152:153], v121 offset:27648
  v_mfma_f32_16x16x32_bf16 v[72:75], v[156:159], a[44:47], v[72:75]
  ds_read_b64_tr_b16 v[154:155], v121 offset:28160
  s_bitset0_b32 s16, 20
  v_mfma_f32_16x16x32_bf16 v[28:31], v[160:163], a[40:43], v[28:31]
  ds_read_b64_tr_b16 v[156:157], v122 offset:27648
  s_add_u32 m0, s38, 26624
  v_mfma_f32_16x16x32_bf16 v[76:79], v[160:163], a[44:47], v[76:79]
  buffer_load_dwordx4 v107, s[8:11], s17 offen lds
  v_mfma_f32_16x16x32_bf16 v[32:35], a[40:43], v[164:167], v[32:35]
  ds_read_b64_tr_b16 v[158:159], v122 offset:28160
  buffer_load_dwordx4 v108, s[8:11], s17 offen offset:1024 lds
  v_mfma_f32_16x16x32_bf16 v[80:83], a[44:47], v[164:167], v[80:83]
  ds_read_b64_tr_b16 v[160:161], v123 offset:27648
  ds_read_b64_tr_b16 v[162:163], v123 offset:28160
  v_mfma_f32_16x16x32_bf16 v[36:39], a[40:43], v[168:171], v[36:39]
  buffer_load_dwordx4 v109, s[8:11], s17 offen offset:2048 lds
  v_mfma_f32_16x16x32_bf16 v[84:87], a[44:47], v[168:171], v[84:87]
  ds_read_b64_tr_b16 v[164:165], v120 offset:28672
  s_add_u32 s17, s17, 196608
  v_mfma_f32_16x16x32_bf16 v[40:43], a[40:43], v[172:175], v[40:43]
  ds_read_b64_tr_b16 v[166:167], v120 offset:29184
  s_cmp_eq_u32 s17, s10
  v_mfma_f32_16x16x32_bf16 v[88:91], a[44:47], v[172:175], v[88:91]
  ds_read_b64_tr_b16 v[168:169], v121 offset:28672
  s_cselect_b32 s17, 0, s17
  v_mfma_f32_16x16x32_bf16 v[44:47], a[40:43], v[176:179], v[44:47]
  ds_read_b64_tr_b16 v[170:171], v121 offset:29184
  ds_read_b64_tr_b16 v[172:173], v122 offset:28672
  v_mfma_f32_16x16x32_bf16 v[92:95], a[44:47], v[176:179], v[92:95]
  s_waitcnt vmcnt(20) lgkmcnt(10)
  s_barrier
  v_mfma_f32_16x16x32_bf16 v[96:99], v[180:183], v[188:191], v[96:99]
  ds_read_b64_tr_b16 v[174:175], v122 offset:29184
  s_add_u32 m0, s39, 26624
  v_mfma_f32_16x16x32_bf16 v[100:103], v[188:191], v[184:187], v[100:103]
  buffer_load_dword v106, s[4:7], s16 offen sc1 lds
  v_mfma_f32_16x16x32_bf16 v[0:3], v[132:135], a[48:51], v[0:3]
  ds_read_b64_tr_b16 v[176:177], v123 offset:28672
  ds_read_b64_tr_b16 v[178:179], v123 offset:29184
  buffer_load_dwordx4 a[16:19], v105, s[4:7], s16 offen sc1
  v_mfma_f32_16x16x32_bf16 v[48:51], v[132:135], a[52:55], v[48:51]
  ds_read_b64_tr_b16 v[180:181], v124 offset:40960
  ds_read_b64_tr_b16 v[182:183], v124 offset:41472
  buffer_load_dwordx4 a[20:23], v105, s[4:7], s16 offen offset:1024 sc1
  v_mfma_f32_16x16x32_bf16 v[4:7], v[136:139], a[48:51], v[4:7]
  ds_read_b128 v[188:191], v125 offset:52224
  ds_read_b64_tr_b16 v[184:185], v124 offset:41984
  ds_read_b64_tr_b16 v[186:187], v124 offset:42496
  v_mfma_f32_16x16x32_bf16 v[52:55], v[136:139], a[52:55], v[52:55]
  ds_read_b64_tr_b16 v[132:133], v120 offset:39936
  s_add_u32 s16, s16, 131072
  v_mfma_f32_16x16x32_bf16 v[8:11], v[140:143], a[48:51], v[8:11]
  ds_read_b64_tr_b16 v[134:135], v120 offset:40448
  s_bitset0_b32 s16, 20
  v_mfma_f32_16x16x32_bf16 v[56:59], v[140:143], a[52:55], v[56:59]
  ds_read_b64_tr_b16 v[136:137], v121 offset:39936
  s_add_u32 m0, s38, 39936
  v_mfma_f32_16x16x32_bf16 v[12:15], v[144:147], a[48:51], v[12:15]
  ds_read_b64_tr_b16 v[138:139], v121 offset:40448
  ds_read_b64_tr_b16 v[140:141], v122 offset:39936
  v_mfma_f32_16x16x32_bf16 v[60:63], v[144:147], a[52:55], v[60:63]
  buffer_load_dwordx4 v107, s[8:11], s17 offen lds
  v_mfma_f32_16x16x32_bf16 v[16:19], v[148:151], a[48:51], v[16:19]
  ds_read_b64_tr_b16 v[142:143], v122 offset:40448
  buffer_load_dwordx4 v108, s[8:11], s17 offen offset:1024 lds
  v_mfma_f32_16x16x32_bf16 v[64:67], v[148:151], a[52:55], v[64:67]
  buffer_load_dwordx4 v109, s[8:11], s17 offen offset:2048 lds
  s_waitcnt lgkmcnt(10)
  v_mfma_f32_16x16x32_bf16 v[20:23], v[152:155], a[48:51], v[20:23]
  ds_read_b64_tr_b16 v[144:145], v123 offset:39936
  ds_read_b64_tr_b16 v[146:147], v123 offset:40448
  v_mfma_f32_16x16x32_bf16 v[68:71], v[152:155], a[52:55], v[68:71]
  ds_read_b64_tr_b16 v[148:149], v120 offset:40960
  s_add_u32 s17, s17, 196608
  v_mfma_f32_16x16x32_bf16 v[24:27], v[156:159], a[48:51], v[24:27]
  ds_read_b64_tr_b16 v[150:151], v120 offset:41472
  s_cmp_eq_u32 s17, s10
  v_mfma_f32_16x16x32_bf16 v[72:75], v[156:159], a[52:55], v[72:75]
  ds_read_b64_tr_b16 v[152:153], v121 offset:40960
  s_cselect_b32 s17, 0, s17
  v_mfma_f32_16x16x32_bf16 v[28:31], v[160:163], a[48:51], v[28:31]
  ds_read_b64_tr_b16 v[154:155], v121 offset:41472
  ds_read_b64_tr_b16 v[156:157], v122 offset:40960
  v_mfma_f32_16x16x32_bf16 v[76:79], v[160:163], a[52:55], v[76:79]
  ds_read_b64_tr_b16 v[158:159], v122 offset:41472
  s_add_u32 m0, s39, 39936
  v_mfma_f32_16x16x32_bf16 v[32:35], a[48:51], v[164:167], v[32:35]
  buffer_load_dword v106, s[4:7], s16 offen sc1 lds
  v_mfma_f32_16x16x32_bf16 v[80:83], a[52:55], v[164:167], v[80:83]
  buffer_load_dwordx4 a[24:27], v105, s[4:7], s16 offen sc1
  v_mfma_f32_16x16x32_bf16 v[36:39], a[48:51], v[168:171], v[36:39]
  ds_read_b64_tr_b16 v[160:161], v123 offset:40960
  ds_read_b64_tr_b16 v[162:163], v123 offset:41472
  v_mfma_f32_16x16x32_bf16 v[84:87], a[52:55], v[168:171], v[84:87]
  buffer_load_dwordx4 a[28:31], v105, s[4:7], s16 offen offset:1024 sc1
  v_mfma_f32_16x16x32_bf16 v[40:43], a[48:51], v[172:175], v[40:43]
  ds_read_b64_tr_b16 v[164:165], v120 offset:41984
  ds_read_b64_tr_b16 v[166:167], v120 offset:42496
  s_add_u32 s16, s16, 131072
  v_mfma_f32_16x16x32_bf16 v[88:91], a[52:55], v[172:175], v[88:91]
  ds_read_b64_tr_b16 v[168:169], v121 offset:41984
  s_bitset0_b32 s16, 20
  v_mfma_f32_16x16x32_bf16 v[44:47], a[48:51], v[176:179], v[44:47]
  ds_read_b64_tr_b16 v[170:171], v121 offset:42496
  ds_read_b64_tr_b16 v[172:173], v122 offset:41984
  v_mfma_f32_16x16x32_bf16 v[92:95], a[52:55], v[176:179], v[92:95]
  s_waitcnt vmcnt(23) lgkmcnt(10)
  s_barrier
  v_mfma_f32_16x16x32_bf16 v[96:99], v[180:183], v[188:191], v[96:99]
  ds_read_b64_tr_b16 v[174:175], v122 offset:42496
  s_add_u32 m0, s38, 53248
  v_mfma_f32_16x16x32_bf16 v[100:103], v[188:191], v[184:187], v[100:103]
  buffer_load_dwordx4 v107, s[8:11], s17 offen lds
  v_mfma_f32_16x16x32_bf16 v[0:3], v[132:135], a[56:59], v[0:3]
  ds_read_b64_tr_b16 v[176:177], v123 offset:41984
  ds_read_b64_tr_b16 v[178:179], v123 offset:42496
  buffer_load_dwordx4 v108, s[8:11], s17 offen offset:1024 lds
  v_mfma_f32_16x16x32_bf16 v[48:51], v[132:135], a[60:63], v[48:51]
  ds_read_b64_tr_b16 v[180:181], v118 offset:1024
  ds_read_b64_tr_b16 v[182:183], v118 offset:1536
  buffer_load_dwordx4 v109, s[8:11], s17 offen offset:2048 lds
  v_mfma_f32_16x16x32_bf16 v[4:7], v[136:139], a[56:59], v[4:7]
  ds_read_b128 v[188:191], v119 offset:12288
  ds_read_b64_tr_b16 v[184:185], v118 offset:2048
  ds_read_b64_tr_b16 v[186:187], v118 offset:2560
  v_mfma_f32_16x16x32_bf16 v[52:55], v[136:139], a[60:63], v[52:55]
  ds_read_b64_tr_b16 v[132:133], v114 offset:0
  s_add_u32 s17, s17, 196608
  v_mfma_f32_16x16x32_bf16 v[8:11], v[140:143], a[56:59], v[8:11]
  ds_read_b64_tr_b16 v[134:135], v114 offset:512
  s_cmp_eq_u32 s17, s10
  v_mfma_f32_16x16x32_bf16 v[56:59], v[140:143], a[60:63], v[56:59]
  ds_read_b64_tr_b16 v[136:137], v115 offset:0
  s_cselect_b32 s17, 0, s17
  v_mfma_f32_16x16x32_bf16 v[12:15], v[144:147], a[56:59], v[12:15]
  ds_read_b64_tr_b16 v[138:139], v115 offset:512
  s_add_u32 m0, s39, 53248
  v_mfma_f32_16x16x32_bf16 v[60:63], v[144:147], a[60:63], v[60:63]
  ds_read_b64_tr_b16 v[140:141], v116 offset:0
  ds_read_b64_tr_b16 v[142:143], v116 offset:512
  v_mfma_f32_16x16x32_bf16 v[16:19], v[148:151], a[56:59], v[16:19]
  buffer_load_dword v106, s[4:7], s16 offen sc1 lds
  v_mfma_f32_16x16x32_bf16 v[64:67], v[148:151], a[60:63], v[64:67]
  buffer_load_dwordx4 a[32:35], v105, s[4:7], s16 offen sc1
  s_waitcnt lgkmcnt(10)
  v_mfma_f32_16x16x32_bf16 v[20:23], v[152:155], a[56:59], v[20:23]
  ds_read_b64_tr_b16 v[144:145], v117 offset:0
  ds_read_b64_tr_b16 v[146:147], v117 offset:512
  buffer_load_dwordx4 a[36:39], v105, s[4:7], s16 offen offset:1024 sc1
  v_mfma_f32_16x16x32_bf16 v[68:71], v[152:155], a[60:63], v[68:71]
  ds_read_b64_tr_b16 v[148:149], v114 offset:1024
  s_add_u32 s16, s16, 131072
  v_mfma_f32_16x16x32_bf16 v[24:27], v[156:159], a[56:59], v[24:27]
  ds_read_b64_tr_b16 v[150:151], v114 offset:1536
  ds_read_b64_tr_b16 v[152:153], v115 offset:1024
  v_mfma_f32_16x16x32_bf16 v[72:75], v[156:159], a[60:63], v[72:75]
  ds_read_b64_tr_b16 v[154:155], v115 offset:1536
  s_bitset0_b32 s16, 20
  v_mfma_f32_16x16x32_bf16 v[28:31], v[160:163], a[56:59], v[28:31]
  ds_read_b64_tr_b16 v[156:157], v116 offset:1024
  s_add_u32 m0, s38, 66560
  v_mfma_f32_16x16x32_bf16 v[76:79], v[160:163], a[60:63], v[76:79]
  buffer_load_dwordx4 v107, s[8:11], s17 offen lds
  v_mfma_f32_16x16x32_bf16 v[32:35], a[56:59], v[164:167], v[32:35]
  ds_read_b64_tr_b16 v[158:159], v116 offset:1536
  buffer_load_dwordx4 v108, s[8:11], s17 offen offset:1024 lds
  v_mfma_f32_16x16x32_bf16 v[80:83], a[60:63], v[164:167], v[80:83]
  ds_read_b64_tr_b16 v[160:161], v117 offset:1024
  ds_read_b64_tr_b16 v[162:163], v117 offset:1536
  v_mfma_f32_16x16x32_bf16 v[36:39], a[56:59], v[168:171], v[36:39]
  buffer_load_dwordx4 v109, s[8:11], s17 offen offset:2048 lds
  v_mfma_f32_16x16x32_bf16 v[84:87], a[60:63], v[168:171], v[84:87]
  ds_read_b64_tr_b16 v[164:165], v114 offset:2048
  s_add_u32 s17, s17, 196608
  v_mfma_f32_16x16x32_bf16 v[40:43], a[56:59], v[172:175], v[40:43]
  ds_read_b64_tr_b16 v[166:167], v114 offset:2560
  s_cmp_eq_u32 s17, s10
  v_mfma_f32_16x16x32_bf16 v[88:91], a[60:63], v[172:175], v[88:91]
  ds_read_b64_tr_b16 v[168:169], v115 offset:2048
  s_cselect_b32 s17, 0, s17
  v_mfma_f32_16x16x32_bf16 v[44:47], a[56:59], v[176:179], v[44:47]
  ds_read_b64_tr_b16 v[170:171], v115 offset:2560
  ds_read_b64_tr_b16 v[172:173], v116 offset:2048
  v_mfma_f32_16x16x32_bf16 v[92:95], a[60:63], v[176:179], v[92:95]
  s_waitcnt vmcnt(21) lgkmcnt(10)
  s_barrier
  v_mfma_f32_16x16x32_bf16 v[96:99], v[180:183], v[188:191], v[96:99]
  ds_read_b64_tr_b16 v[174:175], v116 offset:2560
  s_add_u32 m0, s39, 66560
  v_mfma_f32_16x16x32_bf16 v[100:103], v[188:191], v[184:187], v[100:103]
  buffer_load_dword v106, s[4:7], s16 offen sc1 lds
  v_mfma_f32_16x16x32_bf16 v[0:3], v[132:135], a[0:3], v[0:3]
  ds_read_b64_tr_b16 v[176:177], v117 offset:2048
  ds_read_b64_tr_b16 v[178:179], v117 offset:2560
  buffer_load_dwordx4 a[40:43], v105, s[4:7], s16 offen sc1
  v_mfma_f32_16x16x32_bf16 v[48:51], v[132:135], a[4:7], v[48:51]
  ds_read_b64_tr_b16 v[180:181], v118 offset:14336
  ds_read_b64_tr_b16 v[182:183], v118 offset:14848
  buffer_load_dwordx4 a[44:47], v105, s[4:7], s16 offen offset:1024 sc1
  v_mfma_f32_16x16x32_bf16 v[4:7], v[136:139], a[0:3], v[4:7]
  ds_read_b128 v[188:191], v119 offset:25600
  ds_read_b64_tr_b16 v[184:185], v118 offset:15360
  ds_read_b64_tr_b16 v[186:187], v118 offset:15872
  v_mfma_f32_16x16x32_bf16 v[52:55], v[136:139], a[4:7], v[52:55]
  ds_read_b64_tr_b16 v[132:133], v114 offset:13312
  s_add_u32 s16, s16, 131072
  v_mfma_f32_16x16x32_bf16 v[8:11], v[140:143], a[0:3], v[8:11]
  ds_read_b64_tr_b16 v[134:135], v114 offset:13824
  s_bitset0_b32 s16, 20
  v_mfma_f32_16x16x32_bf16 v[56:59], v[140:143], a[4:7], v[56:59]
  ds_read_b64_tr_b16 v[136:137], v115 offset:13312
  s_add_u32 m0, s38, 79872
  v_mfma_f32_16x16x32_bf16 v[12:15], v[144:147], a[0:3], v[12:15]
  ds_read_b64_tr_b16 v[138:139], v115 offset:13824
  buffer_load_dwordx4 v107, s[8:11], s17 offen lds
  v_mfma_f32_16x16x32_bf16 v[60:63], v[144:147], a[4:7], v[60:63]
  ds_read_b64_tr_b16 v[140:141], v116 offset:13312
  ds_read_b64_tr_b16 v[142:143], v116 offset:13824
  v_mfma_f32_16x16x32_bf16 v[16:19], v[148:151], a[0:3], v[16:19]
  buffer_load_dwordx4 v108, s[8:11], s17 offen offset:1024 lds
  v_mfma_f32_16x16x32_bf16 v[64:67], v[148:151], a[4:7], v[64:67]
  buffer_load_dwordx4 v109, s[8:11], s17 offen offset:2048 lds
  s_waitcnt lgkmcnt(10)
  v_mfma_f32_16x16x32_bf16 v[20:23], v[152:155], a[0:3], v[20:23]
  ds_read_b64_tr_b16 v[144:145], v117 offset:13312
  ds_read_b64_tr_b16 v[146:147], v117 offset:13824
  s_add_u32 s17, s17, 196608
  v_mfma_f32_16x16x32_bf16 v[68:71], v[152:155], a[4:7], v[68:71]
  ds_read_b64_tr_b16 v[148:149], v114 offset:14336
  s_cmp_eq_u32 s17, s10
  v_mfma_f32_16x16x32_bf16 v[24:27], v[156:159], a[0:3], v[24:27]
  ds_read_b64_tr_b16 v[150:151], v114 offset:14848
  ds_read_b64_tr_b16 v[152:153], v115 offset:14336
  v_mfma_f32_16x16x32_bf16 v[72:75], v[156:159], a[4:7], v[72:75]
  ds_read_b64_tr_b16 v[154:155], v115 offset:14848
  s_cselect_b32 s17, 0, s17
  v_mfma_f32_16x16x32_bf16 v[28:31], v[160:163], a[0:3], v[28:31]
  ds_read_b64_tr_b16 v[156:157], v116 offset:14336
  s_add_u32 m0, s39, 79872
  v_mfma_f32_16x16x32_bf16 v[76:79], v[160:163], a[4:7], v[76:79]
  buffer_load_dword v106, s[4:7], s16 offen sc1 lds
  v_mfma_f32_16x16x32_bf16 v[32:35], a[0:3], v[164:167], v[32:35]
  ds_read_b64_tr_b16 v[158:159], v116 offset:14848
  buffer_load_dwordx4 a[48:51], v105, s[4:7], s16 offen sc1
  v_mfma_f32_16x16x32_bf16 v[80:83], a[4:7], v[164:167], v[80:83]
  ds_read_b64_tr_b16 v[160:161], v117 offset:14336
  ds_read_b64_tr_b16 v[162:163], v117 offset:14848
  v_mfma_f32_16x16x32_bf16 v[36:39], a[0:3], v[168:171], v[36:39]
  buffer_load_dwordx4 a[52:55], v105, s[4:7], s16 offen offset:1024 sc1
  v_mfma_f32_16x16x32_bf16 v[84:87], a[4:7], v[168:171], v[84:87]
  ds_read_b64_tr_b16 v[164:165], v114 offset:15360
  s_add_u32 s16, s16, 131072
  v_mfma_f32_16x16x32_bf16 v[40:43], a[0:3], v[172:175], v[40:43]
  ds_read_b64_tr_b16 v[166:167], v114 offset:15872
  s_bitset0_b32 s16, 20
  v_mfma_f32_16x16x32_bf16 v[88:91], a[4:7], v[172:175], v[88:91]
  buffer_store_dwordx4 v[244:247], v119, s[92:95], s35 offen offset:1024 sc1
  v_mfma_f32_16x16x32_bf16 v[44:47], a[0:3], v[176:179], v[44:47]
  ds_read_b64_tr_b16 v[168:169], v115 offset:15360
  ds_read_b64_tr_b16 v[170:171], v115 offset:15872
  v_mfma_f32_16x16x32_bf16 v[92:95], a[4:7], v[176:179], v[92:95]
  s_waitcnt vmcnt(25) lgkmcnt(10)
  s_barrier
  v_mfma_f32_16x16x32_bf16 v[96:99], v[180:183], v[188:191], v[96:99]
  ds_read_b64_tr_b16 v[172:173], v116 offset:15360
  ds_read_b64_tr_b16 v[174:175], v116 offset:15872
  s_add_u32 m0, s38, 93184
  v_mfma_f32_16x16x32_bf16 v[100:103], v[188:191], v[184:187], v[100:103]
  buffer_load_dwordx4 v107, s[8:11], s17 offen lds
  v_mfma_f32_16x16x32_bf16 v[0:3], v[132:135], a[8:11], v[0:3]
  ds_read_b64_tr_b16 v[176:177], v117 offset:15360
  ds_read_b64_tr_b16 v[178:179], v117 offset:15872
  buffer_load_dwordx4 v108, s[8:11], s17 offen offset:1024 lds
  v_mfma_f32_16x16x32_bf16 v[48:51], v[132:135], a[12:15], v[48:51]
  ds_read_b64_tr_b16 v[180:181], v118 offset:27648
  ds_read_b64_tr_b16 v[182:183], v118 offset:28160
  buffer_load_dwordx4 v109, s[8:11], s17 offen offset:2048 lds
  v_mfma_f32_16x16x32_bf16 v[4:7], v[136:139], a[8:11], v[4:7]
  ds_read_b128 v[188:191], v119 offset:38912
  ds_read_b64_tr_b16 v[184:185], v118 offset:28672
  ds_read_b64_tr_b16 v[186:187], v118 offset:29184
  s_add_u32 s17, s17, 196608
  v_mfma_f32_16x16x32_bf16 v[52:55], v[136:139], a[12:15], v[52:55]
  ds_read_b64_tr_b16 v[132:133], v114 offset:26624
  s_cmp_eq_u32 s17, s10
  v_mfma_f32_16x16x32_bf16 v[8:11], v[140:143], a[8:11], v[8:11]
  ds_read_b64_tr_b16 v[134:135], v114 offset:27136
  ds_read_b64_tr_b16 v[136:137], v115 offset:26624
  v_mfma_f32_16x16x32_bf16 v[56:59], v[140:143], a[12:15], v[56:59]
  ds_read_b64_tr_b16 v[138:139], v115 offset:27136
  s_cselect_b32 s17, 0, s17
  v_mfma_f32_16x16x32_bf16 v[12:15], v[144:147], a[8:11], v[12:15]
  s_add_u32 s8, s8, s10
  s_addc_u32 s9, s9, 0
  v_mfma_f32_16x16x32_bf16 v[60:63], v[144:147], a[12:15], v[60:63]
  ds_read_b64_tr_b16 v[140:141], v116 offset:26624
  s_add_u32 m0, s39, 93184
  v_mfma_f32_16x16x32_bf16 v[16:19], v[148:151], a[8:11], v[16:19]
  ds_read_b64_tr_b16 v[142:143], v116 offset:27136
  buffer_load_dword v106, s[4:7], s16 offen sc1 lds
  v_mfma_f32_16x16x32_bf16 v[64:67], v[148:151], a[12:15], v[64:67]
  buffer_load_dwordx4 a[56:59], v105, s[4:7], s16 offen sc1
  s_waitcnt lgkmcnt(10)
  v_mfma_f32_16x16x32_bf16 v[20:23], v[152:155], a[8:11], v[20:23]
  ds_read_b64_tr_b16 v[144:145], v117 offset:26624
  ds_read_b64_tr_b16 v[146:147], v117 offset:27136
  v_mfma_f32_16x16x32_bf16 v[68:71], v[152:155], a[12:15], v[68:71]
  buffer_load_dwordx4 a[60:63], v105, s[4:7], s16 offen offset:1024 sc1
  v_mfma_f32_16x16x32_bf16 v[24:27], v[156:159], a[8:11], v[24:27]
  ds_read_b64_tr_b16 v[148:149], v114 offset:27648
  ds_read_b64_tr_b16 v[150:151], v114 offset:28160
  s_add_u32 s16, s16, 131072
  v_mfma_f32_16x16x32_bf16 v[72:75], v[156:159], a[12:15], v[72:75]
  ds_read_b64_tr_b16 v[152:153], v115 offset:27648
  s_bitset0_b32 s16, 20
  v_mfma_f32_16x16x32_bf16 v[28:31], v[160:163], a[8:11], v[28:31]
  ds_read_b64_tr_b16 v[154:155], v115 offset:28160
  s_add_u32 s4, s4, s6
  s_addc_u32 s5, s5, 0
  v_mfma_f32_16x16x32_bf16 v[76:79], v[160:163], a[12:15], v[76:79]
  ds_read_b64_tr_b16 v[156:157], v116 offset:27648
  s_add_u32 m0, s39, 0
  v_mfma_f32_16x16x32_bf16 v[32:35], a[8:11], v[164:167], v[32:35]
  ds_read_b64_tr_b16 v[158:159], v116 offset:28160
  ds_read_b64_tr_b16 v[160:161], v117 offset:27648
  v_mfma_f32_16x16x32_bf16 v[80:83], a[12:15], v[164:167], v[80:83]
  buffer_load_dword v106, s[4:7], s16 offen sc1 lds
  v_mfma_f32_16x16x32_bf16 v[36:39], a[8:11], v[168:171], v[36:39]
  ds_read_b64_tr_b16 v[162:163], v117 offset:28160
  buffer_load_dwordx4 a[0:3], v105, s[4:7], s16 offen sc1
  v_mfma_f32_16x16x32_bf16 v[84:87], a[12:15], v[168:171], v[84:87]
  buffer_load_dwordx4 a[4:7], v105, s[4:7], s16 offen offset:1024 sc1
  v_mfma_f32_16x16x32_bf16 v[40:43], a[8:11], v[172:175], v[40:43]
  ds_read_b64_tr_b16 v[164:165], v114 offset:28672
  ds_read_b64_tr_b16 v[166:167], v114 offset:29184
  s_add_u32 s16, s16, 131072
  v_mfma_f32_16x16x32_bf16 v[88:91], a[12:15], v[172:175], v[88:91]
  ds_read_b64_tr_b16 v[168:169], v115 offset:28672
  s_bitset0_b32 s16, 20
  v_mfma_f32_16x16x32_bf16 v[44:47], a[8:11], v[176:179], v[44:47]
  ds_read_b64_tr_b16 v[170:171], v115 offset:29184
  ds_read_b64_tr_b16 v[172:173], v116 offset:28672
  v_mfma_f32_16x16x32_bf16 v[92:95], a[12:15], v[176:179], v[92:95]
  s_waitcnt vmcnt(28) lgkmcnt(10)
  s_barrier
  v_mfma_f32_16x16x32_bf16 v[96:99], v[180:183], v[188:191], v[96:99]
  ds_read_b64_tr_b16 v[174:175], v116 offset:29184
  s_add_u32 m0, s39, 13312
  s_nop 0
  buffer_load_dword v106, s[4:7], s16 offen sc1 lds
  v_mfma_f32_16x16x32_bf16 v[100:103], v[188:191], v[184:187], v[100:103]
  buffer_load_dwordx4 a[8:11], v105, s[4:7], s16 offen sc1
  v_mfma_f32_16x16x32_bf16 v[0:3], v[132:135], a[16:19], v[0:3]
  ds_read_b64_tr_b16 v[176:177], v117 offset:28672
  ds_read_b64_tr_b16 v[178:179], v117 offset:29184
  buffer_load_dwordx4 a[12:15], v105, s[4:7], s16 offen offset:1024 sc1
  v_mfma_f32_16x16x32_bf16 v[48:51], v[132:135], a[20:23], v[48:51]
  ds_read_b64_tr_b16 v[180:181], v118 offset:40960
  ds_read_b64_tr_b16 v[182:183], v118 offset:41472
  s_add_u32 s16, s16, 131072
  v_mfma_f32_16x16x32_bf16 v[4:7], v[136:139], a[16:19], v[4:7]
  ds_read_b128 v[188:191], v119 offset:52224
  ds_read_b64_tr_b16 v[184:185], v118 offset:41984
  ds_read_b64_tr_b16 v[186:187], v118 offset:42496
  s_bitset0_b32 s16, 20
  v_mfma_f32_16x16x32_bf16 v[52:55], v[136:139], a[20:23], v[52:55]
  s_add_u32 m0, s38, 0
  s_nop 0
  buffer_load_dwordx4 v107, s[8:11], s17 offen lds
  v_mfma_f32_16x16x32_bf16 v[8:11], v[140:143], a[16:19], v[8:11]
  ds_read_b64_tr_b16 v[132:133], v114 offset:39936
  ds_read_b64_tr_b16 v[134:135], v114 offset:40448
  buffer_load_dwordx4 v108, s[8:11], s17 offen offset:1024 lds
  v_mfma_f32_16x16x32_bf16 v[56:59], v[140:143], a[20:23], v[56:59]
  buffer_load_dwordx4 v109, s[8:11], s17 offen offset:2048 lds
  v_mfma_f32_16x16x32_bf16 v[12:15], v[144:147], a[16:19], v[12:15]
  ds_read_b64_tr_b16 v[136:137], v115 offset:39936
  ds_read_b64_tr_b16 v[138:139], v115 offset:40448
  s_add_u32 s17, s17, 196608
  v_mfma_f32_16x16x32_bf16 v[60:63], v[144:147], a[20:23], v[60:63]
  ds_read_b64_tr_b16 v[140:141], v116 offset:39936
  s_cmp_eq_u32 s17, s10
  v_mfma_f32_16x16x32_bf16 v[16:19], v[148:151], a[16:19], v[16:19]
  ds_read_b64_tr_b16 v[142:143], v116 offset:40448
  s_cselect_b32 s17, 0, s17
  s_mov_b32 m0, s51
  v_mfma_f32_16x16x32_bf16 v[64:67], v[148:151], a[20:23], v[64:67]
  ds_read_b64_tr_b16 v[144:145], v117 offset:39936
  s_add_u32 s51, s51, 1024
  s_waitcnt lgkmcnt(10)
  v_mfma_f32_16x16x32_bf16 v[20:23], v[152:155], a[16:19], v[20:23]
  ds_read_b64_tr_b16 v[146:147], v117 offset:40448
  buffer_load_dwordx4 v129, s[52:55], s50 offen nt lds
  v_mfma_f32_16x16x32_bf16 v[68:71], v[152:155], a[20:23], v[68:71]
  ds_read_b64_tr_b16 v[148:149], v114 offset:40960
  s_add_u32 s50, s50, 98304
  v_mfma_f32_16x16x32_bf16 v[24:27], v[156:159], a[16:19], v[24:27]
  ds_read_b64_tr_b16 v[150:151], v114 offset:41472
  s_mov_b32 m0, s51
  v_mfma_f32_16x16x32_bf16 v[72:75], v[156:159], a[20:23], v[72:75]
  s_add_u32 s51, s51, 1024
  buffer_load_dwordx4 v129, s[52:55], s50 offen nt lds
  v_mfma_f32_16x16x32_bf16 v[28:31], v[160:163], a[16:19], v[28:31]
  ds_read_b64_tr_b16 v[152:153], v115 offset:40960
  ds_read_b64_tr_b16 v[154:155], v115 offset:41472
  s_add_u32 s50, s50, 98304
  v_mfma_f32_16x16x32_bf16 v[76:79], v[160:163], a[20:23], v[76:79]
  ds_read_b64_tr_b16 v[156:157], v116 offset:40960
  s_mov_b32 m0, s51
  v_mfma_f32_16x16x32_bf16 v[32:35], a[16:19], v[164:167], v[32:35]
  ds_read_b64_tr_b16 v[158:159], v116 offset:41472
  s_add_u32 s51, s51, 1024
  v_mfma_f32_16x16x32_bf16 v[80:83], a[20:23], v[164:167], v[80:83]
  buffer_load_dwordx4 v129, s[52:55], s50 offen nt lds
  v_mfma_f32_16x16x32_bf16 v[36:39], a[16:19], v[168:171], v[36:39]
  ds_read_b64_tr_b16 v[160:161], v117 offset:40960
  ds_read_b64_tr_b16 v[162:163], v117 offset:41472
  s_add_u32 s50, s50, 98304
  s_mov_b32 m0, s51
  v_mfma_f32_16x16x32_bf16 v[84:87], a[20:23], v[168:171], v[84:87]
  ds_read_b64_tr_b16 v[164:165], v114 offset:41984
  s_add_u32 s51, s51, 1024
  v_mfma_f32_16x16x32_bf16 v[40:43], a[16:19], v[172:175], v[40:43]
  ds_read_b64_tr_b16 v[166:167], v114 offset:42496
  buffer_load_dwordx4 v129, s[52:55], s50 offen nt lds
  v_mfma_f32_16x16x32_bf16 v[88:91], a[20:23], v[172:175], v[88:91]
  ds_read_b64_tr_b16 v[168:169], v115 offset:41984
  s_add_u32 s50, s50, 98304
  v_mfma_f32_16x16x32_bf16 v[44:47], a[16:19], v[176:179], v[44:47]
  ds_read_b64_tr_b16 v[170:171], v115 offset:42496
  s_mov_b32 s40, s20
  s_mov_b32 s41, s21
  s_mov_b32 s42, 0x200000
  s_mov_b32 s43, 0x20000
  v_min_u32 v200, 9, v104
  v_lshlrev_b32 v201, 16, v200
  v_add_u32 v201, 524288, v201
  v_lshlrev_b32 v202, 7, v200
  s_lshl2_add_u32 s33, s2, s3
  s_mul_i32 s32, s33, 448
  s_add_u32 s32, s32, 1572096
  v_add_u32 v202, s32, v202
  v_cmp_le_u32 vcc, 6, v104
  s_lshl_b32 s33, s33, 6
  s_nop 0
  v_cndmask_b32 v201, v201, v202, vcc
  buffer_load_dword v131, v201, s[40:43], s33 offen
  v_mfma_f32_16x16x32_bf16 v[92:95], a[20:23], v[176:179], v[92:95]
  s_waitcnt vmcnt(33) lgkmcnt(10)
  s_barrier
  v_mfma_f32_16x16x32_bf16 v[96:99], v[180:183], v[188:191], v[96:99]
  ds_read_b64_tr_b16 v[172:173], v116 offset:41984
  ds_read_b64_tr_b16 v[174:175], v116 offset:42496
  v_mfma_f32_16x16x32_bf16 v[100:103], v[188:191], v[184:187], v[100:103]
  ds_read_b64_tr_b16 v[176:177], v117 offset:41984
  ds_read_b64_tr_b16 v[178:179], v117 offset:42496
  v_mfma_f32_16x16x32_bf16 v[0:3], v[132:135], a[24:27], v[0:3]
  ds_read_b64_tr_b16 v[180:181], v124 offset:1024
  ds_read_b64_tr_b16 v[182:183], v124 offset:1536
  v_mfma_f32_16x16x32_bf16 v[48:51], v[132:135], a[28:31], v[48:51]
  ds_read_b128 v[188:191], v125 offset:12288
  ds_read_b64_tr_b16 v[184:185], v124 offset:2048
  v_mfma_f32_16x16x32_bf16 v[4:7], v[136:139], a[24:27], v[4:7]
  ds_read_b64_tr_b16 v[186:187], v124 offset:2560
  ds_read_b64_tr_b16 v[132:133], v120 offset:0
  v_mfma_f32_16x16x32_bf16 v[52:55], v[136:139], a[28:31], v[52:55]
  ds_read_b64_tr_b16 v[134:135], v120 offset:512
  ds_read_b64_tr_b16 v[136:137], v121 offset:0
  v_mfma_f32_16x16x32_bf16 v[8:11], v[140:143], a[24:27], v[8:11]
  ds_read_b64_tr_b16 v[138:139], v121 offset:512
  v_mfma_f32_16x16x32_bf16 v[56:59], v[140:143], a[28:31], v[56:59]
  ds_read_b64_tr_b16 v[140:141], v122 offset:0
  ds_read_b64_tr_b16 v[142:143], v122 offset:512
  v_mfma_f32_16x16x32_bf16 v[12:15], v[144:147], a[24:27], v[12:15]
  v_mfma_f32_16x16x32_bf16 v[60:63], v[144:147], a[28:31], v[60:63]
  ds_read_b64_tr_b16 v[144:145], v123 offset:0
  ds_read_b64_tr_b16 v[146:147], v123 offset:512
  v_mfma_f32_16x16x32_bf16 v[16:19], v[148:151], a[24:27], v[16:19]
  v_mfma_f32_16x16x32_bf16 v[64:67], v[148:151], a[28:31], v[64:67]
  ds_read_b64_tr_b16 v[148:149], v120 offset:1024
  ds_read_b64_tr_b16 v[150:151], v120 offset:1536
  s_waitcnt lgkmcnt(10)
  v_mfma_f32_16x16x32_bf16 v[20:23], v[152:155], a[24:27], v[20:23]
  v_mfma_f32_16x16x32_bf16 v[68:71], v[152:155], a[28:31], v[68:71]
  ds_read_b64_tr_b16 v[152:153], v121 offset:1024
  ds_read_b64_tr_b16 v[154:155], v121 offset:1536
  v_mfma_f32_16x16x32_bf16 v[24:27], v[156:159], a[24:27], v[24:27]
  v_mfma_f32_16x16x32_bf16 v[72:75], v[156:159], a[28:31], v[72:75]
  ds_read_b64_tr_b16 v[156:157], v122 offset:1024
  ds_read_b64_tr_b16 v[158:159], v122 offset:1536
  v_mfma_f32_16x16x32_bf16 v[28:31], v[160:163], a[24:27], v[28:31]
  v_mfma_f32_16x16x32_bf16 v[76:79], v[160:163], a[28:31], v[76:79]
  ds_read_b64_tr_b16 v[160:161], v123 offset:1024
  ds_read_b64_tr_b16 v[162:163], v123 offset:1536
  v_mfma_f32_16x16x32_bf16 v[32:35], a[24:27], v[164:167], v[32:35]
  v_mfma_f32_16x16x32_bf16 v[80:83], a[28:31], v[164:167], v[80:83]
  ds_read_b64_tr_b16 v[164:165], v120 offset:2048
  ds_read_b64_tr_b16 v[166:167], v120 offset:2560
  v_mfma_f32_16x16x32_bf16 v[36:39], a[24:27], v[168:171], v[36:39]
  v_mfma_f32_16x16x32_bf16 v[84:87], a[28:31], v[168:171], v[84:87]
  ds_read_b64_tr_b16 v[168:169], v121 offset:2048
  ds_read_b64_tr_b16 v[170:171], v121 offset:2560
  v_mfma_f32_16x16x32_bf16 v[40:43], a[24:27], v[172:175], v[40:43]
  v_mfma_f32_16x16x32_bf16 v[88:91], a[28:31], v[172:175], v[88:91]
  ds_read_b64_tr_b16 v[172:173], v122 offset:2048
  ds_read_b64_tr_b16 v[174:175], v122 offset:2560
  v_mfma_f32_16x16x32_bf16 v[44:47], a[24:27], v[176:179], v[44:47]
  v_mfma_f32_16x16x32_bf16 v[92:95], a[28:31], v[176:179], v[92:95]
  s_waitcnt vmcnt(27) lgkmcnt(10)
  s_barrier
  v_mfma_f32_16x16x32_bf16 v[96:99], v[180:183], v[188:191], v[96:99]
  buffer_store_dwordx4 v[244:247], v119, s[92:95], s35 offen offset:2048 sc1
  v_mfma_f32_16x16x32_bf16 v[100:103], v[188:191], v[184:187], v[100:103]
  ds_read_b64_tr_b16 v[176:177], v123 offset:2048
  ds_read_b64_tr_b16 v[178:179], v123 offset:2560
  v_mfma_f32_16x16x32_bf16 v[0:3], v[132:135], a[32:35], v[0:3]
  ds_read_b64_tr_b16 v[180:181], v124 offset:14336
  ds_read_b64_tr_b16 v[182:183], v124 offset:14848
  v_mfma_f32_16x16x32_bf16 v[48:51], v[132:135], a[36:39], v[48:51]
  ds_read_b128 v[188:191], v125 offset:25600
  ds_read_b64_tr_b16 v[184:185], v124 offset:15360
  v_mfma_f32_16x16x32_bf16 v[4:7], v[136:139], a[32:35], v[4:7]
  ds_read_b64_tr_b16 v[186:187], v124 offset:15872
  ds_read_b64_tr_b16 v[132:133], v120 offset:13312
  v_mfma_f32_16x16x32_bf16 v[52:55], v[136:139], a[36:39], v[52:55]
  ds_read_b64_tr_b16 v[134:135], v120 offset:13824
  ds_read_b64_tr_b16 v[136:137], v121 offset:13312
  v_mfma_f32_16x16x32_bf16 v[8:11], v[140:143], a[32:35], v[8:11]
  ds_read_b64_tr_b16 v[138:139], v121 offset:13824
  v_mfma_f32_16x16x32_bf16 v[56:59], v[140:143], a[36:39], v[56:59]
  ds_read_b64_tr_b16 v[140:141], v122 offset:13312
  ds_read_b64_tr_b16 v[142:143], v122 offset:13824
  v_mfma_f32_16x16x32_bf16 v[12:15], v[144:147], a[32:35], v[12:15]
  v_mfma_f32_16x16x32_bf16 v[60:63], v[144:147], a[36:39], v[60:63]
  ds_read_b64_tr_b16 v[144:145], v123 offset:13312
  ds_read_b64_tr_b16 v[146:147], v123 offset:13824
  v_mfma_f32_16x16x32_bf16 v[16:19], v[148:151], a[32:35], v[16:19]
  v_mfma_f32_16x16x32_bf16 v[64:67], v[148:151], a[36:39], v[64:67]
  ds_read_b64_tr_b16 v[148:149], v120 offset:14336
  ds_read_b64_tr_b16 v[150:151], v120 offset:14848
  v_mfma_f32_16x16x32_bf16 v[20:23], v[152:155], a[32:35], v[20:23]
  v_mfma_f32_16x16x32_bf16 v[68:71], v[152:155], a[36:39], v[68:71]
  ds_read_b64_tr_b16 v[152:153], v121 offset:14336
  ds_read_b64_tr_b16 v[154:155], v121 offset:14848
  s_waitcnt lgkmcnt(10)
  v_mfma_f32_16x16x32_bf16 v[24:27], v[156:159], a[32:35], v[24:27]
  v_mfma_f32_16x16x32_bf16 v[72:75], v[156:159], a[36:39], v[72:75]
  ds_read_b64_tr_b16 v[156:157], v122 offset:14336
  ds_read_b64_tr_b16 v[158:159], v122 offset:14848
  v_mfma_f32_16x16x32_bf16 v[28:31], v[160:163], a[32:35], v[28:31]
  v_mfma_f32_16x16x32_bf16 v[76:79], v[160:163], a[36:39], v[76:79]
  ds_read_b64_tr_b16 v[160:161], v123 offset:14336
  ds_read_b64_tr_b16 v[162:163], v123 offset:14848
  v_mfma_f32_16x16x32_bf16 v[32:35], a[32:35], v[164:167], v[32:35]
  v_mfma_f32_16x16x32_bf16 v[80:83], a[36:39], v[164:167], v[80:83]
  ds_read_b64_tr_b16 v[164:165], v120 offset:15360
  ds_read_b64_tr_b16 v[166:167], v120 offset:15872
  v_mfma_f32_16x16x32_bf16 v[36:39], a[32:35], v[168:171], v[36:39]
  v_mfma_f32_16x16x32_bf16 v[84:87], a[36:39], v[168:171], v[84:87]
  ds_read_b64_tr_b16 v[168:169], v121 offset:15360
  ds_read_b64_tr_b16 v[170:171], v121 offset:15872
  v_mfma_f32_16x16x32_bf16 v[40:43], a[32:35], v[172:175], v[40:43]
  v_mfma_f32_16x16x32_bf16 v[88:91], a[36:39], v[172:175], v[88:91]
  ds_read_b64_tr_b16 v[172:173], v122 offset:15360
  ds_read_b64_tr_b16 v[174:175], v122 offset:15872
  v_mfma_f32_16x16x32_bf16 v[44:47], a[32:35], v[176:179], v[44:47]
  v_mfma_f32_16x16x32_bf16 v[92:95], a[36:39], v[176:179], v[92:95]
  s_waitcnt vmcnt(22) lgkmcnt(10)
  s_barrier
  v_mfma_f32_16x16x32_bf16 v[96:99], v[180:183], v[188:191], v[96:99]
  ds_read_b64_tr_b16 v[176:177], v123 offset:15360
  s_add_u32 m0, s38, 13312
  v_mfma_f32_16x16x32_bf16 v[100:103], v[188:191], v[184:187], v[100:103]
  buffer_load_dwordx4 v107, s[8:11], s17 offen lds
  v_mfma_f32_16x16x32_bf16 v[0:3], v[132:135], a[40:43], v[0:3]
  ds_read_b64_tr_b16 v[178:179], v123 offset:15872
  buffer_load_dwordx4 v108, s[8:11], s17 offen offset:1024 lds
  v_mfma_f32_16x16x32_bf16 v[48:51], v[132:135], a[44:47], v[48:51]
  ds_read_b64_tr_b16 v[180:181], v124 offset:27648
  ds_read_b64_tr_b16 v[182:183], v124 offset:28160
  buffer_load_dwordx4 v109, s[8:11], s17 offen offset:2048 lds
  v_mfma_f32_16x16x32_bf16 v[4:7], v[136:139], a[40:43], v[4:7]
  ds_read_b128 v[188:191], v125 offset:38912
  ds_read_b64_tr_b16 v[184:185], v124 offset:28672
  ds_read_b64_tr_b16 v[186:187], v124 offset:29184
  v_mfma_f32_16x16x32_bf16 v[52:55], v[136:139], a[44:47], v[52:55]
  ds_read_b64_tr_b16 v[132:133], v120 offset:26624
  s_add_u32 s17, s17, 196608
  v_mfma_f32_16x16x32_bf16 v[8:11], v[140:143], a[40:43], v[8:11]
  ds_read_b64_tr_b16 v[134:135], v120 offset:27136
  s_cmp_eq_u32 s17, s10
  v_mfma_f32_16x16x32_bf16 v[56:59], v[140:143], a[44:47], v[56:59]
  ds_read_b64_tr_b16 v[136:137], v121 offset:26624
  s_cselect_b32 s17, 0, s17
  v_mfma_f32_16x16x32_bf16 v[12:15], v[144:147], a[40:43], v[12:15]
  ds_read_b64_tr_b16 v[138:139], v121 offset:27136
  s_add_u32 m0, s38, 26624
  v_mfma_f32_16x16x32_bf16 v[60:63], v[144:147], a[44:47], v[60:63]
  ds_read_b64_tr_b16 v[140:141], v122 offset:26624
  ds_read_b64_tr_b16 v[142:143], v122 offset:27136
  v_mfma_f32_16x16x32_bf16 v[16:19], v[148:151], a[40:43], v[16:19]
  buffer_load_dwordx4 v107, s[8:11], s17 offen lds
  v_mfma_f32_16x16x32_bf16 v[64:67], v[148:151], a[44:47], v[64:67]
  buffer_load_dwordx4 v108, s[8:11], s17 offen offset:1024 lds
  v_mfma_f32_16x16x32_bf16 v[20:23], v[152:155], a[40:43], v[20:23]
  ds_read_b64_tr_b16 v[144:145], v123 offset:26624
  ds_read_b64_tr_b16 v[146:147], v123 offset:27136
  buffer_load_dwordx4 v109, s[8:11], s17 offen offset:2048 lds
  v_mfma_f32_16x16x32_bf16 v[68:71], v[152:155], a[44:47], v[68:71]
  ds_read_b64_tr_b16 v[148:149], v120 offset:27648
  s_add_u32 s17, s17, 196608
  s_waitcnt lgkmcnt(10)
  v_mfma_f32_16x16x32_bf16 v[24:27], v[156:159], a[40:43], v[24:27]
  ds_read_b64_tr_b16 v[150:151], v120 offset:28160
  ds_read_b64_tr_b16 v[152:153], v121 offset:27648
  v_mfma_f32_16x16x32_bf16 v[72:75], v[156:159], a[44:47], v[72:75]
  ds_read_b64_tr_b16 v[154:155], v121 offset:28160
  s_cmp_eq_u32 s17, s10
  v_mfma_f32_16x16x32_bf16 v[28:31], v[160:163], a[40:43], v[28:31]
  ds_read_b64_tr_b16 v[156:157], v122 offset:27648
  s_cselect_b32 s17, 0, s17
  v_mfma_f32_16x16x32_bf16 v[76:79], v[160:163], a[44:47], v[76:79]
  ds_read_b64_tr_b16 v[158:159], v122 offset:28160
  s_add_u32 m0, s39, 26624
  v_mfma_f32_16x16x32_bf16 v[32:35], a[40:43], v[164:167], v[32:35]
  buffer_load_dword v106, s[4:7], s16 offen sc1 lds
  v_mfma_f32_16x16x32_bf16 v[80:83], a[44:47], v[164:167], v[80:83]
  ds_read_b64_tr_b16 v[160:161], v123 offset:27648
  ds_read_b64_tr_b16 v[162:163], v123 offset:28160
  v_mfma_f32_16x16x32_bf16 v[36:39], a[40:43], v[168:171], v[36:39]
  buffer_load_dwordx4 a[16:19], v105, s[4:7], s16 offen sc1
  v_mfma_f32_16x16x32_bf16 v[84:87], a[44:47], v[168:171], v[84:87]
  buffer_load_dwordx4 a[20:23], v105, s[4:7], s16 offen offset:1024 sc1
  v_mfma_f32_16x16x32_bf16 v[40:43], a[40:43], v[172:175], v[40:43]
  ds_read_b64_tr_b16 v[164:165], v120 offset:28672
  ds_read_b64_tr_b16 v[166:167], v120 offset:29184
  s_add_u32 s16, s16, 131072
  v_mfma_f32_16x16x32_bf16 v[88:91], a[44:47], v[172:175], v[88:91]
  ds_read_b64_tr_b16 v[168:169], v121 offset:28672
  s_bitset0_b32 s16, 20
  v_mfma_f32_16x16x32_bf16 v[44:47], a[40:43], v[176:179], v[44:47]
  ds_read_b64_tr_b16 v[170:171], v121 offset:29184
  ds_read_b64_tr_b16 v[172:173], v122 offset:28672
  v_mfma_f32_16x16x32_bf16 v[92:95], a[44:47], v[176:179], v[92:95]
  s_waitcnt vmcnt(10) lgkmcnt(10)
  s_barrier
  v_mfma_f32_16x16x32_bf16 v[96:99], v[180:183], v[188:191], v[96:99]
  ds_read_b64_tr_b16 v[174:175], v122 offset:29184
  s_add_u32 m0, s38, 39936
  v_mfma_f32_16x16x32_bf16 v[100:103], v[188:191], v[184:187], v[100:103]
  ds_read_b64_tr_b16 a[64:65], v196 offset:0
  buffer_load_dwordx4 v107, s[8:11], s17 offen lds
  v_mfma_f32_16x16x32_bf16 v[0:3], v[132:135], a[48:51], v[0:3]
  ds_read_b64_tr_b16 v[176:177], v123 offset:28672
  ds_read_b64_tr_b16 v[178:179], v123 offset:29184
  buffer_load_dwordx4 v108, s[8:11], s17 offen offset:1024 lds
  v_mfma_f32_16x16x32_bf16 v[48:51], v[132:135], a[52:55], v[48:51]
  ds_read_b64_tr_b16 v[180:181], v124 offset:40960
  ds_read_b64_tr_b16 v[182:183], v124 offset:41472
  ds_read_b64_tr_b16 a[66:67], v196 offset:512
  buffer_load_dwordx4 v109, s[8:11], s17 offen offset:2048 lds
  v_mfma_f32_16x16x32_bf16 v[4:7], v[136:139], a[48:51], v[4:7]
  ds_read_b128 v[188:191], v125 offset:52224
  ds_read_b64_tr_b16 v[184:185], v124 offset:41984
  ds_read_b64_tr_b16 v[186:187], v124 offset:42496
  s_add_u32 s17, s17, 196608
  v_mfma_f32_16x16x32_bf16 v[52:55], v[136:139], a[52:55], v[52:55]
  ds_read_b128 a[68:71], v197 offset:0
  s_cmp_eq_u32 s17, s10
  v_mfma_f32_16x16x32_bf16 v[8:11], v[140:143], a[48:51], v[8:11]
  ds_read_b64_tr_b16 v[132:133], v120 offset:39936
  ds_read_b64_tr_b16 v[134:135], v120 offset:40448
  s_cselect_b32 s17, 0, s17
  v_mfma_f32_16x16x32_bf16 v[56:59], v[140:143], a[52:55], v[56:59]
  ds_read_b64_tr_b16 a[72:73], v196 offset:4096
  s_add_u32 m0, s39, 39936
  v_mfma_f32_16x16x32_bf16 v[12:15], v[144:147], a[48:51], v[12:15]
  ds_read_b64_tr_b16 v[136:137], v121 offset:39936
  ds_read_b64_tr_b16 v[138:139], v121 offset:40448
  buffer_load_dword v106, s[4:7], s16 offen sc1 lds
  v_mfma_f32_16x16x32_bf16 v[60:63], v[144:147], a[52:55], v[60:63]
  ds_read_b64_tr_b16 a[74:75], v196 offset:4608
  buffer_load_dwordx4 a[24:27], v105, s[4:7], s16 offen sc1
  v_mfma_f32_16x16x32_bf16 v[16:19], v[148:151], a[48:51], v[16:19]
  ds_read_b64_tr_b16 v[140:141], v122 offset:39936
  ds_read_b64_tr_b16 v[142:143], v122 offset:40448
  buffer_load_dwordx4 a[28:31], v105, s[4:7], s16 offen offset:1024 sc1
  v_mfma_f32_16x16x32_bf16 v[64:67], v[148:151], a[52:55], v[64:67]
  ds_read_b128 a[76:79], v197 offset:64
  s_add_u32 s16, s16, 131072
  s_waitcnt lgkmcnt(10)
  v_mfma_f32_16x16x32_bf16 v[20:23], v[152:155], a[48:51], v[20:23]
  ds_read_b64_tr_b16 v[144:145], v123 offset:39936
  ds_read_b64_tr_b16 v[146:147], v123 offset:40448
  s_bitset0_b32 s16, 20
  v_mfma_f32_16x16x32_bf16 v[68:71], v[152:155], a[52:55], v[68:71]
  ds_read_b64_tr_b16 a[80:81], v196 offset:8192
  s_add_u32 m0, s38, 53248
  v_mfma_f32_16x16x32_bf16 v[24:27], v[156:159], a[48:51], v[24:27]
  ds_read_b64_tr_b16 v[148:149], v120 offset:40960
  ds_read_b64_tr_b16 v[150:151], v120 offset:41472
  buffer_load_dwordx4 v107, s[8:11], s17 offen lds
  v_mfma_f32_16x16x32_bf16 v[72:75], v[156:159], a[52:55], v[72:75]
  ds_read_b64_tr_b16 a[82:83], v196 offset:8704
  buffer_load_dwordx4 v108, s[8:11], s17 offen offset:1024 lds
  v_mfma_f32_16x16x32_bf16 v[28:31], v[160:163], a[48:51], v[28:31]
  ds_read_b64_tr_b16 v[152:153], v121 offset:40960
  ds_read_b64_tr_b16 v[154:155], v121 offset:41472
  buffer_load_dwordx4 v109, s[8:11], s17 offen offset:2048 lds
  v_mfma_f32_16x16x32_bf16 v[76:79], v[160:163], a[52:55], v[76:79]
  ds_read_b128 a[84:87], v197 offset:128
  s_add_u32 s17, s17, 196608
  v_mfma_f32_16x16x32_bf16 v[32:35], a[48:51], v[164:167], v[32:35]
  ds_read_b64_tr_b16 v[156:157], v122 offset:40960
  ds_read_b64_tr_b16 v[158:159], v122 offset:41472
  s_cmp_eq_u32 s17, s10
  v_mfma_f32_16x16x32_bf16 v[80:83], a[52:55], v[164:167], v[80:83]
  ds_read_b64_tr_b16 a[88:89], v196 offset:12288
  s_cselect_b32 s17, 0, s17
  v_mfma_f32_16x16x32_bf16 v[36:39], a[48:51], v[168:171], v[36:39]
  ds_read_b64_tr_b16 v[160:161], v123 offset:40960
  ds_read_b64_tr_b16 v[162:163], v123 offset:41472
  s_mov_b32 s52, s24
  v_mfma_f32_16x16x32_bf16 v[84:87], a[52:55], v[168:171], v[84:87]
  ds_read_b64_tr_b16 a[90:91], v196 offset:12800
  s_mov_b32 s53, s25
  v_mfma_f32_16x16x32_bf16 v[40:43], a[48:51], v[172:175], v[40:43]
  ds_read_b64_tr_b16 v[164:165], v120 offset:41984
  ds_read_b64_tr_b16 v[166:167], v120 offset:42496
  s_mov_b32 s54, 0x200000
  v_mfma_f32_16x16x32_bf16 v[88:91], a[52:55], v[172:175], v[88:91]
  ds_read_b128 a[92:95], v197 offset:192
  s_mov_b32 s55, 0x20000
  v_mfma_f32_16x16x32_bf16 v[44:47], a[48:51], v[176:179], v[44:47]
  ds_read_b64_tr_b16 v[168:169], v121 offset:41984
  ds_read_b64_tr_b16 v[170:171], v121 offset:42496
  s_lshl_b32 s51, s3, 11
  v_mfma_f32_16x16x32_bf16 v[92:95], a[52:55], v[176:179], v[92:95]
  s_waitcnt vmcnt(24) lgkmcnt(10)
  s_barrier
  v_mfma_f32_16x16x32_bf16 v[96:99], v[180:183], v[188:191], v[96:99]
  ds_read_b64_tr_b16 v[172:173], v122 offset:41984
  ds_read_b64_tr_b16 v[174:175], v122 offset:42496
  s_add_u32 m0, s39, 53248
  v_mfma_f32_16x16x32_bf16 v[100:103], v[188:191], v[184:187], v[100:103]
  ds_read_b64_tr_b16 a[96:97], v196 offset:16384
  buffer_load_dword v106, s[4:7], s16 offen sc1 lds
  v_mfma_f32_16x16x32_bf16 v[0:3], v[132:135], a[56:59], v[0:3]
  ds_read_b64_tr_b16 v[176:177], v123 offset:41984
  ds_read_b64_tr_b16 v[178:179], v123 offset:42496
  v_mfma_f32_16x16x32_bf16 v[192:195], a[64:67], a[68:71], 0
  buffer_load_dwordx4 a[32:35], v105, s[4:7], s16 offen sc1
  v_mfma_f32_16x16x32_bf16 v[48:51], v[132:135], a[60:63], v[48:51]
  ds_read_b64_tr_b16 v[180:181], v118 offset:1024
  ds_read_b64_tr_b16 v[182:183], v118 offset:1536
  ds_read_b64_tr_b16 a[98:99], v196 offset:16896
  v_mfma_f32_16x16x32_bf16 v[4:7], v[136:139], a[56:59], v[4:7]
  ds_read_b128 v[188:191], v119 offset:12288
  ds_read_b64_tr_b16 v[184:185], v118 offset:2048
  ds_read_b64_tr_b16 v[186:187], v118 offset:2560
  buffer_load_dwordx4 a[36:39], v105, s[4:7], s16 offen offset:1024 sc1
  v_mfma_f32_16x16x32_bf16 v[52:55], v[136:139], a[60:63], v[52:55]
  ds_read_b128 a[100:103], v197 offset:256
  s_add_u32 s16, s16, 131072
  v_mfma_f32_16x16x32_bf16 v[8:11], v[140:143], a[56:59], v[8:11]
  ds_read_b64_tr_b16 v[132:133], v114 offset:0
  ds_read_b64_tr_b16 v[134:135], v114 offset:512
  s_bitset0_b32 s16, 20
  v_mfma_f32_16x16x32_bf16 v[56:59], v[140:143], a[60:63], v[56:59]
  ds_read_b64_tr_b16 a[104:105], v196 offset:20480
  s_add_u32 m0, s38, 66560
  v_mfma_f32_16x16x32_bf16 v[12:15], v[144:147], a[56:59], v[12:15]
  ds_read_b64_tr_b16 v[136:137], v115 offset:0
  ds_read_b64_tr_b16 v[138:139], v115 offset:512
  v_mfma_f32_16x16x32_bf16 v[192:195], a[72:75], a[76:79], v[192:195]
  v_mfma_f32_16x16x32_bf16 v[60:63], v[144:147], a[60:63], v[60:63]
  ds_read_b64_tr_b16 a[106:107], v196 offset:20992
  buffer_load_dwordx4 v107, s[8:11], s17 offen lds
  v_mfma_f32_16x16x32_bf16 v[16:19], v[148:151], a[56:59], v[16:19]
  ds_read_b64_tr_b16 v[140:141], v116 offset:0
  ds_read_b64_tr_b16 v[142:143], v116 offset:512
  buffer_load_dwordx4 v108, s[8:11], s17 offen offset:1024 lds
  v_mfma_f32_16x16x32_bf16 v[64:67], v[148:151], a[60:63], v[64:67]
  ds_read_b64_tr_b16 v[144:145], v117 offset:0
  ds_read_b128 a[108:111], v197 offset:320
  v_mfma_f32_16x16x32_bf16 v[20:23], v[152:155], a[56:59], v[20:23]
  ds_read_b64_tr_b16 v[146:147], v117 offset:512
  buffer_load_dwordx4 v109, s[8:11], s17 offen offset:2048 lds
  v_mfma_f32_16x16x32_bf16 v[68:71], v[152:155], a[60:63], v[68:71]
  ds_read_b64_tr_b16 a[112:113], v196 offset:24576
  s_add_u32 s17, s17, 196608
  s_waitcnt lgkmcnt(10)
  v_mfma_f32_16x16x32_bf16 v[24:27], v[156:159], a[56:59], v[24:27]
  ds_read_b64_tr_b16 v[148:149], v114 offset:1024
  ds_read_b64_tr_b16 v[150:151], v114 offset:1536
  v_mfma_f32_16x16x32_bf16 v[192:195], a[80:83], a[84:87], v[192:195]
  s_cmp_eq_u32 s17, s10
  v_mfma_f32_16x16x32_bf16 v[72:75], v[156:159], a[60:63], v[72:75]
  ds_read_b64_tr_b16 v[152:153], v115 offset:1024
  ds_read_b64_tr_b16 a[114:115], v196 offset:25088
  v_mfma_f32_16x16x32_bf16 v[28:31], v[160:163], a[56:59], v[28:31]
  ds_read_b64_tr_b16 v[154:155], v115 offset:1536
  s_cselect_b32 s17, 0, s17
  v_mfma_f32_16x16x32_bf16 v[76:79], v[160:163], a[60:63], v[76:79]
  ds_read_b128 a[116:119], v197 offset:384
  s_add_u32 m0, s39, 66560
  v_mfma_f32_16x16x32_bf16 v[32:35], a[56:59], v[164:167], v[32:35]
  ds_read_b64_tr_b16 v[156:157], v116 offset:1024
  ds_read_b64_tr_b16 v[158:159], v116 offset:1536
  buffer_load_dword v106, s[4:7], s16 offen sc1 lds
  v_mfma_f32_16x16x32_bf16 v[80:83], a[60:63], v[164:167], v[80:83]
  ds_read_b64_tr_b16 a[120:121], v196 offset:28672
  buffer_load_dwordx4 a[40:43], v105, s[4:7], s16 offen sc1
  v_mfma_f32_16x16x32_bf16 v[36:39], a[56:59], v[168:171], v[36:39]
  ds_read_b64_tr_b16 v[160:161], v117 offset:1024
  ds_read_b64_tr_b16 v[162:163], v117 offset:1536
  v_mfma_f32_16x16x32_bf16 v[192:195], a[88:91], a[92:95], v[192:195]
  v_mfma_f32_16x16x32_bf16 v[84:87], a[60:63], v[168:171], v[84:87]
  ds_read_b64_tr_b16 a[122:123], v196 offset:29184
  buffer_load_dwordx4 a[44:47], v105, s[4:7], s16 offen offset:1024 sc1
  v_mfma_f32_16x16x32_bf16 v[40:43], a[56:59], v[172:175], v[40:43]
  ds_read_b64_tr_b16 v[164:165], v114 offset:2048
  ds_read_b64_tr_b16 v[166:167], v114 offset:2560
  s_add_u32 s16, s16, 131072
  v_mfma_f32_16x16x32_bf16 v[88:91], a[60:63], v[172:175], v[88:91]
  ds_read_b64_tr_b16 v[168:169], v115 offset:2048
  ds_read_b128 a[124:127], v197 offset:448
  v_mfma_f32_16x16x32_bf16 v[44:47], a[56:59], v[176:179], v[44:47]
  ds_read_b64_tr_b16 v[170:171], v115 offset:2560
  s_bitset0_b32 s16, 20
  v_mfma_f32_16x16x32_bf16 v[92:95], a[60:63], v[176:179], v[92:95]
  s_waitcnt vmcnt(24) lgkmcnt(10)
  s_barrier
  v_mfma_f32_16x16x32_bf16 v[96:99], v[180:183], v[188:191], v[96:99]
  ds_read_b64_tr_b16 v[172:173], v116 offset:2048
  ds_read_b64_tr_b16 v[174:175], v116 offset:2560
  s_add_u32 m0, s38, 79872
  v_mfma_f32_16x16x32_bf16 v[100:103], v[188:191], v[184:187], v[100:103]
  buffer_load_dwordx4 v107, s[8:11], s17 offen lds
  v_mfma_f32_16x16x32_bf16 v[0:3], v[132:135], a[0:3], v[0:3]
  ds_read_b64_tr_b16 v[176:177], v117 offset:2048
  ds_read_b64_tr_b16 v[178:179], v117 offset:2560
  v_mfma_f32_16x16x32_bf16 v[192:195], a[96:99], a[100:103], v[192:195]
  buffer_load_dwordx4 v108, s[8:11], s17 offen offset:1024 lds
  v_mfma_f32_16x16x32_bf16 v[48:51], v[132:135], a[4:7], v[48:51]
  ds_read_b64_tr_b16 v[180:181], v118 offset:14336
  ds_read_b64_tr_b16 v[182:183], v118 offset:14848
  buffer_load_dwordx4 v109, s[8:11], s17 offen offset:2048 lds
  v_mfma_f32_16x16x32_bf16 v[4:7], v[136:139], a[0:3], v[4:7]
  ds_read_b128 v[188:191], v119 offset:25600
  ds_read_b64_tr_b16 v[184:185], v118 offset:15360
  ds_read_b64_tr_b16 v[186:187], v118 offset:15872
  s_add_u32 s17, s17, 196608
  v_mfma_f32_16x16x32_bf16 v[52:55], v[136:139], a[4:7], v[52:55]
  ds_read_b64_tr_b16 v[132:133], v114 offset:13312
  s_cmp_eq_u32 s17, s10
  v_mfma_f32_16x16x32_bf16 v[8:11], v[140:143], a[0:3], v[8:11]
  ds_read_b64_tr_b16 v[134:135], v114 offset:13824
  s_cselect_b32 s17, 0, s17
  v_mfma_f32_16x16x32_bf16 v[56:59], v[140:143], a[4:7], v[56:59]
  ds_read_b64_tr_b16 v[136:137], v115 offset:13312
  s_add_u32 m0, s39, 79872
  v_mfma_f32_16x16x32_bf16 v[12:15], v[144:147], a[0:3], v[12:15]
  ds_read_b64_tr_b16 v[138:139], v115 offset:13824
  v_mfma_f32_16x16x32_bf16 v[192:195], a[104:107], a[108:111], v[192:195]
  v_mfma_f32_16x16x32_bf16 v[60:63], v[144:147], a[4:7], v[60:63]
  buffer_load_dword v106, s[4:7], s16 offen sc1 lds
  v_mfma_f32_16x16x32_bf16 v[16:19], v[148:151], a[0:3], v[16:19]
  ds_read_b64_tr_b16 v[140:141], v116 offset:13312
  ds_read_b64_tr_b16 v[142:143], v116 offset:13824
  buffer_load_dwordx4 a[48:51], v105, s[4:7], s16 offen sc1
  v_mfma_f32_16x16x32_bf16 v[64:67], v[148:151], a[4:7], v[64:67]
  buffer_load_dwordx4 a[52:55], v105, s[4:7], s16 offen offset:1024 sc1
  v_mfma_f32_16x16x32_bf16 v[20:23], v[152:155], a[0:3], v[20:23]
  ds_read_b64_tr_b16 v[144:145], v117 offset:13312
  ds_read_b64_tr_b16 v[146:147], v117 offset:13824
  s_add_u32 s16, s16, 131072
  v_mfma_f32_16x16x32_bf16 v[68:71], v[152:155], a[4:7], v[68:71]
  ds_read_b64_tr_b16 v[148:149], v114 offset:14336
  s_bitset0_b32 s16, 20
  s_waitcnt lgkmcnt(10)
  v_mfma_f32_16x16x32_bf16 v[24:27], v[156:159], a[0:3], v[24:27]
  ds_read_b64_tr_b16 v[150:151], v114 offset:14848
  v_mfma_f32_16x16x32_bf16 v[192:195], a[112:115], a[116:119], v[192:195]
  s_add_u32 m0, s38, 93184
  v_mfma_f32_16x16x32_bf16 v[72:75], v[156:159], a[4:7], v[72:75]
  buffer_load_dwordx4 v107, s[8:11], s17 offen lds
  v_mfma_f32_16x16x32_bf16 v[28:31], v[160:163], a[0:3], v[28:31]
  ds_read_b64_tr_b16 v[152:153], v115 offset:14336
  ds_read_b64_tr_b16 v[154:155], v115 offset:14848
  v_mfma_f32_16x16x32_bf16 v[76:79], v[160:163], a[4:7], v[76:79]
  buffer_load_dwordx4 v108, s[8:11], s17 offen offset:1024 lds
  v_mfma_f32_16x16x32_bf16 v[32:35], a[0:3], v[164:167], v[32:35]
  ds_read_b64_tr_b16 v[156:157], v116 offset:14336
  ds_read_b64_tr_b16 v[158:159], v116 offset:14848
  buffer_load_dwordx4 v109, s[8:11], s17 offen offset:2048 lds
  v_mfma_f32_16x16x32_bf16 v[80:83], a[4:7], v[164:167], v[80:83]
  ds_read_b64_tr_b16 v[160:161], v117 offset:14336
  s_add_u32 s17, s17, 196608
  v_mfma_f32_16x16x32_bf16 v[36:39], a[0:3], v[168:171], v[36:39]
  ds_read_b64_tr_b16 v[162:163], v117 offset:14848
  v_mfma_f32_16x16x32_bf16 v[192:195], a[120:123], a[124:127], v[192:195]
  s_cmp_eq_u32 s17, s10
  v_mfma_f32_16x16x32_bf16 v[84:87], a[4:7], v[168:171], v[84:87]
  ds_read_b64_tr_b16 v[164:165], v114 offset:15360
  s_cselect_b32 s17, 0, s17
  v_mfma_f32_16x16x32_bf16 v[40:43], a[0:3], v[172:175], v[40:43]
  ds_read_b64_tr_b16 v[166:167], v114 offset:15872
  s_add_u32 s8, s8, s10
  s_addc_u32 s9, s9, 0
  v_mfma_f32_16x16x32_bf16 v[88:91], a[4:7], v[172:175], v[88:91]
  buffer_store_dwordx4 v[244:247], v119, s[92:95], s35 offen offset:3072 sc1
  v_mfma_f32_16x16x32_bf16 v[44:47], a[0:3], v[176:179], v[44:47]
  ds_read_b64_tr_b16 v[168:169], v115 offset:15360
  ds_read_b64_tr_b16 v[170:171], v115 offset:15872
  v_mfma_f32_16x16x32_bf16 v[92:95], a[4:7], v[176:179], v[92:95]
  s_waitcnt vmcnt(28) lgkmcnt(10)
  s_barrier
  v_mfma_f32_16x16x32_bf16 v[96:99], v[180:183], v[188:191], v[96:99]
  ds_read_b64_tr_b16 v[172:173], v116 offset:15360
  ds_read_b64_tr_b16 v[174:175], v116 offset:15872
  s_add_u32 m0, s39, 93184
  v_mfma_f32_16x16x32_bf16 v[100:103], v[188:191], v[184:187], v[100:103]
  buffer_load_dword v106, s[4:7], s16 offen sc1 lds
  v_mfma_f32_16x16x32_bf16 v[0:3], v[132:135], a[8:11], v[0:3]
  ds_read_b64_tr_b16 v[176:177], v117 offset:15360
  ds_read_b64_tr_b16 v[178:179], v117 offset:15872
  v_mfma_f32_16x16x32_bf16 v[48:51], v[132:135], a[12:15], v[48:51]
  ds_read_b64_tr_b16 v[180:181], v118 offset:27648
  ds_read_b64_tr_b16 v[182:183], v118 offset:28160
  buffer_load_dwordx4 a[56:59], v105, s[4:7], s16 offen sc1
  v_mfma_f32_16x16x32_bf16 v[4:7], v[136:139], a[8:11], v[4:7]
  ds_read_b128 v[188:191], v119 offset:38912
  ds_read_b64_tr_b16 v[184:185], v118 offset:28672
  ds_read_b64_tr_b16 v[186:187], v118 offset:29184
  v_mfma_f32_16x16x32_bf16 v[52:55], v[136:139], a[12:15], v[52:55]
  s_bfe_u32 s40, s19, 0x80000
  s_bfe_u32 s41, s19, 0x80008
  s_bfe_u32 s42, s19, 0x80010
  s_bfe_u32 s43, s19, 0x80018
  v_and_or_b32 v192, v192, v198, s40
  v_and_or_b32 v193, v193, v198, s41
  v_and_or_b32 v194, v194, v198, s42
  v_and_or_b32 v195, v195, v198, s43
  buffer_store_dwordx4 v[192:195], v255, s[12:15], s96 offen sc1
  v_mfma_f32_16x16x32_bf16 v[8:11], v[140:143], a[8:11], v[8:11]
  ds_read_b64_tr_b16 v[132:133], v114 offset:26624
  ds_read_b64_tr_b16 v[134:135], v114 offset:27136
  buffer_load_dwordx4 a[60:63], v105, s[4:7], s16 offen offset:1024 sc1
  v_mfma_f32_16x16x32_bf16 v[56:59], v[140:143], a[12:15], v[56:59]
  ds_read_b64_tr_b16 v[136:137], v115 offset:26624
  s_add_u32 s16, s16, 131072
  v_mfma_f32_16x16x32_bf16 v[12:15], v[144:147], a[8:11], v[12:15]
  ds_read_b64_tr_b16 v[138:139], v115 offset:27136
  ds_read_b64_tr_b16 v[140:141], v116 offset:26624
  v_mfma_f32_16x16x32_bf16 v[60:63], v[144:147], a[12:15], v[60:63]
  ds_read_b64_tr_b16 v[142:143], v116 offset:27136
  s_bitset0_b32 s16, 20
  v_mfma_f32_16x16x32_bf16 v[16:19], v[148:151], a[8:11], v[16:19]
  ds_read_b64_tr_b16 v[144:145], v117 offset:26624
  ds_read_b64_tr_b16 v[146:147], v117 offset:27136
  v_mfma_f32_16x16x32_bf16 v[64:67], v[148:151], a[12:15], v[64:67]
  s_add_u32 s4, s4, s6
  s_addc_u32 s5, s5, 0
  s_waitcnt lgkmcnt(10)
  v_mfma_f32_16x16x32_bf16 v[20:23], v[152:155], a[8:11], v[20:23]
  ds_read_b64_tr_b16 v[148:149], v114 offset:27648
  ds_read_b64_tr_b16 v[150:151], v114 offset:28160
  v_mfma_f32_16x16x32_bf16 v[68:71], v[152:155], a[12:15], v[68:71]
  ds_read_b64_tr_b16 v[152:153], v115 offset:27648
  s_add_u32 m0, s39, 0
  v_mfma_f32_16x16x32_bf16 v[24:27], v[156:159], a[8:11], v[24:27]
  ds_read_b64_tr_b16 v[154:155], v115 offset:28160
  v_mfma_f32_16x16x32_bf16 v[72:75], v[156:159], a[12:15], v[72:75]
  buffer_load_dword v106, s[4:7], s16 offen sc1 lds
  v_mfma_f32_16x16x32_bf16 v[28:31], v[160:163], a[8:11], v[28:31]
  ds_read_b64_tr_b16 v[156:157], v116 offset:27648
  ds_read_b64_tr_b16 v[158:159], v116 offset:28160
  v_mfma_f32_16x16x32_bf16 v[76:79], v[160:163], a[12:15], v[76:79]
  buffer_load_dwordx4 a[0:3], v105, s[4:7], s16 offen sc1
  v_mfma_f32_16x16x32_bf16 v[32:35], a[8:11], v[164:167], v[32:35]
  ds_read_b64_tr_b16 v[160:161], v117 offset:27648
  ds_read_b64_tr_b16 v[162:163], v117 offset:28160
  v_mfma_f32_16x16x32_bf16 v[80:83], a[12:15], v[164:167], v[80:83]
  buffer_load_dwordx4 a[4:7], v105, s[4:7], s16 offen offset:1024 sc1
  v_mfma_f32_16x16x32_bf16 v[36:39], a[8:11], v[168:171], v[36:39]
  ds_read_b64_tr_b16 v[164:165], v114 offset:28672
  ds_read_b64_tr_b16 v[166:167], v114 offset:29184
  v_mfma_f32_16x16x32_bf16 v[84:87], a[12:15], v[168:171], v[84:87]
  ds_read_b64_tr_b16 v[168:169], v115 offset:28672
  s_add_u32 s16, s16, 131072
  v_mfma_f32_16x16x32_bf16 v[40:43], a[8:11], v[172:175], v[40:43]
  ds_read_b64_tr_b16 v[170:171], v115 offset:29184
  v_mfma_f32_16x16x32_bf16 v[88:91], a[12:15], v[172:175], v[88:91]
  ds_read_b64_tr_b16 v[172:173], v116 offset:28672
  s_bitset0_b32 s16, 20
  v_mfma_f32_16x16x32_bf16 v[44:47], a[8:11], v[176:179], v[44:47]
  ds_read_b64_tr_b16 v[174:175], v116 offset:29184
  v_mfma_f32_16x16x32_bf16 v[92:95], a[12:15], v[176:179], v[92:95]
  s_waitcnt vmcnt(29) lgkmcnt(10)
  s_barrier
  v_mfma_f32_16x16x32_bf16 v[96:99], v[180:183], v[188:191], v[96:99]
  ds_read_b64_tr_b16 v[176:177], v117 offset:28672
  s_add_u32 m0, s39, 13312
  v_mfma_f32_16x16x32_bf16 v[100:103], v[188:191], v[184:187], v[100:103]
  buffer_load_dword v106, s[4:7], s16 offen sc1 lds
  v_mfma_f32_16x16x32_bf16 v[0:3], v[132:135], a[16:19], v[0:3]
  ds_read_b64_tr_b16 v[178:179], v117 offset:29184
  buffer_load_dwordx4 a[8:11], v105, s[4:7], s16 offen sc1
  v_mfma_f32_16x16x32_bf16 v[48:51], v[132:135], a[20:23], v[48:51]
  ds_read_b64_tr_b16 v[180:181], v118 offset:40960
  ds_read_b64_tr_b16 v[182:183], v118 offset:41472
  buffer_load_dwordx4 a[12:15], v105, s[4:7], s16 offen offset:1024 sc1
  v_mfma_f32_16x16x32_bf16 v[4:7], v[136:139], a[16:19], v[4:7]
  ds_read_b128 v[188:191], v119 offset:52224
  ds_read_b64_tr_b16 v[184:185], v118 offset:41984
  ds_read_b64_tr_b16 v[186:187], v118 offset:42496
  v_mfma_f32_16x16x32_bf16 v[52:55], v[136:139], a[20:23], v[52:55]
  ds_read_b64_tr_b16 v[132:133], v114 offset:39936
  s_add_u32 s16, s16, 131072
  v_mfma_f32_16x16x32_bf16 v[8:11], v[140:143], a[16:19], v[8:11]
  ds_read_b64_tr_b16 v[134:135], v114 offset:40448
  s_bitset0_b32 s16, 20
  v_mfma_f32_16x16x32_bf16 v[56:59], v[140:143], a[20:23], v[56:59]
  ds_read_b64_tr_b16 v[136:137], v115 offset:39936
  s_add_u32 m0, s38, 0
  v_mfma_f32_16x16x32_bf16 v[12:15], v[144:147], a[16:19], v[12:15]
  ds_read_b64_tr_b16 v[138:139], v115 offset:40448
  ds_read_b64_tr_b16 v[140:141], v116 offset:39936
  v_mfma_f32_16x16x32_bf16 v[60:63], v[144:147], a[20:23], v[60:63]
  buffer_load_dwordx4 v107, s[8:11], s17 offen lds
  v_mfma_f32_16x16x32_bf16 v[16:19], v[148:151], a[16:19], v[16:19]
  ds_read_b64_tr_b16 v[142:143], v116 offset:40448
  buffer_load_dwordx4 v108, s[8:11], s17 offen offset:1024 lds
  v_mfma_f32_16x16x32_bf16 v[64:67], v[148:151], a[20:23], v[64:67]
  buffer_load_dwordx4 v109, s[8:11], s17 offen offset:2048 lds
  v_mfma_f32_16x16x32_bf16 v[20:23], v[152:155], a[16:19], v[20:23]
  ds_read_b64_tr_b16 v[144:145], v117 offset:39936
  ds_read_b64_tr_b16 v[146:147], v117 offset:40448
  v_mfma_f32_16x16x32_bf16 v[68:71], v[152:155], a[20:23], v[68:71]
  ds_read_b64_tr_b16 v[148:149], v114 offset:40960
  s_add_u32 s17, s17, 196608
  s_waitcnt lgkmcnt(10)
  v_mfma_f32_16x16x32_bf16 v[24:27], v[156:159], a[16:19], v[24:27]
  ds_read_b64_tr_b16 v[150:151], v114 offset:41472
  s_cmp_eq_u32 s17, s10
  v_mfma_f32_16x16x32_bf16 v[72:75], v[156:159], a[20:23], v[72:75]
  ds_read_b64_tr_b16 v[152:153], v115 offset:40960
  s_cselect_b32 s17, 0, s17
  v_mfma_f32_16x16x32_bf16 v[28:31], v[160:163], a[16:19], v[28:31]
  ds_read_b64_tr_b16 v[154:155], v115 offset:41472
  ds_read_b64_tr_b16 v[156:157], v116 offset:40960
  v_mfma_f32_16x16x32_bf16 v[76:79], v[160:163], a[20:23], v[76:79]
  buffer_load_dword v131, v130, s[56:59], s97 offen
  v_mfma_f32_16x16x32_bf16 v[32:35], a[16:19], v[164:167], v[32:35]
  ds_read_b64_tr_b16 v[158:159], v116 offset:41472
  s_add_u32 m0, s51, 106496
  v_mfma_f32_16x16x32_bf16 v[80:83], a[20:23], v[164:167], v[80:83]
  ds_read_b64_tr_b16 v[160:161], v117 offset:40960
  s_add_u32 s50, s98, 1703936
  v_mfma_f32_16x16x32_bf16 v[36:39], a[16:19], v[168:171], v[36:39]
  ds_read_b64_tr_b16 v[162:163], v117 offset:41472
  ds_read_b64_tr_b16 v[164:165], v114 offset:41984
  v_mfma_f32_16x16x32_bf16 v[84:87], a[20:23], v[168:171], v[84:87]
  ds_read_b64_tr_b16 v[166:167], v114 offset:42496
  s_bitset0_b32 s50, 21
  v_mfma_f32_16x16x32_bf16 v[40:43], a[16:19], v[172:175], v[40:43]
  buffer_load_dwordx4 v248, s[52:55], s50 offen lds
  v_mfma_f32_16x16x32_bf16 v[88:91], a[20:23], v[172:175], v[88:91]
  buffer_load_dwordx4 v249, s[52:55], s50 offen offset:1024 lds
  v_mfma_f32_16x16x32_bf16 v[44:47], a[16:19], v[176:179], v[44:47]
  ds_read_b64_tr_b16 v[168:169], v115 offset:41984
  ds_read_b64_tr_b16 v[170:171], v115 offset:42496
  v_mfma_f32_16x16x32_bf16 v[92:95], a[20:23], v[176:179], v[92:95]
  s_waitcnt vmcnt(32) lgkmcnt(10)
  s_barrier
  v_mfma_f32_16x16x32_bf16 v[96:99], v[180:183], v[188:191], v[96:99]
  ds_read_b64_tr_b16 v[172:173], v116 offset:41984
  ds_read_b64_tr_b16 v[174:175], v116 offset:42496
  v_mfma_f32_16x16x32_bf16 v[100:103], v[188:191], v[184:187], v[100:103]
  ds_read_b64_tr_b16 v[176:177], v117 offset:41984
  ds_read_b64_tr_b16 v[178:179], v117 offset:42496
  v_mfma_f32_16x16x32_bf16 v[0:3], v[132:135], a[24:27], v[0:3]
  ds_read_b64_tr_b16 v[180:181], v124 offset:1024
  ds_read_b64_tr_b16 v[182:183], v124 offset:1536
  v_mfma_f32_16x16x32_bf16 v[48:51], v[132:135], a[28:31], v[48:51]
  ds_read_b128 v[188:191], v125 offset:12288
  ds_read_b64_tr_b16 v[184:185], v124 offset:2048
  v_mfma_f32_16x16x32_bf16 v[4:7], v[136:139], a[24:27], v[4:7]
  ds_read_b64_tr_b16 v[186:187], v124 offset:2560
  ds_read_b64_tr_b16 v[132:133], v120 offset:0
  v_mfma_f32_16x16x32_bf16 v[52:55], v[136:139], a[28:31], v[52:55]
  ds_read_b64_tr_b16 v[134:135], v120 offset:512
  ds_read_b64_tr_b16 v[136:137], v121 offset:0
  v_mfma_f32_16x16x32_bf16 v[8:11], v[140:143], a[24:27], v[8:11]
  ds_read_b64_tr_b16 v[138:139], v121 offset:512
  v_mfma_f32_16x16x32_bf16 v[56:59], v[140:143], a[28:31], v[56:59]
  ds_read_b64_tr_b16 v[140:141], v122 offset:0
  ds_read_b64_tr_b16 v[142:143], v122 offset:512
  v_mfma_f32_16x16x32_bf16 v[12:15], v[144:147], a[24:27], v[12:15]
  v_mfma_f32_16x16x32_bf16 v[60:63], v[144:147], a[28:31], v[60:63]
  ds_read_b64_tr_b16 v[144:145], v123 offset:0
  ds_read_b64_tr_b16 v[146:147], v123 offset:512
  v_mfma_f32_16x16x32_bf16 v[16:19], v[148:151], a[24:27], v[16:19]
  v_mfma_f32_16x16x32_bf16 v[64:67], v[148:151], a[28:31], v[64:67]
  ds_read_b64_tr_b16 v[148:149], v120 offset:1024
  ds_read_b64_tr_b16 v[150:151], v120 offset:1536
  s_waitcnt lgkmcnt(10)
  v_mfma_f32_16x16x32_bf16 v[20:23], v[152:155], a[24:27], v[20:23]
  v_mfma_f32_16x16x32_bf16 v[68:71], v[152:155], a[28:31], v[68:71]
  ds_read_b64_tr_b16 v[152:153], v121 offset:1024
  ds_read_b64_tr_b16 v[154:155], v121 offset:1536
  v_mfma_f32_16x16x32_bf16 v[24:27], v[156:159], a[24:27], v[24:27]
  v_mfma_f32_16x16x32_bf16 v[72:75], v[156:159], a[28:31], v[72:75]
  ds_read_b64_tr_b16 v[156:157], v122 offset:1024
  ds_read_b64_tr_b16 v[158:159], v122 offset:1536
  v_mfma_f32_16x16x32_bf16 v[28:31], v[160:163], a[24:27], v[28:31]
  v_mfma_f32_16x16x32_bf16 v[76:79], v[160:163], a[28:31], v[76:79]
  ds_read_b64_tr_b16 v[160:161], v123 offset:1024
  ds_read_b64_tr_b16 v[162:163], v123 offset:1536
  v_mfma_f32_16x16x32_bf16 v[32:35], a[24:27], v[164:167], v[32:35]
  v_mfma_f32_16x16x32_bf16 v[80:83], a[28:31], v[164:167], v[80:83]
  ds_read_b64_tr_b16 v[164:165], v120 offset:2048
  ds_read_b64_tr_b16 v[166:167], v120 offset:2560
  v_mfma_f32_16x16x32_bf16 v[36:39], a[24:27], v[168:171], v[36:39]
  v_mfma_f32_16x16x32_bf16 v[84:87], a[28:31], v[168:171], v[84:87]
  ds_read_b64_tr_b16 v[168:169], v121 offset:2048
  ds_read_b64_tr_b16 v[170:171], v121 offset:2560
  v_mfma_f32_16x16x32_bf16 v[40:43], a[24:27], v[172:175], v[40:43]
  v_mfma_f32_16x16x32_bf16 v[88:91], a[28:31], v[172:175], v[88:91]
  ds_read_b64_tr_b16 v[172:173], v122 offset:2048
  ds_read_b64_tr_b16 v[174:175], v122 offset:2560
  v_mfma_f32_16x16x32_bf16 v[44:47], a[24:27], v[176:179], v[44:47]
  v_mfma_f32_16x16x32_bf16 v[92:95], a[28:31], v[176:179], v[92:95]
  s_waitcnt vmcnt(26) lgkmcnt(10)
  s_barrier
  v_mfma_f32_16x16x32_bf16 v[96:99], v[180:183], v[188:191], v[96:99]
  ds_read_b64_tr_b16 v[176:177], v123 offset:2048
  ds_read_b64_tr_b16 v[178:179], v123 offset:2560
  v_mfma_f32_16x16x32_bf16 v[100:103], v[188:191], v[184:187], v[100:103]
  ds_read_b64_tr_b16 v[180:181], v124 offset:14336
  ds_read_b64_tr_b16 v[182:183], v124 offset:14848
  v_mfma_f32_16x16x32_bf16 v[0:3], v[132:135], a[32:35], v[0:3]
  ds_read_b128 v[188:191], v125 offset:25600
  ds_read_b64_tr_b16 v[184:185], v124 offset:15360
  v_mfma_f32_16x16x32_bf16 v[48:51], v[132:135], a[36:39], v[48:51]
  ds_read_b64_tr_b16 v[186:187], v124 offset:15872
  ds_read_b64_tr_b16 v[132:133], v120 offset:13312
  v_mfma_f32_16x16x32_bf16 v[4:7], v[136:139], a[32:35], v[4:7]
  ds_read_b64_tr_b16 v[134:135], v120 offset:13824
  v_mfma_f32_16x16x32_bf16 v[52:55], v[136:139], a[36:39], v[52:55]
  ds_read_b64_tr_b16 v[136:137], v121 offset:13312
  ds_read_b64_tr_b16 v[138:139], v121 offset:13824
  v_mfma_f32_16x16x32_bf16 v[8:11], v[140:143], a[32:35], v[8:11]
  v_mfma_f32_16x16x32_bf16 v[56:59], v[140:143], a[36:39], v[56:59]
  ds_read_b64_tr_b16 v[140:141], v122 offset:13312
  ds_read_b64_tr_b16 v[142:143], v122 offset:13824
  v_mfma_f32_16x16x32_bf16 v[12:15], v[144:147], a[32:35], v[12:15]
  v_mfma_f32_16x16x32_bf16 v[60:63], v[144:147], a[36:39], v[60:63]
  ds_read_b64_tr_b16 v[144:145], v123 offset:13312
  ds_read_b64_tr_b16 v[146:147], v123 offset:13824
  v_mfma_f32_16x16x32_bf16 v[16:19], v[148:151], a[32:35], v[16:19]
  v_mfma_f32_16x16x32_bf16 v[64:67], v[148:151], a[36:39], v[64:67]
  ds_read_b64_tr_b16 v[148:149], v120 offset:14336
  ds_read_b64_tr_b16 v[150:151], v120 offset:14848
  v_mfma_f32_16x16x32_bf16 v[20:23], v[152:155], a[32:35], v[20:23]
  v_mfma_f32_16x16x32_bf16 v[68:71], v[152:155], a[36:39], v[68:71]
  ds_read_b64_tr_b16 v[152:153], v121 offset:14336
  ds_read_b64_tr_b16 v[154:155], v121 offset:14848
  s_waitcnt lgkmcnt(10)
  v_mfma_f32_16x16x32_bf16 v[24:27], v[156:159], a[32:35], v[24:27]
  v_mfma_f32_16x16x32_bf16 v[72:75], v[156:159], a[36:39], v[72:75]
  ds_read_b64_tr_b16 v[156:157], v122 offset:14336
  ds_read_b64_tr_b16 v[158:159], v122 offset:14848
  v_mfma_f32_16x16x32_bf16 v[28:31], v[160:163], a[32:35], v[28:31]
  v_mfma_f32_16x16x32_bf16 v[76:79], v[160:163], a[36:39], v[76:79]
  ds_read_b64_tr_b16 v[160:161], v123 offset:14336
  ds_read_b64_tr_b16 v[162:163], v123 offset:14848
  v_mfma_f32_16x16x32_bf16 v[32:35], a[32:35], v[164:167], v[32:35]
  v_mfma_f32_16x16x32_bf16 v[80:83], a[36:39], v[164:167], v[80:83]
  ds_read_b64_tr_b16 v[164:165], v120 offset:15360
  ds_read_b64_tr_b16 v[166:167], v120 offset:15872
  v_mfma_f32_16x16x32_bf16 v[36:39], a[32:35], v[168:171], v[36:39]
  v_mfma_f32_16x16x32_bf16 v[84:87], a[36:39], v[168:171], v[84:87]
  ds_read_b64_tr_b16 v[168:169], v121 offset:15360
  ds_read_b64_tr_b16 v[170:171], v121 offset:15872
  v_mfma_f32_16x16x32_bf16 v[40:43], a[32:35], v[172:175], v[40:43]
  v_mfma_f32_16x16x32_bf16 v[88:91], a[36:39], v[172:175], v[88:91]
  ds_read_b64_tr_b16 v[172:173], v122 offset:15360
  ds_read_b64_tr_b16 v[174:175], v122 offset:15872
  v_mfma_f32_16x16x32_bf16 v[44:47], a[32:35], v[176:179], v[44:47]
  v_mfma_f32_16x16x32_bf16 v[92:95], a[36:39], v[176:179], v[92:95]
  s_waitcnt vmcnt(20) lgkmcnt(10)
  s_barrier
  v_mfma_f32_16x16x32_bf16 v[96:99], v[180:183], v[188:191], v[96:99]
  ds_read_b64_tr_b16 v[176:177], v123 offset:15360
  s_add_u32 m0, s38, 13312
  v_mfma_f32_16x16x32_bf16 v[100:103], v[188:191], v[184:187], v[100:103]
  buffer_load_dwordx4 v107, s[8:11], s17 offen lds
  v_mfma_f32_16x16x32_bf16 v[0:3], v[132:135], a[40:43], v[0:3]
  ds_read_b64_tr_b16 v[178:179], v123 offset:15872
  buffer_load_dwordx4 v108, s[8:11], s17 offen offset:1024 lds
  v_mfma_f32_16x16x32_bf16 v[48:51], v[132:135], a[44:47], v[48:51]
  ds_read_b64_tr_b16 v[180:181], v124 offset:27648
  ds_read_b64_tr_b16 v[182:183], v124 offset:28160
  buffer_load_dwordx4 v109, s[8:11], s17 offen offset:2048 lds
  v_mfma_f32_16x16x32_bf16 v[4:7], v[136:139], a[40:43], v[4:7]
  ds_read_b128 v[188:191], v125 offset:38912
  ds_read_b64_tr_b16 v[184:185], v124 offset:28672
  ds_read_b64_tr_b16 v[186:187], v124 offset:29184
  v_mfma_f32_16x16x32_bf16 v[52:55], v[136:139], a[44:47], v[52:55]
  ds_read_b64_tr_b16 v[132:133], v120 offset:26624
  s_add_u32 s17, s17, 196608
  v_mfma_f32_16x16x32_bf16 v[8:11], v[140:143], a[40:43], v[8:11]
  ds_read_b64_tr_b16 v[134:135], v120 offset:27136
  s_cmp_eq_u32 s17, s10
  v_mfma_f32_16x16x32_bf16 v[56:59], v[140:143], a[44:47], v[56:59]
  ds_read_b64_tr_b16 v[136:137], v121 offset:26624
  s_cselect_b32 s17, 0, s17
  v_mfma_f32_16x16x32_bf16 v[12:15], v[144:147], a[40:43], v[12:15]
  ds_read_b64_tr_b16 v[138:139], v121 offset:27136
  s_add_u32 m0, s38, 26624
  v_mfma_f32_16x16x32_bf16 v[60:63], v[144:147], a[44:47], v[60:63]
  ds_read_b64_tr_b16 v[140:141], v122 offset:26624
  ds_read_b64_tr_b16 v[142:143], v122 offset:27136
  v_mfma_f32_16x16x32_bf16 v[16:19], v[148:151], a[40:43], v[16:19]
  buffer_load_dwordx4 v107, s[8:11], s17 offen lds
  v_mfma_f32_16x16x32_bf16 v[64:67], v[148:151], a[44:47], v[64:67]
  buffer_load_dwordx4 v108, s[8:11], s17 offen offset:1024 lds
  v_mfma_f32_16x16x32_bf16 v[20:23], v[152:155], a[40:43], v[20:23]
  ds_read_b64_tr_b16 v[144:145], v123 offset:26624
  ds_read_b64_tr_b16 v[146:147], v123 offset:27136
  buffer_load_dwordx4 v109, s[8:11], s17 offen offset:2048 lds
  v_mfma_f32_16x16x32_bf16 v[68:71], v[152:155], a[44:47], v[68:71]
  ds_read_b64_tr_b16 v[148:149], v120 offset:27648
  s_add_u32 s17, s17, 196608
  s_waitcnt lgkmcnt(10)
  v_mfma_f32_16x16x32_bf16 v[24:27], v[156:159], a[40:43], v[24:27]
  ds_read_b64_tr_b16 v[150:151], v120 offset:28160
  ds_read_b64_tr_b16 v[152:153], v121 offset:27648
  v_mfma_f32_16x16x32_bf16 v[72:75], v[156:159], a[44:47], v[72:75]
  ds_read_b64_tr_b16 v[154:155], v121 offset:28160
  s_cmp_eq_u32 s17, s10
  v_mfma_f32_16x16x32_bf16 v[28:31], v[160:163], a[40:43], v[28:31]
  ds_read_b64_tr_b16 v[156:157], v122 offset:27648
  s_cselect_b32 s17, 0, s17
  v_mfma_f32_16x16x32_bf16 v[76:79], v[160:163], a[44:47], v[76:79]
  ds_read_b64_tr_b16 v[158:159], v122 offset:28160
  s_add_u32 m0, s39, 26624
  v_mfma_f32_16x16x32_bf16 v[32:35], a[40:43], v[164:167], v[32:35]
  buffer_load_dword v106, s[4:7], s16 offen sc1 lds
  v_mfma_f32_16x16x32_bf16 v[80:83], a[44:47], v[164:167], v[80:83]
  ds_read_b64_tr_b16 v[160:161], v123 offset:27648
  ds_read_b64_tr_b16 v[162:163], v123 offset:28160
  v_mfma_f32_16x16x32_bf16 v[36:39], a[40:43], v[168:171], v[36:39]
  buffer_load_dwordx4 a[16:19], v105, s[4:7], s16 offen sc1
  v_mfma_f32_16x16x32_bf16 v[84:87], a[44:47], v[168:171], v[84:87]
  buffer_load_dwordx4 a[20:23], v105, s[4:7], s16 offen offset:1024 sc1
  v_mfma_f32_16x16x32_bf16 v[40:43], a[40:43], v[172:175], v[40:43]
  ds_read_b64_tr_b16 v[164:165], v120 offset:28672
  ds_read_b64_tr_b16 v[166:167], v120 offset:29184
  s_add_u32 s16, s16, 131072
  v_mfma_f32_16x16x32_bf16 v[88:91], a[44:47], v[172:175], v[88:91]
  ds_read_b64_tr_b16 v[168:169], v121 offset:28672
  s_bitset0_b32 s16, 20
  v_mfma_f32_16x16x32_bf16 v[44:47], a[40:43], v[176:179], v[44:47]
  ds_read_b64_tr_b16 v[170:171], v121 offset:29184
  ds_read_b64_tr_b16 v[172:173], v122 offset:28672
  v_mfma_f32_16x16x32_bf16 v[92:95], a[44:47], v[176:179], v[92:95]
  s_waitcnt vmcnt(21) lgkmcnt(10)
  s_barrier
  v_mfma_f32_16x16x32_bf16 v[96:99], v[180:183], v[188:191], v[96:99]
  ds_read_b64_tr_b16 v[174:175], v122 offset:29184
  s_add_u32 m0, s38, 39936
  v_mfma_f32_16x16x32_bf16 v[100:103], v[188:191], v[184:187], v[100:103]
  buffer_load_dwordx4 v107, s[8:11], s17 offen lds
  v_mfma_f32_16x16x32_bf16 v[0:3], v[132:135], a[48:51], v[0:3]
  ds_read_b64_tr_b16 v[176:177], v123 offset:28672
  ds_read_b64_tr_b16 v[178:179], v123 offset:29184
  buffer_load_dwordx4 v108, s[8:11], s17 offen offset:1024 lds
  v_mfma_f32_16x16x32_bf16 v[48:51], v[132:135], a[52:55], v[48:51]
  ds_read_b64_tr_b16 v[180:181], v124 offset:40960
  ds_read_b64_tr_b16 v[182:183], v124 offset:41472
  buffer_load_dwordx4 v109, s[8:11], s17 offen offset:2048 lds
  v_mfma_f32_16x16x32_bf16 v[4:7], v[136:139], a[48:51], v[4:7]
  ds_read_b128 v[188:191], v125 offset:52224
  ds_read_b64_tr_b16 v[184:185], v124 offset:41984
  ds_read_b64_tr_b16 v[186:187], v124 offset:42496
  v_mfma_f32_16x16x32_bf16 v[52:55], v[136:139], a[52:55], v[52:55]
  ds_read_b64_tr_b16 v[132:133], v120 offset:39936
  s_add_u32 s17, s17, 196608
  v_mfma_f32_16x16x32_bf16 v[8:11], v[140:143], a[48:51], v[8:11]
  ds_read_b64_tr_b16 v[134:135], v120 offset:40448
  s_cmp_eq_u32 s17, s10
  v_mfma_f32_16x16x32_bf16 v[56:59], v[140:143], a[52:55], v[56:59]
  ds_read_b64_tr_b16 v[136:137], v121 offset:39936
  s_cselect_b32 s17, 0, s17
  v_mfma_f32_16x16x32_bf16 v[12:15], v[144:147], a[48:51], v[12:15]
  ds_read_b64_tr_b16 v[138:139], v121 offset:40448
  s_add_u32 m0, s39, 39936
  v_mfma_f32_16x16x32_bf16 v[60:63], v[144:147], a[52:55], v[60:63]
  ds_read_b64_tr_b16 v[140:141], v122 offset:39936
  ds_read_b64_tr_b16 v[142:143], v122 offset:40448
  v_mfma_f32_16x16x32_bf16 v[16:19], v[148:151], a[48:51], v[16:19]
  buffer_load_dword v106, s[4:7], s16 offen sc1 lds
  v_mfma_f32_16x16x32_bf16 v[64:67], v[148:151], a[52:55], v[64:67]
  buffer_load_dwordx4 a[24:27], v105, s[4:7], s16 offen sc1
  s_waitcnt lgkmcnt(10)
  v_mfma_f32_16x16x32_bf16 v[20:23], v[152:155], a[48:51], v[20:23]
  ds_read_b64_tr_b16 v[144:145], v123 offset:39936
  ds_read_b64_tr_b16 v[146:147], v123 offset:40448
  buffer_load_dwordx4 a[28:31], v105, s[4:7], s16 offen offset:1024 sc1
  v_mfma_f32_16x16x32_bf16 v[68:71], v[152:155], a[52:55], v[68:71]
  ds_read_b64_tr_b16 v[148:149], v120 offset:40960
  s_add_u32 s16, s16, 131072
  v_mfma_f32_16x16x32_bf16 v[24:27], v[156:159], a[48:51], v[24:27]
  ds_read_b64_tr_b16 v[150:151], v120 offset:41472
  ds_read_b64_tr_b16 v[152:153], v121 offset:40960
  v_mfma_f32_16x16x32_bf16 v[72:75], v[156:159], a[52:55], v[72:75]
  ds_read_b64_tr_b16 v[154:155], v121 offset:41472
  s_bitset0_b32 s16, 20
  v_mfma_f32_16x16x32_bf16 v[28:31], v[160:163], a[48:51], v[28:31]
  ds_read_b64_tr_b16 v[156:157], v122 offset:40960
  s_add_u32 m0, s38, 53248
  v_mfma_f32_16x16x32_bf16 v[76:79], v[160:163], a[52:55], v[76:79]
  buffer_load_dwordx4 v107, s[8:11], s17 offen lds
  v_mfma_f32_16x16x32_bf16 v[32:35], a[48:51], v[164:167], v[32:35]
  ds_read_b64_tr_b16 v[158:159], v122 offset:41472
  buffer_load_dwordx4 v108, s[8:11], s17 offen offset:1024 lds
  v_mfma_f32_16x16x32_bf16 v[80:83], a[52:55], v[164:167], v[80:83]
  ds_read_b64_tr_b16 v[160:161], v123 offset:40960
  ds_read_b64_tr_b16 v[162:163], v123 offset:41472
  v_mfma_f32_16x16x32_bf16 v[36:39], a[48:51], v[168:171], v[36:39]
  buffer_load_dwordx4 v109, s[8:11], s17 offen offset:2048 lds
  v_mfma_f32_16x16x32_bf16 v[84:87], a[52:55], v[168:171], v[84:87]
  ds_read_b64_tr_b16 v[164:165], v120 offset:41984
  s_add_u32 s17, s17, 196608
  v_mfma_f32_16x16x32_bf16 v[40:43], a[48:51], v[172:175], v[40:43]
  ds_read_b64_tr_b16 v[166:167], v120 offset:42496
  s_cmp_eq_u32 s17, s10
  v_mfma_f32_16x16x32_bf16 v[88:91], a[52:55], v[172:175], v[88:91]
  ds_read_b64_tr_b16 v[168:169], v121 offset:41984
  s_cselect_b32 s17, 0, s17
  v_mfma_f32_16x16x32_bf16 v[44:47], a[48:51], v[176:179], v[44:47]
  ds_read_b64_tr_b16 v[170:171], v121 offset:42496
  ds_read_b64_tr_b16 v[172:173], v122 offset:41984
  v_mfma_f32_16x16x32_bf16 v[92:95], a[52:55], v[176:179], v[92:95]
  s_waitcnt vmcnt(21) lgkmcnt(10)
  s_barrier
  v_mfma_f32_16x16x32_bf16 v[96:99], v[180:183], v[188:191], v[96:99]
  ds_read_b64_tr_b16 v[174:175], v122 offset:42496
  s_add_u32 m0, s39, 53248
  v_mfma_f32_16x16x32_bf16 v[100:103], v[188:191], v[184:187], v[100:103]
  buffer_load_dword v106, s[4:7], s16 offen sc1 lds
  v_mfma_f32_16x16x32_bf16 v[0:3], v[132:135], a[56:59], v[0:3]
  ds_read_b64_tr_b16 v[176:177], v123 offset:41984
  ds_read_b64_tr_b16 v[178:179], v123 offset:42496
  buffer_load_dwordx4 a[32:35], v105, s[4:7], s16 offen sc1
  v_mfma_f32_16x16x32_bf16 v[48:51], v[132:135], a[60:63], v[48:51]
  ds_read_b64_tr_b16 v[180:181], v118 offset:1024
  ds_read_b64_tr_b16 v[182:183], v118 offset:1536
  buffer_load_dwordx4 a[36:39], v105, s[4:7], s16 offen offset:1024 sc1
  v_mfma_f32_16x16x32_bf16 v[4:7], v[136:139], a[56:59], v[4:7]
  ds_read_b128 v[188:191], v119 offset:12288
  ds_read_b64_tr_b16 v[184:185], v118 offset:2048
  ds_read_b64_tr_b16 v[186:187], v118 offset:2560
  v_mfma_f32_16x16x32_bf16 v[52:55], v[136:139], a[60:63], v[52:55]
  ds_read_b64_tr_b16 v[132:133], v114 offset:0
  s_add_u32 s16, s16, 131072
  v_mfma_f32_16x16x32_bf16 v[8:11], v[140:143], a[56:59], v[8:11]
  ds_read_b64_tr_b16 v[134:135], v114 offset:512
  s_bitset0_b32 s16, 20
  v_mfma_f32_16x16x32_bf16 v[56:59], v[140:143], a[60:63], v[56:59]
  ds_read_b64_tr_b16 v[136:137], v115 offset:0
  s_add_u32 m0, s38, 66560
  v_mfma_f32_16x16x32_bf16 v[12:15], v[144:147], a[56:59], v[12:15]
  ds_read_b64_tr_b16 v[138:139], v115 offset:512
  ds_read_b64_tr_b16 v[140:141], v116 offset:0
  v_mfma_f32_16x16x32_bf16 v[60:63], v[144:147], a[60:63], v[60:63]
  buffer_load_dwordx4 v107, s[8:11], s17 offen lds
  v_mfma_f32_16x16x32_bf16 v[16:19], v[148:151], a[56:59], v[16:19]
  ds_read_b64_tr_b16 v[142:143], v116 offset:512
  buffer_load_dwordx4 v108, s[8:11], s17 offen offset:1024 lds
  v_mfma_f32_16x16x32_bf16 v[64:67], v[148:151], a[60:63], v[64:67]
  buffer_load_dwordx4 v109, s[8:11], s17 offen offset:2048 lds
  s_waitcnt lgkmcnt(10)
  v_mfma_f32_16x16x32_bf16 v[20:23], v[152:155], a[56:59], v[20:23]
  ds_read_b64_tr_b16 v[144:145], v117 offset:0
  ds_read_b64_tr_b16 v[146:147], v117 offset:512
  v_mfma_f32_16x16x32_bf16 v[68:71], v[152:155], a[60:63], v[68:71]
  ds_read_b64_tr_b16 v[148:149], v114 offset:1024
  s_add_u32 s17, s17, 196608
  v_mfma_f32_16x16x32_bf16 v[24:27], v[156:159], a[56:59], v[24:27]
  ds_read_b64_tr_b16 v[150:151], v114 offset:1536
  s_cmp_eq_u32 s17, s10
  v_mfma_f32_16x16x32_bf16 v[72:75], v[156:159], a[60:63], v[72:75]
  ds_read_b64_tr_b16 v[152:153], v115 offset:1024
  s_cselect_b32 s17, 0, s17
  v_mfma_f32_16x16x32_bf16 v[28:31], v[160:163], a[56:59], v[28:31]
  ds_read_b64_tr_b16 v[154:155], v115 offset:1536
  ds_read_b64_tr_b16 v[156:157], v116 offset:1024
  v_mfma_f32_16x16x32_bf16 v[76:79], v[160:163], a[60:63], v[76:79]
  ds_read_b64_tr_b16 v[158:159], v116 offset:1536
  s_add_u32 m0, s39, 66560
  v_mfma_f32_16x16x32_bf16 v[32:35], a[56:59], v[164:167], v[32:35]
  buffer_load_dword v106, s[4:7], s16 offen sc1 lds
  v_mfma_f32_16x16x32_bf16 v[80:83], a[60:63], v[164:167], v[80:83]
  buffer_load_dwordx4 a[40:43], v105, s[4:7], s16 offen sc1
  v_mfma_f32_16x16x32_bf16 v[36:39], a[56:59], v[168:171], v[36:39]
  ds_read_b64_tr_b16 v[160:161], v117 offset:1024
  ds_read_b64_tr_b16 v[162:163], v117 offset:1536
  v_mfma_f32_16x16x32_bf16 v[84:87], a[60:63], v[168:171], v[84:87]
  buffer_load_dwordx4 a[44:47], v105, s[4:7], s16 offen offset:1024 sc1
  v_mfma_f32_16x16x32_bf16 v[40:43], a[56:59], v[172:175], v[40:43]
  ds_read_b64_tr_b16 v[164:165], v114 offset:2048
  ds_read_b64_tr_b16 v[166:167], v114 offset:2560
  s_add_u32 s16, s16, 131072
  v_mfma_f32_16x16x32_bf16 v[88:91], a[60:63], v[172:175], v[88:91]
  ds_read_b64_tr_b16 v[168:169], v115 offset:2048
  s_bitset0_b32 s16, 20
  v_mfma_f32_16x16x32_bf16 v[44:47], a[56:59], v[176:179], v[44:47]
  ds_read_b64_tr_b16 v[170:171], v115 offset:2560
  ds_read_b64_tr_b16 v[172:173], v116 offset:2048
  v_mfma_f32_16x16x32_bf16 v[92:95], a[60:63], v[176:179], v[92:95]
  s_waitcnt vmcnt(24) lgkmcnt(10)
  s_barrier
  v_mfma_f32_16x16x32_bf16 v[96:99], v[180:183], v[188:191], v[96:99]
  ds_read_b64_tr_b16 v[174:175], v116 offset:2560
  s_add_u32 m0, s38, 79872
  v_mfma_f32_16x16x32_bf16 v[100:103], v[188:191], v[184:187], v[100:103]
  buffer_load_dwordx4 v107, s[8:11], s17 offen lds
  v_mfma_f32_16x16x32_bf16 v[0:3], v[132:135], a[0:3], v[0:3]
  ds_read_b64_tr_b16 v[176:177], v117 offset:2048
  ds_read_b64_tr_b16 v[178:179], v117 offset:2560
  buffer_load_dwordx4 v108, s[8:11], s17 offen offset:1024 lds
  v_mfma_f32_16x16x32_bf16 v[48:51], v[132:135], a[4:7], v[48:51]
  ds_read_b64_tr_b16 v[180:181], v118 offset:14336
  ds_read_b64_tr_b16 v[182:183], v118 offset:14848
  buffer_load_dwordx4 v109, s[8:11], s17 offen offset:2048 lds
  v_mfma_f32_16x16x32_bf16 v[4:7], v[136:139], a[0:3], v[4:7]
  ds_read_b128 v[188:191], v119 offset:25600
  ds_read_b64_tr_b16 v[184:185], v118 offset:15360
  ds_read_b64_tr_b16 v[186:187], v118 offset:15872
  v_mfma_f32_16x16x32_bf16 v[52:55], v[136:139], a[4:7], v[52:55]
  ds_read_b64_tr_b16 v[132:133], v114 offset:13312
  s_add_u32 s17, s17, 196608
  v_mfma_f32_16x16x32_bf16 v[8:11], v[140:143], a[0:3], v[8:11]
  ds_read_b64_tr_b16 v[134:135], v114 offset:13824
  s_cmp_eq_u32 s17, s10
  v_mfma_f32_16x16x32_bf16 v[56:59], v[140:143], a[4:7], v[56:59]
  ds_read_b64_tr_b16 v[136:137], v115 offset:13312
  s_cselect_b32 s17, 0, s17
  v_mfma_f32_16x16x32_bf16 v[12:15], v[144:147], a[0:3], v[12:15]
  ds_read_b64_tr_b16 v[138:139], v115 offset:13824
  s_add_u32 m0, s39, 79872
  v_mfma_f32_16x16x32_bf16 v[60:63], v[144:147], a[4:7], v[60:63]
  ds_read_b64_tr_b16 v[140:141], v116 offset:13312
  ds_read_b64_tr_b16 v[142:143], v116 offset:13824
  v_mfma_f32_16x16x32_bf16 v[16:19], v[148:151], a[0:3], v[16:19]
  buffer_load_dword v106, s[4:7], s16 offen sc1 lds
  v_mfma_f32_16x16x32_bf16 v[64:67], v[148:151], a[4:7], v[64:67]
  buffer_load_dwordx4 a[48:51], v105, s[4:7], s16 offen sc1
  s_waitcnt lgkmcnt(10)
  v_mfma_f32_16x16x32_bf16 v[20:23], v[152:155], a[0:3], v[20:23]
  ds_read_b64_tr_b16 v[144:145], v117 offset:13312
  ds_read_b64_tr_b16 v[146:147], v117 offset:13824
  buffer_load_dwordx4 a[52:55], v105, s[4:7], s16 offen offset:1024 sc1
  v_mfma_f32_16x16x32_bf16 v[68:71], v[152:155], a[4:7], v[68:71]
  ds_read_b64_tr_b16 v[148:149], v114 offset:14336
  s_add_u32 s16, s16, 131072
  v_mfma_f32_16x16x32_bf16 v[24:27], v[156:159], a[0:3], v[24:27]
  ds_read_b64_tr_b16 v[150:151], v114 offset:14848
  ds_read_b64_tr_b16 v[152:153], v115 offset:14336
  v_mfma_f32_16x16x32_bf16 v[72:75], v[156:159], a[4:7], v[72:75]
  ds_read_b64_tr_b16 v[154:155], v115 offset:14848
  s_bitset0_b32 s16, 20
  v_mfma_f32_16x16x32_bf16 v[28:31], v[160:163], a[0:3], v[28:31]
  ds_read_b64_tr_b16 v[156:157], v116 offset:14336
  s_add_u32 m0, s38, 93184
  v_mfma_f32_16x16x32_bf16 v[76:79], v[160:163], a[4:7], v[76:79]
  buffer_load_dwordx4 v107, s[8:11], s17 offen lds
  v_mfma_f32_16x16x32_bf16 v[32:35], a[0:3], v[164:167], v[32:35]
  ds_read_b64_tr_b16 v[158:159], v116 offset:14848
  buffer_load_dwordx4 v108, s[8:11], s17 offen offset:1024 lds
  v_mfma_f32_16x16x32_bf16 v[80:83], a[4:7], v[164:167], v[80:83]
  ds_read_b64_tr_b16 v[160:161], v117 offset:14336
  ds_read_b64_tr_b16 v[162:163], v117 offset:14848
  v_mfma_f32_16x16x32_bf16 v[36:39], a[0:3], v[168:171], v[36:39]
  buffer_load_dwordx4 v109, s[8:11], s17 offen offset:2048 lds
  v_mfma_f32_16x16x32_bf16 v[84:87], a[4:7], v[168:171], v[84:87]
  ds_read_b64_tr_b16 v[164:165], v114 offset:15360
  s_add_u32 s17, s17, 196608
  v_mfma_f32_16x16x32_bf16 v[40:43], a[0:3], v[172:175], v[40:43]
  ds_read_b64_tr_b16 v[166:167], v114 offset:15872
  s_cmp_eq_u32 s17, s10
  v_mfma_f32_16x16x32_bf16 v[88:91], a[4:7], v[172:175], v[88:91]
  ds_read_b64_tr_b16 v[168:169], v115 offset:15360
  s_cselect_b32 s17, 0, s17
  v_mfma_f32_16x16x32_bf16 v[44:47], a[0:3], v[176:179], v[44:47]
  ds_read_b64_tr_b16 v[170:171], v115 offset:15872
  ds_read_b64_tr_b16 v[172:173], v116 offset:15360
  v_mfma_f32_16x16x32_bf16 v[92:95], a[4:7], v[176:179], v[92:95]
  s_waitcnt vmcnt(27) lgkmcnt(10)
  s_barrier
  v_mfma_f32_16x16x32_bf16 v[96:99], v[180:183], v[188:191], v[96:99]
  ds_read_b64_tr_b16 v[174:175], v116 offset:15872
  s_add_u32 m0, s39, 93184
  v_mfma_f32_16x16x32_bf16 v[100:103], v[188:191], v[184:187], v[100:103]
  buffer_load_dword v106, s[4:7], s16 offen sc1 lds
  v_mfma_f32_16x16x32_bf16 v[0:3], v[132:135], a[8:11], v[0:3]
  ds_read_b64_tr_b16 v[176:177], v117 offset:15360
  ds_read_b64_tr_b16 v[178:179], v117 offset:15872
  buffer_load_dwordx4 a[56:59], v105, s[4:7], s16 offen sc1
  v_mfma_f32_16x16x32_bf16 v[48:51], v[132:135], a[12:15], v[48:51]
  ds_read_b64_tr_b16 v[180:181], v118 offset:27648
  ds_read_b64_tr_b16 v[182:183], v118 offset:28160
  buffer_load_dwordx4 a[60:63], v105, s[4:7], s16 offen offset:1024 sc1
  v_mfma_f32_16x16x32_bf16 v[4:7], v[136:139], a[8:11], v[4:7]
  ds_read_b128 v[188:191], v119 offset:38912
  ds_read_b64_tr_b16 v[184:185], v118 offset:28672
  ds_read_b64_tr_b16 v[186:187], v118 offset:29184
  s_add_u32 s16, s16, 131072
  v_mfma_f32_16x16x32_bf16 v[52:55], v[136:139], a[12:15], v[52:55]
  ds_read_b64_tr_b16 v[132:133], v114 offset:26624
  s_bitset0_b32 s16, 20
  v_mfma_f32_16x16x32_bf16 v[8:11], v[140:143], a[8:11], v[8:11]
  ds_read_b64_tr_b16 v[134:135], v114 offset:27136
  ds_read_b64_tr_b16 v[136:137], v115 offset:26624
  v_mfma_f32_16x16x32_bf16 v[56:59], v[140:143], a[12:15], v[56:59]
  ds_read_b64_tr_b16 v[138:139], v115 offset:27136
  s_add_u32 m0, s51, 0
  v_mfma_f32_16x16x32_bf16 v[12:15], v[144:147], a[8:11], v[12:15]
  ds_read_b64_tr_b16 v[140:141], v116 offset:26624
  s_add_u32 s50, s98, 0
  v_mfma_f32_16x16x32_bf16 v[60:63], v[144:147], a[12:15], v[60:63]
  ds_read_b64_tr_b16 v[142:143], v116 offset:27136
  s_bitset0_b32 s50, 21
  v_mfma_f32_16x16x32_bf16 v[16:19], v[148:151], a[8:11], v[16:19]
  buffer_load_dwordx4 v248, s[52:55], s50 offen lds
  v_mfma_f32_16x16x32_bf16 v[64:67], v[148:151], a[12:15], v[64:67]
  buffer_load_dwordx4 v249, s[52:55], s50 offen offset:1024 lds
  s_waitcnt lgkmcnt(10)
  v_mfma_f32_16x16x32_bf16 v[20:23], v[152:155], a[8:11], v[20:23]
  ds_read_b64_tr_b16 v[144:145], v117 offset:26624
  ds_read_b64_tr_b16 v[146:147], v117 offset:27136
  v_mfma_f32_16x16x32_bf16 v[68:71], v[152:155], a[12:15], v[68:71]
  ds_read_b64_tr_b16 v[148:149], v114 offset:27648
  s_add_u32 m0, s51, 114688
  v_mfma_f32_16x16x32_bf16 v[24:27], v[156:159], a[8:11], v[24:27]
  ds_read_b64_tr_b16 v[150:151], v114 offset:28160
  s_add_u32 s50, s98, 1835008
  v_mfma_f32_16x16x32_bf16 v[72:75], v[156:159], a[12:15], v[72:75]
  ds_read_b64_tr_b16 v[152:153], v115 offset:27648
  s_bitset0_b32 s50, 21
  v_mfma_f32_16x16x32_bf16 v[28:31], v[160:163], a[8:11], v[28:31]
  ds_read_b64_tr_b16 v[154:155], v115 offset:28160
  buffer_load_dwordx4 v248, s[52:55], s50 offen lds
  v_mfma_f32_16x16x32_bf16 v[76:79], v[160:163], a[12:15], v[76:79]
  buffer_load_dwordx4 v249, s[52:55], s50 offen offset:1024 lds
  v_mfma_f32_16x16x32_bf16 v[32:35], a[8:11], v[164:167], v[32:35]
  ds_read_b64_tr_b16 v[156:157], v116 offset:27648
  ds_read_b64_tr_b16 v[158:159], v116 offset:28160
  v_mfma_f32_16x16x32_bf16 v[80:83], a[12:15], v[164:167], v[80:83]
  ds_read_b64_tr_b16 v[160:161], v117 offset:27648
  s_add_u32 m0, s51, 122880
  v_mfma_f32_16x16x32_bf16 v[36:39], a[8:11], v[168:171], v[36:39]
  ds_read_b64_tr_b16 v[162:163], v117 offset:28160
  s_add_u32 s50, s98, 1966080
  v_mfma_f32_16x16x32_bf16 v[84:87], a[12:15], v[168:171], v[84:87]
  ds_read_b64_tr_b16 v[164:165], v114 offset:28672
  s_bitset0_b32 s50, 21
  v_mfma_f32_16x16x32_bf16 v[40:43], a[8:11], v[172:175], v[40:43]
  ds_read_b64_tr_b16 v[166:167], v114 offset:29184
  buffer_load_dwordx4 v248, s[52:55], s50 offen lds
  v_mfma_f32_16x16x32_bf16 v[88:91], a[12:15], v[172:175], v[88:91]
  buffer_load_dwordx4 v249, s[52:55], s50 offen offset:1024 lds
  v_mfma_f32_16x16x32_bf16 v[44:47], a[8:11], v[176:179], v[44:47]
  ds_read_b64_tr_b16 v[168:169], v115 offset:28672
  ds_read_b64_tr_b16 v[170:171], v115 offset:29184
  v_mfma_f32_16x16x32_bf16 v[92:95], a[12:15], v[176:179], v[92:95]
  s_waitcnt vmcnt(30) lgkmcnt(10)
  s_barrier
  v_mfma_f32_16x16x32_bf16 v[96:99], v[180:183], v[188:191], v[96:99]
  ds_read_b64_tr_b16 v[172:173], v116 offset:28672
  ds_read_b64_tr_b16 v[174:175], v116 offset:29184
  s_add_u32 m0, s51, 8192
  v_mfma_f32_16x16x32_bf16 v[100:103], v[188:191], v[184:187], v[100:103]
  ds_read_b64_tr_b16 v[176:177], v117 offset:28672
  ds_read_b64_tr_b16 v[178:179], v117 offset:29184
  v_mfma_f32_16x16x32_bf16 v[0:3], v[132:135], a[16:19], v[0:3]
  ds_read_b64_tr_b16 v[180:181], v118 offset:40960
  s_add_u32 s50, s98, 131072
  v_mfma_f32_16x16x32_bf16 v[48:51], v[132:135], a[20:23], v[48:51]
  ds_read_b64_tr_b16 v[182:183], v118 offset:41472
  ds_read_b128 v[188:191], v119 offset:52224
  v_mfma_f32_16x16x32_bf16 v[4:7], v[136:139], a[16:19], v[4:7]
  ds_read_b64_tr_b16 v[184:185], v118 offset:41984
  ds_read_b64_tr_b16 v[186:187], v118 offset:42496
  v_mfma_f32_16x16x32_bf16 v[52:55], v[136:139], a[20:23], v[52:55]
  ds_read_b64_tr_b16 v[132:133], v114 offset:39936
  s_bitset0_b32 s50, 21
  v_mfma_f32_16x16x32_bf16 v[8:11], v[140:143], a[16:19], v[8:11]
  ds_read_b64_tr_b16 v[134:135], v114 offset:40448
  ds_read_b64_tr_b16 v[136:137], v115 offset:39936
  v_mfma_f32_16x16x32_bf16 v[56:59], v[140:143], a[20:23], v[56:59]
  buffer_load_dwordx4 v248, s[52:55], s50 offen lds
  v_mfma_f32_16x16x32_bf16 v[12:15], v[144:147], a[16:19], v[12:15]
  ds_read_b64_tr_b16 v[138:139], v115 offset:40448
  ds_read_b64_tr_b16 v[140:141], v116 offset:39936
  v_mfma_f32_16x16x32_bf16 v[60:63], v[144:147], a[20:23], v[60:63]
  ds_read_b64_tr_b16 v[142:143], v116 offset:40448
  ds_read_b64_tr_b16 v[144:145], v117 offset:39936
  v_mfma_f32_16x16x32_bf16 v[16:19], v[148:151], a[16:19], v[16:19]
  buffer_load_dwordx4 v249, s[52:55], s50 offen offset:1024 lds
  v_mfma_f32_16x16x32_bf16 v[64:67], v[148:151], a[20:23], v[64:67]
  ds_read_b64_tr_b16 v[146:147], v117 offset:40448
  ds_read_b64_tr_b16 v[148:149], v114 offset:40960
  s_waitcnt lgkmcnt(10)
  v_mfma_f32_16x16x32_bf16 v[20:23], v[152:155], a[16:19], v[20:23]
  ds_read_b64_tr_b16 v[150:151], v114 offset:41472
  s_add_u32 m0, s51, 16384
  v_mfma_f32_16x16x32_bf16 v[68:71], v[152:155], a[20:23], v[68:71]
  ds_read_b64_tr_b16 v[152:153], v115 offset:40960
  ds_read_b64_tr_b16 v[154:155], v115 offset:41472
  v_mfma_f32_16x16x32_bf16 v[24:27], v[156:159], a[16:19], v[24:27]
  v_mfma_f32_16x16x32_bf16 v[72:75], v[156:159], a[20:23], v[72:75]
  ds_read_b64_tr_b16 v[156:157], v116 offset:40960
  s_add_u32 s50, s98, 262144
  v_mfma_f32_16x16x32_bf16 v[28:31], v[160:163], a[16:19], v[28:31]
  ds_read_b64_tr_b16 v[158:159], v116 offset:41472
  v_mfma_f32_16x16x32_bf16 v[76:79], v[160:163], a[20:23], v[76:79]
  ds_read_b64_tr_b16 v[160:161], v117 offset:40960
  s_bitset0_b32 s50, 21
  v_mfma_f32_16x16x32_bf16 v[32:35], a[16:19], v[164:167], v[32:35]
  ds_read_b64_tr_b16 v[162:163], v117 offset:41472
  v_mfma_f32_16x16x32_bf16 v[80:83], a[20:23], v[164:167], v[80:83]
  ds_read_b64_tr_b16 v[164:165], v114 offset:41984
  ds_read_b64_tr_b16 v[166:167], v114 offset:42496
  v_mfma_f32_16x16x32_bf16 v[36:39], a[16:19], v[168:171], v[36:39]
  buffer_load_dwordx4 v248, s[52:55], s50 offen lds
  v_mfma_f32_16x16x32_bf16 v[84:87], a[20:23], v[168:171], v[84:87]
  ds_read_b64_tr_b16 v[168:169], v115 offset:41984
  ds_read_b64_tr_b16 v[170:171], v115 offset:42496
  v_mfma_f32_16x16x32_bf16 v[40:43], a[16:19], v[172:175], v[40:43]
  buffer_load_dwordx4 v249, s[52:55], s50 offen offset:1024 lds
  v_mfma_f32_16x16x32_bf16 v[88:91], a[20:23], v[172:175], v[88:91]
  ds_read_b64_tr_b16 v[172:173], v116 offset:41984
  ds_read_b64_tr_b16 v[174:175], v116 offset:42496
  v_mfma_f32_16x16x32_bf16 v[44:47], a[16:19], v[176:179], v[44:47]
  v_mfma_f32_16x16x32_bf16 v[92:95], a[20:23], v[176:179], v[92:95]
  s_waitcnt vmcnt(28) lgkmcnt(10)
  s_barrier
  v_mfma_f32_16x16x32_bf16 v[96:99], v[180:183], v[188:191], v[96:99]
  ds_read_b64_tr_b16 v[176:177], v117 offset:41984
  s_add_u32 m0, s51, 24576
  v_mfma_f32_16x16x32_bf16 v[100:103], v[188:191], v[184:187], v[100:103]
  ds_read_b64_tr_b16 v[178:179], v117 offset:42496
  ds_read_b64_tr_b16 v[180:181], v124 offset:1024
  v_mfma_f32_16x16x32_bf16 v[0:3], v[132:135], a[24:27], v[0:3]
  ds_read_b64_tr_b16 v[182:183], v124 offset:1536
  ds_read_b128 v[188:191], v125 offset:12288
  v_mfma_f32_16x16x32_bf16 v[48:51], v[132:135], a[28:31], v[48:51]
  ds_read_b64_tr_b16 v[184:185], v124 offset:2048
  ds_read_b64_tr_b16 v[186:187], v124 offset:2560
  v_mfma_f32_16x16x32_bf16 v[4:7], v[136:139], a[24:27], v[4:7]
  ds_read_b64_tr_b16 v[132:133], v120 offset:0
  ds_read_b64_tr_b16 v[134:135], v120 offset:512
  v_mfma_f32_16x16x32_bf16 v[52:55], v[136:139], a[28:31], v[52:55]
  ds_read_b64_tr_b16 v[136:137], v121 offset:0
  s_add_u32 s50, s98, 393216
  v_mfma_f32_16x16x32_bf16 v[8:11], v[140:143], a[24:27], v[8:11]
  ds_read_b64_tr_b16 v[138:139], v121 offset:512
  v_mfma_f32_16x16x32_bf16 v[56:59], v[140:143], a[28:31], v[56:59]
  ds_read_b64_tr_b16 v[140:141], v122 offset:0
  ds_read_b64_tr_b16 v[142:143], v122 offset:512
  v_mfma_f32_16x16x32_bf16 v[12:15], v[144:147], a[24:27], v[12:15]
  v_mfma_f32_16x16x32_bf16 v[60:63], v[144:147], a[28:31], v[60:63]
  ds_read_b64_tr_b16 v[144:145], v123 offset:0
  ds_read_b64_tr_b16 v[146:147], v123 offset:512
  v_mfma_f32_16x16x32_bf16 v[16:19], v[148:151], a[24:27], v[16:19]
  s_bitset0_b32 s50, 21
  v_mfma_f32_16x16x32_bf16 v[64:67], v[148:151], a[28:31], v[64:67]
  ds_read_b64_tr_b16 v[148:149], v120 offset:1024
  ds_read_b64_tr_b16 v[150:151], v120 offset:1536
  v_mfma_f32_16x16x32_bf16 v[20:23], v[152:155], a[24:27], v[20:23]
  v_mfma_f32_16x16x32_bf16 v[68:71], v[152:155], a[28:31], v[68:71]
  ds_read_b64_tr_b16 v[152:153], v121 offset:1024
  ds_read_b64_tr_b16 v[154:155], v121 offset:1536
  s_waitcnt lgkmcnt(10)
  v_mfma_f32_16x16x32_bf16 v[24:27], v[156:159], a[24:27], v[24:27]
  v_mfma_f32_16x16x32_bf16 v[72:75], v[156:159], a[28:31], v[72:75]
  buffer_load_dwordx4 v248, s[52:55], s50 offen lds
  v_mfma_f32_16x16x32_bf16 v[28:31], v[160:163], a[24:27], v[28:31]
  ds_read_b64_tr_b16 v[156:157], v122 offset:1024
  ds_read_b64_tr_b16 v[158:159], v122 offset:1536
  v_mfma_f32_16x16x32_bf16 v[76:79], v[160:163], a[28:31], v[76:79]
  ds_read_b64_tr_b16 v[160:161], v123 offset:1024
  ds_read_b64_tr_b16 v[162:163], v123 offset:1536
  v_mfma_f32_16x16x32_bf16 v[32:35], a[24:27], v[164:167], v[32:35]
  v_mfma_f32_16x16x32_bf16 v[80:83], a[28:31], v[164:167], v[80:83]
  ds_read_b64_tr_b16 v[164:165], v120 offset:2048
  ds_read_b64_tr_b16 v[166:167], v120 offset:2560
  v_mfma_f32_16x16x32_bf16 v[36:39], a[24:27], v[168:171], v[36:39]
  buffer_load_dwordx4 v249, s[52:55], s50 offen offset:1024 lds
  v_mfma_f32_16x16x32_bf16 v[84:87], a[28:31], v[168:171], v[84:87]
  ds_read_b64_tr_b16 v[168:169], v121 offset:2048
  ds_read_b64_tr_b16 v[170:171], v121 offset:2560
  v_mfma_f32_16x16x32_bf16 v[40:43], a[24:27], v[172:175], v[40:43]
  v_mfma_f32_16x16x32_bf16 v[88:91], a[28:31], v[172:175], v[88:91]
  ds_read_b64_tr_b16 v[172:173], v122 offset:2048
  ds_read_b64_tr_b16 v[174:175], v122 offset:2560
  v_mfma_f32_16x16x32_bf16 v[44:47], a[24:27], v[176:179], v[44:47]
  v_mfma_f32_16x16x32_bf16 v[92:95], a[28:31], v[176:179], v[92:95]
  s_waitcnt vmcnt(24) lgkmcnt(10)
  s_barrier
  v_mfma_f32_16x16x32_bf16 v[96:99], v[180:183], v[188:191], v[96:99]
  ds_read_b64_tr_b16 v[176:177], v123 offset:2048
  s_add_u32 m0, s51, 32768
  v_mfma_f32_16x16x32_bf16 v[100:103], v[188:191], v[184:187], v[100:103]
  ds_read_b64_tr_b16 v[178:179], v123 offset:2560
  ds_read_b64_tr_b16 v[180:181], v124 offset:14336
  v_mfma_f32_16x16x32_bf16 v[0:3], v[132:135], a[32:35], v[0:3]
  ds_read_b64_tr_b16 v[182:183], v124 offset:14848
  s_add_u32 s50, s98, 524288
  v_mfma_f32_16x16x32_bf16 v[48:51], v[132:135], a[36:39], v[48:51]
  ds_read_b128 v[188:191], v125 offset:25600
  ds_read_b64_tr_b16 v[184:185], v124 offset:15360
  v_mfma_f32_16x16x32_bf16 v[4:7], v[136:139], a[32:35], v[4:7]
  ds_read_b64_tr_b16 v[186:187], v124 offset:15872
  ds_read_b64_tr_b16 v[132:133], v120 offset:13312
  v_mfma_f32_16x16x32_bf16 v[52:55], v[136:139], a[36:39], v[52:55]
  ds_read_b64_tr_b16 v[134:135], v120 offset:13824
  s_bitset0_b32 s50, 21
  v_mfma_f32_16x16x32_bf16 v[8:11], v[140:143], a[32:35], v[8:11]
  ds_read_b64_tr_b16 v[136:137], v121 offset:13312
  ds_read_b64_tr_b16 v[138:139], v121 offset:13824
  v_mfma_f32_16x16x32_bf16 v[56:59], v[140:143], a[36:39], v[56:59]
  buffer_load_dwordx4 v248, s[52:55], s50 offen lds
  v_mfma_f32_16x16x32_bf16 v[12:15], v[144:147], a[32:35], v[12:15]
  ds_read_b64_tr_b16 v[140:141], v122 offset:13312
  ds_read_b64_tr_b16 v[142:143], v122 offset:13824
  v_mfma_f32_16x16x32_bf16 v[60:63], v[144:147], a[36:39], v[60:63]
  ds_read_b64_tr_b16 v[144:145], v123 offset:13312
  ds_read_b64_tr_b16 v[146:147], v123 offset:13824
  v_mfma_f32_16x16x32_bf16 v[16:19], v[148:151], a[32:35], v[16:19]
  buffer_load_dwordx4 v249, s[52:55], s50 offen offset:1024 lds
  v_mfma_f32_16x16x32_bf16 v[64:67], v[148:151], a[36:39], v[64:67]
  ds_read_b64_tr_b16 v[148:149], v120 offset:14336
  ds_read_b64_tr_b16 v[150:151], v120 offset:14848
  v_mfma_f32_16x16x32_bf16 v[20:23], v[152:155], a[32:35], v[20:23]
  s_add_u32 m0, s51, 40960
  v_mfma_f32_16x16x32_bf16 v[68:71], v[152:155], a[36:39], v[68:71]
  ds_read_b64_tr_b16 v[152:153], v121 offset:14336
  ds_read_b64_tr_b16 v[154:155], v121 offset:14848
  s_waitcnt lgkmcnt(10)
  v_mfma_f32_16x16x32_bf16 v[24:27], v[156:159], a[32:35], v[24:27]
  v_mfma_f32_16x16x32_bf16 v[72:75], v[156:159], a[36:39], v[72:75]
  ds_read_b64_tr_b16 v[156:157], v122 offset:14336
  s_add_u32 s50, s98, 655360
  v_mfma_f32_16x16x32_bf16 v[28:31], v[160:163], a[32:35], v[28:31]
  ds_read_b64_tr_b16 v[158:159], v122 offset:14848
  v_mfma_f32_16x16x32_bf16 v[76:79], v[160:163], a[36:39], v[76:79]
  ds_read_b64_tr_b16 v[160:161], v123 offset:14336
  s_bitset0_b32 s50, 21
  v_mfma_f32_16x16x32_bf16 v[32:35], a[32:35], v[164:167], v[32:35]
  ds_read_b64_tr_b16 v[162:163], v123 offset:14848
  v_mfma_f32_16x16x32_bf16 v[80:83], a[36:39], v[164:167], v[80:83]
  ds_read_b64_tr_b16 v[164:165], v120 offset:15360
  ds_read_b64_tr_b16 v[166:167], v120 offset:15872
  v_mfma_f32_16x16x32_bf16 v[36:39], a[32:35], v[168:171], v[36:39]
  buffer_load_dwordx4 v248, s[52:55], s50 offen lds
  v_mfma_f32_16x16x32_bf16 v[84:87], a[36:39], v[168:171], v[84:87]
  ds_read_b64_tr_b16 v[168:169], v121 offset:15360
  ds_read_b64_tr_b16 v[170:171], v121 offset:15872
  v_mfma_f32_16x16x32_bf16 v[40:43], a[32:35], v[172:175], v[40:43]
  buffer_load_dwordx4 v249, s[52:55], s50 offen offset:1024 lds
  v_mfma_f32_16x16x32_bf16 v[88:91], a[36:39], v[172:175], v[88:91]
  ds_read_b64_tr_b16 v[172:173], v122 offset:15360
  ds_read_b64_tr_b16 v[174:175], v122 offset:15872
  v_mfma_f32_16x16x32_bf16 v[44:47], a[32:35], v[176:179], v[44:47]
  v_mfma_f32_16x16x32_bf16 v[92:95], a[36:39], v[176:179], v[92:95]
  s_waitcnt vmcnt(22) lgkmcnt(10)
  s_barrier
  v_mfma_f32_16x16x32_bf16 v[96:99], v[180:183], v[188:191], v[96:99]
  ds_read_b64_tr_b16 v[176:177], v123 offset:15360
  s_add_u32 m0, s51, 49152
  v_mfma_f32_16x16x32_bf16 v[100:103], v[188:191], v[184:187], v[100:103]
  ds_read_b64_tr_b16 v[178:179], v123 offset:15872
  s_add_u32 s50, s98, 786432
  v_mfma_f32_16x16x32_bf16 v[0:3], v[132:135], a[40:43], v[0:3]
  ds_read_b64_tr_b16 v[180:181], v124 offset:27648
  s_bitset0_b32 s50, 21
  v_mfma_f32_16x16x32_bf16 v[48:51], v[132:135], a[44:47], v[48:51]
  ds_read_b64_tr_b16 v[182:183], v124 offset:28160
  buffer_load_dwordx4 v248, s[52:55], s50 offen lds
  v_mfma_f32_16x16x32_bf16 v[4:7], v[136:139], a[40:43], v[4:7]
  ds_read_b128 v[188:191], v125 offset:38912
  ds_read_b64_tr_b16 v[184:185], v124 offset:28672
  ds_read_b64_tr_b16 v[186:187], v124 offset:29184
  v_mfma_f32_16x16x32_bf16 v[52:55], v[136:139], a[44:47], v[52:55]
  buffer_load_dwordx4 v249, s[52:55], s50 offen offset:1024 lds
  v_mfma_f32_16x16x32_bf16 v[8:11], v[140:143], a[40:43], v[8:11]
  ds_read_b64_tr_b16 v[132:133], v120 offset:26624
  ds_read_b64_tr_b16 v[134:135], v120 offset:27136
  s_add_u32 m0, s51, 57344
  v_mfma_f32_16x16x32_bf16 v[56:59], v[140:143], a[44:47], v[56:59]
  ds_read_b64_tr_b16 v[136:137], v121 offset:26624
  s_add_u32 s50, s98, 917504
  v_mfma_f32_16x16x32_bf16 v[12:15], v[144:147], a[40:43], v[12:15]
  ds_read_b64_tr_b16 v[138:139], v121 offset:27136
  ds_read_b64_tr_b16 v[140:141], v122 offset:26624
  v_mfma_f32_16x16x32_bf16 v[60:63], v[144:147], a[44:47], v[60:63]
  ds_read_b64_tr_b16 v[142:143], v122 offset:27136
  s_bitset0_b32 s50, 21
  v_mfma_f32_16x16x32_bf16 v[16:19], v[148:151], a[40:43], v[16:19]
  buffer_load_dwordx4 v248, s[52:55], s50 offen lds
  v_mfma_f32_16x16x32_bf16 v[64:67], v[148:151], a[44:47], v[64:67]
  buffer_load_dwordx4 v249, s[52:55], s50 offen offset:1024 lds
  v_mfma_f32_16x16x32_bf16 v[20:23], v[152:155], a[40:43], v[20:23]
  ds_read_b64_tr_b16 v[144:145], v123 offset:26624
  ds_read_b64_tr_b16 v[146:147], v123 offset:27136
  v_mfma_f32_16x16x32_bf16 v[68:71], v[152:155], a[44:47], v[68:71]
  ds_read_b64_tr_b16 v[148:149], v120 offset:27648
  s_mov_b32 s56, s26
  s_waitcnt lgkmcnt(10)
  v_mfma_f32_16x16x32_bf16 v[24:27], v[156:159], a[40:43], v[24:27]
  ds_read_b64_tr_b16 v[150:151], v120 offset:28160
  s_mov_b32 s57, s27
  v_mfma_f32_16x16x32_bf16 v[72:75], v[156:159], a[44:47], v[72:75]
  ds_read_b64_tr_b16 v[152:153], v121 offset:27648
  s_mov_b32 s58, 0x400000
  v_mfma_f32_16x16x32_bf16 v[28:31], v[160:163], a[40:43], v[28:31]
  ds_read_b64_tr_b16 v[154:155], v121 offset:28160
  ds_read_b64_tr_b16 v[156:157], v122 offset:27648
  v_mfma_f32_16x16x32_bf16 v[76:79], v[160:163], a[44:47], v[76:79]
  ds_read_b64_tr_b16 v[158:159], v122 offset:28160
  s_mov_b32 s59, 0x20000
  v_mfma_f32_16x16x32_bf16 v[32:35], a[40:43], v[164:167], v[32:35]
  ds_read_b64_tr_b16 v[160:161], v123 offset:27648
  s_mov_b32 s33, 0x8000
  v_mfma_f32_16x16x32_bf16 v[80:83], a[44:47], v[164:167], v[80:83]
  buffer_load_dwordx4 a[240:243], v128, s[56:59], 0 offen offset:0
  v_mfma_f32_16x16x32_bf16 v[36:39], a[40:43], v[168:171], v[36:39]
  ds_read_b64_tr_b16 v[162:163], v123 offset:28160
  ds_read_b64_tr_b16 v[164:165], v120 offset:28672
  v_mfma_f32_16x16x32_bf16 v[84:87], a[44:47], v[168:171], v[84:87]
  buffer_load_dwordx4 a[244:247], v128, s[56:59], 0 offen offset:64
  v_mfma_f32_16x16x32_bf16 v[40:43], a[40:43], v[172:175], v[40:43]
  ds_read_b64_tr_b16 v[166:167], v120 offset:29184
  buffer_load_dwordx4 a[248:251], v128, s[56:59], s33 offen offset:0
  v_mfma_f32_16x16x32_bf16 v[88:91], a[44:47], v[172:175], v[88:91]
  buffer_load_dwordx4 a[252:255], v128, s[56:59], s33 offen offset:64
  v_mfma_f32_16x16x32_bf16 v[44:47], a[40:43], v[176:179], v[44:47]
  ds_read_b64_tr_b16 v[168:169], v121 offset:28672
  ds_read_b64_tr_b16 v[170:171], v121 offset:29184
  v_mfma_f32_16x16x32_bf16 v[92:95], a[44:47], v[176:179], v[92:95]
  s_waitcnt vmcnt(24) lgkmcnt(10)
  s_barrier
  v_mfma_f32_16x16x32_bf16 v[96:99], v[180:183], v[188:191], v[96:99]
  ds_read_b64_tr_b16 v[172:173], v122 offset:28672
  ds_read_b64_tr_b16 v[174:175], v122 offset:29184
  s_add_u32 m0, s51, 65536
  v_mfma_f32_16x16x32_bf16 v[100:103], v[188:191], v[184:187], v[100:103]
  ds_read_b64_tr_b16 v[176:177], v123 offset:28672
  ds_read_b64_tr_b16 v[178:179], v123 offset:29184
  v_mfma_f32_16x16x32_bf16 v[0:3], v[132:135], a[48:51], v[0:3]
  ds_read_b64_tr_b16 v[180:181], v124 offset:40960
  ds_read_b64_tr_b16 v[182:183], v124 offset:41472
  v_mfma_f32_16x16x32_bf16 v[48:51], v[132:135], a[52:55], v[48:51]
  ds_read_b128 v[188:191], v125 offset:52224
  ds_read_b64_tr_b16 v[184:185], v124 offset:41984
  v_mfma_f32_16x16x32_bf16 v[4:7], v[136:139], a[48:51], v[4:7]
  ds_read_b64_tr_b16 v[186:187], v124 offset:42496
  ds_read_b64_tr_b16 v[132:133], v120 offset:39936
  v_mfma_f32_16x16x32_bf16 v[52:55], v[136:139], a[52:55], v[52:55]
  ds_read_b64_tr_b16 v[134:135], v120 offset:40448
  s_add_u32 s50, s98, 1048576
  v_mfma_f32_16x16x32_bf16 v[8:11], v[140:143], a[48:51], v[8:11]
  ds_read_b64_tr_b16 v[136:137], v121 offset:39936
  ds_read_b64_tr_b16 v[138:139], v121 offset:40448
  v_mfma_f32_16x16x32_bf16 v[56:59], v[140:143], a[52:55], v[56:59]
  ds_read_b64_tr_b16 v[140:141], v122 offset:39936
  ds_read_b64_tr_b16 v[142:143], v122 offset:40448
  v_mfma_f32_16x16x32_bf16 v[12:15], v[144:147], a[48:51], v[12:15]
  v_mfma_f32_16x16x32_bf16 v[60:63], v[144:147], a[52:55], v[60:63]
  ds_read_b64_tr_b16 v[144:145], v123 offset:39936
  ds_read_b64_tr_b16 v[146:147], v123 offset:40448
  v_mfma_f32_16x16x32_bf16 v[16:19], v[148:151], a[48:51], v[16:19]
  s_bitset0_b32 s50, 21
  v_mfma_f32_16x16x32_bf16 v[64:67], v[148:151], a[52:55], v[64:67]
  ds_read_b64_tr_b16 v[148:149], v120 offset:40960
  ds_read_b64_tr_b16 v[150:151], v120 offset:41472
  s_waitcnt lgkmcnt(10)
  v_mfma_f32_16x16x32_bf16 v[20:23], v[152:155], a[48:51], v[20:23]
  v_mfma_f32_16x16x32_bf16 v[68:71], v[152:155], a[52:55], v[68:71]
  ds_read_b64_tr_b16 v[152:153], v121 offset:40960
  ds_read_b64_tr_b16 v[154:155], v121 offset:41472
  v_mfma_f32_16x16x32_bf16 v[24:27], v[156:159], a[48:51], v[24:27]
  v_mfma_f32_16x16x32_bf16 v[72:75], v[156:159], a[52:55], v[72:75]
  buffer_load_dwordx4 v248, s[52:55], s50 offen lds
  v_mfma_f32_16x16x32_bf16 v[28:31], v[160:163], a[48:51], v[28:31]
  ds_read_b64_tr_b16 v[156:157], v122 offset:40960
  ds_read_b64_tr_b16 v[158:159], v122 offset:41472
  v_mfma_f32_16x16x32_bf16 v[76:79], v[160:163], a[52:55], v[76:79]
  ds_read_b64_tr_b16 v[160:161], v123 offset:40960
  ds_read_b64_tr_b16 v[162:163], v123 offset:41472
  v_mfma_f32_16x16x32_bf16 v[32:35], a[48:51], v[164:167], v[32:35]
  v_mfma_f32_16x16x32_bf16 v[80:83], a[52:55], v[164:167], v[80:83]
  ds_read_b64_tr_b16 v[164:165], v120 offset:41984
  ds_read_b64_tr_b16 v[166:167], v120 offset:42496
  v_mfma_f32_16x16x32_bf16 v[36:39], a[48:51], v[168:171], v[36:39]
  buffer_load_dwordx4 v249, s[52:55], s50 offen offset:1024 lds
  v_mfma_f32_16x16x32_bf16 v[84:87], a[52:55], v[168:171], v[84:87]
  ds_read_b64_tr_b16 v[168:169], v121 offset:41984
  ds_read_b64_tr_b16 v[170:171], v121 offset:42496
  v_mfma_f32_16x16x32_bf16 v[40:43], a[48:51], v[172:175], v[40:43]
  v_mfma_f32_16x16x32_bf16 v[88:91], a[52:55], v[172:175], v[88:91]
  ds_read_b64_tr_b16 v[172:173], v122 offset:41984
  ds_read_b64_tr_b16 v[174:175], v122 offset:42496
  v_mfma_f32_16x16x32_bf16 v[44:47], a[48:51], v[176:179], v[44:47]
  v_mfma_f32_16x16x32_bf16 v[92:95], a[52:55], v[176:179], v[92:95]
  s_waitcnt vmcnt(26) lgkmcnt(10)
  s_barrier
  v_mfma_f32_16x16x32_bf16 v[96:99], v[180:183], v[188:191], v[96:99]
  ds_read_b64_tr_b16 v[176:177], v123 offset:41984
  s_add_u32 m0, s51, 73728
  v_mfma_f32_16x16x32_bf16 v[100:103], v[188:191], v[184:187], v[100:103]
  ds_read_b64_tr_b16 v[178:179], v123 offset:42496
  s_add_u32 s50, s98, 1179648
  v_mfma_f32_16x16x32_bf16 v[0:3], v[132:135], a[56:59], v[0:3]
  v_mfma_f32_16x16x32_bf16 v[48:51], v[132:135], a[60:63], v[48:51]
  s_bitset0_b32 s50, 21
  v_mfma_f32_16x16x32_bf16 v[4:7], v[136:139], a[56:59], v[4:7]
  v_mfma_f32_16x16x32_bf16 v[52:55], v[136:139], a[60:63], v[52:55]
  buffer_load_dwordx4 v248, s[52:55], s50 offen lds
  v_mfma_f32_16x16x32_bf16 v[8:11], v[140:143], a[56:59], v[8:11]
  buffer_load_dwordx4 v249, s[52:55], s50 offen offset:1024 lds
  v_mfma_f32_16x16x32_bf16 v[56:59], v[140:143], a[60:63], v[56:59]
  v_mfma_f32_16x16x32_bf16 v[12:15], v[144:147], a[56:59], v[12:15]
  s_add_u32 m0, s51, 81920
  v_mfma_f32_16x16x32_bf16 v[60:63], v[144:147], a[60:63], v[60:63]
  v_mfma_f32_16x16x32_bf16 v[16:19], v[148:151], a[56:59], v[16:19]
  s_add_u32 s50, s98, 1310720
  v_mfma_f32_16x16x32_bf16 v[64:67], v[148:151], a[60:63], v[64:67]
  s_bitset0_b32 s50, 21
  v_mfma_f32_16x16x32_bf16 v[20:23], v[152:155], a[56:59], v[20:23]
  v_mfma_f32_16x16x32_bf16 v[68:71], v[152:155], a[60:63], v[68:71]
  buffer_load_dwordx4 v248, s[52:55], s50 offen lds
  s_waitcnt lgkmcnt(10)
  v_mfma_f32_16x16x32_bf16 v[24:27], v[156:159], a[56:59], v[24:27]
  v_mfma_f32_16x16x32_bf16 v[72:75], v[156:159], a[60:63], v[72:75]
  buffer_load_dwordx4 v249, s[52:55], s50 offen offset:1024 lds
  s_waitcnt lgkmcnt(8)
  v_mfma_f32_16x16x32_bf16 v[28:31], v[160:163], a[56:59], v[28:31]
  s_lshl_b32 s34, s37, 8
  v_mfma_f32_16x16x32_bf16 v[76:79], v[160:163], a[60:63], v[76:79]
  s_waitcnt lgkmcnt(6)
  v_mfma_f32_16x16x32_bf16 v[32:35], a[56:59], v[164:167], v[32:35]
  s_lshl_b32 s33, s3, 12
  v_mfma_f32_16x16x32_bf16 v[80:83], a[60:63], v[164:167], v[80:83]
  s_waitcnt lgkmcnt(4)
  v_mfma_f32_16x16x32_bf16 v[36:39], a[56:59], v[168:171], v[36:39]
  s_add_u32 s34, s34, s33
  v_mfma_f32_16x16x32_bf16 v[84:87], a[60:63], v[168:171], v[84:87]
  s_add_u32 s68, s34, 8192
  s_waitcnt lgkmcnt(2)
  v_mfma_f32_16x16x32_bf16 v[40:43], a[56:59], v[172:175], v[40:43]
  v_mfma_f32_16x16x32_bf16 v[88:91], a[60:63], v[172:175], v[88:91]
  buffer_load_dwordx4 v[250:253], v254, s[12:15], s68 offen sc1
  s_waitcnt lgkmcnt(0)
  v_mfma_f32_16x16x32_bf16 v[44:47], a[56:59], v[176:179], v[44:47]
  v_mfma_f32_16x16x32_bf16 v[92:95], a[60:63], v[176:179], v[92:95]
  s_nop 7
  s_nop 1
L_att:
  s_add_u32 s4, s20, 0x600000
  s_addc_u32 s5, s21, 0
  s_mov_b32 s6, 0x400000
  s_mov_b32 s7, 0x20000
  s_lshl_b32 s33, s3, 12
  s_add_u32 s33, s33, 139264
  v_add_u32 v110, s33, v119
  s_lshr_b32 s33, s3, 1
  s_lshl_b32 s33, s33, 10
  s_and_b32 s34, s3, 1
  s_lshl_b32 s34, s34, 3
  s_add_u32 s33, s33, s34
  s_add_u32 s33, s33, 139264
  v_add_u32 v111, s33, v119
  v_cvt_pk_bf16_f32 v196, v96, v97
  v_cvt_pk_bf16_f32 v197, v98, v99
  v_cvt_pk_bf16_f32 v198, v100, v101
  v_cvt_pk_bf16_f32 v199, v102, v103
  v_cvt_pk_bf16_f32 v164, v64, v65
  v_cvt_pk_bf16_f32 v165, v66, v67
  v_cvt_pk_bf16_f32 v176, v80, v81
  v_cvt_pk_bf16_f32 v177, v82, v83
  v_cvt_pk_bf16_f32 v166, v68, v69
  v_cvt_pk_bf16_f32 v167, v70, v71
  v_cvt_pk_bf16_f32 v182, v84, v85
  v_cvt_pk_bf16_f32 v183, v86, v87
  v_cvt_pk_bf16_f32 v168, v72, v73
  v_cvt_pk_bf16_f32 v169, v74, v75
  v_cvt_pk_bf16_f32 v188, v88, v89
  v_cvt_pk_bf16_f32 v189, v90, v91
  v_cvt_pk_bf16_f32 v170, v76, v77
  v_cvt_pk_bf16_f32 v171, v78, v79
  v_cvt_pk_bf16_f32 v194, v92, v93
  v_cvt_pk_bf16_f32 v195, v94, v95
  ds_write_b64 v111, v[196:197]
  ds_write_b64 v111, v[198:199] offset:2048
  ds_write_b128 v110, v[164:167] offset:4096
  ds_write_b64 v110, v[176:177] offset:6144
  ds_write_b64 v110, v[182:183] offset:6152
  ds_write_b128 v110, v[168:171] offset:5120
  ds_write_b64 v110, v[188:189] offset:7168
  ds_write_b64 v110, v[194:195] offset:7176
  v_cvt_pk_bf16_f32 v132, v0, v1
  v_cvt_pk_bf16_f32 v133, v2, v3
  v_cvt_pk_bf16_f32 v140, v48, v49
  v_cvt_pk_bf16_f32 v141, v50, v51
  v_cvt_pk_bf16_f32 v156, v16, v17
  v_cvt_pk_bf16_f32 v157, v18, v19
  v_cvt_pk_bf16_f32 v174, v32, v33
  v_cvt_pk_bf16_f32 v175, v34, v35
  v_cvt_pk_bf16_f32 v134, v4, v5
  v_cvt_pk_bf16_f32 v135, v6, v7
  v_cvt_pk_bf16_f32 v142, v52, v53
  v_cvt_pk_bf16_f32 v143, v54, v55
  v_cvt_pk_bf16_f32 v158, v20, v21
  v_cvt_pk_bf16_f32 v159, v22, v23
  v_cvt_pk_bf16_f32 v180, v36, v37
  v_cvt_pk_bf16_f32 v181, v38, v39
  v_cvt_pk_bf16_f32 v136, v8, v9
  v_cvt_pk_bf16_f32 v137, v10, v11
  v_cvt_pk_bf16_f32 v144, v56, v57
  v_cvt_pk_bf16_f32 v145, v58, v59
  v_cvt_pk_bf16_f32 v160, v24, v25
  v_cvt_pk_bf16_f32 v161, v26, v27
  v_cvt_pk_bf16_f32 v186, v40, v41
  v_cvt_pk_bf16_f32 v187, v42, v43
  v_cvt_pk_bf16_f32 v138, v12, v13
  v_cvt_pk_bf16_f32 v139, v14, v15
  v_cvt_pk_bf16_f32 v146, v60, v61
  v_cvt_pk_bf16_f32 v147, v62, v63
  v_cvt_pk_bf16_f32 v162, v28, v29
  v_cvt_pk_bf16_f32 v163, v30, v31
  v_cvt_pk_bf16_f32 v192, v44, v45
  v_cvt_pk_bf16_f32 v193, v46, v47
  s_waitcnt lgkmcnt(0)
  s_barrier
  ds_read_b128 v[148:151], v110 offset:0
  ds_read_b64 v[172:173], v110 offset:2048
  ds_read_b64 v[178:179], v110 offset:2056
  ds_read_b128 v[152:155], v110 offset:1024
  ds_read_b64 v[184:185], v110 offset:3072
  ds_read_b64 v[190:191], v110 offset:3080
  s_add_u32 m0, s51, 90112
  s_add_u32 s50, s98, 1441792
  s_bitset0_b32 s50, 21
  buffer_load_dwordx4 v248, s[52:55], s50 offen lds
  buffer_load_dwordx4 v249, s[52:55], s50 offen offset:1024 lds
  s_add_u32 m0, s51, 98304
  s_add_u32 s50, s98, 1572864
  s_bitset0_b32 s50, 21
  buffer_load_dwordx4 v248, s[52:55], s50 offen lds
  buffer_load_dwordx4 v249, s[52:55], s50 offen offset:1024 lds
  v_mfma_f32_16x16x32_bf16 v[200:203], v[156:159], v[140:143], 0
  v_mfma_f32_16x16x32_bf16 v[204:207], v[164:167], v[140:143], 0
  v_mfma_f32_16x16x32_bf16 v[208:211], v[160:163], v[144:147], 0
  v_mfma_f32_16x16x32_bf16 v[212:215], v[168:171], v[144:147], 0
  s_or_b32 s33, s30, s3
  s_cmp_eq_u32 s33, 0
  s_cselect_b32 s33, 0xf149f2ca, 0
  v_mov_b32 v232, s33
  v_cndmask_b32_e64 v120, v232, 0, s[44:45]
  v_cndmask_b32_e64 v121, v232, 0, s[46:47]
  v_and_b32 v122, 1, v104
  v_lshlrev_b32 v122, 4, v122
  s_waitcnt lgkmcnt(0)
  v_mfma_f32_16x16x32_bf16 v[216:219], v[148:151], v[132:135], 0
  v_mfma_f32_16x16x32_bf16 v[220:223], v[156:159], v[132:135], 0
  v_mfma_f32_16x16x32_bf16 v[224:227], v[152:155], v[136:139], 0
  v_mfma_f32_16x16x32_bf16 v[228:231], v[160:163], v[136:139], 0
  s_mov_b32 s40, 0x3e8293ee
  v_cndmask_b32_e64 v200, v200, v201, s[48:49]
  v_cndmask_b32_e64 v202, v202, v203, s[48:49]
  v_cndmask_b32_e64 v204, v204, v205, s[48:49]
  v_cndmask_b32_e64 v206, v206, v207, s[48:49]
  v_cndmask_b32_e64 v208, v208, v209, s[48:49]
  v_cndmask_b32_e64 v210, v210, v211, s[48:49]
  v_cndmask_b32_e64 v212, v212, v213, s[48:49]
  v_cndmask_b32_e64 v214, v214, v215, s[48:49]
  v_cndmask_b32_e64 v216, v216, v217, s[48:49]
  v_cndmask_b32_e64 v218, v218, v219, s[48:49]
  v_cndmask_b32_e64 v220, v220, v221, s[48:49]
  v_cndmask_b32_e64 v222, v222, v223, s[48:49]
  v_cndmask_b32_e64 v224, v224, v225, s[48:49]
  v_cndmask_b32_e64 v226, v226, v227, s[48:49]
  v_cndmask_b32_e64 v228, v228, v229, s[48:49]
  v_cndmask_b32_e64 v230, v230, v231, s[48:49]
  v_cndmask_b32_e64 v200, v200, v204, s[44:45]
  v_cndmask_b32_e64 v201, v202, v206, s[46:47]
  v_cndmask_b32_e64 v208, v208, v212, s[44:45]
  v_cndmask_b32_e64 v209, v210, v214, s[46:47]
  v_cndmask_b32_e64 v216, v216, v220, s[44:45]
  v_cndmask_b32_e64 v217, v218, v222, s[46:47]
  v_cndmask_b32_e64 v224, v224, v228, s[44:45]
  v_cndmask_b32_e64 v225, v226, v230, s[46:47]
  v_mul_f32 v200, s40, v200
  v_mul_f32 v201, s40, v201
  v_mul_f32 v208, s40, v208
  v_mul_f32 v209, s40, v209
  v_fma_f32 v216, v216, s40, v120
  v_fma_f32 v217, v217, s40, v121
  v_fma_f32 v224, v224, s40, v120
  v_fma_f32 v225, v225, s40, v121
  v_max_f32 v232, v200, v201
  v_max_f32 v233, v208, v209
  v_max_f32 v234, v216, v217
  v_max_f32 v235, v224, v225
  v_mov_b32 v236, v232
  v_mov_b32 v237, v233
  v_mov_b32 v238, v234
  v_mov_b32 v239, v235
  s_nop 1
  v_permlane16_swap_b32 v236, v232
  v_permlane16_swap_b32 v237, v233
  v_permlane16_swap_b32 v238, v234
  v_permlane16_swap_b32 v239, v235
  s_nop 1
  v_max_f32 v232, v232, v236
  v_max_f32 v233, v233, v237
  v_max_f32 v234, v234, v238
  v_max_f32 v235, v235, v239
  v_mov_b32 v236, v232
  v_mov_b32 v237, v233
  v_mov_b32 v238, v234
  v_mov_b32 v239, v235
  s_nop 1
  v_permlane32_swap_b32 v236, v232
  v_permlane32_swap_b32 v237, v233
  v_permlane32_swap_b32 v238, v234
  v_permlane32_swap_b32 v239, v235
  s_nop 1
  v_max_f32 v232, v232, v236
  v_max_f32 v233, v233, v237
  v_max_f32 v234, v234, v238
  v_max_f32 v235, v235, v239
  v_sub_f32 v200, v200, v232
  v_sub_f32 v201, v201, v232
  v_sub_f32 v208, v208, v233
  v_sub_f32 v209, v209, v233
  v_sub_f32 v216, v216, v234
  v_sub_f32 v217, v217, v234
  v_sub_f32 v224, v224, v235
  v_sub_f32 v225, v225, v235
  v_exp_f32 v200, v200
  v_exp_f32 v201, v201
  v_exp_f32 v208, v208
  v_exp_f32 v209, v209
  v_exp_f32 v216, v216
  v_exp_f32 v217, v217
  v_exp_f32 v224, v224
  v_exp_f32 v225, v225
  s_nop 0
  v_add_f32 v232, v200, v201
  v_add_f32 v233, v208, v209
  v_add_f32 v234, v216, v217
  v_add_f32 v235, v224, v225
  v_mov_b32 v236, v232
  v_mov_b32 v237, v233
  v_mov_b32 v238, v234
  v_mov_b32 v239, v235
  s_nop 1
  v_permlane16_swap_b32 v236, v232
  v_permlane16_swap_b32 v237, v233
  v_permlane16_swap_b32 v238, v234
  v_permlane16_swap_b32 v239, v235
  s_nop 1
  v_add_f32 v232, v232, v236
  v_add_f32 v233, v233, v237
  v_add_f32 v234, v234, v238
  v_add_f32 v235, v235, v239
  v_mov_b32 v236, v232
  v_mov_b32 v237, v233
  v_mov_b32 v238, v234
  v_mov_b32 v239, v235
  s_nop 1
  v_permlane32_swap_b32 v236, v232
  v_permlane32_swap_b32 v237, v233
  v_permlane32_swap_b32 v238, v234
  v_permlane32_swap_b32 v239, v235
  s_nop 1
  v_add_f32 v232, v232, v236
  v_add_f32 v233, v233, v237
  v_add_f32 v234, v234, v238
  v_add_f32 v235, v235, v239
  v_rcp_f32 v232, v232
  v_rcp_f32 v233, v233
  v_rcp_f32 v234, v234
  v_rcp_f32 v235, v235
  s_nop 0
  v_mul_f32 v200, v200, v232
  v_mul_f32 v201, v201, v232
  v_mul_f32 v208, v208, v233
  v_mul_f32 v209, v209, v233
  v_mul_f32 v216, v216, v234
  v_mul_f32 v217, v217, v234
  v_mul_f32 v224, v224, v235
  v_mul_f32 v225, v225, v235
  v_cvt_pk_bf16_f32 v200, v200, 0
  v_cvt_pk_bf16_f32 v201, v201, 0
  v_cvt_pk_bf16_f32 v208, v208, 0
  v_cvt_pk_bf16_f32 v209, v209, 0
  v_cvt_pk_bf16_f32 v216, v216, 0
  v_cvt_pk_bf16_f32 v217, v217, 0
  v_cvt_pk_bf16_f32 v224, v224, 0
  v_cvt_pk_bf16_f32 v225, v225, 0
  v_lshlrev_b32 v200, v122, v200
  v_lshlrev_b32 v201, v122, v201
  v_lshlrev_b32 v208, v122, v208
  v_lshlrev_b32 v209, v122, v209
  v_lshlrev_b32 v216, v122, v216
  v_lshlrev_b32 v217, v122, v217
  v_lshlrev_b32 v224, v122, v224
  v_lshlrev_b32 v225, v122, v225
  v_cndmask_b32_e64 v132, v200, 0, s[44:45]
  v_cndmask_b32_e64 v134, 0, v200, s[44:45]
  v_cndmask_b32_e64 v133, v201, 0, s[46:47]
  v_cndmask_b32_e64 v135, 0, v201, s[46:47]
  v_cndmask_b32_e64 v136, v208, 0, s[44:45]
  v_cndmask_b32_e64 v138, 0, v208, s[44:45]
  v_cndmask_b32_e64 v137, v209, 0, s[46:47]
  v_cndmask_b32_e64 v139, 0, v209, s[46:47]
  v_cndmask_b32_e64 v140, v216, 0, s[44:45]
  v_cndmask_b32_e64 v142, 0, v216, s[44:45]
  v_cndmask_b32_e64 v141, v217, 0, s[46:47]
  v_cndmask_b32_e64 v143, 0, v217, s[46:47]
  v_cndmask_b32_e64 v144, v224, 0, s[44:45]
  v_cndmask_b32_e64 v146, 0, v224, s[44:45]
  v_cndmask_b32_e64 v145, v225, 0, s[46:47]
  v_cndmask_b32_e64 v147, 0, v225, s[46:47]
  s_nop 1
  v_mfma_f32_16x16x32_bf16 v[200:203], v[174:177], v[132:135], 0
  v_mfma_f32_16x16x32_bf16 v[204:207], v[180:183], v[132:135], 0
  v_mfma_f32_16x16x32_bf16 v[208:211], v[186:189], v[136:139], 0
  v_mfma_f32_16x16x32_bf16 v[212:215], v[192:195], v[136:139], 0
  v_mfma_f32_16x16x32_bf16 v[216:219], v[172:175], v[140:143], 0
  v_mfma_f32_16x16x32_bf16 v[220:223], v[178:181], v[140:143], 0
  v_mfma_f32_16x16x32_bf16 v[224:227], v[184:187], v[144:147], 0
  v_mfma_f32_16x16x32_bf16 v[228:231], v[190:193], v[144:147], 0
  s_lshl_b32 s41, s31, 18
  s_add_u32 s42, s41, 131072
  s_nop 1
  v_cvt_pk_bf16_f32 v148, v200, v201
  v_cvt_pk_bf16_f32 v149, v202, v203
  v_cvt_pk_bf16_f32 v150, v204, v205
  v_cvt_pk_bf16_f32 v151, v206, v207
  buffer_store_dwordx4 v[148:151], v105, s[4:7], s41 offen offset:1024 sc1
  v_cvt_pk_bf16_f32 v152, v208, v209
  v_cvt_pk_bf16_f32 v153, v210, v211
  v_cvt_pk_bf16_f32 v154, v212, v213
  v_cvt_pk_bf16_f32 v155, v214, v215
  buffer_store_dwordx4 v[152:155], v105, s[4:7], s42 offen offset:1024 sc1
  v_cvt_pk_bf16_f32 v156, v216, v217
  v_cvt_pk_bf16_f32 v157, v218, v219
  v_cvt_pk_bf16_f32 v158, v220, v221
  v_cvt_pk_bf16_f32 v159, v222, v223
  buffer_store_dwordx4 v[156:159], v105, s[4:7], s41 offen offset:0 sc1
  s_nop 0
  v_cvt_pk_bf16_f32 v160, v224, v225
  v_cvt_pk_bf16_f32 v161, v226, v227
  v_cvt_pk_bf16_f32 v162, v228, v229
  v_cvt_pk_bf16_f32 v163, v230, v231
  buffer_store_dwordx4 v[160:163], v105, s[4:7], s42 offen offset:0 sc1
  s_lshl_b32 s69, s30, 2
  s_add_u32 s69, s69, s3
  s_lshl_b32 s69, s69, 4
  s_add_u32 s69, s69, s31
  s_add_u32 s69, s69, 1024
  s_lshl_b32 s69, s69, 6
  s_mov_b32 s30, s36
  s_mov_b32 s31, s37
  v_mov_b32 v32, v104
  v_mov_b32 v231, v104
  v_mov_b32 v43, v128
  v_and_b32 v44, 15, v32
  s_lshl_b32 s32, s30, 13
  s_lshl_b32 s33, s3, 11
  s_add_u32 s32, s32, s33
  v_lshlrev_b32 v80, 4, v32
  v_add_u32 v33, s32, v80
  v_add_u32 v34, 131072, v33
  s_lshl_b32 s16, s98, 1
  s_lshl_b32 s32, s30, 2
  s_add_u32 s32, s32, s3
  s_lshl_b32 s32, s32, 4
  s_add_u32 s32, s32, 1024
  v_add_u32 v45, s32, v44
  v_lshlrev_b32 v45, 6, v45
  v_mov_b32 v158, s19
  v_mov_b32 v159, s19
  v_lshlrev_b32 v46, 2, v32
  s_bfe_u32 s48, s19, 0x80000
  s_bfe_u32 s49, s19, 0x80008
  s_bfe_u32 s50, s19, 0x80010
  s_bfe_u32 s51, s19, 0x80018
  s_mov_b32 s92, s30
  s_mov_b32 s93, s31
  s_and_b32 s28, s2, 7
  s_lshr_b32 s29, s2, 3
  s_and_b32 s30, s28, 1
  s_lshl_b32 s30, s30, 2
  s_and_b32 s31, s29, 3
  s_add_u32 s30, s30, s31
  s_lshr_b32 s31, s28, 1
  s_lshl_b32 s31, s31, 3
  s_lshr_b32 s29, s29, 2
  s_add_u32 s31, s31, s29
  s_lshl_b32 s32, s30, 14
  s_lshl_b32 s33, s3, 12
  s_add_u32 s32, s32, s33
  v_lshlrev_b32 v224, 4, v231
  v_add_u32 v224, s32, v224
  s_and_b32 s33, s3, 1
  s_mul_i32 s34, s33, 114688
  s_mul_i32 s35, s31, 224
  s_add_u32 s34, s34, s35
  s_movk_i32 s36, 4682
  s_movk_i32 s37, 7168
  s_and_b32 s39, s31, 1
  s_lshl_b32 s39, s39, 1
  v_add_u32 v234, 0, v231
  v_mul_u32_u24 v235, s36, v234
  v_lshrrev_b32 v235, 16, v235
  v_mul_u32_u24 v236, 14, v235
  v_sub_u32 v236, v234, v236
  v_add_u32 v236, s39, v236
  v_subrev_u32 v237, 14, v236
  v_min_u32 v236, v236, v237
  v_mul_u32_u24 v235, s37, v235
  v_lshl_add_u32 v235, v236, 4, v235
  v_add_u32 v235, s34, v235
  v_subrev_u32 v225, 0, v235
  v_add_u32 v234, 64, v231
  v_mul_u32_u24 v235, s36, v234
  v_lshrrev_b32 v235, 16, v235
  v_mul_u32_u24 v236, 14, v235
  v_sub_u32 v236, v234, v236
  v_add_u32 v236, s39, v236
  v_subrev_u32 v237, 14, v236
  v_min_u32 v236, v236, v237
  v_mul_u32_u24 v235, s37, v235
  v_lshl_add_u32 v235, v236, 4, v235
  v_add_u32 v235, s34, v235
  v_subrev_u32 v226, 1024, v235
  v_add_u32 v234, 128, v231
  v_mul_u32_u24 v235, s36, v234
  v_lshrrev_b32 v235, 16, v235
  v_mul_u32_u24 v236, 14, v235
  v_sub_u32 v236, v234, v236
  v_add_u32 v236, s39, v236
  v_subrev_u32 v237, 14, v236
  v_min_u32 v236, v236, v237
  v_mul_u32_u24 v235, s37, v235
  v_lshl_add_u32 v235, v236, 4, v235
  v_add_u32 v235, s34, v235
  v_subrev_u32 v227, 2048, v235
  v_add_u32 v234, 192, v231
  v_mul_u32_u24 v235, s36, v234
  v_lshrrev_b32 v235, 16, v235
  v_mul_u32_u24 v236, 14, v235
  v_sub_u32 v236, v234, v236
  v_add_u32 v236, s39, v236
  v_subrev_u32 v237, 14, v236
  v_min_u32 v236, v236, v237
  v_mul_u32_u24 v235, s37, v235
  v_lshl_add_u32 v235, v236, 4, v235
  v_add_u32 v235, s34, v235
  v_subrev_u32 v228, 3072, v235
  s_mov_b32 s94, s30
  s_mov_b32 s95, s31
  s_mov_b32 s30, s92
  s_mov_b32 s31, s93
  s_mul_i32 s38, s3, 3584
  s_add_u32 s38, s38, 98304
  s_mov_b32 s17, 0
  s_cmp_lt_u32 s3, 2
  s_cselect_b32 s8, s60, s62
  s_cselect_b32 s9, s61, s63
  s_mov_b32 s10, 7340032
  s_mov_b32 s11, 0x20000
  s_waitcnt vmcnt(0)
  s_mov_b64 exec, 1
  buffer_store_dword v158, v46, s[64:67], s69 offen sc1
  s_mov_b64 exec, -1
  v_xor_b32 v168, s48, v250
  v_xor_b32 v169, s49, v251
  v_xor_b32 v170, s50, v252
  v_xor_b32 v171, s51, v253
  v_or3_b32 v172, v168, v169, v170
  v_or_b32 v172, v172, v171
  v_and_b32 v172, 0xff, v172
  v_cmp_ne_u32 vcc, 0, v172
  s_nop 1
  s_cmp_lg_u64 vcc, 0
  s_cbranch_scc1 L_vslow_11
L_vback_12:
  v_mov_b32 v172, v168
  v_mov_b32 v173, v169
  v_mov_b32 v174, v170
  v_mov_b32 v175, v171
  s_nop 1
  v_permlane16_swap_b32 v172, v168
  v_permlane16_swap_b32 v173, v169
  v_permlane16_swap_b32 v174, v170
  v_permlane16_swap_b32 v175, v171
  s_nop 1
  v_add_f32 v168, v168, v172
  v_add_f32 v169, v169, v173
  v_add_f32 v170, v170, v174
  v_add_f32 v171, v171, v175
  v_mov_b32 v172, v168
  v_mov_b32 v173, v169
  v_mov_b32 v174, v170
  v_mov_b32 v175, v171
  s_nop 1
  v_permlane32_swap_b32 v172, v168
  v_permlane32_swap_b32 v173, v169
  v_permlane32_swap_b32 v174, v170
  v_permlane32_swap_b32 v175, v171
  s_nop 1
  v_add_f32 v168, v168, v172
  v_add_f32 v169, v169, v173
  v_add_f32 v170, v170, v174
  v_add_f32 v171, v171, v175
  v_cvt_pk_bf16_f32 v172, v168, v169
  v_lshlrev_b32 v168, 16, v172
  v_and_b32 v169, 0xffff0000, v172
  v_cvt_pk_bf16_f32 v173, v170, v171
  v_lshlrev_b32 v170, 16, v173
  v_and_b32 v171, 0xffff0000, v173
  s_cmp_eq_u32 s3, 2
  s_cselect_b32 s33, 1.0, 0
  v_add_f32 v168, s33, v168
  v_add_f32 v169, s33, v169
  v_add_f32 v170, s33, v170
  v_add_f32 v171, s33, v171
  v_cvt_pk_bf16_f32 v172, v168, v169
  v_lshlrev_b32 v168, 16, v172
  v_and_b32 v169, 0xffff0000, v172
  v_cvt_pk_bf16_f32 v173, v170, v171
  v_lshlrev_b32 v170, 16, v173
  v_and_b32 v171, 0xffff0000, v173
  v_lshlrev_b32 v172, 4, v44
  s_lshl_b32 s33, s3, 8
  s_add_u32 s33, s33, 162816
  v_add_u32 v172, s33, v172
  ds_write_b128 v172, v[168:171]
  v_lshrrev_b32 v82, 2, v32
  v_lshlrev_b32 v82, 7, v82
  v_bfe_u32 v81, v32, 3, 2
  v_lshl_add_u32 v82, v81, 5, v82
  v_and_b32 v81, 3, v32
  v_lshl_add_u32 v35, v81, 3, v82
  v_xor_b32 v36, 32, v35
  v_xor_b32 v37, 64, v35
  v_xor_b32 v38, 96, v35
  v_add_u32 v39, 65536, v35
  v_add_u32 v40, 65536, v36
  v_add_u32 v41, 65536, v37
  v_add_u32 v42, 65536, v38
  v_lshrrev_b32 v47, 4, v32
  v_lshlrev_b32 v46, 4, v47
  v_add_u32 v253, 162816, v46
  s_waitcnt lgkmcnt(0)
  s_waitcnt vmcnt(63)
  s_barrier
  ds_read_b64_tr_b16 v[88:89], v35 offset:0
  ds_read_b64_tr_b16 v[90:91], v35 offset:2048
  ds_read_b64_tr_b16 v[92:93], v36 offset:0
  ds_read_b64_tr_b16 v[94:95], v36 offset:2048
  ds_read_b64_tr_b16 v[96:97], v37 offset:0
  ds_read_b64_tr_b16 v[98:99], v37 offset:2048
  ds_read_b64_tr_b16 v[100:101], v38 offset:0
  ds_read_b64_tr_b16 v[102:103], v38 offset:2048
  ds_read_b64_tr_b16 v[104:105], v35 offset:4096
  ds_read_b64_tr_b16 v[106:107], v35 offset:6144
  ds_read_b64_tr_b16 v[108:109], v36 offset:4096
  ds_read_b64_tr_b16 v[110:111], v36 offset:6144
  ds_read_b64_tr_b16 v[112:113], v37 offset:4096
  ds_read_b64_tr_b16 v[114:115], v37 offset:6144
  ds_read_b64_tr_b16 v[116:117], v38 offset:4096
  ds_read_b64_tr_b16 v[118:119], v38 offset:6144
  ds_read_b128 v[64:67], v253 offset:0
  ds_read_b128 v[68:71], v253 offset:64
  ds_read_b128 v[72:75], v253 offset:128
  ds_read_b128 v[76:79], v253 offset:192
  ds_read_b128 v[168:171], v253 offset:256
  ds_read_b128 v[172:175], v253 offset:320
  ds_read_b128 v[176:179], v253 offset:384
  ds_read_b128 v[180:183], v253 offset:448
  ds_read_b128 v[184:187], v253 offset:512
  ds_read_b128 v[188:191], v253 offset:576
  ds_read_b128 v[192:195], v253 offset:640
  ds_read_b128 v[196:199], v253 offset:704
  buffer_load_dword v87, v45, s[64:67], 0 offen sc1
  v_mov_b32 v252, v43
  v_accvgpr_read_b32 v48, a240
  v_accvgpr_read_b32 v49, a241
  v_accvgpr_read_b32 v50, a242
  v_accvgpr_read_b32 v51, a243
  v_accvgpr_read_b32 v52, a244
  v_accvgpr_read_b32 v53, a245
  v_accvgpr_read_b32 v54, a246
  v_accvgpr_read_b32 v55, a247
  v_accvgpr_read_b32 v56, a248
  v_accvgpr_read_b32 v57, a249
  v_accvgpr_read_b32 v58, a250
  v_accvgpr_read_b32 v59, a251
  v_accvgpr_read_b32 v60, a252
  v_accvgpr_read_b32 v61, a253
  v_accvgpr_read_b32 v62, a254
  v_accvgpr_read_b32 v63, a255
  s_lshl_b32 s41, s31, 18
  s_add_u32 s42, s41, 131072
  v_permlane16_swap_b32 v48, v50
  v_permlane16_swap_b32 v49, v51
  v_permlane16_swap_b32 v52, v54
  v_permlane16_swap_b32 v53, v55
  v_permlane16_swap_b32 v56, v58
  v_permlane16_swap_b32 v57, v59
  v_permlane16_swap_b32 v60, v62
  v_permlane16_swap_b32 v61, v63
  v_lshlrev_b32 v120, 16, v48
  v_and_b32 v121, 0xffff0000, v48
  v_lshlrev_b32 v122, 16, v49
  v_and_b32 v123, 0xffff0000, v49
  v_lshlrev_b32 v124, 16, v50
  v_and_b32 v125, 0xffff0000, v50
  v_lshlrev_b32 v126, 16, v51
  v_and_b32 v127, 0xffff0000, v51
  v_lshlrev_b32 v128, 16, v52
  v_and_b32 v129, 0xffff0000, v52
  v_lshlrev_b32 v130, 16, v53
  v_and_b32 v131, 0xffff0000, v53
  v_lshlrev_b32 v132, 16, v54
  v_and_b32 v133, 0xffff0000, v54
  v_lshlrev_b32 v134, 16, v55
  v_and_b32 v135, 0xffff0000, v55
  v_lshlrev_b32 v136, 16, v56
  v_and_b32 v137, 0xffff0000, v56
  v_lshlrev_b32 v138, 16, v57
  v_and_b32 v139, 0xffff0000, v57
  v_lshlrev_b32 v140, 16, v58
  v_and_b32 v141, 0xffff0000, v58
  v_lshlrev_b32 v142, 16, v59
  v_and_b32 v143, 0xffff0000, v59
  v_lshlrev_b32 v144, 16, v60
  v_and_b32 v145, 0xffff0000, v60
  v_lshlrev_b32 v146, 16, v61
  v_and_b32 v147, 0xffff0000, v61
  v_lshlrev_b32 v148, 16, v62
  v_and_b32 v149, 0xffff0000, v62
  v_lshlrev_b32 v150, 16, v63
  v_and_b32 v151, 0xffff0000, v63
  s_add_u32 s52, s20, 0x180000
  s_addc_u32 s53, s21, 0
  s_mov_b32 s54, 0x80000
  s_mov_b32 s55, 0x20000
  s_lshl2_add_u32 s56, s30, s3
  s_lshl_b32 s56, s56, 12
  s_lshl_b32 s57, s31, 8
  s_add_u32 s57, s57, s56
  v_mov_b32 v81, 0xffffff00
  s_bfe_u32 s44, s19, 0x80000
  s_bfe_u32 s45, s19, 0x80008
  s_bfe_u32 s46, s19, 0x80010
  s_bfe_u32 s47, s19, 0x80018
  s_mov_b32 s33, 262144
L_spin_15:
  s_waitcnt vmcnt(0)
  v_cmp_ne_u32 vcc, s19, v87
  s_nop 1
  s_and_b32 s32, vcc_lo, 0xffff
  s_cbranch_scc0 L_rdy_16
  buffer_load_dword v87, v45, s[64:67], 0 offen sc1
  s_sub_u32 s33, s33, 1
  s_cmp_lg_u32 s33, 0
  s_cbranch_scc1 L_spin_15
L_rdy_16:
  buffer_load_dwordx4 a[0:3], v33, s[4:7], s16 offen offset:0 sc1
  buffer_load_dwordx4 a[4:7], v33, s[4:7], s16 offen offset:1024 sc1
  buffer_load_dwordx4 a[8:11], v34, s[4:7], s16 offen offset:0 sc1
  buffer_load_dwordx4 a[12:15], v34, s[4:7], s16 offen offset:1024 sc1
  s_add_u32 s16, s16, 262144
  s_bitset0_b32 s16, 22
  buffer_load_dwordx4 a[16:19], v33, s[4:7], s16 offen offset:0 sc1
  buffer_load_dwordx4 a[20:23], v33, s[4:7], s16 offen offset:1024 sc1
  buffer_load_dwordx4 a[24:27], v34, s[4:7], s16 offen offset:0 sc1
  buffer_load_dwordx4 a[28:31], v34, s[4:7], s16 offen offset:1024 sc1
  s_add_u32 s16, s16, 262144
  s_bitset0_b32 s16, 22
  buffer_load_dwordx4 a[32:35], v33, s[4:7], s16 offen offset:0 sc1
  buffer_load_dwordx4 a[36:39], v33, s[4:7], s16 offen offset:1024 sc1
  buffer_load_dwordx4 a[40:43], v34, s[4:7], s16 offen offset:0 sc1
  buffer_load_dwordx4 a[44:47], v34, s[4:7], s16 offen offset:1024 sc1
  s_add_u32 s16, s16, 262144
  s_bitset0_b32 s16, 22
  buffer_load_dwordx4 a[48:51], v33, s[4:7], s16 offen offset:0 sc1
  buffer_load_dwordx4 a[52:55], v33, s[4:7], s16 offen offset:1024 sc1
  buffer_load_dwordx4 a[56:59], v34, s[4:7], s16 offen offset:0 sc1
  buffer_load_dwordx4 a[60:63], v34, s[4:7], s16 offen offset:1024 sc1
  s_add_u32 s16, s16, 262144
  s_bitset0_b32 s16, 22
  s_waitcnt vmcnt(12) lgkmcnt(10)
  v_mfma_f32_16x16x32_bf16 v[0:3], v[88:91], a[0:3], 0
  buffer_load_dwordx4 a[64:67], v33, s[4:7], s16 offen offset:0 sc1
  v_mfma_f32_16x16x32_bf16 v[16:19], v[88:91], a[4:7], 0
  ds_read_b64_tr_b16 v[88:89], v35 offset:8192
  ds_read_b64_tr_b16 v[90:91], v35 offset:10240
  v_mfma_f32_16x16x32_bf16 v[4:7], v[92:95], a[0:3], 0
  buffer_load_dwordx4 a[68:71], v33, s[4:7], s16 offen offset:1024 sc1
  v_mfma_f32_16x16x32_bf16 v[20:23], v[92:95], a[4:7], 0
  ds_read_b64_tr_b16 v[92:93], v36 offset:8192
  ds_read_b64_tr_b16 v[94:95], v36 offset:10240
  v_mfma_f32_16x16x32_bf16 v[8:11], v[96:99], a[0:3], 0
  v_mfma_f32_16x16x32_bf16 v[24:27], v[96:99], a[4:7], 0
  buffer_load_dwordx4 a[72:75], v34, s[4:7], s16 offen offset:0 sc1
  v_mfma_f32_16x16x32_bf16 v[12:15], v[100:103], a[0:3], 0
  ds_read_b64_tr_b16 v[96:97], v37 offset:8192
  ds_read_b64_tr_b16 v[98:99], v37 offset:10240
  v_mfma_f32_16x16x32_bf16 v[28:31], v[100:103], a[4:7], 0
  buffer_load_dwordx4 a[76:79], v34, s[4:7], s16 offen offset:1024 sc1
  v_mfma_f32_16x16x32_bf16 v[0:3], v[104:107], a[8:11], v[0:3]
  ds_read_b64_tr_b16 v[100:101], v38 offset:8192
  ds_read_b64_tr_b16 v[102:103], v38 offset:10240
  v_mfma_f32_16x16x32_bf16 v[16:19], v[104:107], a[12:15], v[16:19]
  ds_read_b64_tr_b16 v[104:105], v35 offset:12288
  ds_read_b64_tr_b16 v[106:107], v35 offset:14336
  v_mfma_f32_16x16x32_bf16 v[4:7], v[108:111], a[8:11], v[4:7]
  s_add_u32 s16, s16, 262144
  v_mfma_f32_16x16x32_bf16 v[20:23], v[108:111], a[12:15], v[20:23]
  ds_read_b64_tr_b16 v[108:109], v36 offset:12288
  ds_read_b64_tr_b16 v[110:111], v36 offset:14336
  v_mfma_f32_16x16x32_bf16 v[8:11], v[112:115], a[8:11], v[8:11]
  s_bitset0_b32 s16, 22
  v_mfma_f32_16x16x32_bf16 v[24:27], v[112:115], a[12:15], v[24:27]
  ds_read_b64_tr_b16 v[112:113], v37 offset:12288
  ds_read_b64_tr_b16 v[114:115], v37 offset:14336
  v_mfma_f32_16x16x32_bf16 v[12:15], v[116:119], a[8:11], v[12:15]
  v_mfma_f32_16x16x32_bf16 v[28:31], v[116:119], a[12:15], v[28:31]
  s_waitcnt vmcnt(12) lgkmcnt(10)
  ds_read_b64_tr_b16 v[116:117], v38 offset:12288
  v_mfma_f32_16x16x32_bf16 v[0:3], v[88:91], a[16:19], v[0:3]
  buffer_load_dwordx4 a[80:83], v33, s[4:7], s16 offen offset:0 sc1
  v_mfma_f32_16x16x32_bf16 v[16:19], v[88:91], a[20:23], v[16:19]
  ds_read_b64_tr_b16 v[118:119], v38 offset:14336
  ds_read_b64_tr_b16 v[88:89], v35 offset:16384
  v_mfma_f32_16x16x32_bf16 v[4:7], v[92:95], a[16:19], v[4:7]
  buffer_load_dwordx4 a[84:87], v33, s[4:7], s16 offen offset:1024 sc1
  v_mfma_f32_16x16x32_bf16 v[20:23], v[92:95], a[20:23], v[20:23]
  ds_read_b64_tr_b16 v[90:91], v35 offset:18432
  ds_read_b64_tr_b16 v[92:93], v36 offset:16384
  s_waitcnt lgkmcnt(10)
  v_mfma_f32_16x16x32_bf16 v[8:11], v[96:99], a[16:19], v[8:11]
  ds_read_b64_tr_b16 v[94:95], v36 offset:18432
  v_mfma_f32_16x16x32_bf16 v[24:27], v[96:99], a[20:23], v[24:27]
  buffer_load_dwordx4 a[88:91], v34, s[4:7], s16 offen offset:0 sc1
  v_mfma_f32_16x16x32_bf16 v[12:15], v[100:103], a[16:19], v[12:15]
  ds_read_b64_tr_b16 v[96:97], v37 offset:16384
  ds_read_b64_tr_b16 v[98:99], v37 offset:18432
  v_mfma_f32_16x16x32_bf16 v[28:31], v[100:103], a[20:23], v[28:31]
  buffer_load_dwordx4 a[92:95], v34, s[4:7], s16 offen offset:1024 sc1
  s_waitcnt lgkmcnt(10)
  v_mfma_f32_16x16x32_bf16 v[0:3], v[104:107], a[24:27], v[0:3]
  ds_read_b64_tr_b16 v[100:101], v38 offset:16384
  ds_read_b64_tr_b16 v[102:103], v38 offset:18432
  v_mfma_f32_16x16x32_bf16 v[16:19], v[104:107], a[28:31], v[16:19]
  ds_read_b64_tr_b16 v[104:105], v35 offset:20480
  ds_read_b64_tr_b16 v[106:107], v35 offset:22528
  v_mfma_f32_16x16x32_bf16 v[4:7], v[108:111], a[24:27], v[4:7]
  s_add_u32 s16, s16, 262144
  v_mfma_f32_16x16x32_bf16 v[20:23], v[108:111], a[28:31], v[20:23]
  ds_read_b64_tr_b16 v[108:109], v36 offset:20480
  ds_read_b64_tr_b16 v[110:111], v36 offset:22528
  s_waitcnt lgkmcnt(10)
  v_mfma_f32_16x16x32_bf16 v[8:11], v[112:115], a[24:27], v[8:11]
  s_bitset0_b32 s16, 22
  v_mfma_f32_16x16x32_bf16 v[24:27], v[112:115], a[28:31], v[24:27]
  ds_read_b64_tr_b16 v[112:113], v37 offset:20480
  ds_read_b64_tr_b16 v[114:115], v37 offset:22528
  v_mfma_f32_16x16x32_bf16 v[12:15], v[116:119], a[24:27], v[12:15]
  v_mfma_f32_16x16x32_bf16 v[28:31], v[116:119], a[28:31], v[28:31]
  s_waitcnt vmcnt(12) lgkmcnt(10)
  ds_read_b64_tr_b16 v[116:117], v38 offset:20480
  v_mfma_f32_16x16x32_bf16 v[0:3], v[88:91], a[32:35], v[0:3]
  buffer_load_dwordx4 a[96:99], v33, s[4:7], s16 offen offset:0 sc1
  v_mfma_f32_16x16x32_bf16 v[16:19], v[88:91], a[36:39], v[16:19]
  ds_read_b64_tr_b16 v[118:119], v38 offset:22528
  ds_read_b64_tr_b16 v[88:89], v35 offset:24576
  v_mfma_f32_16x16x32_bf16 v[4:7], v[92:95], a[32:35], v[4:7]
  buffer_load_dwordx4 a[100:103], v33, s[4:7], s16 offen offset:1024 sc1
  v_mfma_f32_16x16x32_bf16 v[20:23], v[92:95], a[36:39], v[20:23]
  ds_read_b64_tr_b16 v[90:91], v35 offset:26624
  ds_read_b64_tr_b16 v[92:93], v36 offset:24576
  s_waitcnt lgkmcnt(10)
  v_mfma_f32_16x16x32_bf16 v[8:11], v[96:99], a[32:35], v[8:11]
  ds_read_b64_tr_b16 v[94:95], v36 offset:26624
  v_mfma_f32_16x16x32_bf16 v[24:27], v[96:99], a[36:39], v[24:27]
  buffer_load_dwordx4 a[104:107], v34, s[4:7], s16 offen offset:0 sc1
  v_mfma_f32_16x16x32_bf16 v[12:15], v[100:103], a[32:35], v[12:15]
  ds_read_b64_tr_b16 v[96:97], v37 offset:24576
  ds_read_b64_tr_b16 v[98:99], v37 offset:26624
  v_mfma_f32_16x16x32_bf16 v[28:31], v[100:103], a[36:39], v[28:31]
  buffer_load_dwordx4 a[108:111], v34, s[4:7], s16 offen offset:1024 sc1
  s_waitcnt lgkmcnt(10)
  v_mfma_f32_16x16x32_bf16 v[0:3], v[104:107], a[40:43], v[0:3]
  ds_read_b64_tr_b16 v[100:101], v38 offset:24576
  ds_read_b64_tr_b16 v[102:103], v38 offset:26624
  v_mfma_f32_16x16x32_bf16 v[16:19], v[104:107], a[44:47], v[16:19]
  ds_read_b64_tr_b16 v[104:105], v35 offset:28672
  ds_read_b64_tr_b16 v[106:107], v35 offset:30720
  v_mfma_f32_16x16x32_bf16 v[4:7], v[108:111], a[40:43], v[4:7]
  s_add_u32 s16, s16, 262144
  v_mfma_f32_16x16x32_bf16 v[20:23], v[108:111], a[44:47], v[20:23]
  ds_read_b64_tr_b16 v[108:109], v36 offset:28672
  ds_read_b64_tr_b16 v[110:111], v36 offset:30720
  s_waitcnt lgkmcnt(10)
  v_mfma_f32_16x16x32_bf16 v[8:11], v[112:115], a[40:43], v[8:11]
  s_bitset0_b32 s16, 22
  v_mfma_f32_16x16x32_bf16 v[24:27], v[112:115], a[44:47], v[24:27]
  ds_read_b64_tr_b16 v[112:113], v37 offset:28672
  ds_read_b64_tr_b16 v[114:115], v37 offset:30720
  v_mfma_f32_16x16x32_bf16 v[12:15], v[116:119], a[40:43], v[12:15]
  v_mfma_f32_16x16x32_bf16 v[28:31], v[116:119], a[44:47], v[28:31]
  s_waitcnt vmcnt(12) lgkmcnt(10)
  ds_read_b64_tr_b16 v[116:117], v38 offset:28672
  v_mfma_f32_16x16x32_bf16 v[0:3], v[88:91], a[48:51], v[0:3]
  buffer_load_dwordx4 a[112:115], v33, s[4:7], s16 offen offset:0 sc1
  v_mfma_f32_16x16x32_bf16 v[16:19], v[88:91], a[52:55], v[16:19]
  ds_read_b64_tr_b16 v[118:119], v38 offset:30720
  ds_read_b64_tr_b16 v[88:89], v35 offset:32768
  v_mfma_f32_16x16x32_bf16 v[4:7], v[92:95], a[48:51], v[4:7]
  buffer_load_dwordx4 a[116:119], v33, s[4:7], s16 offen offset:1024 sc1
  v_mfma_f32_16x16x32_bf16 v[20:23], v[92:95], a[52:55], v[20:23]
  ds_read_b64_tr_b16 v[90:91], v35 offset:34816
  ds_read_b64_tr_b16 v[92:93], v36 offset:32768
  s_waitcnt lgkmcnt(10)
  v_mfma_f32_16x16x32_bf16 v[8:11], v[96:99], a[48:51], v[8:11]
  ds_read_b64_tr_b16 v[94:95], v36 offset:34816
  v_mfma_f32_16x16x32_bf16 v[24:27], v[96:99], a[52:55], v[24:27]
  buffer_load_dwordx4 a[120:123], v34, s[4:7], s16 offen offset:0 sc1
  v_mfma_f32_16x16x32_bf16 v[12:15], v[100:103], a[48:51], v[12:15]
  ds_read_b64_tr_b16 v[96:97], v37 offset:32768
  ds_read_b64_tr_b16 v[98:99], v37 offset:34816
  v_mfma_f32_16x16x32_bf16 v[28:31], v[100:103], a[52:55], v[28:31]
  buffer_load_dwordx4 a[124:127], v34, s[4:7], s16 offen offset:1024 sc1
  s_waitcnt lgkmcnt(10)
  v_mfma_f32_16x16x32_bf16 v[0:3], v[104:107], a[56:59], v[0:3]
  ds_read_b64_tr_b16 v[100:101], v38 offset:32768
  ds_read_b64_tr_b16 v[102:103], v38 offset:34816
  v_mfma_f32_16x16x32_bf16 v[16:19], v[104:107], a[60:63], v[16:19]
  ds_read_b64_tr_b16 v[104:105], v35 offset:36864
  ds_read_b64_tr_b16 v[106:107], v35 offset:38912
  v_mfma_f32_16x16x32_bf16 v[4:7], v[108:111], a[56:59], v[4:7]
  s_add_u32 s16, s16, 262144
  v_mfma_f32_16x16x32_bf16 v[20:23], v[108:111], a[60:63], v[20:23]
  ds_read_b64_tr_b16 v[108:109], v36 offset:36864
  ds_read_b64_tr_b16 v[110:111], v36 offset:38912
  s_waitcnt lgkmcnt(10)
  v_mfma_f32_16x16x32_bf16 v[8:11], v[112:115], a[56:59], v[8:11]
  s_bitset0_b32 s16, 22
  v_mfma_f32_16x16x32_bf16 v[24:27], v[112:115], a[60:63], v[24:27]
  ds_read_b64_tr_b16 v[112:113], v37 offset:36864
  ds_read_b64_tr_b16 v[114:115], v37 offset:38912
  v_mfma_f32_16x16x32_bf16 v[12:15], v[116:119], a[56:59], v[12:15]
  v_mfma_f32_16x16x32_bf16 v[28:31], v[116:119], a[60:63], v[28:31]
  s_waitcnt vmcnt(12) lgkmcnt(10)
  ds_read_b64_tr_b16 v[116:117], v38 offset:36864
  v_mfma_f32_16x16x32_bf16 v[0:3], v[88:91], a[64:67], v[0:3]
  buffer_load_dwordx4 a[0:3], v33, s[4:7], s16 offen offset:0 sc1
  v_mfma_f32_16x16x32_bf16 v[16:19], v[88:91], a[68:71], v[16:19]
  ds_read_b64_tr_b16 v[118:119], v38 offset:38912
  ds_read_b64_tr_b16 v[88:89], v35 offset:40960
  v_mfma_f32_16x16x32_bf16 v[4:7], v[92:95], a[64:67], v[4:7]
  buffer_load_dwordx4 a[4:7], v33, s[4:7], s16 offen offset:1024 sc1
  v_mfma_f32_16x16x32_bf16 v[20:23], v[92:95], a[68:71], v[20:23]
  ds_read_b64_tr_b16 v[90:91], v35 offset:43008
  ds_read_b64_tr_b16 v[92:93], v36 offset:40960
  s_waitcnt lgkmcnt(10)
  v_mfma_f32_16x16x32_bf16 v[8:11], v[96:99], a[64:67], v[8:11]
  ds_read_b64_tr_b16 v[94:95], v36 offset:43008
  v_mfma_f32_16x16x32_bf16 v[24:27], v[96:99], a[68:71], v[24:27]
  buffer_load_dwordx4 a[8:11], v34, s[4:7], s16 offen offset:0 sc1
  v_mfma_f32_16x16x32_bf16 v[12:15], v[100:103], a[64:67], v[12:15]
  ds_read_b64_tr_b16 v[96:97], v37 offset:40960
  ds_read_b64_tr_b16 v[98:99], v37 offset:43008
  v_mfma_f32_16x16x32_bf16 v[28:31], v[100:103], a[68:71], v[28:31]
  buffer_load_dwordx4 a[12:15], v34, s[4:7], s16 offen offset:1024 sc1
  s_waitcnt lgkmcnt(10)
  v_mfma_f32_16x16x32_bf16 v[0:3], v[104:107], a[72:75], v[0:3]
  ds_read_b64_tr_b16 v[100:101], v38 offset:40960
  ds_read_b64_tr_b16 v[102:103], v38 offset:43008
  v_mfma_f32_16x16x32_bf16 v[16:19], v[104:107], a[76:79], v[16:19]
  ds_read_b64_tr_b16 v[104:105], v35 offset:45056
  ds_read_b64_tr_b16 v[106:107], v35 offset:47104
  v_mfma_f32_16x16x32_bf16 v[4:7], v[108:111], a[72:75], v[4:7]
  s_add_u32 s16, s16, 262144
  v_mfma_f32_16x16x32_bf16 v[20:23], v[108:111], a[76:79], v[20:23]
  ds_read_b64_tr_b16 v[108:109], v36 offset:45056
  ds_read_b64_tr_b16 v[110:111], v36 offset:47104
  s_waitcnt lgkmcnt(10)
  v_mfma_f32_16x16x32_bf16 v[8:11], v[112:115], a[72:75], v[8:11]
  s_bitset0_b32 s16, 22
  v_mfma_f32_16x16x32_bf16 v[24:27], v[112:115], a[76:79], v[24:27]
  ds_read_b64_tr_b16 v[112:113], v37 offset:45056
  ds_read_b64_tr_b16 v[114:115], v37 offset:47104
  v_mfma_f32_16x16x32_bf16 v[12:15], v[116:119], a[72:75], v[12:15]
  v_mfma_f32_16x16x32_bf16 v[28:31], v[116:119], a[76:79], v[28:31]
  s_waitcnt vmcnt(12) lgkmcnt(10)
  ds_read_b64_tr_b16 v[116:117], v38 offset:45056
  v_mfma_f32_16x16x32_bf16 v[0:3], v[88:91], a[80:83], v[0:3]
  buffer_load_dwordx4 a[16:19], v33, s[4:7], s16 offen offset:0 sc1
  v_mfma_f32_16x16x32_bf16 v[16:19], v[88:91], a[84:87], v[16:19]
  ds_read_b64_tr_b16 v[118:119], v38 offset:47104
  ds_read_b64_tr_b16 v[88:89], v35 offset:49152
  v_mfma_f32_16x16x32_bf16 v[4:7], v[92:95], a[80:83], v[4:7]
  buffer_load_dwordx4 a[20:23], v33, s[4:7], s16 offen offset:1024 sc1
  v_mfma_f32_16x16x32_bf16 v[20:23], v[92:95], a[84:87], v[20:23]
  ds_read_b64_tr_b16 v[90:91], v35 offset:51200
  ds_read_b64_tr_b16 v[92:93], v36 offset:49152
  s_waitcnt lgkmcnt(10)
  v_mfma_f32_16x16x32_bf16 v[8:11], v[96:99], a[80:83], v[8:11]
  ds_read_b64_tr_b16 v[94:95], v36 offset:51200
  v_mfma_f32_16x16x32_bf16 v[24:27], v[96:99], a[84:87], v[24:27]
  buffer_load_dwordx4 a[24:27], v34, s[4:7], s16 offen offset:0 sc1
  v_mfma_f32_16x16x32_bf16 v[12:15], v[100:103], a[80:83], v[12:15]
  ds_read_b64_tr_b16 v[96:97], v37 offset:49152
  ds_read_b64_tr_b16 v[98:99], v37 offset:51200
  v_mfma_f32_16x16x32_bf16 v[28:31], v[100:103], a[84:87], v[28:31]
  buffer_load_dwordx4 a[28:31], v34, s[4:7], s16 offen offset:1024 sc1
  s_waitcnt lgkmcnt(10)
  v_mfma_f32_16x16x32_bf16 v[0:3], v[104:107], a[88:91], v[0:3]
  ds_read_b64_tr_b16 v[100:101], v38 offset:49152
  ds_read_b64_tr_b16 v[102:103], v38 offset:51200
  v_mfma_f32_16x16x32_bf16 v[16:19], v[104:107], a[92:95], v[16:19]
  ds_read_b64_tr_b16 v[104:105], v35 offset:53248
  ds_read_b64_tr_b16 v[106:107], v35 offset:55296
  v_mfma_f32_16x16x32_bf16 v[4:7], v[108:111], a[88:91], v[4:7]
  s_add_u32 s16, s16, 262144
  v_mfma_f32_16x16x32_bf16 v[20:23], v[108:111], a[92:95], v[20:23]
  ds_read_b64_tr_b16 v[108:109], v36 offset:53248
  ds_read_b64_tr_b16 v[110:111], v36 offset:55296
  s_waitcnt lgkmcnt(10)
  v_mfma_f32_16x16x32_bf16 v[8:11], v[112:115], a[88:91], v[8:11]
  s_bitset0_b32 s16, 22
  v_mfma_f32_16x16x32_bf16 v[24:27], v[112:115], a[92:95], v[24:27]
  ds_read_b64_tr_b16 v[112:113], v37 offset:53248
  ds_read_b64_tr_b16 v[114:115], v37 offset:55296
  v_mfma_f32_16x16x32_bf16 v[12:15], v[116:119], a[88:91], v[12:15]
  v_mfma_f32_16x16x32_bf16 v[28:31], v[116:119], a[92:95], v[28:31]
  s_waitcnt vmcnt(12) lgkmcnt(10)
  ds_read_b64_tr_b16 v[116:117], v38 offset:53248
  v_mfma_f32_16x16x32_bf16 v[0:3], v[88:91], a[96:99], v[0:3]
  buffer_load_dwordx4 a[32:35], v33, s[4:7], s16 offen offset:0 sc1
  v_mfma_f32_16x16x32_bf16 v[16:19], v[88:91], a[100:103], v[16:19]
  ds_read_b64_tr_b16 v[118:119], v38 offset:55296
  ds_read_b64_tr_b16 v[88:89], v35 offset:57344
  v_mfma_f32_16x16x32_bf16 v[4:7], v[92:95], a[96:99], v[4:7]
  buffer_load_dwordx4 a[36:39], v33, s[4:7], s16 offen offset:1024 sc1
  v_mfma_f32_16x16x32_bf16 v[20:23], v[92:95], a[100:103], v[20:23]
  ds_read_b64_tr_b16 v[90:91], v35 offset:59392
  ds_read_b64_tr_b16 v[92:93], v36 offset:57344
  s_waitcnt lgkmcnt(10)
  v_mfma_f32_16x16x32_bf16 v[8:11], v[96:99], a[96:99], v[8:11]
  ds_read_b64_tr_b16 v[94:95], v36 offset:59392
  v_mfma_f32_16x16x32_bf16 v[24:27], v[96:99], a[100:103], v[24:27]
  buffer_load_dwordx4 a[40:43], v34, s[4:7], s16 offen offset:0 sc1
  v_mfma_f32_16x16x32_bf16 v[12:15], v[100:103], a[96:99], v[12:15]
  ds_read_b64_tr_b16 v[96:97], v37 offset:57344
  ds_read_b64_tr_b16 v[98:99], v37 offset:59392
  v_mfma_f32_16x16x32_bf16 v[28:31], v[100:103], a[100:103], v[28:31]
  buffer_load_dwordx4 a[44:47], v34, s[4:7], s16 offen offset:1024 sc1
  s_waitcnt lgkmcnt(10)
  v_mfma_f32_16x16x32_bf16 v[0:3], v[104:107], a[104:107], v[0:3]
  ds_read_b64_tr_b16 v[100:101], v38 offset:57344
  ds_read_b64_tr_b16 v[102:103], v38 offset:59392
  v_mfma_f32_16x16x32_bf16 v[16:19], v[104:107], a[108:111], v[16:19]
  ds_read_b64_tr_b16 v[104:105], v35 offset:61440
  ds_read_b64_tr_b16 v[106:107], v35 offset:63488
  v_mfma_f32_16x16x32_bf16 v[4:7], v[108:111], a[104:107], v[4:7]
  s_add_u32 s16, s16, 262144
  v_mfma_f32_16x16x32_bf16 v[20:23], v[108:111], a[108:111], v[20:23]
  ds_read_b64_tr_b16 v[108:109], v36 offset:61440
  ds_read_b64_tr_b16 v[110:111], v36 offset:63488
  s_waitcnt lgkmcnt(10)
  v_mfma_f32_16x16x32_bf16 v[8:11], v[112:115], a[104:107], v[8:11]
  s_bitset0_b32 s16, 22
  v_mfma_f32_16x16x32_bf16 v[24:27], v[112:115], a[108:111], v[24:27]
  ds_read_b64_tr_b16 v[112:113], v37 offset:61440
  ds_read_b64_tr_b16 v[114:115], v37 offset:63488
  v_mfma_f32_16x16x32_bf16 v[12:15], v[116:119], a[104:107], v[12:15]
  v_mfma_f32_16x16x32_bf16 v[28:31], v[116:119], a[108:111], v[28:31]
  s_waitcnt vmcnt(12) lgkmcnt(10)
  ds_read_b64_tr_b16 v[116:117], v38 offset:61440
  v_mfma_f32_16x16x32_bf16 v[0:3], v[88:91], a[112:115], v[0:3]
  buffer_load_dwordx4 a[48:51], v33, s[4:7], s16 offen offset:0 sc1
  v_mfma_f32_16x16x32_bf16 v[16:19], v[88:91], a[116:119], v[16:19]
  ds_read_b64_tr_b16 v[118:119], v38 offset:63488
  ds_read_b64_tr_b16 v[88:89], v39 offset:0
  v_mfma_f32_16x16x32_bf16 v[4:7], v[92:95], a[112:115], v[4:7]
  buffer_load_dwordx4 a[52:55], v33, s[4:7], s16 offen offset:1024 sc1
  v_mfma_f32_16x16x32_bf16 v[20:23], v[92:95], a[116:119], v[20:23]
  ds_read_b64_tr_b16 v[90:91], v39 offset:2048
  ds_read_b64_tr_b16 v[92:93], v40 offset:0
  s_waitcnt lgkmcnt(10)
  v_mfma_f32_16x16x32_bf16 v[8:11], v[96:99], a[112:115], v[8:11]
  ds_read_b64_tr_b16 v[94:95], v40 offset:2048
  v_mfma_f32_16x16x32_bf16 v[24:27], v[96:99], a[116:119], v[24:27]
  buffer_load_dwordx4 a[56:59], v34, s[4:7], s16 offen offset:0 sc1
  v_mfma_f32_16x16x32_bf16 v[12:15], v[100:103], a[112:115], v[12:15]
  ds_read_b64_tr_b16 v[96:97], v41 offset:0
  ds_read_b64_tr_b16 v[98:99], v41 offset:2048
  v_mfma_f32_16x16x32_bf16 v[28:31], v[100:103], a[116:119], v[28:31]
  buffer_load_dwordx4 a[60:63], v34, s[4:7], s16 offen offset:1024 sc1
  s_waitcnt lgkmcnt(10)
  v_mfma_f32_16x16x32_bf16 v[0:3], v[104:107], a[120:123], v[0:3]
  ds_read_b64_tr_b16 v[100:101], v42 offset:0
  ds_read_b64_tr_b16 v[102:103], v42 offset:2048
  v_mfma_f32_16x16x32_bf16 v[16:19], v[104:107], a[124:127], v[16:19]
  ds_read_b64_tr_b16 v[104:105], v39 offset:4096
  ds_read_b64_tr_b16 v[106:107], v39 offset:6144
  v_mfma_f32_16x16x32_bf16 v[4:7], v[108:111], a[120:123], v[4:7]
  s_add_u32 s16, s16, 262144
  v_mfma_f32_16x16x32_bf16 v[20:23], v[108:111], a[124:127], v[20:23]
  ds_read_b64_tr_b16 v[108:109], v40 offset:4096
  ds_read_b64_tr_b16 v[110:111], v40 offset:6144
  s_waitcnt lgkmcnt(10)
  v_mfma_f32_16x16x32_bf16 v[8:11], v[112:115], a[120:123], v[8:11]
  s_bitset0_b32 s16, 22
  v_mfma_f32_16x16x32_bf16 v[24:27], v[112:115], a[124:127], v[24:27]
  ds_read_b64_tr_b16 v[112:113], v41 offset:4096
  ds_read_b64_tr_b16 v[114:115], v41 offset:6144
  v_mfma_f32_16x16x32_bf16 v[12:15], v[116:119], a[120:123], v[12:15]
  v_mfma_f32_16x16x32_bf16 v[28:31], v[116:119], a[124:127], v[28:31]
  s_waitcnt vmcnt(12) lgkmcnt(10)
  ds_read_b64_tr_b16 v[116:117], v42 offset:4096
  v_mfma_f32_16x16x32_bf16 v[0:3], v[88:91], a[0:3], v[0:3]
  buffer_load_dwordx4 a[64:67], v33, s[4:7], s16 offen offset:0 sc1
  v_mfma_f32_16x16x32_bf16 v[16:19], v[88:91], a[4:7], v[16:19]
  ds_read_b64_tr_b16 v[118:119], v42 offset:6144
  ds_read_b64_tr_b16 v[88:89], v39 offset:8192
  v_mfma_f32_16x16x32_bf16 v[4:7], v[92:95], a[0:3], v[4:7]
  buffer_load_dwordx4 a[68:71], v33, s[4:7], s16 offen offset:1024 sc1
  v_mfma_f32_16x16x32_bf16 v[20:23], v[92:95], a[4:7], v[20:23]
  ds_read_b64_tr_b16 v[90:91], v39 offset:10240
  ds_read_b64_tr_b16 v[92:93], v40 offset:8192
  s_waitcnt lgkmcnt(10)
  v_mfma_f32_16x16x32_bf16 v[8:11], v[96:99], a[0:3], v[8:11]
  ds_read_b64_tr_b16 v[94:95], v40 offset:10240
  v_mfma_f32_16x16x32_bf16 v[24:27], v[96:99], a[4:7], v[24:27]
  buffer_load_dwordx4 a[72:75], v34, s[4:7], s16 offen offset:0 sc1
  v_mfma_f32_16x16x32_bf16 v[12:15], v[100:103], a[0:3], v[12:15]
  ds_read_b64_tr_b16 v[96:97], v41 offset:8192
  ds_read_b64_tr_b16 v[98:99], v41 offset:10240
  v_mfma_f32_16x16x32_bf16 v[28:31], v[100:103], a[4:7], v[28:31]
  buffer_load_dwordx4 a[76:79], v34, s[4:7], s16 offen offset:1024 sc1
  s_waitcnt lgkmcnt(10)
  v_mfma_f32_16x16x32_bf16 v[0:3], v[104:107], a[8:11], v[0:3]
  ds_read_b64_tr_b16 v[100:101], v42 offset:8192
  ds_read_b64_tr_b16 v[102:103], v42 offset:10240
  v_mfma_f32_16x16x32_bf16 v[16:19], v[104:107], a[12:15], v[16:19]
  ds_read_b64_tr_b16 v[104:105], v39 offset:12288
  ds_read_b64_tr_b16 v[106:107], v39 offset:14336
  v_mfma_f32_16x16x32_bf16 v[4:7], v[108:111], a[8:11], v[4:7]
  s_add_u32 s16, s16, 262144
  v_mfma_f32_16x16x32_bf16 v[20:23], v[108:111], a[12:15], v[20:23]
  ds_read_b64_tr_b16 v[108:109], v40 offset:12288
  ds_read_b64_tr_b16 v[110:111], v40 offset:14336
  s_waitcnt lgkmcnt(10)
  v_mfma_f32_16x16x32_bf16 v[8:11], v[112:115], a[8:11], v[8:11]
  s_bitset0_b32 s16, 22
  v_mfma_f32_16x16x32_bf16 v[24:27], v[112:115], a[12:15], v[24:27]
  ds_read_b64_tr_b16 v[112:113], v41 offset:12288
  ds_read_b64_tr_b16 v[114:115], v41 offset:14336
  v_mfma_f32_16x16x32_bf16 v[12:15], v[116:119], a[8:11], v[12:15]
  v_mfma_f32_16x16x32_bf16 v[28:31], v[116:119], a[12:15], v[28:31]
  s_waitcnt vmcnt(12) lgkmcnt(10)
  ds_read_b64_tr_b16 v[116:117], v42 offset:12288
  v_mfma_f32_16x16x32_bf16 v[0:3], v[88:91], a[16:19], v[0:3]
  buffer_load_dwordx4 a[80:83], v33, s[4:7], s16 offen offset:0 sc1
  v_mfma_f32_16x16x32_bf16 v[16:19], v[88:91], a[20:23], v[16:19]
  ds_read_b64_tr_b16 v[118:119], v42 offset:14336
  ds_read_b64_tr_b16 v[88:89], v39 offset:16384
  v_mfma_f32_16x16x32_bf16 v[4:7], v[92:95], a[16:19], v[4:7]
  buffer_load_dwordx4 a[84:87], v33, s[4:7], s16 offen offset:1024 sc1
  v_mfma_f32_16x16x32_bf16 v[20:23], v[92:95], a[20:23], v[20:23]
  ds_read_b64_tr_b16 v[90:91], v39 offset:18432
  ds_read_b64_tr_b16 v[92:93], v40 offset:16384
  s_waitcnt lgkmcnt(10)
  v_mfma_f32_16x16x32_bf16 v[8:11], v[96:99], a[16:19], v[8:11]
  ds_read_b64_tr_b16 v[94:95], v40 offset:18432
  v_mfma_f32_16x16x32_bf16 v[24:27], v[96:99], a[20:23], v[24:27]
  buffer_load_dwordx4 a[88:91], v34, s[4:7], s16 offen offset:0 sc1
  v_mfma_f32_16x16x32_bf16 v[12:15], v[100:103], a[16:19], v[12:15]
  ds_read_b64_tr_b16 v[96:97], v41 offset:16384
  ds_read_b64_tr_b16 v[98:99], v41 offset:18432
  v_mfma_f32_16x16x32_bf16 v[28:31], v[100:103], a[20:23], v[28:31]
  buffer_load_dwordx4 a[92:95], v34, s[4:7], s16 offen offset:1024 sc1
  s_waitcnt lgkmcnt(10)
  v_mfma_f32_16x16x32_bf16 v[0:3], v[104:107], a[24:27], v[0:3]
  ds_read_b64_tr_b16 v[100:101], v42 offset:16384
  ds_read_b64_tr_b16 v[102:103], v42 offset:18432
  v_mfma_f32_16x16x32_bf16 v[16:19], v[104:107], a[28:31], v[16:19]
  ds_read_b64_tr_b16 v[104:105], v39 offset:20480
  ds_read_b64_tr_b16 v[106:107], v39 offset:22528
  v_mfma_f32_16x16x32_bf16 v[4:7], v[108:111], a[24:27], v[4:7]
  s_add_u32 s16, s16, 262144
  v_mfma_f32_16x16x32_bf16 v[20:23], v[108:111], a[28:31], v[20:23]
  ds_read_b64_tr_b16 v[108:109], v40 offset:20480
  ds_read_b64_tr_b16 v[110:111], v40 offset:22528
  s_waitcnt lgkmcnt(10)
  v_mfma_f32_16x16x32_bf16 v[8:11], v[112:115], a[24:27], v[8:11]
  s_bitset0_b32 s16, 22
  v_mfma_f32_16x16x32_bf16 v[24:27], v[112:115], a[28:31], v[24:27]
  ds_read_b64_tr_b16 v[112:113], v41 offset:20480
  ds_read_b64_tr_b16 v[114:115], v41 offset:22528
  v_mfma_f32_16x16x32_bf16 v[12:15], v[116:119], a[24:27], v[12:15]
  v_mfma_f32_16x16x32_bf16 v[28:31], v[116:119], a[28:31], v[28:31]
  s_waitcnt vmcnt(12) lgkmcnt(10)
  ds_read_b64_tr_b16 v[116:117], v42 offset:20480
  v_mfma_f32_16x16x32_bf16 v[0:3], v[88:91], a[32:35], v[0:3]
  buffer_load_dwordx4 a[96:99], v33, s[4:7], s16 offen offset:0 sc1
  v_mfma_f32_16x16x32_bf16 v[16:19], v[88:91], a[36:39], v[16:19]
  ds_read_b64_tr_b16 v[118:119], v42 offset:22528
  ds_read_b64_tr_b16 v[88:89], v39 offset:24576
  v_mfma_f32_16x16x32_bf16 v[4:7], v[92:95], a[32:35], v[4:7]
  buffer_load_dwordx4 a[100:103], v33, s[4:7], s16 offen offset:1024 sc1
  v_mfma_f32_16x16x32_bf16 v[20:23], v[92:95], a[36:39], v[20:23]
  ds_read_b64_tr_b16 v[90:91], v39 offset:26624
  ds_read_b64_tr_b16 v[92:93], v40 offset:24576
  s_waitcnt lgkmcnt(10)
  v_mfma_f32_16x16x32_bf16 v[8:11], v[96:99], a[32:35], v[8:11]
  ds_read_b64_tr_b16 v[94:95], v40 offset:26624
  v_mfma_f32_16x16x32_bf16 v[24:27], v[96:99], a[36:39], v[24:27]
  buffer_load_dwordx4 a[104:107], v34, s[4:7], s16 offen offset:0 sc1
  v_mfma_f32_16x16x32_bf16 v[12:15], v[100:103], a[32:35], v[12:15]
  ds_read_b64_tr_b16 v[96:97], v41 offset:24576
  ds_read_b64_tr_b16 v[98:99], v41 offset:26624
  v_mfma_f32_16x16x32_bf16 v[28:31], v[100:103], a[36:39], v[28:31]
  buffer_load_dwordx4 a[108:111], v34, s[4:7], s16 offen offset:1024 sc1
  s_waitcnt lgkmcnt(10)
  v_mfma_f32_16x16x32_bf16 v[0:3], v[104:107], a[40:43], v[0:3]
  ds_read_b64_tr_b16 v[100:101], v42 offset:24576
  ds_read_b64_tr_b16 v[102:103], v42 offset:26624
  v_mfma_f32_16x16x32_bf16 v[16:19], v[104:107], a[44:47], v[16:19]
  ds_read_b64_tr_b16 v[104:105], v39 offset:28672
  ds_read_b64_tr_b16 v[106:107], v39 offset:30720
  v_mfma_f32_16x16x32_bf16 v[4:7], v[108:111], a[40:43], v[4:7]
  s_add_u32 s16, s16, 262144
  v_mfma_f32_16x16x32_bf16 v[20:23], v[108:111], a[44:47], v[20:23]
  ds_read_b64_tr_b16 v[108:109], v40 offset:28672
  ds_read_b64_tr_b16 v[110:111], v40 offset:30720
  s_waitcnt lgkmcnt(10)
  v_mfma_f32_16x16x32_bf16 v[8:11], v[112:115], a[40:43], v[8:11]
  s_bitset0_b32 s16, 22
  v_mfma_f32_16x16x32_bf16 v[24:27], v[112:115], a[44:47], v[24:27]
  ds_read_b64_tr_b16 v[112:113], v41 offset:28672
  ds_read_b64_tr_b16 v[114:115], v41 offset:30720
  v_mfma_f32_16x16x32_bf16 v[12:15], v[116:119], a[40:43], v[12:15]
  v_mfma_f32_16x16x32_bf16 v[28:31], v[116:119], a[44:47], v[28:31]
  s_waitcnt vmcnt(12) lgkmcnt(10)
  ds_read_b64_tr_b16 v[116:117], v42 offset:28672
  v_mfma_f32_16x16x32_bf16 v[0:3], v[88:91], a[48:51], v[0:3]
  buffer_load_dwordx4 a[112:115], v33, s[4:7], s16 offen offset:0 sc1
  v_mfma_f32_16x16x32_bf16 v[16:19], v[88:91], a[52:55], v[16:19]
  ds_read_b64_tr_b16 v[118:119], v42 offset:30720
  ds_read_b64_tr_b16 v[88:89], v39 offset:32768
  v_mfma_f32_16x16x32_bf16 v[4:7], v[92:95], a[48:51], v[4:7]
  buffer_load_dwordx4 a[116:119], v33, s[4:7], s16 offen offset:1024 sc1
  v_mfma_f32_16x16x32_bf16 v[20:23], v[92:95], a[52:55], v[20:23]
  ds_read_b64_tr_b16 v[90:91], v39 offset:34816
  ds_read_b64_tr_b16 v[92:93], v40 offset:32768
  s_waitcnt lgkmcnt(10)
  v_mfma_f32_16x16x32_bf16 v[8:11], v[96:99], a[48:51], v[8:11]
  ds_read_b64_tr_b16 v[94:95], v40 offset:34816
  v_mfma_f32_16x16x32_bf16 v[24:27], v[96:99], a[52:55], v[24:27]
  buffer_load_dwordx4 a[120:123], v34, s[4:7], s16 offen offset:0 sc1
  v_mfma_f32_16x16x32_bf16 v[12:15], v[100:103], a[48:51], v[12:15]
  ds_read_b64_tr_b16 v[96:97], v41 offset:32768
  ds_read_b64_tr_b16 v[98:99], v41 offset:34816
  v_mfma_f32_16x16x32_bf16 v[28:31], v[100:103], a[52:55], v[28:31]
  buffer_load_dwordx4 a[124:127], v34, s[4:7], s16 offen offset:1024 sc1
  s_waitcnt lgkmcnt(10)
  v_mfma_f32_16x16x32_bf16 v[0:3], v[104:107], a[56:59], v[0:3]
  ds_read_b64_tr_b16 v[100:101], v42 offset:32768
  ds_read_b64_tr_b16 v[102:103], v42 offset:34816
  v_mfma_f32_16x16x32_bf16 v[16:19], v[104:107], a[60:63], v[16:19]
  ds_read_b64_tr_b16 v[104:105], v39 offset:36864
  ds_read_b64_tr_b16 v[106:107], v39 offset:38912
  v_mfma_f32_16x16x32_bf16 v[4:7], v[108:111], a[56:59], v[4:7]
  s_add_u32 s16, s16, 262144
  v_mfma_f32_16x16x32_bf16 v[20:23], v[108:111], a[60:63], v[20:23]
  ds_read_b64_tr_b16 v[108:109], v40 offset:36864
  ds_read_b64_tr_b16 v[110:111], v40 offset:38912
  s_waitcnt lgkmcnt(10)
  v_mfma_f32_16x16x32_bf16 v[8:11], v[112:115], a[56:59], v[8:11]
  s_bitset0_b32 s16, 22
  v_mfma_f32_16x16x32_bf16 v[24:27], v[112:115], a[60:63], v[24:27]
  ds_read_b64_tr_b16 v[112:113], v41 offset:36864
  ds_read_b64_tr_b16 v[114:115], v41 offset:38912
  v_mfma_f32_16x16x32_bf16 v[12:15], v[116:119], a[56:59], v[12:15]
  v_mfma_f32_16x16x32_bf16 v[28:31], v[116:119], a[60:63], v[28:31]
  s_waitcnt vmcnt(12) lgkmcnt(10)
  ds_read_b64_tr_b16 v[116:117], v42 offset:36864
  v_mfma_f32_16x16x32_bf16 v[0:3], v[88:91], a[64:67], v[0:3]
  ds_read_b64_tr_b16 v[118:119], v42 offset:38912
  v_mfma_f32_16x16x32_bf16 v[16:19], v[88:91], a[68:71], v[16:19]
  ds_read_b64_tr_b16 v[88:89], v39 offset:40960
  ds_read_b64_tr_b16 v[90:91], v39 offset:43008
  v_mfma_f32_16x16x32_bf16 v[4:7], v[92:95], a[64:67], v[4:7]
  v_mfma_f32_16x16x32_bf16 v[20:23], v[92:95], a[68:71], v[20:23]
  ds_read_b64_tr_b16 v[92:93], v40 offset:40960
  ds_read_b64_tr_b16 v[94:95], v40 offset:43008
  s_waitcnt lgkmcnt(10)
  v_mfma_f32_16x16x32_bf16 v[8:11], v[96:99], a[64:67], v[8:11]
  v_mfma_f32_16x16x32_bf16 v[24:27], v[96:99], a[68:71], v[24:27]
  ds_read_b64_tr_b16 v[96:97], v41 offset:40960
  ds_read_b64_tr_b16 v[98:99], v41 offset:43008
  v_mfma_f32_16x16x32_bf16 v[12:15], v[100:103], a[64:67], v[12:15]
  v_mfma_f32_16x16x32_bf16 v[28:31], v[100:103], a[68:71], v[28:31]
  ds_read_b64_tr_b16 v[100:101], v42 offset:40960
  ds_read_b64_tr_b16 v[102:103], v42 offset:43008
  v_mfma_f32_16x16x32_bf16 v[0:3], v[104:107], a[72:75], v[0:3]
  v_mfma_f32_16x16x32_bf16 v[16:19], v[104:107], a[76:79], v[16:19]
  ds_read_b64_tr_b16 v[104:105], v39 offset:45056
  ds_read_b64_tr_b16 v[106:107], v39 offset:47104
  s_waitcnt lgkmcnt(10)
  v_mfma_f32_16x16x32_bf16 v[4:7], v[108:111], a[72:75], v[4:7]
  v_mfma_f32_16x16x32_bf16 v[20:23], v[108:111], a[76:79], v[20:23]
  ds_read_b64_tr_b16 v[108:109], v40 offset:45056
  ds_read_b64_tr_b16 v[110:111], v40 offset:47104
  v_mfma_f32_16x16x32_bf16 v[8:11], v[112:115], a[72:75], v[8:11]
  v_mfma_f32_16x16x32_bf16 v[24:27], v[112:115], a[76:79], v[24:27]
  ds_read_b64_tr_b16 v[112:113], v41 offset:45056
  ds_read_b64_tr_b16 v[114:115], v41 offset:47104
  v_mfma_f32_16x16x32_bf16 v[12:15], v[116:119], a[72:75], v[12:15]
  v_mfma_f32_16x16x32_bf16 v[28:31], v[116:119], a[76:79], v[28:31]
  s_waitcnt vmcnt(8) lgkmcnt(10)
  ds_read_b64_tr_b16 v[116:117], v42 offset:45056
  v_mfma_f32_16x16x32_bf16 v[0:3], v[88:91], a[80:83], v[0:3]
  ds_read_b64_tr_b16 v[118:119], v42 offset:47104
  v_mfma_f32_16x16x32_bf16 v[16:19], v[88:91], a[84:87], v[16:19]
  ds_read_b64_tr_b16 v[88:89], v39 offset:49152
  ds_read_b64_tr_b16 v[90:91], v39 offset:51200
  v_mfma_f32_16x16x32_bf16 v[4:7], v[92:95], a[80:83], v[4:7]
  v_mfma_f32_16x16x32_bf16 v[20:23], v[92:95], a[84:87], v[20:23]
  ds_read_b64_tr_b16 v[92:93], v40 offset:49152
  ds_read_b64_tr_b16 v[94:95], v40 offset:51200
  s_waitcnt lgkmcnt(10)
  v_mfma_f32_16x16x32_bf16 v[8:11], v[96:99], a[80:83], v[8:11]
  v_mfma_f32_16x16x32_bf16 v[24:27], v[96:99], a[84:87], v[24:27]
  ds_read_b64_tr_b16 v[96:97], v41 offset:49152
  ds_read_b64_tr_b16 v[98:99], v41 offset:51200
  v_mfma_f32_16x16x32_bf16 v[12:15], v[100:103], a[80:83], v[12:15]
  v_mfma_f32_16x16x32_bf16 v[28:31], v[100:103], a[84:87], v[28:31]
  ds_read_b64_tr_b16 v[100:101], v42 offset:49152
  ds_read_b64_tr_b16 v[102:103], v42 offset:51200
  v_mfma_f32_16x16x32_bf16 v[0:3], v[104:107], a[88:91], v[0:3]
  v_mfma_f32_16x16x32_bf16 v[16:19], v[104:107], a[92:95], v[16:19]
  ds_read_b64_tr_b16 v[104:105], v39 offset:53248
  ds_read_b64_tr_b16 v[106:107], v39 offset:55296
  s_waitcnt lgkmcnt(10)
  v_mfma_f32_16x16x32_bf16 v[4:7], v[108:111], a[88:91], v[4:7]
  v_mfma_f32_16x16x32_bf16 v[20:23], v[108:111], a[92:95], v[20:23]
  ds_read_b64_tr_b16 v[108:109], v40 offset:53248
  ds_read_b64_tr_b16 v[110:111], v40 offset:55296
  v_mfma_f32_16x16x32_bf16 v[8:11], v[112:115], a[88:91], v[8:11]
  v_mfma_f32_16x16x32_bf16 v[24:27], v[112:115], a[92:95], v[24:27]
  ds_read_b64_tr_b16 v[112:113], v41 offset:53248
  ds_read_b64_tr_b16 v[114:115], v41 offset:55296
  v_mfma_f32_16x16x32_bf16 v[12:15], v[116:119], a[88:91], v[12:15]
  v_mfma_f32_16x16x32_bf16 v[28:31], v[116:119], a[92:95], v[28:31]
  s_waitcnt vmcnt(4) lgkmcnt(10)
  ds_read_b64_tr_b16 v[116:117], v42 offset:53248
  v_mfma_f32_16x16x32_bf16 v[0:3], v[88:91], a[96:99], v[0:3]
  ds_read_b64_tr_b16 v[118:119], v42 offset:55296
  v_mfma_f32_16x16x32_bf16 v[16:19], v[88:91], a[100:103], v[16:19]
  ds_read_b64_tr_b16 v[88:89], v39 offset:57344
  ds_read_b64_tr_b16 v[90:91], v39 offset:59392
  v_mfma_f32_16x16x32_bf16 v[4:7], v[92:95], a[96:99], v[4:7]
  v_mfma_f32_16x16x32_bf16 v[20:23], v[92:95], a[100:103], v[20:23]
  ds_read_b64_tr_b16 v[92:93], v40 offset:57344
  ds_read_b64_tr_b16 v[94:95], v40 offset:59392
  s_waitcnt lgkmcnt(10)
  v_mfma_f32_16x16x32_bf16 v[8:11], v[96:99], a[96:99], v[8:11]
  v_mfma_f32_16x16x32_bf16 v[24:27], v[96:99], a[100:103], v[24:27]
  ds_read_b64_tr_b16 v[96:97], v41 offset:57344
  ds_read_b64_tr_b16 v[98:99], v41 offset:59392
  v_mfma_f32_16x16x32_bf16 v[12:15], v[100:103], a[96:99], v[12:15]
  v_mfma_f32_16x16x32_bf16 v[28:31], v[100:103], a[100:103], v[28:31]
  ds_read_b64_tr_b16 v[100:101], v42 offset:57344
  ds_read_b64_tr_b16 v[102:103], v42 offset:59392
  v_mfma_f32_16x16x32_bf16 v[0:3], v[104:107], a[104:107], v[0:3]
  v_mfma_f32_16x16x32_bf16 v[16:19], v[104:107], a[108:111], v[16:19]
  ds_read_b64_tr_b16 v[104:105], v39 offset:61440
  ds_read_b64_tr_b16 v[106:107], v39 offset:63488
  s_waitcnt lgkmcnt(10)
  v_mfma_f32_16x16x32_bf16 v[4:7], v[108:111], a[104:107], v[4:7]
  v_mfma_f32_16x16x32_bf16 v[20:23], v[108:111], a[108:111], v[20:23]
  ds_read_b64_tr_b16 v[108:109], v40 offset:61440
  ds_read_b64_tr_b16 v[110:111], v40 offset:63488
  v_mfma_f32_16x16x32_bf16 v[8:11], v[112:115], a[104:107], v[8:11]
  v_mfma_f32_16x16x32_bf16 v[24:27], v[112:115], a[108:111], v[24:27]
  ds_read_b64_tr_b16 v[112:113], v41 offset:61440
  ds_read_b64_tr_b16 v[114:115], v41 offset:63488
  v_mfma_f32_16x16x32_bf16 v[12:15], v[116:119], a[104:107], v[12:15]
  v_mfma_f32_16x16x32_bf16 v[28:31], v[116:119], a[108:111], v[28:31]
  s_waitcnt vmcnt(0) lgkmcnt(10)
  ds_read_b64_tr_b16 v[116:117], v42 offset:61440
  v_mfma_f32_16x16x32_bf16 v[0:3], v[88:91], a[112:115], v[0:3]
  ds_read_b64_tr_b16 v[118:119], v42 offset:63488
  v_mfma_f32_16x16x32_bf16 v[16:19], v[88:91], a[116:119], v[16:19]
  v_mfma_f32_16x16x32_bf16 v[4:7], v[92:95], a[112:115], v[4:7]
  v_mfma_f32_16x16x32_bf16 v[20:23], v[92:95], a[116:119], v[20:23]
  s_waitcnt lgkmcnt(10)
  v_mfma_f32_16x16x32_bf16 v[8:11], v[96:99], a[112:115], v[8:11]
  v_mfma_f32_16x16x32_bf16 v[24:27], v[96:99], a[116:119], v[24:27]
  s_waitcnt lgkmcnt(8)
  v_mfma_f32_16x16x32_bf16 v[12:15], v[100:103], a[112:115], v[12:15]
  v_mfma_f32_16x16x32_bf16 v[28:31], v[100:103], a[116:119], v[28:31]
  s_waitcnt lgkmcnt(6)
  v_mfma_f32_16x16x32_bf16 v[0:3], v[104:107], a[120:123], v[0:3]
  v_mfma_f32_16x16x32_bf16 v[16:19], v[104:107], a[124:127], v[16:19]
  s_waitcnt lgkmcnt(4)
  v_mfma_f32_16x16x32_bf16 v[4:7], v[108:111], a[120:123], v[4:7]
  v_mfma_f32_16x16x32_bf16 v[20:23], v[108:111], a[124:127], v[20:23]
  s_waitcnt lgkmcnt(2)
  v_mfma_f32_16x16x32_bf16 v[8:11], v[112:115], a[120:123], v[8:11]
  v_mfma_f32_16x16x32_bf16 v[24:27], v[112:115], a[124:127], v[24:27]
  s_waitcnt lgkmcnt(0)
  v_mfma_f32_16x16x32_bf16 v[12:15], v[116:119], a[120:123], v[12:15]
  v_mfma_f32_16x16x32_bf16 v[28:31], v[116:119], a[124:127], v[28:31]
  s_nop 7
  s_nop 1
  s_barrier
  v_pk_fma_f32 v[120:121], v[0:1], v[64:65], v[120:121]
  v_pk_fma_f32 v[122:123], v[2:3], v[66:67], v[122:123]
  v_pk_fma_f32 v[124:125], v[4:5], v[68:69], v[124:125]
  v_pk_fma_f32 v[126:127], v[6:7], v[70:71], v[126:127]
  v_pk_fma_f32 v[128:129], v[8:9], v[72:73], v[128:129]
  v_pk_fma_f32 v[130:131], v[10:11], v[74:75], v[130:131]
  v_pk_fma_f32 v[132:133], v[12:13], v[76:77], v[132:133]
  v_pk_fma_f32 v[134:135], v[14:15], v[78:79], v[134:135]
  v_pk_fma_f32 v[136:137], v[16:17], v[64:65], v[136:137]
  v_pk_fma_f32 v[138:139], v[18:19], v[66:67], v[138:139]
  v_pk_fma_f32 v[140:141], v[20:21], v[68:69], v[140:141]
  v_pk_fma_f32 v[142:143], v[22:23], v[70:71], v[142:143]
  v_pk_fma_f32 v[144:145], v[24:25], v[72:73], v[144:145]
  v_pk_fma_f32 v[146:147], v[26:27], v[74:75], v[146:147]
  v_pk_fma_f32 v[148:149], v[28:29], v[76:77], v[148:149]
  v_pk_fma_f32 v[150:151], v[30:31], v[78:79], v[150:151]
  v_pk_mul_f32 v[160:161], v[120:121], v[120:121]
  v_pk_mul_f32 v[162:163], v[136:137], v[136:137]
  v_pk_fma_f32 v[160:161], v[122:123], v[122:123], v[160:161]
  v_pk_add_f32 v[152:153], v[120:121], v[122:123]
  v_pk_fma_f32 v[162:163], v[138:139], v[138:139], v[162:163]
  v_pk_add_f32 v[154:155], v[136:137], v[138:139]
  v_pk_fma_f32 v[160:161], v[124:125], v[124:125], v[160:161]
  v_pk_add_f32 v[152:153], v[152:153], v[124:125]
  v_pk_fma_f32 v[162:163], v[140:141], v[140:141], v[162:163]
  v_pk_add_f32 v[154:155], v[154:155], v[140:141]
  v_pk_fma_f32 v[160:161], v[126:127], v[126:127], v[160:161]
  v_pk_add_f32 v[152:153], v[152:153], v[126:127]
  v_pk_fma_f32 v[162:163], v[142:143], v[142:143], v[162:163]
  v_pk_add_f32 v[154:155], v[154:155], v[142:143]
  v_pk_fma_f32 v[160:161], v[128:129], v[128:129], v[160:161]
  v_pk_add_f32 v[152:153], v[152:153], v[128:129]
  v_pk_fma_f32 v[162:163], v[144:145], v[144:145], v[162:163]
  v_pk_add_f32 v[154:155], v[154:155], v[144:145]
  v_pk_fma_f32 v[160:161], v[130:131], v[130:131], v[160:161]
  v_pk_add_f32 v[152:153], v[152:153], v[130:131]
  v_pk_fma_f32 v[162:163], v[146:147], v[146:147], v[162:163]
  v_pk_add_f32 v[154:155], v[154:155], v[146:147]
  v_pk_fma_f32 v[160:161], v[132:133], v[132:133], v[160:161]
  v_pk_add_f32 v[152:153], v[152:153], v[132:133]
  v_pk_fma_f32 v[162:163], v[148:149], v[148:149], v[162:163]
  v_pk_add_f32 v[154:155], v[154:155], v[148:149]
  v_pk_fma_f32 v[160:161], v[134:135], v[134:135], v[160:161]
  v_pk_add_f32 v[152:153], v[152:153], v[134:135]
  v_pk_fma_f32 v[162:163], v[150:151], v[150:151], v[162:163]
  v_pk_add_f32 v[154:155], v[154:155], v[150:151]
  v_add_f32 v152, v152, v153
  v_add_f32 v153, v160, v161
  v_add_f32 v154, v154, v155
  v_add_f32 v155, v162, v163
  v_mov_b32 v160, v152
  v_mov_b32 v161, v153
  v_mov_b32 v162, v154
  v_mov_b32 v163, v155
  s_nop 1
  v_permlane16_swap_b32 v160, v152
  v_permlane16_swap_b32 v161, v153
  v_permlane16_swap_b32 v162, v154
  v_permlane16_swap_b32 v163, v155
  s_nop 1
  v_add_f32 v152, v152, v160
  v_add_f32 v153, v153, v161
  v_add_f32 v154, v154, v162
  v_add_f32 v155, v155, v163
  v_mov_b32 v160, v152
  v_mov_b32 v161, v153
  v_mov_b32 v162, v154
  v_mov_b32 v163, v155
  s_nop 1
  v_permlane32_swap_b32 v160, v152
  v_permlane32_swap_b32 v161, v153
  v_permlane32_swap_b32 v162, v154
  v_permlane32_swap_b32 v163, v155
  s_nop 1
  v_add_f32 v152, v152, v160
  v_add_f32 v153, v153, v161
  v_add_f32 v154, v154, v162
  v_add_f32 v155, v155, v163
  v_mul_f32 v160, 0xbc800000, v152
  v_mul_f32 v161, 0xbc800000, v154
  v_fmac_f32 v153, v160, v152
  v_fmac_f32 v155, v161, v154
  v_and_or_b32 v156, v152, v81, s44
  v_and_or_b32 v157, v153, v81, s45
  v_and_or_b32 v158, v154, v81, s46
  v_and_or_b32 v159, v155, v81, s47
  s_mov_b64 exec, 0xffff
  buffer_store_dwordx4 v[156:159], v80, s[52:55], s57 offen sc1
  s_mov_b64 exec, -1
  s_add_u32 m0, s38, 0
  s_nop 0
  buffer_load_dwordx4 v225, s[8:11], s17 offen lds
  buffer_load_dwordx4 v226, s[8:11], s17 offen offset:1024 lds
  buffer_load_dwordx4 v227, s[8:11], s17 offen offset:2048 lds
  s_mov_b32 exec_hi, 0
  buffer_load_dwordx4 v228, s[8:11], s17 offen offset:3072 lds
  s_mov_b32 exec_hi, -1
  s_add_u32 s17, s17, 229376
  s_add_u32 m0, s38, 14336
  s_nop 0
  buffer_load_dwordx4 v225, s[8:11], s17 offen lds
  buffer_load_dwordx4 v226, s[8:11], s17 offen offset:1024 lds
  buffer_load_dwordx4 v227, s[8:11], s17 offen offset:2048 lds
  s_mov_b32 exec_hi, 0
  buffer_load_dwordx4 v228, s[8:11], s17 offen offset:3072 lds
  s_mov_b32 exec_hi, -1
  s_add_u32 s17, s17, 229376
  s_add_u32 m0, s38, 28672
  s_nop 0
  buffer_load_dwordx4 v225, s[8:11], s17 offen lds
  buffer_load_dwordx4 v226, s[8:11], s17 offen offset:1024 lds
  buffer_load_dwordx4 v227, s[8:11], s17 offen offset:2048 lds
  s_mov_b32 exec_hi, 0
  buffer_load_dwordx4 v228, s[8:11], s17 offen offset:3072 lds
  s_mov_b32 exec_hi, -1
  s_add_u32 s17, s17, 229376
  v_cvt_pk_bf16_f32 v48, v120, v121
  v_cvt_pk_bf16_f32 v49, v122, v123
  v_cvt_pk_bf16_f32 v50, v124, v125
  v_cvt_pk_bf16_f32 v51, v126, v127
  v_cvt_pk_bf16_f32 v52, v128, v129
  v_cvt_pk_bf16_f32 v53, v130, v131
  v_cvt_pk_bf16_f32 v54, v132, v133
  v_cvt_pk_bf16_f32 v55, v134, v135
  v_cvt_pk_bf16_f32 v56, v136, v137
  v_cvt_pk_bf16_f32 v57, v138, v139
  v_cvt_pk_bf16_f32 v58, v140, v141
  v_cvt_pk_bf16_f32 v59, v142, v143
  v_cvt_pk_bf16_f32 v60, v144, v145
  v_cvt_pk_bf16_f32 v61, v146, v147
  v_cvt_pk_bf16_f32 v62, v148, v149
  v_cvt_pk_bf16_f32 v63, v150, v151
  v_accvgpr_write_b32 a128, v48
  v_lshlrev_b32 v0, 16, v48
  v_and_b32 v1, 0xffff0000, v48
  v_accvgpr_write_b32 a129, v49
  v_lshlrev_b32 v2, 16, v49
  v_and_b32 v3, 0xffff0000, v49
  v_accvgpr_write_b32 a130, v50
  v_lshlrev_b32 v4, 16, v50
  v_and_b32 v5, 0xffff0000, v50
  v_accvgpr_write_b32 a131, v51
  v_lshlrev_b32 v6, 16, v51
  v_and_b32 v7, 0xffff0000, v51
  v_accvgpr_write_b32 a132, v52
  v_lshlrev_b32 v8, 16, v52
  v_and_b32 v9, 0xffff0000, v52
  v_accvgpr_write_b32 a133, v53
  v_lshlrev_b32 v10, 16, v53
  v_and_b32 v11, 0xffff0000, v53
  v_accvgpr_write_b32 a134, v54
  v_lshlrev_b32 v12, 16, v54
  v_and_b32 v13, 0xffff0000, v54
  v_accvgpr_write_b32 a135, v55
  v_lshlrev_b32 v14, 16, v55
  v_and_b32 v15, 0xffff0000, v55
  v_accvgpr_write_b32 a136, v56
  v_lshlrev_b32 v16, 16, v56
  v_and_b32 v17, 0xffff0000, v56
  v_accvgpr_write_b32 a137, v57
  v_lshlrev_b32 v18, 16, v57
  v_and_b32 v19, 0xffff0000, v57
  v_accvgpr_write_b32 a138, v58
  v_lshlrev_b32 v20, 16, v58
  v_and_b32 v21, 0xffff0000, v58
  v_accvgpr_write_b32 a139, v59
  v_lshlrev_b32 v22, 16, v59
  v_and_b32 v23, 0xffff0000, v59
  v_accvgpr_write_b32 a140, v60
  v_lshlrev_b32 v24, 16, v60
  v_and_b32 v25, 0xffff0000, v60
  v_accvgpr_write_b32 a141, v61
  v_lshlrev_b32 v26, 16, v61
  v_and_b32 v27, 0xffff0000, v61
  v_accvgpr_write_b32 a142, v62
  v_lshlrev_b32 v28, 16, v62
  v_and_b32 v29, 0xffff0000, v62
  v_accvgpr_write_b32 a143, v63
  v_lshlrev_b32 v30, 16, v63
  v_and_b32 v31, 0xffff0000, v63
  s_add_u32 s48, s20, 0xa00000
  s_addc_u32 s49, s21, 0
  s_mov_b32 s50, 0x400000
  s_mov_b32 s51, 0x20000
  s_mov_b32 s59, 262144
L_poll_17:
  buffer_load_dwordx4 v[88:91], v80, s[52:55], s56 offen offset:0 sc1
  buffer_load_dwordx4 v[92:95], v80, s[52:55], s56 offen offset:1024 sc1
  buffer_load_dwordx4 v[96:99], v80, s[52:55], s56 offen offset:2048 sc1
  buffer_load_dwordx4 v[100:103], v80, s[52:55], s56 offen offset:3072 sc1
  s_waitcnt vmcnt(3)
  v_xor_b32 v88, s44, v88
  v_xor_b32 v89, s45, v89
  v_xor_b32 v90, s46, v90
  v_xor_b32 v91, s47, v91
  v_or3_b32 v160, v88, v89, v90
  v_or_b32 v160, v160, v91
  s_waitcnt vmcnt(2)
  v_xor_b32 v92, s44, v92
  v_xor_b32 v93, s45, v93
  v_xor_b32 v94, s46, v94
  v_xor_b32 v95, s47, v95
  v_or3_b32 v160, v160, v92, v93
  v_or3_b32 v160, v160, v94, v95
  s_waitcnt vmcnt(1)
  v_xor_b32 v96, s44, v96
  v_xor_b32 v97, s45, v97
  v_xor_b32 v98, s46, v98
  v_xor_b32 v99, s47, v99
  v_or3_b32 v160, v160, v96, v97
  v_or3_b32 v160, v160, v98, v99
  s_waitcnt vmcnt(0)
  v_xor_b32 v100, s44, v100
  v_xor_b32 v101, s45, v101
  v_xor_b32 v102, s46, v102
  v_xor_b32 v103, s47, v103
  v_or3_b32 v160, v160, v100, v101
  v_or3_b32 v160, v160, v102, v103
  v_and_b32 v160, 0xff, v160
  v_cmp_ne_u32 vcc, 0, v160
  s_nop 1
  s_cmp_eq_u64 vcc, 0
  s_cbranch_scc1 L_ready_18
  s_sub_u32 s59, s59, 1
  s_cmp_lg_u32 s59, 0
  s_cbranch_scc1 L_poll_17
L_ready_18:
  v_mul_f32 v104, 0x3c800000, v88
  v_mul_f32 v105, 0x3c800000, v90
  v_mul_f32 v106, 0x3c800000, v92
  v_mul_f32 v107, 0x3c800000, v94
  v_mul_f32 v108, 0x3c800000, v96
  v_mul_f32 v109, 0x3c800000, v98
  v_mul_f32 v110, 0x3c800000, v100
  v_mul_f32 v111, 0x3c800000, v102
  v_fmac_f32 v89, v104, v88
  v_fmac_f32 v91, v105, v90
  v_fmac_f32 v93, v106, v92
  v_fmac_f32 v95, v107, v94
  v_fmac_f32 v97, v108, v96
  v_fmac_f32 v99, v109, v98
  v_fmac_f32 v101, v110, v100
  v_fmac_f32 v103, v111, v102
  v_pk_add_f32 v[152:153], v[88:89], v[92:93]
  v_pk_add_f32 v[160:161], v[96:97], v[100:101]
  v_pk_add_f32 v[154:155], v[90:91], v[94:95]
  v_pk_add_f32 v[162:163], v[98:99], v[102:103]
  v_pk_add_f32 v[152:153], v[152:153], v[160:161]
  v_pk_add_f32 v[154:155], v[154:155], v[162:163]
  v_mov_b32 v160, v152
  v_mov_b32 v161, v153
  v_mov_b32 v162, v154
  v_mov_b32 v163, v155
  s_nop 1
  v_permlane16_swap_b32 v160, v152
  v_permlane16_swap_b32 v161, v153
  v_permlane16_swap_b32 v162, v154
  v_permlane16_swap_b32 v163, v155
  s_nop 1
  v_add_f32 v152, v152, v160
  v_add_f32 v153, v153, v161
  v_add_f32 v154, v154, v162
  v_add_f32 v155, v155, v163
  v_mov_b32 v160, v152
  v_mov_b32 v161, v153
  v_mov_b32 v162, v154
  v_mov_b32 v163, v155
  s_nop 1
  v_permlane32_swap_b32 v160, v152
  v_permlane32_swap_b32 v161, v153
  v_permlane32_swap_b32 v162, v154
  v_permlane32_swap_b32 v163, v155
  s_nop 1
  v_add_f32 v152, v152, v160
  v_add_f32 v153, v153, v161
  v_add_f32 v154, v154, v162
  v_add_f32 v155, v155, v163
  v_mul_f32 v120, 0x3a800000, v152
  v_mul_f32 v124, 0x3a800000, v153
  v_mul_f32 v132, 0x3a800000, v154
  v_mul_f32 v136, 0x3a800000, v155
  v_fma_f32 v124, -v120, v120, v124
  v_fma_f32 v136, -v132, v132, v136
  v_max_f32 v124, 0, v124
  v_max_f32 v136, 0, v136
  v_cvt_pk_bf16_f32 v128, v120, v124
  v_lshlrev_b32 v120, 16, v128
  v_and_b32 v124, 0xffff0000, v128
  v_add_f32 v124, 0x3727c5ac, v124
  v_cvt_pk_bf16_f32 v128, v124, v125
  v_lshlrev_b32 v124, 16, v128
  v_and_b32 v125, 0xffff0000, v128
  v_sqrt_f32 v124, v124
  s_nop 0
  v_cvt_pk_bf16_f32 v128, v124, v125
  v_lshlrev_b32 v124, 16, v128
  v_and_b32 v125, 0xffff0000, v128
  v_rcp_f32 v124, v124
  v_mov_b32 v121, v120
  s_nop 0
  v_mov_b32 v125, v124
  v_cvt_pk_bf16_f32 v140, v132, v136
  v_lshlrev_b32 v132, 16, v140
  v_and_b32 v136, 0xffff0000, v140
  v_add_f32 v136, 0x3727c5ac, v136
  v_cvt_pk_bf16_f32 v140, v136, v137
  v_lshlrev_b32 v136, 16, v140
  v_and_b32 v137, 0xffff0000, v140
  v_sqrt_f32 v136, v136
  s_nop 0
  v_cvt_pk_bf16_f32 v140, v136, v137
  v_lshlrev_b32 v136, 16, v140
  v_and_b32 v137, 0xffff0000, v140
  v_rcp_f32 v136, v136
  v_mov_b32 v133, v132
  s_nop 0
  v_mov_b32 v137, v136
  v_pk_add_f32 v[0:1], v[0:1], v[120:121] neg_lo:[0,1] neg_hi:[0,1]
  v_pk_add_f32 v[2:3], v[2:3], v[120:121] neg_lo:[0,1] neg_hi:[0,1]
  v_pk_add_f32 v[4:5], v[4:5], v[120:121] neg_lo:[0,1] neg_hi:[0,1]
  v_pk_add_f32 v[6:7], v[6:7], v[120:121] neg_lo:[0,1] neg_hi:[0,1]
  v_pk_add_f32 v[8:9], v[8:9], v[120:121] neg_lo:[0,1] neg_hi:[0,1]
  v_pk_add_f32 v[10:11], v[10:11], v[120:121] neg_lo:[0,1] neg_hi:[0,1]
  v_pk_add_f32 v[12:13], v[12:13], v[120:121] neg_lo:[0,1] neg_hi:[0,1]
  v_pk_add_f32 v[14:15], v[14:15], v[120:121] neg_lo:[0,1] neg_hi:[0,1]
  v_pk_mul_f32 v[0:1], v[0:1], v[124:125]
  v_pk_mul_f32 v[2:3], v[2:3], v[124:125]
  v_pk_mul_f32 v[4:5], v[4:5], v[124:125]
  v_pk_mul_f32 v[6:7], v[6:7], v[124:125]
  v_pk_mul_f32 v[8:9], v[8:9], v[124:125]
  v_pk_mul_f32 v[10:11], v[10:11], v[124:125]
  v_pk_mul_f32 v[12:13], v[12:13], v[124:125]
  v_pk_mul_f32 v[14:15], v[14:15], v[124:125]
  v_pk_fma_f32 v[0:1], v[0:1], v[184:185], v[168:169]
  v_pk_fma_f32 v[2:3], v[2:3], v[186:187], v[170:171]
  v_pk_fma_f32 v[4:5], v[4:5], v[188:189], v[172:173]
  v_pk_fma_f32 v[6:7], v[6:7], v[190:191], v[174:175]
  v_pk_fma_f32 v[8:9], v[8:9], v[192:193], v[176:177]
  v_pk_fma_f32 v[10:11], v[10:11], v[194:195], v[178:179]
  v_pk_fma_f32 v[12:13], v[12:13], v[196:197], v[180:181]
  v_pk_fma_f32 v[14:15], v[14:15], v[198:199], v[182:183]
  v_cvt_pk_bf16_f32 v88, v0, v1
  v_cvt_pk_bf16_f32 v89, v2, v3
  v_cvt_pk_bf16_f32 v90, v4, v5
  v_cvt_pk_bf16_f32 v91, v6, v7
  v_cvt_pk_bf16_f32 v92, v8, v9
  v_cvt_pk_bf16_f32 v93, v10, v11
  v_cvt_pk_bf16_f32 v94, v12, v13
  v_cvt_pk_bf16_f32 v95, v14, v15
  buffer_store_dwordx4 v[88:91], v33, s[48:51], s41 offen offset:0 sc1
  buffer_store_dwordx4 v[92:95], v33, s[48:51], s42 offen offset:0 sc1
  v_pk_add_f32 v[16:17], v[16:17], v[132:133] neg_lo:[0,1] neg_hi:[0,1]
  v_pk_add_f32 v[18:19], v[18:19], v[132:133] neg_lo:[0,1] neg_hi:[0,1]
  v_pk_add_f32 v[20:21], v[20:21], v[132:133] neg_lo:[0,1] neg_hi:[0,1]
  v_pk_add_f32 v[22:23], v[22:23], v[132:133] neg_lo:[0,1] neg_hi:[0,1]
  v_pk_add_f32 v[24:25], v[24:25], v[132:133] neg_lo:[0,1] neg_hi:[0,1]
  v_pk_add_f32 v[26:27], v[26:27], v[132:133] neg_lo:[0,1] neg_hi:[0,1]
  v_pk_add_f32 v[28:29], v[28:29], v[132:133] neg_lo:[0,1] neg_hi:[0,1]
  v_pk_add_f32 v[30:31], v[30:31], v[132:133] neg_lo:[0,1] neg_hi:[0,1]
  v_pk_mul_f32 v[16:17], v[16:17], v[136:137]
  v_pk_mul_f32 v[18:19], v[18:19], v[136:137]
  v_pk_mul_f32 v[20:21], v[20:21], v[136:137]
  v_pk_mul_f32 v[22:23], v[22:23], v[136:137]
  v_pk_mul_f32 v[24:25], v[24:25], v[136:137]
  v_pk_mul_f32 v[26:27], v[26:27], v[136:137]
  v_pk_mul_f32 v[28:29], v[28:29], v[136:137]
  v_pk_mul_f32 v[30:31], v[30:31], v[136:137]
  v_pk_fma_f32 v[16:17], v[16:17], v[184:185], v[168:169]
  v_pk_fma_f32 v[18:19], v[18:19], v[186:187], v[170:171]
  v_pk_fma_f32 v[20:21], v[20:21], v[188:189], v[172:173]
  v_pk_fma_f32 v[22:23], v[22:23], v[190:191], v[174:175]
  v_pk_fma_f32 v[24:25], v[24:25], v[192:193], v[176:177]
  v_pk_fma_f32 v[26:27], v[26:27], v[194:195], v[178:179]
  v_pk_fma_f32 v[28:29], v[28:29], v[196:197], v[180:181]
  v_pk_fma_f32 v[30:31], v[30:31], v[198:199], v[182:183]
  v_cvt_pk_bf16_f32 v96, v16, v17
  v_cvt_pk_bf16_f32 v97, v18, v19
  v_cvt_pk_bf16_f32 v98, v20, v21
  v_cvt_pk_bf16_f32 v99, v22, v23
  v_cvt_pk_bf16_f32 v100, v24, v25
  v_cvt_pk_bf16_f32 v101, v26, v27
  v_cvt_pk_bf16_f32 v102, v28, v29
  v_cvt_pk_bf16_f32 v103, v30, v31
  buffer_store_dwordx4 v[96:99], v33, s[48:51], s41 offen offset:1024 sc1
  buffer_store_dwordx4 v[100:103], v33, s[48:51], s42 offen offset:1024 sc1
  s_add_u32 s64, s20, 0xb0000
  s_addc_u32 s65, s21, 0
  s_mov_b32 s66, 0x10000
  s_mov_b32 s67, 0x20000
  s_lshl_b32 s32, s30, 2
  s_add_u32 s32, s32, s3
  s_lshl_b32 s32, s32, 4
  s_add_u32 s32, s32, s31
  s_lshl_b32 s32, s32, 6
  s_mov_b32 s30, s94
  s_mov_b32 s31, s95
  s_lshl_b32 s33, s30, 2
  s_add_u32 s33, s33, s3
  s_lshl_b32 s68, s33, 11
  v_lshlrev_b32 v250, 2, v231
  v_mov_b32 v248, s19
  v_and_b32 v246, 31, v231
  v_and_b32 v245, 17, v246
  v_lshlrev_b32 v245, 6, v245
  v_lshlrev_b32 v246, 6, v246
  s_mov_b64 s[24:25], s[60:61]
  s_mov_b64 s[26:27], s[62:63]
  s_add_u32 s4, s20, 0xa00000
  s_addc_u32 s5, s21, 0
  s_mov_b32 s6, 0x400000
  s_mov_b32 s7, 0x20000
  s_mov_b32 s16, 0
  s_waitcnt vmcnt(0)
  s_mov_b64 exec, 1
  buffer_store_dword v248, v250, s[64:67], s32 offen sc1
  s_mov_b64 exec, -1
  s_mov_b32 s34, 262144
L_spin_19:
  buffer_load_dword v247, v245, s[64:67], s68 offen sc1
  s_waitcnt vmcnt(0)
  v_cmp_ne_u32 vcc, s19, v247
  s_nop 1
  s_cmp_eq_u64 vcc, 0
  s_cbranch_scc1 L_rdy_20
  s_sub_u32 s34, s34, 1
  s_cmp_lg_u32 s34, 0
  s_cbranch_scc1 L_spin_19
L_rdy_20:
  buffer_load_dwordx4 a[0:3], v224, s[4:7], s16 offen offset:0 sc1
  buffer_load_dwordx4 a[4:7], v224, s[4:7], s16 offen offset:1024 sc1
  buffer_load_dwordx4 a[8:11], v224, s[4:7], s16 offen offset:2048 sc1
  buffer_load_dwordx4 a[12:15], v224, s[4:7], s16 offen offset:3072 sc1
  s_add_u32 s16, s16, 131072
  buffer_load_dwordx4 a[16:19], v224, s[4:7], s16 offen offset:0 sc1
  buffer_load_dwordx4 a[20:23], v224, s[4:7], s16 offen offset:1024 sc1
  buffer_load_dwordx4 a[24:27], v224, s[4:7], s16 offen offset:2048 sc1
  buffer_load_dwordx4 a[28:31], v224, s[4:7], s16 offen offset:3072 sc1
  s_add_u32 s16, s16, 131072
  s_bitcmp1_b32 s3, 0
  s_cselect_b32 s52, s26, s24
  s_cselect_b32 s53, s27, s25
  s_cselect_b32 s60, 3670016, 0
  s_mov_b32 s54, 7340032
  s_mov_b32 s55, 0x20000
  s_lshl_b32 s56, s2, 1
  s_lshr_b32 s59, s3, 1
  s_add_u32 s56, s56, s59
  s_lshl_b32 s56, s56, 10
  s_add_u32 s60, s60, s56
  s_add_u32 s56, s56, 1572864
  s_mov_b32 s59, 0
  v_lshrrev_b32 v249, 3, v231
  v_lshlrev_b32 v249, 7, v249
  v_and_b32 v251, 1, v231
  v_lshl_add_u32 v249, v251, 19, v249
  s_add_u32 s12, s20, 0x1600000
  s_addc_u32 s13, s21, 0
  s_mov_b32 s14, 0xe00000
  s_mov_b32 s15, 0x20000
  v_lshrrev_b32 v234, 2, v231
  v_mul_u32_u24 v234, 224, v234
  v_and_b32 v235, 3, v231
  v_lshl_add_u32 v229, v235, 3, v234
  v_add_u32 v229, 98304, v229
  v_add_u32 v230, 57344, v229
  s_waitcnt vmcnt(16)
  s_barrier
  ds_read_b64_tr_b16 a[64:65], v229 offset:0
  ds_read_b64_tr_b16 a[66:67], v229 offset:3584
  ds_read_b64_tr_b16 a[68:69], v229 offset:32
  ds_read_b64_tr_b16 a[70:71], v229 offset:3616
  ds_read_b64_tr_b16 a[72:73], v229 offset:64
  ds_read_b64_tr_b16 a[74:75], v229 offset:3648
  ds_read_b64_tr_b16 a[76:77], v229 offset:96
  ds_read_b64_tr_b16 a[78:79], v229 offset:3680
  ds_read_b64_tr_b16 a[80:81], v229 offset:128
  ds_read_b64_tr_b16 a[82:83], v229 offset:3712
  ds_read_b64_tr_b16 a[84:85], v229 offset:160
  ds_read_b64_tr_b16 a[86:87], v229 offset:3744
  ds_read_b64_tr_b16 a[88:89], v229 offset:192
  ds_read_b64_tr_b16 a[90:91], v229 offset:3776
  ds_read_b64_tr_b16 a[92:93], v229 offset:7168
  ds_read_b64_tr_b16 a[94:95], v229 offset:10752
  ds_read_b64_tr_b16 a[96:97], v229 offset:7200
  ds_read_b64_tr_b16 a[98:99], v229 offset:10784
  ds_read_b64_tr_b16 a[100:101], v229 offset:7232
  ds_read_b64_tr_b16 a[102:103], v229 offset:10816
  ds_read_b64_tr_b16 a[104:105], v229 offset:7264
  ds_read_b64_tr_b16 a[106:107], v229 offset:10848
  ds_read_b64_tr_b16 a[108:109], v229 offset:7296
  ds_read_b64_tr_b16 a[110:111], v229 offset:10880
  ds_read_b64_tr_b16 a[112:113], v229 offset:7328
  ds_read_b64_tr_b16 a[114:115], v229 offset:10912
  ds_read_b64_tr_b16 a[116:117], v229 offset:7360
  ds_read_b64_tr_b16 a[118:119], v229 offset:10944
  s_waitcnt vmcnt(4) lgkmcnt(10)
  s_barrier
  buffer_load_dword v247, v246, s[64:67], s68 offen sc1
  v_mfma_f32_16x16x32_bf16 v[0:3], a[64:67], a[0:3], 0
  buffer_load_dwordx4 a[32:35], v224, s[4:7], s16 offen offset:0 sc1
  v_mfma_f32_16x16x32_bf16 v[56:59], a[64:67], a[4:7], 0
  v_mfma_f32_16x16x32_bf16 v[112:115], a[64:67], a[8:11], 0
  buffer_load_dwordx4 a[36:39], v224, s[4:7], s16 offen offset:1024 sc1
  v_mfma_f32_16x16x32_bf16 v[168:171], a[64:67], a[12:15], 0
  ds_read_b64_tr_b16 a[64:65], v229 offset:14336
  ds_read_b64_tr_b16 a[66:67], v229 offset:17920
  v_mfma_f32_16x16x32_bf16 v[4:7], a[68:71], a[0:3], 0
  buffer_load_dwordx4 a[40:43], v224, s[4:7], s16 offen offset:2048 sc1
  v_mfma_f32_16x16x32_bf16 v[60:63], a[68:71], a[4:7], 0
  v_mfma_f32_16x16x32_bf16 v[116:119], a[68:71], a[8:11], 0
  v_mfma_f32_16x16x32_bf16 v[172:175], a[68:71], a[12:15], 0
  buffer_load_dwordx4 a[44:47], v224, s[4:7], s16 offen offset:3072 sc1
  v_mfma_f32_16x16x32_bf16 v[8:11], a[72:75], a[0:3], 0
  ds_read_b64_tr_b16 a[68:69], v229 offset:14368
  ds_read_b64_tr_b16 a[70:71], v229 offset:17952
  v_mfma_f32_16x16x32_bf16 v[64:67], a[72:75], a[4:7], 0
  s_add_u32 s16, s16, 131072
  v_mfma_f32_16x16x32_bf16 v[120:123], a[72:75], a[8:11], 0
  v_mfma_f32_16x16x32_bf16 v[176:179], a[72:75], a[12:15], 0
  ds_read_b64_tr_b16 a[72:73], v229 offset:14400
  s_add_u32 m0, s38, 43008
  v_mfma_f32_16x16x32_bf16 v[12:15], a[76:79], a[0:3], 0
  ds_read_b64_tr_b16 a[74:75], v229 offset:17984
  v_mfma_f32_16x16x32_bf16 v[68:71], a[76:79], a[4:7], 0
  v_mfma_f32_16x16x32_bf16 v[124:127], a[76:79], a[8:11], 0
  buffer_load_dwordx4 v225, s[8:11], s17 offen lds
  v_mfma_f32_16x16x32_bf16 v[180:183], a[76:79], a[12:15], 0
  ds_read_b64_tr_b16 a[76:77], v229 offset:14432
  ds_read_b64_tr_b16 a[78:79], v229 offset:18016
  v_mfma_f32_16x16x32_bf16 v[16:19], a[80:83], a[0:3], 0
  buffer_load_dwordx4 v226, s[8:11], s17 offen offset:1024 lds
  v_mfma_f32_16x16x32_bf16 v[72:75], a[80:83], a[4:7], 0
  v_mfma_f32_16x16x32_bf16 v[128:131], a[80:83], a[8:11], 0
  v_mfma_f32_16x16x32_bf16 v[184:187], a[80:83], a[12:15], 0
  buffer_load_dwordx4 v227, s[8:11], s17 offen offset:2048 lds
  v_mfma_f32_16x16x32_bf16 v[20:23], a[84:87], a[0:3], 0
  ds_read_b64_tr_b16 a[80:81], v229 offset:14464
  ds_read_b64_tr_b16 a[82:83], v229 offset:18048
  v_mfma_f32_16x16x32_bf16 v[76:79], a[84:87], a[4:7], 0
  s_mov_b32 exec_hi, 0
  buffer_load_dwordx4 v228, s[8:11], s17 offen offset:3072 lds
  s_mov_b32 exec_hi, -1
  v_mfma_f32_16x16x32_bf16 v[132:135], a[84:87], a[8:11], 0
  v_mfma_f32_16x16x32_bf16 v[188:191], a[84:87], a[12:15], 0
  ds_read_b64_tr_b16 a[84:85], v229 offset:14496
  s_add_u32 s17, s17, 229376
  v_mfma_f32_16x16x32_bf16 v[24:27], a[88:91], a[0:3], 0
  ds_read_b64_tr_b16 a[86:87], v229 offset:18080
  v_mfma_f32_16x16x32_bf16 v[80:83], a[88:91], a[4:7], 0
  v_mfma_f32_16x16x32_bf16 v[136:139], a[88:91], a[8:11], 0
  buffer_load_dwordx4 a[48:51], v224, s[4:7], s16 offen offset:0 sc1
  v_mfma_f32_16x16x32_bf16 v[192:195], a[88:91], a[12:15], 0
  ds_read_b64_tr_b16 a[88:89], v229 offset:14528
  ds_read_b64_tr_b16 a[90:91], v229 offset:18112
  v_mfma_f32_16x16x32_bf16 v[28:31], a[92:95], a[0:3], 0
  buffer_load_dwordx4 a[52:55], v224, s[4:7], s16 offen offset:1024 sc1
  v_mfma_f32_16x16x32_bf16 v[84:87], a[92:95], a[4:7], 0
  v_mfma_f32_16x16x32_bf16 v[140:143], a[92:95], a[8:11], 0
  v_mfma_f32_16x16x32_bf16 v[196:199], a[92:95], a[12:15], 0
  buffer_load_dwordx4 a[56:59], v224, s[4:7], s16 offen offset:2048 sc1
  v_mfma_f32_16x16x32_bf16 v[32:35], a[96:99], a[0:3], 0
  ds_read_b64_tr_b16 a[92:93], v229 offset:21504
  ds_read_b64_tr_b16 a[94:95], v229 offset:25088
  v_mfma_f32_16x16x32_bf16 v[88:91], a[96:99], a[4:7], 0
  buffer_load_dwordx4 a[60:63], v224, s[4:7], s16 offen offset:3072 sc1
  v_mfma_f32_16x16x32_bf16 v[144:147], a[96:99], a[8:11], 0
  v_mfma_f32_16x16x32_bf16 v[200:203], a[96:99], a[12:15], 0
  ds_read_b64_tr_b16 a[96:97], v229 offset:21536
  s_add_u32 s16, s16, 131072
  s_waitcnt lgkmcnt(10)
  v_mfma_f32_16x16x32_bf16 v[36:39], a[100:103], a[0:3], 0
  ds_read_b64_tr_b16 a[98:99], v229 offset:25120
  v_mfma_f32_16x16x32_bf16 v[92:95], a[100:103], a[4:7], 0
  v_mfma_f32_16x16x32_bf16 v[148:151], a[100:103], a[8:11], 0
  buffer_load_dword v251, v249, s[52:55], s56 offen
  v_mfma_f32_16x16x32_bf16 v[204:207], a[100:103], a[12:15], 0
  ds_read_b64_tr_b16 a[100:101], v229 offset:21568
  ds_read_b64_tr_b16 a[102:103], v229 offset:25152
  v_mfma_f32_16x16x32_bf16 v[40:43], a[104:107], a[0:3], 0
  s_add_u32 s56, s56, 1048576
  v_mfma_f32_16x16x32_bf16 v[96:99], a[104:107], a[4:7], 0
  v_mfma_f32_16x16x32_bf16 v[152:155], a[104:107], a[8:11], 0
  v_mfma_f32_16x16x32_bf16 v[208:211], a[104:107], a[12:15], 0
  ds_read_b64_tr_b16 a[104:105], v229 offset:21600
  s_add_u32 s59, s59, 1
  v_mfma_f32_16x16x32_bf16 v[44:47], a[108:111], a[0:3], 0
  ds_read_b64_tr_b16 a[106:107], v229 offset:25184
  v_mfma_f32_16x16x32_bf16 v[100:103], a[108:111], a[4:7], 0
  s_cmp_eq_u32 s59, 6
  v_mfma_f32_16x16x32_bf16 v[156:159], a[108:111], a[8:11], 0
  v_mfma_f32_16x16x32_bf16 v[212:215], a[108:111], a[12:15], 0
  ds_read_b64_tr_b16 a[108:109], v229 offset:21632
  s_cselect_b32 s52, s22, s52
  v_mfma_f32_16x16x32_bf16 v[48:51], a[112:115], a[0:3], 0
  ds_read_b64_tr_b16 a[110:111], v229 offset:25216
  v_mfma_f32_16x16x32_bf16 v[104:107], a[112:115], a[4:7], 0
  v_mfma_f32_16x16x32_bf16 v[160:163], a[112:115], a[8:11], 0
  s_cselect_b32 s53, s23, s53
  v_mfma_f32_16x16x32_bf16 v[216:219], a[112:115], a[12:15], 0
  ds_read_b64_tr_b16 a[112:113], v229 offset:21664
  ds_read_b64_tr_b16 a[114:115], v229 offset:25248
  v_mfma_f32_16x16x32_bf16 v[52:55], a[116:119], a[0:3], 0
  s_cselect_b32 s56, s60, s56
  v_mfma_f32_16x16x32_bf16 v[108:111], a[116:119], a[4:7], 0
  v_mfma_f32_16x16x32_bf16 v[164:167], a[116:119], a[8:11], 0
  v_mfma_f32_16x16x32_bf16 v[220:223], a[116:119], a[12:15], 0
  s_waitcnt vmcnt(13) lgkmcnt(10)
  s_barrier
  v_cmp_ne_u32 vcc, s19, v247
  s_nop 1
  s_cmp_lg_u64 vcc, 0
  s_cbranch_scc1 L_slow_21
  L_back_22:
  v_mfma_f32_16x16x32_bf16 v[0:3], a[64:67], a[16:19], v[0:3]
  ds_read_b64_tr_b16 a[116:117], v229 offset:21696
  s_add_u32 m0, s38, 0
  v_mfma_f32_16x16x32_bf16 v[56:59], a[64:67], a[20:23], v[56:59]
  ds_read_b64_tr_b16 a[118:119], v229 offset:25280
  v_mfma_f32_16x16x32_bf16 v[112:115], a[64:67], a[24:27], v[112:115]
  v_mfma_f32_16x16x32_bf16 v[168:171], a[64:67], a[28:31], v[168:171]
  ds_read_b64_tr_b16 a[64:65], v229 offset:28672
  ds_read_b64_tr_b16 a[66:67], v229 offset:32256
  v_mfma_f32_16x16x32_bf16 v[4:7], a[68:71], a[16:19], v[4:7]
  v_mfma_f32_16x16x32_bf16 v[60:63], a[68:71], a[20:23], v[60:63]
  buffer_load_dwordx4 v225, s[8:11], s17 offen lds
  v_mfma_f32_16x16x32_bf16 v[116:119], a[68:71], a[24:27], v[116:119]
  v_mfma_f32_16x16x32_bf16 v[172:175], a[68:71], a[28:31], v[172:175]
  ds_read_b64_tr_b16 a[68:69], v229 offset:28704
  ds_read_b64_tr_b16 a[70:71], v229 offset:32288
  v_mfma_f32_16x16x32_bf16 v[8:11], a[72:75], a[16:19], v[8:11]
  v_mfma_f32_16x16x32_bf16 v[64:67], a[72:75], a[20:23], v[64:67]
  v_mfma_f32_16x16x32_bf16 v[120:123], a[72:75], a[24:27], v[120:123]
  buffer_load_dwordx4 v226, s[8:11], s17 offen offset:1024 lds
  v_mfma_f32_16x16x32_bf16 v[176:179], a[72:75], a[28:31], v[176:179]
  ds_read_b64_tr_b16 a[72:73], v229 offset:28736
  ds_read_b64_tr_b16 a[74:75], v229 offset:32320
  v_mfma_f32_16x16x32_bf16 v[12:15], a[76:79], a[16:19], v[12:15]
  v_mfma_f32_16x16x32_bf16 v[68:71], a[76:79], a[20:23], v[68:71]
  v_mfma_f32_16x16x32_bf16 v[124:127], a[76:79], a[24:27], v[124:127]
  v_mfma_f32_16x16x32_bf16 v[180:183], a[76:79], a[28:31], v[180:183]
  buffer_load_dwordx4 v227, s[8:11], s17 offen offset:2048 lds
  v_mfma_f32_16x16x32_bf16 v[16:19], a[80:83], a[16:19], v[16:19]
  ds_read_b64_tr_b16 a[76:77], v229 offset:28768
  ds_read_b64_tr_b16 a[78:79], v229 offset:32352
  v_mfma_f32_16x16x32_bf16 v[72:75], a[80:83], a[20:23], v[72:75]
  v_mfma_f32_16x16x32_bf16 v[128:131], a[80:83], a[24:27], v[128:131]
  v_mfma_f32_16x16x32_bf16 v[184:187], a[80:83], a[28:31], v[184:187]
  ds_read_b64_tr_b16 a[80:81], v229 offset:28800
  ds_read_b64_tr_b16 a[82:83], v229 offset:32384
  v_mfma_f32_16x16x32_bf16 v[20:23], a[84:87], a[16:19], v[20:23]
  s_mov_b32 exec_hi, 0
  buffer_load_dwordx4 v228, s[8:11], s17 offen offset:3072 lds
  s_mov_b32 exec_hi, -1
  v_mfma_f32_16x16x32_bf16 v[76:79], a[84:87], a[20:23], v[76:79]
  v_mfma_f32_16x16x32_bf16 v[132:135], a[84:87], a[24:27], v[132:135]
  v_mfma_f32_16x16x32_bf16 v[188:191], a[84:87], a[28:31], v[188:191]
  ds_read_b64_tr_b16 a[84:85], v229 offset:28832
  ds_read_b64_tr_b16 a[86:87], v229 offset:32416
  v_mfma_f32_16x16x32_bf16 v[24:27], a[88:91], a[16:19], v[24:27]
  v_mfma_f32_16x16x32_bf16 v[80:83], a[88:91], a[20:23], v[80:83]
  s_add_u32 s17, s17, 229376
  v_mfma_f32_16x16x32_bf16 v[136:139], a[88:91], a[24:27], v[136:139]
  v_mfma_f32_16x16x32_bf16 v[192:195], a[88:91], a[28:31], v[192:195]
  ds_read_b64_tr_b16 a[88:89], v229 offset:28864
  ds_read_b64_tr_b16 a[90:91], v229 offset:32448
  v_mfma_f32_16x16x32_bf16 v[28:31], a[92:95], a[16:19], v[28:31]
  v_mfma_f32_16x16x32_bf16 v[84:87], a[92:95], a[20:23], v[84:87]
  v_mfma_f32_16x16x32_bf16 v[140:143], a[92:95], a[24:27], v[140:143]
  buffer_load_dwordx4 a[0:3], v224, s[4:7], s16 offen offset:0 sc1
  v_mfma_f32_16x16x32_bf16 v[196:199], a[92:95], a[28:31], v[196:199]
  ds_read_b64_tr_b16 a[92:93], v229 offset:35840
  ds_read_b64_tr_b16 a[94:95], v229 offset:39424
  s_waitcnt lgkmcnt(10)
  v_mfma_f32_16x16x32_bf16 v[32:35], a[96:99], a[16:19], v[32:35]
  v_mfma_f32_16x16x32_bf16 v[88:91], a[96:99], a[20:23], v[88:91]
  v_mfma_f32_16x16x32_bf16 v[144:147], a[96:99], a[24:27], v[144:147]
  v_mfma_f32_16x16x32_bf16 v[200:203], a[96:99], a[28:31], v[200:203]
  buffer_load_dwordx4 a[4:7], v224, s[4:7], s16 offen offset:1024 sc1
  v_mfma_f32_16x16x32_bf16 v[36:39], a[100:103], a[16:19], v[36:39]
  ds_read_b64_tr_b16 a[96:97], v229 offset:35872
  ds_read_b64_tr_b16 a[98:99], v229 offset:39456
  v_mfma_f32_16x16x32_bf16 v[92:95], a[100:103], a[20:23], v[92:95]
  v_mfma_f32_16x16x32_bf16 v[148:151], a[100:103], a[24:27], v[148:151]
  v_mfma_f32_16x16x32_bf16 v[204:207], a[100:103], a[28:31], v[204:207]
  ds_read_b64_tr_b16 a[100:101], v229 offset:35904
  ds_read_b64_tr_b16 a[102:103], v229 offset:39488
  v_mfma_f32_16x16x32_bf16 v[40:43], a[104:107], a[16:19], v[40:43]
  buffer_load_dwordx4 a[8:11], v224, s[4:7], s16 offen offset:2048 sc1
  v_mfma_f32_16x16x32_bf16 v[96:99], a[104:107], a[20:23], v[96:99]
  v_mfma_f32_16x16x32_bf16 v[152:155], a[104:107], a[24:27], v[152:155]
  v_mfma_f32_16x16x32_bf16 v[208:211], a[104:107], a[28:31], v[208:211]
  ds_read_b64_tr_b16 a[104:105], v229 offset:35936
  ds_read_b64_tr_b16 a[106:107], v229 offset:39520
  v_mfma_f32_16x16x32_bf16 v[44:47], a[108:111], a[16:19], v[44:47]
  v_mfma_f32_16x16x32_bf16 v[100:103], a[108:111], a[20:23], v[100:103]
  buffer_load_dwordx4 a[12:15], v224, s[4:7], s16 offen offset:3072 sc1
  v_mfma_f32_16x16x32_bf16 v[156:159], a[108:111], a[24:27], v[156:159]
  v_mfma_f32_16x16x32_bf16 v[212:215], a[108:111], a[28:31], v[212:215]
  ds_read_b64_tr_b16 a[108:109], v229 offset:35968
  ds_read_b64_tr_b16 a[110:111], v229 offset:39552
  v_mfma_f32_16x16x32_bf16 v[48:51], a[112:115], a[16:19], v[48:51]
  v_mfma_f32_16x16x32_bf16 v[104:107], a[112:115], a[20:23], v[104:107]
  v_mfma_f32_16x16x32_bf16 v[160:163], a[112:115], a[24:27], v[160:163]
  s_add_u32 s16, s16, 131072
  v_mfma_f32_16x16x32_bf16 v[216:219], a[112:115], a[28:31], v[216:219]
  ds_read_b64_tr_b16 a[112:113], v229 offset:36000
  ds_read_b64_tr_b16 a[114:115], v229 offset:39584
  v_mfma_f32_16x16x32_bf16 v[52:55], a[116:119], a[16:19], v[52:55]
  v_mfma_f32_16x16x32_bf16 v[108:111], a[116:119], a[20:23], v[108:111]
  v_mfma_f32_16x16x32_bf16 v[164:167], a[116:119], a[24:27], v[164:167]
  v_mfma_f32_16x16x32_bf16 v[220:223], a[116:119], a[28:31], v[220:223]
  s_mov_b32 s18, 5
  .p2align 6
L_loop_24:
  s_waitcnt vmcnt(13) lgkmcnt(10)
  s_barrier
  v_mfma_f32_16x16x32_bf16 v[0:3], a[64:67], a[32:35], v[0:3]
  ds_read_b64_tr_b16 a[116:117], v229 offset:36032
  s_add_u32 m0, s38, 14336
  v_mfma_f32_16x16x32_bf16 v[56:59], a[64:67], a[36:39], v[56:59]
  ds_read_b64_tr_b16 a[118:119], v229 offset:39616
  v_mfma_f32_16x16x32_bf16 v[112:115], a[64:67], a[40:43], v[112:115]
  v_mfma_f32_16x16x32_bf16 v[168:171], a[64:67], a[44:47], v[168:171]
  buffer_load_dwordx4 v225, s[8:11], s17 offen lds
  v_mfma_f32_16x16x32_bf16 v[4:7], a[68:71], a[32:35], v[4:7]
  ds_read_b64_tr_b16 a[64:65], v229 offset:43008
  ds_read_b64_tr_b16 a[66:67], v229 offset:46592
  v_mfma_f32_16x16x32_bf16 v[60:63], a[68:71], a[36:39], v[60:63]
  v_mfma_f32_16x16x32_bf16 v[116:119], a[68:71], a[40:43], v[116:119]
  buffer_load_dwordx4 v226, s[8:11], s17 offen offset:1024 lds
  v_mfma_f32_16x16x32_bf16 v[172:175], a[68:71], a[44:47], v[172:175]
  ds_read_b64_tr_b16 a[68:69], v229 offset:43040
  ds_read_b64_tr_b16 a[70:71], v229 offset:46624
  v_mfma_f32_16x16x32_bf16 v[8:11], a[72:75], a[32:35], v[8:11]
  v_mfma_f32_16x16x32_bf16 v[64:67], a[72:75], a[36:39], v[64:67]
  buffer_load_dwordx4 v227, s[8:11], s17 offen offset:2048 lds
  v_mfma_f32_16x16x32_bf16 v[120:123], a[72:75], a[40:43], v[120:123]
  v_mfma_f32_16x16x32_bf16 v[176:179], a[72:75], a[44:47], v[176:179]
  ds_read_b64_tr_b16 a[72:73], v229 offset:43072
  ds_read_b64_tr_b16 a[74:75], v229 offset:46656
  v_mfma_f32_16x16x32_bf16 v[12:15], a[76:79], a[32:35], v[12:15]
  s_mov_b32 exec_hi, 0
  buffer_load_dwordx4 v228, s[8:11], s17 offen offset:3072 lds
  s_mov_b32 exec_hi, -1
  v_mfma_f32_16x16x32_bf16 v[68:71], a[76:79], a[36:39], v[68:71]
  v_mfma_f32_16x16x32_bf16 v[124:127], a[76:79], a[40:43], v[124:127]
  v_mfma_f32_16x16x32_bf16 v[180:183], a[76:79], a[44:47], v[180:183]
  ds_read_b64_tr_b16 a[76:77], v229 offset:43104
  s_add_u32 s17, s17, 229376
  v_mfma_f32_16x16x32_bf16 v[16:19], a[80:83], a[32:35], v[16:19]
  ds_read_b64_tr_b16 a[78:79], v229 offset:46688
  v_mfma_f32_16x16x32_bf16 v[72:75], a[80:83], a[36:39], v[72:75]
  v_mfma_f32_16x16x32_bf16 v[128:131], a[80:83], a[40:43], v[128:131]
  buffer_load_dwordx4 a[16:19], v224, s[4:7], s16 offen offset:0 sc1
  v_mfma_f32_16x16x32_bf16 v[184:187], a[80:83], a[44:47], v[184:187]
  ds_read_b64_tr_b16 a[80:81], v229 offset:43136
  ds_read_b64_tr_b16 a[82:83], v229 offset:46720
  v_mfma_f32_16x16x32_bf16 v[20:23], a[84:87], a[32:35], v[20:23]
  v_mfma_f32_16x16x32_bf16 v[76:79], a[84:87], a[36:39], v[76:79]
  buffer_load_dwordx4 a[20:23], v224, s[4:7], s16 offen offset:1024 sc1
  v_mfma_f32_16x16x32_bf16 v[132:135], a[84:87], a[40:43], v[132:135]
  v_mfma_f32_16x16x32_bf16 v[188:191], a[84:87], a[44:47], v[188:191]
  ds_read_b64_tr_b16 a[84:85], v229 offset:43168
  ds_read_b64_tr_b16 a[86:87], v229 offset:46752
  v_mfma_f32_16x16x32_bf16 v[24:27], a[88:91], a[32:35], v[24:27]
  buffer_load_dwordx4 a[24:27], v224, s[4:7], s16 offen offset:2048 sc1
  v_mfma_f32_16x16x32_bf16 v[80:83], a[88:91], a[36:39], v[80:83]
  v_mfma_f32_16x16x32_bf16 v[136:139], a[88:91], a[40:43], v[136:139]
  v_mfma_f32_16x16x32_bf16 v[192:195], a[88:91], a[44:47], v[192:195]
  buffer_load_dwordx4 a[28:31], v224, s[4:7], s16 offen offset:3072 sc1
  v_mfma_f32_16x16x32_bf16 v[28:31], a[92:95], a[32:35], v[28:31]
  ds_read_b64_tr_b16 a[88:89], v229 offset:43200
  ds_read_b64_tr_b16 a[90:91], v229 offset:46784
  v_mfma_f32_16x16x32_bf16 v[84:87], a[92:95], a[36:39], v[84:87]
  v_mfma_f32_16x16x32_bf16 v[140:143], a[92:95], a[40:43], v[140:143]
  s_add_u32 s16, s16, 131072
  v_mfma_f32_16x16x32_bf16 v[196:199], a[92:95], a[44:47], v[196:199]
  ds_read_b64_tr_b16 a[92:93], v229 offset:50176
  ds_read_b64_tr_b16 a[94:95], v229 offset:53760
  s_waitcnt lgkmcnt(10)
  v_mfma_f32_16x16x32_bf16 v[32:35], a[96:99], a[32:35], v[32:35]
  v_mfma_f32_16x16x32_bf16 v[88:91], a[96:99], a[36:39], v[88:91]
  buffer_load_dword v251, v249, s[52:55], s56 offen
  v_mfma_f32_16x16x32_bf16 v[144:147], a[96:99], a[40:43], v[144:147]
  v_mfma_f32_16x16x32_bf16 v[200:203], a[96:99], a[44:47], v[200:203]
  ds_read_b64_tr_b16 a[96:97], v229 offset:50208
  ds_read_b64_tr_b16 a[98:99], v229 offset:53792
  v_mfma_f32_16x16x32_bf16 v[36:39], a[100:103], a[32:35], v[36:39]
  s_add_u32 s56, s56, 1048576
  v_mfma_f32_16x16x32_bf16 v[92:95], a[100:103], a[36:39], v[92:95]
  v_mfma_f32_16x16x32_bf16 v[148:151], a[100:103], a[40:43], v[148:151]
  v_mfma_f32_16x16x32_bf16 v[204:207], a[100:103], a[44:47], v[204:207]
  ds_read_b64_tr_b16 a[100:101], v229 offset:50240
  s_add_u32 s59, s59, 1
  v_mfma_f32_16x16x32_bf16 v[40:43], a[104:107], a[32:35], v[40:43]
  ds_read_b64_tr_b16 a[102:103], v229 offset:53824
  v_mfma_f32_16x16x32_bf16 v[96:99], a[104:107], a[36:39], v[96:99]
  v_mfma_f32_16x16x32_bf16 v[152:155], a[104:107], a[40:43], v[152:155]
  s_cmp_eq_u32 s59, 6
  v_mfma_f32_16x16x32_bf16 v[208:211], a[104:107], a[44:47], v[208:211]
  ds_read_b64_tr_b16 a[104:105], v229 offset:50272
  ds_read_b64_tr_b16 a[106:107], v229 offset:53856
  v_mfma_f32_16x16x32_bf16 v[44:47], a[108:111], a[32:35], v[44:47]
  v_mfma_f32_16x16x32_bf16 v[100:103], a[108:111], a[36:39], v[100:103]
  s_cselect_b32 s52, s22, s52
  v_mfma_f32_16x16x32_bf16 v[156:159], a[108:111], a[40:43], v[156:159]
  v_mfma_f32_16x16x32_bf16 v[212:215], a[108:111], a[44:47], v[212:215]
  ds_read_b64_tr_b16 a[108:109], v229 offset:50304
  ds_read_b64_tr_b16 a[110:111], v229 offset:53888
  v_mfma_f32_16x16x32_bf16 v[48:51], a[112:115], a[32:35], v[48:51]
  s_cselect_b32 s53, s23, s53
  v_mfma_f32_16x16x32_bf16 v[104:107], a[112:115], a[36:39], v[104:107]
  v_mfma_f32_16x16x32_bf16 v[160:163], a[112:115], a[40:43], v[160:163]
  v_mfma_f32_16x16x32_bf16 v[216:219], a[112:115], a[44:47], v[216:219]
  ds_read_b64_tr_b16 a[112:113], v229 offset:50336
  s_cselect_b32 s56, s60, s56
  v_mfma_f32_16x16x32_bf16 v[52:55], a[116:119], a[32:35], v[52:55]
  ds_read_b64_tr_b16 a[114:115], v229 offset:53920
  v_mfma_f32_16x16x32_bf16 v[108:111], a[116:119], a[36:39], v[108:111]
  v_mfma_f32_16x16x32_bf16 v[164:167], a[116:119], a[40:43], v[164:167]
  v_mfma_f32_16x16x32_bf16 v[220:223], a[116:119], a[44:47], v[220:223]
  s_waitcnt vmcnt(13) lgkmcnt(10)
  s_barrier
  v_mfma_f32_16x16x32_bf16 v[0:3], a[64:67], a[48:51], v[0:3]
  ds_read_b64_tr_b16 a[116:117], v229 offset:50368
  s_add_u32 m0, s38, 28672
  v_mfma_f32_16x16x32_bf16 v[56:59], a[64:67], a[52:55], v[56:59]
  ds_read_b64_tr_b16 a[118:119], v229 offset:53952
  v_mfma_f32_16x16x32_bf16 v[112:115], a[64:67], a[56:59], v[112:115]
  v_mfma_f32_16x16x32_bf16 v[168:171], a[64:67], a[60:63], v[168:171]
  ds_read_b64_tr_b16 a[64:65], v229 offset:0
  ds_read_b64_tr_b16 a[66:67], v229 offset:3584
  v_mfma_f32_16x16x32_bf16 v[4:7], a[68:71], a[48:51], v[4:7]
  v_mfma_f32_16x16x32_bf16 v[60:63], a[68:71], a[52:55], v[60:63]
  buffer_load_dwordx4 v225, s[8:11], s17 offen lds
  v_mfma_f32_16x16x32_bf16 v[116:119], a[68:71], a[56:59], v[116:119]
  v_mfma_f32_16x16x32_bf16 v[172:175], a[68:71], a[60:63], v[172:175]
  ds_read_b64_tr_b16 a[68:69], v229 offset:32
  ds_read_b64_tr_b16 a[70:71], v229 offset:3616
  v_mfma_f32_16x16x32_bf16 v[8:11], a[72:75], a[48:51], v[8:11]
  v_mfma_f32_16x16x32_bf16 v[64:67], a[72:75], a[52:55], v[64:67]
  v_mfma_f32_16x16x32_bf16 v[120:123], a[72:75], a[56:59], v[120:123]
  buffer_load_dwordx4 v226, s[8:11], s17 offen offset:1024 lds
  v_mfma_f32_16x16x32_bf16 v[176:179], a[72:75], a[60:63], v[176:179]
  ds_read_b64_tr_b16 a[72:73], v229 offset:64
  ds_read_b64_tr_b16 a[74:75], v229 offset:3648
  v_mfma_f32_16x16x32_bf16 v[12:15], a[76:79], a[48:51], v[12:15]
  v_mfma_f32_16x16x32_bf16 v[68:71], a[76:79], a[52:55], v[68:71]
  v_mfma_f32_16x16x32_bf16 v[124:127], a[76:79], a[56:59], v[124:127]
  v_mfma_f32_16x16x32_bf16 v[180:183], a[76:79], a[60:63], v[180:183]
  buffer_load_dwordx4 v227, s[8:11], s17 offen offset:2048 lds
  v_mfma_f32_16x16x32_bf16 v[16:19], a[80:83], a[48:51], v[16:19]
  ds_read_b64_tr_b16 a[76:77], v229 offset:96
  ds_read_b64_tr_b16 a[78:79], v229 offset:3680
  v_mfma_f32_16x16x32_bf16 v[72:75], a[80:83], a[52:55], v[72:75]
  v_mfma_f32_16x16x32_bf16 v[128:131], a[80:83], a[56:59], v[128:131]
  v_mfma_f32_16x16x32_bf16 v[184:187], a[80:83], a[60:63], v[184:187]
  ds_read_b64_tr_b16 a[80:81], v229 offset:128
  ds_read_b64_tr_b16 a[82:83], v229 offset:3712
  v_mfma_f32_16x16x32_bf16 v[20:23], a[84:87], a[48:51], v[20:23]
  s_mov_b32 exec_hi, 0
  buffer_load_dwordx4 v228, s[8:11], s17 offen offset:3072 lds
  s_mov_b32 exec_hi, -1
  v_mfma_f32_16x16x32_bf16 v[76:79], a[84:87], a[52:55], v[76:79]
  v_mfma_f32_16x16x32_bf16 v[132:135], a[84:87], a[56:59], v[132:135]
  v_mfma_f32_16x16x32_bf16 v[188:191], a[84:87], a[60:63], v[188:191]
  ds_read_b64_tr_b16 a[84:85], v229 offset:160
  ds_read_b64_tr_b16 a[86:87], v229 offset:3744
  v_mfma_f32_16x16x32_bf16 v[24:27], a[88:91], a[48:51], v[24:27]
  v_mfma_f32_16x16x32_bf16 v[80:83], a[88:91], a[52:55], v[80:83]
  s_add_u32 s17, s17, 229376
  v_mfma_f32_16x16x32_bf16 v[136:139], a[88:91], a[56:59], v[136:139]
  v_mfma_f32_16x16x32_bf16 v[192:195], a[88:91], a[60:63], v[192:195]
  ds_read_b64_tr_b16 a[88:89], v229 offset:192
  ds_read_b64_tr_b16 a[90:91], v229 offset:3776
  v_mfma_f32_16x16x32_bf16 v[28:31], a[92:95], a[48:51], v[28:31]
  v_mfma_f32_16x16x32_bf16 v[84:87], a[92:95], a[52:55], v[84:87]
  v_mfma_f32_16x16x32_bf16 v[140:143], a[92:95], a[56:59], v[140:143]
  buffer_load_dwordx4 a[32:35], v224, s[4:7], s16 offen offset:0 sc1
  v_mfma_f32_16x16x32_bf16 v[196:199], a[92:95], a[60:63], v[196:199]
  ds_read_b64_tr_b16 a[92:93], v229 offset:7168
  ds_read_b64_tr_b16 a[94:95], v229 offset:10752
  s_waitcnt lgkmcnt(10)
  v_mfma_f32_16x16x32_bf16 v[32:35], a[96:99], a[48:51], v[32:35]
  v_mfma_f32_16x16x32_bf16 v[88:91], a[96:99], a[52:55], v[88:91]
  v_mfma_f32_16x16x32_bf16 v[144:147], a[96:99], a[56:59], v[144:147]
  v_mfma_f32_16x16x32_bf16 v[200:203], a[96:99], a[60:63], v[200:203]
  buffer_load_dwordx4 a[36:39], v224, s[4:7], s16 offen offset:1024 sc1
  v_mfma_f32_16x16x32_bf16 v[36:39], a[100:103], a[48:51], v[36:39]
  ds_read_b64_tr_b16 a[96:97], v229 offset:7200
  ds_read_b64_tr_b16 a[98:99], v229 offset:10784
  v_mfma_f32_16x16x32_bf16 v[92:95], a[100:103], a[52:55], v[92:95]
  v_mfma_f32_16x16x32_bf16 v[148:151], a[100:103], a[56:59], v[148:151]
  v_mfma_f32_16x16x32_bf16 v[204:207], a[100:103], a[60:63], v[204:207]
  ds_read_b64_tr_b16 a[100:101], v229 offset:7232
  ds_read_b64_tr_b16 a[102:103], v229 offset:10816
  v_mfma_f32_16x16x32_bf16 v[40:43], a[104:107], a[48:51], v[40:43]
  buffer_load_dwordx4 a[40:43], v224, s[4:7], s16 offen offset:2048 sc1
  v_mfma_f32_16x16x32_bf16 v[96:99], a[104:107], a[52:55], v[96:99]
  v_mfma_f32_16x16x32_bf16 v[152:155], a[104:107], a[56:59], v[152:155]
  v_mfma_f32_16x16x32_bf16 v[208:211], a[104:107], a[60:63], v[208:211]
  ds_read_b64_tr_b16 a[104:105], v229 offset:7264
  ds_read_b64_tr_b16 a[106:107], v229 offset:10848
  v_mfma_f32_16x16x32_bf16 v[44:47], a[108:111], a[48:51], v[44:47]
  v_mfma_f32_16x16x32_bf16 v[100:103], a[108:111], a[52:55], v[100:103]
  buffer_load_dwordx4 a[44:47], v224, s[4:7], s16 offen offset:3072 sc1
  v_mfma_f32_16x16x32_bf16 v[156:159], a[108:111], a[56:59], v[156:159]
  v_mfma_f32_16x16x32_bf16 v[212:215], a[108:111], a[60:63], v[212:215]
  ds_read_b64_tr_b16 a[108:109], v229 offset:7296
  ds_read_b64_tr_b16 a[110:111], v229 offset:10880
  v_mfma_f32_16x16x32_bf16 v[48:51], a[112:115], a[48:51], v[48:51]
  v_mfma_f32_16x16x32_bf16 v[104:107], a[112:115], a[52:55], v[104:107]
  v_mfma_f32_16x16x32_bf16 v[160:163], a[112:115], a[56:59], v[160:163]
  s_add_u32 s16, s16, 131072
  v_mfma_f32_16x16x32_bf16 v[216:219], a[112:115], a[60:63], v[216:219]
  ds_read_b64_tr_b16 a[112:113], v229 offset:7328
  ds_read_b64_tr_b16 a[114:115], v229 offset:10912
  v_mfma_f32_16x16x32_bf16 v[52:55], a[116:119], a[48:51], v[52:55]
  v_mfma_f32_16x16x32_bf16 v[108:111], a[116:119], a[52:55], v[108:111]
  v_mfma_f32_16x16x32_bf16 v[164:167], a[116:119], a[56:59], v[164:167]
  v_mfma_f32_16x16x32_bf16 v[220:223], a[116:119], a[60:63], v[220:223]
  s_waitcnt vmcnt(13) lgkmcnt(10)
  s_barrier
  v_mfma_f32_16x16x32_bf16 v[0:3], a[64:67], a[0:3], v[0:3]
  ds_read_b64_tr_b16 a[116:117], v229 offset:7360
  s_add_u32 m0, s38, 43008
  v_mfma_f32_16x16x32_bf16 v[56:59], a[64:67], a[4:7], v[56:59]
  ds_read_b64_tr_b16 a[118:119], v229 offset:10944
  v_mfma_f32_16x16x32_bf16 v[112:115], a[64:67], a[8:11], v[112:115]
  v_mfma_f32_16x16x32_bf16 v[168:171], a[64:67], a[12:15], v[168:171]
  buffer_load_dwordx4 v225, s[8:11], s17 offen lds
  v_mfma_f32_16x16x32_bf16 v[4:7], a[68:71], a[0:3], v[4:7]
  ds_read_b64_tr_b16 a[64:65], v229 offset:14336
  ds_read_b64_tr_b16 a[66:67], v229 offset:17920
  v_mfma_f32_16x16x32_bf16 v[60:63], a[68:71], a[4:7], v[60:63]
  v_mfma_f32_16x16x32_bf16 v[116:119], a[68:71], a[8:11], v[116:119]
  buffer_load_dwordx4 v226, s[8:11], s17 offen offset:1024 lds
  v_mfma_f32_16x16x32_bf16 v[172:175], a[68:71], a[12:15], v[172:175]
  ds_read_b64_tr_b16 a[68:69], v229 offset:14368
  ds_read_b64_tr_b16 a[70:71], v229 offset:17952
  v_mfma_f32_16x16x32_bf16 v[8:11], a[72:75], a[0:3], v[8:11]
  v_mfma_f32_16x16x32_bf16 v[64:67], a[72:75], a[4:7], v[64:67]
  buffer_load_dwordx4 v227, s[8:11], s17 offen offset:2048 lds
  v_mfma_f32_16x16x32_bf16 v[120:123], a[72:75], a[8:11], v[120:123]
  v_mfma_f32_16x16x32_bf16 v[176:179], a[72:75], a[12:15], v[176:179]
  ds_read_b64_tr_b16 a[72:73], v229 offset:14400
  ds_read_b64_tr_b16 a[74:75], v229 offset:17984
  v_mfma_f32_16x16x32_bf16 v[12:15], a[76:79], a[0:3], v[12:15]
  s_mov_b32 exec_hi, 0
  buffer_load_dwordx4 v228, s[8:11], s17 offen offset:3072 lds
  s_mov_b32 exec_hi, -1
  v_mfma_f32_16x16x32_bf16 v[68:71], a[76:79], a[4:7], v[68:71]
  v_mfma_f32_16x16x32_bf16 v[124:127], a[76:79], a[8:11], v[124:127]
  v_mfma_f32_16x16x32_bf16 v[180:183], a[76:79], a[12:15], v[180:183]
  ds_read_b64_tr_b16 a[76:77], v229 offset:14432
  s_add_u32 s17, s17, 229376
  v_mfma_f32_16x16x32_bf16 v[16:19], a[80:83], a[0:3], v[16:19]
  ds_read_b64_tr_b16 a[78:79], v229 offset:18016
  v_mfma_f32_16x16x32_bf16 v[72:75], a[80:83], a[4:7], v[72:75]
  v_mfma_f32_16x16x32_bf16 v[128:131], a[80:83], a[8:11], v[128:131]
  buffer_load_dwordx4 a[48:51], v224, s[4:7], s16 offen offset:0 sc1
  v_mfma_f32_16x16x32_bf16 v[184:187], a[80:83], a[12:15], v[184:187]
  ds_read_b64_tr_b16 a[80:81], v229 offset:14464
  ds_read_b64_tr_b16 a[82:83], v229 offset:18048
  v_mfma_f32_16x16x32_bf16 v[20:23], a[84:87], a[0:3], v[20:23]
  v_mfma_f32_16x16x32_bf16 v[76:79], a[84:87], a[4:7], v[76:79]
  buffer_load_dwordx4 a[52:55], v224, s[4:7], s16 offen offset:1024 sc1
  v_mfma_f32_16x16x32_bf16 v[132:135], a[84:87], a[8:11], v[132:135]
  v_mfma_f32_16x16x32_bf16 v[188:191], a[84:87], a[12:15], v[188:191]
  ds_read_b64_tr_b16 a[84:85], v229 offset:14496
  ds_read_b64_tr_b16 a[86:87], v229 offset:18080
  v_mfma_f32_16x16x32_bf16 v[24:27], a[88:91], a[0:3], v[24:27]
  buffer_load_dwordx4 a[56:59], v224, s[4:7], s16 offen offset:2048 sc1
  v_mfma_f32_16x16x32_bf16 v[80:83], a[88:91], a[4:7], v[80:83]
  v_mfma_f32_16x16x32_bf16 v[136:139], a[88:91], a[8:11], v[136:139]
  v_mfma_f32_16x16x32_bf16 v[192:195], a[88:91], a[12:15], v[192:195]
  buffer_load_dwordx4 a[60:63], v224, s[4:7], s16 offen offset:3072 sc1
  v_mfma_f32_16x16x32_bf16 v[28:31], a[92:95], a[0:3], v[28:31]
  ds_read_b64_tr_b16 a[88:89], v229 offset:14528
  ds_read_b64_tr_b16 a[90:91], v229 offset:18112
  v_mfma_f32_16x16x32_bf16 v[84:87], a[92:95], a[4:7], v[84:87]
  v_mfma_f32_16x16x32_bf16 v[140:143], a[92:95], a[8:11], v[140:143]
  s_add_u32 s16, s16, 131072
  v_mfma_f32_16x16x32_bf16 v[196:199], a[92:95], a[12:15], v[196:199]
  ds_read_b64_tr_b16 a[92:93], v229 offset:21504
  ds_read_b64_tr_b16 a[94:95], v229 offset:25088
  s_waitcnt lgkmcnt(10)
  v_mfma_f32_16x16x32_bf16 v[32:35], a[96:99], a[0:3], v[32:35]
  v_mfma_f32_16x16x32_bf16 v[88:91], a[96:99], a[4:7], v[88:91]
  buffer_load_dword v251, v249, s[52:55], s56 offen
  v_mfma_f32_16x16x32_bf16 v[144:147], a[96:99], a[8:11], v[144:147]
  v_mfma_f32_16x16x32_bf16 v[200:203], a[96:99], a[12:15], v[200:203]
  ds_read_b64_tr_b16 a[96:97], v229 offset:21536
  ds_read_b64_tr_b16 a[98:99], v229 offset:25120
  v_mfma_f32_16x16x32_bf16 v[36:39], a[100:103], a[0:3], v[36:39]
  s_add_u32 s56, s56, 1048576
  v_mfma_f32_16x16x32_bf16 v[92:95], a[100:103], a[4:7], v[92:95]
  v_mfma_f32_16x16x32_bf16 v[148:151], a[100:103], a[8:11], v[148:151]
  v_mfma_f32_16x16x32_bf16 v[204:207], a[100:103], a[12:15], v[204:207]
  ds_read_b64_tr_b16 a[100:101], v229 offset:21568
  s_add_u32 s59, s59, 1
  v_mfma_f32_16x16x32_bf16 v[40:43], a[104:107], a[0:3], v[40:43]
  ds_read_b64_tr_b16 a[102:103], v229 offset:25152
  v_mfma_f32_16x16x32_bf16 v[96:99], a[104:107], a[4:7], v[96:99]
  v_mfma_f32_16x16x32_bf16 v[152:155], a[104:107], a[8:11], v[152:155]
  s_cmp_eq_u32 s59, 6
  v_mfma_f32_16x16x32_bf16 v[208:211], a[104:107], a[12:15], v[208:211]
  ds_read_b64_tr_b16 a[104:105], v229 offset:21600
  ds_read_b64_tr_b16 a[106:107], v229 offset:25184
  v_mfma_f32_16x16x32_bf16 v[44:47], a[108:111], a[0:3], v[44:47]
  v_mfma_f32_16x16x32_bf16 v[100:103], a[108:111], a[4:7], v[100:103]
  s_cselect_b32 s52, s22, s52
  v_mfma_f32_16x16x32_bf16 v[156:159], a[108:111], a[8:11], v[156:159]
  v_mfma_f32_16x16x32_bf16 v[212:215], a[108:111], a[12:15], v[212:215]
  ds_read_b64_tr_b16 a[108:109], v229 offset:21632
  ds_read_b64_tr_b16 a[110:111], v229 offset:25216
  v_mfma_f32_16x16x32_bf16 v[48:51], a[112:115], a[0:3], v[48:51]
  s_cselect_b32 s53, s23, s53
  v_mfma_f32_16x16x32_bf16 v[104:107], a[112:115], a[4:7], v[104:107]
  v_mfma_f32_16x16x32_bf16 v[160:163], a[112:115], a[8:11], v[160:163]
  v_mfma_f32_16x16x32_bf16 v[216:219], a[112:115], a[12:15], v[216:219]
  ds_read_b64_tr_b16 a[112:113], v229 offset:21664
  s_cselect_b32 s56, s60, s56
  v_mfma_f32_16x16x32_bf16 v[52:55], a[116:119], a[0:3], v[52:55]
  ds_read_b64_tr_b16 a[114:115], v229 offset:25248
  v_mfma_f32_16x16x32_bf16 v[108:111], a[116:119], a[4:7], v[108:111]
  v_mfma_f32_16x16x32_bf16 v[164:167], a[116:119], a[8:11], v[164:167]
  v_mfma_f32_16x16x32_bf16 v[220:223], a[116:119], a[12:15], v[220:223]
  s_waitcnt vmcnt(13) lgkmcnt(10)
  s_barrier
  v_mfma_f32_16x16x32_bf16 v[0:3], a[64:67], a[16:19], v[0:3]
  ds_read_b64_tr_b16 a[116:117], v229 offset:21696
  s_add_u32 m0, s38, 0
  v_mfma_f32_16x16x32_bf16 v[56:59], a[64:67], a[20:23], v[56:59]
  ds_read_b64_tr_b16 a[118:119], v229 offset:25280
  v_mfma_f32_16x16x32_bf16 v[112:115], a[64:67], a[24:27], v[112:115]
  v_mfma_f32_16x16x32_bf16 v[168:171], a[64:67], a[28:31], v[168:171]
  ds_read_b64_tr_b16 a[64:65], v229 offset:28672
  ds_read_b64_tr_b16 a[66:67], v229 offset:32256
  v_mfma_f32_16x16x32_bf16 v[4:7], a[68:71], a[16:19], v[4:7]
  v_mfma_f32_16x16x32_bf16 v[60:63], a[68:71], a[20:23], v[60:63]
  buffer_load_dwordx4 v225, s[8:11], s17 offen lds
  v_mfma_f32_16x16x32_bf16 v[116:119], a[68:71], a[24:27], v[116:119]
  v_mfma_f32_16x16x32_bf16 v[172:175], a[68:71], a[28:31], v[172:175]
  ds_read_b64_tr_b16 a[68:69], v229 offset:28704
  ds_read_b64_tr_b16 a[70:71], v229 offset:32288
  v_mfma_f32_16x16x32_bf16 v[8:11], a[72:75], a[16:19], v[8:11]
  v_mfma_f32_16x16x32_bf16 v[64:67], a[72:75], a[20:23], v[64:67]
  v_mfma_f32_16x16x32_bf16 v[120:123], a[72:75], a[24:27], v[120:123]
  buffer_load_dwordx4 v226, s[8:11], s17 offen offset:1024 lds
  v_mfma_f32_16x16x32_bf16 v[176:179], a[72:75], a[28:31], v[176:179]
  ds_read_b64_tr_b16 a[72:73], v229 offset:28736
  ds_read_b64_tr_b16 a[74:75], v229 offset:32320
  v_mfma_f32_16x16x32_bf16 v[12:15], a[76:79], a[16:19], v[12:15]
  v_mfma_f32_16x16x32_bf16 v[68:71], a[76:79], a[20:23], v[68:71]
  v_mfma_f32_16x16x32_bf16 v[124:127], a[76:79], a[24:27], v[124:127]
  v_mfma_f32_16x16x32_bf16 v[180:183], a[76:79], a[28:31], v[180:183]
  buffer_load_dwordx4 v227, s[8:11], s17 offen offset:2048 lds
  v_mfma_f32_16x16x32_bf16 v[16:19], a[80:83], a[16:19], v[16:19]
  ds_read_b64_tr_b16 a[76:77], v229 offset:28768
  ds_read_b64_tr_b16 a[78:79], v229 offset:32352
  v_mfma_f32_16x16x32_bf16 v[72:75], a[80:83], a[20:23], v[72:75]
  v_mfma_f32_16x16x32_bf16 v[128:131], a[80:83], a[24:27], v[128:131]
  v_mfma_f32_16x16x32_bf16 v[184:187], a[80:83], a[28:31], v[184:187]
  ds_read_b64_tr_b16 a[80:81], v229 offset:28800
  ds_read_b64_tr_b16 a[82:83], v229 offset:32384
  v_mfma_f32_16x16x32_bf16 v[20:23], a[84:87], a[16:19], v[20:23]
  s_mov_b32 exec_hi, 0
  buffer_load_dwordx4 v228, s[8:11], s17 offen offset:3072 lds
  s_mov_b32 exec_hi, -1
  v_mfma_f32_16x16x32_bf16 v[76:79], a[84:87], a[20:23], v[76:79]
  v_mfma_f32_16x16x32_bf16 v[132:135], a[84:87], a[24:27], v[132:135]
  v_mfma_f32_16x16x32_bf16 v[188:191], a[84:87], a[28:31], v[188:191]
  ds_read_b64_tr_b16 a[84:85], v229 offset:28832
  ds_read_b64_tr_b16 a[86:87], v229 offset:32416
  v_mfma_f32_16x16x32_bf16 v[24:27], a[88:91], a[16:19], v[24:27]
  v_mfma_f32_16x16x32_bf16 v[80:83], a[88:91], a[20:23], v[80:83]
  s_add_u32 s17, s17, 229376
  v_mfma_f32_16x16x32_bf16 v[136:139], a[88:91], a[24:27], v[136:139]
  v_mfma_f32_16x16x32_bf16 v[192:195], a[88:91], a[28:31], v[192:195]
  ds_read_b64_tr_b16 a[88:89], v229 offset:28864
  ds_read_b64_tr_b16 a[90:91], v229 offset:32448
  v_mfma_f32_16x16x32_bf16 v[28:31], a[92:95], a[16:19], v[28:31]
  v_mfma_f32_16x16x32_bf16 v[84:87], a[92:95], a[20:23], v[84:87]
  v_mfma_f32_16x16x32_bf16 v[140:143], a[92:95], a[24:27], v[140:143]
  buffer_load_dwordx4 a[0:3], v224, s[4:7], s16 offen offset:0 sc1
  v_mfma_f32_16x16x32_bf16 v[196:199], a[92:95], a[28:31], v[196:199]
  ds_read_b64_tr_b16 a[92:93], v229 offset:35840
  ds_read_b64_tr_b16 a[94:95], v229 offset:39424
  s_waitcnt lgkmcnt(10)
  v_mfma_f32_16x16x32_bf16 v[32:35], a[96:99], a[16:19], v[32:35]
  v_mfma_f32_16x16x32_bf16 v[88:91], a[96:99], a[20:23], v[88:91]
  v_mfma_f32_16x16x32_bf16 v[144:147], a[96:99], a[24:27], v[144:147]
  v_mfma_f32_16x16x32_bf16 v[200:203], a[96:99], a[28:31], v[200:203]
  buffer_load_dwordx4 a[4:7], v224, s[4:7], s16 offen offset:1024 sc1
  v_mfma_f32_16x16x32_bf16 v[36:39], a[100:103], a[16:19], v[36:39]
  ds_read_b64_tr_b16 a[96:97], v229 offset:35872
  ds_read_b64_tr_b16 a[98:99], v229 offset:39456
  v_mfma_f32_16x16x32_bf16 v[92:95], a[100:103], a[20:23], v[92:95]
  v_mfma_f32_16x16x32_bf16 v[148:151], a[100:103], a[24:27], v[148:151]
  v_mfma_f32_16x16x32_bf16 v[204:207], a[100:103], a[28:31], v[204:207]
  ds_read_b64_tr_b16 a[100:101], v229 offset:35904
  ds_read_b64_tr_b16 a[102:103], v229 offset:39488
  v_mfma_f32_16x16x32_bf16 v[40:43], a[104:107], a[16:19], v[40:43]
  buffer_load_dwordx4 a[8:11], v224, s[4:7], s16 offen offset:2048 sc1
  v_mfma_f32_16x16x32_bf16 v[96:99], a[104:107], a[20:23], v[96:99]
  v_mfma_f32_16x16x32_bf16 v[152:155], a[104:107], a[24:27], v[152:155]
  v_mfma_f32_16x16x32_bf16 v[208:211], a[104:107], a[28:31], v[208:211]
  ds_read_b64_tr_b16 a[104:105], v229 offset:35936
  ds_read_b64_tr_b16 a[106:107], v229 offset:39520
  v_mfma_f32_16x16x32_bf16 v[44:47], a[108:111], a[16:19], v[44:47]
  v_mfma_f32_16x16x32_bf16 v[100:103], a[108:111], a[20:23], v[100:103]
  buffer_load_dwordx4 a[12:15], v224, s[4:7], s16 offen offset:3072 sc1
  v_mfma_f32_16x16x32_bf16 v[156:159], a[108:111], a[24:27], v[156:159]
  v_mfma_f32_16x16x32_bf16 v[212:215], a[108:111], a[28:31], v[212:215]
  ds_read_b64_tr_b16 a[108:109], v229 offset:35968
  ds_read_b64_tr_b16 a[110:111], v229 offset:39552
  v_mfma_f32_16x16x32_bf16 v[48:51], a[112:115], a[16:19], v[48:51]
  v_mfma_f32_16x16x32_bf16 v[104:107], a[112:115], a[20:23], v[104:107]
  v_mfma_f32_16x16x32_bf16 v[160:163], a[112:115], a[24:27], v[160:163]
  s_add_u32 s16, s16, 131072
  v_mfma_f32_16x16x32_bf16 v[216:219], a[112:115], a[28:31], v[216:219]
  ds_read_b64_tr_b16 a[112:113], v229 offset:36000
  ds_read_b64_tr_b16 a[114:115], v229 offset:39584
  v_mfma_f32_16x16x32_bf16 v[52:55], a[116:119], a[16:19], v[52:55]
  v_mfma_f32_16x16x32_bf16 v[108:111], a[116:119], a[20:23], v[108:111]
  v_mfma_f32_16x16x32_bf16 v[164:167], a[116:119], a[24:27], v[164:167]
  v_mfma_f32_16x16x32_bf16 v[220:223], a[116:119], a[28:31], v[220:223]
  s_sub_u32 s18, s18, 1
  s_cmp_lg_u32 s18, 0
  s_cbranch_scc1 L_loop_24
  s_waitcnt vmcnt(13) lgkmcnt(10)
  s_barrier
  v_mfma_f32_16x16x32_bf16 v[0:3], a[64:67], a[32:35], v[0:3]
  ds_read_b64_tr_b16 a[116:117], v229 offset:36032
  s_add_u32 m0, s38, 14336
  v_mfma_f32_16x16x32_bf16 v[56:59], a[64:67], a[36:39], v[56:59]
  ds_read_b64_tr_b16 a[118:119], v229 offset:39616
  v_mfma_f32_16x16x32_bf16 v[112:115], a[64:67], a[40:43], v[112:115]
  v_mfma_f32_16x16x32_bf16 v[168:171], a[64:67], a[44:47], v[168:171]
  buffer_load_dwordx4 v225, s[8:11], s17 offen lds
  v_mfma_f32_16x16x32_bf16 v[4:7], a[68:71], a[32:35], v[4:7]
  ds_read_b64_tr_b16 a[64:65], v229 offset:43008
  ds_read_b64_tr_b16 a[66:67], v229 offset:46592
  v_mfma_f32_16x16x32_bf16 v[60:63], a[68:71], a[36:39], v[60:63]
  v_mfma_f32_16x16x32_bf16 v[116:119], a[68:71], a[40:43], v[116:119]
  buffer_load_dwordx4 v226, s[8:11], s17 offen offset:1024 lds
  v_mfma_f32_16x16x32_bf16 v[172:175], a[68:71], a[44:47], v[172:175]
  ds_read_b64_tr_b16 a[68:69], v229 offset:43040
  ds_read_b64_tr_b16 a[70:71], v229 offset:46624
  v_mfma_f32_16x16x32_bf16 v[8:11], a[72:75], a[32:35], v[8:11]
  v_mfma_f32_16x16x32_bf16 v[64:67], a[72:75], a[36:39], v[64:67]
  buffer_load_dwordx4 v227, s[8:11], s17 offen offset:2048 lds
  v_mfma_f32_16x16x32_bf16 v[120:123], a[72:75], a[40:43], v[120:123]
  v_mfma_f32_16x16x32_bf16 v[176:179], a[72:75], a[44:47], v[176:179]
  ds_read_b64_tr_b16 a[72:73], v229 offset:43072
  ds_read_b64_tr_b16 a[74:75], v229 offset:46656
  v_mfma_f32_16x16x32_bf16 v[12:15], a[76:79], a[32:35], v[12:15]
  s_mov_b32 exec_hi, 0
  buffer_load_dwordx4 v228, s[8:11], s17 offen offset:3072 lds
  s_mov_b32 exec_hi, -1
  v_mfma_f32_16x16x32_bf16 v[68:71], a[76:79], a[36:39], v[68:71]
  v_mfma_f32_16x16x32_bf16 v[124:127], a[76:79], a[40:43], v[124:127]
  v_mfma_f32_16x16x32_bf16 v[180:183], a[76:79], a[44:47], v[180:183]
  ds_read_b64_tr_b16 a[76:77], v229 offset:43104
  s_add_u32 s17, s17, 229376
  v_mfma_f32_16x16x32_bf16 v[16:19], a[80:83], a[32:35], v[16:19]
  ds_read_b64_tr_b16 a[78:79], v229 offset:46688
  v_mfma_f32_16x16x32_bf16 v[72:75], a[80:83], a[36:39], v[72:75]
  v_mfma_f32_16x16x32_bf16 v[128:131], a[80:83], a[40:43], v[128:131]
  buffer_load_dwordx4 a[16:19], v224, s[4:7], s16 offen offset:0 sc1
  v_mfma_f32_16x16x32_bf16 v[184:187], a[80:83], a[44:47], v[184:187]
  ds_read_b64_tr_b16 a[80:81], v229 offset:43136
  ds_read_b64_tr_b16 a[82:83], v229 offset:46720
  v_mfma_f32_16x16x32_bf16 v[20:23], a[84:87], a[32:35], v[20:23]
  v_mfma_f32_16x16x32_bf16 v[76:79], a[84:87], a[36:39], v[76:79]
  buffer_load_dwordx4 a[20:23], v224, s[4:7], s16 offen offset:1024 sc1
  v_mfma_f32_16x16x32_bf16 v[132:135], a[84:87], a[40:43], v[132:135]
  v_mfma_f32_16x16x32_bf16 v[188:191], a[84:87], a[44:47], v[188:191]
  ds_read_b64_tr_b16 a[84:85], v229 offset:43168
  ds_read_b64_tr_b16 a[86:87], v229 offset:46752
  v_mfma_f32_16x16x32_bf16 v[24:27], a[88:91], a[32:35], v[24:27]
  buffer_load_dwordx4 a[24:27], v224, s[4:7], s16 offen offset:2048 sc1
  v_mfma_f32_16x16x32_bf16 v[80:83], a[88:91], a[36:39], v[80:83]
  v_mfma_f32_16x16x32_bf16 v[136:139], a[88:91], a[40:43], v[136:139]
  v_mfma_f32_16x16x32_bf16 v[192:195], a[88:91], a[44:47], v[192:195]
  buffer_load_dwordx4 a[28:31], v224, s[4:7], s16 offen offset:3072 sc1
  v_mfma_f32_16x16x32_bf16 v[28:31], a[92:95], a[32:35], v[28:31]
  ds_read_b64_tr_b16 a[88:89], v229 offset:43200
  ds_read_b64_tr_b16 a[90:91], v229 offset:46784
  v_mfma_f32_16x16x32_bf16 v[84:87], a[92:95], a[36:39], v[84:87]
  v_mfma_f32_16x16x32_bf16 v[140:143], a[92:95], a[40:43], v[140:143]
  s_add_u32 s16, s16, 131072
  v_mfma_f32_16x16x32_bf16 v[196:199], a[92:95], a[44:47], v[196:199]
  ds_read_b64_tr_b16 a[92:93], v229 offset:50176
  ds_read_b64_tr_b16 a[94:95], v229 offset:53760
  s_waitcnt lgkmcnt(10)
  v_mfma_f32_16x16x32_bf16 v[32:35], a[96:99], a[32:35], v[32:35]
  v_mfma_f32_16x16x32_bf16 v[88:91], a[96:99], a[36:39], v[88:91]
  buffer_load_dword v251, v249, s[52:55], s56 offen
  v_mfma_f32_16x16x32_bf16 v[144:147], a[96:99], a[40:43], v[144:147]
  v_mfma_f32_16x16x32_bf16 v[200:203], a[96:99], a[44:47], v[200:203]
  ds_read_b64_tr_b16 a[96:97], v229 offset:50208
  ds_read_b64_tr_b16 a[98:99], v229 offset:53792
  v_mfma_f32_16x16x32_bf16 v[36:39], a[100:103], a[32:35], v[36:39]
  s_add_u32 s56, s56, 1048576
  v_mfma_f32_16x16x32_bf16 v[92:95], a[100:103], a[36:39], v[92:95]
  v_mfma_f32_16x16x32_bf16 v[148:151], a[100:103], a[40:43], v[148:151]
  v_mfma_f32_16x16x32_bf16 v[204:207], a[100:103], a[44:47], v[204:207]
  ds_read_b64_tr_b16 a[100:101], v229 offset:50240
  s_add_u32 s59, s59, 1
  v_mfma_f32_16x16x32_bf16 v[40:43], a[104:107], a[32:35], v[40:43]
  ds_read_b64_tr_b16 a[102:103], v229 offset:53824
  v_mfma_f32_16x16x32_bf16 v[96:99], a[104:107], a[36:39], v[96:99]
  v_mfma_f32_16x16x32_bf16 v[152:155], a[104:107], a[40:43], v[152:155]
  s_cmp_eq_u32 s59, 6
  v_mfma_f32_16x16x32_bf16 v[208:211], a[104:107], a[44:47], v[208:211]
  ds_read_b64_tr_b16 a[104:105], v229 offset:50272
  ds_read_b64_tr_b16 a[106:107], v229 offset:53856
  v_mfma_f32_16x16x32_bf16 v[44:47], a[108:111], a[32:35], v[44:47]
  v_mfma_f32_16x16x32_bf16 v[100:103], a[108:111], a[36:39], v[100:103]
  s_cselect_b32 s52, s22, s52
  v_mfma_f32_16x16x32_bf16 v[156:159], a[108:111], a[40:43], v[156:159]
  v_mfma_f32_16x16x32_bf16 v[212:215], a[108:111], a[44:47], v[212:215]
  ds_read_b64_tr_b16 a[108:109], v229 offset:50304
  ds_read_b64_tr_b16 a[110:111], v229 offset:53888
  v_mfma_f32_16x16x32_bf16 v[48:51], a[112:115], a[32:35], v[48:51]
  s_cselect_b32 s53, s23, s53
  v_mfma_f32_16x16x32_bf16 v[104:107], a[112:115], a[36:39], v[104:107]
  v_mfma_f32_16x16x32_bf16 v[160:163], a[112:115], a[40:43], v[160:163]
  v_mfma_f32_16x16x32_bf16 v[216:219], a[112:115], a[44:47], v[216:219]
  ds_read_b64_tr_b16 a[112:113], v229 offset:50336
  s_cselect_b32 s56, s60, s56
  v_mfma_f32_16x16x32_bf16 v[52:55], a[116:119], a[32:35], v[52:55]
  ds_read_b64_tr_b16 a[114:115], v229 offset:53920
  v_mfma_f32_16x16x32_bf16 v[108:111], a[116:119], a[36:39], v[108:111]
  v_mfma_f32_16x16x32_bf16 v[164:167], a[116:119], a[40:43], v[164:167]
  v_mfma_f32_16x16x32_bf16 v[220:223], a[116:119], a[44:47], v[220:223]
  s_waitcnt vmcnt(13) lgkmcnt(10)
  s_barrier
  v_mfma_f32_16x16x32_bf16 v[0:3], a[64:67], a[48:51], v[0:3]
  ds_read_b64_tr_b16 a[116:117], v229 offset:50368
  s_add_u32 m0, s38, 28672
  v_mfma_f32_16x16x32_bf16 v[56:59], a[64:67], a[52:55], v[56:59]
  ds_read_b64_tr_b16 a[118:119], v229 offset:53952
  v_mfma_f32_16x16x32_bf16 v[112:115], a[64:67], a[56:59], v[112:115]
  v_mfma_f32_16x16x32_bf16 v[168:171], a[64:67], a[60:63], v[168:171]
  ds_read_b64_tr_b16 a[64:65], v229 offset:0
  ds_read_b64_tr_b16 a[66:67], v229 offset:3584
  v_mfma_f32_16x16x32_bf16 v[4:7], a[68:71], a[48:51], v[4:7]
  v_mfma_f32_16x16x32_bf16 v[60:63], a[68:71], a[52:55], v[60:63]
  buffer_load_dwordx4 v225, s[8:11], s17 offen lds
  v_mfma_f32_16x16x32_bf16 v[116:119], a[68:71], a[56:59], v[116:119]
  v_mfma_f32_16x16x32_bf16 v[172:175], a[68:71], a[60:63], v[172:175]
  ds_read_b64_tr_b16 a[68:69], v229 offset:32
  ds_read_b64_tr_b16 a[70:71], v229 offset:3616
  v_mfma_f32_16x16x32_bf16 v[8:11], a[72:75], a[48:51], v[8:11]
  v_mfma_f32_16x16x32_bf16 v[64:67], a[72:75], a[52:55], v[64:67]
  v_mfma_f32_16x16x32_bf16 v[120:123], a[72:75], a[56:59], v[120:123]
  buffer_load_dwordx4 v226, s[8:11], s17 offen offset:1024 lds
  v_mfma_f32_16x16x32_bf16 v[176:179], a[72:75], a[60:63], v[176:179]
  ds_read_b64_tr_b16 a[72:73], v229 offset:64
  ds_read_b64_tr_b16 a[74:75], v229 offset:3648
  v_mfma_f32_16x16x32_bf16 v[12:15], a[76:79], a[48:51], v[12:15]
  v_mfma_f32_16x16x32_bf16 v[68:71], a[76:79], a[52:55], v[68:71]
  v_mfma_f32_16x16x32_bf16 v[124:127], a[76:79], a[56:59], v[124:127]
  v_mfma_f32_16x16x32_bf16 v[180:183], a[76:79], a[60:63], v[180:183]
  buffer_load_dwordx4 v227, s[8:11], s17 offen offset:2048 lds
  v_mfma_f32_16x16x32_bf16 v[16:19], a[80:83], a[48:51], v[16:19]
  ds_read_b64_tr_b16 a[76:77], v229 offset:96
  ds_read_b64_tr_b16 a[78:79], v229 offset:3680
  v_mfma_f32_16x16x32_bf16 v[72:75], a[80:83], a[52:55], v[72:75]
  v_mfma_f32_16x16x32_bf16 v[128:131], a[80:83], a[56:59], v[128:131]
  v_mfma_f32_16x16x32_bf16 v[184:187], a[80:83], a[60:63], v[184:187]
  ds_read_b64_tr_b16 a[80:81], v229 offset:128
  ds_read_b64_tr_b16 a[82:83], v229 offset:3712
  v_mfma_f32_16x16x32_bf16 v[20:23], a[84:87], a[48:51], v[20:23]
  s_mov_b32 exec_hi, 0
  buffer_load_dwordx4 v228, s[8:11], s17 offen offset:3072 lds
  s_mov_b32 exec_hi, -1
  v_mfma_f32_16x16x32_bf16 v[76:79], a[84:87], a[52:55], v[76:79]
  v_mfma_f32_16x16x32_bf16 v[132:135], a[84:87], a[56:59], v[132:135]
  v_mfma_f32_16x16x32_bf16 v[188:191], a[84:87], a[60:63], v[188:191]
  ds_read_b64_tr_b16 a[84:85], v229 offset:160
  ds_read_b64_tr_b16 a[86:87], v229 offset:3744
  v_mfma_f32_16x16x32_bf16 v[24:27], a[88:91], a[48:51], v[24:27]
  v_mfma_f32_16x16x32_bf16 v[80:83], a[88:91], a[52:55], v[80:83]
  s_add_u32 s17, s17, 229376
  v_mfma_f32_16x16x32_bf16 v[136:139], a[88:91], a[56:59], v[136:139]
  v_mfma_f32_16x16x32_bf16 v[192:195], a[88:91], a[60:63], v[192:195]
  ds_read_b64_tr_b16 a[88:89], v229 offset:192
  ds_read_b64_tr_b16 a[90:91], v229 offset:3776
  v_mfma_f32_16x16x32_bf16 v[28:31], a[92:95], a[48:51], v[28:31]
  v_mfma_f32_16x16x32_bf16 v[84:87], a[92:95], a[52:55], v[84:87]
  v_mfma_f32_16x16x32_bf16 v[140:143], a[92:95], a[56:59], v[140:143]
  buffer_load_dwordx4 a[32:35], v224, s[4:7], s16 offen offset:0 sc1
  v_mfma_f32_16x16x32_bf16 v[196:199], a[92:95], a[60:63], v[196:199]
  ds_read_b64_tr_b16 a[92:93], v229 offset:7168
  ds_read_b64_tr_b16 a[94:95], v229 offset:10752
  s_waitcnt lgkmcnt(10)
  v_mfma_f32_16x16x32_bf16 v[32:35], a[96:99], a[48:51], v[32:35]
  v_mfma_f32_16x16x32_bf16 v[88:91], a[96:99], a[52:55], v[88:91]
  v_mfma_f32_16x16x32_bf16 v[144:147], a[96:99], a[56:59], v[144:147]
  v_mfma_f32_16x16x32_bf16 v[200:203], a[96:99], a[60:63], v[200:203]
  buffer_load_dwordx4 a[36:39], v224, s[4:7], s16 offen offset:1024 sc1
  v_mfma_f32_16x16x32_bf16 v[36:39], a[100:103], a[48:51], v[36:39]
  ds_read_b64_tr_b16 a[96:97], v229 offset:7200
  ds_read_b64_tr_b16 a[98:99], v229 offset:10784
  v_mfma_f32_16x16x32_bf16 v[92:95], a[100:103], a[52:55], v[92:95]
  v_mfma_f32_16x16x32_bf16 v[148:151], a[100:103], a[56:59], v[148:151]
  v_mfma_f32_16x16x32_bf16 v[204:207], a[100:103], a[60:63], v[204:207]
  ds_read_b64_tr_b16 a[100:101], v229 offset:7232
  ds_read_b64_tr_b16 a[102:103], v229 offset:10816
  v_mfma_f32_16x16x32_bf16 v[40:43], a[104:107], a[48:51], v[40:43]
  buffer_load_dwordx4 a[40:43], v224, s[4:7], s16 offen offset:2048 sc1
  v_mfma_f32_16x16x32_bf16 v[96:99], a[104:107], a[52:55], v[96:99]
  v_mfma_f32_16x16x32_bf16 v[152:155], a[104:107], a[56:59], v[152:155]
  v_mfma_f32_16x16x32_bf16 v[208:211], a[104:107], a[60:63], v[208:211]
  ds_read_b64_tr_b16 a[104:105], v229 offset:7264
  ds_read_b64_tr_b16 a[106:107], v229 offset:10848
  v_mfma_f32_16x16x32_bf16 v[44:47], a[108:111], a[48:51], v[44:47]
  v_mfma_f32_16x16x32_bf16 v[100:103], a[108:111], a[52:55], v[100:103]
  buffer_load_dwordx4 a[44:47], v224, s[4:7], s16 offen offset:3072 sc1
  v_mfma_f32_16x16x32_bf16 v[156:159], a[108:111], a[56:59], v[156:159]
  v_mfma_f32_16x16x32_bf16 v[212:215], a[108:111], a[60:63], v[212:215]
  ds_read_b64_tr_b16 a[108:109], v229 offset:7296
  ds_read_b64_tr_b16 a[110:111], v229 offset:10880
  v_mfma_f32_16x16x32_bf16 v[48:51], a[112:115], a[48:51], v[48:51]
  v_mfma_f32_16x16x32_bf16 v[104:107], a[112:115], a[52:55], v[104:107]
  v_mfma_f32_16x16x32_bf16 v[160:163], a[112:115], a[56:59], v[160:163]
  s_add_u32 s16, s16, 131072
  v_mfma_f32_16x16x32_bf16 v[216:219], a[112:115], a[60:63], v[216:219]
  ds_read_b64_tr_b16 a[112:113], v229 offset:7328
  ds_read_b64_tr_b16 a[114:115], v229 offset:10912
  v_mfma_f32_16x16x32_bf16 v[52:55], a[116:119], a[48:51], v[52:55]
  v_mfma_f32_16x16x32_bf16 v[108:111], a[116:119], a[52:55], v[108:111]
  v_mfma_f32_16x16x32_bf16 v[164:167], a[116:119], a[56:59], v[164:167]
  v_mfma_f32_16x16x32_bf16 v[220:223], a[116:119], a[60:63], v[220:223]
  s_waitcnt vmcnt(13) lgkmcnt(10)
  s_barrier
  v_mfma_f32_16x16x32_bf16 v[0:3], a[64:67], a[0:3], v[0:3]
  ds_read_b64_tr_b16 a[116:117], v229 offset:7360
  s_add_u32 m0, s38, 43008
  v_mfma_f32_16x16x32_bf16 v[56:59], a[64:67], a[4:7], v[56:59]
  ds_read_b64_tr_b16 a[118:119], v229 offset:10944
  v_mfma_f32_16x16x32_bf16 v[112:115], a[64:67], a[8:11], v[112:115]
  v_mfma_f32_16x16x32_bf16 v[168:171], a[64:67], a[12:15], v[168:171]
  ds_read_b64_tr_b16 a[64:65], v229 offset:14336
  ds_read_b64_tr_b16 a[66:67], v229 offset:17920
  v_mfma_f32_16x16x32_bf16 v[4:7], a[68:71], a[0:3], v[4:7]
  v_mfma_f32_16x16x32_bf16 v[60:63], a[68:71], a[4:7], v[60:63]
  buffer_load_dwordx4 v225, s[8:11], s17 offen lds
  v_mfma_f32_16x16x32_bf16 v[116:119], a[68:71], a[8:11], v[116:119]
  v_mfma_f32_16x16x32_bf16 v[172:175], a[68:71], a[12:15], v[172:175]
  ds_read_b64_tr_b16 a[68:69], v229 offset:14368
  ds_read_b64_tr_b16 a[70:71], v229 offset:17952
  v_mfma_f32_16x16x32_bf16 v[8:11], a[72:75], a[0:3], v[8:11]
  v_mfma_f32_16x16x32_bf16 v[64:67], a[72:75], a[4:7], v[64:67]
  v_mfma_f32_16x16x32_bf16 v[120:123], a[72:75], a[8:11], v[120:123]
  buffer_load_dwordx4 v226, s[8:11], s17 offen offset:1024 lds
  v_mfma_f32_16x16x32_bf16 v[176:179], a[72:75], a[12:15], v[176:179]
  ds_read_b64_tr_b16 a[72:73], v229 offset:14400
  ds_read_b64_tr_b16 a[74:75], v229 offset:17984
  v_mfma_f32_16x16x32_bf16 v[12:15], a[76:79], a[0:3], v[12:15]
  v_mfma_f32_16x16x32_bf16 v[68:71], a[76:79], a[4:7], v[68:71]
  v_mfma_f32_16x16x32_bf16 v[124:127], a[76:79], a[8:11], v[124:127]
  v_mfma_f32_16x16x32_bf16 v[180:183], a[76:79], a[12:15], v[180:183]
  buffer_load_dwordx4 v227, s[8:11], s17 offen offset:2048 lds
  v_mfma_f32_16x16x32_bf16 v[16:19], a[80:83], a[0:3], v[16:19]
  ds_read_b64_tr_b16 a[76:77], v229 offset:14432
  ds_read_b64_tr_b16 a[78:79], v229 offset:18016
  v_mfma_f32_16x16x32_bf16 v[72:75], a[80:83], a[4:7], v[72:75]
  v_mfma_f32_16x16x32_bf16 v[128:131], a[80:83], a[8:11], v[128:131]
  v_mfma_f32_16x16x32_bf16 v[184:187], a[80:83], a[12:15], v[184:187]
  ds_read_b64_tr_b16 a[80:81], v229 offset:14464
  ds_read_b64_tr_b16 a[82:83], v229 offset:18048
  v_mfma_f32_16x16x32_bf16 v[20:23], a[84:87], a[0:3], v[20:23]
  s_mov_b32 exec_hi, 0
  buffer_load_dwordx4 v228, s[8:11], s17 offen offset:3072 lds
  s_mov_b32 exec_hi, -1
  v_mfma_f32_16x16x32_bf16 v[76:79], a[84:87], a[4:7], v[76:79]
  v_mfma_f32_16x16x32_bf16 v[132:135], a[84:87], a[8:11], v[132:135]
  v_mfma_f32_16x16x32_bf16 v[188:191], a[84:87], a[12:15], v[188:191]
  ds_read_b64_tr_b16 a[84:85], v229 offset:14496
  ds_read_b64_tr_b16 a[86:87], v229 offset:18080
  v_mfma_f32_16x16x32_bf16 v[24:27], a[88:91], a[0:3], v[24:27]
  v_mfma_f32_16x16x32_bf16 v[80:83], a[88:91], a[4:7], v[80:83]
  s_add_u32 s17, s17, 229376
  v_mfma_f32_16x16x32_bf16 v[136:139], a[88:91], a[8:11], v[136:139]
  v_mfma_f32_16x16x32_bf16 v[192:195], a[88:91], a[12:15], v[192:195]
  ds_read_b64_tr_b16 a[88:89], v229 offset:14528
  ds_read_b64_tr_b16 a[90:91], v229 offset:18112
  v_mfma_f32_16x16x32_bf16 v[28:31], a[92:95], a[0:3], v[28:31]
  v_mfma_f32_16x16x32_bf16 v[84:87], a[92:95], a[4:7], v[84:87]
  v_mfma_f32_16x16x32_bf16 v[140:143], a[92:95], a[8:11], v[140:143]
  buffer_load_dwordx4 a[48:51], v224, s[4:7], s16 offen offset:0 sc1
  v_mfma_f32_16x16x32_bf16 v[196:199], a[92:95], a[12:15], v[196:199]
  ds_read_b64_tr_b16 a[92:93], v229 offset:21504
  ds_read_b64_tr_b16 a[94:95], v229 offset:25088
  s_waitcnt lgkmcnt(10)
  v_mfma_f32_16x16x32_bf16 v[32:35], a[96:99], a[0:3], v[32:35]
  v_mfma_f32_16x16x32_bf16 v[88:91], a[96:99], a[4:7], v[88:91]
  v_mfma_f32_16x16x32_bf16 v[144:147], a[96:99], a[8:11], v[144:147]
  v_mfma_f32_16x16x32_bf16 v[200:203], a[96:99], a[12:15], v[200:203]
  buffer_load_dwordx4 a[52:55], v224, s[4:7], s16 offen offset:1024 sc1
  v_mfma_f32_16x16x32_bf16 v[36:39], a[100:103], a[0:3], v[36:39]
  ds_read_b64_tr_b16 a[96:97], v229 offset:21536
  ds_read_b64_tr_b16 a[98:99], v229 offset:25120
  v_mfma_f32_16x16x32_bf16 v[92:95], a[100:103], a[4:7], v[92:95]
  v_mfma_f32_16x16x32_bf16 v[148:151], a[100:103], a[8:11], v[148:151]
  v_mfma_f32_16x16x32_bf16 v[204:207], a[100:103], a[12:15], v[204:207]
  ds_read_b64_tr_b16 a[100:101], v229 offset:21568
  ds_read_b64_tr_b16 a[102:103], v229 offset:25152
  v_mfma_f32_16x16x32_bf16 v[40:43], a[104:107], a[0:3], v[40:43]
  buffer_load_dwordx4 a[56:59], v224, s[4:7], s16 offen offset:2048 sc1
  v_mfma_f32_16x16x32_bf16 v[96:99], a[104:107], a[4:7], v[96:99]
  v_mfma_f32_16x16x32_bf16 v[152:155], a[104:107], a[8:11], v[152:155]
  v_mfma_f32_16x16x32_bf16 v[208:211], a[104:107], a[12:15], v[208:211]
  ds_read_b64_tr_b16 a[104:105], v229 offset:21600
  ds_read_b64_tr_b16 a[106:107], v229 offset:25184
  v_mfma_f32_16x16x32_bf16 v[44:47], a[108:111], a[0:3], v[44:47]
  v_mfma_f32_16x16x32_bf16 v[100:103], a[108:111], a[4:7], v[100:103]
  buffer_load_dwordx4 a[60:63], v224, s[4:7], s16 offen offset:3072 sc1
  v_mfma_f32_16x16x32_bf16 v[156:159], a[108:111], a[8:11], v[156:159]
  v_mfma_f32_16x16x32_bf16 v[212:215], a[108:111], a[12:15], v[212:215]
  ds_read_b64_tr_b16 a[108:109], v229 offset:21632
  ds_read_b64_tr_b16 a[110:111], v229 offset:25216
  v_mfma_f32_16x16x32_bf16 v[48:51], a[112:115], a[0:3], v[48:51]
  v_mfma_f32_16x16x32_bf16 v[104:107], a[112:115], a[4:7], v[104:107]
  v_mfma_f32_16x16x32_bf16 v[160:163], a[112:115], a[8:11], v[160:163]
  s_add_u32 s16, s16, 131072
  v_mfma_f32_16x16x32_bf16 v[216:219], a[112:115], a[12:15], v[216:219]
  ds_read_b64_tr_b16 a[112:113], v229 offset:21664
  ds_read_b64_tr_b16 a[114:115], v229 offset:25248
  v_mfma_f32_16x16x32_bf16 v[52:55], a[116:119], a[0:3], v[52:55]
  v_mfma_f32_16x16x32_bf16 v[108:111], a[116:119], a[4:7], v[108:111]
  v_mfma_f32_16x16x32_bf16 v[164:167], a[116:119], a[8:11], v[164:167]
  v_mfma_f32_16x16x32_bf16 v[220:223], a[116:119], a[12:15], v[220:223]
  s_waitcnt vmcnt(12) lgkmcnt(10)
  s_barrier
  v_mfma_f32_16x16x32_bf16 v[0:3], a[64:67], a[16:19], v[0:3]
  ds_read_b64_tr_b16 a[116:117], v229 offset:21696
  s_add_u32 m0, s38, 0
  v_mfma_f32_16x16x32_bf16 v[56:59], a[64:67], a[20:23], v[56:59]
  ds_read_b64_tr_b16 a[118:119], v229 offset:25280
  v_mfma_f32_16x16x32_bf16 v[112:115], a[64:67], a[24:27], v[112:115]
  v_mfma_f32_16x16x32_bf16 v[168:171], a[64:67], a[28:31], v[168:171]
  ds_read_b64_tr_b16 a[64:65], v229 offset:28672
  ds_read_b64_tr_b16 a[66:67], v229 offset:32256
  v_mfma_f32_16x16x32_bf16 v[4:7], a[68:71], a[16:19], v[4:7]
  v_mfma_f32_16x16x32_bf16 v[60:63], a[68:71], a[20:23], v[60:63]
  buffer_load_dwordx4 v225, s[8:11], s17 offen lds
  v_mfma_f32_16x16x32_bf16 v[116:119], a[68:71], a[24:27], v[116:119]
  v_mfma_f32_16x16x32_bf16 v[172:175], a[68:71], a[28:31], v[172:175]
  ds_read_b64_tr_b16 a[68:69], v229 offset:28704
  ds_read_b64_tr_b16 a[70:71], v229 offset:32288
  v_mfma_f32_16x16x32_bf16 v[8:11], a[72:75], a[16:19], v[8:11]
  v_mfma_f32_16x16x32_bf16 v[64:67], a[72:75], a[20:23], v[64:67]
  v_mfma_f32_16x16x32_bf16 v[120:123], a[72:75], a[24:27], v[120:123]
  buffer_load_dwordx4 v226, s[8:11], s17 offen offset:1024 lds
  v_mfma_f32_16x16x32_bf16 v[176:179], a[72:75], a[28:31], v[176:179]
  ds_read_b64_tr_b16 a[72:73], v229 offset:28736
  ds_read_b64_tr_b16 a[74:75], v229 offset:32320
  v_mfma_f32_16x16x32_bf16 v[12:15], a[76:79], a[16:19], v[12:15]
  v_mfma_f32_16x16x32_bf16 v[68:71], a[76:79], a[20:23], v[68:71]
  v_mfma_f32_16x16x32_bf16 v[124:127], a[76:79], a[24:27], v[124:127]
  v_mfma_f32_16x16x32_bf16 v[180:183], a[76:79], a[28:31], v[180:183]
  buffer_load_dwordx4 v227, s[8:11], s17 offen offset:2048 lds
  v_mfma_f32_16x16x32_bf16 v[16:19], a[80:83], a[16:19], v[16:19]
  ds_read_b64_tr_b16 a[76:77], v229 offset:28768
  ds_read_b64_tr_b16 a[78:79], v229 offset:32352
  v_mfma_f32_16x16x32_bf16 v[72:75], a[80:83], a[20:23], v[72:75]
  v_mfma_f32_16x16x32_bf16 v[128:131], a[80:83], a[24:27], v[128:131]
  v_mfma_f32_16x16x32_bf16 v[184:187], a[80:83], a[28:31], v[184:187]
  ds_read_b64_tr_b16 a[80:81], v229 offset:28800
  ds_read_b64_tr_b16 a[82:83], v229 offset:32384
  v_mfma_f32_16x16x32_bf16 v[20:23], a[84:87], a[16:19], v[20:23]
  s_mov_b32 exec_hi, 0
  buffer_load_dwordx4 v228, s[8:11], s17 offen offset:3072 lds
  s_mov_b32 exec_hi, -1
  v_mfma_f32_16x16x32_bf16 v[76:79], a[84:87], a[20:23], v[76:79]
  v_mfma_f32_16x16x32_bf16 v[132:135], a[84:87], a[24:27], v[132:135]
  v_mfma_f32_16x16x32_bf16 v[188:191], a[84:87], a[28:31], v[188:191]
  ds_read_b64_tr_b16 a[84:85], v229 offset:28832
  ds_read_b64_tr_b16 a[86:87], v229 offset:32416
  v_mfma_f32_16x16x32_bf16 v[24:27], a[88:91], a[16:19], v[24:27]
  v_mfma_f32_16x16x32_bf16 v[80:83], a[88:91], a[20:23], v[80:83]
  s_add_u32 s17, s17, 229376
  v_mfma_f32_16x16x32_bf16 v[136:139], a[88:91], a[24:27], v[136:139]
  v_mfma_f32_16x16x32_bf16 v[192:195], a[88:91], a[28:31], v[192:195]
  ds_read_b64_tr_b16 a[88:89], v229 offset:28864
  ds_read_b64_tr_b16 a[90:91], v229 offset:32448
  v_mfma_f32_16x16x32_bf16 v[28:31], a[92:95], a[16:19], v[28:31]
  v_mfma_f32_16x16x32_bf16 v[84:87], a[92:95], a[20:23], v[84:87]
  v_mfma_f32_16x16x32_bf16 v[140:143], a[92:95], a[24:27], v[140:143]
  buffer_load_dwordx4 a[0:3], v224, s[4:7], s16 offen offset:0 sc1
  v_mfma_f32_16x16x32_bf16 v[196:199], a[92:95], a[28:31], v[196:199]
  ds_read_b64_tr_b16 a[92:93], v229 offset:35840
  ds_read_b64_tr_b16 a[94:95], v229 offset:39424
  s_waitcnt lgkmcnt(10)
  v_mfma_f32_16x16x32_bf16 v[32:35], a[96:99], a[16:19], v[32:35]
  v_mfma_f32_16x16x32_bf16 v[88:91], a[96:99], a[20:23], v[88:91]
  v_mfma_f32_16x16x32_bf16 v[144:147], a[96:99], a[24:27], v[144:147]
  v_mfma_f32_16x16x32_bf16 v[200:203], a[96:99], a[28:31], v[200:203]
  buffer_load_dwordx4 a[4:7], v224, s[4:7], s16 offen offset:1024 sc1
  v_mfma_f32_16x16x32_bf16 v[36:39], a[100:103], a[16:19], v[36:39]
  ds_read_b64_tr_b16 a[96:97], v229 offset:35872
  ds_read_b64_tr_b16 a[98:99], v229 offset:39456
  v_mfma_f32_16x16x32_bf16 v[92:95], a[100:103], a[20:23], v[92:95]
  v_mfma_f32_16x16x32_bf16 v[148:151], a[100:103], a[24:27], v[148:151]
  v_mfma_f32_16x16x32_bf16 v[204:207], a[100:103], a[28:31], v[204:207]
  ds_read_b64_tr_b16 a[100:101], v229 offset:35904
  ds_read_b64_tr_b16 a[102:103], v229 offset:39488
  v_mfma_f32_16x16x32_bf16 v[40:43], a[104:107], a[16:19], v[40:43]
  buffer_load_dwordx4 a[8:11], v224, s[4:7], s16 offen offset:2048 sc1
  v_mfma_f32_16x16x32_bf16 v[96:99], a[104:107], a[20:23], v[96:99]
  v_mfma_f32_16x16x32_bf16 v[152:155], a[104:107], a[24:27], v[152:155]
  v_mfma_f32_16x16x32_bf16 v[208:211], a[104:107], a[28:31], v[208:211]
  ds_read_b64_tr_b16 a[104:105], v229 offset:35936
  ds_read_b64_tr_b16 a[106:107], v229 offset:39520
  v_mfma_f32_16x16x32_bf16 v[44:47], a[108:111], a[16:19], v[44:47]
  v_mfma_f32_16x16x32_bf16 v[100:103], a[108:111], a[20:23], v[100:103]
  buffer_load_dwordx4 a[12:15], v224, s[4:7], s16 offen offset:3072 sc1
  v_mfma_f32_16x16x32_bf16 v[156:159], a[108:111], a[24:27], v[156:159]
  v_mfma_f32_16x16x32_bf16 v[212:215], a[108:111], a[28:31], v[212:215]
  ds_read_b64_tr_b16 a[108:109], v229 offset:35968
  ds_read_b64_tr_b16 a[110:111], v229 offset:39552
  v_mfma_f32_16x16x32_bf16 v[48:51], a[112:115], a[16:19], v[48:51]
  v_mfma_f32_16x16x32_bf16 v[104:107], a[112:115], a[20:23], v[104:107]
  v_mfma_f32_16x16x32_bf16 v[160:163], a[112:115], a[24:27], v[160:163]
  s_add_u32 s16, s16, 131072
  v_mfma_f32_16x16x32_bf16 v[216:219], a[112:115], a[28:31], v[216:219]
  ds_read_b64_tr_b16 a[112:113], v229 offset:36000
  ds_read_b64_tr_b16 a[114:115], v229 offset:39584
  v_mfma_f32_16x16x32_bf16 v[52:55], a[116:119], a[16:19], v[52:55]
  v_mfma_f32_16x16x32_bf16 v[108:111], a[116:119], a[20:23], v[108:111]
  v_mfma_f32_16x16x32_bf16 v[164:167], a[116:119], a[24:27], v[164:167]
  v_mfma_f32_16x16x32_bf16 v[220:223], a[116:119], a[28:31], v[220:223]
  s_waitcnt vmcnt(12) lgkmcnt(10)
  s_barrier
  v_mfma_f32_16x16x32_bf16 v[0:3], a[64:67], a[32:35], v[0:3]
  ds_read_b64_tr_b16 a[116:117], v229 offset:36032
  s_add_u32 m0, s38, 14336
  v_mfma_f32_16x16x32_bf16 v[56:59], a[64:67], a[36:39], v[56:59]
  ds_read_b64_tr_b16 a[118:119], v229 offset:39616
  v_mfma_f32_16x16x32_bf16 v[112:115], a[64:67], a[40:43], v[112:115]
  v_mfma_f32_16x16x32_bf16 v[168:171], a[64:67], a[44:47], v[168:171]
  ds_read_b64_tr_b16 a[64:65], v229 offset:43008
  ds_read_b64_tr_b16 a[66:67], v229 offset:46592
  v_mfma_f32_16x16x32_bf16 v[4:7], a[68:71], a[32:35], v[4:7]
  v_mfma_f32_16x16x32_bf16 v[60:63], a[68:71], a[36:39], v[60:63]
  buffer_load_dwordx4 v225, s[8:11], s17 offen lds
  v_mfma_f32_16x16x32_bf16 v[116:119], a[68:71], a[40:43], v[116:119]
  v_mfma_f32_16x16x32_bf16 v[172:175], a[68:71], a[44:47], v[172:175]
  ds_read_b64_tr_b16 a[68:69], v229 offset:43040
  ds_read_b64_tr_b16 a[70:71], v229 offset:46624
  v_mfma_f32_16x16x32_bf16 v[8:11], a[72:75], a[32:35], v[8:11]
  v_mfma_f32_16x16x32_bf16 v[64:67], a[72:75], a[36:39], v[64:67]
  v_mfma_f32_16x16x32_bf16 v[120:123], a[72:75], a[40:43], v[120:123]
  buffer_load_dwordx4 v226, s[8:11], s17 offen offset:1024 lds
  v_mfma_f32_16x16x32_bf16 v[176:179], a[72:75], a[44:47], v[176:179]
  ds_read_b64_tr_b16 a[72:73], v229 offset:43072
  ds_read_b64_tr_b16 a[74:75], v229 offset:46656
  v_mfma_f32_16x16x32_bf16 v[12:15], a[76:79], a[32:35], v[12:15]
  v_mfma_f32_16x16x32_bf16 v[68:71], a[76:79], a[36:39], v[68:71]
  v_mfma_f32_16x16x32_bf16 v[124:127], a[76:79], a[40:43], v[124:127]
  v_mfma_f32_16x16x32_bf16 v[180:183], a[76:79], a[44:47], v[180:183]
  buffer_load_dwordx4 v227, s[8:11], s17 offen offset:2048 lds
  v_mfma_f32_16x16x32_bf16 v[16:19], a[80:83], a[32:35], v[16:19]
  ds_read_b64_tr_b16 a[76:77], v229 offset:43104
  ds_read_b64_tr_b16 a[78:79], v229 offset:46688
  v_mfma_f32_16x16x32_bf16 v[72:75], a[80:83], a[36:39], v[72:75]
  v_mfma_f32_16x16x32_bf16 v[128:131], a[80:83], a[40:43], v[128:131]
  v_mfma_f32_16x16x32_bf16 v[184:187], a[80:83], a[44:47], v[184:187]
  ds_read_b64_tr_b16 a[80:81], v229 offset:43136
  ds_read_b64_tr_b16 a[82:83], v229 offset:46720
  v_mfma_f32_16x16x32_bf16 v[20:23], a[84:87], a[32:35], v[20:23]
  s_mov_b32 exec_hi, 0
  buffer_load_dwordx4 v228, s[8:11], s17 offen offset:3072 lds
  s_mov_b32 exec_hi, -1
  v_mfma_f32_16x16x32_bf16 v[76:79], a[84:87], a[36:39], v[76:79]
  v_mfma_f32_16x16x32_bf16 v[132:135], a[84:87], a[40:43], v[132:135]
  v_mfma_f32_16x16x32_bf16 v[188:191], a[84:87], a[44:47], v[188:191]
  ds_read_b64_tr_b16 a[84:85], v229 offset:43168
  ds_read_b64_tr_b16 a[86:87], v229 offset:46752
  v_mfma_f32_16x16x32_bf16 v[24:27], a[88:91], a[32:35], v[24:27]
  v_mfma_f32_16x16x32_bf16 v[80:83], a[88:91], a[36:39], v[80:83]
  s_add_u32 s17, s17, 229376
  v_mfma_f32_16x16x32_bf16 v[136:139], a[88:91], a[40:43], v[136:139]
  v_mfma_f32_16x16x32_bf16 v[192:195], a[88:91], a[44:47], v[192:195]
  ds_read_b64_tr_b16 a[88:89], v229 offset:43200
  ds_read_b64_tr_b16 a[90:91], v229 offset:46784
  v_mfma_f32_16x16x32_bf16 v[28:31], a[92:95], a[32:35], v[28:31]
  v_mfma_f32_16x16x32_bf16 v[84:87], a[92:95], a[36:39], v[84:87]
  v_mfma_f32_16x16x32_bf16 v[140:143], a[92:95], a[40:43], v[140:143]
  buffer_load_dwordx4 a[16:19], v224, s[4:7], s16 offen offset:0 sc1
  v_mfma_f32_16x16x32_bf16 v[196:199], a[92:95], a[44:47], v[196:199]
  ds_read_b64_tr_b16 a[92:93], v229 offset:50176
  ds_read_b64_tr_b16 a[94:95], v229 offset:53760
  s_waitcnt lgkmcnt(10)
  v_mfma_f32_16x16x32_bf16 v[32:35], a[96:99], a[32:35], v[32:35]
  v_mfma_f32_16x16x32_bf16 v[88:91], a[96:99], a[36:39], v[88:91]
  v_mfma_f32_16x16x32_bf16 v[144:147], a[96:99], a[40:43], v[144:147]
  v_mfma_f32_16x16x32_bf16 v[200:203], a[96:99], a[44:47], v[200:203]
  buffer_load_dwordx4 a[20:23], v224, s[4:7], s16 offen offset:1024 sc1
  v_mfma_f32_16x16x32_bf16 v[36:39], a[100:103], a[32:35], v[36:39]
  ds_read_b64_tr_b16 a[96:97], v229 offset:50208
  ds_read_b64_tr_b16 a[98:99], v229 offset:53792
  v_mfma_f32_16x16x32_bf16 v[92:95], a[100:103], a[36:39], v[92:95]
  v_mfma_f32_16x16x32_bf16 v[148:151], a[100:103], a[40:43], v[148:151]
  v_mfma_f32_16x16x32_bf16 v[204:207], a[100:103], a[44:47], v[204:207]
  ds_read_b64_tr_b16 a[100:101], v229 offset:50240
  ds_read_b64_tr_b16 a[102:103], v229 offset:53824
  v_mfma_f32_16x16x32_bf16 v[40:43], a[104:107], a[32:35], v[40:43]
  buffer_load_dwordx4 a[24:27], v224, s[4:7], s16 offen offset:2048 sc1
  v_mfma_f32_16x16x32_bf16 v[96:99], a[104:107], a[36:39], v[96:99]
  v_mfma_f32_16x16x32_bf16 v[152:155], a[104:107], a[40:43], v[152:155]
  v_mfma_f32_16x16x32_bf16 v[208:211], a[104:107], a[44:47], v[208:211]
  ds_read_b64_tr_b16 a[104:105], v229 offset:50272
  ds_read_b64_tr_b16 a[106:107], v229 offset:53856
  v_mfma_f32_16x16x32_bf16 v[44:47], a[108:111], a[32:35], v[44:47]
  v_mfma_f32_16x16x32_bf16 v[100:103], a[108:111], a[36:39], v[100:103]
  buffer_load_dwordx4 a[28:31], v224, s[4:7], s16 offen offset:3072 sc1
  v_mfma_f32_16x16x32_bf16 v[156:159], a[108:111], a[40:43], v[156:159]
  v_mfma_f32_16x16x32_bf16 v[212:215], a[108:111], a[44:47], v[212:215]
  ds_read_b64_tr_b16 a[108:109], v229 offset:50304
  ds_read_b64_tr_b16 a[110:111], v229 offset:53888
  v_mfma_f32_16x16x32_bf16 v[48:51], a[112:115], a[32:35], v[48:51]
  v_mfma_f32_16x16x32_bf16 v[104:107], a[112:115], a[36:39], v[104:107]
  v_mfma_f32_16x16x32_bf16 v[160:163], a[112:115], a[40:43], v[160:163]
  s_add_u32 s16, s16, 131072
  v_mfma_f32_16x16x32_bf16 v[216:219], a[112:115], a[44:47], v[216:219]
  ds_read_b64_tr_b16 a[112:113], v229 offset:50336
  ds_read_b64_tr_b16 a[114:115], v229 offset:53920
  v_mfma_f32_16x16x32_bf16 v[52:55], a[116:119], a[32:35], v[52:55]
  v_mfma_f32_16x16x32_bf16 v[108:111], a[116:119], a[36:39], v[108:111]
  v_mfma_f32_16x16x32_bf16 v[164:167], a[116:119], a[40:43], v[164:167]
  v_mfma_f32_16x16x32_bf16 v[220:223], a[116:119], a[44:47], v[220:223]
  s_waitcnt vmcnt(12) lgkmcnt(10)
  s_barrier
  v_mfma_f32_16x16x32_bf16 v[0:3], a[64:67], a[48:51], v[0:3]
  ds_read_b64_tr_b16 a[116:117], v229 offset:50368
  s_add_u32 m0, s38, 28672
  v_mfma_f32_16x16x32_bf16 v[56:59], a[64:67], a[52:55], v[56:59]
  ds_read_b64_tr_b16 a[118:119], v229 offset:53952
  v_mfma_f32_16x16x32_bf16 v[112:115], a[64:67], a[56:59], v[112:115]
  v_mfma_f32_16x16x32_bf16 v[168:171], a[64:67], a[60:63], v[168:171]
  ds_read_b64_tr_b16 a[64:65], v229 offset:0
  ds_read_b64_tr_b16 a[66:67], v229 offset:3584
  v_mfma_f32_16x16x32_bf16 v[4:7], a[68:71], a[48:51], v[4:7]
  v_mfma_f32_16x16x32_bf16 v[60:63], a[68:71], a[52:55], v[60:63]
  buffer_load_dwordx4 v225, s[8:11], s17 offen lds
  v_mfma_f32_16x16x32_bf16 v[116:119], a[68:71], a[56:59], v[116:119]
  v_mfma_f32_16x16x32_bf16 v[172:175], a[68:71], a[60:63], v[172:175]
  ds_read_b64_tr_b16 a[68:69], v229 offset:32
  ds_read_b64_tr_b16 a[70:71], v229 offset:3616
  v_mfma_f32_16x16x32_bf16 v[8:11], a[72:75], a[48:51], v[8:11]
  v_mfma_f32_16x16x32_bf16 v[64:67], a[72:75], a[52:55], v[64:67]
  v_mfma_f32_16x16x32_bf16 v[120:123], a[72:75], a[56:59], v[120:123]
  buffer_load_dwordx4 v226, s[8:11], s17 offen offset:1024 lds
  v_mfma_f32_16x16x32_bf16 v[176:179], a[72:75], a[60:63], v[176:179]
  ds_read_b64_tr_b16 a[72:73], v229 offset:64
  ds_read_b64_tr_b16 a[74:75], v229 offset:3648
  v_mfma_f32_16x16x32_bf16 v[12:15], a[76:79], a[48:51], v[12:15]
  v_mfma_f32_16x16x32_bf16 v[68:71], a[76:79], a[52:55], v[68:71]
  v_mfma_f32_16x16x32_bf16 v[124:127], a[76:79], a[56:59], v[124:127]
  v_mfma_f32_16x16x32_bf16 v[180:183], a[76:79], a[60:63], v[180:183]
  buffer_load_dwordx4 v227, s[8:11], s17 offen offset:2048 lds
  v_mfma_f32_16x16x32_bf16 v[16:19], a[80:83], a[48:51], v[16:19]
  ds_read_b64_tr_b16 a[76:77], v229 offset:96
  ds_read_b64_tr_b16 a[78:79], v229 offset:3680
  v_mfma_f32_16x16x32_bf16 v[72:75], a[80:83], a[52:55], v[72:75]
  v_mfma_f32_16x16x32_bf16 v[128:131], a[80:83], a[56:59], v[128:131]
  v_mfma_f32_16x16x32_bf16 v[184:187], a[80:83], a[60:63], v[184:187]
  ds_read_b64_tr_b16 a[80:81], v229 offset:128
  ds_read_b64_tr_b16 a[82:83], v229 offset:3712
  v_mfma_f32_16x16x32_bf16 v[20:23], a[84:87], a[48:51], v[20:23]
  s_mov_b32 exec_hi, 0
  buffer_load_dwordx4 v228, s[8:11], s17 offen offset:3072 lds
  s_mov_b32 exec_hi, -1
  v_mfma_f32_16x16x32_bf16 v[76:79], a[84:87], a[52:55], v[76:79]
  v_mfma_f32_16x16x32_bf16 v[132:135], a[84:87], a[56:59], v[132:135]
  v_mfma_f32_16x16x32_bf16 v[188:191], a[84:87], a[60:63], v[188:191]
  ds_read_b64_tr_b16 a[84:85], v229 offset:160
  ds_read_b64_tr_b16 a[86:87], v229 offset:3744
  v_mfma_f32_16x16x32_bf16 v[24:27], a[88:91], a[48:51], v[24:27]
  v_mfma_f32_16x16x32_bf16 v[80:83], a[88:91], a[52:55], v[80:83]
  s_add_u32 s17, s17, 229376
  v_mfma_f32_16x16x32_bf16 v[136:139], a[88:91], a[56:59], v[136:139]
  v_mfma_f32_16x16x32_bf16 v[192:195], a[88:91], a[60:63], v[192:195]
  ds_read_b64_tr_b16 a[88:89], v229 offset:192
  ds_read_b64_tr_b16 a[90:91], v229 offset:3776
  v_mfma_f32_16x16x32_bf16 v[28:31], a[92:95], a[48:51], v[28:31]
  v_mfma_f32_16x16x32_bf16 v[84:87], a[92:95], a[52:55], v[84:87]
  v_mfma_f32_16x16x32_bf16 v[140:143], a[92:95], a[56:59], v[140:143]
  buffer_load_dwordx4 a[32:35], v224, s[4:7], s16 offen offset:0 sc1
  v_mfma_f32_16x16x32_bf16 v[196:199], a[92:95], a[60:63], v[196:199]
  ds_read_b64_tr_b16 a[92:93], v229 offset:7168
  ds_read_b64_tr_b16 a[94:95], v229 offset:10752
  s_waitcnt lgkmcnt(10)
  v_mfma_f32_16x16x32_bf16 v[32:35], a[96:99], a[48:51], v[32:35]
  v_mfma_f32_16x16x32_bf16 v[88:91], a[96:99], a[52:55], v[88:91]
  v_mfma_f32_16x16x32_bf16 v[144:147], a[96:99], a[56:59], v[144:147]
  v_mfma_f32_16x16x32_bf16 v[200:203], a[96:99], a[60:63], v[200:203]
  buffer_load_dwordx4 a[36:39], v224, s[4:7], s16 offen offset:1024 sc1
  v_mfma_f32_16x16x32_bf16 v[36:39], a[100:103], a[48:51], v[36:39]
  ds_read_b64_tr_b16 a[96:97], v229 offset:7200
  ds_read_b64_tr_b16 a[98:99], v229 offset:10784
  v_mfma_f32_16x16x32_bf16 v[92:95], a[100:103], a[52:55], v[92:95]
  v_mfma_f32_16x16x32_bf16 v[148:151], a[100:103], a[56:59], v[148:151]
  v_mfma_f32_16x16x32_bf16 v[204:207], a[100:103], a[60:63], v[204:207]
  ds_read_b64_tr_b16 a[100:101], v229 offset:7232
  ds_read_b64_tr_b16 a[102:103], v229 offset:10816
  v_mfma_f32_16x16x32_bf16 v[40:43], a[104:107], a[48:51], v[40:43]
  buffer_load_dwordx4 a[40:43], v224, s[4:7], s16 offen offset:2048 sc1
  v_mfma_f32_16x16x32_bf16 v[96:99], a[104:107], a[52:55], v[96:99]
  v_mfma_f32_16x16x32_bf16 v[152:155], a[104:107], a[56:59], v[152:155]
  v_mfma_f32_16x16x32_bf16 v[208:211], a[104:107], a[60:63], v[208:211]
  ds_read_b64_tr_b16 a[104:105], v229 offset:7264
  ds_read_b64_tr_b16 a[106:107], v229 offset:10848
  v_mfma_f32_16x16x32_bf16 v[44:47], a[108:111], a[48:51], v[44:47]
  v_mfma_f32_16x16x32_bf16 v[100:103], a[108:111], a[52:55], v[100:103]
  buffer_load_dwordx4 a[44:47], v224, s[4:7], s16 offen offset:3072 sc1
  v_mfma_f32_16x16x32_bf16 v[156:159], a[108:111], a[56:59], v[156:159]
  v_mfma_f32_16x16x32_bf16 v[212:215], a[108:111], a[60:63], v[212:215]
  ds_read_b64_tr_b16 a[108:109], v229 offset:7296
  ds_read_b64_tr_b16 a[110:111], v229 offset:10880
  v_mfma_f32_16x16x32_bf16 v[48:51], a[112:115], a[48:51], v[48:51]
  v_mfma_f32_16x16x32_bf16 v[104:107], a[112:115], a[52:55], v[104:107]
  v_mfma_f32_16x16x32_bf16 v[160:163], a[112:115], a[56:59], v[160:163]
  s_add_u32 s16, s16, 131072
  v_mfma_f32_16x16x32_bf16 v[216:219], a[112:115], a[60:63], v[216:219]
  ds_read_b64_tr_b16 a[112:113], v229 offset:7328
  ds_read_b64_tr_b16 a[114:115], v229 offset:10912
  v_mfma_f32_16x16x32_bf16 v[52:55], a[116:119], a[48:51], v[52:55]
  v_mfma_f32_16x16x32_bf16 v[108:111], a[116:119], a[52:55], v[108:111]
  v_mfma_f32_16x16x32_bf16 v[164:167], a[116:119], a[56:59], v[164:167]
  v_mfma_f32_16x16x32_bf16 v[220:223], a[116:119], a[60:63], v[220:223]
  s_waitcnt vmcnt(12) lgkmcnt(10)
  s_barrier
  v_mfma_f32_16x16x32_bf16 v[0:3], a[64:67], a[0:3], v[0:3]
  ds_read_b64_tr_b16 a[116:117], v229 offset:7360
  s_add_u32 m0, s38, 43008
  v_mfma_f32_16x16x32_bf16 v[56:59], a[64:67], a[4:7], v[56:59]
  ds_read_b64_tr_b16 a[118:119], v229 offset:10944
  v_mfma_f32_16x16x32_bf16 v[112:115], a[64:67], a[8:11], v[112:115]
  v_mfma_f32_16x16x32_bf16 v[168:171], a[64:67], a[12:15], v[168:171]
  ds_read_b64_tr_b16 a[64:65], v229 offset:14336
  ds_read_b64_tr_b16 a[66:67], v229 offset:17920
  v_mfma_f32_16x16x32_bf16 v[4:7], a[68:71], a[0:3], v[4:7]
  buffer_load_dwordx4 v225, s[8:11], s17 offen lds
  v_mfma_f32_16x16x32_bf16 v[60:63], a[68:71], a[4:7], v[60:63]
  v_mfma_f32_16x16x32_bf16 v[116:119], a[68:71], a[8:11], v[116:119]
  v_mfma_f32_16x16x32_bf16 v[172:175], a[68:71], a[12:15], v[172:175]
  ds_read_b64_tr_b16 a[68:69], v229 offset:14368
  ds_read_b64_tr_b16 a[70:71], v229 offset:17952
  v_mfma_f32_16x16x32_bf16 v[8:11], a[72:75], a[0:3], v[8:11]
  v_mfma_f32_16x16x32_bf16 v[64:67], a[72:75], a[4:7], v[64:67]
  buffer_load_dwordx4 v226, s[8:11], s17 offen offset:1024 lds
  v_mfma_f32_16x16x32_bf16 v[120:123], a[72:75], a[8:11], v[120:123]
  v_mfma_f32_16x16x32_bf16 v[176:179], a[72:75], a[12:15], v[176:179]
  ds_read_b64_tr_b16 a[72:73], v229 offset:14400
  ds_read_b64_tr_b16 a[74:75], v229 offset:17984
  v_mfma_f32_16x16x32_bf16 v[12:15], a[76:79], a[0:3], v[12:15]
  v_mfma_f32_16x16x32_bf16 v[68:71], a[76:79], a[4:7], v[68:71]
  buffer_load_dwordx4 v227, s[8:11], s17 offen offset:2048 lds
  v_mfma_f32_16x16x32_bf16 v[124:127], a[76:79], a[8:11], v[124:127]
  v_mfma_f32_16x16x32_bf16 v[180:183], a[76:79], a[12:15], v[180:183]
  ds_read_b64_tr_b16 a[76:77], v229 offset:14432
  ds_read_b64_tr_b16 a[78:79], v229 offset:18016
  v_mfma_f32_16x16x32_bf16 v[16:19], a[80:83], a[0:3], v[16:19]
  v_mfma_f32_16x16x32_bf16 v[72:75], a[80:83], a[4:7], v[72:75]
  v_mfma_f32_16x16x32_bf16 v[128:131], a[80:83], a[8:11], v[128:131]
  s_mov_b32 exec_hi, 0
  buffer_load_dwordx4 v228, s[8:11], s17 offen offset:3072 lds
  s_mov_b32 exec_hi, -1
  v_mfma_f32_16x16x32_bf16 v[184:187], a[80:83], a[12:15], v[184:187]
  ds_read_b64_tr_b16 a[80:81], v229 offset:14464
  ds_read_b64_tr_b16 a[82:83], v229 offset:18048
  v_mfma_f32_16x16x32_bf16 v[20:23], a[84:87], a[0:3], v[20:23]
  v_mfma_f32_16x16x32_bf16 v[76:79], a[84:87], a[4:7], v[76:79]
  v_mfma_f32_16x16x32_bf16 v[132:135], a[84:87], a[8:11], v[132:135]
  s_add_u32 s17, s17, 229376
  v_mfma_f32_16x16x32_bf16 v[188:191], a[84:87], a[12:15], v[188:191]
  ds_read_b64_tr_b16 a[84:85], v229 offset:14496
  ds_read_b64_tr_b16 a[86:87], v229 offset:18080
  v_mfma_f32_16x16x32_bf16 v[24:27], a[88:91], a[0:3], v[24:27]
  v_mfma_f32_16x16x32_bf16 v[80:83], a[88:91], a[4:7], v[80:83]
  v_mfma_f32_16x16x32_bf16 v[136:139], a[88:91], a[8:11], v[136:139]
  v_mfma_f32_16x16x32_bf16 v[192:195], a[88:91], a[12:15], v[192:195]
  buffer_load_dwordx4 a[48:51], v224, s[4:7], s16 offen offset:0 sc1
  v_mfma_f32_16x16x32_bf16 v[28:31], a[92:95], a[0:3], v[28:31]
  ds_read_b64_tr_b16 a[88:89], v229 offset:14528
  ds_read_b64_tr_b16 a[90:91], v229 offset:18112
  v_mfma_f32_16x16x32_bf16 v[84:87], a[92:95], a[4:7], v[84:87]
  v_mfma_f32_16x16x32_bf16 v[140:143], a[92:95], a[8:11], v[140:143]
  v_mfma_f32_16x16x32_bf16 v[196:199], a[92:95], a[12:15], v[196:199]
  ds_read_b64_tr_b16 a[92:93], v229 offset:21504
  ds_read_b64_tr_b16 a[94:95], v229 offset:25088
  s_waitcnt lgkmcnt(10)
  v_mfma_f32_16x16x32_bf16 v[32:35], a[96:99], a[0:3], v[32:35]
  buffer_load_dwordx4 a[52:55], v224, s[4:7], s16 offen offset:1024 sc1
  v_mfma_f32_16x16x32_bf16 v[88:91], a[96:99], a[4:7], v[88:91]
  v_mfma_f32_16x16x32_bf16 v[144:147], a[96:99], a[8:11], v[144:147]
  v_mfma_f32_16x16x32_bf16 v[200:203], a[96:99], a[12:15], v[200:203]
  ds_read_b64_tr_b16 a[96:97], v229 offset:21536
  ds_read_b64_tr_b16 a[98:99], v229 offset:25120
  v_mfma_f32_16x16x32_bf16 v[36:39], a[100:103], a[0:3], v[36:39]
  buffer_load_dwordx4 a[56:59], v224, s[4:7], s16 offen offset:2048 sc1
  v_mfma_f32_16x16x32_bf16 v[92:95], a[100:103], a[4:7], v[92:95]
  v_mfma_f32_16x16x32_bf16 v[148:151], a[100:103], a[8:11], v[148:151]
  v_mfma_f32_16x16x32_bf16 v[204:207], a[100:103], a[12:15], v[204:207]
  ds_read_b64_tr_b16 a[100:101], v229 offset:21568
  ds_read_b64_tr_b16 a[102:103], v229 offset:25152
  v_mfma_f32_16x16x32_bf16 v[40:43], a[104:107], a[0:3], v[40:43]
  v_mfma_f32_16x16x32_bf16 v[96:99], a[104:107], a[4:7], v[96:99]
  buffer_load_dwordx4 a[60:63], v224, s[4:7], s16 offen offset:3072 sc1
  v_mfma_f32_16x16x32_bf16 v[152:155], a[104:107], a[8:11], v[152:155]
  v_mfma_f32_16x16x32_bf16 v[208:211], a[104:107], a[12:15], v[208:211]
  ds_read_b64_tr_b16 a[104:105], v229 offset:21600
  ds_read_b64_tr_b16 a[106:107], v229 offset:25184
  v_mfma_f32_16x16x32_bf16 v[44:47], a[108:111], a[0:3], v[44:47]
  v_mfma_f32_16x16x32_bf16 v[100:103], a[108:111], a[4:7], v[100:103]
  s_add_u32 s16, s16, 131072
  v_mfma_f32_16x16x32_bf16 v[156:159], a[108:111], a[8:11], v[156:159]
  v_mfma_f32_16x16x32_bf16 v[212:215], a[108:111], a[12:15], v[212:215]
  ds_read_b64_tr_b16 a[108:109], v229 offset:21632
  ds_read_b64_tr_b16 a[110:111], v229 offset:25216
  v_mfma_f32_16x16x32_bf16 v[48:51], a[112:115], a[0:3], v[48:51]
  v_mfma_f32_16x16x32_bf16 v[104:107], a[112:115], a[4:7], v[104:107]
  v_mfma_f32_16x16x32_bf16 v[160:163], a[112:115], a[8:11], v[160:163]
  s_getpc_b64 s[52:53]
  L_pc_23:
  s_add_u32 s52, s52, L_k56_seam-L_pc_23
  s_addc_u32 s53, s53, 0
  s_lshr_b32 s56, s2, 3
  s_lshl_b32 s56, s56, 2
  s_add_u32 s56, s56, s3
  s_lshl_b32 s56, s56, 13
  v_lshlrev_b32 v254, 7, v231
  v_add_u32 v254, s56, v254
  v_min_u32 v254, L_code_end-L_k56_seam-4, v254
  v_mov_b32 v255, s53
  v_add_co_u32 v254, vcc, s52, v254
  s_nop 1
  v_addc_co_u32 v255, vcc, 0, v255, vcc
  global_load_dword v251, v[254:255], off
  v_mfma_f32_16x16x32_bf16 v[216:219], a[112:115], a[12:15], v[216:219]
  ds_read_b64_tr_b16 a[112:113], v229 offset:21664
  ds_read_b64_tr_b16 a[114:115], v229 offset:25248
  v_mfma_f32_16x16x32_bf16 v[52:55], a[116:119], a[0:3], v[52:55]
  v_mfma_f32_16x16x32_bf16 v[108:111], a[116:119], a[4:7], v[108:111]
  v_mfma_f32_16x16x32_bf16 v[164:167], a[116:119], a[8:11], v[164:167]
  v_mfma_f32_16x16x32_bf16 v[220:223], a[116:119], a[12:15], v[220:223]
  s_waitcnt vmcnt(13) lgkmcnt(10)
  s_barrier
  s_lshr_b32 s32, s31, 4
  s_mul_i32 s32, s32, 56
  v_mfma_f32_16x16x32_bf16 v[0:3], a[64:67], a[16:19], v[0:3]
  s_and_b32 s33, s31, 15
  s_add_u32 s34, s33, s32
  v_mfma_f32_16x16x32_bf16 v[56:59], a[64:67], a[20:23], v[56:59]
  s_lshl_b32 s98, s34, 17
  s_add_u32 s99, s98, 2097152
  v_mfma_f32_16x16x32_bf16 v[112:115], a[64:67], a[24:27], v[112:115]
  ds_read_b64_tr_b16 a[116:117], v229 offset:21696
  ds_read_b64_tr_b16 a[118:119], v229 offset:25280
  s_add_u32 s100, s98, 4194304
  s_lshr_b32 s34, s33, 1
  v_mfma_f32_16x16x32_bf16 v[168:171], a[64:67], a[28:31], v[168:171]
  s_add_u32 s34, s34, s32
  s_add_u32 s34, s34, 48
  v_mfma_f32_16x16x32_bf16 v[4:7], a[68:71], a[16:19], v[4:7]
  s_lshl_b32 s101, s34, 17
  s_and_b32 s35, s31, 1
  v_mfma_f32_16x16x32_bf16 v[60:63], a[68:71], a[20:23], v[60:63]
  s_lshl_b32 s35, s35, 10
  s_add_u32 s101, s101, s35
  v_mfma_f32_16x16x32_bf16 v[116:119], a[68:71], a[24:27], v[116:119]
  ds_read_b64_tr_b16 a[64:65], v229 offset:28672
  ds_read_b64_tr_b16 a[66:67], v229 offset:32256
  s_lshl_b32 s92, s30, 2
  s_add_u32 s92, s92, s3
  v_mfma_f32_16x16x32_bf16 v[172:175], a[68:71], a[28:31], v[172:175]
  s_lshl_b32 s92, s92, 5
  s_add_u32 s92, s92, s31
  v_mfma_f32_16x16x32_bf16 v[8:11], a[72:75], a[16:19], v[8:11]
  s_lshl_b32 s92, s92, 6
  s_add_u32 s56, s20, 0x80000
  v_mfma_f32_16x16x32_bf16 v[64:67], a[72:75], a[20:23], v[64:67]
  s_addc_u32 s57, s21, 0
  s_mov_b32 s58, 0x30000
  v_mfma_f32_16x16x32_bf16 v[120:123], a[72:75], a[24:27], v[120:123]
  ds_read_b64_tr_b16 a[68:69], v229 offset:28704
  ds_read_b64_tr_b16 a[70:71], v229 offset:32288
  s_mov_b32 s59, 0x20000
  s_and_b32 s28, s2, 1
  v_mfma_f32_16x16x32_bf16 v[176:179], a[72:75], a[28:31], v[176:179]
  s_lshr_b32 s29, s2, 3
  s_bfe_u32 s30, s2, 0x20001
  v_mfma_f32_16x16x32_bf16 v[12:15], a[76:79], a[16:19], v[12:15]
  s_lshl_b32 s30, s30, 2
  s_and_b32 s31, s29, 3
  v_mfma_f32_16x16x32_bf16 v[68:71], a[76:79], a[20:23], v[68:71]
  s_add_u32 s30, s30, s31
  s_lshr_b32 s29, s29, 2
  v_mfma_f32_16x16x32_bf16 v[124:127], a[76:79], a[24:27], v[124:127]
  ds_read_b64_tr_b16 a[72:73], v229 offset:28736
  ds_read_b64_tr_b16 a[74:75], v229 offset:32320
  s_lshl_b32 s31, s29, 1
  s_add_u32 s31, s31, s28
  v_mfma_f32_16x16x32_bf16 v[180:183], a[76:79], a[28:31], v[180:183]
  s_lshl_b32 s94, s30, 1
  s_lshr_b32 s33, s3, 1
  v_mfma_f32_16x16x32_bf16 v[16:19], a[80:83], a[16:19], v[16:19]
  s_add_u32 s94, s94, s33
  s_lshl_b32 s94, s94, 11
  v_mfma_f32_16x16x32_bf16 v[72:75], a[80:83], a[20:23], v[72:75]
  s_lshl_b32 s33, s28, 10
  s_add_u32 s94, s94, s33
  v_mfma_f32_16x16x32_bf16 v[128:131], a[80:83], a[24:27], v[128:131]
  ds_read_b64_tr_b16 a[76:77], v229 offset:28768
  ds_read_b64_tr_b16 a[78:79], v229 offset:32352
  v_and_b32 v246, 15, v231
  v_lshlrev_b32 v246, 6, v246
  v_mfma_f32_16x16x32_bf16 v[184:187], a[80:83], a[28:31], v[184:187]
  s_lshl_b32 s32, s30, 13
  s_lshl_b32 s33, s3, 11
  v_mfma_f32_16x16x32_bf16 v[20:23], a[84:87], a[16:19], v[20:23]
  s_add_u32 s32, s32, s33
  v_lshlrev_b32 v240, 4, v231
  v_mfma_f32_16x16x32_bf16 v[76:79], a[84:87], a[20:23], v[76:79]
  v_add_u32 v240, s32, v240
  v_add_u32 v241, 131072, v240
  v_mfma_f32_16x16x32_bf16 v[132:135], a[84:87], a[24:27], v[132:135]
  ds_read_b64_tr_b16 a[80:81], v229 offset:28800
  ds_read_b64_tr_b16 a[82:83], v229 offset:32384
  v_lshrrev_b32 v232, 3, v231
  v_and_b32 v233, 6, v232
  v_mfma_f32_16x16x32_bf16 v[188:191], a[84:87], a[28:31], v[188:191]
  v_and_b32 v234, 7, v231
  v_xor_b32 v233, v233, v234
  v_mfma_f32_16x16x32_bf16 v[24:27], a[88:91], a[16:19], v[24:27]
  v_lshlrev_b32 v232, 11, v232
  v_lshl_add_u32 v232, v233, 4, v232
  v_mfma_f32_16x16x32_bf16 v[80:83], a[88:91], a[20:23], v[80:83]
  s_lshl_b32 s32, s3, 15
  s_add_u32 s32, s32, 4096
  v_mfma_f32_16x16x32_bf16 v[136:139], a[88:91], a[24:27], v[136:139]
  ds_read_b64_tr_b16 a[84:85], v229 offset:28832
  ds_read_b64_tr_b16 a[86:87], v229 offset:32416
  s_lshl_b32 s33, s31, 7
  s_add_u32 s34, s32, s33
  v_mfma_f32_16x16x32_bf16 v[192:195], a[88:91], a[28:31], v[192:195]
  s_xor_b32 s33, s33, 128
  s_add_u32 s35, s32, s33
  v_mfma_f32_16x16x32_bf16 v[28:31], a[92:95], a[16:19], v[28:31]
  v_add_u32 v225, s34, v232
  v_add_u32 v226, 15360, v225
  v_mfma_f32_16x16x32_bf16 v[84:87], a[92:95], a[20:23], v[84:87]
  v_add_u32 v227, s35, v232
  v_add_u32 v228, 13312, v227
  v_mfma_f32_16x16x32_bf16 v[140:143], a[92:95], a[24:27], v[140:143]
  ds_read_b64_tr_b16 a[88:89], v229 offset:28864
  ds_read_b64_tr_b16 a[90:91], v229 offset:32448
  v_subrev_u32 v227, 2048, v227
  s_lshl_b32 s38, s3, 12
  v_mfma_f32_16x16x32_bf16 v[196:199], a[92:95], a[28:31], v[196:199]
  s_add_u32 s38, s38, 0
  s_mul_i32 s16, s28, 7340032
  s_waitcnt lgkmcnt(10)
  v_mfma_f32_16x16x32_bf16 v[32:35], a[96:99], a[16:19], v[32:35]
  s_mul_i32 s17, s28, 3670016
  s_lshr_b32 s33, s3, 1
  v_mfma_f32_16x16x32_bf16 v[88:91], a[96:99], a[20:23], v[88:91]
  s_mul_i32 s33, s33, 196608
  s_add_u32 s17, s17, s33
  v_mfma_f32_16x16x32_bf16 v[144:147], a[96:99], a[24:27], v[144:147]
  ds_read_b64_tr_b16 a[92:93], v229 offset:35840
  ds_read_b64_tr_b16 a[94:95], v229 offset:39424
  s_add_u32 s97, s17, s33
  s_add_u32 s97, s97, 196608
  v_mfma_f32_16x16x32_bf16 v[200:203], a[96:99], a[28:31], v[200:203]
  s_lshr_b32 s33, s2, 5
  s_mul_i32 s33, s33, 2
  v_mfma_f32_16x16x32_bf16 v[36:39], a[100:103], a[16:19], v[36:39]
  s_bfe_u32 s34, s2, 0x20003
  s_mul_i32 s34, s34, 1
  v_mfma_f32_16x16x32_bf16 v[92:95], a[100:103], a[20:23], v[92:95]
  s_add_u32 s33, s33, s34
  s_and_b32 s33, s33, 7
  v_mfma_f32_16x16x32_bf16 v[148:151], a[100:103], a[24:27], v[148:151]
  ds_read_b64_tr_b16 a[96:97], v229 offset:35872
  ds_read_b64_tr_b16 a[98:99], v229 offset:39456
  s_mov_b32 s95, s17
  s_add_u32 s93, s17, 3670016
  v_mfma_f32_16x16x32_bf16 v[204:207], a[100:103], a[28:31], v[204:207]
  s_mul_i32 s34, s33, 458752
  s_add_u32 s17, s17, s34
  v_mfma_f32_16x16x32_bf16 v[40:43], a[104:107], a[16:19], v[40:43]
  s_mov_b32 s40, s16
  s_lshl_b32 s41, s33, 18
  v_mfma_f32_16x16x32_bf16 v[96:99], a[104:107], a[20:23], v[96:99]
  s_add_u32 s16, s40, s41
  s_sub_u32 s8, s22, 4096
  v_mfma_f32_16x16x32_bf16 v[152:155], a[104:107], a[24:27], v[152:155]
  ds_read_b64_tr_b16 a[100:101], v229 offset:35904
  ds_read_b64_tr_b16 a[102:103], v229 offset:39488
  s_subb_u32 s9, s23, 0
  s_mov_b32 s10, 7344128
  v_mfma_f32_16x16x32_bf16 v[208:211], a[104:107], a[28:31], v[208:211]
  s_add_u32 s4, s20, 0x1600000
  s_addc_u32 s5, s21, 0
  v_mfma_f32_16x16x32_bf16 v[44:47], a[108:111], a[16:19], v[44:47]
  s_mov_b32 s6, 0xe00000
  s_mov_b32 s7, 0x20000
  v_mfma_f32_16x16x32_bf16 v[100:103], a[108:111], a[20:23], v[100:103]
  v_lshrrev_b32 v232, 2, v231
  v_lshlrev_b32 v232, 7, v232
  v_mfma_f32_16x16x32_bf16 v[156:159], a[108:111], a[24:27], v[156:159]
  ds_read_b64_tr_b16 a[104:105], v229 offset:35936
  ds_read_b64_tr_b16 a[106:107], v229 offset:39520
  v_bfe_u32 v233, v231, 3, 2
  v_lshl_add_u32 v232, v233, 5, v232
  v_mfma_f32_16x16x32_bf16 v[212:215], a[108:111], a[28:31], v[212:215]
  v_and_b32 v233, 3, v231
  v_lshl_add_u32 v232, v233, 3, v232
  v_mfma_f32_16x16x32_bf16 v[48:51], a[112:115], a[16:19], v[48:51]
  v_xor_b32 v242, 0, v232
  v_add_u32 v242, 0, v242
  v_mfma_f32_16x16x32_bf16 v[104:107], a[112:115], a[20:23], v[104:107]
  v_xor_b32 v243, 32, v232
  v_add_u32 v243, 0, v243
  v_mfma_f32_16x16x32_bf16 v[160:163], a[112:115], a[24:27], v[160:163]
  ds_read_b64_tr_b16 a[108:109], v229 offset:35968
  ds_read_b64_tr_b16 a[110:111], v229 offset:39552
  v_xor_b32 v244, 64, v232
  v_add_u32 v244, 0, v244
  v_mfma_f32_16x16x32_bf16 v[216:219], a[112:115], a[28:31], v[216:219]
  v_xor_b32 v245, 96, v232
  v_add_u32 v245, 0, v245
  v_mfma_f32_16x16x32_bf16 v[52:55], a[116:119], a[16:19], v[52:55]
  s_mov_b32 s42, 0xbfb8aa3b
  s_mov_b32 s43, 0xbfb8aa3b
  v_mfma_f32_16x16x32_bf16 v[108:111], a[116:119], a[20:23], v[108:111]
  s_mov_b32 s62, 1.0
  s_mov_b32 s63, 1.0
  v_mfma_f32_16x16x32_bf16 v[164:167], a[116:119], a[24:27], v[164:167]
  ds_read_b64_tr_b16 a[112:113], v229 offset:36000
  ds_read_b64_tr_b16 a[114:115], v229 offset:39584
  v_mfma_f32_16x16x32_bf16 v[220:223], a[116:119], a[28:31], v[220:223]
  s_waitcnt vmcnt(5) lgkmcnt(10)
  s_barrier
  v_mfma_f32_16x16x32_bf16 v[0:3], a[64:67], a[32:35], v[0:3]
  ds_read_b64_tr_b16 a[116:117], v229 offset:36032
  ds_read_b64_tr_b16 a[118:119], v229 offset:39616
  v_mfma_f32_16x16x32_bf16 v[56:59], a[64:67], a[36:39], v[56:59]
  s_add_u32 m0, s38, 0
  s_nop 0
  buffer_load_dwordx4 v225, s[8:11], s17 offen lds
  v_mfma_f32_16x16x32_bf16 v[112:115], a[64:67], a[40:43], v[112:115]
  v_mfma_f32_16x16x32_bf16 v[168:171], a[64:67], a[44:47], v[168:171]
  ds_read_b64_tr_b16 a[64:65], v229 offset:43008
  ds_read_b64_tr_b16 a[66:67], v229 offset:46592
  v_mfma_f32_16x16x32_bf16 v[4:7], a[68:71], a[32:35], v[4:7]
  v_mfma_f32_16x16x32_bf16 v[60:63], a[68:71], a[36:39], v[60:63]
  buffer_load_dwordx4 v226, s[8:11], s17 offen offset:1024 lds
  v_mfma_f32_16x16x32_bf16 v[116:119], a[68:71], a[40:43], v[116:119]
  v_mfma_f32_16x16x32_bf16 v[172:175], a[68:71], a[44:47], v[172:175]
  ds_read_b64_tr_b16 a[68:69], v229 offset:43040
  ds_read_b64_tr_b16 a[70:71], v229 offset:46624
  v_mfma_f32_16x16x32_bf16 v[8:11], a[72:75], a[32:35], v[8:11]
  v_mfma_f32_16x16x32_bf16 v[64:67], a[72:75], a[36:39], v[64:67]
  buffer_load_dwordx4 v227, s[8:11], s17 offen offset:2048 lds
  v_mfma_f32_16x16x32_bf16 v[120:123], a[72:75], a[40:43], v[120:123]
  v_mfma_f32_16x16x32_bf16 v[176:179], a[72:75], a[44:47], v[176:179]
  ds_read_b64_tr_b16 a[72:73], v229 offset:50176
  ds_read_b64_tr_b16 a[74:75], v229 offset:53760
  v_mfma_f32_16x16x32_bf16 v[12:15], a[76:79], a[32:35], v[12:15]
  v_mfma_f32_16x16x32_bf16 v[68:71], a[76:79], a[36:39], v[68:71]
  buffer_load_dwordx4 v228, s[8:11], s17 offen offset:3072 lds
  s_add_u32 s17, s17, 458752
  s_cmp_eq_u32 s17, s93
  s_cselect_b32 s17, s95, s17
  v_mfma_f32_16x16x32_bf16 v[124:127], a[76:79], a[40:43], v[124:127]
  v_mfma_f32_16x16x32_bf16 v[180:183], a[76:79], a[44:47], v[180:183]
  ds_read_b64_tr_b16 a[76:77], v229 offset:50208
  ds_read_b64_tr_b16 a[78:79], v229 offset:53792
  v_mfma_f32_16x16x32_bf16 v[16:19], a[80:83], a[32:35], v[16:19]
  v_mfma_f32_16x16x32_bf16 v[72:75], a[80:83], a[36:39], v[72:75]
  s_add_u32 m0, s38, 16384
  s_nop 0
  buffer_load_dwordx4 v225, s[8:11], s17 offen lds
  v_mfma_f32_16x16x32_bf16 v[128:131], a[80:83], a[40:43], v[128:131]
  v_mfma_f32_16x16x32_bf16 v[184:187], a[80:83], a[44:47], v[184:187]
  ds_read_b64_tr_b16 a[80:81], v229 offset:43072
  ds_read_b64_tr_b16 a[82:83], v229 offset:46656
  v_mfma_f32_16x16x32_bf16 v[20:23], a[84:87], a[32:35], v[20:23]
  v_mfma_f32_16x16x32_bf16 v[76:79], a[84:87], a[36:39], v[76:79]
  buffer_load_dwordx4 v226, s[8:11], s17 offen offset:1024 lds
  v_mfma_f32_16x16x32_bf16 v[132:135], a[84:87], a[40:43], v[132:135]
  v_mfma_f32_16x16x32_bf16 v[188:191], a[84:87], a[44:47], v[188:191]
  ds_read_b64_tr_b16 a[84:85], v229 offset:43104
  ds_read_b64_tr_b16 a[86:87], v229 offset:46688
  v_mfma_f32_16x16x32_bf16 v[24:27], a[88:91], a[32:35], v[24:27]
  v_mfma_f32_16x16x32_bf16 v[80:83], a[88:91], a[36:39], v[80:83]
  buffer_load_dwordx4 v227, s[8:11], s17 offen offset:2048 lds
  v_mfma_f32_16x16x32_bf16 v[136:139], a[88:91], a[40:43], v[136:139]
  v_mfma_f32_16x16x32_bf16 v[192:195], a[88:91], a[44:47], v[192:195]
  ds_read_b64_tr_b16 a[88:89], v229 offset:50240
  ds_read_b64_tr_b16 a[90:91], v229 offset:53824
  v_mfma_f32_16x16x32_bf16 v[28:31], a[92:95], a[32:35], v[28:31]
  v_mfma_f32_16x16x32_bf16 v[84:87], a[92:95], a[36:39], v[84:87]
  buffer_load_dwordx4 v228, s[8:11], s17 offen offset:3072 lds
  s_add_u32 s17, s17, 458752
  s_cmp_eq_u32 s17, s93
  s_cselect_b32 s17, s95, s17
  v_mfma_f32_16x16x32_bf16 v[140:143], a[92:95], a[40:43], v[140:143]
  v_mfma_f32_16x16x32_bf16 v[196:199], a[92:95], a[44:47], v[196:199]
  ds_read_b64_tr_b16 a[92:93], v229 offset:50272
  ds_read_b64_tr_b16 a[94:95], v229 offset:53856
  s_waitcnt lgkmcnt(10)
  v_mfma_f32_16x16x32_bf16 v[32:35], a[96:99], a[32:35], v[32:35]
  v_mfma_f32_16x16x32_bf16 v[88:91], a[96:99], a[36:39], v[88:91]
  s_add_u32 m0, s38, 32768
  s_nop 0
  buffer_load_dwordx4 v225, s[8:11], s17 offen lds
  v_mfma_f32_16x16x32_bf16 v[144:147], a[96:99], a[40:43], v[144:147]
  v_mfma_f32_16x16x32_bf16 v[200:203], a[96:99], a[44:47], v[200:203]
  ds_read_b64_tr_b16 a[96:97], v229 offset:43136
  ds_read_b64_tr_b16 a[98:99], v229 offset:46720
  v_mfma_f32_16x16x32_bf16 v[36:39], a[100:103], a[32:35], v[36:39]
  v_mfma_f32_16x16x32_bf16 v[92:95], a[100:103], a[36:39], v[92:95]
  buffer_load_dwordx4 v226, s[8:11], s17 offen offset:1024 lds
  v_mfma_f32_16x16x32_bf16 v[148:151], a[100:103], a[40:43], v[148:151]
  v_mfma_f32_16x16x32_bf16 v[204:207], a[100:103], a[44:47], v[204:207]
  ds_read_b64_tr_b16 a[100:101], v229 offset:43168
  ds_read_b64_tr_b16 a[102:103], v229 offset:46752
  v_mfma_f32_16x16x32_bf16 v[40:43], a[104:107], a[32:35], v[40:43]
  v_mfma_f32_16x16x32_bf16 v[96:99], a[104:107], a[36:39], v[96:99]
  buffer_load_dwordx4 v227, s[8:11], s17 offen offset:2048 lds
  v_mfma_f32_16x16x32_bf16 v[152:155], a[104:107], a[40:43], v[152:155]
  v_mfma_f32_16x16x32_bf16 v[208:211], a[104:107], a[44:47], v[208:211]
  ds_read_b64_tr_b16 a[104:105], v229 offset:43200
  ds_read_b64_tr_b16 a[106:107], v229 offset:46784
  v_mfma_f32_16x16x32_bf16 v[44:47], a[108:111], a[32:35], v[44:47]
  v_mfma_f32_16x16x32_bf16 v[100:103], a[108:111], a[36:39], v[100:103]
  buffer_load_dwordx4 v228, s[8:11], s17 offen offset:3072 lds
  s_add_u32 s17, s17, 458752
  s_cmp_eq_u32 s17, s93
  s_cselect_b32 s17, s95, s17
  v_mfma_f32_16x16x32_bf16 v[156:159], a[108:111], a[40:43], v[156:159]
  v_mfma_f32_16x16x32_bf16 v[212:215], a[108:111], a[44:47], v[212:215]
  ds_read_b64_tr_b16 a[108:109], v229 offset:50304
  ds_read_b64_tr_b16 a[110:111], v229 offset:53888
  v_mfma_f32_16x16x32_bf16 v[48:51], a[112:115], a[32:35], v[48:51]
  v_mfma_f32_16x16x32_bf16 v[104:107], a[112:115], a[36:39], v[104:107]
  v_mfma_f32_16x16x32_bf16 v[160:163], a[112:115], a[40:43], v[160:163]
  v_mfma_f32_16x16x32_bf16 v[216:219], a[112:115], a[44:47], v[216:219]
  ds_read_b64_tr_b16 a[112:113], v229 offset:50336
  ds_read_b64_tr_b16 a[114:115], v229 offset:53920
  v_mfma_f32_16x16x32_bf16 v[52:55], a[116:119], a[32:35], v[52:55]
  v_mfma_f32_16x16x32_bf16 v[108:111], a[116:119], a[36:39], v[108:111]
  v_mfma_f32_16x16x32_bf16 v[164:167], a[116:119], a[40:43], v[164:167]
  v_mfma_f32_16x16x32_bf16 v[220:223], a[116:119], a[44:47], v[220:223]
  s_waitcnt vmcnt(13) lgkmcnt(10)
  s_barrier
  v_mfma_f32_16x16x32_bf16 v[0:3], a[64:67], a[48:51], v[0:3]
  ds_read_b64_tr_b16 a[116:117], v229 offset:50368
  ds_read_b64_tr_b16 a[118:119], v229 offset:53952
  v_mfma_f32_16x16x32_bf16 v[56:59], a[64:67], a[52:55], v[56:59]
  s_add_u32 m0, s38, 49152
  s_nop 0
  buffer_load_dwordx4 v225, s[8:11], s17 offen lds
  v_mfma_f32_16x16x32_bf16 v[112:115], a[64:67], a[56:59], v[112:115]
  v_mfma_f32_16x16x32_bf16 v[168:171], a[64:67], a[60:63], v[168:171]
  v_mfma_f32_16x16x32_bf16 v[4:7], a[68:71], a[48:51], v[4:7]
  v_mfma_f32_16x16x32_bf16 v[60:63], a[68:71], a[52:55], v[60:63]
  buffer_load_dwordx4 v226, s[8:11], s17 offen offset:1024 lds
  v_mfma_f32_16x16x32_bf16 v[116:119], a[68:71], a[56:59], v[116:119]
  v_mfma_f32_16x16x32_bf16 v[172:175], a[68:71], a[60:63], v[172:175]
  v_mfma_f32_16x16x32_bf16 v[28:31], a[72:75], a[48:51], v[28:31]
  v_mfma_f32_16x16x32_bf16 v[84:87], a[72:75], a[52:55], v[84:87]
  buffer_load_dwordx4 v227, s[8:11], s17 offen offset:2048 lds
  v_mfma_f32_16x16x32_bf16 v[140:143], a[72:75], a[56:59], v[140:143]
  v_mfma_f32_16x16x32_bf16 v[196:199], a[72:75], a[60:63], v[196:199]
  v_mfma_f32_16x16x32_bf16 v[32:35], a[76:79], a[48:51], v[32:35]
  v_mfma_f32_16x16x32_bf16 v[88:91], a[76:79], a[52:55], v[88:91]
  buffer_load_dwordx4 v228, s[8:11], s17 offen offset:3072 lds
  s_add_u32 s17, s17, 458752
  s_cmp_eq_u32 s17, s93
  s_cselect_b32 s17, s95, s17
  v_mfma_f32_16x16x32_bf16 v[144:147], a[76:79], a[56:59], v[144:147]
  v_mfma_f32_16x16x32_bf16 v[200:203], a[76:79], a[60:63], v[200:203]
  v_mfma_f32_16x16x32_bf16 v[8:11], a[80:83], a[48:51], v[8:11]
  v_mfma_f32_16x16x32_bf16 v[64:67], a[80:83], a[52:55], v[64:67]
  s_add_u32 m0, s38, 65536
  s_nop 0
  buffer_load_dwordx4 v225, s[8:11], s17 offen lds
  v_mfma_f32_16x16x32_bf16 v[120:123], a[80:83], a[56:59], v[120:123]
  v_mfma_f32_16x16x32_bf16 v[176:179], a[80:83], a[60:63], v[176:179]
  v_mfma_f32_16x16x32_bf16 v[12:15], a[84:87], a[48:51], v[12:15]
  v_mfma_f32_16x16x32_bf16 v[68:71], a[84:87], a[52:55], v[68:71]
  buffer_load_dwordx4 v226, s[8:11], s17 offen offset:1024 lds
  v_mfma_f32_16x16x32_bf16 v[124:127], a[84:87], a[56:59], v[124:127]
  v_mfma_f32_16x16x32_bf16 v[180:183], a[84:87], a[60:63], v[180:183]
  v_mfma_f32_16x16x32_bf16 v[36:39], a[88:91], a[48:51], v[36:39]
  v_mfma_f32_16x16x32_bf16 v[92:95], a[88:91], a[52:55], v[92:95]
  buffer_load_dwordx4 v227, s[8:11], s17 offen offset:2048 lds
  v_mfma_f32_16x16x32_bf16 v[148:151], a[88:91], a[56:59], v[148:151]
  v_mfma_f32_16x16x32_bf16 v[204:207], a[88:91], a[60:63], v[204:207]
  v_mfma_f32_16x16x32_bf16 v[40:43], a[92:95], a[48:51], v[40:43]
  v_mfma_f32_16x16x32_bf16 v[96:99], a[92:95], a[52:55], v[96:99]
  buffer_load_dwordx4 v228, s[8:11], s17 offen offset:3072 lds
  s_add_u32 s17, s17, 458752
  s_cmp_eq_u32 s17, s93
  s_cselect_b32 s17, s95, s17
  v_mfma_f32_16x16x32_bf16 v[152:155], a[92:95], a[56:59], v[152:155]
  v_mfma_f32_16x16x32_bf16 v[208:211], a[92:95], a[60:63], v[208:211]
  s_waitcnt lgkmcnt(10)
  v_mfma_f32_16x16x32_bf16 v[16:19], a[96:99], a[48:51], v[16:19]
  v_mfma_f32_16x16x32_bf16 v[72:75], a[96:99], a[52:55], v[72:75]
  s_add_u32 m0, s38, 81920
  s_nop 0
  buffer_load_dwordx4 v225, s[8:11], s17 offen lds
  v_mfma_f32_16x16x32_bf16 v[128:131], a[96:99], a[56:59], v[128:131]
  v_mfma_f32_16x16x32_bf16 v[184:187], a[96:99], a[60:63], v[184:187]
  s_waitcnt lgkmcnt(8)
  v_mfma_f32_16x16x32_bf16 v[20:23], a[100:103], a[48:51], v[20:23]
  v_mfma_f32_16x16x32_bf16 v[76:79], a[100:103], a[52:55], v[76:79]
  buffer_load_dwordx4 v226, s[8:11], s17 offen offset:1024 lds
  v_mfma_f32_16x16x32_bf16 v[132:135], a[100:103], a[56:59], v[132:135]
  v_mfma_f32_16x16x32_bf16 v[188:191], a[100:103], a[60:63], v[188:191]
  s_waitcnt lgkmcnt(6)
  v_mfma_f32_16x16x32_bf16 v[24:27], a[104:107], a[48:51], v[24:27]
  v_mfma_f32_16x16x32_bf16 v[80:83], a[104:107], a[52:55], v[80:83]
  buffer_load_dwordx4 v227, s[8:11], s17 offen offset:2048 lds
  v_mfma_f32_16x16x32_bf16 v[136:139], a[104:107], a[56:59], v[136:139]
  v_mfma_f32_16x16x32_bf16 v[192:195], a[104:107], a[60:63], v[192:195]
  s_waitcnt lgkmcnt(4)
  v_mfma_f32_16x16x32_bf16 v[44:47], a[108:111], a[48:51], v[44:47]
  v_mfma_f32_16x16x32_bf16 v[100:103], a[108:111], a[52:55], v[100:103]
  buffer_load_dwordx4 v228, s[8:11], s17 offen offset:3072 lds
  s_add_u32 s17, s17, 458752
  s_cmp_eq_u32 s17, s93
  s_cselect_b32 s17, s95, s17
  v_mfma_f32_16x16x32_bf16 v[156:159], a[108:111], a[56:59], v[156:159]
  v_mfma_f32_16x16x32_bf16 v[212:215], a[108:111], a[60:63], v[212:215]
  s_waitcnt lgkmcnt(2)
  v_mfma_f32_16x16x32_bf16 v[48:51], a[112:115], a[48:51], v[48:51]
  v_mfma_f32_16x16x32_bf16 v[104:107], a[112:115], a[52:55], v[104:107]
  v_mfma_f32_16x16x32_bf16 v[160:163], a[112:115], a[56:59], v[160:163]
  v_mfma_f32_16x16x32_bf16 v[216:219], a[112:115], a[60:63], v[216:219]
  s_waitcnt lgkmcnt(0)
  v_mfma_f32_16x16x32_bf16 v[52:55], a[116:119], a[48:51], v[52:55]
  v_mfma_f32_16x16x32_bf16 v[108:111], a[116:119], a[52:55], v[108:111]
  v_mfma_f32_16x16x32_bf16 v[164:167], a[116:119], a[56:59], v[164:167]
  v_mfma_f32_16x16x32_bf16 v[220:223], a[116:119], a[60:63], v[220:223]
  s_nop 7
  s_nop 1
L_k56_seam:
  v_pk_mul_f32 v[232:233], v[0:1], s[42:43]
  v_pk_mul_f32 v[234:235], v[2:3], s[42:43]
  v_exp_f32 v232, v232
  v_exp_f32 v233, v233
  v_exp_f32 v234, v234
  v_exp_f32 v235, v235
  v_pk_add_f32 v[232:233], v[232:233], s[62:63]
  v_pk_add_f32 v[234:235], v[234:235], s[62:63]
  v_rcp_f32 v232, v232
  v_rcp_f32 v233, v233
  v_rcp_f32 v234, v234
  v_rcp_f32 v235, v235
  v_pk_mul_f32 v[232:233], v[232:233], v[28:29]
  v_pk_mul_f32 v[234:235], v[234:235], v[30:31]
  v_cvt_pk_bf16_f32 v0, v232, v233
  v_cvt_pk_bf16_f32 v1, v234, v235
  v_pk_mul_f32 v[236:237], v[4:5], s[42:43]
  v_pk_mul_f32 v[238:239], v[6:7], s[42:43]
  v_exp_f32 v236, v236
  v_exp_f32 v237, v237
  v_exp_f32 v238, v238
  v_exp_f32 v239, v239
  v_pk_add_f32 v[236:237], v[236:237], s[62:63]
  v_pk_add_f32 v[238:239], v[238:239], s[62:63]
  v_rcp_f32 v236, v236
  v_rcp_f32 v237, v237
  v_rcp_f32 v238, v238
  v_rcp_f32 v239, v239
  v_pk_mul_f32 v[236:237], v[236:237], v[32:33]
  v_pk_mul_f32 v[238:239], v[238:239], v[34:35]
  v_cvt_pk_bf16_f32 v2, v236, v237
  v_cvt_pk_bf16_f32 v3, v238, v239
  buffer_store_dwordx4 v[0:3], v224, s[12:15], s98 offen offset:0 sc1
  v_pk_mul_f32 v[232:233], v[56:57], s[42:43]
  v_pk_mul_f32 v[234:235], v[58:59], s[42:43]
  v_exp_f32 v232, v232
  v_exp_f32 v233, v233
  v_exp_f32 v234, v234
  v_exp_f32 v235, v235
  v_pk_add_f32 v[232:233], v[232:233], s[62:63]
  v_pk_add_f32 v[234:235], v[234:235], s[62:63]
  v_rcp_f32 v232, v232
  v_rcp_f32 v233, v233
  v_rcp_f32 v234, v234
  v_rcp_f32 v235, v235
  v_pk_mul_f32 v[232:233], v[232:233], v[84:85]
  v_pk_mul_f32 v[234:235], v[234:235], v[86:87]
  v_cvt_pk_bf16_f32 v56, v232, v233
  v_cvt_pk_bf16_f32 v57, v234, v235
  v_pk_mul_f32 v[236:237], v[60:61], s[42:43]
  v_pk_mul_f32 v[238:239], v[62:63], s[42:43]
  v_exp_f32 v236, v236
  v_exp_f32 v237, v237
  v_exp_f32 v238, v238
  v_exp_f32 v239, v239
  v_pk_add_f32 v[236:237], v[236:237], s[62:63]
  v_pk_add_f32 v[238:239], v[238:239], s[62:63]
  v_rcp_f32 v236, v236
  v_rcp_f32 v237, v237
  v_rcp_f32 v238, v238
  v_rcp_f32 v239, v239
  v_pk_mul_f32 v[236:237], v[236:237], v[88:89]
  v_pk_mul_f32 v[238:239], v[238:239], v[90:91]
  v_cvt_pk_bf16_f32 v58, v236, v237
  v_cvt_pk_bf16_f32 v59, v238, v239
  buffer_store_dwordx4 v[56:59], v224, s[12:15], s98 offen offset:1024 sc1
  v_pk_mul_f32 v[232:233], v[112:113], s[42:43]
  v_pk_mul_f32 v[234:235], v[114:115], s[42:43]
  v_exp_f32 v232, v232
  v_exp_f32 v233, v233
  v_exp_f32 v234, v234
  v_exp_f32 v235, v235
  v_pk_add_f32 v[232:233], v[232:233], s[62:63]
  v_pk_add_f32 v[234:235], v[234:235], s[62:63]
  v_rcp_f32 v232, v232
  v_rcp_f32 v233, v233
  v_rcp_f32 v234, v234
  v_rcp_f32 v235, v235
  v_pk_mul_f32 v[232:233], v[232:233], v[140:141]
  v_pk_mul_f32 v[234:235], v[234:235], v[142:143]
  v_cvt_pk_bf16_f32 v112, v232, v233
  v_cvt_pk_bf16_f32 v113, v234, v235
  v_pk_mul_f32 v[236:237], v[116:117], s[42:43]
  v_pk_mul_f32 v[238:239], v[118:119], s[42:43]
  v_exp_f32 v236, v236
  v_exp_f32 v237, v237
  v_exp_f32 v238, v238
  v_exp_f32 v239, v239
  v_pk_add_f32 v[236:237], v[236:237], s[62:63]
  v_pk_add_f32 v[238:239], v[238:239], s[62:63]
  v_rcp_f32 v236, v236
  v_rcp_f32 v237, v237
  v_rcp_f32 v238, v238
  v_rcp_f32 v239, v239
  v_pk_mul_f32 v[236:237], v[236:237], v[144:145]
  v_pk_mul_f32 v[238:239], v[238:239], v[146:147]
  v_cvt_pk_bf16_f32 v114, v236, v237
  v_cvt_pk_bf16_f32 v115, v238, v239
  buffer_store_dwordx4 v[112:115], v224, s[12:15], s98 offen offset:2048 sc1
  v_pk_mul_f32 v[232:233], v[168:169], s[42:43]
  v_pk_mul_f32 v[234:235], v[170:171], s[42:43]
  v_exp_f32 v232, v232
  v_exp_f32 v233, v233
  v_exp_f32 v234, v234
  v_exp_f32 v235, v235
  v_pk_add_f32 v[232:233], v[232:233], s[62:63]
  v_pk_add_f32 v[234:235], v[234:235], s[62:63]
  v_rcp_f32 v232, v232
  v_rcp_f32 v233, v233
  v_rcp_f32 v234, v234
  v_rcp_f32 v235, v235
  v_pk_mul_f32 v[232:233], v[232:233], v[196:197]
  v_pk_mul_f32 v[234:235], v[234:235], v[198:199]
  v_cvt_pk_bf16_f32 v168, v232, v233
  v_cvt_pk_bf16_f32 v169, v234, v235
  v_pk_mul_f32 v[236:237], v[172:173], s[42:43]
  v_pk_mul_f32 v[238:239], v[174:175], s[42:43]
  v_exp_f32 v236, v236
  v_exp_f32 v237, v237
  v_exp_f32 v238, v238
  v_exp_f32 v239, v239
  v_pk_add_f32 v[236:237], v[236:237], s[62:63]
  v_pk_add_f32 v[238:239], v[238:239], s[62:63]
  v_rcp_f32 v236, v236
  v_rcp_f32 v237, v237
  v_rcp_f32 v238, v238
  v_rcp_f32 v239, v239
  v_pk_mul_f32 v[236:237], v[236:237], v[200:201]
  v_pk_mul_f32 v[238:239], v[238:239], v[202:203]
  v_cvt_pk_bf16_f32 v170, v236, v237
  v_cvt_pk_bf16_f32 v171, v238, v239
  buffer_store_dwordx4 v[168:171], v224, s[12:15], s98 offen offset:3072 sc1
  v_pk_mul_f32 v[232:233], v[8:9], s[42:43]
  v_pk_mul_f32 v[234:235], v[10:11], s[42:43]
  v_exp_f32 v232, v232
  v_exp_f32 v233, v233
  v_exp_f32 v234, v234
  v_exp_f32 v235, v235
  v_pk_add_f32 v[232:233], v[232:233], s[62:63]
  v_pk_add_f32 v[234:235], v[234:235], s[62:63]
  v_rcp_f32 v232, v232
  v_rcp_f32 v233, v233
  v_rcp_f32 v234, v234
  v_rcp_f32 v235, v235
  v_pk_mul_f32 v[232:233], v[232:233], v[36:37]
  v_pk_mul_f32 v[234:235], v[234:235], v[38:39]
  v_cvt_pk_bf16_f32 v4, v232, v233
  v_cvt_pk_bf16_f32 v5, v234, v235
  v_pk_mul_f32 v[236:237], v[12:13], s[42:43]
  v_pk_mul_f32 v[238:239], v[14:15], s[42:43]
  v_exp_f32 v236, v236
  v_exp_f32 v237, v237
  v_exp_f32 v238, v238
  v_exp_f32 v239, v239
  v_pk_add_f32 v[236:237], v[236:237], s[62:63]
  v_pk_add_f32 v[238:239], v[238:239], s[62:63]
  v_rcp_f32 v236, v236
  v_rcp_f32 v237, v237
  v_rcp_f32 v238, v238
  v_rcp_f32 v239, v239
  v_pk_mul_f32 v[236:237], v[236:237], v[40:41]
  v_pk_mul_f32 v[238:239], v[238:239], v[42:43]
  v_cvt_pk_bf16_f32 v6, v236, v237
  v_cvt_pk_bf16_f32 v7, v238, v239
  v_pk_mul_f32 v[232:233], v[64:65], s[42:43]
  v_pk_mul_f32 v[234:235], v[66:67], s[42:43]
  v_exp_f32 v232, v232
  v_exp_f32 v233, v233
  v_exp_f32 v234, v234
  v_exp_f32 v235, v235
  v_pk_add_f32 v[232:233], v[232:233], s[62:63]
  v_pk_add_f32 v[234:235], v[234:235], s[62:63]
  v_rcp_f32 v232, v232
  v_rcp_f32 v233, v233
  v_rcp_f32 v234, v234
  v_rcp_f32 v235, v235
  v_pk_mul_f32 v[232:233], v[232:233], v[92:93]
  v_pk_mul_f32 v[234:235], v[234:235], v[94:95]
  v_cvt_pk_bf16_f32 v60, v232, v233
  v_cvt_pk_bf16_f32 v61, v234, v235
  v_pk_mul_f32 v[236:237], v[68:69], s[42:43]
  v_pk_mul_f32 v[238:239], v[70:71], s[42:43]
  v_exp_f32 v236, v236
  v_exp_f32 v237, v237
  v_exp_f32 v238, v238
  v_exp_f32 v239, v239
  v_pk_add_f32 v[236:237], v[236:237], s[62:63]
  v_pk_add_f32 v[238:239], v[238:239], s[62:63]
  v_rcp_f32 v236, v236
  v_rcp_f32 v237, v237
  v_rcp_f32 v238, v238
  v_rcp_f32 v239, v239
  v_pk_mul_f32 v[236:237], v[236:237], v[96:97]
  v_pk_mul_f32 v[238:239], v[238:239], v[98:99]
  v_cvt_pk_bf16_f32 v62, v236, v237
  v_cvt_pk_bf16_f32 v63, v238, v239
  v_pk_mul_f32 v[232:233], v[120:121], s[42:43]
  v_pk_mul_f32 v[234:235], v[122:123], s[42:43]
  v_exp_f32 v232, v232
  v_exp_f32 v233, v233
  v_exp_f32 v234, v234
  v_exp_f32 v235, v235
  v_pk_add_f32 v[232:233], v[232:233], s[62:63]
  v_pk_add_f32 v[234:235], v[234:235], s[62:63]
  v_rcp_f32 v232, v232
  v_rcp_f32 v233, v233
  v_rcp_f32 v234, v234
  v_rcp_f32 v235, v235
  v_pk_mul_f32 v[232:233], v[232:233], v[148:149]
  v_pk_mul_f32 v[234:235], v[234:235], v[150:151]
  v_cvt_pk_bf16_f32 v116, v232, v233
  v_cvt_pk_bf16_f32 v117, v234, v235
  v_pk_mul_f32 v[236:237], v[124:125], s[42:43]
  v_pk_mul_f32 v[238:239], v[126:127], s[42:43]
  v_exp_f32 v236, v236
  v_exp_f32 v237, v237
  v_exp_f32 v238, v238
  v_exp_f32 v239, v239
  v_pk_add_f32 v[236:237], v[236:237], s[62:63]
  v_pk_add_f32 v[238:239], v[238:239], s[62:63]
  v_rcp_f32 v236, v236
  v_rcp_f32 v237, v237
  v_rcp_f32 v238, v238
  v_rcp_f32 v239, v239
  v_pk_mul_f32 v[236:237], v[236:237], v[152:153]
  v_pk_mul_f32 v[238:239], v[238:239], v[154:155]
  v_cvt_pk_bf16_f32 v118, v236, v237
  v_cvt_pk_bf16_f32 v119, v238, v239
  s_waitcnt vmcnt(0)
  s_mov_b64 exec, 1
  buffer_store_dword v248, v250, s[56:59], s92 offen sc1
  s_mov_b64 exec, -1
  s_add_u32 s92, s92, 65536
  s_barrier
  v_pk_mul_f32 v[232:233], v[176:177], s[42:43]
  v_pk_mul_f32 v[234:235], v[178:179], s[42:43]
  v_exp_f32 v232, v232
  v_exp_f32 v233, v233
  v_exp_f32 v234, v234
  v_exp_f32 v235, v235
  v_pk_add_f32 v[232:233], v[232:233], s[62:63]
  v_pk_add_f32 v[234:235], v[234:235], s[62:63]
  s_add_u32 m0, s38, 98304
  s_nop 0
  buffer_load_dwordx4 v225, s[8:11], s17 offen lds
  v_rcp_f32 v232, v232
  v_rcp_f32 v233, v233
  v_rcp_f32 v234, v234
  v_rcp_f32 v235, v235
  v_pk_mul_f32 v[232:233], v[232:233], v[204:205]
  v_pk_mul_f32 v[234:235], v[234:235], v[206:207]
  v_cvt_pk_bf16_f32 v172, v232, v233
  v_cvt_pk_bf16_f32 v173, v234, v235
  buffer_load_dwordx4 v226, s[8:11], s17 offen offset:1024 lds
  v_pk_mul_f32 v[236:237], v[180:181], s[42:43]
  v_pk_mul_f32 v[238:239], v[182:183], s[42:43]
  v_exp_f32 v236, v236
  v_exp_f32 v237, v237
  v_exp_f32 v238, v238
  v_exp_f32 v239, v239
  v_pk_add_f32 v[236:237], v[236:237], s[62:63]
  v_pk_add_f32 v[238:239], v[238:239], s[62:63]
  buffer_load_dwordx4 v227, s[8:11], s17 offen offset:2048 lds
  v_rcp_f32 v236, v236
  v_rcp_f32 v237, v237
  v_rcp_f32 v238, v238
  v_rcp_f32 v239, v239
  v_pk_mul_f32 v[236:237], v[236:237], v[208:209]
  v_pk_mul_f32 v[238:239], v[238:239], v[210:211]
  v_cvt_pk_bf16_f32 v174, v236, v237
  v_cvt_pk_bf16_f32 v175, v238, v239
  buffer_load_dwordx4 v228, s[8:11], s17 offen offset:3072 lds
  s_add_u32 s17, s17, 458752
  s_cmp_eq_u32 s17, s93
  s_cselect_b32 s17, s95, s17
  v_pk_mul_f32 v[232:233], v[16:17], s[42:43]
  v_pk_mul_f32 v[234:235], v[18:19], s[42:43]
  v_exp_f32 v232, v232
  v_exp_f32 v233, v233
  v_exp_f32 v234, v234
  v_exp_f32 v235, v235
  v_pk_add_f32 v[232:233], v[232:233], s[62:63]
  v_pk_add_f32 v[234:235], v[234:235], s[62:63]
  s_add_u32 m0, s38, 114688
  s_nop 0
  buffer_load_dwordx4 v225, s[8:11], s17 offen lds
  v_rcp_f32 v232, v232
  v_rcp_f32 v233, v233
  v_rcp_f32 v234, v234
  v_rcp_f32 v235, v235
  v_pk_mul_f32 v[232:233], v[232:233], v[44:45]
  v_pk_mul_f32 v[234:235], v[234:235], v[46:47]
  v_cvt_pk_bf16_f32 v8, v232, v233
  v_cvt_pk_bf16_f32 v9, v234, v235
  buffer_load_dwordx4 v226, s[8:11], s17 offen offset:1024 lds
  v_pk_mul_f32 v[236:237], v[20:21], s[42:43]
  v_pk_mul_f32 v[238:239], v[22:23], s[42:43]
  v_exp_f32 v236, v236
  v_exp_f32 v237, v237
  v_exp_f32 v238, v238
  v_exp_f32 v239, v239
  v_pk_add_f32 v[236:237], v[236:237], s[62:63]
  v_pk_add_f32 v[238:239], v[238:239], s[62:63]
  buffer_load_dwordx4 v227, s[8:11], s17 offen offset:2048 lds
  v_rcp_f32 v236, v236
  v_rcp_f32 v237, v237
  v_rcp_f32 v238, v238
  v_rcp_f32 v239, v239
  v_pk_mul_f32 v[236:237], v[236:237], v[48:49]
  v_pk_mul_f32 v[238:239], v[238:239], v[50:51]
  v_cvt_pk_bf16_f32 v10, v236, v237
  v_cvt_pk_bf16_f32 v11, v238, v239
  buffer_load_dwordx4 v228, s[8:11], s17 offen offset:3072 lds
  s_add_u32 s17, s17, 458752
  s_cmp_eq_u32 s17, s93
  s_cselect_b32 s17, s95, s17
  s_add_u32 s17, s17, 65536
  s_add_u32 s93, s93, 65536
  s_add_u32 s95, s95, 65536
  v_pk_mul_f32 v[232:233], v[72:73], s[42:43]
  v_pk_mul_f32 v[234:235], v[74:75], s[42:43]
  v_exp_f32 v232, v232
  v_exp_f32 v233, v233
  v_exp_f32 v234, v234
  v_exp_f32 v235, v235
  v_pk_add_f32 v[232:233], v[232:233], s[62:63]
  v_pk_add_f32 v[234:235], v[234:235], s[62:63]
  s_add_u32 m0, s38, 131072
  s_nop 0
  buffer_load_dwordx4 v225, s[8:11], s17 offen lds
  v_rcp_f32 v232, v232
  v_rcp_f32 v233, v233
  v_rcp_f32 v234, v234
  v_rcp_f32 v235, v235
  v_pk_mul_f32 v[232:233], v[232:233], v[100:101]
  v_pk_mul_f32 v[234:235], v[234:235], v[102:103]
  v_cvt_pk_bf16_f32 v64, v232, v233
  v_cvt_pk_bf16_f32 v65, v234, v235
  buffer_load_dwordx4 v226, s[8:11], s17 offen offset:1024 lds
  v_pk_mul_f32 v[236:237], v[76:77], s[42:43]
  v_pk_mul_f32 v[238:239], v[78:79], s[42:43]
  v_exp_f32 v236, v236
  v_exp_f32 v237, v237
  v_exp_f32 v238, v238
  v_exp_f32 v239, v239
  v_pk_add_f32 v[236:237], v[236:237], s[62:63]
  v_pk_add_f32 v[238:239], v[238:239], s[62:63]
  buffer_load_dwordx4 v227, s[8:11], s17 offen offset:2048 lds
  v_rcp_f32 v236, v236
  v_rcp_f32 v237, v237
  v_rcp_f32 v238, v238
  v_rcp_f32 v239, v239
  v_pk_mul_f32 v[236:237], v[236:237], v[104:105]
  v_pk_mul_f32 v[238:239], v[238:239], v[106:107]
  v_cvt_pk_bf16_f32 v66, v236, v237
  v_cvt_pk_bf16_f32 v67, v238, v239
  buffer_load_dwordx4 v228, s[8:11], s17 offen offset:3072 lds
  s_add_u32 s17, s17, 458752
  s_cmp_eq_u32 s17, s93
  s_cselect_b32 s17, s95, s17
  v_pk_mul_f32 v[232:233], v[128:129], s[42:43]
  v_pk_mul_f32 v[234:235], v[130:131], s[42:43]
  v_exp_f32 v232, v232
  v_exp_f32 v233, v233
  v_exp_f32 v234, v234
  v_exp_f32 v235, v235
  v_pk_add_f32 v[232:233], v[232:233], s[62:63]
  v_pk_add_f32 v[234:235], v[234:235], s[62:63]
  v_rcp_f32 v232, v232
  v_rcp_f32 v233, v233
  v_rcp_f32 v234, v234
  v_rcp_f32 v235, v235
  v_pk_mul_f32 v[232:233], v[232:233], v[156:157]
  v_pk_mul_f32 v[234:235], v[234:235], v[158:159]
  v_cvt_pk_bf16_f32 v120, v232, v233
  v_cvt_pk_bf16_f32 v121, v234, v235
  v_pk_mul_f32 v[236:237], v[132:133], s[42:43]
  v_pk_mul_f32 v[238:239], v[134:135], s[42:43]
  v_exp_f32 v236, v236
  v_exp_f32 v237, v237
  v_exp_f32 v238, v238
  v_exp_f32 v239, v239
  v_pk_add_f32 v[236:237], v[236:237], s[62:63]
  v_pk_add_f32 v[238:239], v[238:239], s[62:63]
  v_rcp_f32 v236, v236
  v_rcp_f32 v237, v237
  v_rcp_f32 v238, v238
  v_rcp_f32 v239, v239
  v_pk_mul_f32 v[236:237], v[236:237], v[160:161]
  v_pk_mul_f32 v[238:239], v[238:239], v[162:163]
  v_cvt_pk_bf16_f32 v122, v236, v237
  v_cvt_pk_bf16_f32 v123, v238, v239
  v_pk_mul_f32 v[232:233], v[184:185], s[42:43]
  v_pk_mul_f32 v[234:235], v[186:187], s[42:43]
  v_exp_f32 v232, v232
  v_exp_f32 v233, v233
  v_exp_f32 v234, v234
  v_exp_f32 v235, v235
  v_pk_add_f32 v[232:233], v[232:233], s[62:63]
  v_pk_add_f32 v[234:235], v[234:235], s[62:63]
  v_rcp_f32 v232, v232
  v_rcp_f32 v233, v233
  v_rcp_f32 v234, v234
  v_rcp_f32 v235, v235
  v_pk_mul_f32 v[232:233], v[232:233], v[212:213]
  v_pk_mul_f32 v[234:235], v[234:235], v[214:215]
  v_cvt_pk_bf16_f32 v176, v232, v233
  v_cvt_pk_bf16_f32 v177, v234, v235
  v_pk_mul_f32 v[236:237], v[188:189], s[42:43]
  v_pk_mul_f32 v[238:239], v[190:191], s[42:43]
  v_exp_f32 v236, v236
  v_exp_f32 v237, v237
  v_exp_f32 v238, v238
  v_exp_f32 v239, v239
  v_pk_add_f32 v[236:237], v[236:237], s[62:63]
  v_pk_add_f32 v[238:239], v[238:239], s[62:63]
  v_rcp_f32 v236, v236
  v_rcp_f32 v237, v237
  v_rcp_f32 v238, v238
  v_rcp_f32 v239, v239
  v_pk_mul_f32 v[236:237], v[236:237], v[216:217]
  v_pk_mul_f32 v[238:239], v[238:239], v[218:219]
  v_cvt_pk_bf16_f32 v178, v236, v237
  v_cvt_pk_bf16_f32 v179, v238, v239
  buffer_load_dword v247, v246, s[56:59], s94 offen sc1
  buffer_store_dwordx4 v[4:7], v224, s[12:15], s99 offen offset:0 sc1
  buffer_store_dwordx4 v[60:63], v224, s[12:15], s99 offen offset:1024 sc1
  buffer_store_dwordx4 v[116:119], v224, s[12:15], s99 offen offset:2048 sc1
  buffer_store_dwordx4 v[172:175], v224, s[12:15], s99 offen offset:3072 sc1
  v_pk_mul_f32 v[232:233], v[24:25], s[42:43]
  v_pk_mul_f32 v[234:235], v[26:27], s[42:43]
  v_exp_f32 v232, v232
  v_exp_f32 v233, v233
  v_exp_f32 v234, v234
  v_exp_f32 v235, v235
  v_pk_add_f32 v[232:233], v[232:233], s[62:63]
  v_pk_add_f32 v[234:235], v[234:235], s[62:63]
  v_rcp_f32 v232, v232
  v_rcp_f32 v233, v233
  v_rcp_f32 v234, v234
  v_rcp_f32 v235, v235
  v_pk_mul_f32 v[232:233], v[232:233], v[52:53]
  v_pk_mul_f32 v[234:235], v[234:235], v[54:55]
  v_cvt_pk_bf16_f32 v12, v232, v233
  v_cvt_pk_bf16_f32 v13, v234, v235
  v_pk_mul_f32 v[236:237], v[80:81], s[42:43]
  v_pk_mul_f32 v[238:239], v[82:83], s[42:43]
  v_exp_f32 v236, v236
  v_exp_f32 v237, v237
  v_exp_f32 v238, v238
  v_exp_f32 v239, v239
  v_pk_add_f32 v[236:237], v[236:237], s[62:63]
  v_pk_add_f32 v[238:239], v[238:239], s[62:63]
  v_rcp_f32 v236, v236
  v_rcp_f32 v237, v237
  v_rcp_f32 v238, v238
  v_rcp_f32 v239, v239
  v_pk_mul_f32 v[236:237], v[236:237], v[108:109]
  v_pk_mul_f32 v[238:239], v[238:239], v[110:111]
  v_cvt_pk_bf16_f32 v14, v236, v237
  v_cvt_pk_bf16_f32 v15, v238, v239
  v_pk_mul_f32 v[232:233], v[136:137], s[42:43]
  v_pk_mul_f32 v[234:235], v[138:139], s[42:43]
  v_exp_f32 v232, v232
  v_exp_f32 v233, v233
  v_exp_f32 v234, v234
  v_exp_f32 v235, v235
  v_pk_add_f32 v[232:233], v[232:233], s[62:63]
  v_pk_add_f32 v[234:235], v[234:235], s[62:63]
  v_rcp_f32 v232, v232
  v_rcp_f32 v233, v233
  v_rcp_f32 v234, v234
  v_rcp_f32 v235, v235
  v_pk_mul_f32 v[232:233], v[232:233], v[164:165]
  v_pk_mul_f32 v[234:235], v[234:235], v[166:167]
  v_cvt_pk_bf16_f32 v124, v232, v233
  v_cvt_pk_bf16_f32 v125, v234, v235
  v_pk_mul_f32 v[236:237], v[192:193], s[42:43]
  v_pk_mul_f32 v[238:239], v[194:195], s[42:43]
  v_exp_f32 v236, v236
  v_exp_f32 v237, v237
  v_exp_f32 v238, v238
  v_exp_f32 v239, v239
  v_pk_add_f32 v[236:237], v[236:237], s[62:63]
  v_pk_add_f32 v[238:239], v[238:239], s[62:63]
  v_rcp_f32 v236, v236
  v_rcp_f32 v237, v237
  v_rcp_f32 v238, v238
  v_rcp_f32 v239, v239
  v_pk_mul_f32 v[236:237], v[236:237], v[220:221]
  v_pk_mul_f32 v[238:239], v[238:239], v[222:223]
  v_cvt_pk_bf16_f32 v126, v236, v237
  v_cvt_pk_bf16_f32 v127, v238, v239
  s_waitcnt vmcnt(4)
  v_cmp_ne_u32 vcc, s19, v247
  s_nop 1
  s_cmp_lg_u64 vcc, 0
  s_cbranch_scc1 L_slow_25
  L_back_26:
  s_add_u32 s94, s94, 65536
  buffer_load_dwordx4 a[0:3], v240, s[4:7], s16 offen offset:0 sc1
  buffer_load_dwordx4 a[4:7], v240, s[4:7], s16 offen offset:1024 sc1
  buffer_load_dwordx4 a[8:11], v241, s[4:7], s16 offen offset:0 sc1
  buffer_load_dwordx4 a[12:15], v241, s[4:7], s16 offen offset:1024 sc1
  s_add_u32 s41, s41, 262144
  s_bitset0_b32 s41, 21
  s_add_u32 s16, s40, s41
  buffer_load_dwordx4 a[16:19], v240, s[4:7], s16 offen offset:0 sc1
  buffer_load_dwordx4 a[20:23], v240, s[4:7], s16 offen offset:1024 sc1
  buffer_load_dwordx4 a[24:27], v241, s[4:7], s16 offen offset:0 sc1
  buffer_load_dwordx4 a[28:31], v241, s[4:7], s16 offen offset:1024 sc1
  s_add_u32 s41, s41, 262144
  s_bitset0_b32 s41, 21
  s_add_u32 s16, s40, s41
  buffer_load_dwordx4 a[32:35], v240, s[4:7], s16 offen offset:0 sc1
  buffer_load_dwordx4 a[36:39], v240, s[4:7], s16 offen offset:1024 sc1
  buffer_load_dwordx4 a[40:43], v241, s[4:7], s16 offen offset:0 sc1
  buffer_load_dwordx4 a[44:47], v241, s[4:7], s16 offen offset:1024 sc1
  s_add_u32 s41, s41, 262144
  s_bitset0_b32 s41, 21
  s_add_u32 s16, s40, s41
  v_add_u32 v104, 65536, v242
  v_add_u32 v105, 65536, v243
  v_add_u32 v106, 65536, v244
  v_add_u32 v107, 65536, v245
  s_waitcnt vmcnt(54)
  s_barrier
  ds_read_b64_tr_b16 a[80:81], v242 offset:2048
  ds_read_b64_tr_b16 a[82:83], v242 offset:6144
  ds_read_b64_tr_b16 a[84:85], v243 offset:2048
  ds_read_b64_tr_b16 a[86:87], v243 offset:6144
  ds_read_b64_tr_b16 a[88:89], v244 offset:2048
  ds_read_b64_tr_b16 a[90:91], v244 offset:6144
  ds_read_b64_tr_b16 a[92:93], v245 offset:2048
  ds_read_b64_tr_b16 a[94:95], v245 offset:6144
  ds_read_b64_tr_b16 a[112:113], v242 offset:10240
  ds_read_b64_tr_b16 a[114:115], v242 offset:14336
  ds_read_b64_tr_b16 a[116:117], v243 offset:10240
  ds_read_b64_tr_b16 a[118:119], v243 offset:14336
  ds_read_b64_tr_b16 a[120:121], v244 offset:10240
  ds_read_b64_tr_b16 a[122:123], v244 offset:14336
  ds_read_b64_tr_b16 a[124:125], v245 offset:10240
  ds_read_b64_tr_b16 a[126:127], v245 offset:14336
  ds_read_b64_tr_b16 a[64:65], v242 offset:0
  ds_read_b64_tr_b16 a[66:67], v242 offset:4096
  ds_read_b64_tr_b16 a[68:69], v243 offset:0
  ds_read_b64_tr_b16 a[70:71], v243 offset:4096
  ds_read_b64_tr_b16 a[72:73], v244 offset:0
  ds_read_b64_tr_b16 a[74:75], v244 offset:4096
  ds_read_b64_tr_b16 a[76:77], v245 offset:0
  ds_read_b64_tr_b16 a[78:79], v245 offset:4096
  ds_read_b64_tr_b16 a[96:97], v242 offset:8192
  ds_read_b64_tr_b16 a[98:99], v242 offset:12288
  ds_read_b64_tr_b16 a[100:101], v243 offset:8192
  ds_read_b64_tr_b16 a[102:103], v243 offset:12288
  ds_read_b64_tr_b16 a[104:105], v244 offset:8192
  ds_read_b64_tr_b16 a[106:107], v244 offset:12288
  ds_read_b64_tr_b16 a[108:109], v245 offset:8192
  ds_read_b64_tr_b16 a[110:111], v245 offset:12288
  s_waitcnt vmcnt(8) lgkmcnt(10)
  s_barrier
  s_mov_b64 exec, 1
  buffer_store_dword v248, v250, s[56:59], s92 offen sc1
  s_mov_b64 exec, -1
  s_add_u32 s92, s92, 65536
  v_mfma_f32_16x16x32_bf16 v[72:75], a[80:83], a[0:3], 0
  buffer_load_dwordx4 a[48:51], v240, s[4:7], s16 offen offset:0 sc1
  v_mfma_f32_16x16x32_bf16 v[88:91], a[80:83], a[4:7], 0
  ds_read_b64_tr_b16 a[80:81], v242 offset:18432
  ds_read_b64_tr_b16 a[82:83], v242 offset:22528
  v_mfma_f32_16x16x32_bf16 v[76:79], a[84:87], a[0:3], 0
  v_mfma_f32_16x16x32_bf16 v[92:95], a[84:87], a[4:7], 0
  buffer_load_dwordx4 a[52:55], v240, s[4:7], s16 offen offset:1024 sc1
  v_mfma_f32_16x16x32_bf16 v[80:83], a[88:91], a[0:3], 0
  ds_read_b64_tr_b16 a[84:85], v243 offset:18432
  ds_read_b64_tr_b16 a[86:87], v243 offset:22528
  v_mfma_f32_16x16x32_bf16 v[96:99], a[88:91], a[4:7], 0
  ds_read_b64_tr_b16 a[88:89], v244 offset:18432
  ds_read_b64_tr_b16 a[90:91], v244 offset:22528
  v_mfma_f32_16x16x32_bf16 v[84:87], a[92:95], a[0:3], 0
  buffer_load_dwordx4 a[56:59], v241, s[4:7], s16 offen offset:0 sc1
  v_mfma_f32_16x16x32_bf16 v[100:103], a[92:95], a[4:7], 0
  ds_read_b64_tr_b16 a[92:93], v245 offset:18432
  ds_read_b64_tr_b16 a[94:95], v245 offset:22528
  v_mfma_f32_16x16x32_bf16 v[72:75], a[112:115], a[8:11], v[72:75]
  v_mfma_f32_16x16x32_bf16 v[88:91], a[112:115], a[12:15], v[88:91]
  ds_read_b64_tr_b16 a[112:113], v242 offset:26624
  ds_read_b64_tr_b16 a[114:115], v242 offset:30720
  v_mfma_f32_16x16x32_bf16 v[76:79], a[116:119], a[8:11], v[76:79]
  buffer_load_dwordx4 a[60:63], v241, s[4:7], s16 offen offset:1024 sc1
  v_mfma_f32_16x16x32_bf16 v[92:95], a[116:119], a[12:15], v[92:95]
  ds_read_b64_tr_b16 a[116:117], v243 offset:26624
  ds_read_b64_tr_b16 a[118:119], v243 offset:30720
  v_mfma_f32_16x16x32_bf16 v[80:83], a[120:123], a[8:11], v[80:83]
  v_mfma_f32_16x16x32_bf16 v[96:99], a[120:123], a[12:15], v[96:99]
  ds_read_b64_tr_b16 a[120:121], v244 offset:26624
  s_add_u32 s41, s41, 262144
  v_mfma_f32_16x16x32_bf16 v[84:87], a[124:127], a[8:11], v[84:87]
  ds_read_b64_tr_b16 a[122:123], v244 offset:30720
  v_mfma_f32_16x16x32_bf16 v[100:103], a[124:127], a[12:15], v[100:103]
  ds_read_b64_tr_b16 a[124:125], v245 offset:26624
  ds_read_b64_tr_b16 a[126:127], v245 offset:30720
  v_mfma_f32_16x16x32_bf16 v[16:19], a[64:67], a[0:3], 0
  v_mfma_f32_16x16x32_bf16 v[32:35], a[64:67], a[4:7], 0
  ds_read_b64_tr_b16 a[64:65], v242 offset:16384
  s_bitset0_b32 s41, 21
  v_mfma_f32_16x16x32_bf16 v[20:23], a[68:71], a[0:3], 0
  ds_read_b64_tr_b16 a[66:67], v242 offset:20480
  v_mfma_f32_16x16x32_bf16 v[36:39], a[68:71], a[4:7], 0
  ds_read_b64_tr_b16 a[68:69], v243 offset:16384
  ds_read_b64_tr_b16 a[70:71], v243 offset:20480
  v_mfma_f32_16x16x32_bf16 v[24:27], a[72:75], a[0:3], 0
  s_add_u32 s16, s40, s41
  v_mfma_f32_16x16x32_bf16 v[40:43], a[72:75], a[4:7], 0
  ds_read_b64_tr_b16 a[72:73], v244 offset:16384
  ds_read_b64_tr_b16 a[74:75], v244 offset:20480
  s_waitcnt lgkmcnt(10)
  v_mfma_f32_16x16x32_bf16 v[28:31], a[76:79], a[0:3], 0
  v_mfma_f32_16x16x32_bf16 v[44:47], a[76:79], a[4:7], 0
  ds_read_b64_tr_b16 a[76:77], v245 offset:16384
  ds_read_b64_tr_b16 a[78:79], v245 offset:20480
  v_mfma_f32_16x16x32_bf16 v[16:19], a[96:99], a[8:11], v[16:19]
  buffer_store_dwordx4 v[8:11], v224, s[12:15], s100 offen offset:0 sc1
  v_mfma_f32_16x16x32_bf16 v[32:35], a[96:99], a[12:15], v[32:35]
  ds_read_b64_tr_b16 a[96:97], v242 offset:24576
  ds_read_b64_tr_b16 a[98:99], v242 offset:28672
  v_mfma_f32_16x16x32_bf16 v[20:23], a[100:103], a[8:11], v[20:23]
  v_mfma_f32_16x16x32_bf16 v[36:39], a[100:103], a[12:15], v[36:39]
  buffer_store_dwordx4 v[64:67], v224, s[12:15], s100 offen offset:1024 sc1
  v_mfma_f32_16x16x32_bf16 v[24:27], a[104:107], a[8:11], v[24:27]
  ds_read_b64_tr_b16 a[100:101], v243 offset:24576
  ds_read_b64_tr_b16 a[102:103], v243 offset:28672
  v_mfma_f32_16x16x32_bf16 v[40:43], a[104:107], a[12:15], v[40:43]
  ds_read_b64_tr_b16 a[104:105], v244 offset:24576
  ds_read_b64_tr_b16 a[106:107], v244 offset:28672
  v_mfma_f32_16x16x32_bf16 v[28:31], a[108:111], a[8:11], v[28:31]
  v_mfma_f32_16x16x32_bf16 v[44:47], a[108:111], a[12:15], v[44:47]
  s_waitcnt vmcnt(11) lgkmcnt(10)
  s_barrier
  v_mfma_f32_16x16x32_bf16 v[72:75], a[80:83], a[16:19], v[72:75]
  buffer_load_dwordx4 a[0:3], v240, s[4:7], s16 offen offset:0 sc1
  v_mfma_f32_16x16x32_bf16 v[88:91], a[80:83], a[20:23], v[88:91]
  ds_read_b64_tr_b16 a[108:109], v245 offset:24576
  ds_read_b64_tr_b16 a[110:111], v245 offset:28672
  v_mfma_f32_16x16x32_bf16 v[76:79], a[84:87], a[16:19], v[76:79]
  ds_read_b64_tr_b16 a[80:81], v242 offset:34816
  ds_read_b64_tr_b16 a[82:83], v242 offset:38912
  v_mfma_f32_16x16x32_bf16 v[92:95], a[84:87], a[20:23], v[92:95]
  buffer_load_dwordx4 a[4:7], v240, s[4:7], s16 offen offset:1024 sc1
  v_mfma_f32_16x16x32_bf16 v[80:83], a[88:91], a[16:19], v[80:83]
  ds_read_b64_tr_b16 a[84:85], v243 offset:34816
  ds_read_b64_tr_b16 a[86:87], v243 offset:38912
  v_mfma_f32_16x16x32_bf16 v[96:99], a[88:91], a[20:23], v[96:99]
  ds_read_b64_tr_b16 a[88:89], v244 offset:34816
  ds_read_b64_tr_b16 a[90:91], v244 offset:38912
  v_mfma_f32_16x16x32_bf16 v[84:87], a[92:95], a[16:19], v[84:87]
  buffer_load_dwordx4 a[8:11], v241, s[4:7], s16 offen offset:0 sc1
  v_mfma_f32_16x16x32_bf16 v[100:103], a[92:95], a[20:23], v[100:103]
  ds_read_b64_tr_b16 a[92:93], v245 offset:34816
  ds_read_b64_tr_b16 a[94:95], v245 offset:38912
  v_mfma_f32_16x16x32_bf16 v[72:75], a[112:115], a[24:27], v[72:75]
  v_mfma_f32_16x16x32_bf16 v[88:91], a[112:115], a[28:31], v[88:91]
  ds_read_b64_tr_b16 a[112:113], v242 offset:43008
  ds_read_b64_tr_b16 a[114:115], v242 offset:47104
  v_mfma_f32_16x16x32_bf16 v[76:79], a[116:119], a[24:27], v[76:79]
  buffer_load_dwordx4 a[12:15], v241, s[4:7], s16 offen offset:1024 sc1
  v_mfma_f32_16x16x32_bf16 v[92:95], a[116:119], a[28:31], v[92:95]
  ds_read_b64_tr_b16 a[116:117], v243 offset:43008
  ds_read_b64_tr_b16 a[118:119], v243 offset:47104
  v_mfma_f32_16x16x32_bf16 v[80:83], a[120:123], a[24:27], v[80:83]
  v_mfma_f32_16x16x32_bf16 v[96:99], a[120:123], a[28:31], v[96:99]
  ds_read_b64_tr_b16 a[120:121], v244 offset:43008
  s_add_u32 s41, s41, 262144
  v_mfma_f32_16x16x32_bf16 v[84:87], a[124:127], a[24:27], v[84:87]
  ds_read_b64_tr_b16 a[122:123], v244 offset:47104
  v_mfma_f32_16x16x32_bf16 v[100:103], a[124:127], a[28:31], v[100:103]
  ds_read_b64_tr_b16 a[124:125], v245 offset:43008
  ds_read_b64_tr_b16 a[126:127], v245 offset:47104
  v_mfma_f32_16x16x32_bf16 v[16:19], a[64:67], a[16:19], v[16:19]
  v_mfma_f32_16x16x32_bf16 v[32:35], a[64:67], a[20:23], v[32:35]
  ds_read_b64_tr_b16 a[64:65], v242 offset:32768
  s_bitset0_b32 s41, 21
  v_mfma_f32_16x16x32_bf16 v[20:23], a[68:71], a[16:19], v[20:23]
  ds_read_b64_tr_b16 a[66:67], v242 offset:36864
  v_mfma_f32_16x16x32_bf16 v[36:39], a[68:71], a[20:23], v[36:39]
  ds_read_b64_tr_b16 a[68:69], v243 offset:32768
  ds_read_b64_tr_b16 a[70:71], v243 offset:36864
  s_waitcnt lgkmcnt(10)
  v_mfma_f32_16x16x32_bf16 v[24:27], a[72:75], a[16:19], v[24:27]
  s_add_u32 s16, s40, s41
  v_mfma_f32_16x16x32_bf16 v[40:43], a[72:75], a[20:23], v[40:43]
  ds_read_b64_tr_b16 a[72:73], v244 offset:32768
  ds_read_b64_tr_b16 a[74:75], v244 offset:36864
  v_mfma_f32_16x16x32_bf16 v[28:31], a[76:79], a[16:19], v[28:31]
  v_mfma_f32_16x16x32_bf16 v[44:47], a[76:79], a[20:23], v[44:47]
  ds_read_b64_tr_b16 a[76:77], v245 offset:32768
  ds_read_b64_tr_b16 a[78:79], v245 offset:36864
  v_mfma_f32_16x16x32_bf16 v[16:19], a[96:99], a[24:27], v[16:19]
  buffer_store_dwordx4 v[120:123], v224, s[12:15], s100 offen offset:2048 sc1
  v_mfma_f32_16x16x32_bf16 v[32:35], a[96:99], a[28:31], v[32:35]
  ds_read_b64_tr_b16 a[96:97], v242 offset:40960
  ds_read_b64_tr_b16 a[98:99], v242 offset:45056
  v_mfma_f32_16x16x32_bf16 v[20:23], a[100:103], a[24:27], v[20:23]
  v_mfma_f32_16x16x32_bf16 v[36:39], a[100:103], a[28:31], v[36:39]
  buffer_store_dwordx4 v[176:179], v224, s[12:15], s100 offen offset:3072 sc1
  v_mfma_f32_16x16x32_bf16 v[24:27], a[104:107], a[24:27], v[24:27]
  ds_read_b64_tr_b16 a[100:101], v243 offset:40960
  ds_read_b64_tr_b16 a[102:103], v243 offset:45056
  v_mfma_f32_16x16x32_bf16 v[40:43], a[104:107], a[28:31], v[40:43]
  ds_read_b64_tr_b16 a[104:105], v244 offset:40960
  ds_read_b64_tr_b16 a[106:107], v244 offset:45056
  v_mfma_f32_16x16x32_bf16 v[28:31], a[108:111], a[24:27], v[28:31]
  v_mfma_f32_16x16x32_bf16 v[44:47], a[108:111], a[28:31], v[44:47]
  s_waitcnt vmcnt(13) lgkmcnt(10)
  s_barrier
  v_mfma_f32_16x16x32_bf16 v[72:75], a[80:83], a[32:35], v[72:75]
  buffer_load_dwordx4 a[16:19], v240, s[4:7], s16 offen offset:0 sc1
  v_mfma_f32_16x16x32_bf16 v[88:91], a[80:83], a[36:39], v[88:91]
  ds_read_b64_tr_b16 a[108:109], v245 offset:40960
  ds_read_b64_tr_b16 a[110:111], v245 offset:45056
  v_mfma_f32_16x16x32_bf16 v[76:79], a[84:87], a[32:35], v[76:79]
  ds_read_b64_tr_b16 a[80:81], v242 offset:51200
  ds_read_b64_tr_b16 a[82:83], v242 offset:55296
  v_mfma_f32_16x16x32_bf16 v[92:95], a[84:87], a[36:39], v[92:95]
  buffer_load_dwordx4 a[20:23], v240, s[4:7], s16 offen offset:1024 sc1
  v_mfma_f32_16x16x32_bf16 v[80:83], a[88:91], a[32:35], v[80:83]
  ds_read_b64_tr_b16 a[84:85], v243 offset:51200
  ds_read_b64_tr_b16 a[86:87], v243 offset:55296
  v_mfma_f32_16x16x32_bf16 v[96:99], a[88:91], a[36:39], v[96:99]
  ds_read_b64_tr_b16 a[88:89], v244 offset:51200
  ds_read_b64_tr_b16 a[90:91], v244 offset:55296
  v_mfma_f32_16x16x32_bf16 v[84:87], a[92:95], a[32:35], v[84:87]
  buffer_load_dwordx4 a[24:27], v241, s[4:7], s16 offen offset:0 sc1
  v_mfma_f32_16x16x32_bf16 v[100:103], a[92:95], a[36:39], v[100:103]
  ds_read_b64_tr_b16 a[92:93], v245 offset:51200
  ds_read_b64_tr_b16 a[94:95], v245 offset:55296
  v_mfma_f32_16x16x32_bf16 v[72:75], a[112:115], a[40:43], v[72:75]
  v_mfma_f32_16x16x32_bf16 v[88:91], a[112:115], a[44:47], v[88:91]
  ds_read_b64_tr_b16 a[112:113], v242 offset:59392
  ds_read_b64_tr_b16 a[114:115], v242 offset:63488
  v_mfma_f32_16x16x32_bf16 v[76:79], a[116:119], a[40:43], v[76:79]
  buffer_load_dwordx4 a[28:31], v241, s[4:7], s16 offen offset:1024 sc1
  v_mfma_f32_16x16x32_bf16 v[92:95], a[116:119], a[44:47], v[92:95]
  ds_read_b64_tr_b16 a[116:117], v243 offset:59392
  ds_read_b64_tr_b16 a[118:119], v243 offset:63488
  v_mfma_f32_16x16x32_bf16 v[80:83], a[120:123], a[40:43], v[80:83]
  v_mfma_f32_16x16x32_bf16 v[96:99], a[120:123], a[44:47], v[96:99]
  ds_read_b64_tr_b16 a[120:121], v244 offset:59392
  s_add_u32 s41, s41, 262144
  v_mfma_f32_16x16x32_bf16 v[84:87], a[124:127], a[40:43], v[84:87]
  ds_read_b64_tr_b16 a[122:123], v244 offset:63488
  v_mfma_f32_16x16x32_bf16 v[100:103], a[124:127], a[44:47], v[100:103]
  ds_read_b64_tr_b16 a[124:125], v245 offset:59392
  ds_read_b64_tr_b16 a[126:127], v245 offset:63488
  v_mfma_f32_16x16x32_bf16 v[16:19], a[64:67], a[32:35], v[16:19]
  v_mfma_f32_16x16x32_bf16 v[32:35], a[64:67], a[36:39], v[32:35]
  ds_read_b64_tr_b16 a[64:65], v242 offset:49152
  s_bitset0_b32 s41, 21
  v_mfma_f32_16x16x32_bf16 v[20:23], a[68:71], a[32:35], v[20:23]
  ds_read_b64_tr_b16 a[66:67], v242 offset:53248
  v_mfma_f32_16x16x32_bf16 v[36:39], a[68:71], a[36:39], v[36:39]
  ds_read_b64_tr_b16 a[68:69], v243 offset:49152
  ds_read_b64_tr_b16 a[70:71], v243 offset:53248
  s_waitcnt lgkmcnt(10)
  v_mfma_f32_16x16x32_bf16 v[24:27], a[72:75], a[32:35], v[24:27]
  s_add_u32 s16, s40, s41
  v_mfma_f32_16x16x32_bf16 v[40:43], a[72:75], a[36:39], v[40:43]
  ds_read_b64_tr_b16 a[72:73], v244 offset:49152
  ds_read_b64_tr_b16 a[74:75], v244 offset:53248
  v_mfma_f32_16x16x32_bf16 v[28:31], a[76:79], a[32:35], v[28:31]
  v_mfma_f32_16x16x32_bf16 v[44:47], a[76:79], a[36:39], v[44:47]
  ds_read_b64_tr_b16 a[76:77], v245 offset:49152
  ds_read_b64_tr_b16 a[78:79], v245 offset:53248
  v_mfma_f32_16x16x32_bf16 v[16:19], a[96:99], a[40:43], v[16:19]
  buffer_store_dwordx4 v[12:15], v224, s[12:15], s101 offen offset:0 sc1
  v_mfma_f32_16x16x32_bf16 v[32:35], a[96:99], a[44:47], v[32:35]
  ds_read_b64_tr_b16 a[96:97], v242 offset:57344
  ds_read_b64_tr_b16 a[98:99], v242 offset:61440
  v_mfma_f32_16x16x32_bf16 v[20:23], a[100:103], a[40:43], v[20:23]
  v_mfma_f32_16x16x32_bf16 v[36:39], a[100:103], a[44:47], v[36:39]
  buffer_store_dwordx4 v[124:127], v224, s[12:15], s101 offen offset:2048 sc1
  v_mfma_f32_16x16x32_bf16 v[24:27], a[104:107], a[40:43], v[24:27]
  ds_read_b64_tr_b16 a[100:101], v243 offset:57344
  ds_read_b64_tr_b16 a[102:103], v243 offset:61440
  v_mfma_f32_16x16x32_bf16 v[40:43], a[104:107], a[44:47], v[40:43]
  ds_read_b64_tr_b16 a[104:105], v244 offset:57344
  ds_read_b64_tr_b16 a[106:107], v244 offset:61440
  v_mfma_f32_16x16x32_bf16 v[28:31], a[108:111], a[40:43], v[28:31]
  v_mfma_f32_16x16x32_bf16 v[44:47], a[108:111], a[44:47], v[44:47]
  s_waitcnt vmcnt(14) lgkmcnt(10)
  s_barrier
  v_mfma_f32_16x16x32_bf16 v[72:75], a[80:83], a[48:51], v[72:75]
  buffer_load_dwordx4 a[32:35], v240, s[4:7], s16 offen offset:0 sc1
  v_mfma_f32_16x16x32_bf16 v[88:91], a[80:83], a[52:55], v[88:91]
  ds_read_b64_tr_b16 a[108:109], v245 offset:57344
  ds_read_b64_tr_b16 a[110:111], v245 offset:61440
  v_mfma_f32_16x16x32_bf16 v[76:79], a[84:87], a[48:51], v[76:79]
  buffer_load_dwordx4 a[36:39], v240, s[4:7], s16 offen offset:1024 sc1
  v_mfma_f32_16x16x32_bf16 v[92:95], a[84:87], a[52:55], v[92:95]
  ds_read_b64_tr_b16 a[80:81], v104 offset:2048
  ds_read_b64_tr_b16 a[82:83], v104 offset:6144
  v_mfma_f32_16x16x32_bf16 v[80:83], a[88:91], a[48:51], v[80:83]
  buffer_load_dwordx4 a[40:43], v241, s[4:7], s16 offen offset:0 sc1
  v_mfma_f32_16x16x32_bf16 v[96:99], a[88:91], a[52:55], v[96:99]
  ds_read_b64_tr_b16 a[84:85], v105 offset:2048
  ds_read_b64_tr_b16 a[86:87], v105 offset:6144
  v_mfma_f32_16x16x32_bf16 v[84:87], a[92:95], a[48:51], v[84:87]
  buffer_load_dwordx4 a[44:47], v241, s[4:7], s16 offen offset:1024 sc1
  v_mfma_f32_16x16x32_bf16 v[100:103], a[92:95], a[52:55], v[100:103]
  ds_read_b64_tr_b16 a[88:89], v106 offset:2048
  ds_read_b64_tr_b16 a[90:91], v106 offset:6144
  v_mfma_f32_16x16x32_bf16 v[72:75], a[112:115], a[56:59], v[72:75]
  ds_read_b64_tr_b16 a[92:93], v107 offset:2048
  s_add_u32 s41, s41, 262144
  v_mfma_f32_16x16x32_bf16 v[88:91], a[112:115], a[60:63], v[88:91]
  ds_read_b64_tr_b16 a[94:95], v107 offset:6144
  ds_read_b64_tr_b16 a[112:113], v104 offset:10240
  v_mfma_f32_16x16x32_bf16 v[76:79], a[116:119], a[56:59], v[76:79]
  ds_read_b64_tr_b16 a[114:115], v104 offset:14336
  s_bitset0_b32 s41, 21
  v_mfma_f32_16x16x32_bf16 v[92:95], a[116:119], a[60:63], v[92:95]
  ds_read_b64_tr_b16 a[116:117], v105 offset:10240
  ds_read_b64_tr_b16 a[118:119], v105 offset:14336
  v_mfma_f32_16x16x32_bf16 v[80:83], a[120:123], a[56:59], v[80:83]
  s_add_u32 s16, s40, s41
  v_mfma_f32_16x16x32_bf16 v[96:99], a[120:123], a[60:63], v[96:99]
  ds_read_b64_tr_b16 a[120:121], v106 offset:10240
  ds_read_b64_tr_b16 a[122:123], v106 offset:14336
  v_mfma_f32_16x16x32_bf16 v[84:87], a[124:127], a[56:59], v[84:87]
  s_add_u32 m0, s38, 0
  v_mfma_f32_16x16x32_bf16 v[100:103], a[124:127], a[60:63], v[100:103]
  buffer_load_dword v247, v246, s[56:59], s94 offen sc1
  v_mfma_f32_16x16x32_bf16 v[16:19], a[64:67], a[48:51], v[16:19]
  buffer_load_dwordx4 v225, s[8:11], s17 offen lds
  v_mfma_f32_16x16x32_bf16 v[32:35], a[64:67], a[52:55], v[32:35]
  ds_read_b64_tr_b16 a[124:125], v107 offset:10240
  ds_read_b64_tr_b16 a[126:127], v107 offset:14336
  v_mfma_f32_16x16x32_bf16 v[20:23], a[68:71], a[48:51], v[20:23]
  buffer_load_dwordx4 v226, s[8:11], s17 offen offset:1024 lds
  v_mfma_f32_16x16x32_bf16 v[36:39], a[68:71], a[52:55], v[36:39]
  ds_read_b64_tr_b16 a[64:65], v104 offset:0
  ds_read_b64_tr_b16 a[66:67], v104 offset:4096
  s_waitcnt lgkmcnt(10)
  v_mfma_f32_16x16x32_bf16 v[24:27], a[72:75], a[48:51], v[24:27]
  buffer_load_dwordx4 v227, s[8:11], s17 offen offset:2048 lds
  v_mfma_f32_16x16x32_bf16 v[40:43], a[72:75], a[52:55], v[40:43]
  ds_read_b64_tr_b16 a[68:69], v105 offset:0
  ds_read_b64_tr_b16 a[70:71], v105 offset:4096
  v_mfma_f32_16x16x32_bf16 v[28:31], a[76:79], a[48:51], v[28:31]
  buffer_load_dwordx4 v228, s[8:11], s17 offen offset:3072 lds
  v_mfma_f32_16x16x32_bf16 v[44:47], a[76:79], a[52:55], v[44:47]
  ds_read_b64_tr_b16 a[72:73], v106 offset:0
  ds_read_b64_tr_b16 a[74:75], v106 offset:4096
  v_mfma_f32_16x16x32_bf16 v[16:19], a[96:99], a[56:59], v[16:19]
  ds_read_b64_tr_b16 a[76:77], v107 offset:0
  s_add_u32 s17, s17, 458752
  v_mfma_f32_16x16x32_bf16 v[32:35], a[96:99], a[60:63], v[32:35]
  ds_read_b64_tr_b16 a[78:79], v107 offset:4096
  ds_read_b64_tr_b16 a[96:97], v104 offset:8192
  v_mfma_f32_16x16x32_bf16 v[20:23], a[100:103], a[56:59], v[20:23]
  ds_read_b64_tr_b16 a[98:99], v104 offset:12288
  s_cmp_eq_u32 s17, s93
  v_mfma_f32_16x16x32_bf16 v[36:39], a[100:103], a[60:63], v[36:39]
  ds_read_b64_tr_b16 a[100:101], v105 offset:8192
  ds_read_b64_tr_b16 a[102:103], v105 offset:12288
  v_mfma_f32_16x16x32_bf16 v[24:27], a[104:107], a[56:59], v[24:27]
  s_cselect_b32 s17, s95, s17
  v_mfma_f32_16x16x32_bf16 v[40:43], a[104:107], a[60:63], v[40:43]
  ds_read_b64_tr_b16 a[104:105], v106 offset:8192
  ds_read_b64_tr_b16 a[106:107], v106 offset:12288
  v_mfma_f32_16x16x32_bf16 v[28:31], a[108:111], a[56:59], v[28:31]
  v_mfma_f32_16x16x32_bf16 v[44:47], a[108:111], a[60:63], v[44:47]
  s_waitcnt vmcnt(17) lgkmcnt(10)
  s_barrier
  v_mfma_f32_16x16x32_bf16 v[72:75], a[80:83], a[0:3], v[72:75]
  buffer_load_dwordx4 a[48:51], v240, s[4:7], s16 offen offset:0 sc1
  v_mfma_f32_16x16x32_bf16 v[88:91], a[80:83], a[4:7], v[88:91]
  buffer_load_dwordx4 a[52:55], v240, s[4:7], s16 offen offset:1024 sc1
  v_mfma_f32_16x16x32_bf16 v[76:79], a[84:87], a[0:3], v[76:79]
  ds_read_b64_tr_b16 a[108:109], v107 offset:8192
  ds_read_b64_tr_b16 a[110:111], v107 offset:12288
  v_add_u32 v124, 131072, v242
  v_mfma_f32_16x16x32_bf16 v[92:95], a[84:87], a[4:7], v[92:95]
  buffer_load_dwordx4 a[56:59], v241, s[4:7], s16 offen offset:0 sc1
  v_mfma_f32_16x16x32_bf16 v[80:83], a[88:91], a[0:3], v[80:83]
  ds_read_b64_tr_b16 a[80:81], v104 offset:18432
  ds_read_b64_tr_b16 a[82:83], v104 offset:22528
  v_mfma_f32_16x16x32_bf16 v[96:99], a[88:91], a[4:7], v[96:99]
  buffer_load_dwordx4 a[60:63], v241, s[4:7], s16 offen offset:1024 sc1
  v_mfma_f32_16x16x32_bf16 v[84:87], a[92:95], a[0:3], v[84:87]
  ds_read_b64_tr_b16 a[84:85], v105 offset:18432
  ds_read_b64_tr_b16 a[86:87], v105 offset:22528
  v_add_u32 v125, 131072, v243
  v_mfma_f32_16x16x32_bf16 v[100:103], a[92:95], a[4:7], v[100:103]
  ds_read_b64_tr_b16 a[88:89], v106 offset:18432
  s_add_u32 s41, s41, 262144
  v_mfma_f32_16x16x32_bf16 v[72:75], a[112:115], a[8:11], v[72:75]
  ds_read_b64_tr_b16 a[90:91], v106 offset:22528
  ds_read_b64_tr_b16 a[92:93], v107 offset:18432
  v_mfma_f32_16x16x32_bf16 v[88:91], a[112:115], a[12:15], v[88:91]
  ds_read_b64_tr_b16 a[94:95], v107 offset:22528
  s_bitset0_b32 s41, 21
  v_mfma_f32_16x16x32_bf16 v[76:79], a[116:119], a[8:11], v[76:79]
  ds_read_b64_tr_b16 a[112:113], v104 offset:26624
  v_add_u32 v126, 131072, v244
  v_mfma_f32_16x16x32_bf16 v[92:95], a[116:119], a[12:15], v[92:95]
  ds_read_b64_tr_b16 a[114:115], v104 offset:30720
  s_add_u32 s40, s40, 2097152
  v_mfma_f32_16x16x32_bf16 v[80:83], a[120:123], a[8:11], v[80:83]
  ds_read_b64_tr_b16 a[116:117], v105 offset:26624
  ds_read_b64_tr_b16 a[118:119], v105 offset:30720
  v_mfma_f32_16x16x32_bf16 v[96:99], a[120:123], a[12:15], v[96:99]
  ds_read_b64_tr_b16 a[120:121], v106 offset:26624
  s_add_u32 s16, s40, s41
  v_mfma_f32_16x16x32_bf16 v[84:87], a[124:127], a[8:11], v[84:87]
  ds_read_b64_tr_b16 a[122:123], v106 offset:30720
  v_add_u32 v127, 131072, v245
  v_mfma_f32_16x16x32_bf16 v[100:103], a[124:127], a[12:15], v[100:103]
  ds_read_b64_tr_b16 a[124:125], v107 offset:26624
  s_add_u32 m0, s38, 16384
  v_mfma_f32_16x16x32_bf16 v[16:19], a[64:67], a[0:3], v[16:19]
  ds_read_b64_tr_b16 a[126:127], v107 offset:30720
  v_mfma_f32_16x16x32_bf16 v[32:35], a[64:67], a[4:7], v[32:35]
  buffer_load_dwordx4 v225, s[8:11], s17 offen lds
  v_mfma_f32_16x16x32_bf16 v[20:23], a[68:71], a[0:3], v[20:23]
  ds_read_b64_tr_b16 a[64:65], v104 offset:16384
  ds_read_b64_tr_b16 a[66:67], v104 offset:20480
  v_mfma_f32_16x16x32_bf16 v[36:39], a[68:71], a[4:7], v[36:39]
  buffer_load_dwordx4 v226, s[8:11], s17 offen offset:1024 lds
  s_waitcnt lgkmcnt(10)
  v_mfma_f32_16x16x32_bf16 v[24:27], a[72:75], a[0:3], v[24:27]
  ds_read_b64_tr_b16 a[68:69], v105 offset:16384
  ds_read_b64_tr_b16 a[70:71], v105 offset:20480
  v_mfma_f32_16x16x32_bf16 v[40:43], a[72:75], a[4:7], v[40:43]
  buffer_load_dwordx4 v227, s[8:11], s17 offen offset:2048 lds
  v_mfma_f32_16x16x32_bf16 v[28:31], a[76:79], a[0:3], v[28:31]
  ds_read_b64_tr_b16 a[72:73], v106 offset:16384
  ds_read_b64_tr_b16 a[74:75], v106 offset:20480
  v_mfma_f32_16x16x32_bf16 v[44:47], a[76:79], a[4:7], v[44:47]
  buffer_load_dwordx4 v228, s[8:11], s17 offen offset:3072 lds
  v_mfma_f32_16x16x32_bf16 v[16:19], a[96:99], a[8:11], v[16:19]
  ds_read_b64_tr_b16 a[76:77], v107 offset:16384
  ds_read_b64_tr_b16 a[78:79], v107 offset:20480
  v_mfma_f32_16x16x32_bf16 v[32:35], a[96:99], a[12:15], v[32:35]
  ds_read_b64_tr_b16 a[96:97], v104 offset:24576
  s_add_u32 s17, s17, 458752
  v_mfma_f32_16x16x32_bf16 v[20:23], a[100:103], a[8:11], v[20:23]
  ds_read_b64_tr_b16 a[98:99], v104 offset:28672
  v_mfma_f32_16x16x32_bf16 v[36:39], a[100:103], a[12:15], v[36:39]
  ds_read_b64_tr_b16 a[100:101], v105 offset:24576
  s_cmp_eq_u32 s17, s93
  v_mfma_f32_16x16x32_bf16 v[24:27], a[104:107], a[8:11], v[24:27]
  ds_read_b64_tr_b16 a[102:103], v105 offset:28672
  v_mfma_f32_16x16x32_bf16 v[40:43], a[104:107], a[12:15], v[40:43]
  ds_read_b64_tr_b16 a[104:105], v106 offset:24576
  s_cselect_b32 s17, s95, s17
  v_mfma_f32_16x16x32_bf16 v[28:31], a[108:111], a[8:11], v[28:31]
  ds_read_b64_tr_b16 a[106:107], v106 offset:28672
  v_mfma_f32_16x16x32_bf16 v[44:47], a[108:111], a[12:15], v[44:47]
  s_waitcnt vmcnt(12) lgkmcnt(10)
  s_barrier
  v_cmp_ne_u32 vcc, s19, v247
  s_nop 1
  s_cmp_lg_u64 vcc, 0
  s_cbranch_scc1 L_slow_27
  L_back_28:
  s_add_u32 s94, s94, 65536
  v_mfma_f32_16x16x32_bf16 v[72:75], a[80:83], a[16:19], v[72:75]
  buffer_load_dwordx4 a[0:3], v240, s[4:7], s16 offen offset:0 sc1
  v_mfma_f32_16x16x32_bf16 v[88:91], a[80:83], a[20:23], v[88:91]
  ds_read_b64_tr_b16 a[108:109], v107 offset:24576
  ds_read_b64_tr_b16 a[110:111], v107 offset:28672
  v_mfma_f32_16x16x32_bf16 v[76:79], a[84:87], a[16:19], v[76:79]
  ds_read_b64_tr_b16 a[80:81], v104 offset:34816
  ds_read_b64_tr_b16 a[82:83], v104 offset:38912
  v_mfma_f32_16x16x32_bf16 v[92:95], a[84:87], a[20:23], v[92:95]
  ds_read_b64_tr_b16 a[84:85], v105 offset:34816
  ds_read_b64_tr_b16 a[86:87], v105 offset:38912
  v_mfma_f32_16x16x32_bf16 v[80:83], a[88:91], a[16:19], v[80:83]
  buffer_load_dwordx4 a[4:7], v240, s[4:7], s16 offen offset:1024 sc1
  v_mfma_f32_16x16x32_bf16 v[96:99], a[88:91], a[20:23], v[96:99]
  ds_read_b64_tr_b16 a[88:89], v106 offset:34816
  ds_read_b64_tr_b16 a[90:91], v106 offset:38912
  v_mfma_f32_16x16x32_bf16 v[84:87], a[92:95], a[16:19], v[84:87]
  v_mfma_f32_16x16x32_bf16 v[100:103], a[92:95], a[20:23], v[100:103]
  ds_read_b64_tr_b16 a[92:93], v107 offset:34816
  ds_read_b64_tr_b16 a[94:95], v107 offset:38912
  v_mfma_f32_16x16x32_bf16 v[72:75], a[112:115], a[24:27], v[72:75]
  buffer_load_dwordx4 a[8:11], v241, s[4:7], s16 offen offset:0 sc1
  v_mfma_f32_16x16x32_bf16 v[88:91], a[112:115], a[28:31], v[88:91]
  ds_read_b64_tr_b16 a[112:113], v104 offset:43008
  ds_read_b64_tr_b16 a[114:115], v104 offset:47104
  v_mfma_f32_16x16x32_bf16 v[76:79], a[116:119], a[24:27], v[76:79]
  v_mfma_f32_16x16x32_bf16 v[92:95], a[116:119], a[28:31], v[92:95]
  ds_read_b64_tr_b16 a[116:117], v105 offset:43008
  ds_read_b64_tr_b16 a[118:119], v105 offset:47104
  v_mfma_f32_16x16x32_bf16 v[80:83], a[120:123], a[24:27], v[80:83]
  v_mfma_f32_16x16x32_bf16 v[96:99], a[120:123], a[28:31], v[96:99]
  buffer_load_dwordx4 a[12:15], v241, s[4:7], s16 offen offset:1024 sc1
  v_mfma_f32_16x16x32_bf16 v[84:87], a[124:127], a[24:27], v[84:87]
  ds_read_b64_tr_b16 a[120:121], v106 offset:43008
  ds_read_b64_tr_b16 a[122:123], v106 offset:47104
  v_mfma_f32_16x16x32_bf16 v[100:103], a[124:127], a[28:31], v[100:103]
  ds_read_b64_tr_b16 a[124:125], v107 offset:43008
  ds_read_b64_tr_b16 a[126:127], v107 offset:47104
  v_mfma_f32_16x16x32_bf16 v[16:19], a[64:67], a[16:19], v[16:19]
  v_mfma_f32_16x16x32_bf16 v[32:35], a[64:67], a[20:23], v[32:35]
  ds_read_b64_tr_b16 a[64:65], v104 offset:32768
  s_add_u32 s41, s41, 262144
  v_mfma_f32_16x16x32_bf16 v[20:23], a[68:71], a[16:19], v[20:23]
  ds_read_b64_tr_b16 a[66:67], v104 offset:36864
  v_mfma_f32_16x16x32_bf16 v[36:39], a[68:71], a[20:23], v[36:39]
  ds_read_b64_tr_b16 a[68:69], v105 offset:32768
  ds_read_b64_tr_b16 a[70:71], v105 offset:36864
  s_waitcnt lgkmcnt(10)
  v_mfma_f32_16x16x32_bf16 v[24:27], a[72:75], a[16:19], v[24:27]
  v_mfma_f32_16x16x32_bf16 v[40:43], a[72:75], a[20:23], v[40:43]
  ds_read_b64_tr_b16 a[72:73], v106 offset:32768
  ds_read_b64_tr_b16 a[74:75], v106 offset:36864
  v_mfma_f32_16x16x32_bf16 v[28:31], a[76:79], a[16:19], v[28:31]
  s_bitset0_b32 s41, 21
  v_mfma_f32_16x16x32_bf16 v[44:47], a[76:79], a[20:23], v[44:47]
  ds_read_b64_tr_b16 a[76:77], v107 offset:32768
  ds_read_b64_tr_b16 a[78:79], v107 offset:36864
  v_mfma_f32_16x16x32_bf16 v[16:19], a[96:99], a[24:27], v[16:19]
  v_mfma_f32_16x16x32_bf16 v[32:35], a[96:99], a[28:31], v[32:35]
  ds_read_b64_tr_b16 a[96:97], v104 offset:40960
  ds_read_b64_tr_b16 a[98:99], v104 offset:45056
  v_mfma_f32_16x16x32_bf16 v[20:23], a[100:103], a[24:27], v[20:23]
  s_add_u32 s16, s40, s41
  v_mfma_f32_16x16x32_bf16 v[36:39], a[100:103], a[28:31], v[36:39]
  ds_read_b64_tr_b16 a[100:101], v105 offset:40960
  ds_read_b64_tr_b16 a[102:103], v105 offset:45056
  v_mfma_f32_16x16x32_bf16 v[24:27], a[104:107], a[24:27], v[24:27]
  v_mfma_f32_16x16x32_bf16 v[40:43], a[104:107], a[28:31], v[40:43]
  ds_read_b64_tr_b16 a[104:105], v106 offset:40960
  ds_read_b64_tr_b16 a[106:107], v106 offset:45056
  v_mfma_f32_16x16x32_bf16 v[28:31], a[108:111], a[24:27], v[28:31]
  v_mfma_f32_16x16x32_bf16 v[44:47], a[108:111], a[28:31], v[44:47]
  s_waitcnt vmcnt(17) lgkmcnt(10)
  s_barrier
  s_mov_b64 exec, 1
  buffer_store_dword v248, v250, s[56:59], s92 offen sc1
  s_mov_b64 exec, -1
  s_add_u32 s92, s92, 65536
  v_mfma_f32_16x16x32_bf16 v[72:75], a[80:83], a[32:35], v[72:75]
  buffer_load_dwordx4 a[16:19], v240, s[4:7], s16 offen offset:0 sc1
  v_mfma_f32_16x16x32_bf16 v[88:91], a[80:83], a[36:39], v[88:91]
  ds_read_b64_tr_b16 a[108:109], v107 offset:40960
  ds_read_b64_tr_b16 a[110:111], v107 offset:45056
  v_mfma_f32_16x16x32_bf16 v[76:79], a[84:87], a[32:35], v[76:79]
  buffer_load_dwordx4 a[20:23], v240, s[4:7], s16 offen offset:1024 sc1
  v_mfma_f32_16x16x32_bf16 v[92:95], a[84:87], a[36:39], v[92:95]
  ds_read_b64_tr_b16 a[80:81], v104 offset:51200
  ds_read_b64_tr_b16 a[82:83], v104 offset:55296
  v_mfma_f32_16x16x32_bf16 v[80:83], a[88:91], a[32:35], v[80:83]
  buffer_load_dwordx4 a[24:27], v241, s[4:7], s16 offen offset:0 sc1
  v_mfma_f32_16x16x32_bf16 v[96:99], a[88:91], a[36:39], v[96:99]
  ds_read_b64_tr_b16 a[84:85], v105 offset:51200
  ds_read_b64_tr_b16 a[86:87], v105 offset:55296
  v_mfma_f32_16x16x32_bf16 v[84:87], a[92:95], a[32:35], v[84:87]
  buffer_load_dwordx4 a[28:31], v241, s[4:7], s16 offen offset:1024 sc1
  v_mfma_f32_16x16x32_bf16 v[100:103], a[92:95], a[36:39], v[100:103]
  ds_read_b64_tr_b16 a[88:89], v106 offset:51200
  ds_read_b64_tr_b16 a[90:91], v106 offset:55296
  v_mfma_f32_16x16x32_bf16 v[72:75], a[112:115], a[40:43], v[72:75]
  ds_read_b64_tr_b16 a[92:93], v107 offset:51200
  s_add_u32 s41, s41, 262144
  v_mfma_f32_16x16x32_bf16 v[88:91], a[112:115], a[44:47], v[88:91]
  ds_read_b64_tr_b16 a[94:95], v107 offset:55296
  ds_read_b64_tr_b16 a[112:113], v104 offset:59392
  v_mfma_f32_16x16x32_bf16 v[76:79], a[116:119], a[40:43], v[76:79]
  ds_read_b64_tr_b16 a[114:115], v104 offset:63488
  s_bitset0_b32 s41, 21
  v_mfma_f32_16x16x32_bf16 v[92:95], a[116:119], a[44:47], v[92:95]
  ds_read_b64_tr_b16 a[116:117], v105 offset:59392
  ds_read_b64_tr_b16 a[118:119], v105 offset:63488
  v_mfma_f32_16x16x32_bf16 v[80:83], a[120:123], a[40:43], v[80:83]
  s_add_u32 s16, s40, s41
  v_mfma_f32_16x16x32_bf16 v[96:99], a[120:123], a[44:47], v[96:99]
  ds_read_b64_tr_b16 a[120:121], v106 offset:59392
  ds_read_b64_tr_b16 a[122:123], v106 offset:63488
  v_mfma_f32_16x16x32_bf16 v[84:87], a[124:127], a[40:43], v[84:87]
  s_add_u32 m0, s38, 32768
  v_mfma_f32_16x16x32_bf16 v[100:103], a[124:127], a[44:47], v[100:103]
  ds_read_b64_tr_b16 a[124:125], v107 offset:59392
  ds_read_b64_tr_b16 a[126:127], v107 offset:63488
  v_mfma_f32_16x16x32_bf16 v[16:19], a[64:67], a[32:35], v[16:19]
  buffer_load_dwordx4 v225, s[8:11], s17 offen lds
  v_mfma_f32_16x16x32_bf16 v[32:35], a[64:67], a[36:39], v[32:35]
  ds_read_b64_tr_b16 a[64:65], v104 offset:49152
  ds_read_b64_tr_b16 a[66:67], v104 offset:53248
  v_mfma_f32_16x16x32_bf16 v[20:23], a[68:71], a[32:35], v[20:23]
  buffer_load_dwordx4 v226, s[8:11], s17 offen offset:1024 lds
  v_mfma_f32_16x16x32_bf16 v[36:39], a[68:71], a[36:39], v[36:39]
  ds_read_b64_tr_b16 a[68:69], v105 offset:49152
  ds_read_b64_tr_b16 a[70:71], v105 offset:53248
  s_waitcnt lgkmcnt(10)
  v_mfma_f32_16x16x32_bf16 v[24:27], a[72:75], a[32:35], v[24:27]
  buffer_load_dwordx4 v227, s[8:11], s17 offen offset:2048 lds
  v_mfma_f32_16x16x32_bf16 v[40:43], a[72:75], a[36:39], v[40:43]
  ds_read_b64_tr_b16 a[72:73], v106 offset:49152
  ds_read_b64_tr_b16 a[74:75], v106 offset:53248
  v_mfma_f32_16x16x32_bf16 v[28:31], a[76:79], a[32:35], v[28:31]
  buffer_load_dwordx4 v228, s[8:11], s17 offen offset:3072 lds
  v_mfma_f32_16x16x32_bf16 v[44:47], a[76:79], a[36:39], v[44:47]
  ds_read_b64_tr_b16 a[76:77], v107 offset:49152
  ds_read_b64_tr_b16 a[78:79], v107 offset:53248
  v_mfma_f32_16x16x32_bf16 v[16:19], a[96:99], a[40:43], v[16:19]
  s_add_u32 s17, s17, 458752
  v_mfma_f32_16x16x32_bf16 v[32:35], a[96:99], a[44:47], v[32:35]
  ds_read_b64_tr_b16 a[96:97], v104 offset:57344
  ds_read_b64_tr_b16 a[98:99], v104 offset:61440
  v_mfma_f32_16x16x32_bf16 v[20:23], a[100:103], a[40:43], v[20:23]
  s_cmp_eq_u32 s17, s93
  v_mfma_f32_16x16x32_bf16 v[36:39], a[100:103], a[44:47], v[36:39]
  ds_read_b64_tr_b16 a[100:101], v105 offset:57344
  ds_read_b64_tr_b16 a[102:103], v105 offset:61440
  v_mfma_f32_16x16x32_bf16 v[24:27], a[104:107], a[40:43], v[24:27]
  s_cselect_b32 s17, s95, s17
  v_mfma_f32_16x16x32_bf16 v[40:43], a[104:107], a[44:47], v[40:43]
  ds_read_b64_tr_b16 a[104:105], v106 offset:57344
  ds_read_b64_tr_b16 a[106:107], v106 offset:61440
  v_mfma_f32_16x16x32_bf16 v[28:31], a[108:111], a[40:43], v[28:31]
  v_mfma_f32_16x16x32_bf16 v[44:47], a[108:111], a[44:47], v[44:47]
  s_waitcnt vmcnt(17) lgkmcnt(10)
  s_barrier
  v_mfma_f32_16x16x32_bf16 v[72:75], a[80:83], a[48:51], v[72:75]
  buffer_load_dwordx4 a[32:35], v240, s[4:7], s16 offen offset:0 sc1
  v_mfma_f32_16x16x32_bf16 v[88:91], a[80:83], a[52:55], v[88:91]
  ds_read_b64_tr_b16 a[108:109], v107 offset:57344
  ds_read_b64_tr_b16 a[110:111], v107 offset:61440
  v_mfma_f32_16x16x32_bf16 v[76:79], a[84:87], a[48:51], v[76:79]
  buffer_load_dwordx4 a[36:39], v240, s[4:7], s16 offen offset:1024 sc1
  v_mfma_f32_16x16x32_bf16 v[92:95], a[84:87], a[52:55], v[92:95]
  ds_read_b64_tr_b16 a[80:81], v124 offset:2048
  ds_read_b64_tr_b16 a[82:83], v124 offset:6144
  v_mfma_f32_16x16x32_bf16 v[80:83], a[88:91], a[48:51], v[80:83]
  buffer_load_dwordx4 a[40:43], v241, s[4:7], s16 offen offset:0 sc1
  v_mfma_f32_16x16x32_bf16 v[96:99], a[88:91], a[52:55], v[96:99]
  ds_read_b64_tr_b16 a[84:85], v125 offset:2048
  ds_read_b64_tr_b16 a[86:87], v125 offset:6144
  v_mfma_f32_16x16x32_bf16 v[84:87], a[92:95], a[48:51], v[84:87]
  buffer_load_dwordx4 a[44:47], v241, s[4:7], s16 offen offset:1024 sc1
  v_mfma_f32_16x16x32_bf16 v[100:103], a[92:95], a[52:55], v[100:103]
  ds_read_b64_tr_b16 a[88:89], v126 offset:2048
  ds_read_b64_tr_b16 a[90:91], v126 offset:6144
  v_mfma_f32_16x16x32_bf16 v[72:75], a[112:115], a[56:59], v[72:75]
  ds_read_b64_tr_b16 a[92:93], v127 offset:2048
  s_add_u32 s41, s41, 262144
  v_mfma_f32_16x16x32_bf16 v[88:91], a[112:115], a[60:63], v[88:91]
  ds_read_b64_tr_b16 a[94:95], v127 offset:6144
  ds_read_b64_tr_b16 a[112:113], v124 offset:10240
  v_mfma_f32_16x16x32_bf16 v[76:79], a[116:119], a[56:59], v[76:79]
  ds_read_b64_tr_b16 a[114:115], v124 offset:14336
  s_bitset0_b32 s41, 21
  v_mfma_f32_16x16x32_bf16 v[92:95], a[116:119], a[60:63], v[92:95]
  ds_read_b64_tr_b16 a[116:117], v125 offset:10240
  ds_read_b64_tr_b16 a[118:119], v125 offset:14336
  v_mfma_f32_16x16x32_bf16 v[80:83], a[120:123], a[56:59], v[80:83]
  s_add_u32 s16, s40, s41
  v_mfma_f32_16x16x32_bf16 v[96:99], a[120:123], a[60:63], v[96:99]
  ds_read_b64_tr_b16 a[120:121], v126 offset:10240
  ds_read_b64_tr_b16 a[122:123], v126 offset:14336
  v_mfma_f32_16x16x32_bf16 v[84:87], a[124:127], a[56:59], v[84:87]
  s_add_u32 m0, s38, 49152
  v_mfma_f32_16x16x32_bf16 v[100:103], a[124:127], a[60:63], v[100:103]
  ds_read_b64_tr_b16 a[124:125], v127 offset:10240
  ds_read_b64_tr_b16 a[126:127], v127 offset:14336
  v_mfma_f32_16x16x32_bf16 v[16:19], a[64:67], a[48:51], v[16:19]
  buffer_load_dwordx4 v225, s[8:11], s17 offen lds
  v_mfma_f32_16x16x32_bf16 v[32:35], a[64:67], a[52:55], v[32:35]
  ds_read_b64_tr_b16 a[64:65], v124 offset:0
  ds_read_b64_tr_b16 a[66:67], v124 offset:4096
  v_mfma_f32_16x16x32_bf16 v[20:23], a[68:71], a[48:51], v[20:23]
  buffer_load_dwordx4 v226, s[8:11], s17 offen offset:1024 lds
  v_mfma_f32_16x16x32_bf16 v[36:39], a[68:71], a[52:55], v[36:39]
  ds_read_b64_tr_b16 a[68:69], v125 offset:0
  ds_read_b64_tr_b16 a[70:71], v125 offset:4096
  s_waitcnt lgkmcnt(10)
  v_mfma_f32_16x16x32_bf16 v[24:27], a[72:75], a[48:51], v[24:27]
  buffer_load_dwordx4 v227, s[8:11], s17 offen offset:2048 lds
  v_mfma_f32_16x16x32_bf16 v[40:43], a[72:75], a[52:55], v[40:43]
  ds_read_b64_tr_b16 a[72:73], v126 offset:0
  ds_read_b64_tr_b16 a[74:75], v126 offset:4096
  v_mfma_f32_16x16x32_bf16 v[28:31], a[76:79], a[48:51], v[28:31]
  buffer_load_dwordx4 v228, s[8:11], s17 offen offset:3072 lds
  v_mfma_f32_16x16x32_bf16 v[44:47], a[76:79], a[52:55], v[44:47]
  ds_read_b64_tr_b16 a[76:77], v127 offset:0
  ds_read_b64_tr_b16 a[78:79], v127 offset:4096
  v_mfma_f32_16x16x32_bf16 v[16:19], a[96:99], a[56:59], v[16:19]
  s_add_u32 s17, s17, 458752
  v_mfma_f32_16x16x32_bf16 v[32:35], a[96:99], a[60:63], v[32:35]
  ds_read_b64_tr_b16 a[96:97], v124 offset:8192
  ds_read_b64_tr_b16 a[98:99], v124 offset:12288
  v_mfma_f32_16x16x32_bf16 v[20:23], a[100:103], a[56:59], v[20:23]
  s_cmp_eq_u32 s17, s93
  v_mfma_f32_16x16x32_bf16 v[36:39], a[100:103], a[60:63], v[36:39]
  ds_read_b64_tr_b16 a[100:101], v125 offset:8192
  ds_read_b64_tr_b16 a[102:103], v125 offset:12288
  v_mfma_f32_16x16x32_bf16 v[24:27], a[104:107], a[56:59], v[24:27]
  s_cselect_b32 s17, s95, s17
  v_mfma_f32_16x16x32_bf16 v[40:43], a[104:107], a[60:63], v[40:43]
  ds_read_b64_tr_b16 a[104:105], v126 offset:8192
  ds_read_b64_tr_b16 a[106:107], v126 offset:12288
  v_mfma_f32_16x16x32_bf16 v[28:31], a[108:111], a[56:59], v[28:31]
  v_mfma_f32_16x16x32_bf16 v[44:47], a[108:111], a[60:63], v[44:47]
  s_waitcnt vmcnt(17) lgkmcnt(10)
  s_barrier
  v_mfma_f32_16x16x32_bf16 v[72:75], a[80:83], a[0:3], v[72:75]
  buffer_load_dwordx4 a[48:51], v240, s[4:7], s16 offen offset:0 sc1
  v_mfma_f32_16x16x32_bf16 v[88:91], a[80:83], a[4:7], v[88:91]
  ds_read_b64_tr_b16 a[108:109], v127 offset:8192
  ds_read_b64_tr_b16 a[110:111], v127 offset:12288
  v_mfma_f32_16x16x32_bf16 v[76:79], a[84:87], a[0:3], v[76:79]
  buffer_load_dwordx4 a[52:55], v240, s[4:7], s16 offen offset:1024 sc1
  v_mfma_f32_16x16x32_bf16 v[92:95], a[84:87], a[4:7], v[92:95]
  ds_read_b64_tr_b16 a[80:81], v242 offset:2048
  ds_read_b64_tr_b16 a[82:83], v242 offset:6144
  v_mfma_f32_16x16x32_bf16 v[80:83], a[88:91], a[0:3], v[80:83]
  buffer_load_dwordx4 a[56:59], v241, s[4:7], s16 offen offset:0 sc1
  v_mfma_f32_16x16x32_bf16 v[96:99], a[88:91], a[4:7], v[96:99]
  ds_read_b64_tr_b16 a[84:85], v243 offset:2048
  ds_read_b64_tr_b16 a[86:87], v243 offset:6144
  v_mfma_f32_16x16x32_bf16 v[84:87], a[92:95], a[0:3], v[84:87]
  buffer_load_dwordx4 a[60:63], v241, s[4:7], s16 offen offset:1024 sc1
  v_mfma_f32_16x16x32_bf16 v[100:103], a[92:95], a[4:7], v[100:103]
  ds_read_b64_tr_b16 a[88:89], v244 offset:2048
  ds_read_b64_tr_b16 a[90:91], v244 offset:6144
  v_mfma_f32_16x16x32_bf16 v[72:75], a[112:115], a[8:11], v[72:75]
  ds_read_b64_tr_b16 a[92:93], v245 offset:2048
  s_add_u32 s41, s41, 262144
  v_mfma_f32_16x16x32_bf16 v[88:91], a[112:115], a[12:15], v[88:91]
  ds_read_b64_tr_b16 a[94:95], v245 offset:6144
  ds_read_b64_tr_b16 a[112:113], v242 offset:10240
  v_mfma_f32_16x16x32_bf16 v[76:79], a[116:119], a[8:11], v[76:79]
  ds_read_b64_tr_b16 a[114:115], v242 offset:14336
  s_bitset0_b32 s41, 21
  v_mfma_f32_16x16x32_bf16 v[92:95], a[116:119], a[12:15], v[92:95]
  ds_read_b64_tr_b16 a[116:117], v243 offset:10240
  ds_read_b64_tr_b16 a[118:119], v243 offset:14336
  v_mfma_f32_16x16x32_bf16 v[80:83], a[120:123], a[8:11], v[80:83]
  s_add_u32 s16, s40, s41
  v_mfma_f32_16x16x32_bf16 v[96:99], a[120:123], a[12:15], v[96:99]
  ds_read_b64_tr_b16 a[120:121], v244 offset:10240
  ds_read_b64_tr_b16 a[122:123], v244 offset:14336
  v_mfma_f32_16x16x32_bf16 v[84:87], a[124:127], a[8:11], v[84:87]
  s_add_u32 m0, s38, 65536
  v_mfma_f32_16x16x32_bf16 v[100:103], a[124:127], a[12:15], v[100:103]
  ds_read_b64_tr_b16 a[124:125], v245 offset:10240
  ds_read_b64_tr_b16 a[126:127], v245 offset:14336
  v_mfma_f32_16x16x32_bf16 v[16:19], a[64:67], a[0:3], v[16:19]
  buffer_load_dwordx4 v225, s[8:11], s17 offen lds
  v_mfma_f32_16x16x32_bf16 v[32:35], a[64:67], a[4:7], v[32:35]
  ds_read_b64_tr_b16 a[64:65], v242 offset:0
  ds_read_b64_tr_b16 a[66:67], v242 offset:4096
  v_mfma_f32_16x16x32_bf16 v[20:23], a[68:71], a[0:3], v[20:23]
  buffer_load_dwordx4 v226, s[8:11], s17 offen offset:1024 lds
  v_mfma_f32_16x16x32_bf16 v[36:39], a[68:71], a[4:7], v[36:39]
  ds_read_b64_tr_b16 a[68:69], v243 offset:0
  ds_read_b64_tr_b16 a[70:71], v243 offset:4096
  s_waitcnt lgkmcnt(10)
  v_mfma_f32_16x16x32_bf16 v[24:27], a[72:75], a[0:3], v[24:27]
  buffer_load_dwordx4 v227, s[8:11], s17 offen offset:2048 lds
  v_mfma_f32_16x16x32_bf16 v[40:43], a[72:75], a[4:7], v[40:43]
  ds_read_b64_tr_b16 a[72:73], v244 offset:0
  ds_read_b64_tr_b16 a[74:75], v244 offset:4096
  v_mfma_f32_16x16x32_bf16 v[28:31], a[76:79], a[0:3], v[28:31]
  buffer_load_dwordx4 v228, s[8:11], s17 offen offset:3072 lds
  v_mfma_f32_16x16x32_bf16 v[44:47], a[76:79], a[4:7], v[44:47]
  ds_read_b64_tr_b16 a[76:77], v245 offset:0
  ds_read_b64_tr_b16 a[78:79], v245 offset:4096
  v_mfma_f32_16x16x32_bf16 v[16:19], a[96:99], a[8:11], v[16:19]
  s_add_u32 s17, s17, 458752
  v_mfma_f32_16x16x32_bf16 v[32:35], a[96:99], a[12:15], v[32:35]
  ds_read_b64_tr_b16 a[96:97], v242 offset:8192
  ds_read_b64_tr_b16 a[98:99], v242 offset:12288
  v_mfma_f32_16x16x32_bf16 v[20:23], a[100:103], a[8:11], v[20:23]
  s_cmp_eq_u32 s17, s93
  v_mfma_f32_16x16x32_bf16 v[36:39], a[100:103], a[12:15], v[36:39]
  ds_read_b64_tr_b16 a[100:101], v243 offset:8192
  ds_read_b64_tr_b16 a[102:103], v243 offset:12288
  v_mfma_f32_16x16x32_bf16 v[24:27], a[104:107], a[8:11], v[24:27]
  s_cselect_b32 s17, s95, s17
  v_mfma_f32_16x16x32_bf16 v[40:43], a[104:107], a[12:15], v[40:43]
  ds_read_b64_tr_b16 a[104:105], v244 offset:8192
  ds_read_b64_tr_b16 a[106:107], v244 offset:12288
  v_mfma_f32_16x16x32_bf16 v[28:31], a[108:111], a[8:11], v[28:31]
  v_mfma_f32_16x16x32_bf16 v[44:47], a[108:111], a[12:15], v[44:47]
  s_waitcnt vmcnt(20) lgkmcnt(10)
  s_barrier
  v_mfma_f32_16x16x32_bf16 v[72:75], a[80:83], a[16:19], v[72:75]
  buffer_load_dwordx4 a[0:3], v240, s[4:7], s16 offen offset:0 sc1
  v_mfma_f32_16x16x32_bf16 v[88:91], a[80:83], a[20:23], v[88:91]
  ds_read_b64_tr_b16 a[108:109], v245 offset:8192
  ds_read_b64_tr_b16 a[110:111], v245 offset:12288
  v_mfma_f32_16x16x32_bf16 v[76:79], a[84:87], a[16:19], v[76:79]
  buffer_load_dwordx4 a[4:7], v240, s[4:7], s16 offen offset:1024 sc1
  v_mfma_f32_16x16x32_bf16 v[92:95], a[84:87], a[20:23], v[92:95]
  ds_read_b64_tr_b16 a[80:81], v242 offset:18432
  ds_read_b64_tr_b16 a[82:83], v242 offset:22528
  v_mfma_f32_16x16x32_bf16 v[80:83], a[88:91], a[16:19], v[80:83]
  buffer_load_dwordx4 a[8:11], v241, s[4:7], s16 offen offset:0 sc1
  v_mfma_f32_16x16x32_bf16 v[96:99], a[88:91], a[20:23], v[96:99]
  ds_read_b64_tr_b16 a[84:85], v243 offset:18432
  ds_read_b64_tr_b16 a[86:87], v243 offset:22528
  v_mfma_f32_16x16x32_bf16 v[84:87], a[92:95], a[16:19], v[84:87]
  buffer_load_dwordx4 a[12:15], v241, s[4:7], s16 offen offset:1024 sc1
  v_mfma_f32_16x16x32_bf16 v[100:103], a[92:95], a[20:23], v[100:103]
  ds_read_b64_tr_b16 a[88:89], v244 offset:18432
  ds_read_b64_tr_b16 a[90:91], v244 offset:22528
  v_mfma_f32_16x16x32_bf16 v[72:75], a[112:115], a[24:27], v[72:75]
  ds_read_b64_tr_b16 a[92:93], v245 offset:18432
  s_add_u32 s41, s41, 262144
  v_mfma_f32_16x16x32_bf16 v[88:91], a[112:115], a[28:31], v[88:91]
  ds_read_b64_tr_b16 a[94:95], v245 offset:22528
  ds_read_b64_tr_b16 a[112:113], v242 offset:26624
  v_mfma_f32_16x16x32_bf16 v[76:79], a[116:119], a[24:27], v[76:79]
  ds_read_b64_tr_b16 a[114:115], v242 offset:30720
  s_bitset0_b32 s41, 21
  v_mfma_f32_16x16x32_bf16 v[92:95], a[116:119], a[28:31], v[92:95]
  ds_read_b64_tr_b16 a[116:117], v243 offset:26624
  ds_read_b64_tr_b16 a[118:119], v243 offset:30720
  v_mfma_f32_16x16x32_bf16 v[80:83], a[120:123], a[24:27], v[80:83]
  s_add_u32 s16, s40, s41
  v_mfma_f32_16x16x32_bf16 v[96:99], a[120:123], a[28:31], v[96:99]
  ds_read_b64_tr_b16 a[120:121], v244 offset:26624
  ds_read_b64_tr_b16 a[122:123], v244 offset:30720
  v_mfma_f32_16x16x32_bf16 v[84:87], a[124:127], a[24:27], v[84:87]
  s_add_u32 m0, s38, 81920
  v_mfma_f32_16x16x32_bf16 v[100:103], a[124:127], a[28:31], v[100:103]
  ds_read_b64_tr_b16 a[124:125], v245 offset:26624
  ds_read_b64_tr_b16 a[126:127], v245 offset:30720
  v_mfma_f32_16x16x32_bf16 v[16:19], a[64:67], a[16:19], v[16:19]
  buffer_load_dwordx4 v225, s[8:11], s17 offen lds
  v_mfma_f32_16x16x32_bf16 v[32:35], a[64:67], a[20:23], v[32:35]
  ds_read_b64_tr_b16 a[64:65], v242 offset:16384
  ds_read_b64_tr_b16 a[66:67], v242 offset:20480
  v_mfma_f32_16x16x32_bf16 v[20:23], a[68:71], a[16:19], v[20:23]
  buffer_load_dwordx4 v226, s[8:11], s17 offen offset:1024 lds
  v_mfma_f32_16x16x32_bf16 v[36:39], a[68:71], a[20:23], v[36:39]
  ds_read_b64_tr_b16 a[68:69], v243 offset:16384
  ds_read_b64_tr_b16 a[70:71], v243 offset:20480
  s_waitcnt lgkmcnt(10)
  v_mfma_f32_16x16x32_bf16 v[24:27], a[72:75], a[16:19], v[24:27]
  buffer_load_dwordx4 v227, s[8:11], s17 offen offset:2048 lds
  v_mfma_f32_16x16x32_bf16 v[40:43], a[72:75], a[20:23], v[40:43]
  ds_read_b64_tr_b16 a[72:73], v244 offset:16384
  ds_read_b64_tr_b16 a[74:75], v244 offset:20480
  v_mfma_f32_16x16x32_bf16 v[28:31], a[76:79], a[16:19], v[28:31]
  buffer_load_dwordx4 v228, s[8:11], s17 offen offset:3072 lds
  v_mfma_f32_16x16x32_bf16 v[44:47], a[76:79], a[20:23], v[44:47]
  ds_read_b64_tr_b16 a[76:77], v245 offset:16384
  ds_read_b64_tr_b16 a[78:79], v245 offset:20480
  v_mfma_f32_16x16x32_bf16 v[16:19], a[96:99], a[24:27], v[16:19]
  s_add_u32 s17, s17, 458752
  v_mfma_f32_16x16x32_bf16 v[32:35], a[96:99], a[28:31], v[32:35]
  ds_read_b64_tr_b16 a[96:97], v242 offset:24576
  ds_read_b64_tr_b16 a[98:99], v242 offset:28672
  v_mfma_f32_16x16x32_bf16 v[20:23], a[100:103], a[24:27], v[20:23]
  s_cmp_eq_u32 s17, s93
  v_mfma_f32_16x16x32_bf16 v[36:39], a[100:103], a[28:31], v[36:39]
  ds_read_b64_tr_b16 a[100:101], v243 offset:24576
  ds_read_b64_tr_b16 a[102:103], v243 offset:28672
  v_mfma_f32_16x16x32_bf16 v[24:27], a[104:107], a[24:27], v[24:27]
  s_cselect_b32 s17, s95, s17
  v_mfma_f32_16x16x32_bf16 v[40:43], a[104:107], a[28:31], v[40:43]
  ds_read_b64_tr_b16 a[104:105], v244 offset:24576
  ds_read_b64_tr_b16 a[106:107], v244 offset:28672
  v_mfma_f32_16x16x32_bf16 v[28:31], a[108:111], a[24:27], v[28:31]
  v_mfma_f32_16x16x32_bf16 v[44:47], a[108:111], a[28:31], v[44:47]
  s_waitcnt vmcnt(20) lgkmcnt(10)
  s_barrier
  v_mfma_f32_16x16x32_bf16 v[72:75], a[80:83], a[32:35], v[72:75]
  buffer_load_dwordx4 a[16:19], v240, s[4:7], s16 offen offset:0 sc1
  v_mfma_f32_16x16x32_bf16 v[88:91], a[80:83], a[36:39], v[88:91]
  ds_read_b64_tr_b16 a[108:109], v245 offset:24576
  v_accvgpr_read_b32 v0, a128
  v_mfma_f32_16x16x32_bf16 v[76:79], a[84:87], a[32:35], v[76:79]
  ds_read_b64_tr_b16 a[110:111], v245 offset:28672
  buffer_load_dwordx4 a[20:23], v240, s[4:7], s16 offen offset:1024 sc1
  v_mfma_f32_16x16x32_bf16 v[92:95], a[84:87], a[36:39], v[92:95]
  ds_read_b64_tr_b16 a[80:81], v242 offset:34816
  v_accvgpr_read_b32 v1, a129
  v_mfma_f32_16x16x32_bf16 v[80:83], a[88:91], a[32:35], v[80:83]
  ds_read_b64_tr_b16 a[82:83], v242 offset:38912
  buffer_load_dwordx4 a[24:27], v241, s[4:7], s16 offen offset:0 sc1
  v_mfma_f32_16x16x32_bf16 v[96:99], a[88:91], a[36:39], v[96:99]
  v_accvgpr_read_b32 v2, a130
  buffer_load_dwordx4 a[28:31], v241, s[4:7], s16 offen offset:1024 sc1
  v_mfma_f32_16x16x32_bf16 v[84:87], a[92:95], a[32:35], v[84:87]
  ds_read_b64_tr_b16 a[84:85], v243 offset:34816
  ds_read_b64_tr_b16 a[86:87], v243 offset:38912
  s_add_u32 s41, s41, 262144
  v_mfma_f32_16x16x32_bf16 v[100:103], a[92:95], a[36:39], v[100:103]
  ds_read_b64_tr_b16 a[88:89], v244 offset:34816
  ds_read_b64_tr_b16 a[90:91], v244 offset:38912
  v_mfma_f32_16x16x32_bf16 v[72:75], a[112:115], a[40:43], v[72:75]
  ds_read_b64_tr_b16 a[92:93], v245 offset:34816
  v_accvgpr_read_b32 v3, a131
  v_mfma_f32_16x16x32_bf16 v[88:91], a[112:115], a[44:47], v[88:91]
  ds_read_b64_tr_b16 a[94:95], v245 offset:38912
  s_bitset0_b32 s41, 21
  v_mfma_f32_16x16x32_bf16 v[76:79], a[116:119], a[40:43], v[76:79]
  ds_read_b64_tr_b16 a[112:113], v242 offset:43008
  v_lshlrev_b32 v192, 16, v0
  v_mfma_f32_16x16x32_bf16 v[92:95], a[116:119], a[44:47], v[92:95]
  ds_read_b64_tr_b16 a[114:115], v242 offset:47104
  s_add_u32 s16, s40, s41
  v_mfma_f32_16x16x32_bf16 v[80:83], a[120:123], a[40:43], v[80:83]
  v_and_b32 v193, 0xffff0000, v0
  s_add_u32 m0, s38, 98304
  v_mfma_f32_16x16x32_bf16 v[96:99], a[120:123], a[44:47], v[96:99]
  buffer_load_dwordx4 v225, s[8:11], s17 offen lds
  v_mfma_f32_16x16x32_bf16 v[84:87], a[124:127], a[40:43], v[84:87]
  ds_read_b64_tr_b16 a[116:117], v243 offset:43008
  ds_read_b64_tr_b16 a[118:119], v243 offset:47104
  v_mfma_f32_16x16x32_bf16 v[100:103], a[124:127], a[44:47], v[100:103]
  ds_read_b64_tr_b16 a[120:121], v244 offset:43008
  v_lshlrev_b32 v194, 16, v1
  v_mfma_f32_16x16x32_bf16 v[16:19], a[64:67], a[32:35], v[16:19]
  ds_read_b64_tr_b16 a[122:123], v244 offset:47104
  buffer_load_dwordx4 v226, s[8:11], s17 offen offset:1024 lds
  v_mfma_f32_16x16x32_bf16 v[32:35], a[64:67], a[36:39], v[32:35]
  v_and_b32 v195, 0xffff0000, v1
  buffer_load_dwordx4 v227, s[8:11], s17 offen offset:2048 lds
  v_mfma_f32_16x16x32_bf16 v[20:23], a[68:71], a[32:35], v[20:23]
  ds_read_b64_tr_b16 a[124:125], v245 offset:43008
  ds_read_b64_tr_b16 a[126:127], v245 offset:47104
  buffer_load_dwordx4 v228, s[8:11], s17 offen offset:3072 lds
  v_mfma_f32_16x16x32_bf16 v[36:39], a[68:71], a[36:39], v[36:39]
  ds_read_b64_tr_b16 a[64:65], v242 offset:32768
  v_lshlrev_b32 v196, 16, v2
  s_waitcnt lgkmcnt(10)
  v_mfma_f32_16x16x32_bf16 v[24:27], a[72:75], a[32:35], v[24:27]
  ds_read_b64_tr_b16 a[66:67], v242 offset:36864
  s_add_u32 s17, s17, 458752
  v_mfma_f32_16x16x32_bf16 v[40:43], a[72:75], a[36:39], v[40:43]
  ds_read_b64_tr_b16 a[68:69], v243 offset:32768
  ds_read_b64_tr_b16 a[70:71], v243 offset:36864
  v_mfma_f32_16x16x32_bf16 v[28:31], a[76:79], a[32:35], v[28:31]
  ds_read_b64_tr_b16 a[72:73], v244 offset:32768
  v_and_b32 v197, 0xffff0000, v2
  v_mfma_f32_16x16x32_bf16 v[44:47], a[76:79], a[36:39], v[44:47]
  ds_read_b64_tr_b16 a[74:75], v244 offset:36864
  s_cmp_eq_u32 s17, s93
  v_mfma_f32_16x16x32_bf16 v[16:19], a[96:99], a[40:43], v[16:19]
  v_lshlrev_b32 v198, 16, v3
  s_cselect_b32 s17, s95, s17
  v_mfma_f32_16x16x32_bf16 v[32:35], a[96:99], a[44:47], v[32:35]
  ds_read_b64_tr_b16 a[76:77], v245 offset:32768
  s_add_u32 s17, s17, 65536
  v_mfma_f32_16x16x32_bf16 v[20:23], a[100:103], a[40:43], v[20:23]
  ds_read_b64_tr_b16 a[78:79], v245 offset:36864
  v_and_b32 v199, 0xffff0000, v3
  v_mfma_f32_16x16x32_bf16 v[36:39], a[100:103], a[44:47], v[36:39]
  ds_read_b64_tr_b16 a[96:97], v242 offset:40960
  s_add_u32 s93, s93, 65536
  v_mfma_f32_16x16x32_bf16 v[24:27], a[104:107], a[40:43], v[24:27]
  ds_read_b64_tr_b16 a[98:99], v242 offset:45056
  ds_read_b64_tr_b16 a[100:101], v243 offset:40960
  v_mfma_f32_16x16x32_bf16 v[40:43], a[104:107], a[44:47], v[40:43]
  ds_read_b64_tr_b16 a[102:103], v243 offset:45056
  s_add_u32 s95, s95, 65536
  v_mfma_f32_16x16x32_bf16 v[28:31], a[108:111], a[40:43], v[28:31]
  ds_read_b64_tr_b16 a[104:105], v244 offset:40960
  ds_read_b128 v[56:59], v253 offset:768
  v_mfma_f32_16x16x32_bf16 v[44:47], a[108:111], a[44:47], v[44:47]
  s_waitcnt vmcnt(20) lgkmcnt(10)
  s_barrier
  v_mfma_f32_16x16x32_bf16 v[72:75], a[80:83], a[48:51], v[72:75]
  ds_read_b64_tr_b16 a[106:107], v244 offset:45056
  buffer_load_dwordx4 a[32:35], v240, s[4:7], s16 offen offset:0 sc1
  v_mfma_f32_16x16x32_bf16 v[88:91], a[80:83], a[52:55], v[88:91]
  ds_read_b64_tr_b16 a[108:109], v245 offset:40960
  v_accvgpr_read_b32 v4, a132
  v_mfma_f32_16x16x32_bf16 v[76:79], a[84:87], a[48:51], v[76:79]
  ds_read_b64_tr_b16 a[110:111], v245 offset:45056
  buffer_load_dwordx4 a[36:39], v240, s[4:7], s16 offen offset:1024 sc1
  v_mfma_f32_16x16x32_bf16 v[92:95], a[84:87], a[52:55], v[92:95]
  ds_read_b64_tr_b16 a[80:81], v242 offset:51200
  v_accvgpr_read_b32 v5, a133
  v_mfma_f32_16x16x32_bf16 v[80:83], a[88:91], a[48:51], v[80:83]
  ds_read_b64_tr_b16 a[82:83], v242 offset:55296
  buffer_load_dwordx4 a[40:43], v241, s[4:7], s16 offen offset:0 sc1
  v_mfma_f32_16x16x32_bf16 v[96:99], a[88:91], a[52:55], v[96:99]
  ds_read_b64_tr_b16 a[84:85], v243 offset:51200
  v_accvgpr_read_b32 v6, a134
  v_mfma_f32_16x16x32_bf16 v[84:87], a[92:95], a[48:51], v[84:87]
  ds_read_b64_tr_b16 a[86:87], v243 offset:55296
  buffer_load_dwordx4 a[44:47], v241, s[4:7], s16 offen offset:1024 sc1
  v_mfma_f32_16x16x32_bf16 v[100:103], a[92:95], a[52:55], v[100:103]
  ds_read_b64_tr_b16 a[88:89], v244 offset:51200
  ds_read_b64_tr_b16 a[90:91], v244 offset:55296
  v_mfma_f32_16x16x32_bf16 v[72:75], a[112:115], a[56:59], v[72:75]
  ds_read_b64_tr_b16 a[92:93], v245 offset:51200
  v_accvgpr_read_b32 v7, a135
  v_mfma_f32_16x16x32_bf16 v[88:91], a[112:115], a[60:63], v[88:91]
  ds_read_b64_tr_b16 a[94:95], v245 offset:55296
  s_add_u32 s41, s41, 262144
  v_mfma_f32_16x16x32_bf16 v[76:79], a[116:119], a[56:59], v[76:79]
  ds_read_b64_tr_b16 a[112:113], v242 offset:59392
  v_lshlrev_b32 v200, 16, v4
  v_mfma_f32_16x16x32_bf16 v[92:95], a[116:119], a[60:63], v[92:95]
  ds_read_b64_tr_b16 a[114:115], v242 offset:63488
  s_bitset0_b32 s41, 21
  v_mfma_f32_16x16x32_bf16 v[80:83], a[120:123], a[56:59], v[80:83]
  ds_read_b64_tr_b16 a[116:117], v243 offset:59392
  v_and_b32 v201, 0xffff0000, v4
  v_mfma_f32_16x16x32_bf16 v[96:99], a[120:123], a[60:63], v[96:99]
  ds_read_b64_tr_b16 a[118:119], v243 offset:63488
  s_add_u32 s16, s40, s41
  v_mfma_f32_16x16x32_bf16 v[84:87], a[124:127], a[56:59], v[84:87]
  ds_read_b64_tr_b16 a[120:121], v244 offset:59392
  s_add_u32 m0, s38, 114688
  v_mfma_f32_16x16x32_bf16 v[100:103], a[124:127], a[60:63], v[100:103]
  v_lshlrev_b32 v202, 16, v5
  buffer_load_dword v247, v246, s[56:59], s94 offen sc1
  v_mfma_f32_16x16x32_bf16 v[16:19], a[64:67], a[48:51], v[16:19]
  ds_read_b64_tr_b16 a[122:123], v244 offset:63488
  buffer_load_dwordx4 v225, s[8:11], s17 offen lds
  v_mfma_f32_16x16x32_bf16 v[32:35], a[64:67], a[52:55], v[32:35]
  ds_read_b64_tr_b16 a[124:125], v245 offset:59392
  v_and_b32 v203, 0xffff0000, v5
  v_mfma_f32_16x16x32_bf16 v[20:23], a[68:71], a[48:51], v[20:23]
  ds_read_b64_tr_b16 a[126:127], v245 offset:63488
  buffer_load_dwordx4 v226, s[8:11], s17 offen offset:1024 lds
  v_mfma_f32_16x16x32_bf16 v[36:39], a[68:71], a[52:55], v[36:39]
  ds_read_b64_tr_b16 a[64:65], v242 offset:49152
  v_lshlrev_b32 v204, 16, v6
  s_waitcnt lgkmcnt(10)
  v_mfma_f32_16x16x32_bf16 v[24:27], a[72:75], a[48:51], v[24:27]
  ds_read_b64_tr_b16 a[66:67], v242 offset:53248
  buffer_load_dwordx4 v227, s[8:11], s17 offen offset:2048 lds
  v_mfma_f32_16x16x32_bf16 v[40:43], a[72:75], a[52:55], v[40:43]
  ds_read_b64_tr_b16 a[68:69], v243 offset:49152
  ds_read_b64_tr_b16 a[70:71], v243 offset:53248
  v_mfma_f32_16x16x32_bf16 v[28:31], a[76:79], a[48:51], v[28:31]
  ds_read_b64_tr_b16 a[72:73], v244 offset:49152
  v_and_b32 v205, 0xffff0000, v6
  v_mfma_f32_16x16x32_bf16 v[44:47], a[76:79], a[52:55], v[44:47]
  buffer_load_dwordx4 v228, s[8:11], s17 offen offset:3072 lds
  v_mfma_f32_16x16x32_bf16 v[16:19], a[96:99], a[56:59], v[16:19]
  ds_read_b64_tr_b16 a[74:75], v244 offset:53248
  v_lshlrev_b32 v206, 16, v7
  v_mfma_f32_16x16x32_bf16 v[32:35], a[96:99], a[60:63], v[32:35]
  ds_read_b64_tr_b16 a[76:77], v245 offset:49152
  s_add_u32 s17, s17, 458752
  v_mfma_f32_16x16x32_bf16 v[20:23], a[100:103], a[56:59], v[20:23]
  ds_read_b64_tr_b16 a[78:79], v245 offset:53248
  v_and_b32 v207, 0xffff0000, v7
  v_mfma_f32_16x16x32_bf16 v[36:39], a[100:103], a[60:63], v[36:39]
  ds_read_b64_tr_b16 a[96:97], v242 offset:57344
  s_cmp_eq_u32 s17, s93
  v_mfma_f32_16x16x32_bf16 v[24:27], a[104:107], a[56:59], v[24:27]
  ds_read_b64_tr_b16 a[98:99], v242 offset:61440
  s_cselect_b32 s17, s95, s17
  v_mfma_f32_16x16x32_bf16 v[40:43], a[104:107], a[60:63], v[40:43]
  ds_read_b64_tr_b16 a[100:101], v243 offset:57344
  ds_read_b64_tr_b16 a[102:103], v243 offset:61440
  v_mfma_f32_16x16x32_bf16 v[28:31], a[108:111], a[56:59], v[28:31]
  ds_read_b64_tr_b16 a[104:105], v244 offset:57344
  ds_read_b128 v[60:63], v253 offset:832
  v_mfma_f32_16x16x32_bf16 v[44:47], a[108:111], a[60:63], v[44:47]
  s_waitcnt vmcnt(21) lgkmcnt(10)
  s_barrier
  v_mfma_f32_16x16x32_bf16 v[72:75], a[80:83], a[0:3], v[72:75]
  ds_read_b64_tr_b16 a[106:107], v244 offset:61440
  buffer_load_dwordx4 a[48:51], v240, s[4:7], s16 offen offset:0 sc1
  v_mfma_f32_16x16x32_bf16 v[88:91], a[80:83], a[4:7], v[88:91]
  ds_read_b64_tr_b16 a[108:109], v245 offset:57344
  v_accvgpr_read_b32 v8, a136
  v_mfma_f32_16x16x32_bf16 v[76:79], a[84:87], a[0:3], v[76:79]
  ds_read_b64_tr_b16 a[110:111], v245 offset:61440
  buffer_load_dwordx4 a[52:55], v240, s[4:7], s16 offen offset:1024 sc1
  v_mfma_f32_16x16x32_bf16 v[92:95], a[84:87], a[4:7], v[92:95]
  ds_read_b64_tr_b16 a[80:81], v104 offset:2048
  v_accvgpr_read_b32 v9, a137
  v_mfma_f32_16x16x32_bf16 v[80:83], a[88:91], a[0:3], v[80:83]
  ds_read_b64_tr_b16 a[82:83], v104 offset:6144
  buffer_load_dwordx4 a[56:59], v241, s[4:7], s16 offen offset:0 sc1
  v_mfma_f32_16x16x32_bf16 v[96:99], a[88:91], a[4:7], v[96:99]
  ds_read_b64_tr_b16 a[84:85], v105 offset:2048
  v_accvgpr_read_b32 v10, a138
  v_mfma_f32_16x16x32_bf16 v[84:87], a[92:95], a[0:3], v[84:87]
  ds_read_b64_tr_b16 a[86:87], v105 offset:6144
  buffer_load_dwordx4 a[60:63], v241, s[4:7], s16 offen offset:1024 sc1
  v_mfma_f32_16x16x32_bf16 v[100:103], a[92:95], a[4:7], v[100:103]
  ds_read_b64_tr_b16 a[88:89], v106 offset:2048
  s_add_u32 s41, s41, 262144
  v_mfma_f32_16x16x32_bf16 v[72:75], a[112:115], a[8:11], v[72:75]
  ds_read_b64_tr_b16 a[90:91], v106 offset:6144
  v_accvgpr_read_b32 v11, a139
  v_mfma_f32_16x16x32_bf16 v[88:91], a[112:115], a[12:15], v[88:91]
  ds_read_b64_tr_b16 a[92:93], v107 offset:2048
  s_bitset0_b32 s41, 21
  v_mfma_f32_16x16x32_bf16 v[76:79], a[116:119], a[8:11], v[76:79]
  ds_read_b64_tr_b16 a[94:95], v107 offset:6144
  v_lshlrev_b32 v208, 16, v8
  v_mfma_f32_16x16x32_bf16 v[92:95], a[116:119], a[12:15], v[92:95]
  ds_read_b64_tr_b16 a[112:113], v104 offset:10240
  s_add_u32 s40, s40, 2097152
  v_mfma_f32_16x16x32_bf16 v[80:83], a[120:123], a[8:11], v[80:83]
  ds_read_b64_tr_b16 a[114:115], v104 offset:14336
  v_and_b32 v209, 0xffff0000, v8
  v_mfma_f32_16x16x32_bf16 v[96:99], a[120:123], a[12:15], v[96:99]
  ds_read_b64_tr_b16 a[116:117], v105 offset:10240
  s_add_u32 s16, s40, s41
  v_mfma_f32_16x16x32_bf16 v[84:87], a[124:127], a[8:11], v[84:87]
  ds_read_b64_tr_b16 a[118:119], v105 offset:14336
  ds_read_b64_tr_b16 a[120:121], v106 offset:10240
  v_mfma_f32_16x16x32_bf16 v[100:103], a[124:127], a[12:15], v[100:103]
  ds_read_b64_tr_b16 a[122:123], v106 offset:14336
  v_lshlrev_b32 v210, 16, v9
  v_mfma_f32_16x16x32_bf16 v[16:19], a[64:67], a[0:3], v[16:19]
  ds_read_b64_tr_b16 a[124:125], v107 offset:10240
  s_add_u32 m0, s38, 131072
  v_mfma_f32_16x16x32_bf16 v[32:35], a[64:67], a[4:7], v[32:35]
  ds_read_b64_tr_b16 a[126:127], v107 offset:14336
  v_and_b32 v211, 0xffff0000, v9
  v_mfma_f32_16x16x32_bf16 v[20:23], a[68:71], a[0:3], v[20:23]
  buffer_load_dwordx4 v225, s[8:11], s17 offen lds
  v_mfma_f32_16x16x32_bf16 v[36:39], a[68:71], a[4:7], v[36:39]
  ds_read_b64_tr_b16 a[64:65], v104 offset:0
  v_lshlrev_b32 v212, 16, v10
  s_waitcnt lgkmcnt(10)
  v_mfma_f32_16x16x32_bf16 v[24:27], a[72:75], a[0:3], v[24:27]
  ds_read_b64_tr_b16 a[66:67], v104 offset:4096
  buffer_load_dwordx4 v226, s[8:11], s17 offen offset:1024 lds
  v_mfma_f32_16x16x32_bf16 v[40:43], a[72:75], a[4:7], v[40:43]
  buffer_load_dwordx4 v227, s[8:11], s17 offen offset:2048 lds
  v_mfma_f32_16x16x32_bf16 v[28:31], a[76:79], a[0:3], v[28:31]
  ds_read_b64_tr_b16 a[68:69], v105 offset:0
  ds_read_b64_tr_b16 a[70:71], v105 offset:4096
  v_and_b32 v213, 0xffff0000, v10
  v_mfma_f32_16x16x32_bf16 v[44:47], a[76:79], a[4:7], v[44:47]
  buffer_load_dwordx4 v228, s[8:11], s17 offen offset:3072 lds
  v_mfma_f32_16x16x32_bf16 v[16:19], a[96:99], a[8:11], v[16:19]
  ds_read_b64_tr_b16 a[72:73], v106 offset:0
  ds_read_b64_tr_b16 a[74:75], v106 offset:4096
  v_lshlrev_b32 v214, 16, v11
  v_mfma_f32_16x16x32_bf16 v[32:35], a[96:99], a[12:15], v[32:35]
  ds_read_b64_tr_b16 a[76:77], v107 offset:0
  s_add_u32 s17, s17, 458752
  v_mfma_f32_16x16x32_bf16 v[20:23], a[100:103], a[8:11], v[20:23]
  ds_read_b64_tr_b16 a[78:79], v107 offset:4096
  v_and_b32 v215, 0xffff0000, v11
  v_mfma_f32_16x16x32_bf16 v[36:39], a[100:103], a[12:15], v[36:39]
  ds_read_b64_tr_b16 a[96:97], v104 offset:8192
  s_cmp_eq_u32 s17, s93
  v_mfma_f32_16x16x32_bf16 v[24:27], a[104:107], a[8:11], v[24:27]
  ds_read_b64_tr_b16 a[98:99], v104 offset:12288
  ds_read_b64_tr_b16 a[100:101], v105 offset:8192
  v_mfma_f32_16x16x32_bf16 v[40:43], a[104:107], a[12:15], v[40:43]
  ds_read_b64_tr_b16 a[102:103], v105 offset:12288
  s_cselect_b32 s17, s95, s17
  v_mfma_f32_16x16x32_bf16 v[28:31], a[108:111], a[8:11], v[28:31]
  ds_read_b64_tr_b16 a[104:105], v106 offset:8192
  ds_read_b128 v[64:67], v253 offset:896
  v_mfma_f32_16x16x32_bf16 v[44:47], a[108:111], a[12:15], v[44:47]
  s_waitcnt vmcnt(12) lgkmcnt(10)
  s_barrier
  v_cmp_ne_u32 vcc, s19, v247
  s_nop 1
  s_cmp_lg_u64 vcc, 0
  s_cbranch_scc1 L_slow_29
  L_back_30:
  s_add_u32 s94, s94, 65536
  v_mfma_f32_16x16x32_bf16 v[72:75], a[80:83], a[16:19], v[72:75]
  ds_read_b64_tr_b16 a[106:107], v106 offset:12288
  buffer_load_dwordx4 a[0:3], v240, s[4:7], s16 offen offset:0 sc1
  v_mfma_f32_16x16x32_bf16 v[88:91], a[80:83], a[20:23], v[88:91]
  ds_read_b64_tr_b16 a[108:109], v107 offset:8192
  v_accvgpr_read_b32 v12, a140
  v_mfma_f32_16x16x32_bf16 v[76:79], a[84:87], a[16:19], v[76:79]
  ds_read_b64_tr_b16 a[110:111], v107 offset:12288
  ds_read_b64_tr_b16 a[80:81], v104 offset:18432
  v_mfma_f32_16x16x32_bf16 v[92:95], a[84:87], a[20:23], v[92:95]
  ds_read_b64_tr_b16 a[82:83], v104 offset:22528
  v_accvgpr_read_b32 v13, a141
  v_mfma_f32_16x16x32_bf16 v[80:83], a[88:91], a[16:19], v[80:83]
  buffer_load_dwordx4 a[4:7], v240, s[4:7], s16 offen offset:1024 sc1
  v_mfma_f32_16x16x32_bf16 v[96:99], a[88:91], a[20:23], v[96:99]
  ds_read_b64_tr_b16 a[84:85], v105 offset:18432
  v_accvgpr_read_b32 v14, a142
  v_mfma_f32_16x16x32_bf16 v[84:87], a[92:95], a[16:19], v[84:87]
  ds_read_b64_tr_b16 a[86:87], v105 offset:22528
  ds_read_b64_tr_b16 a[88:89], v106 offset:18432
  v_mfma_f32_16x16x32_bf16 v[100:103], a[92:95], a[20:23], v[100:103]
  ds_read_b64_tr_b16 a[90:91], v106 offset:22528
  ds_read_b64_tr_b16 a[92:93], v107 offset:18432
  v_mfma_f32_16x16x32_bf16 v[72:75], a[112:115], a[24:27], v[72:75]
  ds_read_b64_tr_b16 a[94:95], v107 offset:22528
  v_accvgpr_read_b32 v15, a143
  v_mfma_f32_16x16x32_bf16 v[88:91], a[112:115], a[28:31], v[88:91]
  buffer_load_dwordx4 a[8:11], v241, s[4:7], s16 offen offset:0 sc1
  v_mfma_f32_16x16x32_bf16 v[76:79], a[116:119], a[24:27], v[76:79]
  ds_read_b64_tr_b16 a[112:113], v104 offset:26624
  v_lshlrev_b32 v216, 16, v12
  v_mfma_f32_16x16x32_bf16 v[92:95], a[116:119], a[28:31], v[92:95]
  ds_read_b64_tr_b16 a[114:115], v104 offset:30720
  ds_read_b64_tr_b16 a[116:117], v105 offset:26624
  v_mfma_f32_16x16x32_bf16 v[80:83], a[120:123], a[24:27], v[80:83]
  ds_read_b64_tr_b16 a[118:119], v105 offset:30720
  v_and_b32 v217, 0xffff0000, v12
  v_mfma_f32_16x16x32_bf16 v[96:99], a[120:123], a[28:31], v[96:99]
  buffer_load_dwordx4 a[12:15], v241, s[4:7], s16 offen offset:1024 sc1
  v_mfma_f32_16x16x32_bf16 v[84:87], a[124:127], a[24:27], v[84:87]
  ds_read_b64_tr_b16 a[120:121], v106 offset:26624
  ds_read_b64_tr_b16 a[122:123], v106 offset:30720
  v_mfma_f32_16x16x32_bf16 v[100:103], a[124:127], a[28:31], v[100:103]
  ds_read_b64_tr_b16 a[124:125], v107 offset:26624
  v_lshlrev_b32 v218, 16, v13
  v_mfma_f32_16x16x32_bf16 v[16:19], a[64:67], a[16:19], v[16:19]
  ds_read_b64_tr_b16 a[126:127], v107 offset:30720
  v_mfma_f32_16x16x32_bf16 v[32:35], a[64:67], a[20:23], v[32:35]
  ds_read_b64_tr_b16 a[64:65], v104 offset:16384
  v_and_b32 v219, 0xffff0000, v13
  v_mfma_f32_16x16x32_bf16 v[20:23], a[68:71], a[16:19], v[20:23]
  ds_read_b64_tr_b16 a[66:67], v104 offset:20480
  s_add_u32 s41, s41, 262144
  v_mfma_f32_16x16x32_bf16 v[36:39], a[68:71], a[20:23], v[36:39]
  ds_read_b64_tr_b16 a[68:69], v105 offset:16384
  v_lshlrev_b32 v220, 16, v14
  s_waitcnt lgkmcnt(10)
  v_mfma_f32_16x16x32_bf16 v[24:27], a[72:75], a[16:19], v[24:27]
  ds_read_b64_tr_b16 a[70:71], v105 offset:20480
  v_mfma_f32_16x16x32_bf16 v[40:43], a[72:75], a[20:23], v[40:43]
  ds_read_b64_tr_b16 a[72:73], v106 offset:16384
  ds_read_b64_tr_b16 a[74:75], v106 offset:20480
  v_mfma_f32_16x16x32_bf16 v[28:31], a[76:79], a[16:19], v[28:31]
  v_and_b32 v221, 0xffff0000, v14
  v_mfma_f32_16x16x32_bf16 v[44:47], a[76:79], a[20:23], v[44:47]
  ds_read_b64_tr_b16 a[76:77], v107 offset:16384
  s_bitset0_b32 s41, 21
  v_mfma_f32_16x16x32_bf16 v[16:19], a[96:99], a[24:27], v[16:19]
  ds_read_b64_tr_b16 a[78:79], v107 offset:20480
  v_lshlrev_b32 v222, 16, v15
  v_mfma_f32_16x16x32_bf16 v[32:35], a[96:99], a[28:31], v[32:35]
  ds_read_b64_tr_b16 a[96:97], v104 offset:24576
  ds_read_b64_tr_b16 a[98:99], v104 offset:28672
  v_mfma_f32_16x16x32_bf16 v[20:23], a[100:103], a[24:27], v[20:23]
  v_and_b32 v223, 0xffff0000, v15
  v_mfma_f32_16x16x32_bf16 v[36:39], a[100:103], a[28:31], v[36:39]
  ds_read_b64_tr_b16 a[100:101], v105 offset:24576
  s_add_u32 s16, s40, s41
  v_mfma_f32_16x16x32_bf16 v[24:27], a[104:107], a[24:27], v[24:27]
  ds_read_b64_tr_b16 a[102:103], v105 offset:28672
  v_mfma_f32_16x16x32_bf16 v[40:43], a[104:107], a[28:31], v[40:43]
  ds_read_b64_tr_b16 a[104:105], v106 offset:24576
  ds_read_b64_tr_b16 a[106:107], v106 offset:28672
  v_mfma_f32_16x16x32_bf16 v[28:31], a[108:111], a[24:27], v[28:31]
  ds_read_b128 v[68:71], v253 offset:960
  v_mfma_f32_16x16x32_bf16 v[44:47], a[108:111], a[28:31], v[44:47]
  s_waitcnt vmcnt(17) lgkmcnt(10)
  s_barrier
  v_mfma_f32_16x16x32_bf16 v[72:75], a[80:83], a[32:35], v[72:75]
  buffer_load_dwordx4 a[16:19], v240, s[4:7], s16 offen offset:0 sc1
  v_mfma_f32_16x16x32_bf16 v[88:91], a[80:83], a[36:39], v[88:91]
  ds_read_b64_tr_b16 a[108:109], v107 offset:24576
  ds_read_b64_tr_b16 a[110:111], v107 offset:28672
  v_mfma_f32_16x16x32_bf16 v[76:79], a[84:87], a[32:35], v[76:79]
  buffer_load_dwordx4 a[20:23], v240, s[4:7], s16 offen offset:1024 sc1
  v_mfma_f32_16x16x32_bf16 v[92:95], a[84:87], a[36:39], v[92:95]
  ds_read_b64_tr_b16 a[80:81], v104 offset:34816
  ds_read_b64_tr_b16 a[82:83], v104 offset:38912
  v_mfma_f32_16x16x32_bf16 v[80:83], a[88:91], a[32:35], v[80:83]
  buffer_load_dwordx4 a[24:27], v241, s[4:7], s16 offen offset:0 sc1
  v_mfma_f32_16x16x32_bf16 v[96:99], a[88:91], a[36:39], v[96:99]
  ds_read_b64_tr_b16 a[84:85], v105 offset:34816
  ds_read_b64_tr_b16 a[86:87], v105 offset:38912
  v_mfma_f32_16x16x32_bf16 v[84:87], a[92:95], a[32:35], v[84:87]
  buffer_load_dwordx4 a[28:31], v241, s[4:7], s16 offen offset:1024 sc1
  v_mfma_f32_16x16x32_bf16 v[100:103], a[92:95], a[36:39], v[100:103]
  ds_read_b64_tr_b16 a[88:89], v106 offset:34816
  ds_read_b64_tr_b16 a[90:91], v106 offset:38912
  v_mfma_f32_16x16x32_bf16 v[72:75], a[112:115], a[40:43], v[72:75]
  ds_read_b64_tr_b16 a[92:93], v107 offset:34816
  s_add_u32 s41, s41, 262144
  v_mfma_f32_16x16x32_bf16 v[88:91], a[112:115], a[44:47], v[88:91]
  ds_read_b64_tr_b16 a[94:95], v107 offset:38912
  ds_read_b64_tr_b16 a[112:113], v104 offset:43008
  v_mfma_f32_16x16x32_bf16 v[76:79], a[116:119], a[40:43], v[76:79]
  ds_read_b64_tr_b16 a[114:115], v104 offset:47104
  s_bitset0_b32 s41, 21
  v_mfma_f32_16x16x32_bf16 v[92:95], a[116:119], a[44:47], v[92:95]
  ds_read_b64_tr_b16 a[116:117], v105 offset:43008
  ds_read_b64_tr_b16 a[118:119], v105 offset:47104
  v_mfma_f32_16x16x32_bf16 v[80:83], a[120:123], a[40:43], v[80:83]
  s_add_u32 s16, s40, s41
  v_mfma_f32_16x16x32_bf16 v[96:99], a[120:123], a[44:47], v[96:99]
  ds_read_b64_tr_b16 a[120:121], v106 offset:43008
  ds_read_b64_tr_b16 a[122:123], v106 offset:47104
  v_mfma_f32_16x16x32_bf16 v[84:87], a[124:127], a[40:43], v[84:87]
  s_add_u32 m0, s38, 0
  v_mfma_f32_16x16x32_bf16 v[100:103], a[124:127], a[44:47], v[100:103]
  ds_read_b64_tr_b16 a[124:125], v107 offset:43008
  ds_read_b64_tr_b16 a[126:127], v107 offset:47104
  v_mfma_f32_16x16x32_bf16 v[16:19], a[64:67], a[32:35], v[16:19]
  buffer_load_dwordx4 v225, s[8:11], s17 offen lds
  v_mfma_f32_16x16x32_bf16 v[32:35], a[64:67], a[36:39], v[32:35]
  ds_read_b64_tr_b16 a[64:65], v104 offset:32768
  ds_read_b64_tr_b16 a[66:67], v104 offset:36864
  v_mfma_f32_16x16x32_bf16 v[20:23], a[68:71], a[32:35], v[20:23]
  buffer_load_dwordx4 v226, s[8:11], s17 offen offset:1024 lds
  v_mfma_f32_16x16x32_bf16 v[36:39], a[68:71], a[36:39], v[36:39]
  ds_read_b64_tr_b16 a[68:69], v105 offset:32768
  ds_read_b64_tr_b16 a[70:71], v105 offset:36864
  s_waitcnt lgkmcnt(10)
  v_mfma_f32_16x16x32_bf16 v[24:27], a[72:75], a[32:35], v[24:27]
  buffer_load_dwordx4 v227, s[8:11], s17 offen offset:2048 lds
  v_mfma_f32_16x16x32_bf16 v[40:43], a[72:75], a[36:39], v[40:43]
  ds_read_b64_tr_b16 a[72:73], v106 offset:32768
  ds_read_b64_tr_b16 a[74:75], v106 offset:36864
  v_mfma_f32_16x16x32_bf16 v[28:31], a[76:79], a[32:35], v[28:31]
  buffer_load_dwordx4 v228, s[8:11], s17 offen offset:3072 lds
  v_mfma_f32_16x16x32_bf16 v[44:47], a[76:79], a[36:39], v[44:47]
  ds_read_b64_tr_b16 a[76:77], v107 offset:32768
  ds_read_b64_tr_b16 a[78:79], v107 offset:36864
  v_mfma_f32_16x16x32_bf16 v[16:19], a[96:99], a[40:43], v[16:19]
  s_add_u32 s17, s17, 458752
  v_mfma_f32_16x16x32_bf16 v[32:35], a[96:99], a[44:47], v[32:35]
  ds_read_b64_tr_b16 a[96:97], v104 offset:40960
  ds_read_b64_tr_b16 a[98:99], v104 offset:45056
  v_mfma_f32_16x16x32_bf16 v[20:23], a[100:103], a[40:43], v[20:23]
  s_cmp_eq_u32 s17, s93
  v_mfma_f32_16x16x32_bf16 v[36:39], a[100:103], a[44:47], v[36:39]
  ds_read_b64_tr_b16 a[100:101], v105 offset:40960
  ds_read_b64_tr_b16 a[102:103], v105 offset:45056
  v_mfma_f32_16x16x32_bf16 v[24:27], a[104:107], a[40:43], v[24:27]
  s_cselect_b32 s17, s95, s17
  v_mfma_f32_16x16x32_bf16 v[40:43], a[104:107], a[44:47], v[40:43]
  ds_read_b64_tr_b16 a[104:105], v106 offset:40960
  ds_read_b64_tr_b16 a[106:107], v106 offset:45056
  v_mfma_f32_16x16x32_bf16 v[28:31], a[108:111], a[40:43], v[28:31]
  v_mfma_f32_16x16x32_bf16 v[44:47], a[108:111], a[44:47], v[44:47]
  s_waitcnt vmcnt(16) lgkmcnt(10)
  s_barrier
  v_mfma_f32_16x16x32_bf16 v[72:75], a[80:83], a[48:51], v[72:75]
  buffer_load_dwordx4 a[32:35], v240, s[4:7], s16 offen offset:0 sc1
  v_mfma_f32_16x16x32_bf16 v[88:91], a[80:83], a[52:55], v[88:91]
  ds_read_b64_tr_b16 a[108:109], v107 offset:40960
  ds_read_b64_tr_b16 a[110:111], v107 offset:45056
  v_mfma_f32_16x16x32_bf16 v[76:79], a[84:87], a[48:51], v[76:79]
  buffer_load_dwordx4 a[36:39], v240, s[4:7], s16 offen offset:1024 sc1
  v_mfma_f32_16x16x32_bf16 v[92:95], a[84:87], a[52:55], v[92:95]
  ds_read_b64_tr_b16 a[80:81], v104 offset:51200
  ds_read_b64_tr_b16 a[82:83], v104 offset:55296
  v_mfma_f32_16x16x32_bf16 v[80:83], a[88:91], a[48:51], v[80:83]
  buffer_load_dwordx4 a[40:43], v241, s[4:7], s16 offen offset:0 sc1
  v_mfma_f32_16x16x32_bf16 v[96:99], a[88:91], a[52:55], v[96:99]
  ds_read_b64_tr_b16 a[84:85], v105 offset:51200
  ds_read_b64_tr_b16 a[86:87], v105 offset:55296
  v_mfma_f32_16x16x32_bf16 v[84:87], a[92:95], a[48:51], v[84:87]
  buffer_load_dwordx4 a[44:47], v241, s[4:7], s16 offen offset:1024 sc1
  v_mfma_f32_16x16x32_bf16 v[100:103], a[92:95], a[52:55], v[100:103]
  ds_read_b64_tr_b16 a[88:89], v106 offset:51200
  ds_read_b64_tr_b16 a[90:91], v106 offset:55296
  v_mfma_f32_16x16x32_bf16 v[72:75], a[112:115], a[56:59], v[72:75]
  ds_read_b64_tr_b16 a[92:93], v107 offset:51200
  s_add_u32 s41, s41, 262144
  v_mfma_f32_16x16x32_bf16 v[88:91], a[112:115], a[60:63], v[88:91]
  ds_read_b64_tr_b16 a[94:95], v107 offset:55296
  ds_read_b64_tr_b16 a[112:113], v104 offset:59392
  v_mfma_f32_16x16x32_bf16 v[76:79], a[116:119], a[56:59], v[76:79]
  ds_read_b64_tr_b16 a[114:115], v104 offset:63488
  s_bitset0_b32 s41, 21
  v_mfma_f32_16x16x32_bf16 v[92:95], a[116:119], a[60:63], v[92:95]
  ds_read_b64_tr_b16 a[116:117], v105 offset:59392
  ds_read_b64_tr_b16 a[118:119], v105 offset:63488
  v_mfma_f32_16x16x32_bf16 v[80:83], a[120:123], a[56:59], v[80:83]
  s_add_u32 s16, s40, s41
  v_mfma_f32_16x16x32_bf16 v[96:99], a[120:123], a[60:63], v[96:99]
  ds_read_b64_tr_b16 a[120:121], v106 offset:59392
  ds_read_b64_tr_b16 a[122:123], v106 offset:63488
  v_mfma_f32_16x16x32_bf16 v[84:87], a[124:127], a[56:59], v[84:87]
  s_add_u32 m0, s38, 16384
  v_mfma_f32_16x16x32_bf16 v[100:103], a[124:127], a[60:63], v[100:103]
  ds_read_b64_tr_b16 a[124:125], v107 offset:59392
  ds_read_b64_tr_b16 a[126:127], v107 offset:63488
  v_mfma_f32_16x16x32_bf16 v[16:19], a[64:67], a[48:51], v[16:19]
  buffer_load_dwordx4 v225, s[8:11], s17 offen lds
  v_mfma_f32_16x16x32_bf16 v[32:35], a[64:67], a[52:55], v[32:35]
  ds_read_b64_tr_b16 a[64:65], v104 offset:49152
  ds_read_b64_tr_b16 a[66:67], v104 offset:53248
  v_mfma_f32_16x16x32_bf16 v[20:23], a[68:71], a[48:51], v[20:23]
  buffer_load_dwordx4 v226, s[8:11], s17 offen offset:1024 lds
  v_mfma_f32_16x16x32_bf16 v[36:39], a[68:71], a[52:55], v[36:39]
  ds_read_b64_tr_b16 a[68:69], v105 offset:49152
  ds_read_b64_tr_b16 a[70:71], v105 offset:53248
  s_waitcnt lgkmcnt(10)
  v_mfma_f32_16x16x32_bf16 v[24:27], a[72:75], a[48:51], v[24:27]
  buffer_load_dwordx4 v227, s[8:11], s17 offen offset:2048 lds
  v_mfma_f32_16x16x32_bf16 v[40:43], a[72:75], a[52:55], v[40:43]
  ds_read_b64_tr_b16 a[72:73], v106 offset:49152
  ds_read_b64_tr_b16 a[74:75], v106 offset:53248
  v_mfma_f32_16x16x32_bf16 v[28:31], a[76:79], a[48:51], v[28:31]
  buffer_load_dwordx4 v228, s[8:11], s17 offen offset:3072 lds
  v_mfma_f32_16x16x32_bf16 v[44:47], a[76:79], a[52:55], v[44:47]
  ds_read_b64_tr_b16 a[76:77], v107 offset:49152
  ds_read_b64_tr_b16 a[78:79], v107 offset:53248
  v_mfma_f32_16x16x32_bf16 v[16:19], a[96:99], a[56:59], v[16:19]
  s_add_u32 s17, s17, 458752
  v_mfma_f32_16x16x32_bf16 v[32:35], a[96:99], a[60:63], v[32:35]
  ds_read_b64_tr_b16 a[96:97], v104 offset:57344
  ds_read_b64_tr_b16 a[98:99], v104 offset:61440
  v_mfma_f32_16x16x32_bf16 v[20:23], a[100:103], a[56:59], v[20:23]
  s_cmp_eq_u32 s17, s93
  v_mfma_f32_16x16x32_bf16 v[36:39], a[100:103], a[60:63], v[36:39]
  ds_read_b64_tr_b16 a[100:101], v105 offset:57344
  ds_read_b64_tr_b16 a[102:103], v105 offset:61440
  v_mfma_f32_16x16x32_bf16 v[24:27], a[104:107], a[56:59], v[24:27]
  s_cselect_b32 s17, s95, s17
  v_mfma_f32_16x16x32_bf16 v[40:43], a[104:107], a[60:63], v[40:43]
  ds_read_b64_tr_b16 a[104:105], v106 offset:57344
  ds_read_b64_tr_b16 a[106:107], v106 offset:61440
  v_mfma_f32_16x16x32_bf16 v[28:31], a[108:111], a[56:59], v[28:31]
  v_mfma_f32_16x16x32_bf16 v[44:47], a[108:111], a[60:63], v[44:47]
  s_waitcnt vmcnt(16) lgkmcnt(10)
  s_barrier
  v_mfma_f32_16x16x32_bf16 v[72:75], a[80:83], a[0:3], v[72:75]
  buffer_load_dwordx4 a[48:51], v240, s[4:7], s16 offen offset:0 sc1
  v_mfma_f32_16x16x32_bf16 v[88:91], a[80:83], a[4:7], v[88:91]
  ds_read_b64_tr_b16 a[108:109], v107 offset:57344
  ds_read_b64_tr_b16 a[110:111], v107 offset:61440
  v_mfma_f32_16x16x32_bf16 v[76:79], a[84:87], a[0:3], v[76:79]
  buffer_load_dwordx4 a[52:55], v240, s[4:7], s16 offen offset:1024 sc1
  v_mfma_f32_16x16x32_bf16 v[92:95], a[84:87], a[4:7], v[92:95]
  ds_read_b64_tr_b16 a[80:81], v124 offset:2048
  ds_read_b64_tr_b16 a[82:83], v124 offset:6144
  v_mfma_f32_16x16x32_bf16 v[80:83], a[88:91], a[0:3], v[80:83]
  buffer_load_dwordx4 a[56:59], v241, s[4:7], s16 offen offset:0 sc1
  v_mfma_f32_16x16x32_bf16 v[96:99], a[88:91], a[4:7], v[96:99]
  ds_read_b64_tr_b16 a[84:85], v125 offset:2048
  ds_read_b64_tr_b16 a[86:87], v125 offset:6144
  v_mfma_f32_16x16x32_bf16 v[84:87], a[92:95], a[0:3], v[84:87]
  buffer_load_dwordx4 a[60:63], v241, s[4:7], s16 offen offset:1024 sc1
  v_mfma_f32_16x16x32_bf16 v[100:103], a[92:95], a[4:7], v[100:103]
  ds_read_b64_tr_b16 a[88:89], v126 offset:2048
  ds_read_b64_tr_b16 a[90:91], v126 offset:6144
  v_mfma_f32_16x16x32_bf16 v[72:75], a[112:115], a[8:11], v[72:75]
  ds_read_b64_tr_b16 a[92:93], v127 offset:2048
  s_add_u32 s41, s41, 262144
  v_mfma_f32_16x16x32_bf16 v[88:91], a[112:115], a[12:15], v[88:91]
  ds_read_b64_tr_b16 a[94:95], v127 offset:6144
  ds_read_b64_tr_b16 a[112:113], v124 offset:10240
  v_mfma_f32_16x16x32_bf16 v[76:79], a[116:119], a[8:11], v[76:79]
  ds_read_b64_tr_b16 a[114:115], v124 offset:14336
  s_bitset0_b32 s41, 21
  v_mfma_f32_16x16x32_bf16 v[92:95], a[116:119], a[12:15], v[92:95]
  ds_read_b64_tr_b16 a[116:117], v125 offset:10240
  ds_read_b64_tr_b16 a[118:119], v125 offset:14336
  v_mfma_f32_16x16x32_bf16 v[80:83], a[120:123], a[8:11], v[80:83]
  s_add_u32 s16, s40, s41
  v_mfma_f32_16x16x32_bf16 v[96:99], a[120:123], a[12:15], v[96:99]
  ds_read_b64_tr_b16 a[120:121], v126 offset:10240
  ds_read_b64_tr_b16 a[122:123], v126 offset:14336
  v_mfma_f32_16x16x32_bf16 v[84:87], a[124:127], a[8:11], v[84:87]
  s_add_u32 m0, s38, 32768
  v_mfma_f32_16x16x32_bf16 v[100:103], a[124:127], a[12:15], v[100:103]
  ds_read_b64_tr_b16 a[124:125], v127 offset:10240
  ds_read_b64_tr_b16 a[126:127], v127 offset:14336
  v_mfma_f32_16x16x32_bf16 v[16:19], a[64:67], a[0:3], v[16:19]
  buffer_load_dwordx4 v225, s[8:11], s17 offen lds
  v_mfma_f32_16x16x32_bf16 v[32:35], a[64:67], a[4:7], v[32:35]
  ds_read_b64_tr_b16 a[64:65], v124 offset:0
  ds_read_b64_tr_b16 a[66:67], v124 offset:4096
  v_mfma_f32_16x16x32_bf16 v[20:23], a[68:71], a[0:3], v[20:23]
  buffer_load_dwordx4 v226, s[8:11], s17 offen offset:1024 lds
  v_mfma_f32_16x16x32_bf16 v[36:39], a[68:71], a[4:7], v[36:39]
  ds_read_b64_tr_b16 a[68:69], v125 offset:0
  ds_read_b64_tr_b16 a[70:71], v125 offset:4096
  s_waitcnt lgkmcnt(10)
  v_mfma_f32_16x16x32_bf16 v[24:27], a[72:75], a[0:3], v[24:27]
  buffer_load_dwordx4 v227, s[8:11], s17 offen offset:2048 lds
  v_mfma_f32_16x16x32_bf16 v[40:43], a[72:75], a[4:7], v[40:43]
  ds_read_b64_tr_b16 a[72:73], v126 offset:0
  ds_read_b64_tr_b16 a[74:75], v126 offset:4096
  v_mfma_f32_16x16x32_bf16 v[28:31], a[76:79], a[0:3], v[28:31]
  buffer_load_dwordx4 v228, s[8:11], s17 offen offset:3072 lds
  v_mfma_f32_16x16x32_bf16 v[44:47], a[76:79], a[4:7], v[44:47]
  ds_read_b64_tr_b16 a[76:77], v127 offset:0
  ds_read_b64_tr_b16 a[78:79], v127 offset:4096
  v_mfma_f32_16x16x32_bf16 v[16:19], a[96:99], a[8:11], v[16:19]
  s_add_u32 s17, s17, 458752
  v_mfma_f32_16x16x32_bf16 v[32:35], a[96:99], a[12:15], v[32:35]
  ds_read_b64_tr_b16 a[96:97], v124 offset:8192
  ds_read_b64_tr_b16 a[98:99], v124 offset:12288
  v_mfma_f32_16x16x32_bf16 v[20:23], a[100:103], a[8:11], v[20:23]
  s_cmp_eq_u32 s17, s93
  v_mfma_f32_16x16x32_bf16 v[36:39], a[100:103], a[12:15], v[36:39]
  ds_read_b64_tr_b16 a[100:101], v125 offset:8192
  ds_read_b64_tr_b16 a[102:103], v125 offset:12288
  v_mfma_f32_16x16x32_bf16 v[24:27], a[104:107], a[8:11], v[24:27]
  s_cselect_b32 s17, s95, s17
  v_mfma_f32_16x16x32_bf16 v[40:43], a[104:107], a[12:15], v[40:43]
  ds_read_b64_tr_b16 a[104:105], v126 offset:8192
  ds_read_b64_tr_b16 a[106:107], v126 offset:12288
  v_mfma_f32_16x16x32_bf16 v[28:31], a[108:111], a[8:11], v[28:31]
  v_mfma_f32_16x16x32_bf16 v[44:47], a[108:111], a[12:15], v[44:47]
  s_waitcnt vmcnt(16) lgkmcnt(10)
  s_barrier
  v_mfma_f32_16x16x32_bf16 v[72:75], a[80:83], a[16:19], v[72:75]
  buffer_load_dwordx4 a[0:3], v240, s[4:7], s16 offen offset:0 sc1
  v_mfma_f32_16x16x32_bf16 v[88:91], a[80:83], a[20:23], v[88:91]
  ds_read_b64_tr_b16 a[108:109], v127 offset:8192
  ds_read_b64_tr_b16 a[110:111], v127 offset:12288
  v_mfma_f32_16x16x32_bf16 v[76:79], a[84:87], a[16:19], v[76:79]
  buffer_load_dwordx4 a[4:7], v240, s[4:7], s16 offen offset:1024 sc1
  v_mfma_f32_16x16x32_bf16 v[92:95], a[84:87], a[20:23], v[92:95]
  ds_read_b64_tr_b16 a[80:81], v242 offset:2048
  ds_read_b64_tr_b16 a[82:83], v242 offset:6144
  v_mfma_f32_16x16x32_bf16 v[80:83], a[88:91], a[16:19], v[80:83]
  buffer_load_dwordx4 a[8:11], v241, s[4:7], s16 offen offset:0 sc1
  v_mfma_f32_16x16x32_bf16 v[96:99], a[88:91], a[20:23], v[96:99]
  ds_read_b64_tr_b16 a[84:85], v243 offset:2048
  ds_read_b64_tr_b16 a[86:87], v243 offset:6144
  v_mfma_f32_16x16x32_bf16 v[84:87], a[92:95], a[16:19], v[84:87]
  buffer_load_dwordx4 a[12:15], v241, s[4:7], s16 offen offset:1024 sc1
  v_mfma_f32_16x16x32_bf16 v[100:103], a[92:95], a[20:23], v[100:103]
  ds_read_b64_tr_b16 a[88:89], v244 offset:2048
  ds_read_b64_tr_b16 a[90:91], v244 offset:6144
  v_mfma_f32_16x16x32_bf16 v[72:75], a[112:115], a[24:27], v[72:75]
  ds_read_b64_tr_b16 a[92:93], v245 offset:2048
  s_add_u32 s41, s41, 262144
  v_mfma_f32_16x16x32_bf16 v[88:91], a[112:115], a[28:31], v[88:91]
  ds_read_b64_tr_b16 a[94:95], v245 offset:6144
  ds_read_b64_tr_b16 a[112:113], v242 offset:10240
  v_mfma_f32_16x16x32_bf16 v[76:79], a[116:119], a[24:27], v[76:79]
  ds_read_b64_tr_b16 a[114:115], v242 offset:14336
  s_bitset0_b32 s41, 21
  v_mfma_f32_16x16x32_bf16 v[92:95], a[116:119], a[28:31], v[92:95]
  ds_read_b64_tr_b16 a[116:117], v243 offset:10240
  ds_read_b64_tr_b16 a[118:119], v243 offset:14336
  v_mfma_f32_16x16x32_bf16 v[80:83], a[120:123], a[24:27], v[80:83]
  s_add_u32 s16, s40, s41
  v_mfma_f32_16x16x32_bf16 v[96:99], a[120:123], a[28:31], v[96:99]
  ds_read_b64_tr_b16 a[120:121], v244 offset:10240
  ds_read_b64_tr_b16 a[122:123], v244 offset:14336
  v_mfma_f32_16x16x32_bf16 v[84:87], a[124:127], a[24:27], v[84:87]
  s_add_u32 m0, s38, 49152
  v_mfma_f32_16x16x32_bf16 v[100:103], a[124:127], a[28:31], v[100:103]
  ds_read_b64_tr_b16 a[124:125], v245 offset:10240
  ds_read_b64_tr_b16 a[126:127], v245 offset:14336
  v_mfma_f32_16x16x32_bf16 v[16:19], a[64:67], a[16:19], v[16:19]
  buffer_load_dwordx4 v225, s[8:11], s17 offen lds
  v_mfma_f32_16x16x32_bf16 v[32:35], a[64:67], a[20:23], v[32:35]
  ds_read_b64_tr_b16 a[64:65], v242 offset:0
  ds_read_b64_tr_b16 a[66:67], v242 offset:4096
  v_mfma_f32_16x16x32_bf16 v[20:23], a[68:71], a[16:19], v[20:23]
  buffer_load_dwordx4 v226, s[8:11], s17 offen offset:1024 lds
  v_mfma_f32_16x16x32_bf16 v[36:39], a[68:71], a[20:23], v[36:39]
  ds_read_b64_tr_b16 a[68:69], v243 offset:0
  ds_read_b64_tr_b16 a[70:71], v243 offset:4096
  s_waitcnt lgkmcnt(10)
  v_mfma_f32_16x16x32_bf16 v[24:27], a[72:75], a[16:19], v[24:27]
  buffer_load_dwordx4 v227, s[8:11], s17 offen offset:2048 lds
  v_mfma_f32_16x16x32_bf16 v[40:43], a[72:75], a[20:23], v[40:43]
  ds_read_b64_tr_b16 a[72:73], v244 offset:0
  ds_read_b64_tr_b16 a[74:75], v244 offset:4096
  v_mfma_f32_16x16x32_bf16 v[28:31], a[76:79], a[16:19], v[28:31]
  buffer_load_dwordx4 v228, s[8:11], s17 offen offset:3072 lds
  v_mfma_f32_16x16x32_bf16 v[44:47], a[76:79], a[20:23], v[44:47]
  ds_read_b64_tr_b16 a[76:77], v245 offset:0
  ds_read_b64_tr_b16 a[78:79], v245 offset:4096
  v_mfma_f32_16x16x32_bf16 v[16:19], a[96:99], a[24:27], v[16:19]
  s_add_u32 s17, s17, 458752
  v_mfma_f32_16x16x32_bf16 v[32:35], a[96:99], a[28:31], v[32:35]
  ds_read_b64_tr_b16 a[96:97], v242 offset:8192
  ds_read_b64_tr_b16 a[98:99], v242 offset:12288
  v_mfma_f32_16x16x32_bf16 v[20:23], a[100:103], a[24:27], v[20:23]
  s_cmp_eq_u32 s17, s93
  v_mfma_f32_16x16x32_bf16 v[36:39], a[100:103], a[28:31], v[36:39]
  ds_read_b64_tr_b16 a[100:101], v243 offset:8192
  ds_read_b64_tr_b16 a[102:103], v243 offset:12288
  v_mfma_f32_16x16x32_bf16 v[24:27], a[104:107], a[24:27], v[24:27]
  s_cselect_b32 s17, s95, s17
  v_mfma_f32_16x16x32_bf16 v[40:43], a[104:107], a[28:31], v[40:43]
  ds_read_b64_tr_b16 a[104:105], v244 offset:8192
  ds_read_b64_tr_b16 a[106:107], v244 offset:12288
  v_mfma_f32_16x16x32_bf16 v[28:31], a[108:111], a[24:27], v[28:31]
  v_mfma_f32_16x16x32_bf16 v[44:47], a[108:111], a[28:31], v[44:47]
  s_waitcnt vmcnt(16) lgkmcnt(10)
  s_barrier
  v_mfma_f32_16x16x32_bf16 v[72:75], a[80:83], a[32:35], v[72:75]
  buffer_load_dwordx4 a[16:19], v240, s[4:7], s16 offen offset:0 sc1
  v_mfma_f32_16x16x32_bf16 v[88:91], a[80:83], a[36:39], v[88:91]
  ds_read_b64_tr_b16 a[108:109], v245 offset:8192
  ds_read_b64_tr_b16 a[110:111], v245 offset:12288
  v_mfma_f32_16x16x32_bf16 v[76:79], a[84:87], a[32:35], v[76:79]
  buffer_load_dwordx4 a[20:23], v240, s[4:7], s16 offen offset:1024 sc1
  v_mfma_f32_16x16x32_bf16 v[92:95], a[84:87], a[36:39], v[92:95]
  ds_read_b64_tr_b16 a[80:81], v242 offset:18432
  ds_read_b64_tr_b16 a[82:83], v242 offset:22528
  v_mfma_f32_16x16x32_bf16 v[80:83], a[88:91], a[32:35], v[80:83]
  buffer_load_dwordx4 a[24:27], v241, s[4:7], s16 offen offset:0 sc1
  v_mfma_f32_16x16x32_bf16 v[96:99], a[88:91], a[36:39], v[96:99]
  ds_read_b64_tr_b16 a[84:85], v243 offset:18432
  ds_read_b64_tr_b16 a[86:87], v243 offset:22528
  v_mfma_f32_16x16x32_bf16 v[84:87], a[92:95], a[32:35], v[84:87]
  buffer_load_dwordx4 a[28:31], v241, s[4:7], s16 offen offset:1024 sc1
  v_mfma_f32_16x16x32_bf16 v[100:103], a[92:95], a[36:39], v[100:103]
  ds_read_b64_tr_b16 a[88:89], v244 offset:18432
  ds_read_b64_tr_b16 a[90:91], v244 offset:22528
  v_mfma_f32_16x16x32_bf16 v[72:75], a[112:115], a[40:43], v[72:75]
  ds_read_b64_tr_b16 a[92:93], v245 offset:18432
  s_add_u32 s41, s41, 262144
  v_mfma_f32_16x16x32_bf16 v[88:91], a[112:115], a[44:47], v[88:91]
  ds_read_b64_tr_b16 a[94:95], v245 offset:22528
  ds_read_b64_tr_b16 a[112:113], v242 offset:26624
  v_mfma_f32_16x16x32_bf16 v[76:79], a[116:119], a[40:43], v[76:79]
  ds_read_b64_tr_b16 a[114:115], v242 offset:30720
  s_bitset0_b32 s41, 21
  v_mfma_f32_16x16x32_bf16 v[92:95], a[116:119], a[44:47], v[92:95]
  ds_read_b64_tr_b16 a[116:117], v243 offset:26624
  ds_read_b64_tr_b16 a[118:119], v243 offset:30720
  v_mfma_f32_16x16x32_bf16 v[80:83], a[120:123], a[40:43], v[80:83]
  s_add_u32 s16, s40, s41
  v_mfma_f32_16x16x32_bf16 v[96:99], a[120:123], a[44:47], v[96:99]
  ds_read_b64_tr_b16 a[120:121], v244 offset:26624
  ds_read_b64_tr_b16 a[122:123], v244 offset:30720
  v_mfma_f32_16x16x32_bf16 v[84:87], a[124:127], a[40:43], v[84:87]
  s_add_u32 m0, s38, 65536
  v_mfma_f32_16x16x32_bf16 v[100:103], a[124:127], a[44:47], v[100:103]
  ds_read_b64_tr_b16 a[124:125], v245 offset:26624
  ds_read_b64_tr_b16 a[126:127], v245 offset:30720
  v_mfma_f32_16x16x32_bf16 v[16:19], a[64:67], a[32:35], v[16:19]
  buffer_load_dwordx4 v225, s[8:11], s17 offen lds
  v_mfma_f32_16x16x32_bf16 v[32:35], a[64:67], a[36:39], v[32:35]
  ds_read_b64_tr_b16 a[64:65], v242 offset:16384
  ds_read_b64_tr_b16 a[66:67], v242 offset:20480
  v_mfma_f32_16x16x32_bf16 v[20:23], a[68:71], a[32:35], v[20:23]
  buffer_load_dwordx4 v226, s[8:11], s17 offen offset:1024 lds
  v_mfma_f32_16x16x32_bf16 v[36:39], a[68:71], a[36:39], v[36:39]
  ds_read_b64_tr_b16 a[68:69], v243 offset:16384
  ds_read_b64_tr_b16 a[70:71], v243 offset:20480
  s_waitcnt lgkmcnt(10)
  v_mfma_f32_16x16x32_bf16 v[24:27], a[72:75], a[32:35], v[24:27]
  buffer_load_dwordx4 v227, s[8:11], s17 offen offset:2048 lds
  v_mfma_f32_16x16x32_bf16 v[40:43], a[72:75], a[36:39], v[40:43]
  ds_read_b64_tr_b16 a[72:73], v244 offset:16384
  ds_read_b64_tr_b16 a[74:75], v244 offset:20480
  v_mfma_f32_16x16x32_bf16 v[28:31], a[76:79], a[32:35], v[28:31]
  buffer_load_dwordx4 v228, s[8:11], s17 offen offset:3072 lds
  v_mfma_f32_16x16x32_bf16 v[44:47], a[76:79], a[36:39], v[44:47]
  ds_read_b64_tr_b16 a[76:77], v245 offset:16384
  ds_read_b64_tr_b16 a[78:79], v245 offset:20480
  v_mfma_f32_16x16x32_bf16 v[16:19], a[96:99], a[40:43], v[16:19]
  s_add_u32 s17, s17, 458752
  v_mfma_f32_16x16x32_bf16 v[32:35], a[96:99], a[44:47], v[32:35]
  ds_read_b64_tr_b16 a[96:97], v242 offset:24576
  ds_read_b64_tr_b16 a[98:99], v242 offset:28672
  v_mfma_f32_16x16x32_bf16 v[20:23], a[100:103], a[40:43], v[20:23]
  s_cmp_eq_u32 s17, s93
  v_mfma_f32_16x16x32_bf16 v[36:39], a[100:103], a[44:47], v[36:39]
  ds_read_b64_tr_b16 a[100:101], v243 offset:24576
  ds_read_b64_tr_b16 a[102:103], v243 offset:28672
  v_mfma_f32_16x16x32_bf16 v[24:27], a[104:107], a[40:43], v[24:27]
  s_cselect_b32 s17, s95, s17
  v_mfma_f32_16x16x32_bf16 v[40:43], a[104:107], a[44:47], v[40:43]
  ds_read_b64_tr_b16 a[104:105], v244 offset:24576
  ds_read_b64_tr_b16 a[106:107], v244 offset:28672
  v_mfma_f32_16x16x32_bf16 v[28:31], a[108:111], a[40:43], v[28:31]
  v_mfma_f32_16x16x32_bf16 v[44:47], a[108:111], a[44:47], v[44:47]
  s_waitcnt vmcnt(16) lgkmcnt(10)
  s_barrier
  v_mfma_f32_16x16x32_bf16 v[72:75], a[80:83], a[48:51], v[72:75]
  buffer_load_dwordx4 a[32:35], v240, s[4:7], s16 offen offset:0 sc1
  v_mfma_f32_16x16x32_bf16 v[88:91], a[80:83], a[52:55], v[88:91]
  ds_read_b64_tr_b16 a[108:109], v245 offset:24576
  ds_read_b64_tr_b16 a[110:111], v245 offset:28672
  v_mfma_f32_16x16x32_bf16 v[76:79], a[84:87], a[48:51], v[76:79]
  buffer_load_dwordx4 a[36:39], v240, s[4:7], s16 offen offset:1024 sc1
  v_mfma_f32_16x16x32_bf16 v[92:95], a[84:87], a[52:55], v[92:95]
  ds_read_b64_tr_b16 a[80:81], v242 offset:34816
  ds_read_b64_tr_b16 a[82:83], v242 offset:38912
  v_mfma_f32_16x16x32_bf16 v[80:83], a[88:91], a[48:51], v[80:83]
  buffer_load_dwordx4 a[40:43], v241, s[4:7], s16 offen offset:0 sc1
  v_mfma_f32_16x16x32_bf16 v[96:99], a[88:91], a[52:55], v[96:99]
  ds_read_b64_tr_b16 a[84:85], v243 offset:34816
  ds_read_b64_tr_b16 a[86:87], v243 offset:38912
  v_mfma_f32_16x16x32_bf16 v[84:87], a[92:95], a[48:51], v[84:87]
  ds_read_b64_tr_b16 a[88:89], v244 offset:34816
  ds_read_b64_tr_b16 a[90:91], v244 offset:38912
  v_mfma_f32_16x16x32_bf16 v[100:103], a[92:95], a[52:55], v[100:103]
  buffer_load_dwordx4 a[44:47], v241, s[4:7], s16 offen offset:1024 sc1
  v_mfma_f32_16x16x32_bf16 v[72:75], a[112:115], a[56:59], v[72:75]
  ds_read_b64_tr_b16 a[92:93], v245 offset:34816
  ds_read_b64_tr_b16 a[94:95], v245 offset:38912
  v_mfma_f32_16x16x32_bf16 v[88:91], a[112:115], a[60:63], v[88:91]
  ds_read_b64_tr_b16 a[112:113], v242 offset:43008
  s_add_u32 s41, s41, 262144
  v_mfma_f32_16x16x32_bf16 v[76:79], a[116:119], a[56:59], v[76:79]
  ds_read_b64_tr_b16 a[114:115], v242 offset:47104
  v_mfma_f32_16x16x32_bf16 v[92:95], a[116:119], a[60:63], v[92:95]
  ds_read_b64_tr_b16 a[116:117], v243 offset:43008
  s_bitset0_b32 s41, 21
  v_mfma_f32_16x16x32_bf16 v[80:83], a[120:123], a[56:59], v[80:83]
  ds_read_b64_tr_b16 a[118:119], v243 offset:47104
  v_mfma_f32_16x16x32_bf16 v[96:99], a[120:123], a[60:63], v[96:99]
  ds_read_b64_tr_b16 a[120:121], v244 offset:43008
  ds_read_b64_tr_b16 a[122:123], v244 offset:47104
  v_mfma_f32_16x16x32_bf16 v[84:87], a[124:127], a[56:59], v[84:87]
  s_add_u32 s16, s40, s41
  v_mfma_f32_16x16x32_bf16 v[100:103], a[124:127], a[60:63], v[100:103]
  ds_read_b64_tr_b16 a[124:125], v245 offset:43008
  ds_read_b64_tr_b16 a[126:127], v245 offset:47104
  v_mfma_f32_16x16x32_bf16 v[16:19], a[64:67], a[48:51], v[16:19]
  s_add_u32 m0, s38, 81920
  v_mfma_f32_16x16x32_bf16 v[32:35], a[64:67], a[52:55], v[32:35]
  ds_read_b64_tr_b16 a[64:65], v242 offset:32768
  ds_read_b64_tr_b16 a[66:67], v242 offset:36864
  v_mfma_f32_16x16x32_bf16 v[20:23], a[68:71], a[48:51], v[20:23]
  v_mfma_f32_16x16x32_bf16 v[36:39], a[68:71], a[52:55], v[36:39]
  buffer_load_dwordx4 v225, s[8:11], s17 offen lds
  s_waitcnt lgkmcnt(10)
  v_mfma_f32_16x16x32_bf16 v[24:27], a[72:75], a[48:51], v[24:27]
  ds_read_b64_tr_b16 a[68:69], v243 offset:32768
  ds_read_b64_tr_b16 a[70:71], v243 offset:36864
  v_mfma_f32_16x16x32_bf16 v[40:43], a[72:75], a[52:55], v[40:43]
  buffer_load_dwordx4 v226, s[8:11], s17 offen offset:1024 lds
  v_mfma_f32_16x16x32_bf16 v[28:31], a[76:79], a[48:51], v[28:31]
  ds_read_b64_tr_b16 a[72:73], v244 offset:32768
  ds_read_b64_tr_b16 a[74:75], v244 offset:36864
  v_mfma_f32_16x16x32_bf16 v[44:47], a[76:79], a[52:55], v[44:47]
  buffer_load_dwordx4 v227, s[8:11], s17 offen offset:2048 lds
  v_mfma_f32_16x16x32_bf16 v[16:19], a[96:99], a[56:59], v[16:19]
  ds_read_b64_tr_b16 a[76:77], v245 offset:32768
  ds_read_b64_tr_b16 a[78:79], v245 offset:36864
  v_mfma_f32_16x16x32_bf16 v[32:35], a[96:99], a[60:63], v[32:35]
  ds_read_b64_tr_b16 a[96:97], v242 offset:40960
  ds_read_b64_tr_b16 a[98:99], v242 offset:45056
  v_mfma_f32_16x16x32_bf16 v[20:23], a[100:103], a[56:59], v[20:23]
  buffer_load_dwordx4 v228, s[8:11], s17 offen offset:3072 lds
  v_mfma_f32_16x16x32_bf16 v[36:39], a[100:103], a[60:63], v[36:39]
  ds_read_b64_tr_b16 a[100:101], v243 offset:40960
  ds_read_b64_tr_b16 a[102:103], v243 offset:45056
  v_mfma_f32_16x16x32_bf16 v[24:27], a[104:107], a[56:59], v[24:27]
  s_mov_b32 s17, s97
  v_mfma_f32_16x16x32_bf16 v[40:43], a[104:107], a[60:63], v[40:43]
  ds_read_b64_tr_b16 a[104:105], v244 offset:40960
  ds_read_b64_tr_b16 a[106:107], v244 offset:45056
  v_mfma_f32_16x16x32_bf16 v[28:31], a[108:111], a[56:59], v[28:31]
  v_mfma_f32_16x16x32_bf16 v[44:47], a[108:111], a[60:63], v[44:47]
  s_waitcnt vmcnt(16) lgkmcnt(10)
  s_barrier
  v_mfma_f32_16x16x32_bf16 v[72:75], a[80:83], a[0:3], v[72:75]
  buffer_load_dwordx4 a[48:51], v240, s[4:7], s16 offen offset:0 sc1
  v_mfma_f32_16x16x32_bf16 v[88:91], a[80:83], a[4:7], v[88:91]
  ds_read_b64_tr_b16 a[108:109], v245 offset:40960
  ds_read_b64_tr_b16 a[110:111], v245 offset:45056
  v_mfma_f32_16x16x32_bf16 v[76:79], a[84:87], a[0:3], v[76:79]
  buffer_load_dwordx4 a[52:55], v240, s[4:7], s16 offen offset:1024 sc1
  v_mfma_f32_16x16x32_bf16 v[92:95], a[84:87], a[4:7], v[92:95]
  ds_read_b64_tr_b16 a[80:81], v242 offset:51200
  ds_read_b64_tr_b16 a[82:83], v242 offset:55296
  v_mfma_f32_16x16x32_bf16 v[80:83], a[88:91], a[0:3], v[80:83]
  buffer_load_dwordx4 a[56:59], v241, s[4:7], s16 offen offset:0 sc1
  v_mfma_f32_16x16x32_bf16 v[96:99], a[88:91], a[4:7], v[96:99]
  ds_read_b64_tr_b16 a[84:85], v243 offset:51200
  ds_read_b64_tr_b16 a[86:87], v243 offset:55296
  v_mfma_f32_16x16x32_bf16 v[84:87], a[92:95], a[0:3], v[84:87]
  ds_read_b64_tr_b16 a[88:89], v244 offset:51200
  ds_read_b64_tr_b16 a[90:91], v244 offset:55296
  v_mfma_f32_16x16x32_bf16 v[100:103], a[92:95], a[4:7], v[100:103]
  buffer_load_dwordx4 a[60:63], v241, s[4:7], s16 offen offset:1024 sc1
  v_mfma_f32_16x16x32_bf16 v[72:75], a[112:115], a[8:11], v[72:75]
  ds_read_b64_tr_b16 a[92:93], v245 offset:51200
  ds_read_b64_tr_b16 a[94:95], v245 offset:55296
  v_mfma_f32_16x16x32_bf16 v[88:91], a[112:115], a[12:15], v[88:91]
  ds_read_b64_tr_b16 a[112:113], v242 offset:59392
  s_add_u32 s16, s40, 2097152
  v_mfma_f32_16x16x32_bf16 v[76:79], a[116:119], a[8:11], v[76:79]
  ds_read_b64_tr_b16 a[114:115], v242 offset:63488
  v_mfma_f32_16x16x32_bf16 v[92:95], a[116:119], a[12:15], v[92:95]
  ds_read_b64_tr_b16 a[116:117], v243 offset:59392
  s_add_u32 m0, s38, 98304
  v_mfma_f32_16x16x32_bf16 v[80:83], a[120:123], a[8:11], v[80:83]
  ds_read_b64_tr_b16 a[118:119], v243 offset:63488
  v_mfma_f32_16x16x32_bf16 v[96:99], a[120:123], a[12:15], v[96:99]
  ds_read_b64_tr_b16 a[120:121], v244 offset:59392
  ds_read_b64_tr_b16 a[122:123], v244 offset:63488
  v_mfma_f32_16x16x32_bf16 v[84:87], a[124:127], a[8:11], v[84:87]
  buffer_load_dwordx4 v227, s[8:11], s17 offen offset:2048 lds
  v_mfma_f32_16x16x32_bf16 v[100:103], a[124:127], a[12:15], v[100:103]
  ds_read_b64_tr_b16 a[124:125], v245 offset:59392
  ds_read_b64_tr_b16 a[126:127], v245 offset:63488
  v_mfma_f32_16x16x32_bf16 v[16:19], a[64:67], a[0:3], v[16:19]
  buffer_load_dwordx4 v228, s[8:11], s17 offen offset:3072 lds
  v_mfma_f32_16x16x32_bf16 v[32:35], a[64:67], a[4:7], v[32:35]
  ds_read_b64_tr_b16 a[64:65], v242 offset:49152
  ds_read_b64_tr_b16 a[66:67], v242 offset:53248
  v_mfma_f32_16x16x32_bf16 v[20:23], a[68:71], a[0:3], v[20:23]
  v_mfma_f32_16x16x32_bf16 v[36:39], a[68:71], a[4:7], v[36:39]
  ds_read_b64_tr_b16 a[68:69], v243 offset:49152
  s_add_u32 s17, s17, 917504
  s_waitcnt lgkmcnt(10)
  v_mfma_f32_16x16x32_bf16 v[24:27], a[72:75], a[0:3], v[24:27]
  ds_read_b64_tr_b16 a[70:71], v243 offset:53248
  v_mfma_f32_16x16x32_bf16 v[40:43], a[72:75], a[4:7], v[40:43]
  ds_read_b64_tr_b16 a[72:73], v244 offset:49152
  s_add_u32 m0, s38, 96256
  v_mfma_f32_16x16x32_bf16 v[28:31], a[76:79], a[0:3], v[28:31]
  ds_read_b64_tr_b16 a[74:75], v244 offset:53248
  v_mfma_f32_16x16x32_bf16 v[44:47], a[76:79], a[4:7], v[44:47]
  buffer_load_dwordx4 v227, s[8:11], s17 offen offset:2048 lds
  v_mfma_f32_16x16x32_bf16 v[16:19], a[96:99], a[8:11], v[16:19]
  ds_read_b64_tr_b16 a[76:77], v245 offset:49152
  ds_read_b64_tr_b16 a[78:79], v245 offset:53248
  v_mfma_f32_16x16x32_bf16 v[32:35], a[96:99], a[12:15], v[32:35]
  ds_read_b64_tr_b16 a[96:97], v242 offset:57344
  ds_read_b64_tr_b16 a[98:99], v242 offset:61440
  v_mfma_f32_16x16x32_bf16 v[20:23], a[100:103], a[8:11], v[20:23]
  buffer_load_dwordx4 v228, s[8:11], s17 offen offset:3072 lds
  v_mfma_f32_16x16x32_bf16 v[36:39], a[100:103], a[12:15], v[36:39]
  ds_read_b64_tr_b16 a[100:101], v243 offset:57344
  ds_read_b64_tr_b16 a[102:103], v243 offset:61440
  v_mfma_f32_16x16x32_bf16 v[24:27], a[104:107], a[8:11], v[24:27]
  s_add_u32 s17, s17, 917504
  v_mfma_f32_16x16x32_bf16 v[40:43], a[104:107], a[12:15], v[40:43]
  ds_read_b64_tr_b16 a[104:105], v244 offset:57344
  ds_read_b64_tr_b16 a[106:107], v244 offset:61440
  v_mfma_f32_16x16x32_bf16 v[28:31], a[108:111], a[8:11], v[28:31]
  v_mfma_f32_16x16x32_bf16 v[44:47], a[108:111], a[12:15], v[44:47]
  s_waitcnt vmcnt(16) lgkmcnt(10)
  s_barrier
  v_mfma_f32_16x16x32_bf16 v[72:75], a[80:83], a[16:19], v[72:75]
  buffer_load_dwordx4 v[128:131], v240, s[4:7], s16 offen offset:0 sc1
  v_mfma_f32_16x16x32_bf16 v[88:91], a[80:83], a[20:23], v[88:91]
  ds_read_b64_tr_b16 a[108:109], v245 offset:57344
  ds_read_b64_tr_b16 a[110:111], v245 offset:61440
  v_mfma_f32_16x16x32_bf16 v[76:79], a[84:87], a[16:19], v[76:79]
  ds_read_b64_tr_b16 a[80:81], v104 offset:2048
  ds_read_b64_tr_b16 a[82:83], v104 offset:6144
  v_mfma_f32_16x16x32_bf16 v[92:95], a[84:87], a[20:23], v[92:95]
  buffer_load_dwordx4 v[132:135], v240, s[4:7], s16 offen offset:1024 sc1
  v_mfma_f32_16x16x32_bf16 v[80:83], a[88:91], a[16:19], v[80:83]
  ds_read_b64_tr_b16 a[84:85], v105 offset:2048
  ds_read_b64_tr_b16 a[86:87], v105 offset:6144
  v_mfma_f32_16x16x32_bf16 v[96:99], a[88:91], a[20:23], v[96:99]
  ds_read_b64_tr_b16 a[88:89], v106 offset:2048
  ds_read_b64_tr_b16 a[90:91], v106 offset:6144
  v_mfma_f32_16x16x32_bf16 v[84:87], a[92:95], a[16:19], v[84:87]
  buffer_load_dwordx4 v[136:139], v241, s[4:7], s16 offen offset:0 sc1
  v_mfma_f32_16x16x32_bf16 v[100:103], a[92:95], a[20:23], v[100:103]
  ds_read_b64_tr_b16 a[92:93], v107 offset:2048
  ds_read_b64_tr_b16 a[94:95], v107 offset:6144
  v_mfma_f32_16x16x32_bf16 v[72:75], a[112:115], a[24:27], v[72:75]
  v_mfma_f32_16x16x32_bf16 v[88:91], a[112:115], a[28:31], v[88:91]
  buffer_load_dwordx4 v[140:143], v241, s[4:7], s16 offen offset:1024 sc1
  v_mfma_f32_16x16x32_bf16 v[76:79], a[116:119], a[24:27], v[76:79]
  ds_read_b64_tr_b16 a[112:113], v104 offset:10240
  ds_read_b64_tr_b16 a[114:115], v104 offset:14336
  v_mfma_f32_16x16x32_bf16 v[92:95], a[116:119], a[28:31], v[92:95]
  ds_read_b64_tr_b16 a[116:117], v105 offset:10240
  ds_read_b64_tr_b16 a[118:119], v105 offset:14336
  v_mfma_f32_16x16x32_bf16 v[80:83], a[120:123], a[24:27], v[80:83]
  s_add_u32 s16, s16, 262144
  v_mfma_f32_16x16x32_bf16 v[96:99], a[120:123], a[28:31], v[96:99]
  ds_read_b64_tr_b16 a[120:121], v106 offset:10240
  ds_read_b64_tr_b16 a[122:123], v106 offset:14336
  v_mfma_f32_16x16x32_bf16 v[84:87], a[124:127], a[24:27], v[84:87]
  v_mfma_f32_16x16x32_bf16 v[100:103], a[124:127], a[28:31], v[100:103]
  buffer_load_dwordx4 v[144:147], v240, s[4:7], s16 offen offset:0 sc1
  v_mfma_f32_16x16x32_bf16 v[16:19], a[64:67], a[16:19], v[16:19]
  ds_read_b64_tr_b16 a[124:125], v107 offset:10240
  ds_read_b64_tr_b16 a[126:127], v107 offset:14336
  v_mfma_f32_16x16x32_bf16 v[32:35], a[64:67], a[20:23], v[32:35]
  ds_read_b64_tr_b16 a[64:65], v104 offset:0
  ds_read_b64_tr_b16 a[66:67], v104 offset:4096
  v_mfma_f32_16x16x32_bf16 v[20:23], a[68:71], a[16:19], v[20:23]
  buffer_load_dwordx4 v[148:151], v240, s[4:7], s16 offen offset:1024 sc1
  v_mfma_f32_16x16x32_bf16 v[36:39], a[68:71], a[20:23], v[36:39]
  ds_read_b64_tr_b16 a[68:69], v105 offset:0
  ds_read_b64_tr_b16 a[70:71], v105 offset:4096
  s_waitcnt lgkmcnt(10)
  v_mfma_f32_16x16x32_bf16 v[24:27], a[72:75], a[16:19], v[24:27]
  v_mfma_f32_16x16x32_bf16 v[40:43], a[72:75], a[20:23], v[40:43]
  buffer_load_dwordx4 v[152:155], v241, s[4:7], s16 offen offset:0 sc1
  v_mfma_f32_16x16x32_bf16 v[28:31], a[76:79], a[16:19], v[28:31]
  ds_read_b64_tr_b16 a[72:73], v106 offset:0
  ds_read_b64_tr_b16 a[74:75], v106 offset:4096
  v_mfma_f32_16x16x32_bf16 v[44:47], a[76:79], a[20:23], v[44:47]
  ds_read_b64_tr_b16 a[76:77], v107 offset:0
  ds_read_b64_tr_b16 a[78:79], v107 offset:4096
  v_mfma_f32_16x16x32_bf16 v[16:19], a[96:99], a[24:27], v[16:19]
  buffer_load_dwordx4 v[156:159], v241, s[4:7], s16 offen offset:1024 sc1
  v_mfma_f32_16x16x32_bf16 v[32:35], a[96:99], a[28:31], v[32:35]
  ds_read_b64_tr_b16 a[96:97], v104 offset:8192
  ds_read_b64_tr_b16 a[98:99], v104 offset:12288
  v_mfma_f32_16x16x32_bf16 v[20:23], a[100:103], a[24:27], v[20:23]
  v_mfma_f32_16x16x32_bf16 v[36:39], a[100:103], a[28:31], v[36:39]
  ds_read_b64_tr_b16 a[100:101], v105 offset:8192
  s_add_u32 s16, s16, 262144
  v_mfma_f32_16x16x32_bf16 v[24:27], a[104:107], a[24:27], v[24:27]
  ds_read_b64_tr_b16 a[102:103], v105 offset:12288
  v_mfma_f32_16x16x32_bf16 v[40:43], a[104:107], a[28:31], v[40:43]
  ds_read_b64_tr_b16 a[104:105], v106 offset:8192
  ds_read_b64_tr_b16 a[106:107], v106 offset:12288
  v_mfma_f32_16x16x32_bf16 v[28:31], a[108:111], a[24:27], v[28:31]
  v_mfma_f32_16x16x32_bf16 v[44:47], a[108:111], a[28:31], v[44:47]
  s_waitcnt vmcnt(16) lgkmcnt(10)
  s_barrier
  v_mfma_f32_16x16x32_bf16 v[72:75], a[80:83], a[32:35], v[72:75]
  ds_read_b64_tr_b16 a[108:109], v107 offset:8192
  s_add_u32 m0, s38, 114688
  v_mfma_f32_16x16x32_bf16 v[88:91], a[80:83], a[36:39], v[88:91]
  buffer_load_dwordx4 v227, s[8:11], s17 offen offset:2048 lds
  v_mfma_f32_16x16x32_bf16 v[76:79], a[84:87], a[32:35], v[76:79]
  ds_read_b64_tr_b16 a[110:111], v107 offset:12288
  ds_read_b64_tr_b16 a[80:81], v104 offset:18432
  v_mfma_f32_16x16x32_bf16 v[92:95], a[84:87], a[36:39], v[92:95]
  buffer_load_dwordx4 v228, s[8:11], s17 offen offset:3072 lds
  v_mfma_f32_16x16x32_bf16 v[80:83], a[88:91], a[32:35], v[80:83]
  ds_read_b64_tr_b16 a[82:83], v104 offset:22528
  ds_read_b64_tr_b16 a[84:85], v105 offset:18432
  v_mfma_f32_16x16x32_bf16 v[96:99], a[88:91], a[36:39], v[96:99]
  ds_read_b64_tr_b16 a[86:87], v105 offset:22528
  s_add_u32 s17, s17, 917504
  v_mfma_f32_16x16x32_bf16 v[84:87], a[92:95], a[32:35], v[84:87]
  ds_read_b64_tr_b16 a[88:89], v106 offset:18432
  s_add_u32 m0, s38, 112640
  v_mfma_f32_16x16x32_bf16 v[100:103], a[92:95], a[36:39], v[100:103]
  ds_read_b64_tr_b16 a[90:91], v106 offset:22528
  ds_read_b64_tr_b16 a[92:93], v107 offset:18432
  v_mfma_f32_16x16x32_bf16 v[72:75], a[112:115], a[40:43], v[72:75]
  buffer_load_dwordx4 v227, s[8:11], s17 offen offset:2048 lds
  v_mfma_f32_16x16x32_bf16 v[88:91], a[112:115], a[44:47], v[88:91]
  ds_read_b64_tr_b16 a[94:95], v107 offset:22528
  ds_read_b64_tr_b16 a[112:113], v104 offset:26624
  v_mfma_f32_16x16x32_bf16 v[76:79], a[116:119], a[40:43], v[76:79]
  buffer_load_dwordx4 v228, s[8:11], s17 offen offset:3072 lds
  v_mfma_f32_16x16x32_bf16 v[92:95], a[116:119], a[44:47], v[92:95]
  ds_read_b64_tr_b16 a[114:115], v104 offset:30720
  ds_read_b64_tr_b16 a[116:117], v105 offset:26624
  v_mfma_f32_16x16x32_bf16 v[80:83], a[120:123], a[40:43], v[80:83]
  ds_read_b64_tr_b16 a[118:119], v105 offset:30720
  s_mov_b32 s17, s97
  v_mfma_f32_16x16x32_bf16 v[96:99], a[120:123], a[44:47], v[96:99]
  buffer_load_dwordx4 v[160:163], v240, s[4:7], s16 offen offset:0 sc1
  v_mfma_f32_16x16x32_bf16 v[84:87], a[124:127], a[40:43], v[84:87]
  ds_read_b64_tr_b16 a[120:121], v106 offset:26624
  ds_read_b64_tr_b16 a[122:123], v106 offset:30720
  v_mfma_f32_16x16x32_bf16 v[100:103], a[124:127], a[44:47], v[100:103]
  buffer_load_dwordx4 v[164:167], v240, s[4:7], s16 offen offset:1024 sc1
  v_mfma_f32_16x16x32_bf16 v[16:19], a[64:67], a[32:35], v[16:19]
  ds_read_b64_tr_b16 a[124:125], v107 offset:26624
  ds_read_b64_tr_b16 a[126:127], v107 offset:30720
  v_mfma_f32_16x16x32_bf16 v[32:35], a[64:67], a[36:39], v[32:35]
  buffer_load_dwordx4 v[168:171], v241, s[4:7], s16 offen offset:0 sc1
  v_mfma_f32_16x16x32_bf16 v[20:23], a[68:71], a[32:35], v[20:23]
  buffer_load_dwordx4 v[172:175], v241, s[4:7], s16 offen offset:1024 sc1
  v_mfma_f32_16x16x32_bf16 v[36:39], a[68:71], a[36:39], v[36:39]
  ds_read_b64_tr_b16 a[64:65], v104 offset:16384
  ds_read_b64_tr_b16 a[66:67], v104 offset:20480
  s_waitcnt lgkmcnt(10)
  v_mfma_f32_16x16x32_bf16 v[24:27], a[72:75], a[32:35], v[24:27]
  ds_read_b64_tr_b16 a[68:69], v105 offset:16384
  s_add_u32 s16, s16, 262144
  v_mfma_f32_16x16x32_bf16 v[40:43], a[72:75], a[36:39], v[40:43]
  ds_read_b64_tr_b16 a[70:71], v105 offset:20480
  ds_read_b64_tr_b16 a[72:73], v106 offset:16384
  v_mfma_f32_16x16x32_bf16 v[28:31], a[76:79], a[32:35], v[28:31]
  buffer_load_dwordx4 v[176:179], v240, s[4:7], s16 offen offset:0 sc1
  v_mfma_f32_16x16x32_bf16 v[44:47], a[76:79], a[36:39], v[44:47]
  ds_read_b64_tr_b16 a[74:75], v106 offset:20480
  ds_read_b64_tr_b16 a[76:77], v107 offset:16384
  v_mfma_f32_16x16x32_bf16 v[16:19], a[96:99], a[40:43], v[16:19]
  buffer_load_dwordx4 v[180:183], v240, s[4:7], s16 offen offset:1024 sc1
  v_mfma_f32_16x16x32_bf16 v[32:35], a[96:99], a[44:47], v[32:35]
  buffer_load_dwordx4 v[184:187], v241, s[4:7], s16 offen offset:0 sc1
  v_mfma_f32_16x16x32_bf16 v[20:23], a[100:103], a[40:43], v[20:23]
  ds_read_b64_tr_b16 a[78:79], v107 offset:20480
  ds_read_b64_tr_b16 a[96:97], v104 offset:24576
  v_mfma_f32_16x16x32_bf16 v[36:39], a[100:103], a[44:47], v[36:39]
  buffer_load_dwordx4 v[188:191], v241, s[4:7], s16 offen offset:1024 sc1
  v_mfma_f32_16x16x32_bf16 v[24:27], a[104:107], a[40:43], v[24:27]
  ds_read_b64_tr_b16 a[98:99], v104 offset:28672
  ds_read_b64_tr_b16 a[100:101], v105 offset:24576
  v_mfma_f32_16x16x32_bf16 v[40:43], a[104:107], a[44:47], v[40:43]
  ds_read_b64_tr_b16 a[102:103], v105 offset:28672
  s_add_u32 s16, s16, 262144
  v_mfma_f32_16x16x32_bf16 v[28:31], a[108:111], a[40:43], v[28:31]
  ds_read_b64_tr_b16 a[104:105], v106 offset:24576
  ds_read_b64_tr_b16 a[106:107], v106 offset:28672
  v_mfma_f32_16x16x32_bf16 v[44:47], a[108:111], a[44:47], v[44:47]
  s_waitcnt vmcnt(20) lgkmcnt(10)
  s_barrier
  v_mfma_f32_16x16x32_bf16 v[72:75], a[80:83], a[48:51], v[72:75]
  ds_read_b64_tr_b16 a[108:109], v107 offset:24576
  s_add_u32 m0, s38, 133120
  v_mfma_f32_16x16x32_bf16 v[88:91], a[80:83], a[52:55], v[88:91]
  ds_read_b64_tr_b16 a[110:111], v107 offset:28672
  ds_read_b64_tr_b16 a[80:81], v104 offset:34816
  v_mfma_f32_16x16x32_bf16 v[76:79], a[84:87], a[48:51], v[76:79]
  ds_read_b64_tr_b16 a[82:83], v104 offset:38912
  v_mfma_f32_16x16x32_bf16 v[92:95], a[84:87], a[52:55], v[92:95]
  buffer_load_dwordx4 v225, s[8:11], s17 offen offset:0 lds
  v_mfma_f32_16x16x32_bf16 v[80:83], a[88:91], a[48:51], v[80:83]
  ds_read_b64_tr_b16 a[84:85], v105 offset:34816
  ds_read_b64_tr_b16 a[86:87], v105 offset:38912
  v_mfma_f32_16x16x32_bf16 v[96:99], a[88:91], a[52:55], v[96:99]
  ds_read_b64_tr_b16 a[88:89], v106 offset:34816
  ds_read_b64_tr_b16 a[90:91], v106 offset:38912
  v_mfma_f32_16x16x32_bf16 v[84:87], a[92:95], a[48:51], v[84:87]
  v_mfma_f32_16x16x32_bf16 v[100:103], a[92:95], a[52:55], v[100:103]
  buffer_load_dwordx4 v226, s[8:11], s17 offen offset:1024 lds
  v_mfma_f32_16x16x32_bf16 v[72:75], a[112:115], a[56:59], v[72:75]
  ds_read_b64_tr_b16 a[92:93], v107 offset:34816
  ds_read_b64_tr_b16 a[94:95], v107 offset:38912
  v_mfma_f32_16x16x32_bf16 v[88:91], a[112:115], a[60:63], v[88:91]
  ds_read_b64_tr_b16 a[112:113], v104 offset:43008
  ds_read_b64_tr_b16 a[114:115], v104 offset:47104
  v_mfma_f32_16x16x32_bf16 v[76:79], a[116:119], a[56:59], v[76:79]
  v_mfma_f32_16x16x32_bf16 v[92:95], a[116:119], a[60:63], v[92:95]
  ds_read_b64_tr_b16 a[116:117], v105 offset:43008
  s_add_u32 s17, s17, 917504
  v_mfma_f32_16x16x32_bf16 v[80:83], a[120:123], a[56:59], v[80:83]
  ds_read_b64_tr_b16 a[118:119], v105 offset:47104
  v_mfma_f32_16x16x32_bf16 v[96:99], a[120:123], a[60:63], v[96:99]
  ds_read_b64_tr_b16 a[120:121], v106 offset:43008
  ds_read_b64_tr_b16 a[122:123], v106 offset:47104
  v_mfma_f32_16x16x32_bf16 v[84:87], a[124:127], a[56:59], v[84:87]
  v_mfma_f32_16x16x32_bf16 v[100:103], a[124:127], a[60:63], v[100:103]
  ds_read_b64_tr_b16 a[124:125], v107 offset:43008
  s_add_u32 m0, s38, 131072
  v_mfma_f32_16x16x32_bf16 v[16:19], a[64:67], a[48:51], v[16:19]
  ds_read_b64_tr_b16 a[126:127], v107 offset:47104
  v_mfma_f32_16x16x32_bf16 v[32:35], a[64:67], a[52:55], v[32:35]
  ds_read_b64_tr_b16 a[64:65], v104 offset:32768
  ds_read_b64_tr_b16 a[66:67], v104 offset:36864
  v_mfma_f32_16x16x32_bf16 v[20:23], a[68:71], a[48:51], v[20:23]
  v_mfma_f32_16x16x32_bf16 v[36:39], a[68:71], a[52:55], v[36:39]
  buffer_load_dwordx4 v225, s[8:11], s17 offen offset:0 lds
  s_waitcnt lgkmcnt(10)
  v_mfma_f32_16x16x32_bf16 v[24:27], a[72:75], a[48:51], v[24:27]
  ds_read_b64_tr_b16 a[68:69], v105 offset:32768
  ds_read_b64_tr_b16 a[70:71], v105 offset:36864
  v_mfma_f32_16x16x32_bf16 v[40:43], a[72:75], a[52:55], v[40:43]
  ds_read_b64_tr_b16 a[72:73], v106 offset:32768
  ds_read_b64_tr_b16 a[74:75], v106 offset:36864
  v_mfma_f32_16x16x32_bf16 v[28:31], a[76:79], a[48:51], v[28:31]
  v_mfma_f32_16x16x32_bf16 v[44:47], a[76:79], a[52:55], v[44:47]
  buffer_load_dwordx4 v226, s[8:11], s17 offen offset:1024 lds
  v_mfma_f32_16x16x32_bf16 v[16:19], a[96:99], a[56:59], v[16:19]
  ds_read_b64_tr_b16 a[76:77], v107 offset:32768
  ds_read_b64_tr_b16 a[78:79], v107 offset:36864
  v_mfma_f32_16x16x32_bf16 v[32:35], a[96:99], a[60:63], v[32:35]
  ds_read_b64_tr_b16 a[96:97], v104 offset:40960
  ds_read_b64_tr_b16 a[98:99], v104 offset:45056
  v_mfma_f32_16x16x32_bf16 v[20:23], a[100:103], a[56:59], v[20:23]
  v_mfma_f32_16x16x32_bf16 v[36:39], a[100:103], a[60:63], v[36:39]
  ds_read_b64_tr_b16 a[100:101], v105 offset:40960
  s_add_u32 s17, s17, 917504
  v_mfma_f32_16x16x32_bf16 v[24:27], a[104:107], a[56:59], v[24:27]
  ds_read_b64_tr_b16 a[102:103], v105 offset:45056
  v_mfma_f32_16x16x32_bf16 v[40:43], a[104:107], a[60:63], v[40:43]
  ds_read_b64_tr_b16 a[104:105], v106 offset:40960
  ds_read_b64_tr_b16 a[106:107], v106 offset:45056
  v_mfma_f32_16x16x32_bf16 v[28:31], a[108:111], a[56:59], v[28:31]
  v_mfma_f32_16x16x32_bf16 v[44:47], a[108:111], a[60:63], v[44:47]
  s_waitcnt vmcnt(12) lgkmcnt(10)
  s_barrier
  v_swap_b32 v130, v132
  v_swap_b32 v131, v133
  v_swap_b32 v138, v140
  v_swap_b32 v139, v141
  v_swap_b32 v146, v148
  v_swap_b32 v147, v149
  v_swap_b32 v154, v156
  v_swap_b32 v155, v157
  s_nop 1
  v_mfma_f32_16x16x32_bf16 v[72:75], a[80:83], v[128:131], v[72:75]
  ds_read_b64_tr_b16 a[108:109], v107 offset:40960
  s_add_u32 m0, s38, 2048
  v_mfma_f32_16x16x32_bf16 v[88:91], a[80:83], v[132:135], v[88:91]
  ds_read_b64_tr_b16 a[110:111], v107 offset:45056
  ds_read_b64_tr_b16 a[80:81], v104 offset:51200
  v_mfma_f32_16x16x32_bf16 v[76:79], a[84:87], v[128:131], v[76:79]
  ds_read_b64_tr_b16 a[82:83], v104 offset:55296
  v_mfma_f32_16x16x32_bf16 v[92:95], a[84:87], v[132:135], v[92:95]
  buffer_load_dwordx4 v225, s[8:11], s17 offen offset:0 lds
  v_mfma_f32_16x16x32_bf16 v[80:83], a[88:91], v[128:131], v[80:83]
  ds_read_b64_tr_b16 a[84:85], v105 offset:51200
  ds_read_b64_tr_b16 a[86:87], v105 offset:55296
  v_mfma_f32_16x16x32_bf16 v[96:99], a[88:91], v[132:135], v[96:99]
  ds_read_b64_tr_b16 a[88:89], v106 offset:51200
  ds_read_b64_tr_b16 a[90:91], v106 offset:55296
  v_mfma_f32_16x16x32_bf16 v[84:87], a[92:95], v[128:131], v[84:87]
  buffer_load_dwordx4 v226, s[8:11], s17 offen offset:1024 lds
  v_mfma_f32_16x16x32_bf16 v[100:103], a[92:95], v[132:135], v[100:103]
  ds_read_b64_tr_b16 a[92:93], v107 offset:51200
  ds_read_b64_tr_b16 a[94:95], v107 offset:55296
  v_mfma_f32_16x16x32_bf16 v[72:75], a[112:115], v[136:139], v[72:75]
  v_mfma_f32_16x16x32_bf16 v[88:91], a[112:115], v[140:143], v[88:91]
  ds_read_b64_tr_b16 a[112:113], v104 offset:59392
  ds_read_b64_tr_b16 a[114:115], v104 offset:63488
  v_mfma_f32_16x16x32_bf16 v[76:79], a[116:119], v[136:139], v[76:79]
  s_add_u32 s17, s17, 917504
  v_mfma_f32_16x16x32_bf16 v[92:95], a[116:119], v[140:143], v[92:95]
  ds_read_b64_tr_b16 a[116:117], v105 offset:59392
  ds_read_b64_tr_b16 a[118:119], v105 offset:63488
  v_mfma_f32_16x16x32_bf16 v[80:83], a[120:123], v[136:139], v[80:83]
  v_mfma_f32_16x16x32_bf16 v[96:99], a[120:123], v[140:143], v[96:99]
  ds_read_b64_tr_b16 a[120:121], v106 offset:59392
  s_add_u32 m0, s38, 0
  v_mfma_f32_16x16x32_bf16 v[84:87], a[124:127], v[136:139], v[84:87]
  ds_read_b64_tr_b16 a[122:123], v106 offset:63488
  v_mfma_f32_16x16x32_bf16 v[100:103], a[124:127], v[140:143], v[100:103]
  ds_read_b64_tr_b16 a[124:125], v107 offset:59392
  ds_read_b64_tr_b16 a[126:127], v107 offset:63488
  v_mfma_f32_16x16x32_bf16 v[72:75], a[64:67], v[144:147], v[72:75]
  v_mfma_f32_16x16x32_bf16 v[88:91], a[64:67], v[148:151], v[88:91]
  buffer_load_dwordx4 v225, s[8:11], s17 offen offset:0 lds
  v_mfma_f32_16x16x32_bf16 v[76:79], a[68:71], v[144:147], v[76:79]
  ds_read_b64_tr_b16 a[64:65], v104 offset:49152
  ds_read_b64_tr_b16 a[66:67], v104 offset:53248
  v_mfma_f32_16x16x32_bf16 v[92:95], a[68:71], v[148:151], v[92:95]
  ds_read_b64_tr_b16 a[68:69], v105 offset:49152
  ds_read_b64_tr_b16 a[70:71], v105 offset:53248
  s_waitcnt lgkmcnt(10)
  v_mfma_f32_16x16x32_bf16 v[80:83], a[72:75], v[144:147], v[80:83]
  buffer_load_dwordx4 v226, s[8:11], s17 offen offset:1024 lds
  v_mfma_f32_16x16x32_bf16 v[96:99], a[72:75], v[148:151], v[96:99]
  ds_read_b64_tr_b16 a[72:73], v106 offset:49152
  ds_read_b64_tr_b16 a[74:75], v106 offset:53248
  v_mfma_f32_16x16x32_bf16 v[84:87], a[76:79], v[144:147], v[84:87]
  v_mfma_f32_16x16x32_bf16 v[100:103], a[76:79], v[148:151], v[100:103]
  ds_read_b64_tr_b16 a[76:77], v107 offset:49152
  ds_read_b64_tr_b16 a[78:79], v107 offset:53248
  v_mfma_f32_16x16x32_bf16 v[72:75], a[96:99], v[152:155], v[72:75]
  s_add_u32 s17, s17, 917504
  v_mfma_f32_16x16x32_bf16 v[88:91], a[96:99], v[156:159], v[88:91]
  ds_read_b64_tr_b16 a[96:97], v104 offset:57344
  ds_read_b64_tr_b16 a[98:99], v104 offset:61440
  v_mfma_f32_16x16x32_bf16 v[76:79], a[100:103], v[152:155], v[76:79]
  v_mfma_f32_16x16x32_bf16 v[92:95], a[100:103], v[156:159], v[92:95]
  s_add_u32 s52, s20, 0xe00000
  s_addc_u32 s53, s21, 0
  s_mov_b32 s54, 0x800000
  s_mov_b32 s55, 0x20000
  v_lshlrev_b32 v50, 4, v231
  s_lshl_b32 s36, s2, 2
  s_add_u32 s36, s36, s3
  s_xor_b32 s37, s36, 4
  s_lshl_b32 s39, s37, 13
  s_lshl_b32 s36, s36, 13
  s_mov_b32 s43, 0x8000
  s_mov_b32 s44, s90
  s_mov_b32 s45, s91
  s_mov_b32 s46, 0x400000
  s_mov_b32 s47, 0x20000
  v_mfma_f32_16x16x32_bf16 v[80:83], a[104:107], v[152:155], v[80:83]
  ds_read_b64_tr_b16 a[100:101], v105 offset:57344
  ds_read_b64_tr_b16 a[102:103], v105 offset:61440
  v_mfma_f32_16x16x32_bf16 v[96:99], a[104:107], v[156:159], v[96:99]
  ds_read_b64_tr_b16 a[104:105], v106 offset:57344
  ds_read_b64_tr_b16 a[106:107], v106 offset:61440
  v_mfma_f32_16x16x32_bf16 v[84:87], a[108:111], v[152:155], v[84:87]
  v_mfma_f32_16x16x32_bf16 v[100:103], a[108:111], v[156:159], v[100:103]
  s_waitcnt vmcnt(4) lgkmcnt(10)
  s_barrier
  v_swap_b32 v162, v164
  v_swap_b32 v163, v165
  v_swap_b32 v170, v172
  v_swap_b32 v171, v173
  v_swap_b32 v178, v180
  v_swap_b32 v179, v181
  v_swap_b32 v186, v188
  v_swap_b32 v187, v189
  s_nop 1
  v_mfma_f32_16x16x32_bf16 v[72:75], a[80:83], v[160:163], v[72:75]
  ds_read_b64_tr_b16 a[108:109], v107 offset:57344
  ds_read_b64_tr_b16 a[110:111], v107 offset:61440
  v_mfma_f32_16x16x32_bf16 v[88:91], a[80:83], v[164:167], v[88:91]
  ds_read_b64_tr_b16 a[80:81], v124 offset:2048
  ds_read_b64_tr_b16 a[82:83], v124 offset:6144
  v_mfma_f32_16x16x32_bf16 v[76:79], a[84:87], v[160:163], v[76:79]
  v_mfma_f32_16x16x32_bf16 v[92:95], a[84:87], v[164:167], v[92:95]
  ds_read_b64_tr_b16 a[84:85], v125 offset:2048
  ds_read_b64_tr_b16 a[86:87], v125 offset:6144
  v_mfma_f32_16x16x32_bf16 v[80:83], a[88:91], v[160:163], v[80:83]
  v_mfma_f32_16x16x32_bf16 v[96:99], a[88:91], v[164:167], v[96:99]
  ds_read_b64_tr_b16 a[88:89], v126 offset:2048
  ds_read_b64_tr_b16 a[90:91], v126 offset:6144
  v_mfma_f32_16x16x32_bf16 v[84:87], a[92:95], v[160:163], v[84:87]
  v_mfma_f32_16x16x32_bf16 v[100:103], a[92:95], v[164:167], v[100:103]
  ds_read_b64_tr_b16 a[92:93], v127 offset:2048
  ds_read_b64_tr_b16 a[94:95], v127 offset:6144
  v_mfma_f32_16x16x32_bf16 v[72:75], a[112:115], v[168:171], v[72:75]
  v_mfma_f32_16x16x32_bf16 v[88:91], a[112:115], v[172:175], v[88:91]
  ds_read_b64_tr_b16 a[112:113], v124 offset:10240
  ds_read_b64_tr_b16 a[114:115], v124 offset:14336
  v_mfma_f32_16x16x32_bf16 v[76:79], a[116:119], v[168:171], v[76:79]
  v_mfma_f32_16x16x32_bf16 v[92:95], a[116:119], v[172:175], v[92:95]
  ds_read_b64_tr_b16 a[116:117], v125 offset:10240
  ds_read_b64_tr_b16 a[118:119], v125 offset:14336
  v_mfma_f32_16x16x32_bf16 v[80:83], a[120:123], v[168:171], v[80:83]
  v_mfma_f32_16x16x32_bf16 v[96:99], a[120:123], v[172:175], v[96:99]
  ds_read_b64_tr_b16 a[120:121], v126 offset:10240
  ds_read_b64_tr_b16 a[122:123], v126 offset:14336
  v_mfma_f32_16x16x32_bf16 v[84:87], a[124:127], v[168:171], v[84:87]
  v_mfma_f32_16x16x32_bf16 v[100:103], a[124:127], v[172:175], v[100:103]
  ds_read_b64_tr_b16 a[124:125], v127 offset:10240
  ds_read_b64_tr_b16 a[126:127], v127 offset:14336
  v_mfma_f32_16x16x32_bf16 v[72:75], a[64:67], v[176:179], v[72:75]
  v_mfma_f32_16x16x32_bf16 v[88:91], a[64:67], v[180:183], v[88:91]
  ds_read_b64_tr_b16 a[64:65], v124 offset:0
  ds_read_b64_tr_b16 a[66:67], v124 offset:4096
  v_mfma_f32_16x16x32_bf16 v[76:79], a[68:71], v[176:179], v[76:79]
  v_mfma_f32_16x16x32_bf16 v[92:95], a[68:71], v[180:183], v[92:95]
  ds_read_b64_tr_b16 a[68:69], v125 offset:0
  ds_read_b64_tr_b16 a[70:71], v125 offset:4096
  s_waitcnt lgkmcnt(10)
  v_mfma_f32_16x16x32_bf16 v[80:83], a[72:75], v[176:179], v[80:83]
  v_mfma_f32_16x16x32_bf16 v[96:99], a[72:75], v[180:183], v[96:99]
  ds_read_b64_tr_b16 a[72:73], v126 offset:0
  ds_read_b64_tr_b16 a[74:75], v126 offset:4096
  v_mfma_f32_16x16x32_bf16 v[84:87], a[76:79], v[176:179], v[84:87]
  v_mfma_f32_16x16x32_bf16 v[100:103], a[76:79], v[180:183], v[100:103]
  ds_read_b64_tr_b16 a[76:77], v127 offset:0
  ds_read_b64_tr_b16 a[78:79], v127 offset:4096
  v_mfma_f32_16x16x32_bf16 v[72:75], a[96:99], v[184:187], v[72:75]
  v_mfma_f32_16x16x32_bf16 v[88:91], a[96:99], v[188:191], v[88:91]
  ds_read_b64_tr_b16 a[96:97], v124 offset:8192
  ds_read_b64_tr_b16 a[98:99], v124 offset:12288
  v_mfma_f32_16x16x32_bf16 v[76:79], a[100:103], v[184:187], v[76:79]
  v_mfma_f32_16x16x32_bf16 v[92:95], a[100:103], v[188:191], v[92:95]
  ds_read_b64_tr_b16 a[100:101], v125 offset:8192
  ds_read_b64_tr_b16 a[102:103], v125 offset:12288
  v_mfma_f32_16x16x32_bf16 v[80:83], a[104:107], v[184:187], v[80:83]
  v_mfma_f32_16x16x32_bf16 v[96:99], a[104:107], v[188:191], v[96:99]
  ds_read_b64_tr_b16 a[104:105], v126 offset:8192
  ds_read_b64_tr_b16 a[106:107], v126 offset:12288
  v_mfma_f32_16x16x32_bf16 v[84:87], a[108:111], v[184:187], v[84:87]
  v_mfma_f32_16x16x32_bf16 v[100:103], a[108:111], v[188:191], v[100:103]
  s_waitcnt vmcnt(0) lgkmcnt(10)
  s_barrier
  v_mfma_f32_16x16x32_bf16 v[16:19], a[80:83], v[128:131], v[16:19]
  ds_read_b64_tr_b16 a[108:109], v127 offset:8192
  ds_read_b64_tr_b16 a[110:111], v127 offset:12288
  v_mfma_f32_16x16x32_bf16 v[32:35], a[80:83], v[132:135], v[32:35]
  ds_read_b64_tr_b16 a[80:81], v242 offset:2048
  ds_read_b64_tr_b16 a[82:83], v242 offset:6144
  v_mfma_f32_16x16x32_bf16 v[20:23], a[84:87], v[128:131], v[20:23]
  v_mfma_f32_16x16x32_bf16 v[36:39], a[84:87], v[132:135], v[36:39]
  v_cvt_pk_bf16_f32 v108, v72, v73
  v_cvt_pk_bf16_f32 v109, v74, v75
  v_cvt_pk_bf16_f32 v110, v76, v77
  v_cvt_pk_bf16_f32 v111, v78, v79
  buffer_store_dwordx4 v[108:111], v50, s[52:55], s39 offen offset:0 sc1
  v_mfma_f32_16x16x32_bf16 v[24:27], a[88:91], v[128:131], v[24:27]
  v_cvt_pk_bf16_f32 v116, v88, v89
  v_cvt_pk_bf16_f32 v117, v90, v91
  v_cvt_pk_bf16_f32 v118, v92, v93
  v_cvt_pk_bf16_f32 v119, v94, v95
  buffer_store_dwordx4 v[116:119], v50, s[52:55], s39 offen offset:2048 sc1
  v_mfma_f32_16x16x32_bf16 v[40:43], a[88:91], v[132:135], v[40:43]
  ds_read_b64_tr_b16 a[84:85], v243 offset:2048
  ds_read_b64_tr_b16 a[86:87], v243 offset:6144
  v_mfma_f32_16x16x32_bf16 v[28:31], a[92:95], v[128:131], v[28:31]
  ds_read_b64_tr_b16 a[88:89], v244 offset:2048
  ds_read_b64_tr_b16 a[90:91], v244 offset:6144
  v_mfma_f32_16x16x32_bf16 v[44:47], a[92:95], v[132:135], v[44:47]
  v_cvt_pk_bf16_f32 v112, v80, v81
  v_cvt_pk_bf16_f32 v113, v82, v83
  v_cvt_pk_bf16_f32 v114, v84, v85
  v_cvt_pk_bf16_f32 v115, v86, v87
  buffer_store_dwordx4 v[112:115], v50, s[52:55], s39 offen offset:1024 sc1
  v_mfma_f32_16x16x32_bf16 v[16:19], a[112:115], v[136:139], v[16:19]
  v_cvt_pk_bf16_f32 v120, v96, v97
  v_cvt_pk_bf16_f32 v121, v98, v99
  v_cvt_pk_bf16_f32 v122, v100, v101
  v_cvt_pk_bf16_f32 v123, v102, v103
  buffer_store_dwordx4 v[120:123], v50, s[52:55], s39 offen offset:3072 sc1
  v_mfma_f32_16x16x32_bf16 v[32:35], a[112:115], v[140:143], v[32:35]
  ds_read_b64_tr_b16 a[92:93], v245 offset:2048
  ds_read_b64_tr_b16 a[94:95], v245 offset:6144
  v_mfma_f32_16x16x32_bf16 v[20:23], a[116:119], v[136:139], v[20:23]
  ds_read_b64_tr_b16 a[112:113], v242 offset:10240
  ds_read_b64_tr_b16 a[114:115], v242 offset:14336
  v_mfma_f32_16x16x32_bf16 v[36:39], a[116:119], v[140:143], v[36:39]
  ds_read_b64_tr_b16 a[116:117], v243 offset:10240
  ds_read_b64_tr_b16 a[118:119], v243 offset:14336
  v_mfma_f32_16x16x32_bf16 v[24:27], a[120:123], v[136:139], v[24:27]
  v_mfma_f32_16x16x32_bf16 v[40:43], a[120:123], v[140:143], v[40:43]
  ds_read_b64_tr_b16 a[120:121], v244 offset:10240
  ds_read_b64_tr_b16 a[122:123], v244 offset:14336
  v_mfma_f32_16x16x32_bf16 v[28:31], a[124:127], v[136:139], v[28:31]
  v_mfma_f32_16x16x32_bf16 v[44:47], a[124:127], v[140:143], v[44:47]
  ds_read_b64_tr_b16 a[124:125], v245 offset:10240
  ds_read_b64_tr_b16 a[126:127], v245 offset:14336
  v_mfma_f32_16x16x32_bf16 v[16:19], a[64:67], v[144:147], v[16:19]
  v_mfma_f32_16x16x32_bf16 v[32:35], a[64:67], v[148:151], v[32:35]
  ds_read_b64_tr_b16 a[64:65], v242 offset:0
  ds_read_b64_tr_b16 a[66:67], v242 offset:4096
  v_mfma_f32_16x16x32_bf16 v[20:23], a[68:71], v[144:147], v[20:23]
  v_mfma_f32_16x16x32_bf16 v[36:39], a[68:71], v[148:151], v[36:39]
  ds_read_b64_tr_b16 a[68:69], v243 offset:0
  ds_read_b64_tr_b16 a[70:71], v243 offset:4096
  s_waitcnt lgkmcnt(10)
  v_mfma_f32_16x16x32_bf16 v[24:27], a[72:75], v[144:147], v[24:27]
  v_mfma_f32_16x16x32_bf16 v[40:43], a[72:75], v[148:151], v[40:43]
  ds_read_b64_tr_b16 a[72:73], v244 offset:0
  ds_read_b64_tr_b16 a[74:75], v244 offset:4096
  v_mfma_f32_16x16x32_bf16 v[28:31], a[76:79], v[144:147], v[28:31]
  v_mfma_f32_16x16x32_bf16 v[44:47], a[76:79], v[148:151], v[44:47]
  ds_read_b64_tr_b16 a[76:77], v245 offset:0
  ds_read_b64_tr_b16 a[78:79], v245 offset:4096
  v_mfma_f32_16x16x32_bf16 v[16:19], a[96:99], v[152:155], v[16:19]
  v_mfma_f32_16x16x32_bf16 v[32:35], a[96:99], v[156:159], v[32:35]
  ds_read_b64_tr_b16 a[96:97], v242 offset:8192
  ds_read_b64_tr_b16 a[98:99], v242 offset:12288
  v_mfma_f32_16x16x32_bf16 v[20:23], a[100:103], v[152:155], v[20:23]
  v_mfma_f32_16x16x32_bf16 v[36:39], a[100:103], v[156:159], v[36:39]
  ds_read_b64_tr_b16 a[100:101], v243 offset:8192
  ds_read_b64_tr_b16 a[102:103], v243 offset:12288
  v_mfma_f32_16x16x32_bf16 v[24:27], a[104:107], v[152:155], v[24:27]
  v_mfma_f32_16x16x32_bf16 v[40:43], a[104:107], v[156:159], v[40:43]
  ds_read_b64_tr_b16 a[104:105], v244 offset:8192
  ds_read_b64_tr_b16 a[106:107], v244 offset:12288
  v_mfma_f32_16x16x32_bf16 v[28:31], a[108:111], v[152:155], v[28:31]
  v_mfma_f32_16x16x32_bf16 v[44:47], a[108:111], v[156:159], v[44:47]
  s_waitcnt vmcnt(63) lgkmcnt(10)
  s_barrier
  v_mfma_f32_16x16x32_bf16 v[16:19], a[80:83], v[160:163], v[16:19]
  ds_read_b64_tr_b16 a[108:109], v245 offset:8192
  ds_read_b64_tr_b16 a[110:111], v245 offset:12288
  v_mfma_f32_16x16x32_bf16 v[32:35], a[80:83], v[164:167], v[32:35]
  v_mfma_f32_16x16x32_bf16 v[20:23], a[84:87], v[160:163], v[20:23]
  v_mfma_f32_16x16x32_bf16 v[36:39], a[84:87], v[164:167], v[36:39]
  v_mfma_f32_16x16x32_bf16 v[24:27], a[88:91], v[160:163], v[24:27]
  v_mfma_f32_16x16x32_bf16 v[40:43], a[88:91], v[164:167], v[40:43]
  v_mfma_f32_16x16x32_bf16 v[28:31], a[92:95], v[160:163], v[28:31]
  v_mfma_f32_16x16x32_bf16 v[44:47], a[92:95], v[164:167], v[44:47]
  v_mfma_f32_16x16x32_bf16 v[16:19], a[112:115], v[168:171], v[16:19]
  v_mfma_f32_16x16x32_bf16 v[32:35], a[112:115], v[172:175], v[32:35]
  v_mfma_f32_16x16x32_bf16 v[20:23], a[116:119], v[168:171], v[20:23]
  v_mfma_f32_16x16x32_bf16 v[36:39], a[116:119], v[172:175], v[36:39]
  v_mfma_f32_16x16x32_bf16 v[24:27], a[120:123], v[168:171], v[24:27]
  v_mfma_f32_16x16x32_bf16 v[40:43], a[120:123], v[172:175], v[40:43]
  v_mfma_f32_16x16x32_bf16 v[28:31], a[124:127], v[168:171], v[28:31]
  v_mfma_f32_16x16x32_bf16 v[44:47], a[124:127], v[172:175], v[44:47]
  v_mfma_f32_16x16x32_bf16 v[16:19], a[64:67], v[176:179], v[16:19]
  v_mfma_f32_16x16x32_bf16 v[32:35], a[64:67], v[180:183], v[32:35]
  v_mfma_f32_16x16x32_bf16 v[20:23], a[68:71], v[176:179], v[20:23]
  v_mfma_f32_16x16x32_bf16 v[36:39], a[68:71], v[180:183], v[36:39]
  buffer_load_dwordx4 v[108:111], v50, s[52:55], s36 offen offset:0 sc1
  s_waitcnt lgkmcnt(10)
  v_mfma_f32_16x16x32_bf16 v[24:27], a[72:75], v[176:179], v[24:27]
  buffer_load_dwordx4 v[112:115], v50, s[52:55], s36 offen offset:1024 sc1
  v_mfma_f32_16x16x32_bf16 v[40:43], a[72:75], v[180:183], v[40:43]
  buffer_load_dwordx4 v[116:119], v50, s[52:55], s36 offen offset:2048 sc1
  s_waitcnt lgkmcnt(8)
  v_mfma_f32_16x16x32_bf16 v[28:31], a[76:79], v[176:179], v[28:31]
  buffer_load_dwordx4 v[120:123], v50, s[52:55], s36 offen offset:3072 sc1
  v_mfma_f32_16x16x32_bf16 v[44:47], a[76:79], v[180:183], v[44:47]
  s_waitcnt lgkmcnt(6)
  v_mfma_f32_16x16x32_bf16 v[16:19], a[96:99], v[184:187], v[16:19]
  v_mfma_f32_16x16x32_bf16 v[32:35], a[96:99], v[188:191], v[32:35]
  s_waitcnt lgkmcnt(4)
  v_mfma_f32_16x16x32_bf16 v[20:23], a[100:103], v[184:187], v[20:23]
  v_mfma_f32_16x16x32_bf16 v[36:39], a[100:103], v[188:191], v[36:39]
  s_waitcnt lgkmcnt(2)
  v_mfma_f32_16x16x32_bf16 v[24:27], a[104:107], v[184:187], v[24:27]
  v_mfma_f32_16x16x32_bf16 v[40:43], a[104:107], v[188:191], v[40:43]
  s_waitcnt lgkmcnt(0)
  v_mfma_f32_16x16x32_bf16 v[28:31], a[108:111], v[184:187], v[28:31]
  v_mfma_f32_16x16x32_bf16 v[44:47], a[108:111], v[188:191], v[44:47]
  s_nop 7
  s_nop 1
  s_waitcnt lgkmcnt(0)
  v_pk_fma_f32 v[192:193], v[16:17], v[56:57], v[192:193]
  v_pk_fma_f32 v[194:195], v[18:19], v[58:59], v[194:195]
  v_pk_fma_f32 v[196:197], v[20:21], v[60:61], v[196:197]
  v_pk_fma_f32 v[198:199], v[22:23], v[62:63], v[198:199]
  v_pk_fma_f32 v[200:201], v[24:25], v[64:65], v[200:201]
  v_pk_fma_f32 v[202:203], v[26:27], v[66:67], v[202:203]
  v_pk_fma_f32 v[204:205], v[28:29], v[68:69], v[204:205]
  v_pk_fma_f32 v[206:207], v[30:31], v[70:71], v[206:207]
  v_pk_fma_f32 v[208:209], v[32:33], v[56:57], v[208:209]
  v_pk_fma_f32 v[210:211], v[34:35], v[58:59], v[210:211]
  v_pk_fma_f32 v[212:213], v[36:37], v[60:61], v[212:213]
  v_pk_fma_f32 v[214:215], v[38:39], v[62:63], v[214:215]
  v_pk_fma_f32 v[216:217], v[40:41], v[64:65], v[216:217]
  v_pk_fma_f32 v[218:219], v[42:43], v[66:67], v[218:219]
  v_pk_fma_f32 v[220:221], v[44:45], v[68:69], v[220:221]
  v_pk_fma_f32 v[222:223], v[46:47], v[70:71], v[222:223]
  s_mov_b32 s60, 262144
  s_branch L_chk_33
L_poll_31:
  buffer_load_dwordx4 v[108:111], v50, s[52:55], s36 offen offset:0 sc1
  buffer_load_dwordx4 v[112:115], v50, s[52:55], s36 offen offset:1024 sc1
  buffer_load_dwordx4 v[116:119], v50, s[52:55], s36 offen offset:2048 sc1
  buffer_load_dwordx4 v[120:123], v50, s[52:55], s36 offen offset:3072 sc1
L_chk_33:
  s_waitcnt vmcnt(3)
  v_max3_u32 v51, v108, v109, v110
  v_max_u32 v51, v51, v111
  s_waitcnt vmcnt(2)
  v_max3_u32 v51, v51, v112, v113
  v_max3_u32 v51, v51, v114, v115
  s_waitcnt vmcnt(1)
  v_max3_u32 v51, v51, v116, v117
  v_max3_u32 v51, v51, v118, v119
  s_waitcnt vmcnt(0)
  v_max3_u32 v51, v51, v120, v121
  v_max3_u32 v51, v51, v122, v123
  v_cmp_eq_u32 vcc, -1, v51
  s_nop 1
  s_cmp_eq_u64 vcc, 0
  s_cbranch_scc1 L_ready_32
  s_sub_u32 s60, s60, 1
  s_cmp_lg_u32 s60, 0
  s_cbranch_scc1 L_poll_31
L_ready_32:
  v_lshlrev_b32 v72, 16, v108
  v_and_b32 v73, 0xffff0000, v108
  v_lshlrev_b32 v74, 16, v109
  v_and_b32 v75, 0xffff0000, v109
  v_pk_fma_f32 v[192:193], v[72:73], v[56:57], v[192:193]
  v_pk_fma_f32 v[194:195], v[74:75], v[58:59], v[194:195]
  v_cvt_pk_bf16_f32 v0, v192, v193
  v_cvt_pk_bf16_f32 v1, v194, v195
  v_lshlrev_b32 v76, 16, v110
  v_and_b32 v77, 0xffff0000, v110
  v_lshlrev_b32 v78, 16, v111
  v_and_b32 v79, 0xffff0000, v111
  v_pk_fma_f32 v[196:197], v[76:77], v[60:61], v[196:197]
  v_pk_fma_f32 v[198:199], v[78:79], v[62:63], v[198:199]
  v_cvt_pk_bf16_f32 v2, v196, v197
  v_cvt_pk_bf16_f32 v3, v198, v199
  s_nop 1
  v_permlane16_swap_b32 v0, v2
  v_permlane16_swap_b32 v1, v3
  s_nop 1
  buffer_store_dwordx4 v[0:3], v252, s[44:47], 0 offen offset:0 sc1
  v_lshlrev_b32 v80, 16, v112
  v_and_b32 v81, 0xffff0000, v112
  v_lshlrev_b32 v82, 16, v113
  v_and_b32 v83, 0xffff0000, v113
  v_pk_fma_f32 v[200:201], v[80:81], v[64:65], v[200:201]
  v_pk_fma_f32 v[202:203], v[82:83], v[66:67], v[202:203]
  v_cvt_pk_bf16_f32 v4, v200, v201
  v_cvt_pk_bf16_f32 v5, v202, v203
  v_lshlrev_b32 v84, 16, v114
  v_and_b32 v85, 0xffff0000, v114
  v_lshlrev_b32 v86, 16, v115
  v_and_b32 v87, 0xffff0000, v115
  v_pk_fma_f32 v[204:205], v[84:85], v[68:69], v[204:205]
  v_pk_fma_f32 v[206:207], v[86:87], v[70:71], v[206:207]
  v_cvt_pk_bf16_f32 v6, v204, v205
  v_cvt_pk_bf16_f32 v7, v206, v207
  s_nop 1
  v_permlane16_swap_b32 v4, v6
  v_permlane16_swap_b32 v5, v7
  s_nop 1
  buffer_store_dwordx4 v[4:7], v252, s[44:47], 0 offen offset:64 sc1
  v_lshlrev_b32 v88, 16, v116
  v_and_b32 v89, 0xffff0000, v116
  v_lshlrev_b32 v90, 16, v117
  v_and_b32 v91, 0xffff0000, v117
  v_pk_fma_f32 v[208:209], v[88:89], v[56:57], v[208:209]
  v_pk_fma_f32 v[210:211], v[90:91], v[58:59], v[210:211]
  v_cvt_pk_bf16_f32 v8, v208, v209
  v_cvt_pk_bf16_f32 v9, v210, v211
  v_lshlrev_b32 v92, 16, v118
  v_and_b32 v93, 0xffff0000, v118
  v_lshlrev_b32 v94, 16, v119
  v_and_b32 v95, 0xffff0000, v119
  v_pk_fma_f32 v[212:213], v[92:93], v[60:61], v[212:213]
  v_pk_fma_f32 v[214:215], v[94:95], v[62:63], v[214:215]
  v_cvt_pk_bf16_f32 v10, v212, v213
  v_cvt_pk_bf16_f32 v11, v214, v215
  s_nop 1
  v_permlane16_swap_b32 v8, v10
  v_permlane16_swap_b32 v9, v11
  s_nop 1
  buffer_store_dwordx4 v[8:11], v252, s[44:47], s43 offen offset:0 sc1
  v_lshlrev_b32 v96, 16, v120
  v_and_b32 v97, 0xffff0000, v120
  v_lshlrev_b32 v98, 16, v121
  v_and_b32 v99, 0xffff0000, v121
  v_pk_fma_f32 v[216:217], v[96:97], v[64:65], v[216:217]
  v_pk_fma_f32 v[218:219], v[98:99], v[66:67], v[218:219]
  v_cvt_pk_bf16_f32 v12, v216, v217
  v_cvt_pk_bf16_f32 v13, v218, v219
  v_lshlrev_b32 v100, 16, v122
  v_and_b32 v101, 0xffff0000, v122
  v_lshlrev_b32 v102, 16, v123
  v_and_b32 v103, 0xffff0000, v123
  v_pk_fma_f32 v[220:221], v[100:101], v[68:69], v[220:221]
  v_pk_fma_f32 v[222:223], v[102:103], v[70:71], v[222:223]
  v_cvt_pk_bf16_f32 v14, v220, v221
  v_cvt_pk_bf16_f32 v15, v222, v223
  s_nop 1
  v_permlane16_swap_b32 v12, v14
  v_permlane16_swap_b32 v13, v15
  s_nop 1
  buffer_store_dwordx4 v[12:15], v252, s[44:47], s43 offen offset:64 sc1
  s_endpgm
L_slow_9:
  s_mov_b32 s33, 262144
L_spin_34:
  buffer_load_dword v127, v126, s[64:67], 0 offen sc1
  s_waitcnt vmcnt(0)
  v_cmp_ne_u32 vcc, s19, v127
  s_nop 1
  s_cmp_eq_u64 vcc, 0
  s_cbranch_scc1 L_back_10
  s_sub_u32 s33, s33, 1
  s_cmp_lg_u32 s33, 0
  s_cbranch_scc1 L_spin_34
  s_branch L_back_10
L_vslow_11:
  s_mov_b32 s33, 262144
L_spin_35:
  buffer_load_dwordx4 v[250:253], v254, s[12:15], s68 offen sc1
  s_waitcnt vmcnt(0)
  v_xor_b32 v168, s48, v250
  v_xor_b32 v169, s49, v251
  v_xor_b32 v170, s50, v252
  v_xor_b32 v171, s51, v253
  v_or3_b32 v172, v168, v169, v170
  v_or_b32 v172, v172, v171
  v_and_b32 v172, 0xff, v172
  v_cmp_ne_u32 vcc, 0, v172
  s_nop 1
  s_cmp_eq_u64 vcc, 0
  s_cbranch_scc1 L_vback_12
  s_sub_u32 s33, s33, 1
  s_cmp_lg_u32 s33, 0
  s_cbranch_scc1 L_spin_35
  s_branch L_vback_12
L_slow_21:
  s_mov_b32 s69, 262144
L_spin_36:
  buffer_load_dword v247, v246, s[64:67], s68 offen sc1
  s_waitcnt vmcnt(0)
  v_cmp_ne_u32 vcc, s19, v247
  s_nop 1
  s_cmp_eq_u64 vcc, 0
  s_cbranch_scc1 L_back_22
  s_sub_u32 s69, s69, 1
  s_cmp_lg_u32 s69, 0
  s_cbranch_scc1 L_spin_36
  s_branch L_back_22
L_slow_25:
  s_mov_b32 s60, 262144
L_spin_37:
  buffer_load_dword v247, v246, s[56:59], s94 offen sc1
  s_waitcnt vmcnt(0)
  v_cmp_ne_u32 vcc, s19, v247
  s_nop 1
  s_cmp_eq_u64 vcc, 0
  s_cbranch_scc1 L_back_26
  s_sub_u32 s60, s60, 1
  s_cmp_lg_u32 s60, 0
  s_cbranch_scc1 L_spin_37
  s_branch L_back_26
L_slow_27:
  s_mov_b32 s60, 262144
L_spin_38:
  buffer_load_dword v247, v246, s[56:59], s94 offen sc1
  s_waitcnt vmcnt(0)
  v_cmp_ne_u32 vcc, s19, v247
  s_nop 1
  s_cmp_eq_u64 vcc, 0
  s_cbranch_scc1 L_back_28
  s_sub_u32 s60, s60, 1
  s_cmp_lg_u32 s60, 0
  s_cbranch_scc1 L_spin_38
  s_branch L_back_28
L_slow_29:
  s_mov_b32 s60, 262144
L_spin_39:
  buffer_load_dword v247, v246, s[56:59], s94 offen sc1
  s_waitcnt vmcnt(0)
  v_cmp_ne_u32 vcc, s19, v247
  s_nop 1
  s_cmp_eq_u64 vcc, 0
  s_cbranch_scc1 L_back_30
  s_sub_u32 s60, s60, 1
  s_cmp_lg_u32 s60, 0
  s_cbranch_scc1 L_spin_39
  s_branch L_back_30
L_end_1:
  s_endpgm
L_code_end:
  s_endpgm
.section .rodata,"a"
.p2align 6
.amdhsa_kernel adaLN_cond__sliding_local_dilated__glu_gated_glu__prompt_kernel
  .amdhsa_next_free_vgpr 512
  .amdhsa_next_free_sgpr 102
  .amdhsa_accum_offset 256
  .amdhsa_group_segment_fixed_size 0
  .amdhsa_kernarg_size 96
  .amdhsa_user_sgpr_count 2
  .amdhsa_user_sgpr_kernarg_segment_ptr 1
  .amdhsa_system_sgpr_workgroup_id_x 1
  .amdhsa_float_denorm_mode_32 3
.end_amdhsa_kernel
```

```asm
; @launch grid=(256,1,1) block=(256,1,1) lds=163840
.amdgcn_target "amdgcn-amd-amdhsa--gfx950"
.text
.globl adaLN_cond__sliding_local_dilated__glu_gated_glu__prompt_kernel
.p2align 8
.type adaLN_cond__sliding_local_dilated__glu_gated_glu__prompt_kernel,@function
adaLN_cond__sliding_local_dilated__glu_gated_glu__prompt_kernel:
  s_cmp_ge_u32 s2, 256
  s_cbranch_scc1 L_end_1
  s_load_dwordx2 s[44:45], s[0:1], 56
  s_load_dwordx2 s[52:53], s[0:1], 64
  s_load_dwordx2 s[12:13], s[0:1], 0
  s_load_dwordx2 s[20:21], s[0:1], 88
  s_load_dwordx2 s[8:9], s[0:1], 8
  s_getpc_b64 s[58:59]
  v_and_b32 v86, 31, v0
  v_lshlrev_b32 v86, 7, v86
  global_load_dword v131, v86, s[58:59] offset:128
  v_lshrrev_b32 v110, 6, v0
  v_and_b32 v104, 63, v0
  s_nop 0
  v_readfirstlane_b32 s3, v110
  s_and_b32 s29, s2, 3
  s_and_b32 s28, s2, 4
  s_lshl_b32 s28, s28, 3
  s_lshr_b32 s31, s2, 3
  s_or_b32 s28, s28, s31
  v_lshrrev_b32 v1, 2, v104
  v_mul_u32_u24 v1, 12288, v1
  v_and_b32 v66, 3, v104
  v_lshl_add_u32 v1, v66, 4, v1
  v_lshlrev_b32 v2, 1, v0
  s_lshl2_add_u32 s30, s29, s3
  s_mul_i32 s50, s30, 786432
  s_lshl_b32 s31, s28, 6
  s_add_u32 s35, s50, s31
  s_lshl_b32 s34, s29, 9
  s_lshl_b32 s31, s3, 12
  s_add_u32 m0, s31, 79872
  v_and_b32 v66, 7, v104
  v_lshlrev_b32 v3, 11, v66
  v_lshrrev_b32 v67, 3, v104
  v_lshl_add_u32 v3, v67, 4, v3
  s_lshl_b32 s36, s2, 14
  s_lshl_b32 s31, s3, 9
  s_add_u32 s36, s36, s31
  s_movk_i32 s46, 2048
  s_mov_b32 s47, 0x20000
  s_mov_b32 s54, 12582912
  s_mov_b32 s55, 0x20000
  s_mov_b32 s14, 4194304
  s_mov_b32 s15, 0x20000
  s_waitcnt lgkmcnt(0)
  s_load_dword s19, s[20:21], 0x40000
  buffer_load_ushort v4, v2, s[44:47], s34 offen
  buffer_load_dwordx4 v1, s[52:55], s35 offen offset:0 lds
  s_add_u32 s35, s35, 195584
  buffer_load_dwordx4 v1, s[52:55], s35 offen offset:1024 lds
  s_add_u32 s35, s35, 195584
  buffer_load_dwordx4 v1, s[52:55], s35 offen offset:2048 lds
  s_add_u32 s35, s35, 195584
  buffer_load_dwordx4 v1, s[52:55], s35 offen offset:3072 lds
  s_barrier
  buffer_load_dwordx4 v[8:11], v3, s[12:15], s36 offen offset:0
  buffer_load_dwordx4 v[12:15], v3, s[12:15], s36 offen offset:128
  buffer_load_dwordx4 v[16:19], v3, s[12:15], s36 offen offset:256
  buffer_load_dwordx4 v[20:23], v3, s[12:15], s36 offen offset:384
  s_load_dwordx2 s[24:25], s[0:1], 16
  s_load_dwordx4 s[60:63], s[0:1], 32
  s_load_dwordx2 s[22:23], s[0:1], 48
  s_load_dwordx2 s[90:91], s[0:1], 72
  s_mov_b64 s[26:27], s[12:13]
  s_and_b32 s30, s2, 1
  s_lshl_b32 s30, s30, 3
  s_bfe_u32 s31, s2, 0x30003
  s_add_u32 s30, s30, s31
  s_bfe_u32 s31, s2, 0x20001
  s_lshl_b32 s31, s31, 2
  s_lshr_b32 s34, s2, 6
  s_add_u32 s31, s31, s34
  v_and_b32 v111, 2, v67
  v_xor_b32 v111, v111, v66
  v_mul_u32_u24 v129, 12288, v67
  v_lshl_add_u32 v129, v111, 4, v129
  s_and_b32 s33, s3, 1
  s_lshl_b32 s33, s33, 2
  v_xor_b32 v111, s33, v111
  v_mul_u32_u24 v110, 6144, v67
  v_lshl_add_u32 v110, v111, 4, v110
  s_mul_i32 s32, s3, 49152
  s_lshl_b32 s33, s31, 7
  s_add_u32 s32, s32, s33
  v_add_u32 v107, s32, v110
  v_add_u32 v108, 1024, v107
  v_add_u32 v109, 2048, v107
  s_mul_i32 s38, s3, 3072
  s_and_b32 s33, s30, 7
  s_mul_i32 s16, s33, 131072
  s_mul_i32 s17, s33, 196608
  s_mov_b32 s10, 1572864
  s_mov_b32 s11, 0x20000
  s_barrier
  s_getpc_b64 s[100:101]
  L_pc_2:
  s_add_u32 s100, s100, L_gemm_a-L_pc_2
  s_addc_u32 s101, s101, 0
  s_lshr_b32 s33, s2, 3
  s_lshl_b32 s33, s33, 2
  s_add_u32 s33, s33, s3
  s_lshl_b32 s33, s33, 13
  v_lshlrev_b32 v200, 7, v104
  v_add_u32 v200, s33, v200
  v_min_u32 v200, L_code_end-L_gemm_a-4, v200
  v_mov_b32 v201, s101
  v_add_co_u32 v200, vcc, s100, v200
  s_nop 1
  v_addc_co_u32 v201, vcc, 0, v201, vcc
  global_load_dword v131, v[200:201], off
  v_lshrrev_b32 v68, 4, v104
  v_bfe_u32 v69, v104, 2, 2
  v_lshl_add_u32 v69, v68, 3, v69
  v_and_b32 v70, 3, v104
  v_lshlrev_b32 v70, 3, v70
  s_lshl_b32 s33, s3, 5
  s_add_u32 s33, s33, 106496
  v_add_u32 v70, s33, v70
  v_lshl_add_u32 v5, v69, 6, v70
  v_subrev_u32 v5, 26624, v5
  v_lshl_add_u32 v196, v69, 7, v70
  v_and_b32 v70, 8, v104
  v_lshlrev_b32 v70, 2, v70
  v_xor_b32 v196, v196, v70
  v_lshlrev_b32 v255, 4, v68
  v_add_u32 v197, 147456, v255
  v_and_b32 v70, 15, v104
  v_lshl_or_b32 v255, v70, 24, v255
  v_mov_b32 v198, 0xffffff00
  v_add_u32 v2, 147456, v2
  s_mov_b32 s12, s20
  s_mov_b32 s13, s21
  s_mov_b32 s14, 0x18000
  s_mov_b32 s15, 0x20000
  s_mul_i32 s96, s29, 24576
  s_lshl_b32 s33, s3, 6
  s_add_u32 s96, s96, s33
  s_lshl_b32 s33, s28, 7
  s_add_u32 s34, s96, s33
  s_add_u32 s96, s34, s33
  s_add_u32 s96, s96, 8192
  s_add_u32 s50, s50, s33
  s_add_u32 s50, s50, 4096
  s_lshl_b32 s51, s3, 13
  s_add_u32 s51, s51, 106496
  s_waitcnt vmcnt(9)
  v_lshlrev_b32 v4, 16, v4
  v_mul_f32 v6, 0xbfb8aa3b, v4
  v_exp_f32 v6, v6
  s_nop 0
  v_add_f32 v6, 1.0, v6
  v_rcp_f32 v6, v6
  s_nop 0
  v_mul_f32 v4, v4, v6
  v_cvt_pk_bf16_f32 v4, v4, v4
  ds_write_b16 v2, v4
  s_waitcnt vmcnt(5) lgkmcnt(0)
  s_barrier
  s_mul_i32 s19, s19, 0x9e3779b1
  s_add_u32 s19, s19, 0x7f4a7c15
  s_bfe_u32 s40, s19, 0x80000
  s_bfe_u32 s41, s19, 0x80008
  s_bfe_u32 s42, s19, 0x80010
  s_bfe_u32 s43, s19, 0x80018
  s_cmp_ge_u32 s3, 2
  s_cbranch_scc1 L_nog_3
  ds_read_b64_tr_b16 a[64:65], v5 offset:0
  ds_read_b64_tr_b16 a[66:67], v5 offset:256
  ds_read_b128 a[68:71], v197 offset:0
  ds_read_b64_tr_b16 a[72:73], v5 offset:2048
  ds_read_b64_tr_b16 a[74:75], v5 offset:2304
  ds_read_b128 a[76:79], v197 offset:64
  ds_read_b64_tr_b16 a[80:81], v5 offset:4096
  ds_read_b64_tr_b16 a[82:83], v5 offset:4352
  ds_read_b128 a[84:87], v197 offset:128
  ds_read_b64_tr_b16 a[88:89], v5 offset:6144
  ds_read_b64_tr_b16 a[90:91], v5 offset:6400
  ds_read_b128 a[92:95], v197 offset:192
  ds_read_b64_tr_b16 a[96:97], v5 offset:8192
  ds_read_b64_tr_b16 a[98:99], v5 offset:8448
  ds_read_b128 a[100:103], v197 offset:256
  s_waitcnt lgkmcnt(12)
  v_mfma_f32_16x16x32_bf16 v[192:195], a[64:67], a[68:71], 0
  ds_read_b64_tr_b16 a[104:105], v5 offset:10240
  ds_read_b64_tr_b16 a[106:107], v5 offset:10496
  ds_read_b128 a[108:111], v197 offset:320
  s_waitcnt lgkmcnt(12)
  v_mfma_f32_16x16x32_bf16 v[192:195], a[72:75], a[76:79], v[192:195]
  ds_read_b64_tr_b16 a[112:113], v5 offset:12288
  ds_read_b64_tr_b16 a[114:115], v5 offset:12544
  ds_read_b128 a[116:119], v197 offset:384
  s_waitcnt lgkmcnt(12)
  v_mfma_f32_16x16x32_bf16 v[192:195], a[80:83], a[84:87], v[192:195]
  ds_read_b64_tr_b16 a[120:121], v5 offset:14336
  ds_read_b64_tr_b16 a[122:123], v5 offset:14592
  ds_read_b128 a[124:127], v197 offset:448
  s_waitcnt lgkmcnt(12)
  v_mfma_f32_16x16x32_bf16 v[192:195], a[88:91], a[92:95], v[192:195]
  s_waitcnt lgkmcnt(9)
  v_mfma_f32_16x16x32_bf16 v[192:195], a[96:99], a[100:103], v[192:195]
  s_waitcnt lgkmcnt(6)
  v_mfma_f32_16x16x32_bf16 v[192:195], a[104:107], a[108:111], v[192:195]
  s_waitcnt lgkmcnt(3)
  v_mfma_f32_16x16x32_bf16 v[192:195], a[112:115], a[116:119], v[192:195]
  s_waitcnt lgkmcnt(0)
  v_mfma_f32_16x16x32_bf16 v[192:195], a[120:123], a[124:127], v[192:195]
  s_nop 7
  v_and_or_b32 v192, v192, v198, s40
  v_and_or_b32 v193, v193, v198, s41
  v_and_or_b32 v194, v194, v198, s42
  v_and_or_b32 v195, v195, v198, s43
  buffer_store_dwordx4 v[192:195], v255, s[12:15], s34 offen sc1
L_nog_3:
  s_waitcnt vmcnt(1)
  v_lshlrev_b32 v24, 16, v8
  v_and_b32 v25, 0xffff0000, v8
  v_lshlrev_b32 v26, 16, v9
  v_and_b32 v27, 0xffff0000, v9
  v_lshlrev_b32 v28, 16, v10
  v_and_b32 v29, 0xffff0000, v10
  v_lshlrev_b32 v30, 16, v11
  v_and_b32 v31, 0xffff0000, v11
  v_lshlrev_b32 v32, 16, v12
  v_and_b32 v33, 0xffff0000, v12
  v_lshlrev_b32 v34, 16, v13
  v_and_b32 v35, 0xffff0000, v13
  v_lshlrev_b32 v36, 16, v14
  v_and_b32 v37, 0xffff0000, v14
  v_lshlrev_b32 v38, 16, v15
  v_and_b32 v39, 0xffff0000, v15
  v_lshlrev_b32 v40, 16, v16
  v_and_b32 v41, 0xffff0000, v16
  v_lshlrev_b32 v42, 16, v17
  v_and_b32 v43, 0xffff0000, v17
  v_lshlrev_b32 v44, 16, v18
  v_and_b32 v45, 0xffff0000, v18
  v_lshlrev_b32 v46, 16, v19
  v_and_b32 v47, 0xffff0000, v19
  v_lshlrev_b32 v48, 16, v20
  v_and_b32 v49, 0xffff0000, v20
  v_lshlrev_b32 v50, 16, v21
  v_and_b32 v51, 0xffff0000, v21
  v_lshlrev_b32 v52, 16, v22
  v_and_b32 v53, 0xffff0000, v22
  v_lshlrev_b32 v54, 16, v23
  v_and_b32 v55, 0xffff0000, v23
  v_pk_add_f32 v[56:57], v[24:25], v[26:27]
  v_pk_mul_f32 v[58:59], v[24:25], v[24:25]
  v_pk_mul_f32 v[60:61], v[26:27], v[26:27]
  v_pk_add_f32 v[56:57], v[56:57], v[28:29]
  v_pk_fma_f32 v[58:59], v[28:29], v[28:29], v[58:59]
  v_pk_add_f32 v[56:57], v[56:57], v[30:31]
  v_pk_fma_f32 v[60:61], v[30:31], v[30:31], v[60:61]
  v_pk_add_f32 v[56:57], v[56:57], v[32:33]
  v_pk_fma_f32 v[58:59], v[32:33], v[32:33], v[58:59]
  v_pk_add_f32 v[56:57], v[56:57], v[34:35]
  v_pk_fma_f32 v[60:61], v[34:35], v[34:35], v[60:61]
  v_pk_add_f32 v[56:57], v[56:57], v[36:37]
  v_pk_fma_f32 v[58:59], v[36:37], v[36:37], v[58:59]
  v_pk_add_f32 v[56:57], v[56:57], v[38:39]
  v_pk_fma_f32 v[60:61], v[38:39], v[38:39], v[60:61]
  v_pk_add_f32 v[56:57], v[56:57], v[40:41]
  v_pk_fma_f32 v[58:59], v[40:41], v[40:41], v[58:59]
  v_pk_add_f32 v[56:57], v[56:57], v[42:43]
  v_pk_fma_f32 v[60:61], v[42:43], v[42:43], v[60:61]
  v_pk_add_f32 v[56:57], v[56:57], v[44:45]
  v_pk_fma_f32 v[58:59], v[44:45], v[44:45], v[58:59]
  v_pk_add_f32 v[56:57], v[56:57], v[46:47]
  v_pk_fma_f32 v[60:61], v[46:47], v[46:47], v[60:61]
  v_pk_add_f32 v[56:57], v[56:57], v[48:49]
  v_pk_fma_f32 v[58:59], v[48:49], v[48:49], v[58:59]
  v_pk_add_f32 v[56:57], v[56:57], v[50:51]
  v_pk_fma_f32 v[60:61], v[50:51], v[50:51], v[60:61]
  v_pk_add_f32 v[56:57], v[56:57], v[52:53]
  v_pk_fma_f32 v[58:59], v[52:53], v[52:53], v[58:59]
  v_pk_add_f32 v[56:57], v[56:57], v[54:55]
  v_pk_fma_f32 v[60:61], v[54:55], v[54:55], v[60:61]
  v_pk_add_f32 v[58:59], v[58:59], v[60:61]
  v_add_f32 v56, v56, v57
  v_add_f32 v57, v58, v59
  s_nop 1
  v_add_f32_dpp v56, v56, v56 row_ror:8 row_mask:0xf bank_mask:0xf
  v_add_f32_dpp v57, v57, v57 row_ror:8 row_mask:0xf bank_mask:0xf
  v_mov_b32 v58, v56
  v_mov_b32 v59, v57
  s_nop 1
  v_permlane16_swap_b32 v58, v56
  v_permlane16_swap_b32 v59, v57
  s_nop 1
  v_add_f32 v56, v56, v58
  v_add_f32 v57, v57, v59
  v_mov_b32 v58, v56
  v_mov_b32 v59, v57
  s_nop 1
  v_permlane32_swap_b32 v58, v56
  v_permlane32_swap_b32 v59, v57
  s_nop 1
  v_add_f32 v56, v56, v58
  v_add_f32 v57, v57, v59
  v_lshlrev_b32 v68, 5, v66
  v_add_u32 v68, 147968, v68
  s_lshl_b32 s33, s3, 3
  v_add_u32 v69, s33, v68
  ds_write_b64 v69, v[56:57]
  v_lshlrev_b32 v119, 4, v104
  s_lshl_b32 s33, s3, 10
  v_add_u32 v1, s33, v119
  v_add_u32 v2, 4096, v1
  s_lshl_b32 s33, s3, 11
  s_add_u32 s33, s33, 139264
  v_add_u32 v3, s33, v119
  v_lshlrev_b32 v4, 5, v67
  v_add_u32 v4, s33, v4
  v_lshrrev_b32 v5, 5, v104
  v_lshlrev_b32 v5, 17, v5
  v_and_b32 v70, 3, v67
  v_lshl_add_u32 v5, v70, 8, v5
  v_lshl_add_u32 v5, v66, 4, v5
  s_waitcnt lgkmcnt(0)
  s_barrier
  ds_read_b128 v[132:135], v68 offset:0
  ds_read_b128 v[136:139], v68 offset:16
  s_add_u32 m0, s38, 0
  s_nop 0
  buffer_load_dwordx4 v107, s[8:11], s17 offen lds
  buffer_load_dwordx4 v108, s[8:11], s17 offen offset:1024 lds
  buffer_load_dwordx4 v109, s[8:11], s17 offen offset:2048 lds
  s_add_u32 s17, s17, 196608
  s_cmp_eq_u32 s17, s10
  s_cselect_b32 s17, 0, s17
  s_mov_b32 s32, 24576
  s_mov_b32 s35, 49152
  s_mov_b32 s36, 73728
  s_add_u32 s4, s20, 0x200000
  s_addc_u32 s5, s21, 0
  s_mov_b32 s6, 0x400000
  s_mov_b32 s7, 0x20000
  s_add_u32 s64, s20, 0xc0000
  s_addc_u32 s65, s21, 0
  s_mov_b32 s66, 0x20000
  s_mov_b32 s67, 0x20000
  s_waitcnt lgkmcnt(0)
  v_pk_add_f32 v[132:133], v[132:133], v[134:135]
  v_pk_add_f32 v[136:137], v[136:137], v[138:139]
  v_pk_add_f32 v[132:133], v[132:133], v[136:137]
  v_mul_f32 v56, 0x3a800000, v132
  v_mul_f32 v60, 0x3a800000, v133
  v_fma_f32 v60, -v56, v56, v60
  v_max_f32 v60, 0, v60
  buffer_load_dwordx4 v[72:75], v1, s[12:15], 0 offen sc1
  buffer_load_dwordx4 v[76:79], v1, s[12:15], s32 offen sc1
  buffer_load_dwordx4 v[80:83], v1, s[12:15], s35 offen sc1
  buffer_load_dwordx4 v[84:87], v1, s[12:15], s36 offen sc1
  buffer_load_dwordx4 v[88:91], v2, s[12:15], 0 offen sc1
  buffer_load_dwordx4 v[92:95], v2, s[12:15], s32 offen sc1
  buffer_load_dwordx4 v[96:99], v2, s[12:15], s35 offen sc1
  buffer_load_dwordx4 v[100:103], v2, s[12:15], s36 offen sc1
  v_cvt_pk_bf16_f32 v64, v56, v60
  v_lshlrev_b32 v56, 16, v64
  v_and_b32 v60, 0xffff0000, v64
  v_add_f32 v60, 0x3727c5ac, v60
  v_cvt_pk_bf16_f32 v64, v60, v61
  v_lshlrev_b32 v60, 16, v64
  v_and_b32 v61, 0xffff0000, v64
  v_sqrt_f32 v60, v60
  s_nop 0
  v_cvt_pk_bf16_f32 v64, v60, v61
  v_lshlrev_b32 v60, 16, v64
  v_and_b32 v61, 0xffff0000, v64
  v_rcp_f32 v60, v60
  v_mov_b32 v57, v56
  s_nop 0
  v_mov_b32 v61, v60
  v_pk_add_f32 v[24:25], v[24:25], v[56:57] neg_lo:[0,1] neg_hi:[0,1]
  v_pk_add_f32 v[26:27], v[26:27], v[56:57] neg_lo:[0,1] neg_hi:[0,1]
  v_pk_add_f32 v[28:29], v[28:29], v[56:57] neg_lo:[0,1] neg_hi:[0,1]
  v_pk_add_f32 v[30:31], v[30:31], v[56:57] neg_lo:[0,1] neg_hi:[0,1]
  v_pk_add_f32 v[32:33], v[32:33], v[56:57] neg_lo:[0,1] neg_hi:[0,1]
  v_pk_add_f32 v[34:35], v[34:35], v[56:57] neg_lo:[0,1] neg_hi:[0,1]
  v_pk_add_f32 v[36:37], v[36:37], v[56:57] neg_lo:[0,1] neg_hi:[0,1]
  v_pk_add_f32 v[38:39], v[38:39], v[56:57] neg_lo:[0,1] neg_hi:[0,1]
  v_pk_add_f32 v[40:41], v[40:41], v[56:57] neg_lo:[0,1] neg_hi:[0,1]
  v_pk_add_f32 v[42:43], v[42:43], v[56:57] neg_lo:[0,1] neg_hi:[0,1]
  v_pk_add_f32 v[44:45], v[44:45], v[56:57] neg_lo:[0,1] neg_hi:[0,1]
  v_pk_add_f32 v[46:47], v[46:47], v[56:57] neg_lo:[0,1] neg_hi:[0,1]
  v_pk_add_f32 v[48:49], v[48:49], v[56:57] neg_lo:[0,1] neg_hi:[0,1]
  v_pk_add_f32 v[50:51], v[50:51], v[56:57] neg_lo:[0,1] neg_hi:[0,1]
  v_pk_add_f32 v[52:53], v[52:53], v[56:57] neg_lo:[0,1] neg_hi:[0,1]
  v_pk_add_f32 v[54:55], v[54:55], v[56:57] neg_lo:[0,1] neg_hi:[0,1]
  v_pk_mul_f32 v[24:25], v[24:25], v[60:61]
  v_pk_mul_f32 v[26:27], v[26:27], v[60:61]
  v_pk_mul_f32 v[28:29], v[28:29], v[60:61]
  v_pk_mul_f32 v[30:31], v[30:31], v[60:61]
  v_pk_mul_f32 v[32:33], v[32:33], v[60:61]
  v_pk_mul_f32 v[34:35], v[34:35], v[60:61]
  v_pk_mul_f32 v[36:37], v[36:37], v[60:61]
  v_pk_mul_f32 v[38:39], v[38:39], v[60:61]
  v_pk_mul_f32 v[40:41], v[40:41], v[60:61]
  v_pk_mul_f32 v[42:43], v[42:43], v[60:61]
  v_pk_mul_f32 v[44:45], v[44:45], v[60:61]
  v_pk_mul_f32 v[46:47], v[46:47], v[60:61]
  v_pk_mul_f32 v[48:49], v[48:49], v[60:61]
  v_pk_mul_f32 v[50:51], v[50:51], v[60:61]
  v_pk_mul_f32 v[52:53], v[52:53], v[60:61]
  v_pk_mul_f32 v[54:55], v[54:55], v[60:61]
  s_lshl_b32 s39, s3, 8
  s_add_u32 s39, s39, 12288
  s_lshl_b32 s33, s30, 6
  s_lshl_b32 s34, s3, 4
  s_add_u32 s34, s34, s33
  s_max_u32 s33, s33, 8
  s_sub_u32 s33, s33, 8
  v_add_u32 v110, s33, v66
  v_add_u32 v126, s34, v104
  v_cmp_lt_u32 vcc, 15, v104
  s_nop 1
  v_cndmask_b32 v126, v126, v110, vcc
  s_mov_b32 s33, 0
  v_and_b32 v128, 0, v126
  v_add_u32 v128, s33, v128
  v_and_b32 v128, 3, v128
  v_and_or_b32 v128, v126, -4, v128
  v_lshlrev_b32 v126, 6, v126
  v_lshlrev_b32 v128, 6, v128
  s_lshl_b32 s34, s30, 13
  s_lshl_b32 s33, s3, 11
  s_add_u32 s34, s34, s33
  v_add_u32 v105, s34, v119
  s_lshl_b32 s34, s30, 3
  s_max_u32 s34, s34, 1
  s_sub_u32 s34, s34, 1
  s_lshl_b32 s34, s34, 10
  s_lshl_b32 s33, s3, 8
  s_add_u32 s34, s34, s33
  v_lshlrev_b32 v106, 2, v104
  v_add_u32 v106, s34, v106
  v_lshrrev_b32 v110, 4, v104
  v_mul_u32_u24 v110, 3072, v110
  v_bfe_u32 v111, v104, 2, 2
  v_lshl_add_u32 v110, v111, 7, v110
  v_bfe_u32 v111, v104, 3, 2
  v_lshl_add_u32 v110, v111, 5, v110
  v_and_b32 v111, 3, v104
  v_lshl_add_u32 v114, v111, 3, v110
  v_xor_b32 v115, 32, v114
  v_xor_b32 v116, 64, v114
  v_xor_b32 v117, 96, v114
  s_lshl_b32 s33, s3, 5
  v_xor_b32 v118, s33, v114
  v_add_u32 v120, 53248, v114
  v_add_u32 v121, 53248, v115
  v_add_u32 v122, 53248, v116
  v_add_u32 v123, 53248, v117
  v_add_u32 v124, 53248, v118
  v_add_u32 v125, 53248, v119
  v_and_b32 v110, 14, v104
  v_lshrrev_b32 v111, 4, v104
  v_lshlrev_b32 v111, 2, v111
  v_cmp_le_u32 s[44:45], v111, v110
  v_add_u32 v111, 2, v111
  v_cmp_le_u32 s[46:47], v111, v110
  v_and_b32 v110, 1, v104
  v_cmp_eq_u32 s[48:49], 1, v110
  s_lshl_b32 s56, s3, 20
  s_lshr_b32 s33, s2, 1
  s_lshl_b32 s33, s33, 10
  s_add_u32 s56, s56, s33
  s_and_b32 s33, s2, 1
  s_lshl_b32 s33, s33, 7
  s_add_u32 s56, s56, s33
  s_add_u32 s57, s56, 262144
  s_add_u32 s58, s56, 524288
  s_add_u32 s59, s56, 786432
  s_lshl_b32 s37, s2, 2
  s_add_u32 s37, s37, s3
  s_lshl_b32 s37, s37, 6
  s_mov_b32 s33, 262144
L_mod_4:
  s_waitcnt vmcnt(7)
  v_xor_b32 v72, s40, v72
  v_xor_b32 v73, s41, v73
  v_xor_b32 v74, s42, v74
  v_xor_b32 v75, s43, v75
  v_or3_b32 v66, v72, v73, v74
  v_or_b32 v66, v66, v75
  s_waitcnt vmcnt(6)
  v_xor_b32 v76, s40, v76
  v_xor_b32 v77, s41, v77
  v_xor_b32 v78, s42, v78
  v_xor_b32 v79, s43, v79
  v_or3_b32 v66, v66, v76, v77
  v_or3_b32 v66, v66, v78, v79
  s_waitcnt vmcnt(5)
  v_xor_b32 v80, s40, v80
  v_xor_b32 v81, s41, v81
  v_xor_b32 v82, s42, v82
  v_xor_b32 v83, s43, v83
  v_or3_b32 v66, v66, v80, v81
  v_or3_b32 v66, v66, v82, v83
  s_waitcnt vmcnt(4)
  v_xor_b32 v84, s40, v84
  v_xor_b32 v85, s41, v85
  v_xor_b32 v86, s42, v86
  v_xor_b32 v87, s43, v87
  v_or3_b32 v66, v66, v84, v85
  v_or3_b32 v66, v66, v86, v87
  s_waitcnt vmcnt(3)
  v_xor_b32 v88, s40, v88
  v_xor_b32 v89, s41, v89
  v_xor_b32 v90, s42, v90
  v_xor_b32 v91, s43, v91
  v_or3_b32 v66, v66, v88, v89
  v_or3_b32 v66, v66, v90, v91
  s_waitcnt vmcnt(2)
  v_xor_b32 v92, s40, v92
  v_xor_b32 v93, s41, v93
  v_xor_b32 v94, s42, v94
  v_xor_b32 v95, s43, v95
  v_or3_b32 v66, v66, v92, v93
  v_or3_b32 v66, v66, v94, v95
  s_waitcnt vmcnt(1)
  v_xor_b32 v96, s40, v96
  v_xor_b32 v97, s41, v97
  v_xor_b32 v98, s42, v98
  v_xor_b32 v99, s43, v99
  v_or3_b32 v66, v66, v96, v97
  v_or3_b32 v66, v66, v98, v99
  s_waitcnt vmcnt(0)
  v_xor_b32 v100, s40, v100
  v_xor_b32 v101, s41, v101
  v_xor_b32 v102, s42, v102
  v_xor_b32 v103, s43, v103
  v_or3_b32 v66, v66, v100, v101
  v_or3_b32 v66, v66, v102, v103
  v_and_b32 v66, 0xff, v66
  v_cmp_ne_u32 vcc, 0, v66
  s_nop 1
  s_cmp_eq_u64 vcc, 0
  s_cbranch_scc1 L_mok_5
  s_mov_b64 exec, vcc
  buffer_load_dwordx4 v[72:75], v1, s[12:15], 0 offen sc1
  buffer_load_dwordx4 v[76:79], v1, s[12:15], s32 offen sc1
  buffer_load_dwordx4 v[80:83], v1, s[12:15], s35 offen sc1
  buffer_load_dwordx4 v[84:87], v1, s[12:15], s36 offen sc1
  buffer_load_dwordx4 v[88:91], v2, s[12:15], 0 offen sc1
  buffer_load_dwordx4 v[92:95], v2, s[12:15], s32 offen sc1
  buffer_load_dwordx4 v[96:99], v2, s[12:15], s35 offen sc1
  buffer_load_dwordx4 v[100:103], v2, s[12:15], s36 offen sc1
  s_sub_u32 s33, s33, 1
  s_cmp_lg_u32 s33, 0
  s_cbranch_scc1 L_mod_4
  s_waitcnt vmcnt(0)
L_mok_5:
  s_mov_b64 exec, -1
  v_pk_add_f32 v[72:73], v[72:73], v[80:81]
  v_pk_add_f32 v[74:75], v[74:75], v[82:83]
  v_pk_add_f32 v[76:77], v[76:77], v[84:85]
  v_pk_add_f32 v[78:79], v[78:79], v[86:87]
  v_pk_add_f32 v[88:89], v[88:89], v[96:97]
  v_pk_add_f32 v[90:91], v[90:91], v[98:99]
  v_pk_add_f32 v[92:93], v[92:93], v[100:101]
  v_pk_add_f32 v[94:95], v[94:95], v[102:103]
  v_pk_add_f32 v[72:73], v[72:73], v[76:77]
  v_pk_add_f32 v[74:75], v[74:75], v[78:79]
  v_pk_add_f32 v[88:89], v[88:89], v[92:93]
  v_pk_add_f32 v[90:91], v[90:91], v[94:95]
  v_cvt_pk_bf16_f32 v80, v72, v73
  v_lshlrev_b32 v72, 16, v80
  v_and_b32 v73, 0xffff0000, v80
  v_cvt_pk_bf16_f32 v81, v74, v75
  v_lshlrev_b32 v74, 16, v81
  v_and_b32 v75, 0xffff0000, v81
  v_cvt_pk_bf16_f32 v82, v88, v89
  v_lshlrev_b32 v88, 16, v82
  v_and_b32 v89, 0xffff0000, v82
  v_cvt_pk_bf16_f32 v83, v90, v91
  v_lshlrev_b32 v90, 16, v83
  v_and_b32 v91, 0xffff0000, v83
  ds_write_b128 v3, v[72:75]
  v_add_f32 v88, 1.0, v88
  v_add_f32 v89, 1.0, v89
  v_add_f32 v90, 1.0, v90
  v_add_f32 v91, 1.0, v91
  v_cvt_pk_bf16_f32 v80, v88, v89
  v_lshlrev_b32 v88, 16, v80
  v_and_b32 v89, 0xffff0000, v80
  v_cvt_pk_bf16_f32 v81, v90, v91
  v_lshlrev_b32 v90, 16, v81
  v_and_b32 v91, 0xffff0000, v81
  ds_write_b128 v3, v[88:91] offset:1024
  ds_read_b128 v[132:135], v4 offset:0
  ds_read_b128 v[164:167], v4 offset:1024
  ds_read_b128 v[136:139], v4 offset:16
  ds_read_b128 v[168:171], v4 offset:1040
  ds_read_b128 v[140:143], v4 offset:256
  ds_read_b128 v[172:175], v4 offset:1280
  ds_read_b128 v[144:147], v4 offset:272
  ds_read_b128 v[176:179], v4 offset:1296
  ds_read_b128 v[148:151], v4 offset:512
  ds_read_b128 v[180:183], v4 offset:1536
  ds_read_b128 v[152:155], v4 offset:528
  ds_read_b128 v[184:187], v4 offset:1552
  s_waitcnt lgkmcnt(8)
  ds_read_b128 v[156:159], v4 offset:768
  ds_read_b128 v[188:191], v4 offset:1792
  ds_read_b128 v[160:163], v4 offset:784
  ds_read_b128 v[192:195], v4 offset:1808
  s_waitcnt lgkmcnt(12)
  v_pk_fma_f32 v[24:25], v[24:25], v[164:165], v[132:133]
  v_pk_fma_f32 v[26:27], v[26:27], v[166:167], v[134:135]
  v_pk_fma_f32 v[28:29], v[28:29], v[168:169], v[136:137]
  v_pk_fma_f32 v[30:31], v[30:31], v[170:171], v[138:139]
  v_cvt_pk_bf16_f32 v8, v24, v25
  v_cvt_pk_bf16_f32 v9, v26, v27
  v_cvt_pk_bf16_f32 v10, v28, v29
  v_cvt_pk_bf16_f32 v11, v30, v31
  buffer_store_dwordx4 v[8:11], v5, s[4:7], s56 offen sc1
  s_waitcnt lgkmcnt(8)
  v_pk_fma_f32 v[32:33], v[32:33], v[172:173], v[140:141]
  v_pk_fma_f32 v[34:35], v[34:35], v[174:175], v[142:143]
  v_pk_fma_f32 v[36:37], v[36:37], v[176:177], v[144:145]
  v_pk_fma_f32 v[38:39], v[38:39], v[178:179], v[146:147]
  v_cvt_pk_bf16_f32 v12, v32, v33
  v_cvt_pk_bf16_f32 v13, v34, v35
  v_cvt_pk_bf16_f32 v14, v36, v37
  v_cvt_pk_bf16_f32 v15, v38, v39
  buffer_store_dwordx4 v[12:15], v5, s[4:7], s57 offen sc1
  s_waitcnt lgkmcnt(4)
  v_pk_fma_f32 v[40:41], v[40:41], v[180:181], v[148:149]
  v_pk_fma_f32 v[42:43], v[42:43], v[182:183], v[150:151]
  v_pk_fma_f32 v[44:45], v[44:45], v[184:185], v[152:153]
  v_pk_fma_f32 v[46:47], v[46:47], v[186:187], v[154:155]
  v_cvt_pk_bf16_f32 v16, v40, v41
  v_cvt_pk_bf16_f32 v17, v42, v43
  v_cvt_pk_bf16_f32 v18, v44, v45
  v_cvt_pk_bf16_f32 v19, v46, v47
  buffer_store_dwordx4 v[16:19], v5, s[4:7], s58 offen sc1
  s_waitcnt lgkmcnt(0)
  v_pk_fma_f32 v[48:49], v[48:49], v[188:189], v[156:157]
  v_pk_fma_f32 v[50:51], v[50:51], v[190:191], v[158:159]
  v_pk_fma_f32 v[52:53], v[52:53], v[192:193], v[160:161]
  v_pk_fma_f32 v[54:55], v[54:55], v[194:195], v[162:163]
  v_cvt_pk_bf16_f32 v20, v48, v49
  v_cvt_pk_bf16_f32 v21, v50, v51
  v_cvt_pk_bf16_f32 v22, v52, v53
  v_cvt_pk_bf16_f32 v23, v54, v55
  buffer_store_dwordx4 v[20:23], v5, s[4:7], s59 offen sc1
  v_mov_b32 v7, s19
  v_lshlrev_b32 v6, 2, v104
  s_waitcnt vmcnt(0)
  s_mov_b64 exec, 1
  buffer_store_dword v7, v6, s[64:67], s37 offen sc1
  s_mov_b64 exec, -1
  s_barrier
  s_add_u32 m0, s38, 13312
  s_nop 0
  buffer_load_dwordx4 v107, s[8:11], s17 offen lds
  buffer_load_dwordx4 v108, s[8:11], s17 offen offset:1024 lds
  buffer_load_dwordx4 v109, s[8:11], s17 offen offset:2048 lds
  s_add_u32 s17, s17, 196608
  s_cmp_eq_u32 s17, s10
  s_cselect_b32 s17, 0, s17
  s_add_u32 m0, s38, 26624
  s_nop 0
  buffer_load_dwordx4 v107, s[8:11], s17 offen lds
  buffer_load_dwordx4 v108, s[8:11], s17 offen offset:1024 lds
  buffer_load_dwordx4 v109, s[8:11], s17 offen offset:2048 lds
  s_add_u32 s17, s17, 196608
  s_cmp_eq_u32 s17, s10
  s_cselect_b32 s17, 0, s17
  s_add_u32 m0, s38, 39936
  s_nop 0
  buffer_load_dwordx4 v107, s[8:11], s17 offen lds
  buffer_load_dwordx4 v108, s[8:11], s17 offen offset:1024 lds
  buffer_load_dwordx4 v109, s[8:11], s17 offen offset:2048 lds
  s_add_u32 s17, s17, 196608
  s_cmp_eq_u32 s17, s10
  s_cselect_b32 s17, 0, s17
  s_add_u32 m0, s38, 53248
  s_nop 0
  buffer_load_dwordx4 v107, s[8:11], s17 offen lds
  buffer_load_dwordx4 v108, s[8:11], s17 offen offset:1024 lds
  buffer_load_dwordx4 v109, s[8:11], s17 offen offset:2048 lds
  s_add_u32 s17, s17, 196608
  s_cmp_eq_u32 s17, s10
  s_cselect_b32 s17, 0, s17
  s_add_u32 m0, s38, 66560
  s_nop 0
  buffer_load_dwordx4 v107, s[8:11], s17 offen lds
  buffer_load_dwordx4 v108, s[8:11], s17 offen offset:1024 lds
  buffer_load_dwordx4 v109, s[8:11], s17 offen offset:2048 lds
  s_add_u32 s17, s17, 196608
  s_cmp_eq_u32 s17, s10
  s_cselect_b32 s17, 0, s17
  s_add_u32 m0, s38, 79872
  s_nop 0
  buffer_load_dwordx4 v107, s[8:11], s17 offen lds
  buffer_load_dwordx4 v108, s[8:11], s17 offen offset:1024 lds
  buffer_load_dwordx4 v109, s[8:11], s17 offen offset:2048 lds
  s_add_u32 s17, s17, 196608
  s_cmp_eq_u32 s17, s10
  s_cselect_b32 s17, 0, s17
L_slow_6:
  s_mov_b32 s33, 262144
L_spin_8:
  buffer_load_dword v127, v128, s[64:67], 0 offen sc1
  s_waitcnt vmcnt(0)
  v_cmp_ne_u32 vcc, s19, v127
  s_nop 1
  s_cmp_eq_u64 vcc, 0
  s_cbranch_scc1 L_back_7
  s_sub_u32 s33, s33, 1
  s_cmp_lg_u32 s33, 0
  s_cbranch_scc1 L_spin_8
  s_branch L_back_7
L_back_7:
L_gemm_a:
  s_mov_b32 s6, 1048576
  s_add_u32 m0, s39, 0
  s_nop 0
  buffer_load_dword v106, s[4:7], s16 offen sc1 lds
  buffer_load_dwordx4 a[0:3], v105, s[4:7], s16 offen sc1
  buffer_load_dwordx4 a[4:7], v105, s[4:7], s16 offen offset:1024 sc1
  s_add_u32 s16, s16, 131072
  s_bitset0_b32 s16, 20
  s_add_u32 m0, s39, 13312
  s_nop 0
  buffer_load_dword v106, s[4:7], s16 offen sc1 lds
  buffer_load_dwordx4 a[8:11], v105, s[4:7], s16 offen sc1
  buffer_load_dwordx4 a[12:15], v105, s[4:7], s16 offen offset:1024 sc1
  s_add_u32 s16, s16, 131072
  s_bitset0_b32 s16, 20
  s_add_u32 m0, s39, 26624
  s_nop 0
  buffer_load_dword v106, s[4:7], s16 offen sc1 lds
  buffer_load_dwordx4 a[16:19], v105, s[4:7], s16 offen sc1
  buffer_load_dwordx4 a[20:23], v105, s[4:7], s16 offen offset:1024 sc1
  s_add_u32 s16, s16, 131072
  s_bitset0_b32 s16, 20
  s_bitcmp1_b32 s3, 0
  s_cselect_b32 s56, s62, s60
  s_cselect_b32 s57, s63, s61
  s_mov_b32 s58, 7340032
  s_mov_b32 s59, 0x20000
  s_lshl_b32 s97, s2, 1
  s_lshr_b32 s33, s3, 1
  s_add_u32 s97, s97, s33
  s_lshl_b32 s97, s97, 10
  v_lshrrev_b32 v110, 3, v104
  v_min_u32 v130, 1, v110
  v_lshlrev_b32 v130, 19, v130
  v_and_b32 v112, 7, v104
  v_lshl_add_u32 v130, v112, 7, v130
  s_bfe_u32 s36, s2, 0x20001
  s_lshl_b32 s36, s36, 2
  s_bfe_u32 s33, s2, 0x20003
  s_add_u32 s36, s36, s33
  s_lshr_b32 s37, s2, 5
  s_lshl_b32 s37, s37, 1
  s_and_b32 s33, s2, 1
  s_add_u32 s37, s37, s33
  s_and_b32 s33, s36, 3
  s_lshl_b32 s98, s33, 19
  v_and_b32 v111, 6, v110
  v_and_b32 v112, 7, v104
  v_xor_b32 v111, v111, v112
  v_lshlrev_b32 v110, 11, v110
  v_lshl_add_u32 v110, v111, 4, v110
  s_lshl_b32 s32, s3, 15
  s_lshl_b32 s33, s37, 7
  s_add_u32 s32, s32, s33
  v_add_u32 v248, s32, v110
  v_add_u32 v249, 15360, v248
  v_mov_b32 v244, -1
  v_mov_b32 v245, -1
  v_mov_b32 v246, -1
  v_mov_b32 v247, -1
  s_add_u32 s92, s20, 0xe00000
  s_addc_u32 s93, s21, 0
  s_mov_b32 s94, 0x800000
  s_mov_b32 s95, 0x20000
  s_lshl_b32 s35, s2, 2
  s_add_u32 s35, s35, s3
  s_lshl_b32 s35, s35, 13
  v_lshrrev_b32 v254, 4, v104
  s_movk_i32 s33, 24576
  v_mul_u32_u24 v254, s33, v254
  v_and_b32 v110, 15, v104
  v_lshl_add_u32 v254, v110, 4, v254
  v_and_b32 v110, 15, v104
  v_lshlrev_b32 v128, 11, v110
  v_bfe_u32 v112, v104, 4, 1
  v_lshl_add_u32 v128, v112, 5, v128
  v_lshrrev_b32 v112, 5, v104
  v_lshl_add_u32 v128, v112, 4, v128
  s_lshl_b32 s32, s36, 18
  s_lshl_b32 s33, s3, 16
  s_add_u32 s32, s32, s33
  s_lshl_b32 s33, s37, 7
  s_add_u32 s32, s32, s33
  v_add_u32 v128, s32, v128
  s_waitcnt vmcnt(6)
  s_barrier
  ds_read_b64_tr_b16 v[180:181], v118 offset:1024
  ds_read_b64_tr_b16 v[182:183], v118 offset:1536
  ds_read_b128 v[188:191], v119 offset:12288
  ds_read_b64_tr_b16 v[184:185], v118 offset:2048
  ds_read_b64_tr_b16 v[186:187], v118 offset:2560
  ds_read_b64_tr_b16 v[132:133], v114 offset:0
  ds_read_b64_tr_b16 v[134:135], v114 offset:512
  ds_read_b64_tr_b16 v[136:137], v115 offset:0
  ds_read_b64_tr_b16 v[138:139], v115 offset:512
  ds_read_b64_tr_b16 v[140:141], v116 offset:0
  ds_read_b64_tr_b16 v[142:143], v116 offset:512
  ds_read_b64_tr_b16 v[144:145], v117 offset:0
  ds_read_b64_tr_b16 v[146:147], v117 offset:512
  ds_read_b64_tr_b16 v[148:149], v114 offset:1024
  ds_read_b64_tr_b16 v[150:151], v114 offset:1536
  ds_read_b64_tr_b16 v[152:153], v115 offset:1024
  ds_read_b64_tr_b16 v[154:155], v115 offset:1536
  ds_read_b64_tr_b16 v[156:157], v116 offset:1024
  ds_read_b64_tr_b16 v[158:159], v116 offset:1536
  ds_read_b64_tr_b16 v[160:161], v117 offset:1024
  ds_read_b64_tr_b16 v[162:163], v117 offset:1536
  ds_read_b64_tr_b16 v[164:165], v114 offset:2048
  ds_read_b64_tr_b16 v[166:167], v114 offset:2560
  ds_read_b64_tr_b16 v[168:169], v115 offset:2048
  ds_read_b64_tr_b16 v[170:171], v115 offset:2560
  ds_read_b64_tr_b16 v[172:173], v116 offset:2048
  ds_read_b64_tr_b16 v[174:175], v116 offset:2560
  ds_read_b64_tr_b16 v[176:177], v117 offset:2048
  ds_read_b64_tr_b16 v[178:179], v117 offset:2560
  s_waitcnt vmcnt(3) lgkmcnt(10)
  s_barrier
  v_mfma_f32_16x16x32_bf16 v[96:99], v[180:183], v[188:191], 0
  ds_read_b64_tr_b16 v[180:181], v118 offset:14336
  s_add_u32 m0, s39, 39936
  v_mfma_f32_16x16x32_bf16 v[100:103], v[188:191], v[184:187], 0
  buffer_load_dword v106, s[4:7], s16 offen sc1 lds
  v_mfma_f32_16x16x32_bf16 v[0:3], v[132:135], a[0:3], 0
  buffer_load_dwordx4 a[24:27], v105, s[4:7], s16 offen sc1
  v_mfma_f32_16x16x32_bf16 v[48:51], v[132:135], a[4:7], 0
  ds_read_b64_tr_b16 v[182:183], v118 offset:14848
  buffer_load_dwordx4 a[28:31], v105, s[4:7], s16 offen offset:1024 sc1
  v_mfma_f32_16x16x32_bf16 v[4:7], v[136:139], a[0:3], 0
  ds_read_b128 v[188:191], v119 offset:25600
  ds_read_b64_tr_b16 v[184:185], v118 offset:15360
  ds_read_b64_tr_b16 v[186:187], v118 offset:15872
  s_add_u32 s16, s16, 131072
  v_mfma_f32_16x16x32_bf16 v[52:55], v[136:139], a[4:7], 0
  ds_read_b64_tr_b16 v[132:133], v114 offset:13312
  s_bitset0_b32 s16, 20
  v_mfma_f32_16x16x32_bf16 v[8:11], v[140:143], a[0:3], 0
  ds_read_b64_tr_b16 v[134:135], v114 offset:13824
  s_add_u32 m0, s39, 53248
  v_mfma_f32_16x16x32_bf16 v[56:59], v[140:143], a[4:7], 0
  buffer_load_dword v106, s[4:7], s16 offen sc1 lds
  v_mfma_f32_16x16x32_bf16 v[12:15], v[144:147], a[0:3], 0
  ds_read_b64_tr_b16 v[136:137], v115 offset:13312
  ds_read_b64_tr_b16 v[138:139], v115 offset:13824
  buffer_load_dwordx4 a[32:35], v105, s[4:7], s16 offen sc1
  v_mfma_f32_16x16x32_bf16 v[60:63], v[144:147], a[4:7], 0
  buffer_load_dwordx4 a[36:39], v105, s[4:7], s16 offen offset:1024 sc1
  v_mfma_f32_16x16x32_bf16 v[16:19], v[148:151], a[0:3], 0
  ds_read_b64_tr_b16 v[140:141], v116 offset:13312
  ds_read_b64_tr_b16 v[142:143], v116 offset:13824
  s_add_u32 s16, s16, 131072
  v_mfma_f32_16x16x32_bf16 v[64:67], v[148:151], a[4:7], 0
  ds_read_b64_tr_b16 v[144:145], v117 offset:13312
  s_bitset0_b32 s16, 20
  v_mfma_f32_16x16x32_bf16 v[20:23], v[152:155], a[0:3], 0
  ds_read_b64_tr_b16 v[146:147], v117 offset:13824
  s_add_u32 m0, s39, 66560
  v_mfma_f32_16x16x32_bf16 v[68:71], v[152:155], a[4:7], 0
  buffer_load_dword v106, s[4:7], s16 offen sc1 lds
  v_mfma_f32_16x16x32_bf16 v[24:27], v[156:159], a[0:3], 0
  ds_read_b64_tr_b16 v[148:149], v114 offset:14336
  ds_read_b64_tr_b16 v[150:151], v114 offset:14848
  buffer_load_dwordx4 a[40:43], v105, s[4:7], s16 offen sc1
  v_mfma_f32_16x16x32_bf16 v[72:75], v[156:159], a[4:7], 0
  buffer_load_dwordx4 a[44:47], v105, s[4:7], s16 offen offset:1024 sc1
  s_waitcnt lgkmcnt(10)
  v_mfma_f32_16x16x32_bf16 v[28:31], v[160:163], a[0:3], 0
  ds_read_b64_tr_b16 v[152:153], v115 offset:14336
  ds_read_b64_tr_b16 v[154:155], v115 offset:14848
  s_add_u32 s16, s16, 131072
  v_mfma_f32_16x16x32_bf16 v[76:79], v[160:163], a[4:7], 0
  ds_read_b64_tr_b16 v[156:157], v116 offset:14336
  s_bitset0_b32 s16, 20
  v_mfma_f32_16x16x32_bf16 v[32:35], a[0:3], v[164:167], 0
  ds_read_b64_tr_b16 v[158:159], v116 offset:14848
  s_add_u32 m0, s39, 79872
  v_mfma_f32_16x16x32_bf16 v[80:83], a[4:7], v[164:167], 0
  buffer_load_dword v106, s[4:7], s16 offen sc1 lds
  v_mfma_f32_16x16x32_bf16 v[36:39], a[0:3], v[168:171], 0
  ds_read_b64_tr_b16 v[160:161], v117 offset:14336
  ds_read_b64_tr_b16 v[162:163], v117 offset:14848
  buffer_load_dwordx4 a[48:51], v105, s[4:7], s16 offen sc1
  v_mfma_f32_16x16x32_bf16 v[84:87], a[4:7], v[168:171], 0
  buffer_load_dwordx4 a[52:55], v105, s[4:7], s16 offen offset:1024 sc1
  v_mfma_f32_16x16x32_bf16 v[40:43], a[0:3], v[172:175], 0
  ds_read_b64_tr_b16 v[164:165], v114 offset:15360
  ds_read_b64_tr_b16 v[166:167], v114 offset:15872
  s_add_u32 s16, s16, 131072
  v_mfma_f32_16x16x32_bf16 v[88:91], a[4:7], v[172:175], 0
  ds_read_b64_tr_b16 v[168:169], v115 offset:15360
  s_bitset0_b32 s16, 20
  v_mfma_f32_16x16x32_bf16 v[44:47], a[0:3], v[176:179], 0
  ds_read_b64_tr_b16 v[170:171], v115 offset:15872
  ds_read_b64_tr_b16 v[172:173], v116 offset:15360
  v_mfma_f32_16x16x32_bf16 v[92:95], a[4:7], v[176:179], 0
  s_waitcnt vmcnt(12) lgkmcnt(10)
  s_barrier
  v_mfma_f32_16x16x32_bf16 v[96:99], v[180:183], v[188:191], v[96:99]
  ds_read_b64_tr_b16 v[174:175], v116 offset:15872
  s_add_u32 m0, s38, 93184
  v_mfma_f32_16x16x32_bf16 v[100:103], v[188:191], v[184:187], v[100:103]
  buffer_load_dwordx4 v107, s[8:11], s17 offen lds
  v_mfma_f32_16x16x32_bf16 v[0:3], v[132:135], a[8:11], v[0:3]
  ds_read_b64_tr_b16 v[176:177], v117 offset:15360
  ds_read_b64_tr_b16 v[178:179], v117 offset:15872
  v_mfma_f32_16x16x32_bf16 v[48:51], v[132:135], a[12:15], v[48:51]
  ds_read_b64_tr_b16 v[180:181], v118 offset:27648
  ds_read_b64_tr_b16 v[182:183], v118 offset:28160
  buffer_load_dword v127, v126, s[64:67], 0 offen sc1
  v_mfma_f32_16x16x32_bf16 v[4:7], v[136:139], a[8:11], v[4:7]
  ds_read_b128 v[188:191], v119 offset:38912
  ds_read_b64_tr_b16 v[184:185], v118 offset:28672
  ds_read_b64_tr_b16 v[186:187], v118 offset:29184
  buffer_load_dwordx4 v108, s[8:11], s17 offen offset:1024 lds
  v_mfma_f32_16x16x32_bf16 v[52:55], v[136:139], a[12:15], v[52:55]
  buffer_load_dwordx4 v109, s[8:11], s17 offen offset:2048 lds
  v_mfma_f32_16x16x32_bf16 v[8:11], v[140:143], a[8:11], v[8:11]
  ds_read_b64_tr_b16 v[132:133], v114 offset:26624
  ds_read_b64_tr_b16 v[134:135], v114 offset:27136
  v_mfma_f32_16x16x32_bf16 v[56:59], v[140:143], a[12:15], v[56:59]
  ds_read_b64_tr_b16 v[136:137], v115 offset:26624
  s_add_u32 s17, s17, 196608
  v_mfma_f32_16x16x32_bf16 v[12:15], v[144:147], a[8:11], v[12:15]
  ds_read_b64_tr_b16 v[138:139], v115 offset:27136
  s_cmp_eq_u32 s17, s10
  s_cselect_b32 s17, 0, s17
  v_mfma_f32_16x16x32_bf16 v[60:63], v[144:147], a[12:15], v[60:63]
  ds_read_b64_tr_b16 v[140:141], v116 offset:26624
  ds_read_b64_tr_b16 v[142:143], v116 offset:27136
  v_mfma_f32_16x16x32_bf16 v[16:19], v[148:151], a[8:11], v[16:19]
  s_add_u32 s8, s8, s10
  s_addc_u32 s9, s9, 0
  v_mfma_f32_16x16x32_bf16 v[64:67], v[148:151], a[12:15], v[64:67]
  ds_read_b64_tr_b16 v[144:145], v117 offset:26624
  ds_read_b64_tr_b16 v[146:147], v117 offset:27136
  s_waitcnt lgkmcnt(10)
  v_mfma_f32_16x16x32_bf16 v[20:23], v[152:155], a[8:11], v[20:23]
  ds_read_b64_tr_b16 v[148:149], v114 offset:27648
  s_add_u32 m0, s39, 93184
  v_mfma_f32_16x16x32_bf16 v[68:71], v[152:155], a[12:15], v[68:71]
  s_add_u32 s40, s20, 0x40000
  s_addc_u32 s41, s21, 0
  s_mov_b32 s42, 0x0
  s_mov_b32 s43, 0x20000
  s_or_b32 s33, s2, s3
  s_cmp_eq_u32 s33, 0
  s_cselect_b32 s42, 4, 0
  v_mov_b32 v192, s19
  buffer_store_dword v192, v119, s[40:43], 0 offen sc1
  v_mfma_f32_16x16x32_bf16 v[24:27], v[156:159], a[8:11], v[24:27]
  ds_read_b64_tr_b16 v[150:151], v114 offset:28160
  buffer_load_dword v106, s[4:7], s16 offen sc1 lds
  v_mfma_f32_16x16x32_bf16 v[72:75], v[156:159], a[12:15], v[72:75]
  ds_read_b64_tr_b16 v[152:153], v115 offset:27648
  ds_read_b64_tr_b16 v[154:155], v115 offset:28160
  v_mfma_f32_16x16x32_bf16 v[28:31], v[160:163], a[8:11], v[28:31]
  buffer_load_dwordx4 a[56:59], v105, s[4:7], s16 offen sc1
  v_mfma_f32_16x16x32_bf16 v[76:79], v[160:163], a[12:15], v[76:79]
  buffer_load_dwordx4 a[60:63], v105, s[4:7], s16 offen offset:1024 sc1
  v_mfma_f32_16x16x32_bf16 v[32:35], a[8:11], v[164:167], v[32:35]
  ds_read_b64_tr_b16 v[156:157], v116 offset:27648
  ds_read_b64_tr_b16 v[158:159], v116 offset:28160
  v_mfma_f32_16x16x32_bf16 v[80:83], a[12:15], v[164:167], v[80:83]
  ds_read_b64_tr_b16 v[160:161], v117 offset:27648
  s_add_u32 s16, s16, 131072
  v_mfma_f32_16x16x32_bf16 v[36:39], a[8:11], v[168:171], v[36:39]
  ds_read_b64_tr_b16 v[162:163], v117 offset:28160
  ds_read_b64_tr_b16 v[164:165], v114 offset:28672
  v_mfma_f32_16x16x32_bf16 v[84:87], a[12:15], v[168:171], v[84:87]
  ds_read_b64_tr_b16 v[166:167], v114 offset:29184
  s_bitset0_b32 s16, 20
  v_mfma_f32_16x16x32_bf16 v[40:43], a[8:11], v[172:175], v[40:43]
  ds_read_b64_tr_b16 v[168:169], v115 offset:28672
  ds_read_b64_tr_b16 v[170:171], v115 offset:29184
  v_mfma_f32_16x16x32_bf16 v[88:91], a[12:15], v[172:175], v[88:91]
  s_add_u32 s4, s4, s6
  s_addc_u32 s5, s5, 0
  v_mfma_f32_16x16x32_bf16 v[44:47], a[8:11], v[176:179], v[44:47]
  ds_read_b64_tr_b16 v[172:173], v116 offset:28672
  ds_read_b64_tr_b16 v[174:175], v116 offset:29184
  v_mfma_f32_16x16x32_bf16 v[92:95], a[12:15], v[176:179], v[92:95]
  s_waitcnt vmcnt(6) lgkmcnt(10)
  s_barrier
  v_cmp_ne_u32 vcc, s19, v127
  s_nop 1
  s_cmp_lg_u64 vcc, 0
  s_cbranch_scc1 L_slow_9
  L_back_10:
  v_mfma_f32_16x16x32_bf16 v[96:99], v[180:183], v[188:191], v[96:99]
  s_add_u32 m0, s39, 0
  s_nop 0
  buffer_load_dword v106, s[4:7], s16 offen sc1 lds
  v_mfma_f32_16x16x32_bf16 v[100:103], v[188:191], v[184:187], v[100:103]
  buffer_load_dwordx4 a[0:3], v105, s[4:7], s16 offen sc1
  v_mfma_f32_16x16x32_bf16 v[0:3], v[132:135], a[16:19], v[0:3]
  ds_read_b64_tr_b16 v[176:177], v117 offset:28672
  ds_read_b64_tr_b16 v[178:179], v117 offset:29184
  buffer_load_dwordx4 a[4:7], v105, s[4:7], s16 offen offset:1024 sc1
  v_mfma_f32_16x16x32_bf16 v[48:51], v[132:135], a[20:23], v[48:51]
  ds_read_b64_tr_b16 v[180:181], v118 offset:40960
  ds_read_b64_tr_b16 v[182:183], v118 offset:41472
  s_add_u32 s16, s16, 131072
  v_mfma_f32_16x16x32_bf16 v[4:7], v[136:139], a[16:19], v[4:7]
  ds_read_b128 v[188:191], v119 offset:52224
  ds_read_b64_tr_b16 v[184:185], v118 offset:41984
  ds_read_b64_tr_b16 v[186:187], v118 offset:42496
  s_bitset0_b32 s16, 20
  v_mfma_f32_16x16x32_bf16 v[52:55], v[136:139], a[20:23], v[52:55]
  ds_read_b64_tr_b16 v[132:133], v114 offset:39936
  s_add_u32 m0, s38, 0
  v_mfma_f32_16x16x32_bf16 v[8:11], v[140:143], a[16:19], v[8:11]
  ds_read_b64_tr_b16 v[134:135], v114 offset:40448
  buffer_load_dwordx4 v107, s[8:11], s17 offen lds
  buffer_load_dwordx4 v108, s[8:11], s17 offen offset:1024 lds
  v_mfma_f32_16x16x32_bf16 v[56:59], v[140:143], a[20:23], v[56:59]
  buffer_load_dwordx4 v109, s[8:11], s17 offen offset:2048 lds
  v_mfma_f32_16x16x32_bf16 v[12:15], v[144:147], a[16:19], v[12:15]
  ds_read_b64_tr_b16 v[136:137], v115 offset:39936
  ds_read_b64_tr_b16 v[138:139], v115 offset:40448
  s_add_u32 s17, s17, 196608
  v_mfma_f32_16x16x32_bf16 v[60:63], v[144:147], a[20:23], v[60:63]
  ds_read_b64_tr_b16 v[140:141], v116 offset:39936
  s_cmp_eq_u32 s17, s10
  v_mfma_f32_16x16x32_bf16 v[16:19], v[148:151], a[16:19], v[16:19]
  ds_read_b64_tr_b16 v[142:143], v116 offset:40448
  s_cselect_b32 s17, 0, s17
  v_mfma_f32_16x16x32_bf16 v[64:67], v[148:151], a[20:23], v[64:67]
  ds_read_b64_tr_b16 v[144:145], v117 offset:39936
  s_mov_b32 m0, s51
  v_mfma_f32_16x16x32_bf16 v[20:23], v[152:155], a[16:19], v[20:23]
  ds_read_b64_tr_b16 v[146:147], v117 offset:40448
  s_add_u32 s51, s51, 1024
  buffer_load_dwordx4 v129, s[52:55], s50 offen nt lds
  v_mfma_f32_16x16x32_bf16 v[68:71], v[152:155], a[20:23], v[68:71]
  ds_read_b64_tr_b16 v[148:149], v114 offset:40960
  s_add_u32 s50, s50, 98304
  s_waitcnt lgkmcnt(10)
  v_mfma_f32_16x16x32_bf16 v[24:27], v[156:159], a[16:19], v[24:27]
  ds_read_b64_tr_b16 v[150:151], v114 offset:41472
  s_mov_b32 m0, s51
  v_mfma_f32_16x16x32_bf16 v[72:75], v[156:159], a[20:23], v[72:75]
  ds_read_b64_tr_b16 v[152:153], v115 offset:40960
  s_add_u32 s51, s51, 1024
  v_mfma_f32_16x16x32_bf16 v[28:31], v[160:163], a[16:19], v[28:31]
  ds_read_b64_tr_b16 v[154:155], v115 offset:41472
  buffer_load_dwordx4 v129, s[52:55], s50 offen nt lds
  v_mfma_f32_16x16x32_bf16 v[76:79], v[160:163], a[20:23], v[76:79]
  ds_read_b64_tr_b16 v[156:157], v116 offset:40960
  s_add_u32 s50, s50, 98304
  v_mfma_f32_16x16x32_bf16 v[32:35], a[16:19], v[164:167], v[32:35]
  ds_read_b64_tr_b16 v[158:159], v116 offset:41472
  s_mov_b32 m0, s51
  s_add_u32 s51, s51, 1024
  v_mfma_f32_16x16x32_bf16 v[80:83], a[20:23], v[164:167], v[80:83]
  buffer_load_dwordx4 v129, s[52:55], s50 offen nt lds
  v_mfma_f32_16x16x32_bf16 v[36:39], a[16:19], v[168:171], v[36:39]
  ds_read_b64_tr_b16 v[160:161], v117 offset:40960
  ds_read_b64_tr_b16 v[162:163], v117 offset:41472
  s_add_u32 s50, s50, 98304
  v_mfma_f32_16x16x32_bf16 v[84:87], a[20:23], v[168:171], v[84:87]
  ds_read_b64_tr_b16 v[164:165], v114 offset:41984
  s_mov_b32 m0, s51
  v_mfma_f32_16x16x32_bf16 v[40:43], a[16:19], v[172:175], v[40:43]
  ds_read_b64_tr_b16 v[166:167], v114 offset:42496
  s_add_u32 s51, s51, 1024
  v_mfma_f32_16x16x32_bf16 v[88:91], a[20:23], v[172:175], v[88:91]
  buffer_load_dwordx4 v129, s[52:55], s50 offen nt lds
  v_mfma_f32_16x16x32_bf16 v[44:47], a[16:19], v[176:179], v[44:47]
  ds_read_b64_tr_b16 v[168:169], v115 offset:41984
  ds_read_b64_tr_b16 v[170:171], v115 offset:42496
  s_add_u32 s50, s50, 98304
  v_mfma_f32_16x16x32_bf16 v[92:95], a[20:23], v[176:179], v[92:95]
  s_waitcnt vmcnt(24) lgkmcnt(10)
  s_barrier
  v_mfma_f32_16x16x32_bf16 v[96:99], v[180:183], v[188:191], v[96:99]
  ds_read_b64_tr_b16 v[172:173], v116 offset:41984
  ds_read_b64_tr_b16 v[174:175], v116 offset:42496
  v_mfma_f32_16x16x32_bf16 v[100:103], v[188:191], v[184:187], v[100:103]
  ds_read_b64_tr_b16 v[176:177], v117 offset:41984
  ds_read_b64_tr_b16 v[178:179], v117 offset:42496
  v_mfma_f32_16x16x32_bf16 v[0:3], v[132:135], a[24:27], v[0:3]
  ds_read_b64_tr_b16 v[180:181], v124 offset:1024
  ds_read_b64_tr_b16 v[182:183], v124 offset:1536
  v_mfma_f32_16x16x32_bf16 v[48:51], v[132:135], a[28:31], v[48:51]
  ds_read_b128 v[188:191], v125 offset:12288
  ds_read_b64_tr_b16 v[184:185], v124 offset:2048
  v_mfma_f32_16x16x32_bf16 v[4:7], v[136:139], a[24:27], v[4:7]
  ds_read_b64_tr_b16 v[186:187], v124 offset:2560
  ds_read_b64_tr_b16 v[132:133], v120 offset:0
  v_mfma_f32_16x16x32_bf16 v[52:55], v[136:139], a[28:31], v[52:55]
  ds_read_b64_tr_b16 v[134:135], v120 offset:512
  ds_read_b64_tr_b16 v[136:137], v121 offset:0
  v_mfma_f32_16x16x32_bf16 v[8:11], v[140:143], a[24:27], v[8:11]
  ds_read_b64_tr_b16 v[138:139], v121 offset:512
  v_mfma_f32_16x16x32_bf16 v[56:59], v[140:143], a[28:31], v[56:59]
  ds_read_b64_tr_b16 v[140:141], v122 offset:0
  ds_read_b64_tr_b16 v[142:143], v122 offset:512
  v_mfma_f32_16x16x32_bf16 v[12:15], v[144:147], a[24:27], v[12:15]
  v_mfma_f32_16x16x32_bf16 v[60:63], v[144:147], a[28:31], v[60:63]
  ds_read_b64_tr_b16 v[144:145], v123 offset:0
  ds_read_b64_tr_b16 v[146:147], v123 offset:512
  v_mfma_f32_16x16x32_bf16 v[16:19], v[148:151], a[24:27], v[16:19]
  v_mfma_f32_16x16x32_bf16 v[64:67], v[148:151], a[28:31], v[64:67]
  ds_read_b64_tr_b16 v[148:149], v120 offset:1024
  ds_read_b64_tr_b16 v[150:151], v120 offset:1536
  s_waitcnt lgkmcnt(10)
  v_mfma_f32_16x16x32_bf16 v[20:23], v[152:155], a[24:27], v[20:23]
  v_mfma_f32_16x16x32_bf16 v[68:71], v[152:155], a[28:31], v[68:71]
  ds_read_b64_tr_b16 v[152:153], v121 offset:1024
  ds_read_b64_tr_b16 v[154:155], v121 offset:1536
  v_mfma_f32_16x16x32_bf16 v[24:27], v[156:159], a[24:27], v[24:27]
  v_mfma_f32_16x16x32_bf16 v[72:75], v[156:159], a[28:31], v[72:75]
  ds_read_b64_tr_b16 v[156:157], v122 offset:1024
  ds_read_b64_tr_b16 v[158:159], v122 offset:1536
  v_mfma_f32_16x16x32_bf16 v[28:31], v[160:163], a[24:27], v[28:31]
  v_mfma_f32_16x16x32_bf16 v[76:79], v[160:163], a[28:31], v[76:79]
  ds_read_b64_tr_b16 v[160:161], v123 offset:1024
  ds_read_b64_tr_b16 v[162:163], v123 offset:1536
  v_mfma_f32_16x16x32_bf16 v[32:35], a[24:27], v[164:167], v[32:35]
  v_mfma_f32_16x16x32_bf16 v[80:83], a[28:31], v[164:167], v[80:83]
  ds_read_b64_tr_b16 v[164:165], v120 offset:2048
  ds_read_b64_tr_b16 v[166:167], v120 offset:2560
  v_mfma_f32_16x16x32_bf16 v[36:39], a[24:27], v[168:171], v[36:39]
  v_mfma_f32_16x16x32_bf16 v[84:87], a[28:31], v[168:171], v[84:87]
  ds_read_b64_tr_b16 v[168:169], v121 offset:2048
  ds_read_b64_tr_b16 v[170:171], v121 offset:2560
  v_mfma_f32_16x16x32_bf16 v[40:43], a[24:27], v[172:175], v[40:43]
  v_mfma_f32_16x16x32_bf16 v[88:91], a[28:31], v[172:175], v[88:91]
  ds_read_b64_tr_b16 v[172:173], v122 offset:2048
  ds_read_b64_tr_b16 v[174:175], v122 offset:2560
  v_mfma_f32_16x16x32_bf16 v[44:47], a[24:27], v[176:179], v[44:47]
  v_mfma_f32_16x16x32_bf16 v[92:95], a[28:31], v[176:179], v[92:95]
  s_waitcnt vmcnt(21) lgkmcnt(10)
  s_barrier
  v_mfma_f32_16x16x32_bf16 v[96:99], v[180:183], v[188:191], v[96:99]
  buffer_store_dwordx4 v[244:247], v119, s[92:95], s35 offen offset:0 sc1
  v_mfma_f32_16x16x32_bf16 v[100:103], v[188:191], v[184:187], v[100:103]
  ds_read_b64_tr_b16 v[176:177], v123 offset:2048
  ds_read_b64_tr_b16 v[178:179], v123 offset:2560
  v_mfma_f32_16x16x32_bf16 v[0:3], v[132:135], a[32:35], v[0:3]
  ds_read_b64_tr_b16 v[180:181], v124 offset:14336
  ds_read_b64_tr_b16 v[182:183], v124 offset:14848
  v_mfma_f32_16x16x32_bf16 v[48:51], v[132:135], a[36:39], v[48:51]
  ds_read_b128 v[188:191], v125 offset:25600
  ds_read_b64_tr_b16 v[184:185], v124 offset:15360
  v_mfma_f32_16x16x32_bf16 v[4:7], v[136:139], a[32:35], v[4:7]
  ds_read_b64_tr_b16 v[186:187], v124 offset:15872
  ds_read_b64_tr_b16 v[132:133], v120 offset:13312
  v_mfma_f32_16x16x32_bf16 v[52:55], v[136:139], a[36:39], v[52:55]
  ds_read_b64_tr_b16 v[134:135], v120 offset:13824
  ds_read_b64_tr_b16 v[136:137], v121 offset:13312
  v_mfma_f32_16x16x32_bf16 v[8:11], v[140:143], a[32:35], v[8:11]
  ds_read_b64_tr_b16 v[138:139], v121 offset:13824
  v_mfma_f32_16x16x32_bf16 v[56:59], v[140:143], a[36:39], v[56:59]
  ds_read_b64_tr_b16 v[140:141], v122 offset:13312
  ds_read_b64_tr_b16 v[142:143], v122 offset:13824
  v_mfma_f32_16x16x32_bf16 v[12:15], v[144:147], a[32:35], v[12:15]
  v_mfma_f32_16x16x32_bf16 v[60:63], v[144:147], a[36:39], v[60:63]
  ds_read_b64_tr_b16 v[144:145], v123 offset:13312
  ds_read_b64_tr_b16 v[146:147], v123 offset:13824
  v_mfma_f32_16x16x32_bf16 v[16:19], v[148:151], a[32:35], v[16:19]
  v_mfma_f32_16x16x32_bf16 v[64:67], v[148:151], a[36:39], v[64:67]
  ds_read_b64_tr_b16 v[148:149], v120 offset:14336
  ds_read_b64_tr_b16 v[150:151], v120 offset:14848
  v_mfma_f32_16x16x32_bf16 v[20:23], v[152:155], a[32:35], v[20:23]
  v_mfma_f32_16x16x32_bf16 v[68:71], v[152:155], a[36:39], v[68:71]
  ds_read_b64_tr_b16 v[152:153], v121 offset:14336
  ds_read_b64_tr_b16 v[154:155], v121 offset:14848
  s_waitcnt lgkmcnt(10)
  v_mfma_f32_16x16x32_bf16 v[24:27], v[156:159], a[32:35], v[24:27]
  v_mfma_f32_16x16x32_bf16 v[72:75], v[156:159], a[36:39], v[72:75]
  ds_read_b64_tr_b16 v[156:157], v122 offset:14336
  ds_read_b64_tr_b16 v[158:159], v122 offset:14848
  v_mfma_f32_16x16x32_bf16 v[28:31], v[160:163], a[32:35], v[28:31]
  v_mfma_f32_16x16x32_bf16 v[76:79], v[160:163], a[36:39], v[76:79]
  ds_read_b64_tr_b16 v[160:161], v123 offset:14336
  ds_read_b64_tr_b16 v[162:163], v123 offset:14848
  v_mfma_f32_16x16x32_bf16 v[32:35], a[32:35], v[164:167], v[32:35]
  v_mfma_f32_16x16x32_bf16 v[80:83], a[36:39], v[164:167], v[80:83]
  ds_read_b64_tr_b16 v[164:165], v120 offset:15360
  ds_read_b64_tr_b16 v[166:167], v120 offset:15872
  v_mfma_f32_16x16x32_bf16 v[36:39], a[32:35], v[168:171], v[36:39]
  v_mfma_f32_16x16x32_bf16 v[84:87], a[36:39], v[168:171], v[84:87]
  ds_read_b64_tr_b16 v[168:169], v121 offset:15360
  ds_read_b64_tr_b16 v[170:171], v121 offset:15872
  v_mfma_f32_16x16x32_bf16 v[40:43], a[32:35], v[172:175], v[40:43]
  v_mfma_f32_16x16x32_bf16 v[88:91], a[36:39], v[172:175], v[88:91]
  ds_read_b64_tr_b16 v[172:173], v122 offset:15360
  ds_read_b64_tr_b16 v[174:175], v122 offset:15872
  v_mfma_f32_16x16x32_bf16 v[44:47], a[32:35], v[176:179], v[44:47]
  v_mfma_f32_16x16x32_bf16 v[92:95], a[36:39], v[176:179], v[92:95]
  s_waitcnt vmcnt(19) lgkmcnt(10)
  s_barrier
  v_mfma_f32_16x16x32_bf16 v[96:99], v[180:183], v[188:191], v[96:99]
  ds_read_b64_tr_b16 v[176:177], v123 offset:15360
  s_add_u32 m0, s38, 13312
  v_mfma_f32_16x16x32_bf16 v[100:103], v[188:191], v[184:187], v[100:103]
  buffer_load_dwordx4 v107, s[8:11], s17 offen lds
  v_mfma_f32_16x16x32_bf16 v[0:3], v[132:135], a[40:43], v[0:3]
  ds_read_b64_tr_b16 v[178:179], v123 offset:15872
  buffer_load_dwordx4 v108, s[8:11], s17 offen offset:1024 lds
  v_mfma_f32_16x16x32_bf16 v[48:51], v[132:135], a[44:47], v[48:51]
  ds_read_b64_tr_b16 v[180:181], v124 offset:27648
  ds_read_b64_tr_b16 v[182:183], v124 offset:28160
  buffer_load_dwordx4 v109, s[8:11], s17 offen offset:2048 lds
  v_mfma_f32_16x16x32_bf16 v[4:7], v[136:139], a[40:43], v[4:7]
  ds_read_b128 v[188:191], v125 offset:38912
  ds_read_b64_tr_b16 v[184:185], v124 offset:28672
  ds_read_b64_tr_b16 v[186:187], v124 offset:29184
  v_mfma_f32_16x16x32_bf16 v[52:55], v[136:139], a[44:47], v[52:55]
  ds_read_b64_tr_b16 v[132:133], v120 offset:26624
  s_add_u32 s17, s17, 196608
  v_mfma_f32_16x16x32_bf16 v[8:11], v[140:143], a[40:43], v[8:11]
  ds_read_b64_tr_b16 v[134:135], v120 offset:27136
  s_cmp_eq_u32 s17, s10
  v_mfma_f32_16x16x32_bf16 v[56:59], v[140:143], a[44:47], v[56:59]
  ds_read_b64_tr_b16 v[136:137], v121 offset:26624
  s_cselect_b32 s17, 0, s17
  v_mfma_f32_16x16x32_bf16 v[12:15], v[144:147], a[40:43], v[12:15]
  ds_read_b64_tr_b16 v[138:139], v121 offset:27136
  s_add_u32 m0, s39, 13312
  v_mfma_f32_16x16x32_bf16 v[60:63], v[144:147], a[44:47], v[60:63]
  ds_read_b64_tr_b16 v[140:141], v122 offset:26624
  ds_read_b64_tr_b16 v[142:143], v122 offset:27136
  v_mfma_f32_16x16x32_bf16 v[16:19], v[148:151], a[40:43], v[16:19]
  buffer_load_dword v106, s[4:7], s16 offen sc1 lds
  v_mfma_f32_16x16x32_bf16 v[64:67], v[148:151], a[44:47], v[64:67]
  buffer_load_dwordx4 a[8:11], v105, s[4:7], s16 offen sc1
  v_mfma_f32_16x16x32_bf16 v[20:23], v[152:155], a[40:43], v[20:23]
  ds_read_b64_tr_b16 v[144:145], v123 offset:26624
  ds_read_b64_tr_b16 v[146:147], v123 offset:27136
  buffer_load_dwordx4 a[12:15], v105, s[4:7], s16 offen offset:1024 sc1
  v_mfma_f32_16x16x32_bf16 v[68:71], v[152:155], a[44:47], v[68:71]
  ds_read_b64_tr_b16 v[148:149], v120 offset:27648
  s_add_u32 s16, s16, 131072
  s_waitcnt lgkmcnt(10)
  v_mfma_f32_16x16x32_bf16 v[24:27], v[156:159], a[40:43], v[24:27]
  ds_read_b64_tr_b16 v[150:151], v120 offset:28160
  ds_read_b64_tr_b16 v[152:153], v121 offset:27648
  v_mfma_f32_16x16x32_bf16 v[72:75], v[156:159], a[44:47], v[72:75]
  ds_read_b64_tr_b16 v[154:155], v121 offset:28160
  s_bitset0_b32 s16, 20
  v_mfma_f32_16x16x32_bf16 v[28:31], v[160:163], a[40:43], v[28:31]
  ds_read_b64_tr_b16 v[156:157], v122 offset:27648
  s_add_u32 m0, s38, 26624
  v_mfma_f32_16x16x32_bf16 v[76:79], v[160:163], a[44:47], v[76:79]
  buffer_load_dwordx4 v107, s[8:11], s17 offen lds
  v_mfma_f32_16x16x32_bf16 v[32:35], a[40:43], v[164:167], v[32:35]
  ds_read_b64_tr_b16 v[158:159], v122 offset:28160
  buffer_load_dwordx4 v108, s[8:11], s17 offen offset:1024 lds
  v_mfma_f32_16x16x32_bf16 v[80:83], a[44:47], v[164:167], v[80:83]
  ds_read_b64_tr_b16 v[160:161], v123 offset:27648
  ds_read_b64_tr_b16 v[162:163], v123 offset:28160
  v_mfma_f32_16x16x32_bf16 v[36:39], a[40:43], v[168:171], v[36:39]
  buffer_load_dwordx4 v109, s[8:11], s17 offen offset:2048 lds
  v_mfma_f32_16x16x32_bf16 v[84:87], a[44:47], v[168:171], v[84:87]
  ds_read_b64_tr_b16 v[164:165], v120 offset:28672
  s_add_u32 s17, s17, 196608
  v_mfma_f32_16x16x32_bf16 v[40:43], a[40:43], v[172:175], v[40:43]
  ds_read_b64_tr_b16 v[166:167], v120 offset:29184
  s_cmp_eq_u32 s17, s10
  v_mfma_f32_16x16x32_bf16 v[88:91], a[44:47], v[172:175], v[88:91]
  ds_read_b64_tr_b16 v[168:169], v121 offset:28672
  s_cselect_b32 s17, 0, s17
  v_mfma_f32_16x16x32_bf16 v[44:47], a[40:43], v[176:179], v[44:47]
  ds_read_b64_tr_b16 v[170:171], v121 offset:29184
  ds_read_b64_tr_b16 v[172:173], v122 offset:28672
  v_mfma_f32_16x16x32_bf16 v[92:95], a[44:47], v[176:179], v[92:95]
  s_waitcnt vmcnt(20) lgkmcnt(10)
  s_barrier
  v_mfma_f32_16x16x32_bf16 v[96:99], v[180:183], v[188:191], v[96:99]
  ds_read_b64_tr_b16 v[174:175], v122 offset:29184
  s_add_u32 m0, s39, 26624
  v_mfma_f32_16x16x32_bf16 v[100:103], v[188:191], v[184:187], v[100:103]
  buffer_load_dword v106, s[4:7], s16 offen sc1 lds
  v_mfma_f32_16x16x32_bf16 v[0:3], v[132:135], a[48:51], v[0:3]
  ds_read_b64_tr_b16 v[176:177], v123 offset:28672
  ds_read_b64_tr_b16 v[178:179], v123 offset:29184
  buffer_load_dwordx4 a[16:19], v105, s[4:7], s16 offen sc1
  v_mfma_f32_16x16x32_bf16 v[48:51], v[132:135], a[52:55], v[48:51]
  ds_read_b64_tr_b16 v[180:181], v124 offset:40960
  ds_read_b64_tr_b16 v[182:183], v124 offset:41472
  buffer_load_dwordx4 a[20:23], v105, s[4:7], s16 offen offset:1024 sc1
  v_mfma_f32_16x16x32_bf16 v[4:7], v[136:139], a[48:51], v[4:7]
  ds_read_b128 v[188:191], v125 offset:52224
  ds_read_b64_tr_b16 v[184:185], v124 offset:41984
  ds_read_b64_tr_b16 v[186:187], v124 offset:42496
  v_mfma_f32_16x16x32_bf16 v[52:55], v[136:139], a[52:55], v[52:55]
  ds_read_b64_tr_b16 v[132:133], v120 offset:39936
  s_add_u32 s16, s16, 131072
  v_mfma_f32_16x16x32_bf16 v[8:11], v[140:143], a[48:51], v[8:11]
  ds_read_b64_tr_b16 v[134:135], v120 offset:40448
  s_bitset0_b32 s16, 20
  v_mfma_f32_16x16x32_bf16 v[56:59], v[140:143], a[52:55], v[56:59]
  ds_read_b64_tr_b16 v[136:137], v121 offset:39936
  s_add_u32 m0, s38, 39936
  v_mfma_f32_16x16x32_bf16 v[12:15], v[144:147], a[48:51], v[12:15]
  ds_read_b64_tr_b16 v[138:139], v121 offset:40448
  ds_read_b64_tr_b16 v[140:141], v122 offset:39936
  v_mfma_f32_16x16x32_bf16 v[60:63], v[144:147], a[52:55], v[60:63]
  buffer_load_dwordx4 v107, s[8:11], s17 offen lds
  v_mfma_f32_16x16x32_bf16 v[16:19], v[148:151], a[48:51], v[16:19]
  ds_read_b64_tr_b16 v[142:143], v122 offset:40448
  buffer_load_dwordx4 v108, s[8:11], s17 offen offset:1024 lds
  v_mfma_f32_16x16x32_bf16 v[64:67], v[148:151], a[52:55], v[64:67]
  buffer_load_dwordx4 v109, s[8:11], s17 offen offset:2048 lds
  s_waitcnt lgkmcnt(10)
  v_mfma_f32_16x16x32_bf16 v[20:23], v[152:155], a[48:51], v[20:23]
  ds_read_b64_tr_b16 v[144:145], v123 offset:39936
  ds_read_b64_tr_b16 v[146:147], v123 offset:40448
  v_mfma_f32_16x16x32_bf16 v[68:71], v[152:155], a[52:55], v[68:71]
  ds_read_b64_tr_b16 v[148:149], v120 offset:40960
  s_add_u32 s17, s17, 196608
  v_mfma_f32_16x16x32_bf16 v[24:27], v[156:159], a[48:51], v[24:27]
  ds_read_b64_tr_b16 v[150:151], v120 offset:41472
  s_cmp_eq_u32 s17, s10
  v_mfma_f32_16x16x32_bf16 v[72:75], v[156:159], a[52:55], v[72:75]
  ds_read_b64_tr_b16 v[152:153], v121 offset:40960
  s_cselect_b32 s17, 0, s17
  v_mfma_f32_16x16x32_bf16 v[28:31], v[160:163], a[48:51], v[28:31]
  ds_read_b64_tr_b16 v[154:155], v121 offset:41472
  ds_read_b64_tr_b16 v[156:157], v122 offset:40960
  v_mfma_f32_16x16x32_bf16 v[76:79], v[160:163], a[52:55], v[76:79]
  ds_read_b64_tr_b16 v[158:159], v122 offset:41472
  s_add_u32 m0, s39, 39936
  v_mfma_f32_16x16x32_bf16 v[32:35], a[48:51], v[164:167], v[32:35]
  buffer_load_dword v106, s[4:7], s16 offen sc1 lds
  v_mfma_f32_16x16x32_bf16 v[80:83], a[52:55], v[164:167], v[80:83]
  buffer_load_dwordx4 a[24:27], v105, s[4:7], s16 offen sc1
  v_mfma_f32_16x16x32_bf16 v[36:39], a[48:51], v[168:171], v[36:39]
  ds_read_b64_tr_b16 v[160:161], v123 offset:40960
  ds_read_b64_tr_b16 v[162:163], v123 offset:41472
  v_mfma_f32_16x16x32_bf16 v[84:87], a[52:55], v[168:171], v[84:87]
  buffer_load_dwordx4 a[28:31], v105, s[4:7], s16 offen offset:1024 sc1
  v_mfma_f32_16x16x32_bf16 v[40:43], a[48:51], v[172:175], v[40:43]
  ds_read_b64_tr_b16 v[164:165], v120 offset:41984
  ds_read_b64_tr_b16 v[166:167], v120 offset:42496
  s_add_u32 s16, s16, 131072
  v_mfma_f32_16x16x32_bf16 v[88:91], a[52:55], v[172:175], v[88:91]
  ds_read_b64_tr_b16 v[168:169], v121 offset:41984
  s_bitset0_b32 s16, 20
  v_mfma_f32_16x16x32_bf16 v[44:47], a[48:51], v[176:179], v[44:47]
  ds_read_b64_tr_b16 v[170:171], v121 offset:42496
  ds_read_b64_tr_b16 v[172:173], v122 offset:41984
  v_mfma_f32_16x16x32_bf16 v[92:95], a[52:55], v[176:179], v[92:95]
  s_waitcnt vmcnt(23) lgkmcnt(10)
  s_barrier
  v_mfma_f32_16x16x32_bf16 v[96:99], v[180:183], v[188:191], v[96:99]
  ds_read_b64_tr_b16 v[174:175], v122 offset:42496
  s_add_u32 m0, s38, 53248
  v_mfma_f32_16x16x32_bf16 v[100:103], v[188:191], v[184:187], v[100:103]
  buffer_load_dwordx4 v107, s[8:11], s17 offen lds
  v_mfma_f32_16x16x32_bf16 v[0:3], v[132:135], a[56:59], v[0:3]
  ds_read_b64_tr_b16 v[176:177], v123 offset:41984
  ds_read_b64_tr_b16 v[178:179], v123 offset:42496
  buffer_load_dwordx4 v108, s[8:11], s17 offen offset:1024 lds
  v_mfma_f32_16x16x32_bf16 v[48:51], v[132:135], a[60:63], v[48:51]
  ds_read_b64_tr_b16 v[180:181], v118 offset:1024
  ds_read_b64_tr_b16 v[182:183], v118 offset:1536
  buffer_load_dwordx4 v109, s[8:11], s17 offen offset:2048 lds
  v_mfma_f32_16x16x32_bf16 v[4:7], v[136:139], a[56:59], v[4:7]
  ds_read_b128 v[188:191], v119 offset:12288
  ds_read_b64_tr_b16 v[184:185], v118 offset:2048
  ds_read_b64_tr_b16 v[186:187], v118 offset:2560
  v_mfma_f32_16x16x32_bf16 v[52:55], v[136:139], a[60:63], v[52:55]
  ds_read_b64_tr_b16 v[132:133], v114 offset:0
  s_add_u32 s17, s17, 196608
  v_mfma_f32_16x16x32_bf16 v[8:11], v[140:143], a[56:59], v[8:11]
  ds_read_b64_tr_b16 v[134:135], v114 offset:512
  s_cmp_eq_u32 s17, s10
  v_mfma_f32_16x16x32_bf16 v[56:59], v[140:143], a[60:63], v[56:59]
  ds_read_b64_tr_b16 v[136:137], v115 offset:0
  s_cselect_b32 s17, 0, s17
  v_mfma_f32_16x16x32_bf16 v[12:15], v[144:147], a[56:59], v[12:15]
  ds_read_b64_tr_b16 v[138:139], v115 offset:512
  s_add_u32 m0, s39, 53248
  v_mfma_f32_16x16x32_bf16 v[60:63], v[144:147], a[60:63], v[60:63]
  ds_read_b64_tr_b16 v[140:141], v116 offset:0
  ds_read_b64_tr_b16 v[142:143], v116 offset:512
  v_mfma_f32_16x16x32_bf16 v[16:19], v[148:151], a[56:59], v[16:19]
  buffer_load_dword v106, s[4:7], s16 offen sc1 lds
  v_mfma_f32_16x16x32_bf16 v[64:67], v[148:151], a[60:63], v[64:67]
  buffer_load_dwordx4 a[32:35], v105, s[4:7], s16 offen sc1
  s_waitcnt lgkmcnt(10)
  v_mfma_f32_16x16x32_bf16 v[20:23], v[152:155], a[56:59], v[20:23]
  ds_read_b64_tr_b16 v[144:145], v117 offset:0
  ds_read_b64_tr_b16 v[146:147], v117 offset:512
  buffer_load_dwordx4 a[36:39], v105, s[4:7], s16 offen offset:1024 sc1
  v_mfma_f32_16x16x32_bf16 v[68:71], v[152:155], a[60:63], v[68:71]
  ds_read_b64_tr_b16 v[148:149], v114 offset:1024
  s_add_u32 s16, s16, 131072
  v_mfma_f32_16x16x32_bf16 v[24:27], v[156:159], a[56:59], v[24:27]
  ds_read_b64_tr_b16 v[150:151], v114 offset:1536
  ds_read_b64_tr_b16 v[152:153], v115 offset:1024
  v_mfma_f32_16x16x32_bf16 v[72:75], v[156:159], a[60:63], v[72:75]
  ds_read_b64_tr_b16 v[154:155], v115 offset:1536
  s_bitset0_b32 s16, 20
  v_mfma_f32_16x16x32_bf16 v[28:31], v[160:163], a[56:59], v[28:31]
  ds_read_b64_tr_b16 v[156:157], v116 offset:1024
  s_add_u32 m0, s38, 66560
  v_mfma_f32_16x16x32_bf16 v[76:79], v[160:163], a[60:63], v[76:79]
  buffer_load_dwordx4 v107, s[8:11], s17 offen lds
  v_mfma_f32_16x16x32_bf16 v[32:35], a[56:59], v[164:167], v[32:35]
  ds_read_b64_tr_b16 v[158:159], v116 offset:1536
  buffer_load_dwordx4 v108, s[8:11], s17 offen offset:1024 lds
  v_mfma_f32_16x16x32_bf16 v[80:83], a[60:63], v[164:167], v[80:83]
  ds_read_b64_tr_b16 v[160:161], v117 offset:1024
  ds_read_b64_tr_b16 v[162:163], v117 offset:1536
  v_mfma_f32_16x16x32_bf16 v[36:39], a[56:59], v[168:171], v[36:39]
  buffer_load_dwordx4 v109, s[8:11], s17 offen offset:2048 lds
  v_mfma_f32_16x16x32_bf16 v[84:87], a[60:63], v[168:171], v[84:87]
  ds_read_b64_tr_b16 v[164:165], v114 offset:2048
  s_add_u32 s17, s17, 196608
  v_mfma_f32_16x16x32_bf16 v[40:43], a[56:59], v[172:175], v[40:43]
  ds_read_b64_tr_b16 v[166:167], v114 offset:2560
  s_cmp_eq_u32 s17, s10
  v_mfma_f32_16x16x32_bf16 v[88:91], a[60:63], v[172:175], v[88:91]
  ds_read_b64_tr_b16 v[168:169], v115 offset:2048
  s_cselect_b32 s17, 0, s17
  v_mfma_f32_16x16x32_bf16 v[44:47], a[56:59], v[176:179], v[44:47]
  ds_read_b64_tr_b16 v[170:171], v115 offset:2560
  ds_read_b64_tr_b16 v[172:173], v116 offset:2048
  v_mfma_f32_16x16x32_bf16 v[92:95], a[60:63], v[176:179], v[92:95]
  s_waitcnt vmcnt(21) lgkmcnt(10)
  s_barrier
  v_mfma_f32_16x16x32_bf16 v[96:99], v[180:183], v[188:191], v[96:99]
  ds_read_b64_tr_b16 v[174:175], v116 offset:2560
  s_add_u32 m0, s39, 66560
  v_mfma_f32_16x16x32_bf16 v[100:103], v[188:191], v[184:187], v[100:103]
  buffer_load_dword v106, s[4:7], s16 offen sc1 lds
  v_mfma_f32_16x16x32_bf16 v[0:3], v[132:135], a[0:3], v[0:3]
  ds_read_b64_tr_b16 v[176:177], v117 offset:2048
  ds_read_b64_tr_b16 v[178:179], v117 offset:2560
  buffer_load_dwordx4 a[40:43], v105, s[4:7], s16 offen sc1
  v_mfma_f32_16x16x32_bf16 v[48:51], v[132:135], a[4:7], v[48:51]
  ds_read_b64_tr_b16 v[180:181], v118 offset:14336
  ds_read_b64_tr_b16 v[182:183], v118 offset:14848
  buffer_load_dwordx4 a[44:47], v105, s[4:7], s16 offen offset:1024 sc1
  v_mfma_f32_16x16x32_bf16 v[4:7], v[136:139], a[0:3], v[4:7]
  ds_read_b128 v[188:191], v119 offset:25600
  ds_read_b64_tr_b16 v[184:185], v118 offset:15360
  ds_read_b64_tr_b16 v[186:187], v118 offset:15872
  v_mfma_f32_16x16x32_bf16 v[52:55], v[136:139], a[4:7], v[52:55]
  ds_read_b64_tr_b16 v[132:133], v114 offset:13312
  s_add_u32 s16, s16, 131072
  v_mfma_f32_16x16x32_bf16 v[8:11], v[140:143], a[0:3], v[8:11]
  ds_read_b64_tr_b16 v[134:135], v114 offset:13824
  s_bitset0_b32 s16, 20
  v_mfma_f32_16x16x32_bf16 v[56:59], v[140:143], a[4:7], v[56:59]
  ds_read_b64_tr_b16 v[136:137], v115 offset:13312
  s_add_u32 m0, s38, 79872
  v_mfma_f32_16x16x32_bf16 v[12:15], v[144:147], a[0:3], v[12:15]
  ds_read_b64_tr_b16 v[138:139], v115 offset:13824
  buffer_load_dwordx4 v107, s[8:11], s17 offen lds
  v_mfma_f32_16x16x32_bf16 v[60:63], v[144:147], a[4:7], v[60:63]
  ds_read_b64_tr_b16 v[140:141], v116 offset:13312
  ds_read_b64_tr_b16 v[142:143], v116 offset:13824
  v_mfma_f32_16x16x32_bf16 v[16:19], v[148:151], a[0:3], v[16:19]
  buffer_load_dwordx4 v108, s[8:11], s17 offen offset:1024 lds
  v_mfma_f32_16x16x32_bf16 v[64:67], v[148:151], a[4:7], v[64:67]
  buffer_load_dwordx4 v109, s[8:11], s17 offen offset:2048 lds
  s_waitcnt lgkmcnt(10)
  v_mfma_f32_16x16x32_bf16 v[20:23], v[152:155], a[0:3], v[20:23]
  ds_read_b64_tr_b16 v[144:145], v117 offset:13312
  ds_read_b64_tr_b16 v[146:147], v117 offset:13824
  s_add_u32 s17, s17, 196608
  v_mfma_f32_16x16x32_bf16 v[68:71], v[152:155], a[4:7], v[68:71]
  ds_read_b64_tr_b16 v[148:149], v114 offset:14336
  s_cmp_eq_u32 s17, s10
  v_mfma_f32_16x16x32_bf16 v[24:27], v[156:159], a[0:3], v[24:27]
  ds_read_b64_tr_b16 v[150:151], v114 offset:14848
  ds_read_b64_tr_b16 v[152:153], v115 offset:14336
  v_mfma_f32_16x16x32_bf16 v[72:75], v[156:159], a[4:7], v[72:75]
  ds_read_b64_tr_b16 v[154:155], v115 offset:14848
  s_cselect_b32 s17, 0, s17
  v_mfma_f32_16x16x32_bf16 v[28:31], v[160:163], a[0:3], v[28:31]
  ds_read_b64_tr_b16 v[156:157], v116 offset:14336
  s_add_u32 m0, s39, 79872
  v_mfma_f32_16x16x32_bf16 v[76:79], v[160:163], a[4:7], v[76:79]
  buffer_load_dword v106, s[4:7], s16 offen sc1 lds
  v_mfma_f32_16x16x32_bf16 v[32:35], a[0:3], v[164:167], v[32:35]
  ds_read_b64_tr_b16 v[158:159], v116 offset:14848
  buffer_load_dwordx4 a[48:51], v105, s[4:7], s16 offen sc1
  v_mfma_f32_16x16x32_bf16 v[80:83], a[4:7], v[164:167], v[80:83]
  ds_read_b64_tr_b16 v[160:161], v117 offset:14336
  ds_read_b64_tr_b16 v[162:163], v117 offset:14848
  v_mfma_f32_16x16x32_bf16 v[36:39], a[0:3], v[168:171], v[36:39]
  buffer_load_dwordx4 a[52:55], v105, s[4:7], s16 offen offset:1024 sc1
  v_mfma_f32_16x16x32_bf16 v[84:87], a[4:7], v[168:171], v[84:87]
  ds_read_b64_tr_b16 v[164:165], v114 offset:15360
  s_add_u32 s16, s16, 131072
  v_mfma_f32_16x16x32_bf16 v[40:43], a[0:3], v[172:175], v[40:43]
  ds_read_b64_tr_b16 v[166:167], v114 offset:15872
  s_bitset0_b32 s16, 20
  v_mfma_f32_16x16x32_bf16 v[88:91], a[4:7], v[172:175], v[88:91]
  buffer_store_dwordx4 v[244:247], v119, s[92:95], s35 offen offset:1024 sc1
  v_mfma_f32_16x16x32_bf16 v[44:47], a[0:3], v[176:179], v[44:47]
  ds_read_b64_tr_b16 v[168:169], v115 offset:15360
  ds_read_b64_tr_b16 v[170:171], v115 offset:15872
  v_mfma_f32_16x16x32_bf16 v[92:95], a[4:7], v[176:179], v[92:95]
  s_waitcnt vmcnt(25) lgkmcnt(10)
  s_barrier
  v_mfma_f32_16x16x32_bf16 v[96:99], v[180:183], v[188:191], v[96:99]
  ds_read_b64_tr_b16 v[172:173], v116 offset:15360
  ds_read_b64_tr_b16 v[174:175], v116 offset:15872
  s_add_u32 m0, s38, 93184
  v_mfma_f32_16x16x32_bf16 v[100:103], v[188:191], v[184:187], v[100:103]
  buffer_load_dwordx4 v107, s[8:11], s17 offen lds
  v_mfma_f32_16x16x32_bf16 v[0:3], v[132:135], a[8:11], v[0:3]
  ds_read_b64_tr_b16 v[176:177], v117 offset:15360
  ds_read_b64_tr_b16 v[178:179], v117 offset:15872
  buffer_load_dwordx4 v108, s[8:11], s17 offen offset:1024 lds
  v_mfma_f32_16x16x32_bf16 v[48:51], v[132:135], a[12:15], v[48:51]
  ds_read_b64_tr_b16 v[180:181], v118 offset:27648
  ds_read_b64_tr_b16 v[182:183], v118 offset:28160
  buffer_load_dwordx4 v109, s[8:11], s17 offen offset:2048 lds
  v_mfma_f32_16x16x32_bf16 v[4:7], v[136:139], a[8:11], v[4:7]
  ds_read_b128 v[188:191], v119 offset:38912
  ds_read_b64_tr_b16 v[184:185], v118 offset:28672
  ds_read_b64_tr_b16 v[186:187], v118 offset:29184
  s_add_u32 s17, s17, 196608
  v_mfma_f32_16x16x32_bf16 v[52:55], v[136:139], a[12:15], v[52:55]
  ds_read_b64_tr_b16 v[132:133], v114 offset:26624
  s_cmp_eq_u32 s17, s10
  v_mfma_f32_16x16x32_bf16 v[8:11], v[140:143], a[8:11], v[8:11]
  ds_read_b64_tr_b16 v[134:135], v114 offset:27136
  ds_read_b64_tr_b16 v[136:137], v115 offset:26624
  v_mfma_f32_16x16x32_bf16 v[56:59], v[140:143], a[12:15], v[56:59]
  ds_read_b64_tr_b16 v[138:139], v115 offset:27136
  s_cselect_b32 s17, 0, s17
  v_mfma_f32_16x16x32_bf16 v[12:15], v[144:147], a[8:11], v[12:15]
  s_add_u32 s8, s8, s10
  s_addc_u32 s9, s9, 0
  v_mfma_f32_16x16x32_bf16 v[60:63], v[144:147], a[12:15], v[60:63]
  ds_read_b64_tr_b16 v[140:141], v116 offset:26624
  s_add_u32 m0, s39, 93184
  v_mfma_f32_16x16x32_bf16 v[16:19], v[148:151], a[8:11], v[16:19]
  ds_read_b64_tr_b16 v[142:143], v116 offset:27136
  buffer_load_dword v106, s[4:7], s16 offen sc1 lds
  v_mfma_f32_16x16x32_bf16 v[64:67], v[148:151], a[12:15], v[64:67]
  buffer_load_dwordx4 a[56:59], v105, s[4:7], s16 offen sc1
  s_waitcnt lgkmcnt(10)
  v_mfma_f32_16x16x32_bf16 v[20:23], v[152:155], a[8:11], v[20:23]
  ds_read_b64_tr_b16 v[144:145], v117 offset:26624
  ds_read_b64_tr_b16 v[146:147], v117 offset:27136
  v_mfma_f32_16x16x32_bf16 v[68:71], v[152:155], a[12:15], v[68:71]
  buffer_load_dwordx4 a[60:63], v105, s[4:7], s16 offen offset:1024 sc1
  v_mfma_f32_16x16x32_bf16 v[24:27], v[156:159], a[8:11], v[24:27]
  ds_read_b64_tr_b16 v[148:149], v114 offset:27648
  ds_read_b64_tr_b16 v[150:151], v114 offset:28160
  s_add_u32 s16, s16, 131072
  v_mfma_f32_16x16x32_bf16 v[72:75], v[156:159], a[12:15], v[72:75]
  ds_read_b64_tr_b16 v[152:153], v115 offset:27648
  s_bitset0_b32 s16, 20
  v_mfma_f32_16x16x32_bf16 v[28:31], v[160:163], a[8:11], v[28:31]
  ds_read_b64_tr_b16 v[154:155], v115 offset:28160
  s_add_u32 s4, s4, s6
  s_addc_u32 s5, s5, 0
  v_mfma_f32_16x16x32_bf16 v[76:79], v[160:163], a[12:15], v[76:79]
  ds_read_b64_tr_b16 v[156:157], v116 offset:27648
  s_add_u32 m0, s39, 0
  v_mfma_f32_16x16x32_bf16 v[32:35], a[8:11], v[164:167], v[32:35]
  ds_read_b64_tr_b16 v[158:159], v116 offset:28160
  ds_read_b64_tr_b16 v[160:161], v117 offset:27648
  v_mfma_f32_16x16x32_bf16 v[80:83], a[12:15], v[164:167], v[80:83]
  buffer_load_dword v106, s[4:7], s16 offen sc1 lds
  v_mfma_f32_16x16x32_bf16 v[36:39], a[8:11], v[168:171], v[36:39]
  ds_read_b64_tr_b16 v[162:163], v117 offset:28160
  buffer_load_dwordx4 a[0:3], v105, s[4:7], s16 offen sc1
  v_mfma_f32_16x16x32_bf16 v[84:87], a[12:15], v[168:171], v[84:87]
  buffer_load_dwordx4 a[4:7], v105, s[4:7], s16 offen offset:1024 sc1
  v_mfma_f32_16x16x32_bf16 v[40:43], a[8:11], v[172:175], v[40:43]
  ds_read_b64_tr_b16 v[164:165], v114 offset:28672
  ds_read_b64_tr_b16 v[166:167], v114 offset:29184
  s_add_u32 s16, s16, 131072
  v_mfma_f32_16x16x32_bf16 v[88:91], a[12:15], v[172:175], v[88:91]
  ds_read_b64_tr_b16 v[168:169], v115 offset:28672
  s_bitset0_b32 s16, 20
  v_mfma_f32_16x16x32_bf16 v[44:47], a[8:11], v[176:179], v[44:47]
  ds_read_b64_tr_b16 v[170:171], v115 offset:29184
  ds_read_b64_tr_b16 v[172:173], v116 offset:28672
  v_mfma_f32_16x16x32_bf16 v[92:95], a[12:15], v[176:179], v[92:95]
  s_waitcnt vmcnt(28) lgkmcnt(10)
  s_barrier
  v_mfma_f32_16x16x32_bf16 v[96:99], v[180:183], v[188:191], v[96:99]
  ds_read_b64_tr_b16 v[174:175], v116 offset:29184
  s_add_u32 m0, s39, 13312
  s_nop 0
  buffer_load_dword v106, s[4:7], s16 offen sc1 lds
  v_mfma_f32_16x16x32_bf16 v[100:103], v[188:191], v[184:187], v[100:103]
  buffer_load_dwordx4 a[8:11], v105, s[4:7], s16 offen sc1
  v_mfma_f32_16x16x32_bf16 v[0:3], v[132:135], a[16:19], v[0:3]
  ds_read_b64_tr_b16 v[176:177], v117 offset:28672
  ds_read_b64_tr_b16 v[178:179], v117 offset:29184
  buffer_load_dwordx4 a[12:15], v105, s[4:7], s16 offen offset:1024 sc1
  v_mfma_f32_16x16x32_bf16 v[48:51], v[132:135], a[20:23], v[48:51]
  ds_read_b64_tr_b16 v[180:181], v118 offset:40960
  ds_read_b64_tr_b16 v[182:183], v118 offset:41472
  s_add_u32 s16, s16, 131072
  v_mfma_f32_16x16x32_bf16 v[4:7], v[136:139], a[16:19], v[4:7]
  ds_read_b128 v[188:191], v119 offset:52224
  ds_read_b64_tr_b16 v[184:185], v118 offset:41984
  ds_read_b64_tr_b16 v[186:187], v118 offset:42496
  s_bitset0_b32 s16, 20
  v_mfma_f32_16x16x32_bf16 v[52:55], v[136:139], a[20:23], v[52:55]
  s_add_u32 m0, s38, 0
  s_nop 0
  buffer_load_dwordx4 v107, s[8:11], s17 offen lds
  v_mfma_f32_16x16x32_bf16 v[8:11], v[140:143], a[16:19], v[8:11]
  ds_read_b64_tr_b16 v[132:133], v114 offset:39936
  ds_read_b64_tr_b16 v[134:135], v114 offset:40448
  buffer_load_dwordx4 v108, s[8:11], s17 offen offset:1024 lds
  v_mfma_f32_16x16x32_bf16 v[56:59], v[140:143], a[20:23], v[56:59]
  buffer_load_dwordx4 v109, s[8:11], s17 offen offset:2048 lds
  v_mfma_f32_16x16x32_bf16 v[12:15], v[144:147], a[16:19], v[12:15]
  ds_read_b64_tr_b16 v[136:137], v115 offset:39936
  ds_read_b64_tr_b16 v[138:139], v115 offset:40448
  s_add_u32 s17, s17, 196608
  v_mfma_f32_16x16x32_bf16 v[60:63], v[144:147], a[20:23], v[60:63]
  ds_read_b64_tr_b16 v[140:141], v116 offset:39936
  s_cmp_eq_u32 s17, s10
  v_mfma_f32_16x16x32_bf16 v[16:19], v[148:151], a[16:19], v[16:19]
  ds_read_b64_tr_b16 v[142:143], v116 offset:40448
  s_cselect_b32 s17, 0, s17
  s_mov_b32 m0, s51
  v_mfma_f32_16x16x32_bf16 v[64:67], v[148:151], a[20:23], v[64:67]
  ds_read_b64_tr_b16 v[144:145], v117 offset:39936
  s_add_u32 s51, s51, 1024
  s_waitcnt lgkmcnt(10)
  v_mfma_f32_16x16x32_bf16 v[20:23], v[152:155], a[16:19], v[20:23]
  ds_read_b64_tr_b16 v[146:147], v117 offset:40448
  buffer_load_dwordx4 v129, s[52:55], s50 offen nt lds
  v_mfma_f32_16x16x32_bf16 v[68:71], v[152:155], a[20:23], v[68:71]
  ds_read_b64_tr_b16 v[148:149], v114 offset:40960
  s_add_u32 s50, s50, 98304
  v_mfma_f32_16x16x32_bf16 v[24:27], v[156:159], a[16:19], v[24:27]
  ds_read_b64_tr_b16 v[150:151], v114 offset:41472
  s_mov_b32 m0, s51
  v_mfma_f32_16x16x32_bf16 v[72:75], v[156:159], a[20:23], v[72:75]
  s_add_u32 s51, s51, 1024
  buffer_load_dwordx4 v129, s[52:55], s50 offen nt lds
  v_mfma_f32_16x16x32_bf16 v[28:31], v[160:163], a[16:19], v[28:31]
  ds_read_b64_tr_b16 v[152:153], v115 offset:40960
  ds_read_b64_tr_b16 v[154:155], v115 offset:41472
  s_add_u32 s50, s50, 98304
  v_mfma_f32_16x16x32_bf16 v[76:79], v[160:163], a[20:23], v[76:79]
  ds_read_b64_tr_b16 v[156:157], v116 offset:40960
  s_mov_b32 m0, s51
  v_mfma_f32_16x16x32_bf16 v[32:35], a[16:19], v[164:167], v[32:35]
  ds_read_b64_tr_b16 v[158:159], v116 offset:41472
  s_add_u32 s51, s51, 1024
  v_mfma_f32_16x16x32_bf16 v[80:83], a[20:23], v[164:167], v[80:83]
  buffer_load_dwordx4 v129, s[52:55], s50 offen nt lds
  v_mfma_f32_16x16x32_bf16 v[36:39], a[16:19], v[168:171], v[36:39]
  ds_read_b64_tr_b16 v[160:161], v117 offset:40960
  ds_read_b64_tr_b16 v[162:163], v117 offset:41472
  s_add_u32 s50, s50, 98304
  s_mov_b32 m0, s51
  v_mfma_f32_16x16x32_bf16 v[84:87], a[20:23], v[168:171], v[84:87]
  ds_read_b64_tr_b16 v[164:165], v114 offset:41984
  s_add_u32 s51, s51, 1024
  v_mfma_f32_16x16x32_bf16 v[40:43], a[16:19], v[172:175], v[40:43]
  ds_read_b64_tr_b16 v[166:167], v114 offset:42496
  buffer_load_dwordx4 v129, s[52:55], s50 offen nt lds
  v_mfma_f32_16x16x32_bf16 v[88:91], a[20:23], v[172:175], v[88:91]
  ds_read_b64_tr_b16 v[168:169], v115 offset:41984
  s_add_u32 s50, s50, 98304
  v_mfma_f32_16x16x32_bf16 v[44:47], a[16:19], v[176:179], v[44:47]
  ds_read_b64_tr_b16 v[170:171], v115 offset:42496
  s_mov_b32 s40, s20
  s_mov_b32 s41, s21
  s_mov_b32 s42, 0x200000
  s_mov_b32 s43, 0x20000
  v_min_u32 v200, 9, v104
  v_lshlrev_b32 v201, 16, v200
  v_add_u32 v201, 524288, v201
  v_lshlrev_b32 v202, 7, v200
  s_lshl2_add_u32 s33, s2, s3
  s_mul_i32 s32, s33, 448
  s_add_u32 s32, s32, 1572096
  v_add_u32 v202, s32, v202
  v_cmp_le_u32 vcc, 6, v104
  s_lshl_b32 s33, s33, 6
  s_nop 0
  v_cndmask_b32 v201, v201, v202, vcc
  buffer_load_dword v131, v201, s[40:43], s33 offen
  v_mfma_f32_16x16x32_bf16 v[92:95], a[20:23], v[176:179], v[92:95]
  s_waitcnt vmcnt(33) lgkmcnt(10)
  s_barrier
  v_mfma_f32_16x16x32_bf16 v[96:99], v[180:183], v[188:191], v[96:99]
  ds_read_b64_tr_b16 v[172:173], v116 offset:41984
  ds_read_b64_tr_b16 v[174:175], v116 offset:42496
  v_mfma_f32_16x16x32_bf16 v[100:103], v[188:191], v[184:187], v[100:103]
  ds_read_b64_tr_b16 v[176:177], v117 offset:41984
  ds_read_b64_tr_b16 v[178:179], v117 offset:42496
  v_mfma_f32_16x16x32_bf16 v[0:3], v[132:135], a[24:27], v[0:3]
  ds_read_b64_tr_b16 v[180:181], v124 offset:1024
  ds_read_b64_tr_b16 v[182:183], v124 offset:1536
  v_mfma_f32_16x16x32_bf16 v[48:51], v[132:135], a[28:31], v[48:51]
  ds_read_b128 v[188:191], v125 offset:12288
  ds_read_b64_tr_b16 v[184:185], v124 offset:2048
  v_mfma_f32_16x16x32_bf16 v[4:7], v[136:139], a[24:27], v[4:7]
  ds_read_b64_tr_b16 v[186:187], v124 offset:2560
  ds_read_b64_tr_b16 v[132:133], v120 offset:0
  v_mfma_f32_16x16x32_bf16 v[52:55], v[136:139], a[28:31], v[52:55]
  ds_read_b64_tr_b16 v[134:135], v120 offset:512
  ds_read_b64_tr_b16 v[136:137], v121 offset:0
  v_mfma_f32_16x16x32_bf16 v[8:11], v[140:143], a[24:27], v[8:11]
  ds_read_b64_tr_b16 v[138:139], v121 offset:512
  v_mfma_f32_16x16x32_bf16 v[56:59], v[140:143], a[28:31], v[56:59]
  ds_read_b64_tr_b16 v[140:141], v122 offset:0
  ds_read_b64_tr_b16 v[142:143], v122 offset:512
  v_mfma_f32_16x16x32_bf16 v[12:15], v[144:147], a[24:27], v[12:15]
  v_mfma_f32_16x16x32_bf16 v[60:63], v[144:147], a[28:31], v[60:63]
  ds_read_b64_tr_b16 v[144:145], v123 offset:0
  ds_read_b64_tr_b16 v[146:147], v123 offset:512
  v_mfma_f32_16x16x32_bf16 v[16:19], v[148:151], a[24:27], v[16:19]
  v_mfma_f32_16x16x32_bf16 v[64:67], v[148:151], a[28:31], v[64:67]
  ds_read_b64_tr_b16 v[148:149], v120 offset:1024
  ds_read_b64_tr_b16 v[150:151], v120 offset:1536
  s_waitcnt lgkmcnt(10)
  v_mfma_f32_16x16x32_bf16 v[20:23], v[152:155], a[24:27], v[20:23]
  v_mfma_f32_16x16x32_bf16 v[68:71], v[152:155], a[28:31], v[68:71]
  ds_read_b64_tr_b16 v[152:153], v121 offset:1024
  ds_read_b64_tr_b16 v[154:155], v121 offset:1536
  v_mfma_f32_16x16x32_bf16 v[24:27], v[156:159], a[24:27], v[24:27]
  v_mfma_f32_16x16x32_bf16 v[72:75], v[156:159], a[28:31], v[72:75]
  ds_read_b64_tr_b16 v[156:157], v122 offset:1024
  ds_read_b64_tr_b16 v[158:159], v122 offset:1536
  v_mfma_f32_16x16x32_bf16 v[28:31], v[160:163], a[24:27], v[28:31]
  v_mfma_f32_16x16x32_bf16 v[76:79], v[160:163], a[28:31], v[76:79]
  ds_read_b64_tr_b16 v[160:161], v123 offset:1024
  ds_read_b64_tr_b16 v[162:163], v123 offset:1536
  v_mfma_f32_16x16x32_bf16 v[32:35], a[24:27], v[164:167], v[32:35]
  v_mfma_f32_16x16x32_bf16 v[80:83], a[28:31], v[164:167], v[80:83]
  ds_read_b64_tr_b16 v[164:165], v120 offset:2048
  ds_read_b64_tr_b16 v[166:167], v120 offset:2560
  v_mfma_f32_16x16x32_bf16 v[36:39], a[24:27], v[168:171], v[36:39]
  v_mfma_f32_16x16x32_bf16 v[84:87], a[28:31], v[168:171], v[84:87]
  ds_read_b64_tr_b16 v[168:169], v121 offset:2048
  ds_read_b64_tr_b16 v[170:171], v121 offset:2560
  v_mfma_f32_16x16x32_bf16 v[40:43], a[24:27], v[172:175], v[40:43]
  v_mfma_f32_16x16x32_bf16 v[88:91], a[28:31], v[172:175], v[88:91]
  ds_read_b64_tr_b16 v[172:173], v122 offset:2048
  ds_read_b64_tr_b16 v[174:175], v122 offset:2560
  v_mfma_f32_16x16x32_bf16 v[44:47], a[24:27], v[176:179], v[44:47]
  v_mfma_f32_16x16x32_bf16 v[92:95], a[28:31], v[176:179], v[92:95]
  s_waitcnt vmcnt(27) lgkmcnt(10)
  s_barrier
  v_mfma_f32_16x16x32_bf16 v[96:99], v[180:183], v[188:191], v[96:99]
  buffer_store_dwordx4 v[244:247], v119, s[92:95], s35 offen offset:2048 sc1
  v_mfma_f32_16x16x32_bf16 v[100:103], v[188:191], v[184:187], v[100:103]
  ds_read_b64_tr_b16 v[176:177], v123 offset:2048
  ds_read_b64_tr_b16 v[178:179], v123 offset:2560
  v_mfma_f32_16x16x32_bf16 v[0:3], v[132:135], a[32:35], v[0:3]
  ds_read_b64_tr_b16 v[180:181], v124 offset:14336
  ds_read_b64_tr_b16 v[182:183], v124 offset:14848
  v_mfma_f32_16x16x32_bf16 v[48:51], v[132:135], a[36:39], v[48:51]
  ds_read_b128 v[188:191], v125 offset:25600
  ds_read_b64_tr_b16 v[184:185], v124 offset:15360
  v_mfma_f32_16x16x32_bf16 v[4:7], v[136:139], a[32:35], v[4:7]
  ds_read_b64_tr_b16 v[186:187], v124 offset:15872
  ds_read_b64_tr_b16 v[132:133], v120 offset:13312
  v_mfma_f32_16x16x32_bf16 v[52:55], v[136:139], a[36:39], v[52:55]
  ds_read_b64_tr_b16 v[134:135], v120 offset:13824
  ds_read_b64_tr_b16 v[136:137], v121 offset:13312
  v_mfma_f32_16x16x32_bf16 v[8:11], v[140:143], a[32:35], v[8:11]
  ds_read_b64_tr_b16 v[138:139], v121 offset:13824
  v_mfma_f32_16x16x32_bf16 v[56:59], v[140:143], a[36:39], v[56:59]
  ds_read_b64_tr_b16 v[140:141], v122 offset:13312
  ds_read_b64_tr_b16 v[142:143], v122 offset:13824
  v_mfma_f32_16x16x32_bf16 v[12:15], v[144:147], a[32:35], v[12:15]
  v_mfma_f32_16x16x32_bf16 v[60:63], v[144:147], a[36:39], v[60:63]
  ds_read_b64_tr_b16 v[144:145], v123 offset:13312
  ds_read_b64_tr_b16 v[146:147], v123 offset:13824
  v_mfma_f32_16x16x32_bf16 v[16:19], v[148:151], a[32:35], v[16:19]
  v_mfma_f32_16x16x32_bf16 v[64:67], v[148:151], a[36:39], v[64:67]
  ds_read_b64_tr_b16 v[148:149], v120 offset:14336
  ds_read_b64_tr_b16 v[150:151], v120 offset:14848
  v_mfma_f32_16x16x32_bf16 v[20:23], v[152:155], a[32:35], v[20:23]
  v_mfma_f32_16x16x32_bf16 v[68:71], v[152:155], a[36:39], v[68:71]
  ds_read_b64_tr_b16 v[152:153], v121 offset:14336
  ds_read_b64_tr_b16 v[154:155], v121 offset:14848
  s_waitcnt lgkmcnt(10)
  v_mfma_f32_16x16x32_bf16 v[24:27], v[156:159], a[32:35], v[24:27]
  v_mfma_f32_16x16x32_bf16 v[72:75], v[156:159], a[36:39], v[72:75]
  ds_read_b64_tr_b16 v[156:157], v122 offset:14336
  ds_read_b64_tr_b16 v[158:159], v122 offset:14848
  v_mfma_f32_16x16x32_bf16 v[28:31], v[160:163], a[32:35], v[28:31]
  v_mfma_f32_16x16x32_bf16 v[76:79], v[160:163], a[36:39], v[76:79]
  ds_read_b64_tr_b16 v[160:161], v123 offset:14336
  ds_read_b64_tr_b16 v[162:163], v123 offset:14848
  v_mfma_f32_16x16x32_bf16 v[32:35], a[32:35], v[164:167], v[32:35]
  v_mfma_f32_16x16x32_bf16 v[80:83], a[36:39], v[164:167], v[80:83]
  ds_read_b64_tr_b16 v[164:165], v120 offset:15360
  ds_read_b64_tr_b16 v[166:167], v120 offset:15872
  v_mfma_f32_16x16x32_bf16 v[36:39], a[32:35], v[168:171], v[36:39]
  v_mfma_f32_16x16x32_bf16 v[84:87], a[36:39], v[168:171], v[84:87]
  ds_read_b64_tr_b16 v[168:169], v121 offset:15360
  ds_read_b64_tr_b16 v[170:171], v121 offset:15872
  v_mfma_f32_16x16x32_bf16 v[40:43], a[32:35], v[172:175], v[40:43]
  v_mfma_f32_16x16x32_bf16 v[88:91], a[36:39], v[172:175], v[88:91]
  ds_read_b64_tr_b16 v[172:173], v122 offset:15360
  ds_read_b64_tr_b16 v[174:175], v122 offset:15872
  v_mfma_f32_16x16x32_bf16 v[44:47], a[32:35], v[176:179], v[44:47]
  v_mfma_f32_16x16x32_bf16 v[92:95], a[36:39], v[176:179], v[92:95]
  s_waitcnt vmcnt(22) lgkmcnt(10)
  s_barrier
  v_mfma_f32_16x16x32_bf16 v[96:99], v[180:183], v[188:191], v[96:99]
  ds_read_b64_tr_b16 v[176:177], v123 offset:15360
  s_add_u32 m0, s38, 13312
  v_mfma_f32_16x16x32_bf16 v[100:103], v[188:191], v[184:187], v[100:103]
  buffer_load_dwordx4 v107, s[8:11], s17 offen lds
  v_mfma_f32_16x16x32_bf16 v[0:3], v[132:135], a[40:43], v[0:3]
  ds_read_b64_tr_b16 v[178:179], v123 offset:15872
  buffer_load_dwordx4 v108, s[8:11], s17 offen offset:1024 lds
  v_mfma_f32_16x16x32_bf16 v[48:51], v[132:135], a[44:47], v[48:51]
  ds_read_b64_tr_b16 v[180:181], v124 offset:27648
  ds_read_b64_tr_b16 v[182:183], v124 offset:28160
  buffer_load_dwordx4 v109, s[8:11], s17 offen offset:2048 lds
  v_mfma_f32_16x16x32_bf16 v[4:7], v[136:139], a[40:43], v[4:7]
  ds_read_b128 v[188:191], v125 offset:38912
  ds_read_b64_tr_b16 v[184:185], v124 offset:28672
  ds_read_b64_tr_b16 v[186:187], v124 offset:29184
  v_mfma_f32_16x16x32_bf16 v[52:55], v[136:139], a[44:47], v[52:55]
  ds_read_b64_tr_b16 v[132:133], v120 offset:26624
  s_add_u32 s17, s17, 196608
  v_mfma_f32_16x16x32_bf16 v[8:11], v[140:143], a[40:43], v[8:11]
  ds_read_b64_tr_b16 v[134:135], v120 offset:27136
  s_cmp_eq_u32 s17, s10
  v_mfma_f32_16x16x32_bf16 v[56:59], v[140:143], a[44:47], v[56:59]
  ds_read_b64_tr_b16 v[136:137], v121 offset:26624
  s_cselect_b32 s17, 0, s17
  v_mfma_f32_16x16x32_bf16 v[12:15], v[144:147], a[40:43], v[12:15]
  ds_read_b64_tr_b16 v[138:139], v121 offset:27136
  s_add_u32 m0, s38, 26624
  v_mfma_f32_16x16x32_bf16 v[60:63], v[144:147], a[44:47], v[60:63]
  ds_read_b64_tr_b16 v[140:141], v122 offset:26624
  ds_read_b64_tr_b16 v[142:143], v122 offset:27136
  v_mfma_f32_16x16x32_bf16 v[16:19], v[148:151], a[40:43], v[16:19]
  buffer_load_dwordx4 v107, s[8:11], s17 offen lds
  v_mfma_f32_16x16x32_bf16 v[64:67], v[148:151], a[44:47], v[64:67]
  buffer_load_dwordx4 v108, s[8:11], s17 offen offset:1024 lds
  v_mfma_f32_16x16x32_bf16 v[20:23], v[152:155], a[40:43], v[20:23]
  ds_read_b64_tr_b16 v[144:145], v123 offset:26624
  ds_read_b64_tr_b16 v[146:147], v123 offset:27136
  buffer_load_dwordx4 v109, s[8:11], s17 offen offset:2048 lds
  v_mfma_f32_16x16x32_bf16 v[68:71], v[152:155], a[44:47], v[68:71]
  ds_read_b64_tr_b16 v[148:149], v120 offset:27648
  s_add_u32 s17, s17, 196608
  s_waitcnt lgkmcnt(10)
  v_mfma_f32_16x16x32_bf16 v[24:27], v[156:159], a[40:43], v[24:27]
  ds_read_b64_tr_b16 v[150:151], v120 offset:28160
  ds_read_b64_tr_b16 v[152:153], v121 offset:27648
  v_mfma_f32_16x16x32_bf16 v[72:75], v[156:159], a[44:47], v[72:75]
  ds_read_b64_tr_b16 v[154:155], v121 offset:28160
  s_cmp_eq_u32 s17, s10
  v_mfma_f32_16x16x32_bf16 v[28:31], v[160:163], a[40:43], v[28:31]
  ds_read_b64_tr_b16 v[156:157], v122 offset:27648
  s_cselect_b32 s17, 0, s17
  v_mfma_f32_16x16x32_bf16 v[76:79], v[160:163], a[44:47], v[76:79]
  ds_read_b64_tr_b16 v[158:159], v122 offset:28160
  s_add_u32 m0, s39, 26624
  v_mfma_f32_16x16x32_bf16 v[32:35], a[40:43], v[164:167], v[32:35]
  buffer_load_dword v106, s[4:7], s16 offen sc1 lds
  v_mfma_f32_16x16x32_bf16 v[80:83], a[44:47], v[164:167], v[80:83]
  ds_read_b64_tr_b16 v[160:161], v123 offset:27648
  ds_read_b64_tr_b16 v[162:163], v123 offset:28160
  v_mfma_f32_16x16x32_bf16 v[36:39], a[40:43], v[168:171], v[36:39]
  buffer_load_dwordx4 a[16:19], v105, s[4:7], s16 offen sc1
  v_mfma_f32_16x16x32_bf16 v[84:87], a[44:47], v[168:171], v[84:87]
  buffer_load_dwordx4 a[20:23], v105, s[4:7], s16 offen offset:1024 sc1
  v_mfma_f32_16x16x32_bf16 v[40:43], a[40:43], v[172:175], v[40:43]
  ds_read_b64_tr_b16 v[164:165], v120 offset:28672
  ds_read_b64_tr_b16 v[166:167], v120 offset:29184
  s_add_u32 s16, s16, 131072
  v_mfma_f32_16x16x32_bf16 v[88:91], a[44:47], v[172:175], v[88:91]
  ds_read_b64_tr_b16 v[168:169], v121 offset:28672
  s_bitset0_b32 s16, 20
  v_mfma_f32_16x16x32_bf16 v[44:47], a[40:43], v[176:179], v[44:47]
  ds_read_b64_tr_b16 v[170:171], v121 offset:29184
  ds_read_b64_tr_b16 v[172:173], v122 offset:28672
  v_mfma_f32_16x16x32_bf16 v[92:95], a[44:47], v[176:179], v[92:95]
  s_waitcnt vmcnt(10) lgkmcnt(10)
  s_barrier
  v_mfma_f32_16x16x32_bf16 v[96:99], v[180:183], v[188:191], v[96:99]
  ds_read_b64_tr_b16 v[174:175], v122 offset:29184
  s_add_u32 m0, s38, 39936
  v_mfma_f32_16x16x32_bf16 v[100:103], v[188:191], v[184:187], v[100:103]
  ds_read_b64_tr_b16 a[64:65], v196 offset:0
  buffer_load_dwordx4 v107, s[8:11], s17 offen lds
  v_mfma_f32_16x16x32_bf16 v[0:3], v[132:135], a[48:51], v[0:3]
  ds_read_b64_tr_b16 v[176:177], v123 offset:28672
  ds_read_b64_tr_b16 v[178:179], v123 offset:29184
  buffer_load_dwordx4 v108, s[8:11], s17 offen offset:1024 lds
  v_mfma_f32_16x16x32_bf16 v[48:51], v[132:135], a[52:55], v[48:51]
  ds_read_b64_tr_b16 v[180:181], v124 offset:40960
  ds_read_b64_tr_b16 v[182:183], v124 offset:41472
  ds_read_b64_tr_b16 a[66:67], v196 offset:512
  buffer_load_dwordx4 v109, s[8:11], s17 offen offset:2048 lds
  v_mfma_f32_16x16x32_bf16 v[4:7], v[136:139], a[48:51], v[4:7]
  ds_read_b128 v[188:191], v125 offset:52224
  ds_read_b64_tr_b16 v[184:185], v124 offset:41984
  ds_read_b64_tr_b16 v[186:187], v124 offset:42496
  s_add_u32 s17, s17, 196608
  v_mfma_f32_16x16x32_bf16 v[52:55], v[136:139], a[52:55], v[52:55]
  ds_read_b128 a[68:71], v197 offset:0
  s_cmp_eq_u32 s17, s10
  v_mfma_f32_16x16x32_bf16 v[8:11], v[140:143], a[48:51], v[8:11]
  ds_read_b64_tr_b16 v[132:133], v120 offset:39936
  ds_read_b64_tr_b16 v[134:135], v120 offset:40448
  s_cselect_b32 s17, 0, s17
  v_mfma_f32_16x16x32_bf16 v[56:59], v[140:143], a[52:55], v[56:59]
  ds_read_b64_tr_b16 a[72:73], v196 offset:4096
  s_add_u32 m0, s39, 39936
  v_mfma_f32_16x16x32_bf16 v[12:15], v[144:147], a[48:51], v[12:15]
  ds_read_b64_tr_b16 v[136:137], v121 offset:39936
  ds_read_b64_tr_b16 v[138:139], v121 offset:40448
  buffer_load_dword v106, s[4:7], s16 offen sc1 lds
  v_mfma_f32_16x16x32_bf16 v[60:63], v[144:147], a[52:55], v[60:63]
  ds_read_b64_tr_b16 a[74:75], v196 offset:4608
  buffer_load_dwordx4 a[24:27], v105, s[4:7], s16 offen sc1
  v_mfma_f32_16x16x32_bf16 v[16:19], v[148:151], a[48:51], v[16:19]
  ds_read_b64_tr_b16 v[140:141], v122 offset:39936
  ds_read_b64_tr_b16 v[142:143], v122 offset:40448
  buffer_load_dwordx4 a[28:31], v105, s[4:7], s16 offen offset:1024 sc1
  v_mfma_f32_16x16x32_bf16 v[64:67], v[148:151], a[52:55], v[64:67]
  ds_read_b128 a[76:79], v197 offset:64
  s_add_u32 s16, s16, 131072
  s_waitcnt lgkmcnt(10)
  v_mfma_f32_16x16x32_bf16 v[20:23], v[152:155], a[48:51], v[20:23]
  ds_read_b64_tr_b16 v[144:145], v123 offset:39936
  ds_read_b64_tr_b16 v[146:147], v123 offset:40448
  s_bitset0_b32 s16, 20
  v_mfma_f32_16x16x32_bf16 v[68:71], v[152:155], a[52:55], v[68:71]
  ds_read_b64_tr_b16 a[80:81], v196 offset:8192
  s_add_u32 m0, s38, 53248
  v_mfma_f32_16x16x32_bf16 v[24:27], v[156:159], a[48:51], v[24:27]
  ds_read_b64_tr_b16 v[148:149], v120 offset:40960
  ds_read_b64_tr_b16 v[150:151], v120 offset:41472
  buffer_load_dwordx4 v107, s[8:11], s17 offen lds
  v_mfma_f32_16x16x32_bf16 v[72:75], v[156:159], a[52:55], v[72:75]
  ds_read_b64_tr_b16 a[82:83], v196 offset:8704
  buffer_load_dwordx4 v108, s[8:11], s17 offen offset:1024 lds
  v_mfma_f32_16x16x32_bf16 v[28:31], v[160:163], a[48:51], v[28:31]
  ds_read_b64_tr_b16 v[152:153], v121 offset:40960
  ds_read_b64_tr_b16 v[154:155], v121 offset:41472
  buffer_load_dwordx4 v109, s[8:11], s17 offen offset:2048 lds
  v_mfma_f32_16x16x32_bf16 v[76:79], v[160:163], a[52:55], v[76:79]
  ds_read_b128 a[84:87], v197 offset:128
  s_add_u32 s17, s17, 196608
  v_mfma_f32_16x16x32_bf16 v[32:35], a[48:51], v[164:167], v[32:35]
  ds_read_b64_tr_b16 v[156:157], v122 offset:40960
  ds_read_b64_tr_b16 v[158:159], v122 offset:41472
  s_cmp_eq_u32 s17, s10
  v_mfma_f32_16x16x32_bf16 v[80:83], a[52:55], v[164:167], v[80:83]
  ds_read_b64_tr_b16 a[88:89], v196 offset:12288
  s_cselect_b32 s17, 0, s17
  v_mfma_f32_16x16x32_bf16 v[36:39], a[48:51], v[168:171], v[36:39]
  ds_read_b64_tr_b16 v[160:161], v123 offset:40960
  ds_read_b64_tr_b16 v[162:163], v123 offset:41472
  s_mov_b32 s52, s24
  v_mfma_f32_16x16x32_bf16 v[84:87], a[52:55], v[168:171], v[84:87]
  ds_read_b64_tr_b16 a[90:91], v196 offset:12800
  s_mov_b32 s53, s25
  v_mfma_f32_16x16x32_bf16 v[40:43], a[48:51], v[172:175], v[40:43]
  ds_read_b64_tr_b16 v[164:165], v120 offset:41984
  ds_read_b64_tr_b16 v[166:167], v120 offset:42496
  s_mov_b32 s54, 0x200000
  v_mfma_f32_16x16x32_bf16 v[88:91], a[52:55], v[172:175], v[88:91]
  ds_read_b128 a[92:95], v197 offset:192
  s_mov_b32 s55, 0x20000
  v_mfma_f32_16x16x32_bf16 v[44:47], a[48:51], v[176:179], v[44:47]
  ds_read_b64_tr_b16 v[168:169], v121 offset:41984
  ds_read_b64_tr_b16 v[170:171], v121 offset:42496
  s_lshl_b32 s51, s3, 11
  v_mfma_f32_16x16x32_bf16 v[92:95], a[52:55], v[176:179], v[92:95]
  s_waitcnt vmcnt(24) lgkmcnt(10)
  s_barrier
  v_mfma_f32_16x16x32_bf16 v[96:99], v[180:183], v[188:191], v[96:99]
  ds_read_b64_tr_b16 v[172:173], v122 offset:41984
  ds_read_b64_tr_b16 v[174:175], v122 offset:42496
  s_add_u32 m0, s39, 53248
  v_mfma_f32_16x16x32_bf16 v[100:103], v[188:191], v[184:187], v[100:103]
  ds_read_b64_tr_b16 a[96:97], v196 offset:16384
  buffer_load_dword v106, s[4:7], s16 offen sc1 lds
  v_mfma_f32_16x16x32_bf16 v[0:3], v[132:135], a[56:59], v[0:3]
  ds_read_b64_tr_b16 v[176:177], v123 offset:41984
  ds_read_b64_tr_b16 v[178:179], v123 offset:42496
  v_mfma_f32_16x16x32_bf16 v[192:195], a[64:67], a[68:71], 0
  buffer_load_dwordx4 a[32:35], v105, s[4:7], s16 offen sc1
  v_mfma_f32_16x16x32_bf16 v[48:51], v[132:135], a[60:63], v[48:51]
  ds_read_b64_tr_b16 v[180:181], v118 offset:1024
  ds_read_b64_tr_b16 v[182:183], v118 offset:1536
  ds_read_b64_tr_b16 a[98:99], v196 offset:16896
  v_mfma_f32_16x16x32_bf16 v[4:7], v[136:139], a[56:59], v[4:7]
  ds_read_b128 v[188:191], v119 offset:12288
  ds_read_b64_tr_b16 v[184:185], v118 offset:2048
  ds_read_b64_tr_b16 v[186:187], v118 offset:2560
  buffer_load_dwordx4 a[36:39], v105, s[4:7], s16 offen offset:1024 sc1
  v_mfma_f32_16x16x32_bf16 v[52:55], v[136:139], a[60:63], v[52:55]
  ds_read_b128 a[100:103], v197 offset:256
  s_add_u32 s16, s16, 131072
  v_mfma_f32_16x16x32_bf16 v[8:11], v[140:143], a[56:59], v[8:11]
  ds_read_b64_tr_b16 v[132:133], v114 offset:0
  ds_read_b64_tr_b16 v[134:135], v114 offset:512
  s_bitset0_b32 s16, 20
  v_mfma_f32_16x16x32_bf16 v[56:59], v[140:143], a[60:63], v[56:59]
  ds_read_b64_tr_b16 a[104:105], v196 offset:20480
  s_add_u32 m0, s38, 66560
  v_mfma_f32_16x16x32_bf16 v[12:15], v[144:147], a[56:59], v[12:15]
  ds_read_b64_tr_b16 v[136:137], v115 offset:0
  ds_read_b64_tr_b16 v[138:139], v115 offset:512
  v_mfma_f32_16x16x32_bf16 v[192:195], a[72:75], a[76:79], v[192:195]
  v_mfma_f32_16x16x32_bf16 v[60:63], v[144:147], a[60:63], v[60:63]
  ds_read_b64_tr_b16 a[106:107], v196 offset:20992
  buffer_load_dwordx4 v107, s[8:11], s17 offen lds
  v_mfma_f32_16x16x32_bf16 v[16:19], v[148:151], a[56:59], v[16:19]
  ds_read_b64_tr_b16 v[140:141], v116 offset:0
  ds_read_b64_tr_b16 v[142:143], v116 offset:512
  buffer_load_dwordx4 v108, s[8:11], s17 offen offset:1024 lds
  v_mfma_f32_16x16x32_bf16 v[64:67], v[148:151], a[60:63], v[64:67]
  ds_read_b64_tr_b16 v[144:145], v117 offset:0
  ds_read_b128 a[108:111], v197 offset:320
  v_mfma_f32_16x16x32_bf16 v[20:23], v[152:155], a[56:59], v[20:23]
  ds_read_b64_tr_b16 v[146:147], v117 offset:512
  buffer_load_dwordx4 v109, s[8:11], s17 offen offset:2048 lds
  v_mfma_f32_16x16x32_bf16 v[68:71], v[152:155], a[60:63], v[68:71]
  ds_read_b64_tr_b16 a[112:113], v196 offset:24576
  s_add_u32 s17, s17, 196608
  s_waitcnt lgkmcnt(10)
  v_mfma_f32_16x16x32_bf16 v[24:27], v[156:159], a[56:59], v[24:27]
  ds_read_b64_tr_b16 v[148:149], v114 offset:1024
  ds_read_b64_tr_b16 v[150:151], v114 offset:1536
  v_mfma_f32_16x16x32_bf16 v[192:195], a[80:83], a[84:87], v[192:195]
  s_cmp_eq_u32 s17, s10
  v_mfma_f32_16x16x32_bf16 v[72:75], v[156:159], a[60:63], v[72:75]
  ds_read_b64_tr_b16 v[152:153], v115 offset:1024
  ds_read_b64_tr_b16 a[114:115], v196 offset:25088
  v_mfma_f32_16x16x32_bf16 v[28:31], v[160:163], a[56:59], v[28:31]
  ds_read_b64_tr_b16 v[154:155], v115 offset:1536
  s_cselect_b32 s17, 0, s17
  v_mfma_f32_16x16x32_bf16 v[76:79], v[160:163], a[60:63], v[76:79]
  ds_read_b128 a[116:119], v197 offset:384
  s_add_u32 m0, s39, 66560
  v_mfma_f32_16x16x32_bf16 v[32:35], a[56:59], v[164:167], v[32:35]
  ds_read_b64_tr_b16 v[156:157], v116 offset:1024
  ds_read_b64_tr_b16 v[158:159], v116 offset:1536
  buffer_load_dword v106, s[4:7], s16 offen sc1 lds
  v_mfma_f32_16x16x32_bf16 v[80:83], a[60:63], v[164:167], v[80:83]
  ds_read_b64_tr_b16 a[120:121], v196 offset:28672
  buffer_load_dwordx4 a[40:43], v105, s[4:7], s16 offen sc1
  v_mfma_f32_16x16x32_bf16 v[36:39], a[56:59], v[168:171], v[36:39]
  ds_read_b64_tr_b16 v[160:161], v117 offset:1024
  ds_read_b64_tr_b16 v[162:163], v117 offset:1536
  v_mfma_f32_16x16x32_bf16 v[192:195], a[88:91], a[92:95], v[192:195]
  v_mfma_f32_16x16x32_bf16 v[84:87], a[60:63], v[168:171], v[84:87]
  ds_read_b64_tr_b16 a[122:123], v196 offset:29184
  buffer_load_dwordx4 a[44:47], v105, s[4:7], s16 offen offset:1024 sc1
  v_mfma_f32_16x16x32_bf16 v[40:43], a[56:59], v[172:175], v[40:43]
  ds_read_b64_tr_b16 v[164:165], v114 offset:2048
  ds_read_b64_tr_b16 v[166:167], v114 offset:2560
  s_add_u32 s16, s16, 131072
  v_mfma_f32_16x16x32_bf16 v[88:91], a[60:63], v[172:175], v[88:91]
  ds_read_b64_tr_b16 v[168:169], v115 offset:2048
  ds_read_b128 a[124:127], v197 offset:448
  v_mfma_f32_16x16x32_bf16 v[44:47], a[56:59], v[176:179], v[44:47]
  ds_read_b64_tr_b16 v[170:171], v115 offset:2560
  s_bitset0_b32 s16, 20
  v_mfma_f32_16x16x32_bf16 v[92:95], a[60:63], v[176:179], v[92:95]
  s_waitcnt vmcnt(24) lgkmcnt(10)
  s_barrier
  v_mfma_f32_16x16x32_bf16 v[96:99], v[180:183], v[188:191], v[96:99]
  ds_read_b64_tr_b16 v[172:173], v116 offset:2048
  ds_read_b64_tr_b16 v[174:175], v116 offset:2560
  s_add_u32 m0, s38, 79872
  v_mfma_f32_16x16x32_bf16 v[100:103], v[188:191], v[184:187], v[100:103]
  buffer_load_dwordx4 v107, s[8:11], s17 offen lds
  v_mfma_f32_16x16x32_bf16 v[0:3], v[132:135], a[0:3], v[0:3]
  ds_read_b64_tr_b16 v[176:177], v117 offset:2048
  ds_read_b64_tr_b16 v[178:179], v117 offset:2560
  v_mfma_f32_16x16x32_bf16 v[192:195], a[96:99], a[100:103], v[192:195]
  buffer_load_dwordx4 v108, s[8:11], s17 offen offset:1024 lds
  v_mfma_f32_16x16x32_bf16 v[48:51], v[132:135], a[4:7], v[48:51]
  ds_read_b64_tr_b16 v[180:181], v118 offset:14336
  ds_read_b64_tr_b16 v[182:183], v118 offset:14848
  buffer_load_dwordx4 v109, s[8:11], s17 offen offset:2048 lds
  v_mfma_f32_16x16x32_bf16 v[4:7], v[136:139], a[0:3], v[4:7]
  ds_read_b128 v[188:191], v119 offset:25600
  ds_read_b64_tr_b16 v[184:185], v118 offset:15360
  ds_read_b64_tr_b16 v[186:187], v118 offset:15872
  s_add_u32 s17, s17, 196608
  v_mfma_f32_16x16x32_bf16 v[52:55], v[136:139], a[4:7], v[52:55]
  ds_read_b64_tr_b16 v[132:133], v114 offset:13312
  s_cmp_eq_u32 s17, s10
  v_mfma_f32_16x16x32_bf16 v[8:11], v[140:143], a[0:3], v[8:11]
  ds_read_b64_tr_b16 v[134:135], v114 offset:13824
  s_cselect_b32 s17, 0, s17
  v_mfma_f32_16x16x32_bf16 v[56:59], v[140:143], a[4:7], v[56:59]
  ds_read_b64_tr_b16 v[136:137], v115 offset:13312
  s_add_u32 m0, s39, 79872
  v_mfma_f32_16x16x32_bf16 v[12:15], v[144:147], a[0:3], v[12:15]
  ds_read_b64_tr_b16 v[138:139], v115 offset:13824
  v_mfma_f32_16x16x32_bf16 v[192:195], a[104:107], a[108:111], v[192:195]
  v_mfma_f32_16x16x32_bf16 v[60:63], v[144:147], a[4:7], v[60:63]
  buffer_load_dword v106, s[4:7], s16 offen sc1 lds
  v_mfma_f32_16x16x32_bf16 v[16:19], v[148:151], a[0:3], v[16:19]
  ds_read_b64_tr_b16 v[140:141], v116 offset:13312
  ds_read_b64_tr_b16 v[142:143], v116 offset:13824
  buffer_load_dwordx4 a[48:51], v105, s[4:7], s16 offen sc1
  v_mfma_f32_16x16x32_bf16 v[64:67], v[148:151], a[4:7], v[64:67]
  buffer_load_dwordx4 a[52:55], v105, s[4:7], s16 offen offset:1024 sc1
  v_mfma_f32_16x16x32_bf16 v[20:23], v[152:155], a[0:3], v[20:23]
  ds_read_b64_tr_b16 v[144:145], v117 offset:13312
  ds_read_b64_tr_b16 v[146:147], v117 offset:13824
  s_add_u32 s16, s16, 131072
  v_mfma_f32_16x16x32_bf16 v[68:71], v[152:155], a[4:7], v[68:71]
  ds_read_b64_tr_b16 v[148:149], v114 offset:14336
  s_bitset0_b32 s16, 20
  s_waitcnt lgkmcnt(10)
  v_mfma_f32_16x16x32_bf16 v[24:27], v[156:159], a[0:3], v[24:27]
  ds_read_b64_tr_b16 v[150:151], v114 offset:14848
  v_mfma_f32_16x16x32_bf16 v[192:195], a[112:115], a[116:119], v[192:195]
  s_add_u32 m0, s38, 93184
  v_mfma_f32_16x16x32_bf16 v[72:75], v[156:159], a[4:7], v[72:75]
  buffer_load_dwordx4 v107, s[8:11], s17 offen lds
  v_mfma_f32_16x16x32_bf16 v[28:31], v[160:163], a[0:3], v[28:31]
  ds_read_b64_tr_b16 v[152:153], v115 offset:14336
  ds_read_b64_tr_b16 v[154:155], v115 offset:14848
  v_mfma_f32_16x16x32_bf16 v[76:79], v[160:163], a[4:7], v[76:79]
  buffer_load_dwordx4 v108, s[8:11], s17 offen offset:1024 lds
  v_mfma_f32_16x16x32_bf16 v[32:35], a[0:3], v[164:167], v[32:35]
  ds_read_b64_tr_b16 v[156:157], v116 offset:14336
  ds_read_b64_tr_b16 v[158:159], v116 offset:14848
  buffer_load_dwordx4 v109, s[8:11], s17 offen offset:2048 lds
  v_mfma_f32_16x16x32_bf16 v[80:83], a[4:7], v[164:167], v[80:83]
  ds_read_b64_tr_b16 v[160:161], v117 offset:14336
  s_add_u32 s17, s17, 196608
  v_mfma_f32_16x16x32_bf16 v[36:39], a[0:3], v[168:171], v[36:39]
  ds_read_b64_tr_b16 v[162:163], v117 offset:14848
  v_mfma_f32_16x16x32_bf16 v[192:195], a[120:123], a[124:127], v[192:195]
  s_cmp_eq_u32 s17, s10
  v_mfma_f32_16x16x32_bf16 v[84:87], a[4:7], v[168:171], v[84:87]
  ds_read_b64_tr_b16 v[164:165], v114 offset:15360
  s_cselect_b32 s17, 0, s17
  v_mfma_f32_16x16x32_bf16 v[40:43], a[0:3], v[172:175], v[40:43]
  ds_read_b64_tr_b16 v[166:167], v114 offset:15872
  s_add_u32 s8, s8, s10
  s_addc_u32 s9, s9, 0
  v_mfma_f32_16x16x32_bf16 v[88:91], a[4:7], v[172:175], v[88:91]
  buffer_store_dwordx4 v[244:247], v119, s[92:95], s35 offen offset:3072 sc1
  v_mfma_f32_16x16x32_bf16 v[44:47], a[0:3], v[176:179], v[44:47]
  ds_read_b64_tr_b16 v[168:169], v115 offset:15360
  ds_read_b64_tr_b16 v[170:171], v115 offset:15872
  v_mfma_f32_16x16x32_bf16 v[92:95], a[4:7], v[176:179], v[92:95]
  s_waitcnt vmcnt(28) lgkmcnt(10)
  s_barrier
  v_mfma_f32_16x16x32_bf16 v[96:99], v[180:183], v[188:191], v[96:99]
  ds_read_b64_tr_b16 v[172:173], v116 offset:15360
  ds_read_b64_tr_b16 v[174:175], v116 offset:15872
  s_add_u32 m0, s39, 93184
  v_mfma_f32_16x16x32_bf16 v[100:103], v[188:191], v[184:187], v[100:103]
  buffer_load_dword v106, s[4:7], s16 offen sc1 lds
  v_mfma_f32_16x16x32_bf16 v[0:3], v[132:135], a[8:11], v[0:3]
  ds_read_b64_tr_b16 v[176:177], v117 offset:15360
  ds_read_b64_tr_b16 v[178:179], v117 offset:15872
  v_mfma_f32_16x16x32_bf16 v[48:51], v[132:135], a[12:15], v[48:51]
  ds_read_b64_tr_b16 v[180:181], v118 offset:27648
  ds_read_b64_tr_b16 v[182:183], v118 offset:28160
  buffer_load_dwordx4 a[56:59], v105, s[4:7], s16 offen sc1
  v_mfma_f32_16x16x32_bf16 v[4:7], v[136:139], a[8:11], v[4:7]
  ds_read_b128 v[188:191], v119 offset:38912
  ds_read_b64_tr_b16 v[184:185], v118 offset:28672
  ds_read_b64_tr_b16 v[186:187], v118 offset:29184
  v_mfma_f32_16x16x32_bf16 v[52:55], v[136:139], a[12:15], v[52:55]
  s_bfe_u32 s40, s19, 0x80000
  s_bfe_u32 s41, s19, 0x80008
  s_bfe_u32 s42, s19, 0x80010
  s_bfe_u32 s43, s19, 0x80018
  v_and_or_b32 v192, v192, v198, s40
  v_and_or_b32 v193, v193, v198, s41
  v_and_or_b32 v194, v194, v198, s42
  v_and_or_b32 v195, v195, v198, s43
  buffer_store_dwordx4 v[192:195], v255, s[12:15], s96 offen sc1
  v_mfma_f32_16x16x32_bf16 v[8:11], v[140:143], a[8:11], v[8:11]
  ds_read_b64_tr_b16 v[132:133], v114 offset:26624
  ds_read_b64_tr_b16 v[134:135], v114 offset:27136
  buffer_load_dwordx4 a[60:63], v105, s[4:7], s16 offen offset:1024 sc1
  v_mfma_f32_16x16x32_bf16 v[56:59], v[140:143], a[12:15], v[56:59]
  ds_read_b64_tr_b16 v[136:137], v115 offset:26624
  s_add_u32 s16, s16, 131072
  v_mfma_f32_16x16x32_bf16 v[12:15], v[144:147], a[8:11], v[12:15]
  ds_read_b64_tr_b16 v[138:139], v115 offset:27136
  ds_read_b64_tr_b16 v[140:141], v116 offset:26624
  v_mfma_f32_16x16x32_bf16 v[60:63], v[144:147], a[12:15], v[60:63]
  ds_read_b64_tr_b16 v[142:143], v116 offset:27136
  s_bitset0_b32 s16, 20
  v_mfma_f32_16x16x32_bf16 v[16:19], v[148:151], a[8:11], v[16:19]
  ds_read_b64_tr_b16 v[144:145], v117 offset:26624
  ds_read_b64_tr_b16 v[146:147], v117 offset:27136
  v_mfma_f32_16x16x32_bf16 v[64:67], v[148:151], a[12:15], v[64:67]
  s_add_u32 s4, s4, s6
  s_addc_u32 s5, s5, 0
  s_waitcnt lgkmcnt(10)
  v_mfma_f32_16x16x32_bf16 v[20:23], v[152:155], a[8:11], v[20:23]
  ds_read_b64_tr_b16 v[148:149], v114 offset:27648
  ds_read_b64_tr_b16 v[150:151], v114 offset:28160
  v_mfma_f32_16x16x32_bf16 v[68:71], v[152:155], a[12:15], v[68:71]
  ds_read_b64_tr_b16 v[152:153], v115 offset:27648
  s_add_u32 m0, s39, 0
  v_mfma_f32_16x16x32_bf16 v[24:27], v[156:159], a[8:11], v[24:27]
  ds_read_b64_tr_b16 v[154:155], v115 offset:28160
  v_mfma_f32_16x16x32_bf16 v[72:75], v[156:159], a[12:15], v[72:75]
  buffer_load_dword v106, s[4:7], s16 offen sc1 lds
  v_mfma_f32_16x16x32_bf16 v[28:31], v[160:163], a[8:11], v[28:31]
  ds_read_b64_tr_b16 v[156:157], v116 offset:27648
  ds_read_b64_tr_b16 v[158:159], v116 offset:28160
  v_mfma_f32_16x16x32_bf16 v[76:79], v[160:163], a[12:15], v[76:79]
  buffer_load_dwordx4 a[0:3], v105, s[4:7], s16 offen sc1
  v_mfma_f32_16x16x32_bf16 v[32:35], a[8:11], v[164:167], v[32:35]
  ds_read_b64_tr_b16 v[160:161], v117 offset:27648
  ds_read_b64_tr_b16 v[162:163], v117 offset:28160
  v_mfma_f32_16x16x32_bf16 v[80:83], a[12:15], v[164:167], v[80:83]
  buffer_load_dwordx4 a[4:7], v105, s[4:7], s16 offen offset:1024 sc1
  v_mfma_f32_16x16x32_bf16 v[36:39], a[8:11], v[168:171], v[36:39]
  ds_read_b64_tr_b16 v[164:165], v114 offset:28672
  ds_read_b64_tr_b16 v[166:167], v114 offset:29184
  v_mfma_f32_16x16x32_bf16 v[84:87], a[12:15], v[168:171], v[84:87]
  ds_read_b64_tr_b16 v[168:169], v115 offset:28672
  s_add_u32 s16, s16, 131072
  v_mfma_f32_16x16x32_bf16 v[40:43], a[8:11], v[172:175], v[40:43]
  ds_read_b64_tr_b16 v[170:171], v115 offset:29184
  v_mfma_f32_16x16x32_bf16 v[88:91], a[12:15], v[172:175], v[88:91]
  ds_read_b64_tr_b16 v[172:173], v116 offset:28672
  s_bitset0_b32 s16, 20
  v_mfma_f32_16x16x32_bf16 v[44:47], a[8:11], v[176:179], v[44:47]
  ds_read_b64_tr_b16 v[174:175], v116 offset:29184
  v_mfma_f32_16x16x32_bf16 v[92:95], a[12:15], v[176:179], v[92:95]
  s_waitcnt vmcnt(29) lgkmcnt(10)
  s_barrier
  v_mfma_f32_16x16x32_bf16 v[96:99], v[180:183], v[188:191], v[96:99]
  ds_read_b64_tr_b16 v[176:177], v117 offset:28672
  s_add_u32 m0, s39, 13312
  v_mfma_f32_16x16x32_bf16 v[100:103], v[188:191], v[184:187], v[100:103]
  buffer_load_dword v106, s[4:7], s16 offen sc1 lds
  v_mfma_f32_16x16x32_bf16 v[0:3], v[132:135], a[16:19], v[0:3]
  ds_read_b64_tr_b16 v[178:179], v117 offset:29184
  buffer_load_dwordx4 a[8:11], v105, s[4:7], s16 offen sc1
  v_mfma_f32_16x16x32_bf16 v[48:51], v[132:135], a[20:23], v[48:51]
  ds_read_b64_tr_b16 v[180:181], v118 offset:40960
  ds_read_b64_tr_b16 v[182:183], v118 offset:41472
  buffer_load_dwordx4 a[12:15], v105, s[4:7], s16 offen offset:1024 sc1
  v_mfma_f32_16x16x32_bf16 v[4:7], v[136:139], a[16:19], v[4:7]
  ds_read_b128 v[188:191], v119 offset:52224
  ds_read_b64_tr_b16 v[184:185], v118 offset:41984
  ds_read_b64_tr_b16 v[186:187], v118 offset:42496
  v_mfma_f32_16x16x32_bf16 v[52:55], v[136:139], a[20:23], v[52:55]
  ds_read_b64_tr_b16 v[132:133], v114 offset:39936
  s_add_u32 s16, s16, 131072
  v_mfma_f32_16x16x32_bf16 v[8:11], v[140:143], a[16:19], v[8:11]
  ds_read_b64_tr_b16 v[134:135], v114 offset:40448
  s_bitset0_b32 s16, 20
  v_mfma_f32_16x16x32_bf16 v[56:59], v[140:143], a[20:23], v[56:59]
  ds_read_b64_tr_b16 v[136:137], v115 offset:39936
  s_add_u32 m0, s38, 0
  v_mfma_f32_16x16x32_bf16 v[12:15], v[144:147], a[16:19], v[12:15]
  ds_read_b64_tr_b16 v[138:139], v115 offset:40448
  ds_read_b64_tr_b16 v[140:141], v116 offset:39936
  v_mfma_f32_16x16x32_bf16 v[60:63], v[144:147], a[20:23], v[60:63]
  buffer_load_dwordx4 v107, s[8:11], s17 offen lds
  v_mfma_f32_16x16x32_bf16 v[16:19], v[148:151], a[16:19], v[16:19]
  ds_read_b64_tr_b16 v[142:143], v116 offset:40448
  buffer_load_dwordx4 v108, s[8:11], s17 offen offset:1024 lds
  v_mfma_f32_16x16x32_bf16 v[64:67], v[148:151], a[20:23], v[64:67]
  buffer_load_dwordx4 v109, s[8:11], s17 offen offset:2048 lds
  v_mfma_f32_16x16x32_bf16 v[20:23], v[152:155], a[16:19], v[20:23]
  ds_read_b64_tr_b16 v[144:145], v117 offset:39936
  ds_read_b64_tr_b16 v[146:147], v117 offset:40448
  v_mfma_f32_16x16x32_bf16 v[68:71], v[152:155], a[20:23], v[68:71]
  ds_read_b64_tr_b16 v[148:149], v114 offset:40960
  s_add_u32 s17, s17, 196608
  s_waitcnt lgkmcnt(10)
  v_mfma_f32_16x16x32_bf16 v[24:27], v[156:159], a[16:19], v[24:27]
  ds_read_b64_tr_b16 v[150:151], v114 offset:41472
  s_cmp_eq_u32 s17, s10
  v_mfma_f32_16x16x32_bf16 v[72:75], v[156:159], a[20:23], v[72:75]
  ds_read_b64_tr_b16 v[152:153], v115 offset:40960
  s_cselect_b32 s17, 0, s17
  v_mfma_f32_16x16x32_bf16 v[28:31], v[160:163], a[16:19], v[28:31]
  ds_read_b64_tr_b16 v[154:155], v115 offset:41472
  ds_read_b64_tr_b16 v[156:157], v116 offset:40960
  v_mfma_f32_16x16x32_bf16 v[76:79], v[160:163], a[20:23], v[76:79]
  buffer_load_dword v131, v130, s[56:59], s97 offen
  v_mfma_f32_16x16x32_bf16 v[32:35], a[16:19], v[164:167], v[32:35]
  ds_read_b64_tr_b16 v[158:159], v116 offset:41472
  s_add_u32 m0, s51, 106496
  v_mfma_f32_16x16x32_bf16 v[80:83], a[20:23], v[164:167], v[80:83]
  ds_read_b64_tr_b16 v[160:161], v117 offset:40960
  s_add_u32 s50, s98, 1703936
  v_mfma_f32_16x16x32_bf16 v[36:39], a[16:19], v[168:171], v[36:39]
  ds_read_b64_tr_b16 v[162:163], v117 offset:41472
  ds_read_b64_tr_b16 v[164:165], v114 offset:41984
  v_mfma_f32_16x16x32_bf16 v[84:87], a[20:23], v[168:171], v[84:87]
  ds_read_b64_tr_b16 v[166:167], v114 offset:42496
  s_bitset0_b32 s50, 21
  v_mfma_f32_16x16x32_bf16 v[40:43], a[16:19], v[172:175], v[40:43]
  buffer_load_dwordx4 v248, s[52:55], s50 offen lds
  v_mfma_f32_16x16x32_bf16 v[88:91], a[20:23], v[172:175], v[88:91]
  buffer_load_dwordx4 v249, s[52:55], s50 offen offset:1024 lds
  v_mfma_f32_16x16x32_bf16 v[44:47], a[16:19], v[176:179], v[44:47]
  ds_read_b64_tr_b16 v[168:169], v115 offset:41984
  ds_read_b64_tr_b16 v[170:171], v115 offset:42496
  v_mfma_f32_16x16x32_bf16 v[92:95], a[20:23], v[176:179], v[92:95]
  s_waitcnt vmcnt(32) lgkmcnt(10)
  s_barrier
  v_mfma_f32_16x16x32_bf16 v[96:99], v[180:183], v[188:191], v[96:99]
  ds_read_b64_tr_b16 v[172:173], v116 offset:41984
  ds_read_b64_tr_b16 v[174:175], v116 offset:42496
  v_mfma_f32_16x16x32_bf16 v[100:103], v[188:191], v[184:187], v[100:103]
  ds_read_b64_tr_b16 v[176:177], v117 offset:41984
  ds_read_b64_tr_b16 v[178:179], v117 offset:42496
  v_mfma_f32_16x16x32_bf16 v[0:3], v[132:135], a[24:27], v[0:3]
  ds_read_b64_tr_b16 v[180:181], v124 offset:1024
  ds_read_b64_tr_b16 v[182:183], v124 offset:1536
  v_mfma_f32_16x16x32_bf16 v[48:51], v[132:135], a[28:31], v[48:51]
  ds_read_b128 v[188:191], v125 offset:12288
  ds_read_b64_tr_b16 v[184:185], v124 offset:2048
  v_mfma_f32_16x16x32_bf16 v[4:7], v[136:139], a[24:27], v[4:7]
  ds_read_b64_tr_b16 v[186:187], v124 offset:2560
  ds_read_b64_tr_b16 v[132:133], v120 offset:0
  v_mfma_f32_16x16x32_bf16 v[52:55], v[136:139], a[28:31], v[52:55]
  ds_read_b64_tr_b16 v[134:135], v120 offset:512
  ds_read_b64_tr_b16 v[136:137], v121 offset:0
  v_mfma_f32_16x16x32_bf16 v[8:11], v[140:143], a[24:27], v[8:11]
  ds_read_b64_tr_b16 v[138:139], v121 offset:512
  v_mfma_f32_16x16x32_bf16 v[56:59], v[140:143], a[28:31], v[56:59]
  ds_read_b64_tr_b16 v[140:141], v122 offset:0
  ds_read_b64_tr_b16 v[142:143], v122 offset:512
  v_mfma_f32_16x16x32_bf16 v[12:15], v[144:147], a[24:27], v[12:15]
  v_mfma_f32_16x16x32_bf16 v[60:63], v[144:147], a[28:31], v[60:63]
  ds_read_b64_tr_b16 v[144:145], v123 offset:0
  ds_read_b64_tr_b16 v[146:147], v123 offset:512
  v_mfma_f32_16x16x32_bf16 v[16:19], v[148:151], a[24:27], v[16:19]
  v_mfma_f32_16x16x32_bf16 v[64:67], v[148:151], a[28:31], v[64:67]
  ds_read_b64_tr_b16 v[148:149], v120 offset:1024
  ds_read_b64_tr_b16 v[150:151], v120 offset:1536
  s_waitcnt lgkmcnt(10)
  v_mfma_f32_16x16x32_bf16 v[20:23], v[152:155], a[24:27], v[20:23]
  v_mfma_f32_16x16x32_bf16 v[68:71], v[152:155], a[28:31], v[68:71]
  ds_read_b64_tr_b16 v[152:153], v121 offset:1024
  ds_read_b64_tr_b16 v[154:155], v121 offset:1536
  v_mfma_f32_16x16x32_bf16 v[24:27], v[156:159], a[24:27], v[24:27]
  v_mfma_f32_16x16x32_bf16 v[72:75], v[156:159], a[28:31], v[72:75]
  ds_read_b64_tr_b16 v[156:157], v122 offset:1024
  ds_read_b64_tr_b16 v[158:159], v122 offset:1536
  v_mfma_f32_16x16x32_bf16 v[28:31], v[160:163], a[24:27], v[28:31]
  v_mfma_f32_16x16x32_bf16 v[76:79], v[160:163], a[28:31], v[76:79]
  ds_read_b64_tr_b16 v[160:161], v123 offset:1024
  ds_read_b64_tr_b16 v[162:163], v123 offset:1536
  v_mfma_f32_16x16x32_bf16 v[32:35], a[24:27], v[164:167], v[32:35]
  v_mfma_f32_16x16x32_bf16 v[80:83], a[28:31], v[164:167], v[80:83]
  ds_read_b64_tr_b16 v[164:165], v120 offset:2048
  ds_read_b64_tr_b16 v[166:167], v120 offset:2560
  v_mfma_f32_16x16x32_bf16 v[36:39], a[24:27], v[168:171], v[36:39]
  v_mfma_f32_16x16x32_bf16 v[84:87], a[28:31], v[168:171], v[84:87]
  ds_read_b64_tr_b16 v[168:169], v121 offset:2048
  ds_read_b64_tr_b16 v[170:171], v121 offset:2560
  v_mfma_f32_16x16x32_bf16 v[40:43], a[24:27], v[172:175], v[40:43]
  v_mfma_f32_16x16x32_bf16 v[88:91], a[28:31], v[172:175], v[88:91]
  ds_read_b64_tr_b16 v[172:173], v122 offset:2048
  ds_read_b64_tr_b16 v[174:175], v122 offset:2560
  v_mfma_f32_16x16x32_bf16 v[44:47], a[24:27], v[176:179], v[44:47]
  v_mfma_f32_16x16x32_bf16 v[92:95], a[28:31], v[176:179], v[92:95]
  s_waitcnt vmcnt(26) lgkmcnt(10)
  s_barrier
  v_mfma_f32_16x16x32_bf16 v[96:99], v[180:183], v[188:191], v[96:99]
  ds_read_b64_tr_b16 v[176:177], v123 offset:2048
  ds_read_b64_tr_b16 v[178:179], v123 offset:2560
  v_mfma_f32_16x16x32_bf16 v[100:103], v[188:191], v[184:187], v[100:103]
  ds_read_b64_tr_b16 v[180:181], v124 offset:14336
  ds_read_b64_tr_b16 v[182:183], v124 offset:14848
  v_mfma_f32_16x16x32_bf16 v[0:3], v[132:135], a[32:35], v[0:3]
  ds_read_b128 v[188:191], v125 offset:25600
  ds_read_b64_tr_b16 v[184:185], v124 offset:15360
  v_mfma_f32_16x16x32_bf16 v[48:51], v[132:135], a[36:39], v[48:51]
  ds_read_b64_tr_b16 v[186:187], v124 offset:15872
  ds_read_b64_tr_b16 v[132:133], v120 offset:13312
  v_mfma_f32_16x16x32_bf16 v[4:7], v[136:139], a[32:35], v[4:7]
  ds_read_b64_tr_b16 v[134:135], v120 offset:13824
  v_mfma_f32_16x16x32_bf16 v[52:55], v[136:139], a[36:39], v[52:55]
  ds_read_b64_tr_b16 v[136:137], v121 offset:13312
  ds_read_b64_tr_b16 v[138:139], v121 offset:13824
  v_mfma_f32_16x16x32_bf16 v[8:11], v[140:143], a[32:35], v[8:11]
  v_mfma_f32_16x16x32_bf16 v[56:59], v[140:143], a[36:39], v[56:59]
  ds_read_b64_tr_b16 v[140:141], v122 offset:13312
  ds_read_b64_tr_b16 v[142:143], v122 offset:13824
  v_mfma_f32_16x16x32_bf16 v[12:15], v[144:147], a[32:35], v[12:15]
  v_mfma_f32_16x16x32_bf16 v[60:63], v[144:147], a[36:39], v[60:63]
  ds_read_b64_tr_b16 v[144:145], v123 offset:13312
  ds_read_b64_tr_b16 v[146:147], v123 offset:13824
  v_mfma_f32_16x16x32_bf16 v[16:19], v[148:151], a[32:35], v[16:19]
  v_mfma_f32_16x16x32_bf16 v[64:67], v[148:151], a[36:39], v[64:67]
  ds_read_b64_tr_b16 v[148:149], v120 offset:14336
  ds_read_b64_tr_b16 v[150:151], v120 offset:14848
  v_mfma_f32_16x16x32_bf16 v[20:23], v[152:155], a[32:35], v[20:23]
  v_mfma_f32_16x16x32_bf16 v[68:71], v[152:155], a[36:39], v[68:71]
  ds_read_b64_tr_b16 v[152:153], v121 offset:14336
  ds_read_b64_tr_b16 v[154:155], v121 offset:14848
  s_waitcnt lgkmcnt(10)
  v_mfma_f32_16x16x32_bf16 v[24:27], v[156:159], a[32:35], v[24:27]
  v_mfma_f32_16x16x32_bf16 v[72:75], v[156:159], a[36:39], v[72:75]
  ds_read_b64_tr_b16 v[156:157], v122 offset:14336
  ds_read_b64_tr_b16 v[158:159], v122 offset:14848
  v_mfma_f32_16x16x32_bf16 v[28:31], v[160:163], a[32:35], v[28:31]
  v_mfma_f32_16x16x32_bf16 v[76:79], v[160:163], a[36:39], v[76:79]
  ds_read_b64_tr_b16 v[160:161], v123 offset:14336
  ds_read_b64_tr_b16 v[162:163], v123 offset:14848
  v_mfma_f32_16x16x32_bf16 v[32:35], a[32:35], v[164:167], v[32:35]
  v_mfma_f32_16x16x32_bf16 v[80:83], a[36:39], v[164:167], v[80:83]
  ds_read_b64_tr_b16 v[164:165], v120 offset:15360
  ds_read_b64_tr_b16 v[166:167], v120 offset:15872
  v_mfma_f32_16x16x32_bf16 v[36:39], a[32:35], v[168:171], v[36:39]
  v_mfma_f32_16x16x32_bf16 v[84:87], a[36:39], v[168:171], v[84:87]
  ds_read_b64_tr_b16 v[168:169], v121 offset:15360
  ds_read_b64_tr_b16 v[170:171], v121 offset:15872
  v_mfma_f32_16x16x32_bf16 v[40:43], a[32:35], v[172:175], v[40:43]
  v_mfma_f32_16x16x32_bf16 v[88:91], a[36:39], v[172:175], v[88:91]
  ds_read_b64_tr_b16 v[172:173], v122 offset:15360
  ds_read_b64_tr_b16 v[174:175], v122 offset:15872
  v_mfma_f32_16x16x32_bf16 v[44:47], a[32:35], v[176:179], v[44:47]
  v_mfma_f32_16x16x32_bf16 v[92:95], a[36:39], v[176:179], v[92:95]
  s_waitcnt vmcnt(20) lgkmcnt(10)
  s_barrier
  v_mfma_f32_16x16x32_bf16 v[96:99], v[180:183], v[188:191], v[96:99]
  ds_read_b64_tr_b16 v[176:177], v123 offset:15360
  s_add_u32 m0, s38, 13312
  v_mfma_f32_16x16x32_bf16 v[100:103], v[188:191], v[184:187], v[100:103]
  buffer_load_dwordx4 v107, s[8:11], s17 offen lds
  v_mfma_f32_16x16x32_bf16 v[0:3], v[132:135], a[40:43], v[0:3]
  ds_read_b64_tr_b16 v[178:179], v123 offset:15872
  buffer_load_dwordx4 v108, s[8:11], s17 offen offset:1024 lds
  v_mfma_f32_16x16x32_bf16 v[48:51], v[132:135], a[44:47], v[48:51]
  ds_read_b64_tr_b16 v[180:181], v124 offset:27648
  ds_read_b64_tr_b16 v[182:183], v124 offset:28160
  buffer_load_dwordx4 v109, s[8:11], s17 offen offset:2048 lds
  v_mfma_f32_16x16x32_bf16 v[4:7], v[136:139], a[40:43], v[4:7]
  ds_read_b128 v[188:191], v125 offset:38912
  ds_read_b64_tr_b16 v[184:185], v124 offset:28672
  ds_read_b64_tr_b16 v[186:187], v124 offset:29184
  v_mfma_f32_16x16x32_bf16 v[52:55], v[136:139], a[44:47], v[52:55]
  ds_read_b64_tr_b16 v[132:133], v120 offset:26624
  s_add_u32 s17, s17, 196608
  v_mfma_f32_16x16x32_bf16 v[8:11], v[140:143], a[40:43], v[8:11]
  ds_read_b64_tr_b16 v[134:135], v120 offset:27136
  s_cmp_eq_u32 s17, s10
  v_mfma_f32_16x16x32_bf16 v[56:59], v[140:143], a[44:47], v[56:59]
  ds_read_b64_tr_b16 v[136:137], v121 offset:26624
  s_cselect_b32 s17, 0, s17
  v_mfma_f32_16x16x32_bf16 v[12:15], v[144:147], a[40:43], v[12:15]
  ds_read_b64_tr_b16 v[138:139], v121 offset:27136
  s_add_u32 m0, s38, 26624
  v_mfma_f32_16x16x32_bf16 v[60:63], v[144:147], a[44:47], v[60:63]
  ds_read_b64_tr_b16 v[140:141], v122 offset:26624
  ds_read_b64_tr_b16 v[142:143], v122 offset:27136
  v_mfma_f32_16x16x32_bf16 v[16:19], v[148:151], a[40:43], v[16:19]
  buffer_load_dwordx4 v107, s[8:11], s17 offen lds
  v_mfma_f32_16x16x32_bf16 v[64:67], v[148:151], a[44:47], v[64:67]
  buffer_load_dwordx4 v108, s[8:11], s17 offen offset:1024 lds
  v_mfma_f32_16x16x32_bf16 v[20:23], v[152:155], a[40:43], v[20:23]
  ds_read_b64_tr_b16 v[144:145], v123 offset:26624
  ds_read_b64_tr_b16 v[146:147], v123 offset:27136
  buffer_load_dwordx4 v109, s[8:11], s17 offen offset:2048 lds
  v_mfma_f32_16x16x32_bf16 v[68:71], v[152:155], a[44:47], v[68:71]
  ds_read_b64_tr_b16 v[148:149], v120 offset:27648
  s_add_u32 s17, s17, 196608
  s_waitcnt lgkmcnt(10)
  v_mfma_f32_16x16x32_bf16 v[24:27], v[156:159], a[40:43], v[24:27]
  ds_read_b64_tr_b16 v[150:151], v120 offset:28160
  ds_read_b64_tr_b16 v[152:153], v121 offset:27648
  v_mfma_f32_16x16x32_bf16 v[72:75], v[156:159], a[44:47], v[72:75]
  ds_read_b64_tr_b16 v[154:155], v121 offset:28160
  s_cmp_eq_u32 s17, s10
  v_mfma_f32_16x16x32_bf16 v[28:31], v[160:163], a[40:43], v[28:31]
  ds_read_b64_tr_b16 v[156:157], v122 offset:27648
  s_cselect_b32 s17, 0, s17
  v_mfma_f32_16x16x32_bf16 v[76:79], v[160:163], a[44:47], v[76:79]
  ds_read_b64_tr_b16 v[158:159], v122 offset:28160
  s_add_u32 m0, s39, 26624
  v_mfma_f32_16x16x32_bf16 v[32:35], a[40:43], v[164:167], v[32:35]
  buffer_load_dword v106, s[4:7], s16 offen sc1 lds
  v_mfma_f32_16x16x32_bf16 v[80:83], a[44:47], v[164:167], v[80:83]
  ds_read_b64_tr_b16 v[160:161], v123 offset:27648
  ds_read_b64_tr_b16 v[162:163], v123 offset:28160
  v_mfma_f32_16x16x32_bf16 v[36:39], a[40:43], v[168:171], v[36:39]
  buffer_load_dwordx4 a[16:19], v105, s[4:7], s16 offen sc1
  v_mfma_f32_16x16x32_bf16 v[84:87], a[44:47], v[168:171], v[84:87]
  buffer_load_dwordx4 a[20:23], v105, s[4:7], s16 offen offset:1024 sc1
  v_mfma_f32_16x16x32_bf16 v[40:43], a[40:43], v[172:175], v[40:43]
  ds_read_b64_tr_b16 v[164:165], v120 offset:28672
  ds_read_b64_tr_b16 v[166:167], v120 offset:29184
  s_add_u32 s16, s16, 131072
  v_mfma_f32_16x16x32_bf16 v[88:91], a[44:47], v[172:175], v[88:91]
  ds_read_b64_tr_b16 v[168:169], v121 offset:28672
  s_bitset0_b32 s16, 20
  v_mfma_f32_16x16x32_bf16 v[44:47], a[40:43], v[176:179], v[44:47]
  ds_read_b64_tr_b16 v[170:171], v121 offset:29184
  ds_read_b64_tr_b16 v[172:173], v122 offset:28672
  v_mfma_f32_16x16x32_bf16 v[92:95], a[44:47], v[176:179], v[92:95]
  s_waitcnt vmcnt(21) lgkmcnt(10)
  s_barrier
  v_mfma_f32_16x16x32_bf16 v[96:99], v[180:183], v[188:191], v[96:99]
  ds_read_b64_tr_b16 v[174:175], v122 offset:29184
  s_add_u32 m0, s38, 39936
  v_mfma_f32_16x16x32_bf16 v[100:103], v[188:191], v[184:187], v[100:103]
  buffer_load_dwordx4 v107, s[8:11], s17 offen lds
  v_mfma_f32_16x16x32_bf16 v[0:3], v[132:135], a[48:51], v[0:3]
  ds_read_b64_tr_b16 v[176:177], v123 offset:28672
  ds_read_b64_tr_b16 v[178:179], v123 offset:29184
  buffer_load_dwordx4 v108, s[8:11], s17 offen offset:1024 lds
  v_mfma_f32_16x16x32_bf16 v[48:51], v[132:135], a[52:55], v[48:51]
  ds_read_b64_tr_b16 v[180:181], v124 offset:40960
  ds_read_b64_tr_b16 v[182:183], v124 offset:41472
  buffer_load_dwordx4 v109, s[8:11], s17 offen offset:2048 lds
  v_mfma_f32_16x16x32_bf16 v[4:7], v[136:139], a[48:51], v[4:7]
  ds_read_b128 v[188:191], v125 offset:52224
  ds_read_b64_tr_b16 v[184:185], v124 offset:41984
  ds_read_b64_tr_b16 v[186:187], v124 offset:42496
  v_mfma_f32_16x16x32_bf16 v[52:55], v[136:139], a[52:55], v[52:55]
  ds_read_b64_tr_b16 v[132:133], v120 offset:39936
  s_add_u32 s17, s17, 196608
  v_mfma_f32_16x16x32_bf16 v[8:11], v[140:143], a[48:51], v[8:11]
  ds_read_b64_tr_b16 v[134:135], v120 offset:40448
  s_cmp_eq_u32 s17, s10
  v_mfma_f32_16x16x32_bf16 v[56:59], v[140:143], a[52:55], v[56:59]
  ds_read_b64_tr_b16 v[136:137], v121 offset:39936
  s_cselect_b32 s17, 0, s17
  v_mfma_f32_16x16x32_bf16 v[12:15], v[144:147], a[48:51], v[12:15]
  ds_read_b64_tr_b16 v[138:139], v121 offset:40448
  s_add_u32 m0, s39, 39936
  v_mfma_f32_16x16x32_bf16 v[60:63], v[144:147], a[52:55], v[60:63]
  ds_read_b64_tr_b16 v[140:141], v122 offset:39936
  ds_read_b64_tr_b16 v[142:143], v122 offset:40448
  v_mfma_f32_16x16x32_bf16 v[16:19], v[148:151], a[48:51], v[16:19]
  buffer_load_dword v106, s[4:7], s16 offen sc1 lds
  v_mfma_f32_16x16x32_bf16 v[64:67], v[148:151], a[52:55], v[64:67]
  buffer_load_dwordx4 a[24:27], v105, s[4:7], s16 offen sc1
  s_waitcnt lgkmcnt(10)
  v_mfma_f32_16x16x32_bf16 v[20:23], v[152:155], a[48:51], v[20:23]
  ds_read_b64_tr_b16 v[144:145], v123 offset:39936
  ds_read_b64_tr_b16 v[146:147], v123 offset:40448
  buffer_load_dwordx4 a[28:31], v105, s[4:7], s16 offen offset:1024 sc1
  v_mfma_f32_16x16x32_bf16 v[68:71], v[152:155], a[52:55], v[68:71]
  ds_read_b64_tr_b16 v[148:149], v120 offset:40960
  s_add_u32 s16, s16, 131072
  v_mfma_f32_16x16x32_bf16 v[24:27], v[156:159], a[48:51], v[24:27]
  ds_read_b64_tr_b16 v[150:151], v120 offset:41472
  ds_read_b64_tr_b16 v[152:153], v121 offset:40960
  v_mfma_f32_16x16x32_bf16 v[72:75], v[156:159], a[52:55], v[72:75]
  ds_read_b64_tr_b16 v[154:155], v121 offset:41472
  s_bitset0_b32 s16, 20
  v_mfma_f32_16x16x32_bf16 v[28:31], v[160:163], a[48:51], v[28:31]
  ds_read_b64_tr_b16 v[156:157], v122 offset:40960
  s_add_u32 m0, s38, 53248
  v_mfma_f32_16x16x32_bf16 v[76:79], v[160:163], a[52:55], v[76:79]
  buffer_load_dwordx4 v107, s[8:11], s17 offen lds
  v_mfma_f32_16x16x32_bf16 v[32:35], a[48:51], v[164:167], v[32:35]
  ds_read_b64_tr_b16 v[158:159], v122 offset:41472
  buffer_load_dwordx4 v108, s[8:11], s17 offen offset:1024 lds
  v_mfma_f32_16x16x32_bf16 v[80:83], a[52:55], v[164:167], v[80:83]
  ds_read_b64_tr_b16 v[160:161], v123 offset:40960
  ds_read_b64_tr_b16 v[162:163], v123 offset:41472
  v_mfma_f32_16x16x32_bf16 v[36:39], a[48:51], v[168:171], v[36:39]
  buffer_load_dwordx4 v109, s[8:11], s17 offen offset:2048 lds
  v_mfma_f32_16x16x32_bf16 v[84:87], a[52:55], v[168:171], v[84:87]
  ds_read_b64_tr_b16 v[164:165], v120 offset:41984
  s_add_u32 s17, s17, 196608
  v_mfma_f32_16x16x32_bf16 v[40:43], a[48:51], v[172:175], v[40:43]
  ds_read_b64_tr_b16 v[166:167], v120 offset:42496
  s_cmp_eq_u32 s17, s10
  v_mfma_f32_16x16x32_bf16 v[88:91], a[52:55], v[172:175], v[88:91]
  ds_read_b64_tr_b16 v[168:169], v121 offset:41984
  s_cselect_b32 s17, 0, s17
  v_mfma_f32_16x16x32_bf16 v[44:47], a[48:51], v[176:179], v[44:47]
  ds_read_b64_tr_b16 v[170:171], v121 offset:42496
  ds_read_b64_tr_b16 v[172:173], v122 offset:41984
  v_mfma_f32_16x16x32_bf16 v[92:95], a[52:55], v[176:179], v[92:95]
  s_waitcnt vmcnt(21) lgkmcnt(10)
  s_barrier
  v_mfma_f32_16x16x32_bf16 v[96:99], v[180:183], v[188:191], v[96:99]
  ds_read_b64_tr_b16 v[174:175], v122 offset:42496
  s_add_u32 m0, s39, 53248
  v_mfma_f32_16x16x32_bf16 v[100:103], v[188:191], v[184:187], v[100:103]
  buffer_load_dword v106, s[4:7], s16 offen sc1 lds
  v_mfma_f32_16x16x32_bf16 v[0:3], v[132:135], a[56:59], v[0:3]
  ds_read_b64_tr_b16 v[176:177], v123 offset:41984
  ds_read_b64_tr_b16 v[178:179], v123 offset:42496
  buffer_load_dwordx4 a[32:35], v105, s[4:7], s16 offen sc1
  v_mfma_f32_16x16x32_bf16 v[48:51], v[132:135], a[60:63], v[48:51]
  ds_read_b64_tr_b16 v[180:181], v118 offset:1024
  ds_read_b64_tr_b16 v[182:183], v118 offset:1536
  buffer_load_dwordx4 a[36:39], v105, s[4:7], s16 offen offset:1024 sc1
  v_mfma_f32_16x16x32_bf16 v[4:7], v[136:139], a[56:59], v[4:7]
  ds_read_b128 v[188:191], v119 offset:12288
  ds_read_b64_tr_b16 v[184:185], v118 offset:2048
  ds_read_b64_tr_b16 v[186:187], v118 offset:2560
  v_mfma_f32_16x16x32_bf16 v[52:55], v[136:139], a[60:63], v[52:55]
  ds_read_b64_tr_b16 v[132:133], v114 offset:0
  s_add_u32 s16, s16, 131072
  v_mfma_f32_16x16x32_bf16 v[8:11], v[140:143], a[56:59], v[8:11]
  ds_read_b64_tr_b16 v[134:135], v114 offset:512
  s_bitset0_b32 s16, 20
  v_mfma_f32_16x16x32_bf16 v[56:59], v[140:143], a[60:63], v[56:59]
  ds_read_b64_tr_b16 v[136:137], v115 offset:0
  s_add_u32 m0, s38, 66560
  v_mfma_f32_16x16x32_bf16 v[12:15], v[144:147], a[56:59], v[12:15]
  ds_read_b64_tr_b16 v[138:139], v115 offset:512
  ds_read_b64_tr_b16 v[140:141], v116 offset:0
  v_mfma_f32_16x16x32_bf16 v[60:63], v[144:147], a[60:63], v[60:63]
  buffer_load_dwordx4 v107, s[8:11], s17 offen lds
  v_mfma_f32_16x16x32_bf16 v[16:19], v[148:151], a[56:59], v[16:19]
  ds_read_b64_tr_b16 v[142:143], v116 offset:512
  buffer_load_dwordx4 v108, s[8:11], s17 offen offset:1024 lds
  v_mfma_f32_16x16x32_bf16 v[64:67], v[148:151], a[60:63], v[64:67]
  buffer_load_dwordx4 v109, s[8:11], s17 offen offset:2048 lds
  s_waitcnt lgkmcnt(10)
  v_mfma_f32_16x16x32_bf16 v[20:23], v[152:155], a[56:59], v[20:23]
  ds_read_b64_tr_b16 v[144:145], v117 offset:0
  ds_read_b64_tr_b16 v[146:147], v117 offset:512
  v_mfma_f32_16x16x32_bf16 v[68:71], v[152:155], a[60:63], v[68:71]
  ds_read_b64_tr_b16 v[148:149], v114 offset:1024
  s_add_u32 s17, s17, 196608
  v_mfma_f32_16x16x32_bf16 v[24:27], v[156:159], a[56:59], v[24:27]
  ds_read_b64_tr_b16 v[150:151], v114 offset:1536
  s_cmp_eq_u32 s17, s10
  v_mfma_f32_16x16x32_bf16 v[72:75], v[156:159], a[60:63], v[72:75]
  ds_read_b64_tr_b16 v[152:153], v115 offset:1024
  s_cselect_b32 s17, 0, s17
  v_mfma_f32_16x16x32_bf16 v[28:31], v[160:163], a[56:59], v[28:31]
  ds_read_b64_tr_b16 v[154:155], v115 offset:1536
  ds_read_b64_tr_b16 v[156:157], v116 offset:1024
  v_mfma_f32_16x16x32_bf16 v[76:79], v[160:163], a[60:63], v[76:79]
  ds_read_b64_tr_b16 v[158:159], v116 offset:1536
  s_add_u32 m0, s39, 66560
  v_mfma_f32_16x16x32_bf16 v[32:35], a[56:59], v[164:167], v[32:35]
  buffer_load_dword v106, s[4:7], s16 offen sc1 lds
  v_mfma_f32_16x16x32_bf16 v[80:83], a[60:63], v[164:167], v[80:83]
  buffer_load_dwordx4 a[40:43], v105, s[4:7], s16 offen sc1
  v_mfma_f32_16x16x32_bf16 v[36:39], a[56:59], v[168:171], v[36:39]
  ds_read_b64_tr_b16 v[160:161], v117 offset:1024
  ds_read_b64_tr_b16 v[162:163], v117 offset:1536
  v_mfma_f32_16x16x32_bf16 v[84:87], a[60:63], v[168:171], v[84:87]
  buffer_load_dwordx4 a[44:47], v105, s[4:7], s16 offen offset:1024 sc1
  v_mfma_f32_16x16x32_bf16 v[40:43], a[56:59], v[172:175], v[40:43]
  ds_read_b64_tr_b16 v[164:165], v114 offset:2048
  ds_read_b64_tr_b16 v[166:167], v114 offset:2560
  s_add_u32 s16, s16, 131072
  v_mfma_f32_16x16x32_bf16 v[88:91], a[60:63], v[172:175], v[88:91]
  ds_read_b64_tr_b16 v[168:169], v115 offset:2048
  s_bitset0_b32 s16, 20
  v_mfma_f32_16x16x32_bf16 v[44:47], a[56:59], v[176:179], v[44:47]
  ds_read_b64_tr_b16 v[170:171], v115 offset:2560
  ds_read_b64_tr_b16 v[172:173], v116 offset:2048
  v_mfma_f32_16x16x32_bf16 v[92:95], a[60:63], v[176:179], v[92:95]
  s_waitcnt vmcnt(24) lgkmcnt(10)
  s_barrier
  v_mfma_f32_16x16x32_bf16 v[96:99], v[180:183], v[188:191], v[96:99]
  ds_read_b64_tr_b16 v[174:175], v116 offset:2560
  s_add_u32 m0, s38, 79872
  v_mfma_f32_16x16x32_bf16 v[100:103], v[188:191], v[184:187], v[100:103]
  buffer_load_dwordx4 v107, s[8:11], s17 offen lds
  v_mfma_f32_16x16x32_bf16 v[0:3], v[132:135], a[0:3], v[0:3]
  ds_read_b64_tr_b16 v[176:177], v117 offset:2048
  ds_read_b64_tr_b16 v[178:179], v117 offset:2560
  buffer_load_dwordx4 v108, s[8:11], s17 offen offset:1024 lds
  v_mfma_f32_16x16x32_bf16 v[48:51], v[132:135], a[4:7], v[48:51]
  ds_read_b64_tr_b16 v[180:181], v118 offset:14336
  ds_read_b64_tr_b16 v[182:183], v118 offset:14848
  buffer_load_dwordx4 v109, s[8:11], s17 offen offset:2048 lds
  v_mfma_f32_16x16x32_bf16 v[4:7], v[136:139], a[0:3], v[4:7]
  ds_read_b128 v[188:191], v119 offset:25600
  ds_read_b64_tr_b16 v[184:185], v118 offset:15360
  ds_read_b64_tr_b16 v[186:187], v118 offset:15872
  v_mfma_f32_16x16x32_bf16 v[52:55], v[136:139], a[4:7], v[52:55]
  ds_read_b64_tr_b16 v[132:133], v114 offset:13312
  s_add_u32 s17, s17, 196608
  v_mfma_f32_16x16x32_bf16 v[8:11], v[140:143], a[0:3], v[8:11]
  ds_read_b64_tr_b16 v[134:135], v114 offset:13824
  s_cmp_eq_u32 s17, s10
  v_mfma_f32_16x16x32_bf16 v[56:59], v[140:143], a[4:7], v[56:59]
  ds_read_b64_tr_b16 v[136:137], v115 offset:13312
  s_cselect_b32 s17, 0, s17
  v_mfma_f32_16x16x32_bf16 v[12:15], v[144:147], a[0:3], v[12:15]
  ds_read_b64_tr_b16 v[138:139], v115 offset:13824
  s_add_u32 m0, s39, 79872
  v_mfma_f32_16x16x32_bf16 v[60:63], v[144:147], a[4:7], v[60:63]
  ds_read_b64_tr_b16 v[140:141], v116 offset:13312
  ds_read_b64_tr_b16 v[142:143], v116 offset:13824
  v_mfma_f32_16x16x32_bf16 v[16:19], v[148:151], a[0:3], v[16:19]
  buffer_load_dword v106, s[4:7], s16 offen sc1 lds
  v_mfma_f32_16x16x32_bf16 v[64:67], v[148:151], a[4:7], v[64:67]
  buffer_load_dwordx4 a[48:51], v105, s[4:7], s16 offen sc1
  s_waitcnt lgkmcnt(10)
  v_mfma_f32_16x16x32_bf16 v[20:23], v[152:155], a[0:3], v[20:23]
  ds_read_b64_tr_b16 v[144:145], v117 offset:13312
  ds_read_b64_tr_b16 v[146:147], v117 offset:13824
  buffer_load_dwordx4 a[52:55], v105, s[4:7], s16 offen offset:1024 sc1
  v_mfma_f32_16x16x32_bf16 v[68:71], v[152:155], a[4:7], v[68:71]
  ds_read_b64_tr_b16 v[148:149], v114 offset:14336
  s_add_u32 s16, s16, 131072
  v_mfma_f32_16x16x32_bf16 v[24:27], v[156:159], a[0:3], v[24:27]
  ds_read_b64_tr_b16 v[150:151], v114 offset:14848
  ds_read_b64_tr_b16 v[152:153], v115 offset:14336
  v_mfma_f32_16x16x32_bf16 v[72:75], v[156:159], a[4:7], v[72:75]
  ds_read_b64_tr_b16 v[154:155], v115 offset:14848
  s_bitset0_b32 s16, 20
  v_mfma_f32_16x16x32_bf16 v[28:31], v[160:163], a[0:3], v[28:31]
  ds_read_b64_tr_b16 v[156:157], v116 offset:14336
  s_add_u32 m0, s38, 93184
  v_mfma_f32_16x16x32_bf16 v[76:79], v[160:163], a[4:7], v[76:79]
  buffer_load_dwordx4 v107, s[8:11], s17 offen lds
  v_mfma_f32_16x16x32_bf16 v[32:35], a[0:3], v[164:167], v[32:35]
  ds_read_b64_tr_b16 v[158:159], v116 offset:14848
  buffer_load_dwordx4 v108, s[8:11], s17 offen offset:1024 lds
  v_mfma_f32_16x16x32_bf16 v[80:83], a[4:7], v[164:167], v[80:83]
  ds_read_b64_tr_b16 v[160:161], v117 offset:14336
  ds_read_b64_tr_b16 v[162:163], v117 offset:14848
  v_mfma_f32_16x16x32_bf16 v[36:39], a[0:3], v[168:171], v[36:39]
  buffer_load_dwordx4 v109, s[8:11], s17 offen offset:2048 lds
  v_mfma_f32_16x16x32_bf16 v[84:87], a[4:7], v[168:171], v[84:87]
  ds_read_b64_tr_b16 v[164:165], v114 offset:15360
  s_add_u32 s17, s17, 196608
  v_mfma_f32_16x16x32_bf16 v[40:43], a[0:3], v[172:175], v[40:43]
  ds_read_b64_tr_b16 v[166:167], v114 offset:15872
  s_cmp_eq_u32 s17, s10
  v_mfma_f32_16x16x32_bf16 v[88:91], a[4:7], v[172:175], v[88:91]
  ds_read_b64_tr_b16 v[168:169], v115 offset:15360
  s_cselect_b32 s17, 0, s17
  v_mfma_f32_16x16x32_bf16 v[44:47], a[0:3], v[176:179], v[44:47]
  ds_read_b64_tr_b16 v[170:171], v115 offset:15872
  ds_read_b64_tr_b16 v[172:173], v116 offset:15360
  v_mfma_f32_16x16x32_bf16 v[92:95], a[4:7], v[176:179], v[92:95]
  s_waitcnt vmcnt(27) lgkmcnt(10)
  s_barrier
  v_mfma_f32_16x16x32_bf16 v[96:99], v[180:183], v[188:191], v[96:99]
  ds_read_b64_tr_b16 v[174:175], v116 offset:15872
  s_add_u32 m0, s39, 93184
  v_mfma_f32_16x16x32_bf16 v[100:103], v[188:191], v[184:187], v[100:103]
  buffer_load_dword v106, s[4:7], s16 offen sc1 lds
  v_mfma_f32_16x16x32_bf16 v[0:3], v[132:135], a[8:11], v[0:3]
  ds_read_b64_tr_b16 v[176:177], v117 offset:15360
  ds_read_b64_tr_b16 v[178:179], v117 offset:15872
  buffer_load_dwordx4 a[56:59], v105, s[4:7], s16 offen sc1
  v_mfma_f32_16x16x32_bf16 v[48:51], v[132:135], a[12:15], v[48:51]
  ds_read_b64_tr_b16 v[180:181], v118 offset:27648
  ds_read_b64_tr_b16 v[182:183], v118 offset:28160
  buffer_load_dwordx4 a[60:63], v105, s[4:7], s16 offen offset:1024 sc1
  v_mfma_f32_16x16x32_bf16 v[4:7], v[136:139], a[8:11], v[4:7]
  ds_read_b128 v[188:191], v119 offset:38912
  ds_read_b64_tr_b16 v[184:185], v118 offset:28672
  ds_read_b64_tr_b16 v[186:187], v118 offset:29184
  s_add_u32 s16, s16, 131072
  v_mfma_f32_16x16x32_bf16 v[52:55], v[136:139], a[12:15], v[52:55]
  ds_read_b64_tr_b16 v[132:133], v114 offset:26624
  s_bitset0_b32 s16, 20
  v_mfma_f32_16x16x32_bf16 v[8:11], v[140:143], a[8:11], v[8:11]
  ds_read_b64_tr_b16 v[134:135], v114 offset:27136
  ds_read_b64_tr_b16 v[136:137], v115 offset:26624
  v_mfma_f32_16x16x32_bf16 v[56:59], v[140:143], a[12:15], v[56:59]
  ds_read_b64_tr_b16 v[138:139], v115 offset:27136
  s_add_u32 m0, s51, 0
  v_mfma_f32_16x16x32_bf16 v[12:15], v[144:147], a[8:11], v[12:15]
  ds_read_b64_tr_b16 v[140:141], v116 offset:26624
  s_add_u32 s50, s98, 0
  v_mfma_f32_16x16x32_bf16 v[60:63], v[144:147], a[12:15], v[60:63]
  ds_read_b64_tr_b16 v[142:143], v116 offset:27136
  s_bitset0_b32 s50, 21
  v_mfma_f32_16x16x32_bf16 v[16:19], v[148:151], a[8:11], v[16:19]
  buffer_load_dwordx4 v248, s[52:55], s50 offen lds
  v_mfma_f32_16x16x32_bf16 v[64:67], v[148:151], a[12:15], v[64:67]
  buffer_load_dwordx4 v249, s[52:55], s50 offen offset:1024 lds
  s_waitcnt lgkmcnt(10)
  v_mfma_f32_16x16x32_bf16 v[20:23], v[152:155], a[8:11], v[20:23]
  ds_read_b64_tr_b16 v[144:145], v117 offset:26624
  ds_read_b64_tr_b16 v[146:147], v117 offset:27136
  v_mfma_f32_16x16x32_bf16 v[68:71], v[152:155], a[12:15], v[68:71]
  ds_read_b64_tr_b16 v[148:149], v114 offset:27648
  s_add_u32 m0, s51, 114688
  v_mfma_f32_16x16x32_bf16 v[24:27], v[156:159], a[8:11], v[24:27]
  ds_read_b64_tr_b16 v[150:151], v114 offset:28160
  s_add_u32 s50, s98, 1835008
  v_mfma_f32_16x16x32_bf16 v[72:75], v[156:159], a[12:15], v[72:75]
  ds_read_b64_tr_b16 v[152:153], v115 offset:27648
  s_bitset0_b32 s50, 21
  v_mfma_f32_16x16x32_bf16 v[28:31], v[160:163], a[8:11], v[28:31]
  ds_read_b64_tr_b16 v[154:155], v115 offset:28160
  buffer_load_dwordx4 v248, s[52:55], s50 offen lds
  v_mfma_f32_16x16x32_bf16 v[76:79], v[160:163], a[12:15], v[76:79]
  buffer_load_dwordx4 v249, s[52:55], s50 offen offset:1024 lds
  v_mfma_f32_16x16x32_bf16 v[32:35], a[8:11], v[164:167], v[32:35]
  ds_read_b64_tr_b16 v[156:157], v116 offset:27648
  ds_read_b64_tr_b16 v[158:159], v116 offset:28160
  v_mfma_f32_16x16x32_bf16 v[80:83], a[12:15], v[164:167], v[80:83]
  ds_read_b64_tr_b16 v[160:161], v117 offset:27648
  s_add_u32 m0, s51, 122880
  v_mfma_f32_16x16x32_bf16 v[36:39], a[8:11], v[168:171], v[36:39]
  ds_read_b64_tr_b16 v[162:163], v117 offset:28160
  s_add_u32 s50, s98, 1966080
  v_mfma_f32_16x16x32_bf16 v[84:87], a[12:15], v[168:171], v[84:87]
  ds_read_b64_tr_b16 v[164:165], v114 offset:28672
  s_bitset0_b32 s50, 21
  v_mfma_f32_16x16x32_bf16 v[40:43], a[8:11], v[172:175], v[40:43]
  ds_read_b64_tr_b16 v[166:167], v114 offset:29184
  buffer_load_dwordx4 v248, s[52:55], s50 offen lds
  v_mfma_f32_16x16x32_bf16 v[88:91], a[12:15], v[172:175], v[88:91]
  buffer_load_dwordx4 v249, s[52:55], s50 offen offset:1024 lds
  v_mfma_f32_16x16x32_bf16 v[44:47], a[8:11], v[176:179], v[44:47]
  ds_read_b64_tr_b16 v[168:169], v115 offset:28672
  ds_read_b64_tr_b16 v[170:171], v115 offset:29184
  v_mfma_f32_16x16x32_bf16 v[92:95], a[12:15], v[176:179], v[92:95]
  s_waitcnt vmcnt(30) lgkmcnt(10)
  s_barrier
  v_mfma_f32_16x16x32_bf16 v[96:99], v[180:183], v[188:191], v[96:99]
  ds_read_b64_tr_b16 v[172:173], v116 offset:28672
  ds_read_b64_tr_b16 v[174:175], v116 offset:29184
  s_add_u32 m0, s51, 8192
  v_mfma_f32_16x16x32_bf16 v[100:103], v[188:191], v[184:187], v[100:103]
  ds_read_b64_tr_b16 v[176:177], v117 offset:28672
  ds_read_b64_tr_b16 v[178:179], v117 offset:29184
  v_mfma_f32_16x16x32_bf16 v[0:3], v[132:135], a[16:19], v[0:3]
  ds_read_b64_tr_b16 v[180:181], v118 offset:40960
  s_add_u32 s50, s98, 131072
  v_mfma_f32_16x16x32_bf16 v[48:51], v[132:135], a[20:23], v[48:51]
  ds_read_b64_tr_b16 v[182:183], v118 offset:41472
  ds_read_b128 v[188:191], v119 offset:52224
  v_mfma_f32_16x16x32_bf16 v[4:7], v[136:139], a[16:19], v[4:7]
  ds_read_b64_tr_b16 v[184:185], v118 offset:41984
  ds_read_b64_tr_b16 v[186:187], v118 offset:42496
  v_mfma_f32_16x16x32_bf16 v[52:55], v[136:139], a[20:23], v[52:55]
  ds_read_b64_tr_b16 v[132:133], v114 offset:39936
  s_bitset0_b32 s50, 21
  v_mfma_f32_16x16x32_bf16 v[8:11], v[140:143], a[16:19], v[8:11]
  ds_read_b64_tr_b16 v[134:135], v114 offset:40448
  ds_read_b64_tr_b16 v[136:137], v115 offset:39936
  v_mfma_f32_16x16x32_bf16 v[56:59], v[140:143], a[20:23], v[56:59]
  buffer_load_dwordx4 v248, s[52:55], s50 offen lds
  v_mfma_f32_16x16x32_bf16 v[12:15], v[144:147], a[16:19], v[12:15]
  ds_read_b64_tr_b16 v[138:139], v115 offset:40448
  ds_read_b64_tr_b16 v[140:141], v116 offset:39936
  v_mfma_f32_16x16x32_bf16 v[60:63], v[144:147], a[20:23], v[60:63]
  ds_read_b64_tr_b16 v[142:143], v116 offset:40448
  ds_read_b64_tr_b16 v[144:145], v117 offset:39936
  v_mfma_f32_16x16x32_bf16 v[16:19], v[148:151], a[16:19], v[16:19]
  buffer_load_dwordx4 v249, s[52:55], s50 offen offset:1024 lds
  v_mfma_f32_16x16x32_bf16 v[64:67], v[148:151], a[20:23], v[64:67]
  ds_read_b64_tr_b16 v[146:147], v117 offset:40448
  ds_read_b64_tr_b16 v[148:149], v114 offset:40960
  s_waitcnt lgkmcnt(10)
  v_mfma_f32_16x16x32_bf16 v[20:23], v[152:155], a[16:19], v[20:23]
  ds_read_b64_tr_b16 v[150:151], v114 offset:41472
  s_add_u32 m0, s51, 16384
  v_mfma_f32_16x16x32_bf16 v[68:71], v[152:155], a[20:23], v[68:71]
  ds_read_b64_tr_b16 v[152:153], v115 offset:40960
  ds_read_b64_tr_b16 v[154:155], v115 offset:41472
  v_mfma_f32_16x16x32_bf16 v[24:27], v[156:159], a[16:19], v[24:27]
  v_mfma_f32_16x16x32_bf16 v[72:75], v[156:159], a[20:23], v[72:75]
  ds_read_b64_tr_b16 v[156:157], v116 offset:40960
  s_add_u32 s50, s98, 262144
  v_mfma_f32_16x16x32_bf16 v[28:31], v[160:163], a[16:19], v[28:31]
  ds_read_b64_tr_b16 v[158:159], v116 offset:41472
  v_mfma_f32_16x16x32_bf16 v[76:79], v[160:163], a[20:23], v[76:79]
  ds_read_b64_tr_b16 v[160:161], v117 offset:40960
  s_bitset0_b32 s50, 21
  v_mfma_f32_16x16x32_bf16 v[32:35], a[16:19], v[164:167], v[32:35]
  ds_read_b64_tr_b16 v[162:163], v117 offset:41472
  v_mfma_f32_16x16x32_bf16 v[80:83], a[20:23], v[164:167], v[80:83]
  ds_read_b64_tr_b16 v[164:165], v114 offset:41984
  ds_read_b64_tr_b16 v[166:167], v114 offset:42496
  v_mfma_f32_16x16x32_bf16 v[36:39], a[16:19], v[168:171], v[36:39]
  buffer_load_dwordx4 v248, s[52:55], s50 offen lds
  v_mfma_f32_16x16x32_bf16 v[84:87], a[20:23], v[168:171], v[84:87]
  ds_read_b64_tr_b16 v[168:169], v115 offset:41984
  ds_read_b64_tr_b16 v[170:171], v115 offset:42496
  v_mfma_f32_16x16x32_bf16 v[40:43], a[16:19], v[172:175], v[40:43]
  buffer_load_dwordx4 v249, s[52:55], s50 offen offset:1024 lds
  v_mfma_f32_16x16x32_bf16 v[88:91], a[20:23], v[172:175], v[88:91]
  ds_read_b64_tr_b16 v[172:173], v116 offset:41984
  ds_read_b64_tr_b16 v[174:175], v116 offset:42496
  v_mfma_f32_16x16x32_bf16 v[44:47], a[16:19], v[176:179], v[44:47]
  v_mfma_f32_16x16x32_bf16 v[92:95], a[20:23], v[176:179], v[92:95]
  s_waitcnt vmcnt(28) lgkmcnt(10)
  s_barrier
  v_mfma_f32_16x16x32_bf16 v[96:99], v[180:183], v[188:191], v[96:99]
  ds_read_b64_tr_b16 v[176:177], v117 offset:41984
  s_add_u32 m0, s51, 24576
  v_mfma_f32_16x16x32_bf16 v[100:103], v[188:191], v[184:187], v[100:103]
  ds_read_b64_tr_b16 v[178:179], v117 offset:42496
  ds_read_b64_tr_b16 v[180:181], v124 offset:1024
  v_mfma_f32_16x16x32_bf16 v[0:3], v[132:135], a[24:27], v[0:3]
  ds_read_b64_tr_b16 v[182:183], v124 offset:1536
  ds_read_b128 v[188:191], v125 offset:12288
  v_mfma_f32_16x16x32_bf16 v[48:51], v[132:135], a[28:31], v[48:51]
  ds_read_b64_tr_b16 v[184:185], v124 offset:2048
  ds_read_b64_tr_b16 v[186:187], v124 offset:2560
  v_mfma_f32_16x16x32_bf16 v[4:7], v[136:139], a[24:27], v[4:7]
  ds_read_b64_tr_b16 v[132:133], v120 offset:0
  ds_read_b64_tr_b16 v[134:135], v120 offset:512
  v_mfma_f32_16x16x32_bf16 v[52:55], v[136:139], a[28:31], v[52:55]
  ds_read_b64_tr_b16 v[136:137], v121 offset:0
  s_add_u32 s50, s98, 393216
  v_mfma_f32_16x16x32_bf16 v[8:11], v[140:143], a[24:27], v[8:11]
  ds_read_b64_tr_b16 v[138:139], v121 offset:512
  v_mfma_f32_16x16x32_bf16 v[56:59], v[140:143], a[28:31], v[56:59]
  ds_read_b64_tr_b16 v[140:141], v122 offset:0
  ds_read_b64_tr_b16 v[142:143], v122 offset:512
  v_mfma_f32_16x16x32_bf16 v[12:15], v[144:147], a[24:27], v[12:15]
  v_mfma_f32_16x16x32_bf16 v[60:63], v[144:147], a[28:31], v[60:63]
  ds_read_b64_tr_b16 v[144:145], v123 offset:0
  ds_read_b64_tr_b16 v[146:147], v123 offset:512
  v_mfma_f32_16x16x32_bf16 v[16:19], v[148:151], a[24:27], v[16:19]
  s_bitset0_b32 s50, 21
  v_mfma_f32_16x16x32_bf16 v[64:67], v[148:151], a[28:31], v[64:67]
  ds_read_b64_tr_b16 v[148:149], v120 offset:1024
  ds_read_b64_tr_b16 v[150:151], v120 offset:1536
  v_mfma_f32_16x16x32_bf16 v[20:23], v[152:155], a[24:27], v[20:23]
  v_mfma_f32_16x16x32_bf16 v[68:71], v[152:155], a[28:31], v[68:71]
  ds_read_b64_tr_b16 v[152:153], v121 offset:1024
  ds_read_b64_tr_b16 v[154:155], v121 offset:1536
  s_waitcnt lgkmcnt(10)
  v_mfma_f32_16x16x32_bf16 v[24:27], v[156:159], a[24:27], v[24:27]
  v_mfma_f32_16x16x32_bf16 v[72:75], v[156:159], a[28:31], v[72:75]
  buffer_load_dwordx4 v248, s[52:55], s50 offen lds
  v_mfma_f32_16x16x32_bf16 v[28:31], v[160:163], a[24:27], v[28:31]
  ds_read_b64_tr_b16 v[156:157], v122 offset:1024
  ds_read_b64_tr_b16 v[158:159], v122 offset:1536
  v_mfma_f32_16x16x32_bf16 v[76:79], v[160:163], a[28:31], v[76:79]
  ds_read_b64_tr_b16 v[160:161], v123 offset:1024
  ds_read_b64_tr_b16 v[162:163], v123 offset:1536
  v_mfma_f32_16x16x32_bf16 v[32:35], a[24:27], v[164:167], v[32:35]
  v_mfma_f32_16x16x32_bf16 v[80:83], a[28:31], v[164:167], v[80:83]
  ds_read_b64_tr_b16 v[164:165], v120 offset:2048
  ds_read_b64_tr_b16 v[166:167], v120 offset:2560
  v_mfma_f32_16x16x32_bf16 v[36:39], a[24:27], v[168:171], v[36:39]
  buffer_load_dwordx4 v249, s[52:55], s50 offen offset:1024 lds
  v_mfma_f32_16x16x32_bf16 v[84:87], a[28:31], v[168:171], v[84:87]
  ds_read_b64_tr_b16 v[168:169], v121 offset:2048
  ds_read_b64_tr_b16 v[170:171], v121 offset:2560
  v_mfma_f32_16x16x32_bf16 v[40:43], a[24:27], v[172:175], v[40:43]
  v_mfma_f32_16x16x32_bf16 v[88:91], a[28:31], v[172:175], v[88:91]
  ds_read_b64_tr_b16 v[172:173], v122 offset:2048
  ds_read_b64_tr_b16 v[174:175], v122 offset:2560
  v_mfma_f32_16x16x32_bf16 v[44:47], a[24:27], v[176:179], v[44:47]
  v_mfma_f32_16x16x32_bf16 v[92:95], a[28:31], v[176:179], v[92:95]
  s_waitcnt vmcnt(24) lgkmcnt(10)
  s_barrier
  v_mfma_f32_16x16x32_bf16 v[96:99], v[180:183], v[188:191], v[96:99]
  ds_read_b64_tr_b16 v[176:177], v123 offset:2048
  s_add_u32 m0, s51, 32768
  v_mfma_f32_16x16x32_bf16 v[100:103], v[188:191], v[184:187], v[100:103]
  ds_read_b64_tr_b16 v[178:179], v123 offset:2560
  ds_read_b64_tr_b16 v[180:181], v124 offset:14336
  v_mfma_f32_16x16x32_bf16 v[0:3], v[132:135], a[32:35], v[0:3]
  ds_read_b64_tr_b16 v[182:183], v124 offset:14848
  s_add_u32 s50, s98, 524288
  v_mfma_f32_16x16x32_bf16 v[48:51], v[132:135], a[36:39], v[48:51]
  ds_read_b128 v[188:191], v125 offset:25600
  ds_read_b64_tr_b16 v[184:185], v124 offset:15360
  v_mfma_f32_16x16x32_bf16 v[4:7], v[136:139], a[32:35], v[4:7]
  ds_read_b64_tr_b16 v[186:187], v124 offset:15872
  ds_read_b64_tr_b16 v[132:133], v120 offset:13312
  v_mfma_f32_16x16x32_bf16 v[52:55], v[136:139], a[36:39], v[52:55]
  ds_read_b64_tr_b16 v[134:135], v120 offset:13824
  s_bitset0_b32 s50, 21
  v_mfma_f32_16x16x32_bf16 v[8:11], v[140:143], a[32:35], v[8:11]
  ds_read_b64_tr_b16 v[136:137], v121 offset:13312
  ds_read_b64_tr_b16 v[138:139], v121 offset:13824
  v_mfma_f32_16x16x32_bf16 v[56:59], v[140:143], a[36:39], v[56:59]
  buffer_load_dwordx4 v248, s[52:55], s50 offen lds
  v_mfma_f32_16x16x32_bf16 v[12:15], v[144:147], a[32:35], v[12:15]
  ds_read_b64_tr_b16 v[140:141], v122 offset:13312
  ds_read_b64_tr_b16 v[142:143], v122 offset:13824
  v_mfma_f32_16x16x32_bf16 v[60:63], v[144:147], a[36:39], v[60:63]
  ds_read_b64_tr_b16 v[144:145], v123 offset:13312
  ds_read_b64_tr_b16 v[146:147], v123 offset:13824
  v_mfma_f32_16x16x32_bf16 v[16:19], v[148:151], a[32:35], v[16:19]
  buffer_load_dwordx4 v249, s[52:55], s50 offen offset:1024 lds
  v_mfma_f32_16x16x32_bf16 v[64:67], v[148:151], a[36:39], v[64:67]
  ds_read_b64_tr_b16 v[148:149], v120 offset:14336
  ds_read_b64_tr_b16 v[150:151], v120 offset:14848
  v_mfma_f32_16x16x32_bf16 v[20:23], v[152:155], a[32:35], v[20:23]
  s_add_u32 m0, s51, 40960
  v_mfma_f32_16x16x32_bf16 v[68:71], v[152:155], a[36:39], v[68:71]
  ds_read_b64_tr_b16 v[152:153], v121 offset:14336
  ds_read_b64_tr_b16 v[154:155], v121 offset:14848
  s_waitcnt lgkmcnt(10)
  v_mfma_f32_16x16x32_bf16 v[24:27], v[156:159], a[32:35], v[24:27]
  v_mfma_f32_16x16x32_bf16 v[72:75], v[156:159], a[36:39], v[72:75]
  ds_read_b64_tr_b16 v[156:157], v122 offset:14336
  s_add_u32 s50, s98, 655360
  v_mfma_f32_16x16x32_bf16 v[28:31], v[160:163], a[32:35], v[28:31]
  ds_read_b64_tr_b16 v[158:159], v122 offset:14848
  v_mfma_f32_16x16x32_bf16 v[76:79], v[160:163], a[36:39], v[76:79]
  ds_read_b64_tr_b16 v[160:161], v123 offset:14336
  s_bitset0_b32 s50, 21
  v_mfma_f32_16x16x32_bf16 v[32:35], a[32:35], v[164:167], v[32:35]
  ds_read_b64_tr_b16 v[162:163], v123 offset:14848
  v_mfma_f32_16x16x32_bf16 v[80:83], a[36:39], v[164:167], v[80:83]
  ds_read_b64_tr_b16 v[164:165], v120 offset:15360
  ds_read_b64_tr_b16 v[166:167], v120 offset:15872
  v_mfma_f32_16x16x32_bf16 v[36:39], a[32:35], v[168:171], v[36:39]
  buffer_load_dwordx4 v248, s[52:55], s50 offen lds
  v_mfma_f32_16x16x32_bf16 v[84:87], a[36:39], v[168:171], v[84:87]
  ds_read_b64_tr_b16 v[168:169], v121 offset:15360
  ds_read_b64_tr_b16 v[170:171], v121 offset:15872
  v_mfma_f32_16x16x32_bf16 v[40:43], a[32:35], v[172:175], v[40:43]
  buffer_load_dwordx4 v249, s[52:55], s50 offen offset:1024 lds
  v_mfma_f32_16x16x32_bf16 v[88:91], a[36:39], v[172:175], v[88:91]
  ds_read_b64_tr_b16 v[172:173], v122 offset:15360
  ds_read_b64_tr_b16 v[174:175], v122 offset:15872
  v_mfma_f32_16x16x32_bf16 v[44:47], a[32:35], v[176:179], v[44:47]
  v_mfma_f32_16x16x32_bf16 v[92:95], a[36:39], v[176:179], v[92:95]
  s_waitcnt vmcnt(22) lgkmcnt(10)
  s_barrier
  v_mfma_f32_16x16x32_bf16 v[96:99], v[180:183], v[188:191], v[96:99]
  ds_read_b64_tr_b16 v[176:177], v123 offset:15360
  s_add_u32 m0, s51, 49152
  v_mfma_f32_16x16x32_bf16 v[100:103], v[188:191], v[184:187], v[100:103]
  ds_read_b64_tr_b16 v[178:179], v123 offset:15872
  s_add_u32 s50, s98, 786432
  v_mfma_f32_16x16x32_bf16 v[0:3], v[132:135], a[40:43], v[0:3]
  ds_read_b64_tr_b16 v[180:181], v124 offset:27648
  s_bitset0_b32 s50, 21
  v_mfma_f32_16x16x32_bf16 v[48:51], v[132:135], a[44:47], v[48:51]
  ds_read_b64_tr_b16 v[182:183], v124 offset:28160
  buffer_load_dwordx4 v248, s[52:55], s50 offen lds
  v_mfma_f32_16x16x32_bf16 v[4:7], v[136:139], a[40:43], v[4:7]
  ds_read_b128 v[188:191], v125 offset:38912
  ds_read_b64_tr_b16 v[184:185], v124 offset:28672
  ds_read_b64_tr_b16 v[186:187], v124 offset:29184
  v_mfma_f32_16x16x32_bf16 v[52:55], v[136:139], a[44:47], v[52:55]
  buffer_load_dwordx4 v249, s[52:55], s50 offen offset:1024 lds
  v_mfma_f32_16x16x32_bf16 v[8:11], v[140:143], a[40:43], v[8:11]
  ds_read_b64_tr_b16 v[132:133], v120 offset:26624
  ds_read_b64_tr_b16 v[134:135], v120 offset:27136
  s_add_u32 m0, s51, 57344
  v_mfma_f32_16x16x32_bf16 v[56:59], v[140:143], a[44:47], v[56:59]
  ds_read_b64_tr_b16 v[136:137], v121 offset:26624
  s_add_u32 s50, s98, 917504
  v_mfma_f32_16x16x32_bf16 v[12:15], v[144:147], a[40:43], v[12:15]
  ds_read_b64_tr_b16 v[138:139], v121 offset:27136
  ds_read_b64_tr_b16 v[140:141], v122 offset:26624
  v_mfma_f32_16x16x32_bf16 v[60:63], v[144:147], a[44:47], v[60:63]
  ds_read_b64_tr_b16 v[142:143], v122 offset:27136
  s_bitset0_b32 s50, 21
  v_mfma_f32_16x16x32_bf16 v[16:19], v[148:151], a[40:43], v[16:19]
  buffer_load_dwordx4 v248, s[52:55], s50 offen lds
  v_mfma_f32_16x16x32_bf16 v[64:67], v[148:151], a[44:47], v[64:67]
  buffer_load_dwordx4 v249, s[52:55], s50 offen offset:1024 lds
  v_mfma_f32_16x16x32_bf16 v[20:23], v[152:155], a[40:43], v[20:23]
  ds_read_b64_tr_b16 v[144:145], v123 offset:26624
  ds_read_b64_tr_b16 v[146:147], v123 offset:27136
  v_mfma_f32_16x16x32_bf16 v[68:71], v[152:155], a[44:47], v[68:71]
  ds_read_b64_tr_b16 v[148:149], v120 offset:27648
  s_mov_b32 s56, s26
  s_waitcnt lgkmcnt(10)
  v_mfma_f32_16x16x32_bf16 v[24:27], v[156:159], a[40:43], v[24:27]
  ds_read_b64_tr_b16 v[150:151], v120 offset:28160
  s_mov_b32 s57, s27
  v_mfma_f32_16x16x32_bf16 v[72:75], v[156:159], a[44:47], v[72:75]
  ds_read_b64_tr_b16 v[152:153], v121 offset:27648
  s_mov_b32 s58, 0x400000
  v_mfma_f32_16x16x32_bf16 v[28:31], v[160:163], a[40:43], v[28:31]
  ds_read_b64_tr_b16 v[154:155], v121 offset:28160
  ds_read_b64_tr_b16 v[156:157], v122 offset:27648
  v_mfma_f32_16x16x32_bf16 v[76:79], v[160:163], a[44:47], v[76:79]
  ds_read_b64_tr_b16 v[158:159], v122 offset:28160
  s_mov_b32 s59, 0x20000
  v_mfma_f32_16x16x32_bf16 v[32:35], a[40:43], v[164:167], v[32:35]
  ds_read_b64_tr_b16 v[160:161], v123 offset:27648
  s_mov_b32 s33, 0x8000
  v_mfma_f32_16x16x32_bf16 v[80:83], a[44:47], v[164:167], v[80:83]
  buffer_load_dwordx4 a[240:243], v128, s[56:59], 0 offen offset:0
  v_mfma_f32_16x16x32_bf16 v[36:39], a[40:43], v[168:171], v[36:39]
  ds_read_b64_tr_b16 v[162:163], v123 offset:28160
  ds_read_b64_tr_b16 v[164:165], v120 offset:28672
  v_mfma_f32_16x16x32_bf16 v[84:87], a[44:47], v[168:171], v[84:87]
  buffer_load_dwordx4 a[244:247], v128, s[56:59], 0 offen offset:64
  v_mfma_f32_16x16x32_bf16 v[40:43], a[40:43], v[172:175], v[40:43]
  ds_read_b64_tr_b16 v[166:167], v120 offset:29184
  buffer_load_dwordx4 a[248:251], v128, s[56:59], s33 offen offset:0
  v_mfma_f32_16x16x32_bf16 v[88:91], a[44:47], v[172:175], v[88:91]
  buffer_load_dwordx4 a[252:255], v128, s[56:59], s33 offen offset:64
  v_mfma_f32_16x16x32_bf16 v[44:47], a[40:43], v[176:179], v[44:47]
  ds_read_b64_tr_b16 v[168:169], v121 offset:28672
  ds_read_b64_tr_b16 v[170:171], v121 offset:29184
  v_mfma_f32_16x16x32_bf16 v[92:95], a[44:47], v[176:179], v[92:95]
  s_waitcnt vmcnt(24) lgkmcnt(10)
  s_barrier
  v_mfma_f32_16x16x32_bf16 v[96:99], v[180:183], v[188:191], v[96:99]
  ds_read_b64_tr_b16 v[172:173], v122 offset:28672
  ds_read_b64_tr_b16 v[174:175], v122 offset:29184
  s_add_u32 m0, s51, 65536
  v_mfma_f32_16x16x32_bf16 v[100:103], v[188:191], v[184:187], v[100:103]
  ds_read_b64_tr_b16 v[176:177], v123 offset:28672
  ds_read_b64_tr_b16 v[178:179], v123 offset:29184
  v_mfma_f32_16x16x32_bf16 v[0:3], v[132:135], a[48:51], v[0:3]
  ds_read_b64_tr_b16 v[180:181], v124 offset:40960
  ds_read_b64_tr_b16 v[182:183], v124 offset:41472
  v_mfma_f32_16x16x32_bf16 v[48:51], v[132:135], a[52:55], v[48:51]
  ds_read_b128 v[188:191], v125 offset:52224
  ds_read_b64_tr_b16 v[184:185], v124 offset:41984
  v_mfma_f32_16x16x32_bf16 v[4:7], v[136:139], a[48:51], v[4:7]
  ds_read_b64_tr_b16 v[186:187], v124 offset:42496
  ds_read_b64_tr_b16 v[132:133], v120 offset:39936
  v_mfma_f32_16x16x32_bf16 v[52:55], v[136:139], a[52:55], v[52:55]
  ds_read_b64_tr_b16 v[134:135], v120 offset:40448
  s_add_u32 s50, s98, 1048576
  v_mfma_f32_16x16x32_bf16 v[8:11], v[140:143], a[48:51], v[8:11]
  ds_read_b64_tr_b16 v[136:137], v121 offset:39936
  ds_read_b64_tr_b16 v[138:139], v121 offset:40448
  v_mfma_f32_16x16x32_bf16 v[56:59], v[140:143], a[52:55], v[56:59]
  ds_read_b64_tr_b16 v[140:141], v122 offset:39936
  ds_read_b64_tr_b16 v[142:143], v122 offset:40448
  v_mfma_f32_16x16x32_bf16 v[12:15], v[144:147], a[48:51], v[12:15]
  v_mfma_f32_16x16x32_bf16 v[60:63], v[144:147], a[52:55], v[60:63]
  ds_read_b64_tr_b16 v[144:145], v123 offset:39936
  ds_read_b64_tr_b16 v[146:147], v123 offset:40448
  v_mfma_f32_16x16x32_bf16 v[16:19], v[148:151], a[48:51], v[16:19]
  s_bitset0_b32 s50, 21
  v_mfma_f32_16x16x32_bf16 v[64:67], v[148:151], a[52:55], v[64:67]
  ds_read_b64_tr_b16 v[148:149], v120 offset:40960
  ds_read_b64_tr_b16 v[150:151], v120 offset:41472
  s_waitcnt lgkmcnt(10)
  v_mfma_f32_16x16x32_bf16 v[20:23], v[152:155], a[48:51], v[20:23]
  v_mfma_f32_16x16x32_bf16 v[68:71], v[152:155], a[52:55], v[68:71]
  ds_read_b64_tr_b16 v[152:153], v121 offset:40960
  ds_read_b64_tr_b16 v[154:155], v121 offset:41472
  v_mfma_f32_16x16x32_bf16 v[24:27], v[156:159], a[48:51], v[24:27]
  v_mfma_f32_16x16x32_bf16 v[72:75], v[156:159], a[52:55], v[72:75]
  buffer_load_dwordx4 v248, s[52:55], s50 offen lds
  v_mfma_f32_16x16x32_bf16 v[28:31], v[160:163], a[48:51], v[28:31]
  ds_read_b64_tr_b16 v[156:157], v122 offset:40960
  ds_read_b64_tr_b16 v[158:159], v122 offset:41472
  v_mfma_f32_16x16x32_bf16 v[76:79], v[160:163], a[52:55], v[76:79]
  ds_read_b64_tr_b16 v[160:161], v123 offset:40960
  ds_read_b64_tr_b16 v[162:163], v123 offset:41472
  v_mfma_f32_16x16x32_bf16 v[32:35], a[48:51], v[164:167], v[32:35]
  v_mfma_f32_16x16x32_bf16 v[80:83], a[52:55], v[164:167], v[80:83]
  ds_read_b64_tr_b16 v[164:165], v120 offset:41984
  ds_read_b64_tr_b16 v[166:167], v120 offset:42496
  v_mfma_f32_16x16x32_bf16 v[36:39], a[48:51], v[168:171], v[36:39]
  buffer_load_dwordx4 v249, s[52:55], s50 offen offset:1024 lds
  v_mfma_f32_16x16x32_bf16 v[84:87], a[52:55], v[168:171], v[84:87]
  ds_read_b64_tr_b16 v[168:169], v121 offset:41984
  ds_read_b64_tr_b16 v[170:171], v121 offset:42496
  v_mfma_f32_16x16x32_bf16 v[40:43], a[48:51], v[172:175], v[40:43]
  v_mfma_f32_16x16x32_bf16 v[88:91], a[52:55], v[172:175], v[88:91]
  ds_read_b64_tr_b16 v[172:173], v122 offset:41984
  ds_read_b64_tr_b16 v[174:175], v122 offset:42496
  v_mfma_f32_16x16x32_bf16 v[44:47], a[48:51], v[176:179], v[44:47]
  v_mfma_f32_16x16x32_bf16 v[92:95], a[52:55], v[176:179], v[92:95]
  s_waitcnt vmcnt(26) lgkmcnt(10)
  s_barrier
  v_mfma_f32_16x16x32_bf16 v[96:99], v[180:183], v[188:191], v[96:99]
  ds_read_b64_tr_b16 v[176:177], v123 offset:41984
  s_add_u32 m0, s51, 73728
  v_mfma_f32_16x16x32_bf16 v[100:103], v[188:191], v[184:187], v[100:103]
  ds_read_b64_tr_b16 v[178:179], v123 offset:42496
  s_add_u32 s50, s98, 1179648
  v_mfma_f32_16x16x32_bf16 v[0:3], v[132:135], a[56:59], v[0:3]
  v_mfma_f32_16x16x32_bf16 v[48:51], v[132:135], a[60:63], v[48:51]
  s_bitset0_b32 s50, 21
  v_mfma_f32_16x16x32_bf16 v[4:7], v[136:139], a[56:59], v[4:7]
  v_mfma_f32_16x16x32_bf16 v[52:55], v[136:139], a[60:63], v[52:55]
  buffer_load_dwordx4 v248, s[52:55], s50 offen lds
  v_mfma_f32_16x16x32_bf16 v[8:11], v[140:143], a[56:59], v[8:11]
  buffer_load_dwordx4 v249, s[52:55], s50 offen offset:1024 lds
  v_mfma_f32_16x16x32_bf16 v[56:59], v[140:143], a[60:63], v[56:59]
  v_mfma_f32_16x16x32_bf16 v[12:15], v[144:147], a[56:59], v[12:15]
  s_add_u32 m0, s51, 81920
  v_mfma_f32_16x16x32_bf16 v[60:63], v[144:147], a[60:63], v[60:63]
  v_mfma_f32_16x16x32_bf16 v[16:19], v[148:151], a[56:59], v[16:19]
  s_add_u32 s50, s98, 1310720
  v_mfma_f32_16x16x32_bf16 v[64:67], v[148:151], a[60:63], v[64:67]
  s_bitset0_b32 s50, 21
  v_mfma_f32_16x16x32_bf16 v[20:23], v[152:155], a[56:59], v[20:23]
  v_mfma_f32_16x16x32_bf16 v[68:71], v[152:155], a[60:63], v[68:71]
  buffer_load_dwordx4 v248, s[52:55], s50 offen lds
  s_waitcnt lgkmcnt(10)
  v_mfma_f32_16x16x32_bf16 v[24:27], v[156:159], a[56:59], v[24:27]
  v_mfma_f32_16x16x32_bf16 v[72:75], v[156:159], a[60:63], v[72:75]
  buffer_load_dwordx4 v249, s[52:55], s50 offen offset:1024 lds
  s_waitcnt lgkmcnt(8)
  v_mfma_f32_16x16x32_bf16 v[28:31], v[160:163], a[56:59], v[28:31]
  s_lshl_b32 s34, s37, 8
  v_mfma_f32_16x16x32_bf16 v[76:79], v[160:163], a[60:63], v[76:79]
  s_waitcnt lgkmcnt(6)
  v_mfma_f32_16x16x32_bf16 v[32:35], a[56:59], v[164:167], v[32:35]
  s_lshl_b32 s33, s3, 12
  v_mfma_f32_16x16x32_bf16 v[80:83], a[60:63], v[164:167], v[80:83]
  s_waitcnt lgkmcnt(4)
  v_mfma_f32_16x16x32_bf16 v[36:39], a[56:59], v[168:171], v[36:39]
  s_add_u32 s34, s34, s33
  v_mfma_f32_16x16x32_bf16 v[84:87], a[60:63], v[168:171], v[84:87]
  s_add_u32 s68, s34, 8192
  s_waitcnt lgkmcnt(2)
  v_mfma_f32_16x16x32_bf16 v[40:43], a[56:59], v[172:175], v[40:43]
  v_mfma_f32_16x16x32_bf16 v[88:91], a[60:63], v[172:175], v[88:91]
  buffer_load_dwordx4 v[250:253], v254, s[12:15], s68 offen sc1
  s_waitcnt lgkmcnt(0)
  v_mfma_f32_16x16x32_bf16 v[44:47], a[56:59], v[176:179], v[44:47]
  v_mfma_f32_16x16x32_bf16 v[92:95], a[60:63], v[176:179], v[92:95]
  s_nop 7
  s_nop 1
L_att:
  s_add_u32 s4, s20, 0x600000
  s_addc_u32 s5, s21, 0
  s_mov_b32 s6, 0x400000
  s_mov_b32 s7, 0x20000
  s_lshl_b32 s33, s3, 12
  s_add_u32 s33, s33, 139264
  v_add_u32 v110, s33, v119
  s_lshr_b32 s33, s3, 1
  s_lshl_b32 s33, s33, 10
  s_and_b32 s34, s3, 1
  s_lshl_b32 s34, s34, 3
  s_add_u32 s33, s33, s34
  s_add_u32 s33, s33, 139264
  v_add_u32 v111, s33, v119
  v_cvt_pk_bf16_f32 v196, v96, v97
  v_cvt_pk_bf16_f32 v197, v98, v99
  v_cvt_pk_bf16_f32 v198, v100, v101
  v_cvt_pk_bf16_f32 v199, v102, v103
  v_cvt_pk_bf16_f32 v164, v64, v65
  v_cvt_pk_bf16_f32 v165, v66, v67
  v_cvt_pk_bf16_f32 v176, v80, v81
  v_cvt_pk_bf16_f32 v177, v82, v83
  v_cvt_pk_bf16_f32 v166, v68, v69
  v_cvt_pk_bf16_f32 v167, v70, v71
  v_cvt_pk_bf16_f32 v182, v84, v85
  v_cvt_pk_bf16_f32 v183, v86, v87
  v_cvt_pk_bf16_f32 v168, v72, v73
  v_cvt_pk_bf16_f32 v169, v74, v75
  v_cvt_pk_bf16_f32 v188, v88, v89
  v_cvt_pk_bf16_f32 v189, v90, v91
  v_cvt_pk_bf16_f32 v170, v76, v77
  v_cvt_pk_bf16_f32 v171, v78, v79
  v_cvt_pk_bf16_f32 v194, v92, v93
  v_cvt_pk_bf16_f32 v195, v94, v95
  ds_write_b64 v111, v[196:197]
  ds_write_b64 v111, v[198:199] offset:2048
  ds_write_b128 v110, v[164:167] offset:4096
  ds_write_b64 v110, v[176:177] offset:6144
  ds_write_b64 v110, v[182:183] offset:6152
  ds_write_b128 v110, v[168:171] offset:5120
  ds_write_b64 v110, v[188:189] offset:7168
  ds_write_b64 v110, v[194:195] offset:7176
  v_cvt_pk_bf16_f32 v132, v0, v1
  v_cvt_pk_bf16_f32 v133, v2, v3
  v_cvt_pk_bf16_f32 v140, v48, v49
  v_cvt_pk_bf16_f32 v141, v50, v51
  v_cvt_pk_bf16_f32 v156, v16, v17
  v_cvt_pk_bf16_f32 v157, v18, v19
  v_cvt_pk_bf16_f32 v174, v32, v33
  v_cvt_pk_bf16_f32 v175, v34, v35
  v_cvt_pk_bf16_f32 v134, v4, v5
  v_cvt_pk_bf16_f32 v135, v6, v7
  v_cvt_pk_bf16_f32 v142, v52, v53
  v_cvt_pk_bf16_f32 v143, v54, v55
  v_cvt_pk_bf16_f32 v158, v20, v21
  v_cvt_pk_bf16_f32 v159, v22, v23
  v_cvt_pk_bf16_f32 v180, v36, v37
  v_cvt_pk_bf16_f32 v181, v38, v39
  v_cvt_pk_bf16_f32 v136, v8, v9
  v_cvt_pk_bf16_f32 v137, v10, v11
  v_cvt_pk_bf16_f32 v144, v56, v57
  v_cvt_pk_bf16_f32 v145, v58, v59
  v_cvt_pk_bf16_f32 v160, v24, v25
  v_cvt_pk_bf16_f32 v161, v26, v27
  v_cvt_pk_bf16_f32 v186, v40, v41
  v_cvt_pk_bf16_f32 v187, v42, v43
  v_cvt_pk_bf16_f32 v138, v12, v13
  v_cvt_pk_bf16_f32 v139, v14, v15
  v_cvt_pk_bf16_f32 v146, v60, v61
  v_cvt_pk_bf16_f32 v147, v62, v63
  v_cvt_pk_bf16_f32 v162, v28, v29
  v_cvt_pk_bf16_f32 v163, v30, v31
  v_cvt_pk_bf16_f32 v192, v44, v45
  v_cvt_pk_bf16_f32 v193, v46, v47
  s_waitcnt lgkmcnt(0)
  s_barrier
  ds_read_b128 v[148:151], v110 offset:0
  ds_read_b64 v[172:173], v110 offset:2048
  ds_read_b64 v[178:179], v110 offset:2056
  ds_read_b128 v[152:155], v110 offset:1024
  ds_read_b64 v[184:185], v110 offset:3072
  ds_read_b64 v[190:191], v110 offset:3080
  s_add_u32 m0, s51, 90112
  s_add_u32 s50, s98, 1441792
  s_bitset0_b32 s50, 21
  buffer_load_dwordx4 v248, s[52:55], s50 offen lds
  buffer_load_dwordx4 v249, s[52:55], s50 offen offset:1024 lds
  s_add_u32 m0, s51, 98304
  s_add_u32 s50, s98, 1572864
  s_bitset0_b32 s50, 21
  buffer_load_dwordx4 v248, s[52:55], s50 offen lds
  buffer_load_dwordx4 v249, s[52:55], s50 offen offset:1024 lds
  v_mfma_f32_16x16x32_bf16 v[200:203], v[156:159], v[140:143], 0
  v_mfma_f32_16x16x32_bf16 v[204:207], v[164:167], v[140:143], 0
  v_mfma_f32_16x16x32_bf16 v[208:211], v[160:163], v[144:147], 0
  v_mfma_f32_16x16x32_bf16 v[212:215], v[168:171], v[144:147], 0
  s_or_b32 s33, s30, s3
  s_cmp_eq_u32 s33, 0
  s_cselect_b32 s33, 0xf149f2ca, 0
  v_mov_b32 v232, s33
  v_cndmask_b32_e64 v120, v232, 0, s[44:45]
  v_cndmask_b32_e64 v121, v232, 0, s[46:47]
  v_and_b32 v122, 1, v104
  v_lshlrev_b32 v122, 4, v122
  s_waitcnt lgkmcnt(0)
  v_mfma_f32_16x16x32_bf16 v[216:219], v[148:151], v[132:135], 0
  v_mfma_f32_16x16x32_bf16 v[220:223], v[156:159], v[132:135], 0
  v_mfma_f32_16x16x32_bf16 v[224:227], v[152:155], v[136:139], 0
  v_mfma_f32_16x16x32_bf16 v[228:231], v[160:163], v[136:139], 0
  s_mov_b32 s40, 0x3e8293ee
  v_cndmask_b32_e64 v200, v200, v201, s[48:49]
  v_cndmask_b32_e64 v202, v202, v203, s[48:49]
  v_cndmask_b32_e64 v204, v204, v205, s[48:49]
  v_cndmask_b32_e64 v206, v206, v207, s[48:49]
  v_cndmask_b32_e64 v208, v208, v209, s[48:49]
  v_cndmask_b32_e64 v210, v210, v211, s[48:49]
  v_cndmask_b32_e64 v212, v212, v213, s[48:49]
  v_cndmask_b32_e64 v214, v214, v215, s[48:49]
  v_cndmask_b32_e64 v216, v216, v217, s[48:49]
  v_cndmask_b32_e64 v218, v218, v219, s[48:49]
  v_cndmask_b32_e64 v220, v220, v221, s[48:49]
  v_cndmask_b32_e64 v222, v222, v223, s[48:49]
  v_cndmask_b32_e64 v224, v224, v225, s[48:49]
  v_cndmask_b32_e64 v226, v226, v227, s[48:49]
  v_cndmask_b32_e64 v228, v228, v229, s[48:49]
  v_cndmask_b32_e64 v230, v230, v231, s[48:49]
  v_cndmask_b32_e64 v200, v200, v204, s[44:45]
  v_cndmask_b32_e64 v201, v202, v206, s[46:47]
  v_cndmask_b32_e64 v208, v208, v212, s[44:45]
  v_cndmask_b32_e64 v209, v210, v214, s[46:47]
  v_cndmask_b32_e64 v216, v216, v220, s[44:45]
  v_cndmask_b32_e64 v217, v218, v222, s[46:47]
  v_cndmask_b32_e64 v224, v224, v228, s[44:45]
  v_cndmask_b32_e64 v225, v226, v230, s[46:47]
  v_mul_f32 v200, s40, v200
  v_mul_f32 v201, s40, v201
  v_mul_f32 v208, s40, v208
  v_mul_f32 v209, s40, v209
  v_fma_f32 v216, v216, s40, v120
  v_fma_f32 v217, v217, s40, v121
  v_fma_f32 v224, v224, s40, v120
  v_fma_f32 v225, v225, s40, v121
  v_max_f32 v232, v200, v201
  v_max_f32 v233, v208, v209
  v_max_f32 v234, v216, v217
  v_max_f32 v235, v224, v225
  v_mov_b32 v236, v232
  v_mov_b32 v237, v233
  v_mov_b32 v238, v234
  v_mov_b32 v239, v235
  s_nop 1
  v_permlane16_swap_b32 v236, v232
  v_permlane16_swap_b32 v237, v233
  v_permlane16_swap_b32 v238, v234
  v_permlane16_swap_b32 v239, v235
  s_nop 1
  v_max_f32 v232, v232, v236
  v_max_f32 v233, v233, v237
  v_max_f32 v234, v234, v238
  v_max_f32 v235, v235, v239
  v_mov_b32 v236, v232
  v_mov_b32 v237, v233
  v_mov_b32 v238, v234
  v_mov_b32 v239, v235
  s_nop 1
  v_permlane32_swap_b32 v236, v232
  v_permlane32_swap_b32 v237, v233
  v_permlane32_swap_b32 v238, v234
  v_permlane32_swap_b32 v239, v235
  s_nop 1
  v_max_f32 v232, v232, v236
  v_max_f32 v233, v233, v237
  v_max_f32 v234, v234, v238
  v_max_f32 v235, v235, v239
  v_sub_f32 v200, v200, v232
  v_sub_f32 v201, v201, v232
  v_sub_f32 v208, v208, v233
  v_sub_f32 v209, v209, v233
  v_sub_f32 v216, v216, v234
  v_sub_f32 v217, v217, v234
  v_sub_f32 v224, v224, v235
  v_sub_f32 v225, v225, v235
  v_exp_f32 v200, v200
  v_exp_f32 v201, v201
  v_exp_f32 v208, v208
  v_exp_f32 v209, v209
  v_exp_f32 v216, v216
  v_exp_f32 v217, v217
  v_exp_f32 v224, v224
  v_exp_f32 v225, v225
  s_nop 0
  v_add_f32 v232, v200, v201
  v_add_f32 v233, v208, v209
  v_add_f32 v234, v216, v217
  v_add_f32 v235, v224, v225
  v_mov_b32 v236, v232
  v_mov_b32 v237, v233
  v_mov_b32 v238, v234
  v_mov_b32 v239, v235
  s_nop 1
  v_permlane16_swap_b32 v236, v232
  v_permlane16_swap_b32 v237, v233
  v_permlane16_swap_b32 v238, v234
  v_permlane16_swap_b32 v239, v235
  s_nop 1
  v_add_f32 v232, v232, v236
  v_add_f32 v233, v233, v237
  v_add_f32 v234, v234, v238
  v_add_f32 v235, v235, v239
  v_mov_b32 v236, v232
  v_mov_b32 v237, v233
  v_mov_b32 v238, v234
  v_mov_b32 v239, v235
  s_nop 1
  v_permlane32_swap_b32 v236, v232
  v_permlane32_swap_b32 v237, v233
  v_permlane32_swap_b32 v238, v234
  v_permlane32_swap_b32 v239, v235
  s_nop 1
  v_add_f32 v232, v232, v236
  v_add_f32 v233, v233, v237
  v_add_f32 v234, v234, v238
  v_add_f32 v235, v235, v239
  v_rcp_f32 v232, v232
  v_rcp_f32 v233, v233
  v_rcp_f32 v234, v234
  v_rcp_f32 v235, v235
  s_nop 0
  v_mul_f32 v200, v200, v232
  v_mul_f32 v201, v201, v232
  v_mul_f32 v208, v208, v233
  v_mul_f32 v209, v209, v233
  v_mul_f32 v216, v216, v234
  v_mul_f32 v217, v217, v234
  v_mul_f32 v224, v224, v235
  v_mul_f32 v225, v225, v235
  v_cvt_pk_bf16_f32 v200, v200, 0
  v_cvt_pk_bf16_f32 v201, v201, 0
  v_cvt_pk_bf16_f32 v208, v208, 0
  v_cvt_pk_bf16_f32 v209, v209, 0
  v_cvt_pk_bf16_f32 v216, v216, 0
  v_cvt_pk_bf16_f32 v217, v217, 0
  v_cvt_pk_bf16_f32 v224, v224, 0
  v_cvt_pk_bf16_f32 v225, v225, 0
  v_lshlrev_b32 v200, v122, v200
  v_lshlrev_b32 v201, v122, v201
  v_lshlrev_b32 v208, v122, v208
  v_lshlrev_b32 v209, v122, v209
  v_lshlrev_b32 v216, v122, v216
  v_lshlrev_b32 v217, v122, v217
  v_lshlrev_b32 v224, v122, v224
  v_lshlrev_b32 v225, v122, v225
  v_cndmask_b32_e64 v132, v200, 0, s[44:45]
  v_cndmask_b32_e64 v134, 0, v200, s[44:45]
  v_cndmask_b32_e64 v133, v201, 0, s[46:47]
  v_cndmask_b32_e64 v135, 0, v201, s[46:47]
  v_cndmask_b32_e64 v136, v208, 0, s[44:45]
  v_cndmask_b32_e64 v138, 0, v208, s[44:45]
  v_cndmask_b32_e64 v137, v209, 0, s[46:47]
  v_cndmask_b32_e64 v139, 0, v209, s[46:47]
  v_cndmask_b32_e64 v140, v216, 0, s[44:45]
  v_cndmask_b32_e64 v142, 0, v216, s[44:45]
  v_cndmask_b32_e64 v141, v217, 0, s[46:47]
  v_cndmask_b32_e64 v143, 0, v217, s[46:47]
  v_cndmask_b32_e64 v144, v224, 0, s[44:45]
  v_cndmask_b32_e64 v146, 0, v224, s[44:45]
  v_cndmask_b32_e64 v145, v225, 0, s[46:47]
  v_cndmask_b32_e64 v147, 0, v225, s[46:47]
  s_nop 1
  v_mfma_f32_16x16x32_bf16 v[200:203], v[174:177], v[132:135], 0
  v_mfma_f32_16x16x32_bf16 v[204:207], v[180:183], v[132:135], 0
  v_mfma_f32_16x16x32_bf16 v[208:211], v[186:189], v[136:139], 0
  v_mfma_f32_16x16x32_bf16 v[212:215], v[192:195], v[136:139], 0
  v_mfma_f32_16x16x32_bf16 v[216:219], v[172:175], v[140:143], 0
  v_mfma_f32_16x16x32_bf16 v[220:223], v[178:181], v[140:143], 0
  v_mfma_f32_16x16x32_bf16 v[224:227], v[184:187], v[144:147], 0
  v_mfma_f32_16x16x32_bf16 v[228:231], v[190:193], v[144:147], 0
  s_lshl_b32 s41, s31, 18
  s_add_u32 s42, s41, 131072
  s_nop 1
  v_cvt_pk_bf16_f32 v148, v200, v201
  v_cvt_pk_bf16_f32 v149, v202, v203
  v_cvt_pk_bf16_f32 v150, v204, v205
  v_cvt_pk_bf16_f32 v151, v206, v207
  buffer_store_dwordx4 v[148:151], v105, s[4:7], s41 offen offset:1024 sc1
  v_cvt_pk_bf16_f32 v152, v208, v209
  v_cvt_pk_bf16_f32 v153, v210, v211
  v_cvt_pk_bf16_f32 v154, v212, v213
  v_cvt_pk_bf16_f32 v155, v214, v215
  buffer_store_dwordx4 v[152:155], v105, s[4:7], s42 offen offset:1024 sc1
  v_cvt_pk_bf16_f32 v156, v216, v217
  v_cvt_pk_bf16_f32 v157, v218, v219
  v_cvt_pk_bf16_f32 v158, v220, v221
  v_cvt_pk_bf16_f32 v159, v222, v223
  buffer_store_dwordx4 v[156:159], v105, s[4:7], s41 offen offset:0 sc1
  s_nop 0
  v_cvt_pk_bf16_f32 v160, v224, v225
  v_cvt_pk_bf16_f32 v161, v226, v227
  v_cvt_pk_bf16_f32 v162, v228, v229
  v_cvt_pk_bf16_f32 v163, v230, v231
  buffer_store_dwordx4 v[160:163], v105, s[4:7], s42 offen offset:0 sc1
  s_lshl_b32 s69, s30, 2
  s_add_u32 s69, s69, s3
  s_lshl_b32 s69, s69, 4
  s_add_u32 s69, s69, s31
  s_add_u32 s69, s69, 1024
  s_lshl_b32 s69, s69, 6
  s_mov_b32 s30, s36
  s_mov_b32 s31, s37
  v_mov_b32 v32, v104
  v_mov_b32 v231, v104
  v_mov_b32 v43, v128
  v_and_b32 v44, 15, v32
  s_lshl_b32 s32, s30, 13
  s_lshl_b32 s33, s3, 11
  s_add_u32 s32, s32, s33
  v_lshlrev_b32 v80, 4, v32
  v_add_u32 v33, s32, v80
  v_add_u32 v34, 131072, v33
  s_lshl_b32 s16, s98, 1
  s_lshl_b32 s32, s30, 2
  s_add_u32 s32, s32, s3
  s_lshl_b32 s32, s32, 4
  s_add_u32 s32, s32, 1024
  v_add_u32 v45, s32, v44
  v_lshlrev_b32 v45, 6, v45
  v_mov_b32 v158, s19
  v_mov_b32 v159, s19
  v_lshlrev_b32 v46, 2, v32
  s_bfe_u32 s48, s19, 0x80000
  s_bfe_u32 s49, s19, 0x80008
  s_bfe_u32 s50, s19, 0x80010
  s_bfe_u32 s51, s19, 0x80018
  s_mov_b32 s92, s30
  s_mov_b32 s93, s31
  s_and_b32 s28, s2, 7
  s_lshr_b32 s29, s2, 3
  s_and_b32 s30, s28, 1
  s_lshl_b32 s30, s30, 2
  s_and_b32 s31, s29, 3
  s_add_u32 s30, s30, s31
  s_lshr_b32 s31, s28, 1
  s_lshl_b32 s31, s31, 3
  s_lshr_b32 s29, s29, 2
  s_add_u32 s31, s31, s29
  s_lshl_b32 s32, s30, 14
  s_lshl_b32 s33, s3, 12
  s_add_u32 s32, s32, s33
  v_lshlrev_b32 v224, 4, v231
  v_add_u32 v224, s32, v224
  s_and_b32 s33, s3, 1
  s_mul_i32 s34, s33, 114688
  s_mul_i32 s35, s31, 224
  s_add_u32 s34, s34, s35
  s_movk_i32 s36, 4682
  s_movk_i32 s37, 7168
  s_and_b32 s39, s31, 1
  s_lshl_b32 s39, s39, 1
  v_add_u32 v234, 0, v231
  v_mul_u32_u24 v235, s36, v234
  v_lshrrev_b32 v235, 16, v235
  v_mul_u32_u24 v236, 14, v235
  v_sub_u32 v236, v234, v236
  v_add_u32 v236, s39, v236
  v_subrev_u32 v237, 14, v236
  v_min_u32 v236, v236, v237
  v_mul_u32_u24 v235, s37, v235
  v_lshl_add_u32 v235, v236, 4, v235
  v_add_u32 v235, s34, v235
  v_subrev_u32 v225, 0, v235
  v_add_u32 v234, 64, v231
  v_mul_u32_u24 v235, s36, v234
  v_lshrrev_b32 v235, 16, v235
  v_mul_u32_u24 v236, 14, v235
  v_sub_u32 v236, v234, v236
  v_add_u32 v236, s39, v236
  v_subrev_u32 v237, 14, v236
  v_min_u32 v236, v236, v237
  v_mul_u32_u24 v235, s37, v235
  v_lshl_add_u32 v235, v236, 4, v235
  v_add_u32 v235, s34, v235
  v_subrev_u32 v226, 1024, v235
  v_add_u32 v234, 128, v231
  v_mul_u32_u24 v235, s36, v234
  v_lshrrev_b32 v235, 16, v235
  v_mul_u32_u24 v236, 14, v235
  v_sub_u32 v236, v234, v236
  v_add_u32 v236, s39, v236
  v_subrev_u32 v237, 14, v236
  v_min_u32 v236, v236, v237
  v_mul_u32_u24 v235, s37, v235
  v_lshl_add_u32 v235, v236, 4, v235
  v_add_u32 v235, s34, v235
  v_subrev_u32 v227, 2048, v235
  v_add_u32 v234, 192, v231
  v_mul_u32_u24 v235, s36, v234
  v_lshrrev_b32 v235, 16, v235
  v_mul_u32_u24 v236, 14, v235
  v_sub_u32 v236, v234, v236
  v_add_u32 v236, s39, v236
  v_subrev_u32 v237, 14, v236
  v_min_u32 v236, v236, v237
  v_mul_u32_u24 v235, s37, v235
  v_lshl_add_u32 v235, v236, 4, v235
  v_add_u32 v235, s34, v235
  v_subrev_u32 v228, 3072, v235
  s_mov_b32 s94, s30
  s_mov_b32 s95, s31
  s_mov_b32 s30, s92
  s_mov_b32 s31, s93
  s_mul_i32 s38, s3, 3584
  s_add_u32 s38, s38, 98304
  s_bfe_u32 s33, s2, 0x20003
  s_mul_i32 s17, s33, 229376
  s_cmp_eq_u32 s33, 3
  s_cselect_b32 s96, -3, 1
  s_mul_i32 s96, s96, 229376
  s_cmp_eq_u32 s33, 2
  s_cselect_b32 s97, -3, 1
  s_mul_i32 s97, s97, 229376
  s_cmp_eq_u32 s33, 1
  s_cselect_b32 s98, -3, 1
  s_mul_i32 s98, s98, 229376
  s_cmp_eq_u32 s33, 0
  s_cselect_b32 s99, 1, 5
  s_mul_i32 s99, s99, 229376
  s_cmp_lt_u32 s3, 2
  s_cselect_b32 s8, s60, s62
  s_cselect_b32 s9, s61, s63
  s_mov_b32 s10, 7340032
  s_mov_b32 s11, 0x20000
  s_waitcnt vmcnt(0)
  s_mov_b64 exec, 1
  buffer_store_dword v158, v46, s[64:67], s69 offen sc1
  s_mov_b64 exec, -1
  v_xor_b32 v168, s48, v250
  v_xor_b32 v169, s49, v251
  v_xor_b32 v170, s50, v252
  v_xor_b32 v171, s51, v253
  v_or3_b32 v172, v168, v169, v170
  v_or_b32 v172, v172, v171
  v_and_b32 v172, 0xff, v172
  v_cmp_ne_u32 vcc, 0, v172
  s_nop 1
  s_cmp_lg_u64 vcc, 0
  s_cbranch_scc1 L_vslow_11
L_vback_12:
  v_mov_b32 v172, v168
  v_mov_b32 v173, v169
  v_mov_b32 v174, v170
  v_mov_b32 v175, v171
  s_nop 1
  v_permlane16_swap_b32 v172, v168
  v_permlane16_swap_b32 v173, v169
  v_permlane16_swap_b32 v174, v170
  v_permlane16_swap_b32 v175, v171
  s_nop 1
  v_add_f32 v168, v168, v172
  v_add_f32 v169, v169, v173
  v_add_f32 v170, v170, v174
  v_add_f32 v171, v171, v175
  v_mov_b32 v172, v168
  v_mov_b32 v173, v169
  v_mov_b32 v174, v170
  v_mov_b32 v175, v171
  s_nop 1
  v_permlane32_swap_b32 v172, v168
  v_permlane32_swap_b32 v173, v169
  v_permlane32_swap_b32 v174, v170
  v_permlane32_swap_b32 v175, v171
  s_nop 1
  v_add_f32 v168, v168, v172
  v_add_f32 v169, v169, v173
  v_add_f32 v170, v170, v174
  v_add_f32 v171, v171, v175
  v_cvt_pk_bf16_f32 v172, v168, v169
  v_lshlrev_b32 v168, 16, v172
  v_and_b32 v169, 0xffff0000, v172
  v_cvt_pk_bf16_f32 v173, v170, v171
  v_lshlrev_b32 v170, 16, v173
  v_and_b32 v171, 0xffff0000, v173
  s_cmp_eq_u32 s3, 2
  s_cselect_b32 s33, 1.0, 0
  v_add_f32 v168, s33, v168
  v_add_f32 v169, s33, v169
  v_add_f32 v170, s33, v170
  v_add_f32 v171, s33, v171
  v_cvt_pk_bf16_f32 v172, v168, v169
  v_lshlrev_b32 v168, 16, v172
  v_and_b32 v169, 0xffff0000, v172
  v_cvt_pk_bf16_f32 v173, v170, v171
  v_lshlrev_b32 v170, 16, v173
  v_and_b32 v171, 0xffff0000, v173
  v_lshlrev_b32 v172, 4, v44
  s_lshl_b32 s33, s3, 8
  s_add_u32 s33, s33, 162816
  v_add_u32 v172, s33, v172
  ds_write_b128 v172, v[168:171]
  v_lshrrev_b32 v82, 2, v32
  v_lshlrev_b32 v82, 7, v82
  v_bfe_u32 v81, v32, 3, 2
  v_lshl_add_u32 v82, v81, 5, v82
  v_and_b32 v81, 3, v32
  v_lshl_add_u32 v35, v81, 3, v82
  v_xor_b32 v36, 32, v35
  v_xor_b32 v37, 64, v35
  v_xor_b32 v38, 96, v35
  v_add_u32 v39, 65536, v35
  v_add_u32 v40, 65536, v36
  v_add_u32 v41, 65536, v37
  v_add_u32 v42, 65536, v38
  v_lshrrev_b32 v47, 4, v32
  v_lshlrev_b32 v46, 4, v47
  v_add_u32 v253, 162816, v46
  s_waitcnt lgkmcnt(0)
  s_waitcnt vmcnt(63)
  s_barrier
  ds_read_b64_tr_b16 v[88:89], v35 offset:0
  ds_read_b64_tr_b16 v[90:91], v35 offset:2048
  ds_read_b64_tr_b16 v[92:93], v36 offset:0
  ds_read_b64_tr_b16 v[94:95], v36 offset:2048
  ds_read_b64_tr_b16 v[96:97], v37 offset:0
  ds_read_b64_tr_b16 v[98:99], v37 offset:2048
  ds_read_b64_tr_b16 v[100:101], v38 offset:0
  ds_read_b64_tr_b16 v[102:103], v38 offset:2048
  ds_read_b64_tr_b16 v[104:105], v35 offset:4096
  ds_read_b64_tr_b16 v[106:107], v35 offset:6144
  ds_read_b64_tr_b16 v[108:109], v36 offset:4096
  ds_read_b64_tr_b16 v[110:111], v36 offset:6144
  ds_read_b64_tr_b16 v[112:113], v37 offset:4096
  ds_read_b64_tr_b16 v[114:115], v37 offset:6144
  ds_read_b64_tr_b16 v[116:117], v38 offset:4096
  ds_read_b64_tr_b16 v[118:119], v38 offset:6144
  ds_read_b128 v[64:67], v253 offset:0
  ds_read_b128 v[68:71], v253 offset:64
  ds_read_b128 v[72:75], v253 offset:128
  ds_read_b128 v[76:79], v253 offset:192
  ds_read_b128 v[168:171], v253 offset:256
  ds_read_b128 v[172:175], v253 offset:320
  ds_read_b128 v[176:179], v253 offset:384
  ds_read_b128 v[180:183], v253 offset:448
  ds_read_b128 v[184:187], v253 offset:512
  ds_read_b128 v[188:191], v253 offset:576
  ds_read_b128 v[192:195], v253 offset:640
  ds_read_b128 v[196:199], v253 offset:704
  buffer_load_dword v87, v45, s[64:67], 0 offen sc1
  v_mov_b32 v252, v43
  v_accvgpr_read_b32 v48, a240
  v_accvgpr_read_b32 v49, a241
  v_accvgpr_read_b32 v50, a242
  v_accvgpr_read_b32 v51, a243
  v_accvgpr_read_b32 v52, a244
  v_accvgpr_read_b32 v53, a245
  v_accvgpr_read_b32 v54, a246
  v_accvgpr_read_b32 v55, a247
  v_accvgpr_read_b32 v56, a248
  v_accvgpr_read_b32 v57, a249
  v_accvgpr_read_b32 v58, a250
  v_accvgpr_read_b32 v59, a251
  v_accvgpr_read_b32 v60, a252
  v_accvgpr_read_b32 v61, a253
  v_accvgpr_read_b32 v62, a254
  v_accvgpr_read_b32 v63, a255
  s_lshl_b32 s41, s31, 18
  s_add_u32 s42, s41, 131072
  v_permlane16_swap_b32 v48, v50
  v_permlane16_swap_b32 v49, v51
  v_permlane16_swap_b32 v52, v54
  v_permlane16_swap_b32 v53, v55
  v_permlane16_swap_b32 v56, v58
  v_permlane16_swap_b32 v57, v59
  v_permlane16_swap_b32 v60, v62
  v_permlane16_swap_b32 v61, v63
  v_lshlrev_b32 v120, 16, v48
  v_and_b32 v121, 0xffff0000, v48
  v_lshlrev_b32 v122, 16, v49
  v_and_b32 v123, 0xffff0000, v49
  v_lshlrev_b32 v124, 16, v50
  v_and_b32 v125, 0xffff0000, v50
  v_lshlrev_b32 v126, 16, v51
  v_and_b32 v127, 0xffff0000, v51
  v_lshlrev_b32 v128, 16, v52
  v_and_b32 v129, 0xffff0000, v52
  v_lshlrev_b32 v130, 16, v53
  v_and_b32 v131, 0xffff0000, v53
  v_lshlrev_b32 v132, 16, v54
  v_and_b32 v133, 0xffff0000, v54
  v_lshlrev_b32 v134, 16, v55
  v_and_b32 v135, 0xffff0000, v55
  v_lshlrev_b32 v136, 16, v56
  v_and_b32 v137, 0xffff0000, v56
  v_lshlrev_b32 v138, 16, v57
  v_and_b32 v139, 0xffff0000, v57
  v_lshlrev_b32 v140, 16, v58
  v_and_b32 v141, 0xffff0000, v58
  v_lshlrev_b32 v142, 16, v59
  v_and_b32 v143, 0xffff0000, v59
  v_lshlrev_b32 v144, 16, v60
  v_and_b32 v145, 0xffff0000, v60
  v_lshlrev_b32 v146, 16, v61
  v_and_b32 v147, 0xffff0000, v61
  v_lshlrev_b32 v148, 16, v62
  v_and_b32 v149, 0xffff0000, v62
  v_lshlrev_b32 v150, 16, v63
  v_and_b32 v151, 0xffff0000, v63
  s_add_u32 s52, s20, 0x180000
  s_addc_u32 s53, s21, 0
  s_mov_b32 s54, 0x80000
  s_mov_b32 s55, 0x20000
  s_lshl2_add_u32 s56, s30, s3
  s_lshl_b32 s56, s56, 12
  s_lshl_b32 s57, s31, 8
  s_add_u32 s57, s57, s56
  v_mov_b32 v81, 0xffffff00
  s_bfe_u32 s44, s19, 0x80000
  s_bfe_u32 s45, s19, 0x80008
  s_bfe_u32 s46, s19, 0x80010
  s_bfe_u32 s47, s19, 0x80018
  s_mov_b32 s33, 262144
L_spin_15:
  s_waitcnt vmcnt(0)
  v_cmp_ne_u32 vcc, s19, v87
  s_nop 1
  s_and_b32 s32, vcc_lo, 0xffff
  s_cbranch_scc0 L_rdy_16
  buffer_load_dword v87, v45, s[64:67], 0 offen sc1
  s_sub_u32 s33, s33, 1
  s_cmp_lg_u32 s33, 0
  s_cbranch_scc1 L_spin_15
L_rdy_16:
  buffer_load_dwordx4 a[0:3], v33, s[4:7], s16 offen offset:0 sc1
  buffer_load_dwordx4 a[4:7], v33, s[4:7], s16 offen offset:1024 sc1
  buffer_load_dwordx4 a[8:11], v34, s[4:7], s16 offen offset:0 sc1
  buffer_load_dwordx4 a[12:15], v34, s[4:7], s16 offen offset:1024 sc1
  s_add_u32 s16, s16, 262144
  s_bitset0_b32 s16, 22
  buffer_load_dwordx4 a[16:19], v33, s[4:7], s16 offen offset:0 sc1
  buffer_load_dwordx4 a[20:23], v33, s[4:7], s16 offen offset:1024 sc1
  buffer_load_dwordx4 a[24:27], v34, s[4:7], s16 offen offset:0 sc1
  buffer_load_dwordx4 a[28:31], v34, s[4:7], s16 offen offset:1024 sc1
  s_add_u32 s16, s16, 262144
  s_bitset0_b32 s16, 22
  buffer_load_dwordx4 a[32:35], v33, s[4:7], s16 offen offset:0 sc1
  buffer_load_dwordx4 a[36:39], v33, s[4:7], s16 offen offset:1024 sc1
  buffer_load_dwordx4 a[40:43], v34, s[4:7], s16 offen offset:0 sc1
  buffer_load_dwordx4 a[44:47], v34, s[4:7], s16 offen offset:1024 sc1
  s_add_u32 s16, s16, 262144
  s_bitset0_b32 s16, 22
  buffer_load_dwordx4 a[48:51], v33, s[4:7], s16 offen offset:0 sc1
  buffer_load_dwordx4 a[52:55], v33, s[4:7], s16 offen offset:1024 sc1
  buffer_load_dwordx4 a[56:59], v34, s[4:7], s16 offen offset:0 sc1
  buffer_load_dwordx4 a[60:63], v34, s[4:7], s16 offen offset:1024 sc1
  s_add_u32 s16, s16, 262144
  s_bitset0_b32 s16, 22
  s_waitcnt vmcnt(12) lgkmcnt(10)
  v_mfma_f32_16x16x32_bf16 v[0:3], v[88:91], a[0:3], 0
  buffer_load_dwordx4 a[64:67], v33, s[4:7], s16 offen offset:0 sc1
  v_mfma_f32_16x16x32_bf16 v[16:19], v[88:91], a[4:7], 0
  ds_read_b64_tr_b16 v[88:89], v35 offset:8192
  ds_read_b64_tr_b16 v[90:91], v35 offset:10240
  v_mfma_f32_16x16x32_bf16 v[4:7], v[92:95], a[0:3], 0
  buffer_load_dwordx4 a[68:71], v33, s[4:7], s16 offen offset:1024 sc1
  v_mfma_f32_16x16x32_bf16 v[20:23], v[92:95], a[4:7], 0
  ds_read_b64_tr_b16 v[92:93], v36 offset:8192
  ds_read_b64_tr_b16 v[94:95], v36 offset:10240
  v_mfma_f32_16x16x32_bf16 v[8:11], v[96:99], a[0:3], 0
  v_mfma_f32_16x16x32_bf16 v[24:27], v[96:99], a[4:7], 0
  buffer_load_dwordx4 a[72:75], v34, s[4:7], s16 offen offset:0 sc1
  v_mfma_f32_16x16x32_bf16 v[12:15], v[100:103], a[0:3], 0
  ds_read_b64_tr_b16 v[96:97], v37 offset:8192
  ds_read_b64_tr_b16 v[98:99], v37 offset:10240
  v_mfma_f32_16x16x32_bf16 v[28:31], v[100:103], a[4:7], 0
  buffer_load_dwordx4 a[76:79], v34, s[4:7], s16 offen offset:1024 sc1
  v_mfma_f32_16x16x32_bf16 v[0:3], v[104:107], a[8:11], v[0:3]
  ds_read_b64_tr_b16 v[100:101], v38 offset:8192
  ds_read_b64_tr_b16 v[102:103], v38 offset:10240
  v_mfma_f32_16x16x32_bf16 v[16:19], v[104:107], a[12:15], v[16:19]
  ds_read_b64_tr_b16 v[104:105], v35 offset:12288
  ds_read_b64_tr_b16 v[106:107], v35 offset:14336
  v_mfma_f32_16x16x32_bf16 v[4:7], v[108:111], a[8:11], v[4:7]
  s_add_u32 s16, s16, 262144
  v_mfma_f32_16x16x32_bf16 v[20:23], v[108:111], a[12:15], v[20:23]
  ds_read_b64_tr_b16 v[108:109], v36 offset:12288
  ds_read_b64_tr_b16 v[110:111], v36 offset:14336
  v_mfma_f32_16x16x32_bf16 v[8:11], v[112:115], a[8:11], v[8:11]
  s_bitset0_b32 s16, 22
  v_mfma_f32_16x16x32_bf16 v[24:27], v[112:115], a[12:15], v[24:27]
  ds_read_b64_tr_b16 v[112:113], v37 offset:12288
  ds_read_b64_tr_b16 v[114:115], v37 offset:14336
  v_mfma_f32_16x16x32_bf16 v[12:15], v[116:119], a[8:11], v[12:15]
  v_mfma_f32_16x16x32_bf16 v[28:31], v[116:119], a[12:15], v[28:31]
  s_waitcnt vmcnt(12) lgkmcnt(10)
  ds_read_b64_tr_b16 v[116:117], v38 offset:12288
  v_mfma_f32_16x16x32_bf16 v[0:3], v[88:91], a[16:19], v[0:3]
  buffer_load_dwordx4 a[80:83], v33, s[4:7], s16 offen offset:0 sc1
  v_mfma_f32_16x16x32_bf16 v[16:19], v[88:91], a[20:23], v[16:19]
  ds_read_b64_tr_b16 v[118:119], v38 offset:14336
  ds_read_b64_tr_b16 v[88:89], v35 offset:16384
  v_mfma_f32_16x16x32_bf16 v[4:7], v[92:95], a[16:19], v[4:7]
  buffer_load_dwordx4 a[84:87], v33, s[4:7], s16 offen offset:1024 sc1
  v_mfma_f32_16x16x32_bf16 v[20:23], v[92:95], a[20:23], v[20:23]
  ds_read_b64_tr_b16 v[90:91], v35 offset:18432
  ds_read_b64_tr_b16 v[92:93], v36 offset:16384
  s_waitcnt lgkmcnt(10)
  v_mfma_f32_16x16x32_bf16 v[8:11], v[96:99], a[16:19], v[8:11]
  ds_read_b64_tr_b16 v[94:95], v36 offset:18432
  v_mfma_f32_16x16x32_bf16 v[24:27], v[96:99], a[20:23], v[24:27]
  buffer_load_dwordx4 a[88:91], v34, s[4:7], s16 offen offset:0 sc1
  v_mfma_f32_16x16x32_bf16 v[12:15], v[100:103], a[16:19], v[12:15]
  ds_read_b64_tr_b16 v[96:97], v37 offset:16384
  ds_read_b64_tr_b16 v[98:99], v37 offset:18432
  v_mfma_f32_16x16x32_bf16 v[28:31], v[100:103], a[20:23], v[28:31]
  buffer_load_dwordx4 a[92:95], v34, s[4:7], s16 offen offset:1024 sc1
  s_waitcnt lgkmcnt(10)
  v_mfma_f32_16x16x32_bf16 v[0:3], v[104:107], a[24:27], v[0:3]
  ds_read_b64_tr_b16 v[100:101], v38 offset:16384
  ds_read_b64_tr_b16 v[102:103], v38 offset:18432
  v_mfma_f32_16x16x32_bf16 v[16:19], v[104:107], a[28:31], v[16:19]
  ds_read_b64_tr_b16 v[104:105], v35 offset:20480
  ds_read_b64_tr_b16 v[106:107], v35 offset:22528
  v_mfma_f32_16x16x32_bf16 v[4:7], v[108:111], a[24:27], v[4:7]
  s_add_u32 s16, s16, 262144
  v_mfma_f32_16x16x32_bf16 v[20:23], v[108:111], a[28:31], v[20:23]
  ds_read_b64_tr_b16 v[108:109], v36 offset:20480
  ds_read_b64_tr_b16 v[110:111], v36 offset:22528
  s_waitcnt lgkmcnt(10)
  v_mfma_f32_16x16x32_bf16 v[8:11], v[112:115], a[24:27], v[8:11]
  s_bitset0_b32 s16, 22
  v_mfma_f32_16x16x32_bf16 v[24:27], v[112:115], a[28:31], v[24:27]
  ds_read_b64_tr_b16 v[112:113], v37 offset:20480
  ds_read_b64_tr_b16 v[114:115], v37 offset:22528
  v_mfma_f32_16x16x32_bf16 v[12:15], v[116:119], a[24:27], v[12:15]
  v_mfma_f32_16x16x32_bf16 v[28:31], v[116:119], a[28:31], v[28:31]
  s_waitcnt vmcnt(12) lgkmcnt(10)
  ds_read_b64_tr_b16 v[116:117], v38 offset:20480
  v_mfma_f32_16x16x32_bf16 v[0:3], v[88:91], a[32:35], v[0:3]
  buffer_load_dwordx4 a[96:99], v33, s[4:7], s16 offen offset:0 sc1
  v_mfma_f32_16x16x32_bf16 v[16:19], v[88:91], a[36:39], v[16:19]
  ds_read_b64_tr_b16 v[118:119], v38 offset:22528
  ds_read_b64_tr_b16 v[88:89], v35 offset:24576
  v_mfma_f32_16x16x32_bf16 v[4:7], v[92:95], a[32:35], v[4:7]
  buffer_load_dwordx4 a[100:103], v33, s[4:7], s16 offen offset:1024 sc1
  v_mfma_f32_16x16x32_bf16 v[20:23], v[92:95], a[36:39], v[20:23]
  ds_read_b64_tr_b16 v[90:91], v35 offset:26624
  ds_read_b64_tr_b16 v[92:93], v36 offset:24576
  s_waitcnt lgkmcnt(10)
  v_mfma_f32_16x16x32_bf16 v[8:11], v[96:99], a[32:35], v[8:11]
  ds_read_b64_tr_b16 v[94:95], v36 offset:26624
  v_mfma_f32_16x16x32_bf16 v[24:27], v[96:99], a[36:39], v[24:27]
  buffer_load_dwordx4 a[104:107], v34, s[4:7], s16 offen offset:0 sc1
  v_mfma_f32_16x16x32_bf16 v[12:15], v[100:103], a[32:35], v[12:15]
  ds_read_b64_tr_b16 v[96:97], v37 offset:24576
  ds_read_b64_tr_b16 v[98:99], v37 offset:26624
  v_mfma_f32_16x16x32_bf16 v[28:31], v[100:103], a[36:39], v[28:31]
  buffer_load_dwordx4 a[108:111], v34, s[4:7], s16 offen offset:1024 sc1
  s_waitcnt lgkmcnt(10)
  v_mfma_f32_16x16x32_bf16 v[0:3], v[104:107], a[40:43], v[0:3]
  ds_read_b64_tr_b16 v[100:101], v38 offset:24576
  ds_read_b64_tr_b16 v[102:103], v38 offset:26624
  v_mfma_f32_16x16x32_bf16 v[16:19], v[104:107], a[44:47], v[16:19]
  ds_read_b64_tr_b16 v[104:105], v35 offset:28672
  ds_read_b64_tr_b16 v[106:107], v35 offset:30720
  v_mfma_f32_16x16x32_bf16 v[4:7], v[108:111], a[40:43], v[4:7]
  s_add_u32 s16, s16, 262144
  v_mfma_f32_16x16x32_bf16 v[20:23], v[108:111], a[44:47], v[20:23]
  ds_read_b64_tr_b16 v[108:109], v36 offset:28672
  ds_read_b64_tr_b16 v[110:111], v36 offset:30720
  s_waitcnt lgkmcnt(10)
  v_mfma_f32_16x16x32_bf16 v[8:11], v[112:115], a[40:43], v[8:11]
  s_bitset0_b32 s16, 22
  v_mfma_f32_16x16x32_bf16 v[24:27], v[112:115], a[44:47], v[24:27]
  ds_read_b64_tr_b16 v[112:113], v37 offset:28672
  ds_read_b64_tr_b16 v[114:115], v37 offset:30720
  v_mfma_f32_16x16x32_bf16 v[12:15], v[116:119], a[40:43], v[12:15]
  v_mfma_f32_16x16x32_bf16 v[28:31], v[116:119], a[44:47], v[28:31]
  s_waitcnt vmcnt(12) lgkmcnt(10)
  ds_read_b64_tr_b16 v[116:117], v38 offset:28672
  v_mfma_f32_16x16x32_bf16 v[0:3], v[88:91], a[48:51], v[0:3]
  buffer_load_dwordx4 a[112:115], v33, s[4:7], s16 offen offset:0 sc1
  v_mfma_f32_16x16x32_bf16 v[16:19], v[88:91], a[52:55], v[16:19]
  ds_read_b64_tr_b16 v[118:119], v38 offset:30720
  ds_read_b64_tr_b16 v[88:89], v35 offset:32768
  v_mfma_f32_16x16x32_bf16 v[4:7], v[92:95], a[48:51], v[4:7]
  buffer_load_dwordx4 a[116:119], v33, s[4:7], s16 offen offset:1024 sc1
  v_mfma_f32_16x16x32_bf16 v[20:23], v[92:95], a[52:55], v[20:23]
  ds_read_b64_tr_b16 v[90:91], v35 offset:34816
  ds_read_b64_tr_b16 v[92:93], v36 offset:32768
  s_waitcnt lgkmcnt(10)
  v_mfma_f32_16x16x32_bf16 v[8:11], v[96:99], a[48:51], v[8:11]
  ds_read_b64_tr_b16 v[94:95], v36 offset:34816
  v_mfma_f32_16x16x32_bf16 v[24:27], v[96:99], a[52:55], v[24:27]
  buffer_load_dwordx4 a[120:123], v34, s[4:7], s16 offen offset:0 sc1
  v_mfma_f32_16x16x32_bf16 v[12:15], v[100:103], a[48:51], v[12:15]
  ds_read_b64_tr_b16 v[96:97], v37 offset:32768
  ds_read_b64_tr_b16 v[98:99], v37 offset:34816
  v_mfma_f32_16x16x32_bf16 v[28:31], v[100:103], a[52:55], v[28:31]
  buffer_load_dwordx4 a[124:127], v34, s[4:7], s16 offen offset:1024 sc1
  s_waitcnt lgkmcnt(10)
  v_mfma_f32_16x16x32_bf16 v[0:3], v[104:107], a[56:59], v[0:3]
  ds_read_b64_tr_b16 v[100:101], v38 offset:32768
  ds_read_b64_tr_b16 v[102:103], v38 offset:34816
  v_mfma_f32_16x16x32_bf16 v[16:19], v[104:107], a[60:63], v[16:19]
  ds_read_b64_tr_b16 v[104:105], v35 offset:36864
  ds_read_b64_tr_b16 v[106:107], v35 offset:38912
  v_mfma_f32_16x16x32_bf16 v[4:7], v[108:111], a[56:59], v[4:7]
  s_add_u32 s16, s16, 262144
  v_mfma_f32_16x16x32_bf16 v[20:23], v[108:111], a[60:63], v[20:23]
  ds_read_b64_tr_b16 v[108:109], v36 offset:36864
  ds_read_b64_tr_b16 v[110:111], v36 offset:38912
  s_waitcnt lgkmcnt(10)
  v_mfma_f32_16x16x32_bf16 v[8:11], v[112:115], a[56:59], v[8:11]
  s_bitset0_b32 s16, 22
  v_mfma_f32_16x16x32_bf16 v[24:27], v[112:115], a[60:63], v[24:27]
  ds_read_b64_tr_b16 v[112:113], v37 offset:36864
  ds_read_b64_tr_b16 v[114:115], v37 offset:38912
  v_mfma_f32_16x16x32_bf16 v[12:15], v[116:119], a[56:59], v[12:15]
  v_mfma_f32_16x16x32_bf16 v[28:31], v[116:119], a[60:63], v[28:31]
  s_waitcnt vmcnt(12) lgkmcnt(10)
  ds_read_b64_tr_b16 v[116:117], v38 offset:36864
  v_mfma_f32_16x16x32_bf16 v[0:3], v[88:91], a[64:67], v[0:3]
  buffer_load_dwordx4 a[0:3], v33, s[4:7], s16 offen offset:0 sc1
  v_mfma_f32_16x16x32_bf16 v[16:19], v[88:91], a[68:71], v[16:19]
  ds_read_b64_tr_b16 v[118:119], v38 offset:38912
  ds_read_b64_tr_b16 v[88:89], v35 offset:40960
  v_mfma_f32_16x16x32_bf16 v[4:7], v[92:95], a[64:67], v[4:7]
  buffer_load_dwordx4 a[4:7], v33, s[4:7], s16 offen offset:1024 sc1
  v_mfma_f32_16x16x32_bf16 v[20:23], v[92:95], a[68:71], v[20:23]
  ds_read_b64_tr_b16 v[90:91], v35 offset:43008
  ds_read_b64_tr_b16 v[92:93], v36 offset:40960
  s_waitcnt lgkmcnt(10)
  v_mfma_f32_16x16x32_bf16 v[8:11], v[96:99], a[64:67], v[8:11]
  ds_read_b64_tr_b16 v[94:95], v36 offset:43008
  v_mfma_f32_16x16x32_bf16 v[24:27], v[96:99], a[68:71], v[24:27]
  buffer_load_dwordx4 a[8:11], v34, s[4:7], s16 offen offset:0 sc1
  v_mfma_f32_16x16x32_bf16 v[12:15], v[100:103], a[64:67], v[12:15]
  ds_read_b64_tr_b16 v[96:97], v37 offset:40960
  ds_read_b64_tr_b16 v[98:99], v37 offset:43008
  v_mfma_f32_16x16x32_bf16 v[28:31], v[100:103], a[68:71], v[28:31]
  buffer_load_dwordx4 a[12:15], v34, s[4:7], s16 offen offset:1024 sc1
  s_waitcnt lgkmcnt(10)
  v_mfma_f32_16x16x32_bf16 v[0:3], v[104:107], a[72:75], v[0:3]
  ds_read_b64_tr_b16 v[100:101], v38 offset:40960
  ds_read_b64_tr_b16 v[102:103], v38 offset:43008
  v_mfma_f32_16x16x32_bf16 v[16:19], v[104:107], a[76:79], v[16:19]
  ds_read_b64_tr_b16 v[104:105], v35 offset:45056
  ds_read_b64_tr_b16 v[106:107], v35 offset:47104
  v_mfma_f32_16x16x32_bf16 v[4:7], v[108:111], a[72:75], v[4:7]
  s_add_u32 s16, s16, 262144
  v_mfma_f32_16x16x32_bf16 v[20:23], v[108:111], a[76:79], v[20:23]
  ds_read_b64_tr_b16 v[108:109], v36 offset:45056
  ds_read_b64_tr_b16 v[110:111], v36 offset:47104
  s_waitcnt lgkmcnt(10)
  v_mfma_f32_16x16x32_bf16 v[8:11], v[112:115], a[72:75], v[8:11]
  s_bitset0_b32 s16, 22
  v_mfma_f32_16x16x32_bf16 v[24:27], v[112:115], a[76:79], v[24:27]
  ds_read_b64_tr_b16 v[112:113], v37 offset:45056
  ds_read_b64_tr_b16 v[114:115], v37 offset:47104
  v_mfma_f32_16x16x32_bf16 v[12:15], v[116:119], a[72:75], v[12:15]
  v_mfma_f32_16x16x32_bf16 v[28:31], v[116:119], a[76:79], v[28:31]
  s_waitcnt vmcnt(12) lgkmcnt(10)
  ds_read_b64_tr_b16 v[116:117], v38 offset:45056
  v_mfma_f32_16x16x32_bf16 v[0:3], v[88:91], a[80:83], v[0:3]
  buffer_load_dwordx4 a[16:19], v33, s[4:7], s16 offen offset:0 sc1
  v_mfma_f32_16x16x32_bf16 v[16:19], v[88:91], a[84:87], v[16:19]
  ds_read_b64_tr_b16 v[118:119], v38 offset:47104
  ds_read_b64_tr_b16 v[88:89], v35 offset:49152
  v_mfma_f32_16x16x32_bf16 v[4:7], v[92:95], a[80:83], v[4:7]
  buffer_load_dwordx4 a[20:23], v33, s[4:7], s16 offen offset:1024 sc1
  v_mfma_f32_16x16x32_bf16 v[20:23], v[92:95], a[84:87], v[20:23]
  ds_read_b64_tr_b16 v[90:91], v35 offset:51200
  ds_read_b64_tr_b16 v[92:93], v36 offset:49152
  s_waitcnt lgkmcnt(10)
  v_mfma_f32_16x16x32_bf16 v[8:11], v[96:99], a[80:83], v[8:11]
  ds_read_b64_tr_b16 v[94:95], v36 offset:51200
  v_mfma_f32_16x16x32_bf16 v[24:27], v[96:99], a[84:87], v[24:27]
  buffer_load_dwordx4 a[24:27], v34, s[4:7], s16 offen offset:0 sc1
  v_mfma_f32_16x16x32_bf16 v[12:15], v[100:103], a[80:83], v[12:15]
  ds_read_b64_tr_b16 v[96:97], v37 offset:49152
  ds_read_b64_tr_b16 v[98:99], v37 offset:51200
  v_mfma_f32_16x16x32_bf16 v[28:31], v[100:103], a[84:87], v[28:31]
  buffer_load_dwordx4 a[28:31], v34, s[4:7], s16 offen offset:1024 sc1
  s_waitcnt lgkmcnt(10)
  v_mfma_f32_16x16x32_bf16 v[0:3], v[104:107], a[88:91], v[0:3]
  ds_read_b64_tr_b16 v[100:101], v38 offset:49152
  ds_read_b64_tr_b16 v[102:103], v38 offset:51200
  v_mfma_f32_16x16x32_bf16 v[16:19], v[104:107], a[92:95], v[16:19]
  ds_read_b64_tr_b16 v[104:105], v35 offset:53248
  ds_read_b64_tr_b16 v[106:107], v35 offset:55296
  v_mfma_f32_16x16x32_bf16 v[4:7], v[108:111], a[88:91], v[4:7]
  s_add_u32 s16, s16, 262144
  v_mfma_f32_16x16x32_bf16 v[20:23], v[108:111], a[92:95], v[20:23]
  ds_read_b64_tr_b16 v[108:109], v36 offset:53248
  ds_read_b64_tr_b16 v[110:111], v36 offset:55296
  s_waitcnt lgkmcnt(10)
  v_mfma_f32_16x16x32_bf16 v[8:11], v[112:115], a[88:91], v[8:11]
  s_bitset0_b32 s16, 22
  v_mfma_f32_16x16x32_bf16 v[24:27], v[112:115], a[92:95], v[24:27]
  ds_read_b64_tr_b16 v[112:113], v37 offset:53248
  ds_read_b64_tr_b16 v[114:115], v37 offset:55296
  v_mfma_f32_16x16x32_bf16 v[12:15], v[116:119], a[88:91], v[12:15]
  v_mfma_f32_16x16x32_bf16 v[28:31], v[116:119], a[92:95], v[28:31]
  s_waitcnt vmcnt(12) lgkmcnt(10)
  ds_read_b64_tr_b16 v[116:117], v38 offset:53248
  v_mfma_f32_16x16x32_bf16 v[0:3], v[88:91], a[96:99], v[0:3]
  buffer_load_dwordx4 a[32:35], v33, s[4:7], s16 offen offset:0 sc1
  v_mfma_f32_16x16x32_bf16 v[16:19], v[88:91], a[100:103], v[16:19]
  ds_read_b64_tr_b16 v[118:119], v38 offset:55296
  ds_read_b64_tr_b16 v[88:89], v35 offset:57344
  v_mfma_f32_16x16x32_bf16 v[4:7], v[92:95], a[96:99], v[4:7]
  buffer_load_dwordx4 a[36:39], v33, s[4:7], s16 offen offset:1024 sc1
  v_mfma_f32_16x16x32_bf16 v[20:23], v[92:95], a[100:103], v[20:23]
  ds_read_b64_tr_b16 v[90:91], v35 offset:59392
  ds_read_b64_tr_b16 v[92:93], v36 offset:57344
  s_waitcnt lgkmcnt(10)
  v_mfma_f32_16x16x32_bf16 v[8:11], v[96:99], a[96:99], v[8:11]
  ds_read_b64_tr_b16 v[94:95], v36 offset:59392
  v_mfma_f32_16x16x32_bf16 v[24:27], v[96:99], a[100:103], v[24:27]
  buffer_load_dwordx4 a[40:43], v34, s[4:7], s16 offen offset:0 sc1
  v_mfma_f32_16x16x32_bf16 v[12:15], v[100:103], a[96:99], v[12:15]
  ds_read_b64_tr_b16 v[96:97], v37 offset:57344
  ds_read_b64_tr_b16 v[98:99], v37 offset:59392
  v_mfma_f32_16x16x32_bf16 v[28:31], v[100:103], a[100:103], v[28:31]
  buffer_load_dwordx4 a[44:47], v34, s[4:7], s16 offen offset:1024 sc1
  s_waitcnt lgkmcnt(10)
  v_mfma_f32_16x16x32_bf16 v[0:3], v[104:107], a[104:107], v[0:3]
  ds_read_b64_tr_b16 v[100:101], v38 offset:57344
  ds_read_b64_tr_b16 v[102:103], v38 offset:59392
  v_mfma_f32_16x16x32_bf16 v[16:19], v[104:107], a[108:111], v[16:19]
  ds_read_b64_tr_b16 v[104:105], v35 offset:61440
  ds_read_b64_tr_b16 v[106:107], v35 offset:63488
  v_mfma_f32_16x16x32_bf16 v[4:7], v[108:111], a[104:107], v[4:7]
  s_add_u32 s16, s16, 262144
  v_mfma_f32_16x16x32_bf16 v[20:23], v[108:111], a[108:111], v[20:23]
  ds_read_b64_tr_b16 v[108:109], v36 offset:61440
  ds_read_b64_tr_b16 v[110:111], v36 offset:63488
  s_waitcnt lgkmcnt(10)
  v_mfma_f32_16x16x32_bf16 v[8:11], v[112:115], a[104:107], v[8:11]
  s_bitset0_b32 s16, 22
  v_mfma_f32_16x16x32_bf16 v[24:27], v[112:115], a[108:111], v[24:27]
  ds_read_b64_tr_b16 v[112:113], v37 offset:61440
  ds_read_b64_tr_b16 v[114:115], v37 offset:63488
  v_mfma_f32_16x16x32_bf16 v[12:15], v[116:119], a[104:107], v[12:15]
  v_mfma_f32_16x16x32_bf16 v[28:31], v[116:119], a[108:111], v[28:31]
  s_waitcnt vmcnt(12) lgkmcnt(10)
  ds_read_b64_tr_b16 v[116:117], v38 offset:61440
  v_mfma_f32_16x16x32_bf16 v[0:3], v[88:91], a[112:115], v[0:3]
  buffer_load_dwordx4 a[48:51], v33, s[4:7], s16 offen offset:0 sc1
  v_mfma_f32_16x16x32_bf16 v[16:19], v[88:91], a[116:119], v[16:19]
  ds_read_b64_tr_b16 v[118:119], v38 offset:63488
  ds_read_b64_tr_b16 v[88:89], v39 offset:0
  v_mfma_f32_16x16x32_bf16 v[4:7], v[92:95], a[112:115], v[4:7]
  buffer_load_dwordx4 a[52:55], v33, s[4:7], s16 offen offset:1024 sc1
  v_mfma_f32_16x16x32_bf16 v[20:23], v[92:95], a[116:119], v[20:23]
  ds_read_b64_tr_b16 v[90:91], v39 offset:2048
  ds_read_b64_tr_b16 v[92:93], v40 offset:0
  s_waitcnt lgkmcnt(10)
  v_mfma_f32_16x16x32_bf16 v[8:11], v[96:99], a[112:115], v[8:11]
  ds_read_b64_tr_b16 v[94:95], v40 offset:2048
  v_mfma_f32_16x16x32_bf16 v[24:27], v[96:99], a[116:119], v[24:27]
  buffer_load_dwordx4 a[56:59], v34, s[4:7], s16 offen offset:0 sc1
  v_mfma_f32_16x16x32_bf16 v[12:15], v[100:103], a[112:115], v[12:15]
  ds_read_b64_tr_b16 v[96:97], v41 offset:0
  ds_read_b64_tr_b16 v[98:99], v41 offset:2048
  v_mfma_f32_16x16x32_bf16 v[28:31], v[100:103], a[116:119], v[28:31]
  buffer_load_dwordx4 a[60:63], v34, s[4:7], s16 offen offset:1024 sc1
  s_waitcnt lgkmcnt(10)
  v_mfma_f32_16x16x32_bf16 v[0:3], v[104:107], a[120:123], v[0:3]
  ds_read_b64_tr_b16 v[100:101], v42 offset:0
  ds_read_b64_tr_b16 v[102:103], v42 offset:2048
  v_mfma_f32_16x16x32_bf16 v[16:19], v[104:107], a[124:127], v[16:19]
  ds_read_b64_tr_b16 v[104:105], v39 offset:4096
  ds_read_b64_tr_b16 v[106:107], v39 offset:6144
  v_mfma_f32_16x16x32_bf16 v[4:7], v[108:111], a[120:123], v[4:7]
  s_add_u32 s16, s16, 262144
  v_mfma_f32_16x16x32_bf16 v[20:23], v[108:111], a[124:127], v[20:23]
  ds_read_b64_tr_b16 v[108:109], v40 offset:4096
  ds_read_b64_tr_b16 v[110:111], v40 offset:6144
  s_waitcnt lgkmcnt(10)
  v_mfma_f32_16x16x32_bf16 v[8:11], v[112:115], a[120:123], v[8:11]
  s_bitset0_b32 s16, 22
  v_mfma_f32_16x16x32_bf16 v[24:27], v[112:115], a[124:127], v[24:27]
  ds_read_b64_tr_b16 v[112:113], v41 offset:4096
  ds_read_b64_tr_b16 v[114:115], v41 offset:6144
  v_mfma_f32_16x16x32_bf16 v[12:15], v[116:119], a[120:123], v[12:15]
  v_mfma_f32_16x16x32_bf16 v[28:31], v[116:119], a[124:127], v[28:31]
  s_waitcnt vmcnt(12) lgkmcnt(10)
  ds_read_b64_tr_b16 v[116:117], v42 offset:4096
  v_mfma_f32_16x16x32_bf16 v[0:3], v[88:91], a[0:3], v[0:3]
  buffer_load_dwordx4 a[64:67], v33, s[4:7], s16 offen offset:0 sc1
  v_mfma_f32_16x16x32_bf16 v[16:19], v[88:91], a[4:7], v[16:19]
  ds_read_b64_tr_b16 v[118:119], v42 offset:6144
  ds_read_b64_tr_b16 v[88:89], v39 offset:8192
  v_mfma_f32_16x16x32_bf16 v[4:7], v[92:95], a[0:3], v[4:7]
  buffer_load_dwordx4 a[68:71], v33, s[4:7], s16 offen offset:1024 sc1
  v_mfma_f32_16x16x32_bf16 v[20:23], v[92:95], a[4:7], v[20:23]
  ds_read_b64_tr_b16 v[90:91], v39 offset:10240
  ds_read_b64_tr_b16 v[92:93], v40 offset:8192
  s_waitcnt lgkmcnt(10)
  v_mfma_f32_16x16x32_bf16 v[8:11], v[96:99], a[0:3], v[8:11]
  ds_read_b64_tr_b16 v[94:95], v40 offset:10240
  v_mfma_f32_16x16x32_bf16 v[24:27], v[96:99], a[4:7], v[24:27]
  buffer_load_dwordx4 a[72:75], v34, s[4:7], s16 offen offset:0 sc1
  v_mfma_f32_16x16x32_bf16 v[12:15], v[100:103], a[0:3], v[12:15]
  ds_read_b64_tr_b16 v[96:97], v41 offset:8192
  ds_read_b64_tr_b16 v[98:99], v41 offset:10240
  v_mfma_f32_16x16x32_bf16 v[28:31], v[100:103], a[4:7], v[28:31]
  buffer_load_dwordx4 a[76:79], v34, s[4:7], s16 offen offset:1024 sc1
  s_waitcnt lgkmcnt(10)
  v_mfma_f32_16x16x32_bf16 v[0:3], v[104:107], a[8:11], v[0:3]
  ds_read_b64_tr_b16 v[100:101], v42 offset:8192
  ds_read_b64_tr_b16 v[102:103], v42 offset:10240
  v_mfma_f32_16x16x32_bf16 v[16:19], v[104:107], a[12:15], v[16:19]
  ds_read_b64_tr_b16 v[104:105], v39 offset:12288
  ds_read_b64_tr_b16 v[106:107], v39 offset:14336
  v_mfma_f32_16x16x32_bf16 v[4:7], v[108:111], a[8:11], v[4:7]
  s_add_u32 s16, s16, 262144
  v_mfma_f32_16x16x32_bf16 v[20:23], v[108:111], a[12:15], v[20:23]
  ds_read_b64_tr_b16 v[108:109], v40 offset:12288
  ds_read_b64_tr_b16 v[110:111], v40 offset:14336
  s_waitcnt lgkmcnt(10)
  v_mfma_f32_16x16x32_bf16 v[8:11], v[112:115], a[8:11], v[8:11]
  s_bitset0_b32 s16, 22
  v_mfma_f32_16x16x32_bf16 v[24:27], v[112:115], a[12:15], v[24:27]
  ds_read_b64_tr_b16 v[112:113], v41 offset:12288
  ds_read_b64_tr_b16 v[114:115], v41 offset:14336
  v_mfma_f32_16x16x32_bf16 v[12:15], v[116:119], a[8:11], v[12:15]
  v_mfma_f32_16x16x32_bf16 v[28:31], v[116:119], a[12:15], v[28:31]
  s_waitcnt vmcnt(12) lgkmcnt(10)
  ds_read_b64_tr_b16 v[116:117], v42 offset:12288
  v_mfma_f32_16x16x32_bf16 v[0:3], v[88:91], a[16:19], v[0:3]
  buffer_load_dwordx4 a[80:83], v33, s[4:7], s16 offen offset:0 sc1
  v_mfma_f32_16x16x32_bf16 v[16:19], v[88:91], a[20:23], v[16:19]
  ds_read_b64_tr_b16 v[118:119], v42 offset:14336
  ds_read_b64_tr_b16 v[88:89], v39 offset:16384
  v_mfma_f32_16x16x32_bf16 v[4:7], v[92:95], a[16:19], v[4:7]
  buffer_load_dwordx4 a[84:87], v33, s[4:7], s16 offen offset:1024 sc1
  v_mfma_f32_16x16x32_bf16 v[20:23], v[92:95], a[20:23], v[20:23]
  ds_read_b64_tr_b16 v[90:91], v39 offset:18432
  ds_read_b64_tr_b16 v[92:93], v40 offset:16384
  s_waitcnt lgkmcnt(10)
  v_mfma_f32_16x16x32_bf16 v[8:11], v[96:99], a[16:19], v[8:11]
  ds_read_b64_tr_b16 v[94:95], v40 offset:18432
  v_mfma_f32_16x16x32_bf16 v[24:27], v[96:99], a[20:23], v[24:27]
  buffer_load_dwordx4 a[88:91], v34, s[4:7], s16 offen offset:0 sc1
  v_mfma_f32_16x16x32_bf16 v[12:15], v[100:103], a[16:19], v[12:15]
  ds_read_b64_tr_b16 v[96:97], v41 offset:16384
  ds_read_b64_tr_b16 v[98:99], v41 offset:18432
  v_mfma_f32_16x16x32_bf16 v[28:31], v[100:103], a[20:23], v[28:31]
  buffer_load_dwordx4 a[92:95], v34, s[4:7], s16 offen offset:1024 sc1
  s_waitcnt lgkmcnt(10)
  v_mfma_f32_16x16x32_bf16 v[0:3], v[104:107], a[24:27], v[0:3]
  ds_read_b64_tr_b16 v[100:101], v42 offset:16384
  ds_read_b64_tr_b16 v[102:103], v42 offset:18432
  v_mfma_f32_16x16x32_bf16 v[16:19], v[104:107], a[28:31], v[16:19]
  ds_read_b64_tr_b16 v[104:105], v39 offset:20480
  ds_read_b64_tr_b16 v[106:107], v39 offset:22528
  v_mfma_f32_16x16x32_bf16 v[4:7], v[108:111], a[24:27], v[4:7]
  s_add_u32 s16, s16, 262144
  v_mfma_f32_16x16x32_bf16 v[20:23], v[108:111], a[28:31], v[20:23]
  ds_read_b64_tr_b16 v[108:109], v40 offset:20480
  ds_read_b64_tr_b16 v[110:111], v40 offset:22528
  s_waitcnt lgkmcnt(10)
  v_mfma_f32_16x16x32_bf16 v[8:11], v[112:115], a[24:27], v[8:11]
  s_bitset0_b32 s16, 22
  v_mfma_f32_16x16x32_bf16 v[24:27], v[112:115], a[28:31], v[24:27]
  ds_read_b64_tr_b16 v[112:113], v41 offset:20480
  ds_read_b64_tr_b16 v[114:115], v41 offset:22528
  v_mfma_f32_16x16x32_bf16 v[12:15], v[116:119], a[24:27], v[12:15]
  v_mfma_f32_16x16x32_bf16 v[28:31], v[116:119], a[28:31], v[28:31]
  s_waitcnt vmcnt(12) lgkmcnt(10)
  ds_read_b64_tr_b16 v[116:117], v42 offset:20480
  v_mfma_f32_16x16x32_bf16 v[0:3], v[88:91], a[32:35], v[0:3]
  buffer_load_dwordx4 a[96:99], v33, s[4:7], s16 offen offset:0 sc1
  v_mfma_f32_16x16x32_bf16 v[16:19], v[88:91], a[36:39], v[16:19]
  ds_read_b64_tr_b16 v[118:119], v42 offset:22528
  ds_read_b64_tr_b16 v[88:89], v39 offset:24576
  v_mfma_f32_16x16x32_bf16 v[4:7], v[92:95], a[32:35], v[4:7]
  buffer_load_dwordx4 a[100:103], v33, s[4:7], s16 offen offset:1024 sc1
  v_mfma_f32_16x16x32_bf16 v[20:23], v[92:95], a[36:39], v[20:23]
  ds_read_b64_tr_b16 v[90:91], v39 offset:26624
  ds_read_b64_tr_b16 v[92:93], v40 offset:24576
  s_waitcnt lgkmcnt(10)
  v_mfma_f32_16x16x32_bf16 v[8:11], v[96:99], a[32:35], v[8:11]
  ds_read_b64_tr_b16 v[94:95], v40 offset:26624
  v_mfma_f32_16x16x32_bf16 v[24:27], v[96:99], a[36:39], v[24:27]
  buffer_load_dwordx4 a[104:107], v34, s[4:7], s16 offen offset:0 sc1
  v_mfma_f32_16x16x32_bf16 v[12:15], v[100:103], a[32:35], v[12:15]
  ds_read_b64_tr_b16 v[96:97], v41 offset:24576
  ds_read_b64_tr_b16 v[98:99], v41 offset:26624
  v_mfma_f32_16x16x32_bf16 v[28:31], v[100:103], a[36:39], v[28:31]
  buffer_load_dwordx4 a[108:111], v34, s[4:7], s16 offen offset:1024 sc1
  s_waitcnt lgkmcnt(10)
  v_mfma_f32_16x16x32_bf16 v[0:3], v[104:107], a[40:43], v[0:3]
  ds_read_b64_tr_b16 v[100:101], v42 offset:24576
  ds_read_b64_tr_b16 v[102:103], v42 offset:26624
  v_mfma_f32_16x16x32_bf16 v[16:19], v[104:107], a[44:47], v[16:19]
  ds_read_b64_tr_b16 v[104:105], v39 offset:28672
  ds_read_b64_tr_b16 v[106:107], v39 offset:30720
  v_mfma_f32_16x16x32_bf16 v[4:7], v[108:111], a[40:43], v[4:7]
  s_add_u32 s16, s16, 262144
  v_mfma_f32_16x16x32_bf16 v[20:23], v[108:111], a[44:47], v[20:23]
  ds_read_b64_tr_b16 v[108:109], v40 offset:28672
  ds_read_b64_tr_b16 v[110:111], v40 offset:30720
  s_waitcnt lgkmcnt(10)
  v_mfma_f32_16x16x32_bf16 v[8:11], v[112:115], a[40:43], v[8:11]
  s_bitset0_b32 s16, 22
  v_mfma_f32_16x16x32_bf16 v[24:27], v[112:115], a[44:47], v[24:27]
  ds_read_b64_tr_b16 v[112:113], v41 offset:28672
  ds_read_b64_tr_b16 v[114:115], v41 offset:30720
  v_mfma_f32_16x16x32_bf16 v[12:15], v[116:119], a[40:43], v[12:15]
  v_mfma_f32_16x16x32_bf16 v[28:31], v[116:119], a[44:47], v[28:31]
  s_waitcnt vmcnt(12) lgkmcnt(10)
  ds_read_b64_tr_b16 v[116:117], v42 offset:28672
  v_mfma_f32_16x16x32_bf16 v[0:3], v[88:91], a[48:51], v[0:3]
  buffer_load_dwordx4 a[112:115], v33, s[4:7], s16 offen offset:0 sc1
  v_mfma_f32_16x16x32_bf16 v[16:19], v[88:91], a[52:55], v[16:19]
  ds_read_b64_tr_b16 v[118:119], v42 offset:30720
  ds_read_b64_tr_b16 v[88:89], v39 offset:32768
  v_mfma_f32_16x16x32_bf16 v[4:7], v[92:95], a[48:51], v[4:7]
  buffer_load_dwordx4 a[116:119], v33, s[4:7], s16 offen offset:1024 sc1
  v_mfma_f32_16x16x32_bf16 v[20:23], v[92:95], a[52:55], v[20:23]
  ds_read_b64_tr_b16 v[90:91], v39 offset:34816
  ds_read_b64_tr_b16 v[92:93], v40 offset:32768
  s_waitcnt lgkmcnt(10)
  v_mfma_f32_16x16x32_bf16 v[8:11], v[96:99], a[48:51], v[8:11]
  ds_read_b64_tr_b16 v[94:95], v40 offset:34816
  v_mfma_f32_16x16x32_bf16 v[24:27], v[96:99], a[52:55], v[24:27]
  buffer_load_dwordx4 a[120:123], v34, s[4:7], s16 offen offset:0 sc1
  v_mfma_f32_16x16x32_bf16 v[12:15], v[100:103], a[48:51], v[12:15]
  ds_read_b64_tr_b16 v[96:97], v41 offset:32768
  ds_read_b64_tr_b16 v[98:99], v41 offset:34816
  v_mfma_f32_16x16x32_bf16 v[28:31], v[100:103], a[52:55], v[28:31]
  buffer_load_dwordx4 a[124:127], v34, s[4:7], s16 offen offset:1024 sc1
  s_waitcnt lgkmcnt(10)
  v_mfma_f32_16x16x32_bf16 v[0:3], v[104:107], a[56:59], v[0:3]
  ds_read_b64_tr_b16 v[100:101], v42 offset:32768
  ds_read_b64_tr_b16 v[102:103], v42 offset:34816
  v_mfma_f32_16x16x32_bf16 v[16:19], v[104:107], a[60:63], v[16:19]
  ds_read_b64_tr_b16 v[104:105], v39 offset:36864
  ds_read_b64_tr_b16 v[106:107], v39 offset:38912
  v_mfma_f32_16x16x32_bf16 v[4:7], v[108:111], a[56:59], v[4:7]
  s_add_u32 s16, s16, 262144
  v_mfma_f32_16x16x32_bf16 v[20:23], v[108:111], a[60:63], v[20:23]
  ds_read_b64_tr_b16 v[108:109], v40 offset:36864
  ds_read_b64_tr_b16 v[110:111], v40 offset:38912
  s_waitcnt lgkmcnt(10)
  v_mfma_f32_16x16x32_bf16 v[8:11], v[112:115], a[56:59], v[8:11]
  s_bitset0_b32 s16, 22
  v_mfma_f32_16x16x32_bf16 v[24:27], v[112:115], a[60:63], v[24:27]
  ds_read_b64_tr_b16 v[112:113], v41 offset:36864
  ds_read_b64_tr_b16 v[114:115], v41 offset:38912
  v_mfma_f32_16x16x32_bf16 v[12:15], v[116:119], a[56:59], v[12:15]
  v_mfma_f32_16x16x32_bf16 v[28:31], v[116:119], a[60:63], v[28:31]
  s_waitcnt vmcnt(12) lgkmcnt(10)
  ds_read_b64_tr_b16 v[116:117], v42 offset:36864
  v_mfma_f32_16x16x32_bf16 v[0:3], v[88:91], a[64:67], v[0:3]
  ds_read_b64_tr_b16 v[118:119], v42 offset:38912
  v_mfma_f32_16x16x32_bf16 v[16:19], v[88:91], a[68:71], v[16:19]
  ds_read_b64_tr_b16 v[88:89], v39 offset:40960
  ds_read_b64_tr_b16 v[90:91], v39 offset:43008
  v_mfma_f32_16x16x32_bf16 v[4:7], v[92:95], a[64:67], v[4:7]
  v_mfma_f32_16x16x32_bf16 v[20:23], v[92:95], a[68:71], v[20:23]
  ds_read_b64_tr_b16 v[92:93], v40 offset:40960
  ds_read_b64_tr_b16 v[94:95], v40 offset:43008
  s_waitcnt lgkmcnt(10)
  v_mfma_f32_16x16x32_bf16 v[8:11], v[96:99], a[64:67], v[8:11]
  v_mfma_f32_16x16x32_bf16 v[24:27], v[96:99], a[68:71], v[24:27]
  ds_read_b64_tr_b16 v[96:97], v41 offset:40960
  ds_read_b64_tr_b16 v[98:99], v41 offset:43008
  v_mfma_f32_16x16x32_bf16 v[12:15], v[100:103], a[64:67], v[12:15]
  v_mfma_f32_16x16x32_bf16 v[28:31], v[100:103], a[68:71], v[28:31]
  ds_read_b64_tr_b16 v[100:101], v42 offset:40960
  ds_read_b64_tr_b16 v[102:103], v42 offset:43008
  v_mfma_f32_16x16x32_bf16 v[0:3], v[104:107], a[72:75], v[0:3]
  v_mfma_f32_16x16x32_bf16 v[16:19], v[104:107], a[76:79], v[16:19]
  ds_read_b64_tr_b16 v[104:105], v39 offset:45056
  ds_read_b64_tr_b16 v[106:107], v39 offset:47104
  s_waitcnt lgkmcnt(10)
  v_mfma_f32_16x16x32_bf16 v[4:7], v[108:111], a[72:75], v[4:7]
  v_mfma_f32_16x16x32_bf16 v[20:23], v[108:111], a[76:79], v[20:23]
  ds_read_b64_tr_b16 v[108:109], v40 offset:45056
  ds_read_b64_tr_b16 v[110:111], v40 offset:47104
  v_mfma_f32_16x16x32_bf16 v[8:11], v[112:115], a[72:75], v[8:11]
  v_mfma_f32_16x16x32_bf16 v[24:27], v[112:115], a[76:79], v[24:27]
  ds_read_b64_tr_b16 v[112:113], v41 offset:45056
  ds_read_b64_tr_b16 v[114:115], v41 offset:47104
  v_mfma_f32_16x16x32_bf16 v[12:15], v[116:119], a[72:75], v[12:15]
  v_mfma_f32_16x16x32_bf16 v[28:31], v[116:119], a[76:79], v[28:31]
  s_waitcnt vmcnt(8) lgkmcnt(10)
  ds_read_b64_tr_b16 v[116:117], v42 offset:45056
  v_mfma_f32_16x16x32_bf16 v[0:3], v[88:91], a[80:83], v[0:3]
  ds_read_b64_tr_b16 v[118:119], v42 offset:47104
  v_mfma_f32_16x16x32_bf16 v[16:19], v[88:91], a[84:87], v[16:19]
  ds_read_b64_tr_b16 v[88:89], v39 offset:49152
  ds_read_b64_tr_b16 v[90:91], v39 offset:51200
  v_mfma_f32_16x16x32_bf16 v[4:7], v[92:95], a[80:83], v[4:7]
  v_mfma_f32_16x16x32_bf16 v[20:23], v[92:95], a[84:87], v[20:23]
  ds_read_b64_tr_b16 v[92:93], v40 offset:49152
  ds_read_b64_tr_b16 v[94:95], v40 offset:51200
  s_waitcnt lgkmcnt(10)
  v_mfma_f32_16x16x32_bf16 v[8:11], v[96:99], a[80:83], v[8:11]
  v_mfma_f32_16x16x32_bf16 v[24:27], v[96:99], a[84:87], v[24:27]
  ds_read_b64_tr_b16 v[96:97], v41 offset:49152
  ds_read_b64_tr_b16 v[98:99], v41 offset:51200
  v_mfma_f32_16x16x32_bf16 v[12:15], v[100:103], a[80:83], v[12:15]
  v_mfma_f32_16x16x32_bf16 v[28:31], v[100:103], a[84:87], v[28:31]
  ds_read_b64_tr_b16 v[100:101], v42 offset:49152
  ds_read_b64_tr_b16 v[102:103], v42 offset:51200
  v_mfma_f32_16x16x32_bf16 v[0:3], v[104:107], a[88:91], v[0:3]
  v_mfma_f32_16x16x32_bf16 v[16:19], v[104:107], a[92:95], v[16:19]
  ds_read_b64_tr_b16 v[104:105], v39 offset:53248
  ds_read_b64_tr_b16 v[106:107], v39 offset:55296
  s_waitcnt lgkmcnt(10)
  v_mfma_f32_16x16x32_bf16 v[4:7], v[108:111], a[88:91], v[4:7]
  v_mfma_f32_16x16x32_bf16 v[20:23], v[108:111], a[92:95], v[20:23]
  ds_read_b64_tr_b16 v[108:109], v40 offset:53248
  ds_read_b64_tr_b16 v[110:111], v40 offset:55296
  v_mfma_f32_16x16x32_bf16 v[8:11], v[112:115], a[88:91], v[8:11]
  v_mfma_f32_16x16x32_bf16 v[24:27], v[112:115], a[92:95], v[24:27]
  ds_read_b64_tr_b16 v[112:113], v41 offset:53248
  ds_read_b64_tr_b16 v[114:115], v41 offset:55296
  v_mfma_f32_16x16x32_bf16 v[12:15], v[116:119], a[88:91], v[12:15]
  v_mfma_f32_16x16x32_bf16 v[28:31], v[116:119], a[92:95], v[28:31]
  s_waitcnt vmcnt(4) lgkmcnt(10)
  ds_read_b64_tr_b16 v[116:117], v42 offset:53248
  v_mfma_f32_16x16x32_bf16 v[0:3], v[88:91], a[96:99], v[0:3]
  ds_read_b64_tr_b16 v[118:119], v42 offset:55296
  v_mfma_f32_16x16x32_bf16 v[16:19], v[88:91], a[100:103], v[16:19]
  ds_read_b64_tr_b16 v[88:89], v39 offset:57344
  ds_read_b64_tr_b16 v[90:91], v39 offset:59392
  v_mfma_f32_16x16x32_bf16 v[4:7], v[92:95], a[96:99], v[4:7]
  v_mfma_f32_16x16x32_bf16 v[20:23], v[92:95], a[100:103], v[20:23]
  ds_read_b64_tr_b16 v[92:93], v40 offset:57344
  ds_read_b64_tr_b16 v[94:95], v40 offset:59392
  s_waitcnt lgkmcnt(10)
  v_mfma_f32_16x16x32_bf16 v[8:11], v[96:99], a[96:99], v[8:11]
  v_mfma_f32_16x16x32_bf16 v[24:27], v[96:99], a[100:103], v[24:27]
  ds_read_b64_tr_b16 v[96:97], v41 offset:57344
  ds_read_b64_tr_b16 v[98:99], v41 offset:59392
  v_mfma_f32_16x16x32_bf16 v[12:15], v[100:103], a[96:99], v[12:15]
  v_mfma_f32_16x16x32_bf16 v[28:31], v[100:103], a[100:103], v[28:31]
  ds_read_b64_tr_b16 v[100:101], v42 offset:57344
  ds_read_b64_tr_b16 v[102:103], v42 offset:59392
  v_mfma_f32_16x16x32_bf16 v[0:3], v[104:107], a[104:107], v[0:3]
  v_mfma_f32_16x16x32_bf16 v[16:19], v[104:107], a[108:111], v[16:19]
  ds_read_b64_tr_b16 v[104:105], v39 offset:61440
  ds_read_b64_tr_b16 v[106:107], v39 offset:63488
  s_waitcnt lgkmcnt(10)
  v_mfma_f32_16x16x32_bf16 v[4:7], v[108:111], a[104:107], v[4:7]
  v_mfma_f32_16x16x32_bf16 v[20:23], v[108:111], a[108:111], v[20:23]
  ds_read_b64_tr_b16 v[108:109], v40 offset:61440
  ds_read_b64_tr_b16 v[110:111], v40 offset:63488
  v_mfma_f32_16x16x32_bf16 v[8:11], v[112:115], a[104:107], v[8:11]
  v_mfma_f32_16x16x32_bf16 v[24:27], v[112:115], a[108:111], v[24:27]
  ds_read_b64_tr_b16 v[112:113], v41 offset:61440
  ds_read_b64_tr_b16 v[114:115], v41 offset:63488
  v_mfma_f32_16x16x32_bf16 v[12:15], v[116:119], a[104:107], v[12:15]
  v_mfma_f32_16x16x32_bf16 v[28:31], v[116:119], a[108:111], v[28:31]
  s_waitcnt vmcnt(0) lgkmcnt(10)
  ds_read_b64_tr_b16 v[116:117], v42 offset:61440
  v_mfma_f32_16x16x32_bf16 v[0:3], v[88:91], a[112:115], v[0:3]
  ds_read_b64_tr_b16 v[118:119], v42 offset:63488
  v_mfma_f32_16x16x32_bf16 v[16:19], v[88:91], a[116:119], v[16:19]
  v_mfma_f32_16x16x32_bf16 v[4:7], v[92:95], a[112:115], v[4:7]
  v_mfma_f32_16x16x32_bf16 v[20:23], v[92:95], a[116:119], v[20:23]
  s_waitcnt lgkmcnt(10)
  v_mfma_f32_16x16x32_bf16 v[8:11], v[96:99], a[112:115], v[8:11]
  v_mfma_f32_16x16x32_bf16 v[24:27], v[96:99], a[116:119], v[24:27]
  s_waitcnt lgkmcnt(8)
  v_mfma_f32_16x16x32_bf16 v[12:15], v[100:103], a[112:115], v[12:15]
  v_mfma_f32_16x16x32_bf16 v[28:31], v[100:103], a[116:119], v[28:31]
  s_waitcnt lgkmcnt(6)
  v_mfma_f32_16x16x32_bf16 v[0:3], v[104:107], a[120:123], v[0:3]
  v_mfma_f32_16x16x32_bf16 v[16:19], v[104:107], a[124:127], v[16:19]
  s_waitcnt lgkmcnt(4)
  v_mfma_f32_16x16x32_bf16 v[4:7], v[108:111], a[120:123], v[4:7]
  v_mfma_f32_16x16x32_bf16 v[20:23], v[108:111], a[124:127], v[20:23]
  s_waitcnt lgkmcnt(2)
  v_mfma_f32_16x16x32_bf16 v[8:11], v[112:115], a[120:123], v[8:11]
  v_mfma_f32_16x16x32_bf16 v[24:27], v[112:115], a[124:127], v[24:27]
  s_waitcnt lgkmcnt(0)
  v_mfma_f32_16x16x32_bf16 v[12:15], v[116:119], a[120:123], v[12:15]
  v_mfma_f32_16x16x32_bf16 v[28:31], v[116:119], a[124:127], v[28:31]
  s_nop 7
  s_nop 1
  s_barrier
  v_pk_fma_f32 v[120:121], v[0:1], v[64:65], v[120:121]
  v_pk_fma_f32 v[122:123], v[2:3], v[66:67], v[122:123]
  v_pk_fma_f32 v[124:125], v[4:5], v[68:69], v[124:125]
  v_pk_fma_f32 v[126:127], v[6:7], v[70:71], v[126:127]
  v_pk_fma_f32 v[128:129], v[8:9], v[72:73], v[128:129]
  v_pk_fma_f32 v[130:131], v[10:11], v[74:75], v[130:131]
  v_pk_fma_f32 v[132:133], v[12:13], v[76:77], v[132:133]
  v_pk_fma_f32 v[134:135], v[14:15], v[78:79], v[134:135]
  v_pk_fma_f32 v[136:137], v[16:17], v[64:65], v[136:137]
  v_pk_fma_f32 v[138:139], v[18:19], v[66:67], v[138:139]
  v_pk_fma_f32 v[140:141], v[20:21], v[68:69], v[140:141]
  v_pk_fma_f32 v[142:143], v[22:23], v[70:71], v[142:143]
  v_pk_fma_f32 v[144:145], v[24:25], v[72:73], v[144:145]
  v_pk_fma_f32 v[146:147], v[26:27], v[74:75], v[146:147]
  v_pk_fma_f32 v[148:149], v[28:29], v[76:77], v[148:149]
  v_pk_fma_f32 v[150:151], v[30:31], v[78:79], v[150:151]
  v_pk_mul_f32 v[160:161], v[120:121], v[120:121]
  v_pk_mul_f32 v[162:163], v[136:137], v[136:137]
  v_pk_fma_f32 v[160:161], v[122:123], v[122:123], v[160:161]
  v_pk_add_f32 v[152:153], v[120:121], v[122:123]
  v_pk_fma_f32 v[162:163], v[138:139], v[138:139], v[162:163]
  v_pk_add_f32 v[154:155], v[136:137], v[138:139]
  v_pk_fma_f32 v[160:161], v[124:125], v[124:125], v[160:161]
  v_pk_add_f32 v[152:153], v[152:153], v[124:125]
  v_pk_fma_f32 v[162:163], v[140:141], v[140:141], v[162:163]
  v_pk_add_f32 v[154:155], v[154:155], v[140:141]
  v_pk_fma_f32 v[160:161], v[126:127], v[126:127], v[160:161]
  v_pk_add_f32 v[152:153], v[152:153], v[126:127]
  v_pk_fma_f32 v[162:163], v[142:143], v[142:143], v[162:163]
  v_pk_add_f32 v[154:155], v[154:155], v[142:143]
  v_pk_fma_f32 v[160:161], v[128:129], v[128:129], v[160:161]
  v_pk_add_f32 v[152:153], v[152:153], v[128:129]
  v_pk_fma_f32 v[162:163], v[144:145], v[144:145], v[162:163]
  v_pk_add_f32 v[154:155], v[154:155], v[144:145]
  v_pk_fma_f32 v[160:161], v[130:131], v[130:131], v[160:161]
  v_pk_add_f32 v[152:153], v[152:153], v[130:131]
  v_pk_fma_f32 v[162:163], v[146:147], v[146:147], v[162:163]
  v_pk_add_f32 v[154:155], v[154:155], v[146:147]
  v_pk_fma_f32 v[160:161], v[132:133], v[132:133], v[160:161]
  v_pk_add_f32 v[152:153], v[152:153], v[132:133]
  v_pk_fma_f32 v[162:163], v[148:149], v[148:149], v[162:163]
  v_pk_add_f32 v[154:155], v[154:155], v[148:149]
  v_pk_fma_f32 v[160:161], v[134:135], v[134:135], v[160:161]
  v_pk_add_f32 v[152:153], v[152:153], v[134:135]
  v_pk_fma_f32 v[162:163], v[150:151], v[150:151], v[162:163]
  v_pk_add_f32 v[154:155], v[154:155], v[150:151]
  v_add_f32 v152, v152, v153
  v_add_f32 v153, v160, v161
  v_add_f32 v154, v154, v155
  v_add_f32 v155, v162, v163
  v_mov_b32 v160, v152
  v_mov_b32 v161, v153
  v_mov_b32 v162, v154
  v_mov_b32 v163, v155
  s_nop 1
  v_permlane16_swap_b32 v160, v152
  v_permlane16_swap_b32 v161, v153
  v_permlane16_swap_b32 v162, v154
  v_permlane16_swap_b32 v163, v155
  s_nop 1
  v_add_f32 v152, v152, v160
  v_add_f32 v153, v153, v161
  v_add_f32 v154, v154, v162
  v_add_f32 v155, v155, v163
  v_mov_b32 v160, v152
  v_mov_b32 v161, v153
  v_mov_b32 v162, v154
  v_mov_b32 v163, v155
  s_nop 1
  v_permlane32_swap_b32 v160, v152
  v_permlane32_swap_b32 v161, v153
  v_permlane32_swap_b32 v162, v154
  v_permlane32_swap_b32 v163, v155
  s_nop 1
  v_add_f32 v152, v152, v160
  v_add_f32 v153, v153, v161
  v_add_f32 v154, v154, v162
  v_add_f32 v155, v155, v163
  v_mul_f32 v160, 0xbc800000, v152
  v_mul_f32 v161, 0xbc800000, v154
  v_fmac_f32 v153, v160, v152
  v_fmac_f32 v155, v161, v154
  v_and_or_b32 v156, v152, v81, s44
  v_and_or_b32 v157, v153, v81, s45
  v_and_or_b32 v158, v154, v81, s46
  v_and_or_b32 v159, v155, v81, s47
  s_mov_b64 exec, 0xffff
  buffer_store_dwordx4 v[156:159], v80, s[52:55], s57 offen sc1
  s_mov_b64 exec, -1
  s_add_u32 m0, s38, 0
  s_nop 0
  buffer_load_dwordx4 v225, s[8:11], s17 offen lds
  buffer_load_dwordx4 v226, s[8:11], s17 offen offset:1024 lds
  buffer_load_dwordx4 v227, s[8:11], s17 offen offset:2048 lds
  s_mov_b32 exec_hi, 0
  buffer_load_dwordx4 v228, s[8:11], s17 offen offset:3072 lds
  s_mov_b32 exec_hi, -1
  s_add_u32 s17, s17, s96
  s_add_u32 m0, s38, 14336
  s_nop 0
  buffer_load_dwordx4 v225, s[8:11], s17 offen lds
  buffer_load_dwordx4 v226, s[8:11], s17 offen offset:1024 lds
  buffer_load_dwordx4 v227, s[8:11], s17 offen offset:2048 lds
  s_mov_b32 exec_hi, 0
  buffer_load_dwordx4 v228, s[8:11], s17 offen offset:3072 lds
  s_mov_b32 exec_hi, -1
  s_add_u32 s17, s17, s97
  s_add_u32 m0, s38, 28672
  s_nop 0
  buffer_load_dwordx4 v225, s[8:11], s17 offen lds
  buffer_load_dwordx4 v226, s[8:11], s17 offen offset:1024 lds
  buffer_load_dwordx4 v227, s[8:11], s17 offen offset:2048 lds
  s_mov_b32 exec_hi, 0
  buffer_load_dwordx4 v228, s[8:11], s17 offen offset:3072 lds
  s_mov_b32 exec_hi, -1
  s_add_u32 s17, s17, s98
  v_cvt_pk_bf16_f32 v48, v120, v121
  v_cvt_pk_bf16_f32 v49, v122, v123
  v_cvt_pk_bf16_f32 v50, v124, v125
  v_cvt_pk_bf16_f32 v51, v126, v127
  v_cvt_pk_bf16_f32 v52, v128, v129
  v_cvt_pk_bf16_f32 v53, v130, v131
  v_cvt_pk_bf16_f32 v54, v132, v133
  v_cvt_pk_bf16_f32 v55, v134, v135
  v_cvt_pk_bf16_f32 v56, v136, v137
  v_cvt_pk_bf16_f32 v57, v138, v139
  v_cvt_pk_bf16_f32 v58, v140, v141
  v_cvt_pk_bf16_f32 v59, v142, v143
  v_cvt_pk_bf16_f32 v60, v144, v145
  v_cvt_pk_bf16_f32 v61, v146, v147
  v_cvt_pk_bf16_f32 v62, v148, v149
  v_cvt_pk_bf16_f32 v63, v150, v151
  v_accvgpr_write_b32 a128, v48
  v_lshlrev_b32 v0, 16, v48
  v_and_b32 v1, 0xffff0000, v48
  v_accvgpr_write_b32 a129, v49
  v_lshlrev_b32 v2, 16, v49
  v_and_b32 v3, 0xffff0000, v49
  v_accvgpr_write_b32 a130, v50
  v_lshlrev_b32 v4, 16, v50
  v_and_b32 v5, 0xffff0000, v50
  v_accvgpr_write_b32 a131, v51
  v_lshlrev_b32 v6, 16, v51
  v_and_b32 v7, 0xffff0000, v51
  v_accvgpr_write_b32 a132, v52
  v_lshlrev_b32 v8, 16, v52
  v_and_b32 v9, 0xffff0000, v52
  v_accvgpr_write_b32 a133, v53
  v_lshlrev_b32 v10, 16, v53
  v_and_b32 v11, 0xffff0000, v53
  v_accvgpr_write_b32 a134, v54
  v_lshlrev_b32 v12, 16, v54
  v_and_b32 v13, 0xffff0000, v54
  v_accvgpr_write_b32 a135, v55
  v_lshlrev_b32 v14, 16, v55
  v_and_b32 v15, 0xffff0000, v55
  v_accvgpr_write_b32 a136, v56
  v_lshlrev_b32 v16, 16, v56
  v_and_b32 v17, 0xffff0000, v56
  v_accvgpr_write_b32 a137, v57
  v_lshlrev_b32 v18, 16, v57
  v_and_b32 v19, 0xffff0000, v57
  v_accvgpr_write_b32 a138, v58
  v_lshlrev_b32 v20, 16, v58
  v_and_b32 v21, 0xffff0000, v58
  v_accvgpr_write_b32 a139, v59
  v_lshlrev_b32 v22, 16, v59
  v_and_b32 v23, 0xffff0000, v59
  v_accvgpr_write_b32 a140, v60
  v_lshlrev_b32 v24, 16, v60
  v_and_b32 v25, 0xffff0000, v60
  v_accvgpr_write_b32 a141, v61
  v_lshlrev_b32 v26, 16, v61
  v_and_b32 v27, 0xffff0000, v61
  v_accvgpr_write_b32 a142, v62
  v_lshlrev_b32 v28, 16, v62
  v_and_b32 v29, 0xffff0000, v62
  v_accvgpr_write_b32 a143, v63
  v_lshlrev_b32 v30, 16, v63
  v_and_b32 v31, 0xffff0000, v63
  s_add_u32 s48, s20, 0xa00000
  s_addc_u32 s49, s21, 0
  s_mov_b32 s50, 0x400000
  s_mov_b32 s51, 0x20000
  s_mov_b32 s59, 262144
L_poll_17:
  buffer_load_dwordx4 v[88:91], v80, s[52:55], s56 offen offset:0 sc1
  buffer_load_dwordx4 v[92:95], v80, s[52:55], s56 offen offset:1024 sc1
  buffer_load_dwordx4 v[96:99], v80, s[52:55], s56 offen offset:2048 sc1
  buffer_load_dwordx4 v[100:103], v80, s[52:55], s56 offen offset:3072 sc1
  s_waitcnt vmcnt(3)
  v_xor_b32 v88, s44, v88
  v_xor_b32 v89, s45, v89
  v_xor_b32 v90, s46, v90
  v_xor_b32 v91, s47, v91
  v_or3_b32 v160, v88, v89, v90
  v_or_b32 v160, v160, v91
  s_waitcnt vmcnt(2)
  v_xor_b32 v92, s44, v92
  v_xor_b32 v93, s45, v93
  v_xor_b32 v94, s46, v94
  v_xor_b32 v95, s47, v95
  v_or3_b32 v160, v160, v92, v93
  v_or3_b32 v160, v160, v94, v95
  s_waitcnt vmcnt(1)
  v_xor_b32 v96, s44, v96
  v_xor_b32 v97, s45, v97
  v_xor_b32 v98, s46, v98
  v_xor_b32 v99, s47, v99
  v_or3_b32 v160, v160, v96, v97
  v_or3_b32 v160, v160, v98, v99
  s_waitcnt vmcnt(0)
  v_xor_b32 v100, s44, v100
  v_xor_b32 v101, s45, v101
  v_xor_b32 v102, s46, v102
  v_xor_b32 v103, s47, v103
  v_or3_b32 v160, v160, v100, v101
  v_or3_b32 v160, v160, v102, v103
  v_and_b32 v160, 0xff, v160
  v_cmp_ne_u32 vcc, 0, v160
  s_nop 1
  s_cmp_eq_u64 vcc, 0
  s_cbranch_scc1 L_ready_18
  s_sub_u32 s59, s59, 1
  s_cmp_lg_u32 s59, 0
  s_cbranch_scc1 L_poll_17
L_ready_18:
  v_mul_f32 v104, 0x3c800000, v88
  v_mul_f32 v105, 0x3c800000, v90
  v_mul_f32 v106, 0x3c800000, v92
  v_mul_f32 v107, 0x3c800000, v94
  v_mul_f32 v108, 0x3c800000, v96
  v_mul_f32 v109, 0x3c800000, v98
  v_mul_f32 v110, 0x3c800000, v100
  v_mul_f32 v111, 0x3c800000, v102
  v_fmac_f32 v89, v104, v88
  v_fmac_f32 v91, v105, v90
  v_fmac_f32 v93, v106, v92
  v_fmac_f32 v95, v107, v94
  v_fmac_f32 v97, v108, v96
  v_fmac_f32 v99, v109, v98
  v_fmac_f32 v101, v110, v100
  v_fmac_f32 v103, v111, v102
  v_pk_add_f32 v[152:153], v[88:89], v[92:93]
  v_pk_add_f32 v[160:161], v[96:97], v[100:101]
  v_pk_add_f32 v[154:155], v[90:91], v[94:95]
  v_pk_add_f32 v[162:163], v[98:99], v[102:103]
  v_pk_add_f32 v[152:153], v[152:153], v[160:161]
  v_pk_add_f32 v[154:155], v[154:155], v[162:163]
  v_mov_b32 v160, v152
  v_mov_b32 v161, v153
  v_mov_b32 v162, v154
  v_mov_b32 v163, v155
  s_nop 1
  v_permlane16_swap_b32 v160, v152
  v_permlane16_swap_b32 v161, v153
  v_permlane16_swap_b32 v162, v154
  v_permlane16_swap_b32 v163, v155
  s_nop 1
  v_add_f32 v152, v152, v160
  v_add_f32 v153, v153, v161
  v_add_f32 v154, v154, v162
  v_add_f32 v155, v155, v163
  v_mov_b32 v160, v152
  v_mov_b32 v161, v153
  v_mov_b32 v162, v154
  v_mov_b32 v163, v155
  s_nop 1
  v_permlane32_swap_b32 v160, v152
  v_permlane32_swap_b32 v161, v153
  v_permlane32_swap_b32 v162, v154
  v_permlane32_swap_b32 v163, v155
  s_nop 1
  v_add_f32 v152, v152, v160
  v_add_f32 v153, v153, v161
  v_add_f32 v154, v154, v162
  v_add_f32 v155, v155, v163
  v_mul_f32 v120, 0x3a800000, v152
  v_mul_f32 v124, 0x3a800000, v153
  v_mul_f32 v132, 0x3a800000, v154
  v_mul_f32 v136, 0x3a800000, v155
  v_fma_f32 v124, -v120, v120, v124
  v_fma_f32 v136, -v132, v132, v136
  v_max_f32 v124, 0, v124
  v_max_f32 v136, 0, v136
  v_cvt_pk_bf16_f32 v128, v120, v124
  v_lshlrev_b32 v120, 16, v128
  v_and_b32 v124, 0xffff0000, v128
  v_add_f32 v124, 0x3727c5ac, v124
  v_cvt_pk_bf16_f32 v128, v124, v125
  v_lshlrev_b32 v124, 16, v128
  v_and_b32 v125, 0xffff0000, v128
  v_sqrt_f32 v124, v124
  s_nop 0
  v_cvt_pk_bf16_f32 v128, v124, v125
  v_lshlrev_b32 v124, 16, v128
  v_and_b32 v125, 0xffff0000, v128
  v_rcp_f32 v124, v124
  v_mov_b32 v121, v120
  s_nop 0
  v_mov_b32 v125, v124
  v_cvt_pk_bf16_f32 v140, v132, v136
  v_lshlrev_b32 v132, 16, v140
  v_and_b32 v136, 0xffff0000, v140
  v_add_f32 v136, 0x3727c5ac, v136
  v_cvt_pk_bf16_f32 v140, v136, v137
  v_lshlrev_b32 v136, 16, v140
  v_and_b32 v137, 0xffff0000, v140
  v_sqrt_f32 v136, v136
  s_nop 0
  v_cvt_pk_bf16_f32 v140, v136, v137
  v_lshlrev_b32 v136, 16, v140
  v_and_b32 v137, 0xffff0000, v140
  v_rcp_f32 v136, v136
  v_mov_b32 v133, v132
  s_nop 0
  v_mov_b32 v137, v136
  v_pk_add_f32 v[0:1], v[0:1], v[120:121] neg_lo:[0,1] neg_hi:[0,1]
  v_pk_add_f32 v[2:3], v[2:3], v[120:121] neg_lo:[0,1] neg_hi:[0,1]
  v_pk_add_f32 v[4:5], v[4:5], v[120:121] neg_lo:[0,1] neg_hi:[0,1]
  v_pk_add_f32 v[6:7], v[6:7], v[120:121] neg_lo:[0,1] neg_hi:[0,1]
  v_pk_add_f32 v[8:9], v[8:9], v[120:121] neg_lo:[0,1] neg_hi:[0,1]
  v_pk_add_f32 v[10:11], v[10:11], v[120:121] neg_lo:[0,1] neg_hi:[0,1]
  v_pk_add_f32 v[12:13], v[12:13], v[120:121] neg_lo:[0,1] neg_hi:[0,1]
  v_pk_add_f32 v[14:15], v[14:15], v[120:121] neg_lo:[0,1] neg_hi:[0,1]
  v_pk_mul_f32 v[0:1], v[0:1], v[124:125]
  v_pk_mul_f32 v[2:3], v[2:3], v[124:125]
  v_pk_mul_f32 v[4:5], v[4:5], v[124:125]
  v_pk_mul_f32 v[6:7], v[6:7], v[124:125]
  v_pk_mul_f32 v[8:9], v[8:9], v[124:125]
  v_pk_mul_f32 v[10:11], v[10:11], v[124:125]
  v_pk_mul_f32 v[12:13], v[12:13], v[124:125]
  v_pk_mul_f32 v[14:15], v[14:15], v[124:125]
  v_pk_fma_f32 v[0:1], v[0:1], v[184:185], v[168:169]
  v_pk_fma_f32 v[2:3], v[2:3], v[186:187], v[170:171]
  v_pk_fma_f32 v[4:5], v[4:5], v[188:189], v[172:173]
  v_pk_fma_f32 v[6:7], v[6:7], v[190:191], v[174:175]
  v_pk_fma_f32 v[8:9], v[8:9], v[192:193], v[176:177]
  v_pk_fma_f32 v[10:11], v[10:11], v[194:195], v[178:179]
  v_pk_fma_f32 v[12:13], v[12:13], v[196:197], v[180:181]
  v_pk_fma_f32 v[14:15], v[14:15], v[198:199], v[182:183]
  v_cvt_pk_bf16_f32 v88, v0, v1
  v_cvt_pk_bf16_f32 v89, v2, v3
  v_cvt_pk_bf16_f32 v90, v4, v5
  v_cvt_pk_bf16_f32 v91, v6, v7
  v_cvt_pk_bf16_f32 v92, v8, v9
  v_cvt_pk_bf16_f32 v93, v10, v11
  v_cvt_pk_bf16_f32 v94, v12, v13
  v_cvt_pk_bf16_f32 v95, v14, v15
  buffer_store_dwordx4 v[88:91], v33, s[48:51], s41 offen offset:0 sc1
  buffer_store_dwordx4 v[92:95], v33, s[48:51], s42 offen offset:0 sc1
  v_pk_add_f32 v[16:17], v[16:17], v[132:133] neg_lo:[0,1] neg_hi:[0,1]
  v_pk_add_f32 v[18:19], v[18:19], v[132:133] neg_lo:[0,1] neg_hi:[0,1]
  v_pk_add_f32 v[20:21], v[20:21], v[132:133] neg_lo:[0,1] neg_hi:[0,1]
  v_pk_add_f32 v[22:23], v[22:23], v[132:133] neg_lo:[0,1] neg_hi:[0,1]
  v_pk_add_f32 v[24:25], v[24:25], v[132:133] neg_lo:[0,1] neg_hi:[0,1]
  v_pk_add_f32 v[26:27], v[26:27], v[132:133] neg_lo:[0,1] neg_hi:[0,1]
  v_pk_add_f32 v[28:29], v[28:29], v[132:133] neg_lo:[0,1] neg_hi:[0,1]
  v_pk_add_f32 v[30:31], v[30:31], v[132:133] neg_lo:[0,1] neg_hi:[0,1]
  v_pk_mul_f32 v[16:17], v[16:17], v[136:137]
  v_pk_mul_f32 v[18:19], v[18:19], v[136:137]
  v_pk_mul_f32 v[20:21], v[20:21], v[136:137]
  v_pk_mul_f32 v[22:23], v[22:23], v[136:137]
  v_pk_mul_f32 v[24:25], v[24:25], v[136:137]
  v_pk_mul_f32 v[26:27], v[26:27], v[136:137]
  v_pk_mul_f32 v[28:29], v[28:29], v[136:137]
  v_pk_mul_f32 v[30:31], v[30:31], v[136:137]
  v_pk_fma_f32 v[16:17], v[16:17], v[184:185], v[168:169]
  v_pk_fma_f32 v[18:19], v[18:19], v[186:187], v[170:171]
  v_pk_fma_f32 v[20:21], v[20:21], v[188:189], v[172:173]
  v_pk_fma_f32 v[22:23], v[22:23], v[190:191], v[174:175]
  v_pk_fma_f32 v[24:25], v[24:25], v[192:193], v[176:177]
  v_pk_fma_f32 v[26:27], v[26:27], v[194:195], v[178:179]
  v_pk_fma_f32 v[28:29], v[28:29], v[196:197], v[180:181]
  v_pk_fma_f32 v[30:31], v[30:31], v[198:199], v[182:183]
  v_cvt_pk_bf16_f32 v96, v16, v17
  v_cvt_pk_bf16_f32 v97, v18, v19
  v_cvt_pk_bf16_f32 v98, v20, v21
  v_cvt_pk_bf16_f32 v99, v22, v23
  v_cvt_pk_bf16_f32 v100, v24, v25
  v_cvt_pk_bf16_f32 v101, v26, v27
  v_cvt_pk_bf16_f32 v102, v28, v29
  v_cvt_pk_bf16_f32 v103, v30, v31
  buffer_store_dwordx4 v[96:99], v33, s[48:51], s41 offen offset:1024 sc1
  buffer_store_dwordx4 v[100:103], v33, s[48:51], s42 offen offset:1024 sc1
  s_add_u32 s64, s20, 0xb0000
  s_addc_u32 s65, s21, 0
  s_mov_b32 s66, 0x10000
  s_mov_b32 s67, 0x20000
  s_lshl_b32 s32, s30, 2
  s_add_u32 s32, s32, s3
  s_lshl_b32 s32, s32, 4
  s_add_u32 s32, s32, s31
  s_lshl_b32 s32, s32, 6
  s_mov_b32 s30, s94
  s_mov_b32 s31, s95
  s_lshl_b32 s33, s30, 2
  s_add_u32 s33, s33, s3
  s_lshl_b32 s68, s33, 11
  v_lshlrev_b32 v250, 2, v231
  v_mov_b32 v248, s19
  v_and_b32 v246, 31, v231
  v_and_b32 v245, 17, v246
  v_lshlrev_b32 v245, 6, v245
  v_lshlrev_b32 v246, 6, v246
  s_mov_b64 s[24:25], s[60:61]
  s_mov_b64 s[26:27], s[62:63]
  s_add_u32 s4, s20, 0xa00000
  s_addc_u32 s5, s21, 0
  s_mov_b32 s6, 0x400000
  s_mov_b32 s7, 0x20000
  s_bfe_u32 s33, s2, 0x20003
  s_mul_i32 s16, s33, 131072
  s_cmp_eq_u32 s33, 3
  s_cselect_b32 s44, -3, 1
  s_mul_i32 s44, s44, 131072
  s_cmp_eq_u32 s33, 2
  s_cselect_b32 s45, -3, 1
  s_mul_i32 s45, s45, 131072
  s_cmp_eq_u32 s33, 1
  s_cselect_b32 s46, -3, 1
  s_mul_i32 s46, s46, 131072
  s_cmp_eq_u32 s33, 0
  s_cselect_b32 s47, 1, 5
  s_mul_i32 s47, s47, 131072
  s_waitcnt vmcnt(0)
  s_mov_b64 exec, 1
  buffer_store_dword v248, v250, s[64:67], s32 offen sc1
  s_mov_b64 exec, -1
  s_mov_b32 s34, 262144
L_spin_19:
  buffer_load_dword v247, v245, s[64:67], s68 offen sc1
  s_waitcnt vmcnt(0)
  v_cmp_ne_u32 vcc, s19, v247
  s_nop 1
  s_cmp_eq_u64 vcc, 0
  s_cbranch_scc1 L_rdy_20
  s_sub_u32 s34, s34, 1
  s_cmp_lg_u32 s34, 0
  s_cbranch_scc1 L_spin_19
L_rdy_20:
  buffer_load_dwordx4 a[0:3], v224, s[4:7], s16 offen offset:0 sc1
  buffer_load_dwordx4 a[4:7], v224, s[4:7], s16 offen offset:1024 sc1
  buffer_load_dwordx4 a[8:11], v224, s[4:7], s16 offen offset:2048 sc1
  buffer_load_dwordx4 a[12:15], v224, s[4:7], s16 offen offset:3072 sc1
  s_add_u32 s16, s16, s44
  buffer_load_dwordx4 a[16:19], v224, s[4:7], s16 offen offset:0 sc1
  buffer_load_dwordx4 a[20:23], v224, s[4:7], s16 offen offset:1024 sc1
  buffer_load_dwordx4 a[24:27], v224, s[4:7], s16 offen offset:2048 sc1
  buffer_load_dwordx4 a[28:31], v224, s[4:7], s16 offen offset:3072 sc1
  s_add_u32 s16, s16, s45
  s_bitcmp1_b32 s3, 0
  s_cselect_b32 s52, s26, s24
  s_cselect_b32 s53, s27, s25
  s_cselect_b32 s60, 3670016, 0
  s_mov_b32 s54, 7340032
  s_mov_b32 s55, 0x20000
  s_lshl_b32 s56, s2, 1
  s_lshr_b32 s59, s3, 1
  s_add_u32 s56, s56, s59
  s_lshl_b32 s56, s56, 10
  s_add_u32 s60, s60, s56
  s_add_u32 s56, s56, 1048576
  s_mov_b32 s59, 0
  v_lshrrev_b32 v249, 3, v231
  v_lshlrev_b32 v249, 7, v249
  v_and_b32 v251, 0, v231
  v_lshl_add_u32 v249, v251, 19, v249
  s_mov_b32 s52, s22
  s_mov_b32 s53, s23
  s_mov_b32 s56, s60
  s_add_u32 s12, s20, 0x1600000
  s_addc_u32 s13, s21, 0
  s_mov_b32 s14, 0xe00000
  s_mov_b32 s15, 0x20000
  v_lshrrev_b32 v234, 2, v231
  v_mul_u32_u24 v234, 224, v234
  v_and_b32 v235, 3, v231
  v_lshl_add_u32 v229, v235, 3, v234
  v_add_u32 v229, 98304, v229
  v_add_u32 v230, 57344, v229
  s_waitcnt vmcnt(16)
  s_barrier
  ds_read_b64_tr_b16 a[64:65], v229 offset:0
  ds_read_b64_tr_b16 a[66:67], v229 offset:3584
  ds_read_b64_tr_b16 a[68:69], v229 offset:32
  ds_read_b64_tr_b16 a[70:71], v229 offset:3616
  ds_read_b64_tr_b16 a[72:73], v229 offset:64
  ds_read_b64_tr_b16 a[74:75], v229 offset:3648
  ds_read_b64_tr_b16 a[76:77], v229 offset:96
  ds_read_b64_tr_b16 a[78:79], v229 offset:3680
  ds_read_b64_tr_b16 a[80:81], v229 offset:128
  ds_read_b64_tr_b16 a[82:83], v229 offset:3712
  ds_read_b64_tr_b16 a[84:85], v229 offset:160
  ds_read_b64_tr_b16 a[86:87], v229 offset:3744
  ds_read_b64_tr_b16 a[88:89], v229 offset:192
  ds_read_b64_tr_b16 a[90:91], v229 offset:3776
  ds_read_b64_tr_b16 a[92:93], v229 offset:7168
  ds_read_b64_tr_b16 a[94:95], v229 offset:10752
  ds_read_b64_tr_b16 a[96:97], v229 offset:7200
  ds_read_b64_tr_b16 a[98:99], v229 offset:10784
  ds_read_b64_tr_b16 a[100:101], v229 offset:7232
  ds_read_b64_tr_b16 a[102:103], v229 offset:10816
  ds_read_b64_tr_b16 a[104:105], v229 offset:7264
  ds_read_b64_tr_b16 a[106:107], v229 offset:10848
  ds_read_b64_tr_b16 a[108:109], v229 offset:7296
  ds_read_b64_tr_b16 a[110:111], v229 offset:10880
  ds_read_b64_tr_b16 a[112:113], v229 offset:7328
  ds_read_b64_tr_b16 a[114:115], v229 offset:10912
  ds_read_b64_tr_b16 a[116:117], v229 offset:7360
  ds_read_b64_tr_b16 a[118:119], v229 offset:10944
  s_waitcnt vmcnt(4) lgkmcnt(10)
  s_barrier
  buffer_load_dword v247, v246, s[64:67], s68 offen sc1
  v_mfma_f32_16x16x32_bf16 v[0:3], a[64:67], a[0:3], 0
  s_add_u32 m0, s38, 43008
  v_mfma_f32_16x16x32_bf16 v[56:59], a[64:67], a[4:7], 0
  buffer_load_dwordx4 v225, s[8:11], s17 offen lds
  v_mfma_f32_16x16x32_bf16 v[112:115], a[64:67], a[8:11], 0
  v_mfma_f32_16x16x32_bf16 v[168:171], a[64:67], a[12:15], 0
  ds_read_b64_tr_b16 a[64:65], v229 offset:14336
  ds_read_b64_tr_b16 a[66:67], v229 offset:17920
  v_mfma_f32_16x16x32_bf16 v[4:7], a[68:71], a[0:3], 0
  v_mfma_f32_16x16x32_bf16 v[60:63], a[68:71], a[4:7], 0
  buffer_load_dwordx4 a[32:35], v224, s[4:7], s16 offen offset:0 sc1
  v_mfma_f32_16x16x32_bf16 v[116:119], a[68:71], a[8:11], 0
  v_mfma_f32_16x16x32_bf16 v[172:175], a[68:71], a[12:15], 0
  ds_read_b64_tr_b16 a[68:69], v229 offset:14368
  ds_read_b64_tr_b16 a[70:71], v229 offset:17952
  v_mfma_f32_16x16x32_bf16 v[8:11], a[72:75], a[0:3], 0
  v_mfma_f32_16x16x32_bf16 v[64:67], a[72:75], a[4:7], 0
  v_mfma_f32_16x16x32_bf16 v[120:123], a[72:75], a[8:11], 0
  buffer_load_dwordx4 v226, s[8:11], s17 offen offset:1024 lds
  v_mfma_f32_16x16x32_bf16 v[176:179], a[72:75], a[12:15], 0
  ds_read_b64_tr_b16 a[72:73], v229 offset:14400
  ds_read_b64_tr_b16 a[74:75], v229 offset:17984
  v_mfma_f32_16x16x32_bf16 v[12:15], a[76:79], a[0:3], 0
  v_mfma_f32_16x16x32_bf16 v[68:71], a[76:79], a[4:7], 0
  v_mfma_f32_16x16x32_bf16 v[124:127], a[76:79], a[8:11], 0
  buffer_load_dwordx4 a[36:39], v224, s[4:7], s16 offen offset:1024 sc1
  v_mfma_f32_16x16x32_bf16 v[180:183], a[76:79], a[12:15], 0
  ds_read_b64_tr_b16 a[76:77], v229 offset:14432
  ds_read_b64_tr_b16 a[78:79], v229 offset:18016
  v_mfma_f32_16x16x32_bf16 v[16:19], a[80:83], a[0:3], 0
  v_mfma_f32_16x16x32_bf16 v[72:75], a[80:83], a[4:7], 0
  v_mfma_f32_16x16x32_bf16 v[128:131], a[80:83], a[8:11], 0
  v_mfma_f32_16x16x32_bf16 v[184:187], a[80:83], a[12:15], 0
  buffer_load_dwordx4 v227, s[8:11], s17 offen offset:2048 lds
  v_mfma_f32_16x16x32_bf16 v[20:23], a[84:87], a[0:3], 0
  ds_read_b64_tr_b16 a[80:81], v229 offset:14464
  ds_read_b64_tr_b16 a[82:83], v229 offset:18048
  v_mfma_f32_16x16x32_bf16 v[76:79], a[84:87], a[4:7], 0
  v_mfma_f32_16x16x32_bf16 v[132:135], a[84:87], a[8:11], 0
  v_mfma_f32_16x16x32_bf16 v[188:191], a[84:87], a[12:15], 0
  buffer_load_dwordx4 a[40:43], v224, s[4:7], s16 offen offset:2048 sc1
  v_mfma_f32_16x16x32_bf16 v[24:27], a[88:91], a[0:3], 0
  ds_read_b64_tr_b16 a[84:85], v229 offset:14496
  ds_read_b64_tr_b16 a[86:87], v229 offset:18080
  v_mfma_f32_16x16x32_bf16 v[80:83], a[88:91], a[4:7], 0
  v_mfma_f32_16x16x32_bf16 v[136:139], a[88:91], a[8:11], 0
  v_mfma_f32_16x16x32_bf16 v[192:195], a[88:91], a[12:15], 0
  ds_read_b64_tr_b16 a[88:89], v229 offset:14528
  ds_read_b64_tr_b16 a[90:91], v229 offset:18112
  v_mfma_f32_16x16x32_bf16 v[28:31], a[92:95], a[0:3], 0
  s_mov_b32 exec_hi, 0
  buffer_load_dwordx4 v228, s[8:11], s17 offen offset:3072 lds
  s_mov_b32 exec_hi, -1
  v_mfma_f32_16x16x32_bf16 v[84:87], a[92:95], a[4:7], 0
  s_add_u32 s17, s17, s99
  v_mfma_f32_16x16x32_bf16 v[140:143], a[92:95], a[8:11], 0
  v_mfma_f32_16x16x32_bf16 v[196:199], a[92:95], a[12:15], 0
  ds_read_b64_tr_b16 a[92:93], v229 offset:21504
  ds_read_b64_tr_b16 a[94:95], v229 offset:25088
  v_mfma_f32_16x16x32_bf16 v[32:35], a[96:99], a[0:3], 0
  v_mfma_f32_16x16x32_bf16 v[88:91], a[96:99], a[4:7], 0
  buffer_load_dwordx4 a[44:47], v224, s[4:7], s16 offen offset:3072 sc1
  v_mfma_f32_16x16x32_bf16 v[144:147], a[96:99], a[8:11], 0
  s_add_u32 s16, s16, s46
  v_mfma_f32_16x16x32_bf16 v[200:203], a[96:99], a[12:15], 0
  ds_read_b64_tr_b16 a[96:97], v229 offset:21536
  ds_read_b64_tr_b16 a[98:99], v229 offset:25120
  s_waitcnt lgkmcnt(10)
  v_mfma_f32_16x16x32_bf16 v[36:39], a[100:103], a[0:3], 0
  v_mfma_f32_16x16x32_bf16 v[92:95], a[100:103], a[4:7], 0
  buffer_load_dwordx4 a[48:51], v224, s[4:7], s16 offen offset:0 sc1
  v_mfma_f32_16x16x32_bf16 v[148:151], a[100:103], a[8:11], 0
  v_mfma_f32_16x16x32_bf16 v[204:207], a[100:103], a[12:15], 0
  ds_read_b64_tr_b16 a[100:101], v229 offset:21568
  ds_read_b64_tr_b16 a[102:103], v229 offset:25152
  v_mfma_f32_16x16x32_bf16 v[40:43], a[104:107], a[0:3], 0
  v_mfma_f32_16x16x32_bf16 v[96:99], a[104:107], a[4:7], 0
  v_mfma_f32_16x16x32_bf16 v[152:155], a[104:107], a[8:11], 0
  buffer_load_dwordx4 a[52:55], v224, s[4:7], s16 offen offset:1024 sc1
  v_mfma_f32_16x16x32_bf16 v[208:211], a[104:107], a[12:15], 0
  ds_read_b64_tr_b16 a[104:105], v229 offset:21600
  ds_read_b64_tr_b16 a[106:107], v229 offset:25184
  v_mfma_f32_16x16x32_bf16 v[44:47], a[108:111], a[0:3], 0
  v_mfma_f32_16x16x32_bf16 v[100:103], a[108:111], a[4:7], 0
  v_mfma_f32_16x16x32_bf16 v[156:159], a[108:111], a[8:11], 0
  buffer_load_dwordx4 a[56:59], v224, s[4:7], s16 offen offset:2048 sc1
  v_mfma_f32_16x16x32_bf16 v[212:215], a[108:111], a[12:15], 0
  ds_read_b64_tr_b16 a[108:109], v229 offset:21632
  ds_read_b64_tr_b16 a[110:111], v229 offset:25216
  v_mfma_f32_16x16x32_bf16 v[48:51], a[112:115], a[0:3], 0
  v_mfma_f32_16x16x32_bf16 v[104:107], a[112:115], a[4:7], 0
  v_mfma_f32_16x16x32_bf16 v[160:163], a[112:115], a[8:11], 0
  v_mfma_f32_16x16x32_bf16 v[216:219], a[112:115], a[12:15], 0
  buffer_load_dwordx4 a[60:63], v224, s[4:7], s16 offen offset:3072 sc1
  v_mfma_f32_16x16x32_bf16 v[52:55], a[116:119], a[0:3], 0
  ds_read_b64_tr_b16 a[112:113], v229 offset:21664
  s_add_u32 s16, s16, s47
  v_mfma_f32_16x16x32_bf16 v[108:111], a[116:119], a[4:7], 0
  ds_read_b64_tr_b16 a[114:115], v229 offset:25248
  v_mfma_f32_16x16x32_bf16 v[164:167], a[116:119], a[8:11], 0
  v_mfma_f32_16x16x32_bf16 v[220:223], a[116:119], a[12:15], 0
  s_waitcnt vmcnt(12) lgkmcnt(10)
  s_barrier
  v_cmp_ne_u32 vcc, s19, v247
  s_nop 1
  s_cmp_lg_u64 vcc, 0
  s_cbranch_scc1 L_slow_21
  L_back_22:
  v_mfma_f32_16x16x32_bf16 v[0:3], a[64:67], a[16:19], v[0:3]
  ds_read_b64_tr_b16 a[116:117], v229 offset:21696
  s_add_u32 m0, s38, 0
  v_mfma_f32_16x16x32_bf16 v[56:59], a[64:67], a[20:23], v[56:59]
  buffer_load_dwordx4 v225, s[8:11], s17 offen lds
  v_mfma_f32_16x16x32_bf16 v[112:115], a[64:67], a[24:27], v[112:115]
  ds_read_b64_tr_b16 a[118:119], v229 offset:25280
  v_mfma_f32_16x16x32_bf16 v[168:171], a[64:67], a[28:31], v[168:171]
  ds_read_b64_tr_b16 a[64:65], v229 offset:28672
  ds_read_b64_tr_b16 a[66:67], v229 offset:32256
  v_mfma_f32_16x16x32_bf16 v[4:7], a[68:71], a[16:19], v[4:7]
  v_mfma_f32_16x16x32_bf16 v[60:63], a[68:71], a[20:23], v[60:63]
  v_mfma_f32_16x16x32_bf16 v[116:119], a[68:71], a[24:27], v[116:119]
  v_mfma_f32_16x16x32_bf16 v[172:175], a[68:71], a[28:31], v[172:175]
  buffer_load_dwordx4 a[0:3], v224, s[4:7], s16 offen offset:0 sc1
  v_mfma_f32_16x16x32_bf16 v[8:11], a[72:75], a[16:19], v[8:11]
  ds_read_b64_tr_b16 a[68:69], v229 offset:28704
  ds_read_b64_tr_b16 a[70:71], v229 offset:32288
  v_mfma_f32_16x16x32_bf16 v[64:67], a[72:75], a[20:23], v[64:67]
  v_mfma_f32_16x16x32_bf16 v[120:123], a[72:75], a[24:27], v[120:123]
  v_mfma_f32_16x16x32_bf16 v[176:179], a[72:75], a[28:31], v[176:179]
  ds_read_b64_tr_b16 a[72:73], v229 offset:28736
  ds_read_b64_tr_b16 a[74:75], v229 offset:32320
  v_mfma_f32_16x16x32_bf16 v[12:15], a[76:79], a[16:19], v[12:15]
  v_mfma_f32_16x16x32_bf16 v[68:71], a[76:79], a[20:23], v[68:71]
  buffer_load_dwordx4 v226, s[8:11], s17 offen offset:1024 lds
  v_mfma_f32_16x16x32_bf16 v[124:127], a[76:79], a[24:27], v[124:127]
  v_mfma_f32_16x16x32_bf16 v[180:183], a[76:79], a[28:31], v[180:183]
  ds_read_b64_tr_b16 a[76:77], v229 offset:28768
  ds_read_b64_tr_b16 a[78:79], v229 offset:32352
  v_mfma_f32_16x16x32_bf16 v[16:19], a[80:83], a[16:19], v[16:19]
  v_mfma_f32_16x16x32_bf16 v[72:75], a[80:83], a[20:23], v[72:75]
  v_mfma_f32_16x16x32_bf16 v[128:131], a[80:83], a[24:27], v[128:131]
  v_mfma_f32_16x16x32_bf16 v[184:187], a[80:83], a[28:31], v[184:187]
  buffer_load_dwordx4 a[4:7], v224, s[4:7], s16 offen offset:1024 sc1
  v_mfma_f32_16x16x32_bf16 v[20:23], a[84:87], a[16:19], v[20:23]
  ds_read_b64_tr_b16 a[80:81], v229 offset:28800
  ds_read_b64_tr_b16 a[82:83], v229 offset:32384
  v_mfma_f32_16x16x32_bf16 v[76:79], a[84:87], a[20:23], v[76:79]
  v_mfma_f32_16x16x32_bf16 v[132:135], a[84:87], a[24:27], v[132:135]
  v_mfma_f32_16x16x32_bf16 v[188:191], a[84:87], a[28:31], v[188:191]
  ds_read_b64_tr_b16 a[84:85], v229 offset:28832
  ds_read_b64_tr_b16 a[86:87], v229 offset:32416
  v_mfma_f32_16x16x32_bf16 v[24:27], a[88:91], a[16:19], v[24:27]
  v_mfma_f32_16x16x32_bf16 v[80:83], a[88:91], a[20:23], v[80:83]
  buffer_load_dwordx4 v227, s[8:11], s17 offen offset:2048 lds
  v_mfma_f32_16x16x32_bf16 v[136:139], a[88:91], a[24:27], v[136:139]
  v_mfma_f32_16x16x32_bf16 v[192:195], a[88:91], a[28:31], v[192:195]
  ds_read_b64_tr_b16 a[88:89], v229 offset:28864
  ds_read_b64_tr_b16 a[90:91], v229 offset:32448
  v_mfma_f32_16x16x32_bf16 v[28:31], a[92:95], a[16:19], v[28:31]
  v_mfma_f32_16x16x32_bf16 v[84:87], a[92:95], a[20:23], v[84:87]
  v_mfma_f32_16x16x32_bf16 v[140:143], a[92:95], a[24:27], v[140:143]
  v_mfma_f32_16x16x32_bf16 v[196:199], a[92:95], a[28:31], v[196:199]
  buffer_load_dwordx4 a[8:11], v224, s[4:7], s16 offen offset:2048 sc1
  s_waitcnt lgkmcnt(10)
  v_mfma_f32_16x16x32_bf16 v[32:35], a[96:99], a[16:19], v[32:35]
  ds_read_b64_tr_b16 a[92:93], v229 offset:35840
  ds_read_b64_tr_b16 a[94:95], v229 offset:39424
  v_mfma_f32_16x16x32_bf16 v[88:91], a[96:99], a[20:23], v[88:91]
  v_mfma_f32_16x16x32_bf16 v[144:147], a[96:99], a[24:27], v[144:147]
  v_mfma_f32_16x16x32_bf16 v[200:203], a[96:99], a[28:31], v[200:203]
  ds_read_b64_tr_b16 a[96:97], v229 offset:35872
  ds_read_b64_tr_b16 a[98:99], v229 offset:39456
  v_mfma_f32_16x16x32_bf16 v[36:39], a[100:103], a[16:19], v[36:39]
  v_mfma_f32_16x16x32_bf16 v[92:95], a[100:103], a[20:23], v[92:95]
  s_mov_b32 exec_hi, 0
  buffer_load_dwordx4 v228, s[8:11], s17 offen offset:3072 lds
  s_mov_b32 exec_hi, -1
  v_mfma_f32_16x16x32_bf16 v[148:151], a[100:103], a[24:27], v[148:151]
  s_add_u32 s17, s17, s96
  v_mfma_f32_16x16x32_bf16 v[204:207], a[100:103], a[28:31], v[204:207]
  ds_read_b64_tr_b16 a[100:101], v229 offset:35904
  ds_read_b64_tr_b16 a[102:103], v229 offset:39488
  v_mfma_f32_16x16x32_bf16 v[40:43], a[104:107], a[16:19], v[40:43]
  v_mfma_f32_16x16x32_bf16 v[96:99], a[104:107], a[20:23], v[96:99]
  v_mfma_f32_16x16x32_bf16 v[152:155], a[104:107], a[24:27], v[152:155]
  v_mfma_f32_16x16x32_bf16 v[208:211], a[104:107], a[28:31], v[208:211]
  buffer_load_dwordx4 a[12:15], v224, s[4:7], s16 offen offset:3072 sc1
  v_mfma_f32_16x16x32_bf16 v[44:47], a[108:111], a[16:19], v[44:47]
  ds_read_b64_tr_b16 a[104:105], v229 offset:35936
  s_add_u32 s16, s16, s44
  v_mfma_f32_16x16x32_bf16 v[100:103], a[108:111], a[20:23], v[100:103]
  ds_read_b64_tr_b16 a[106:107], v229 offset:39520
  v_mfma_f32_16x16x32_bf16 v[156:159], a[108:111], a[24:27], v[156:159]
  v_mfma_f32_16x16x32_bf16 v[212:215], a[108:111], a[28:31], v[212:215]
  ds_read_b64_tr_b16 a[108:109], v229 offset:35968
  ds_read_b64_tr_b16 a[110:111], v229 offset:39552
  v_mfma_f32_16x16x32_bf16 v[48:51], a[112:115], a[16:19], v[48:51]
  v_mfma_f32_16x16x32_bf16 v[104:107], a[112:115], a[20:23], v[104:107]
  buffer_load_dword v251, v249, s[52:55], s56 offen
  v_mfma_f32_16x16x32_bf16 v[160:163], a[112:115], a[24:27], v[160:163]
  s_add_u32 s56, s56, 524288
  v_mfma_f32_16x16x32_bf16 v[216:219], a[112:115], a[28:31], v[216:219]
  ds_read_b64_tr_b16 a[112:113], v229 offset:36000
  ds_read_b64_tr_b16 a[114:115], v229 offset:39584
  v_mfma_f32_16x16x32_bf16 v[52:55], a[116:119], a[16:19], v[52:55]
  v_mfma_f32_16x16x32_bf16 v[108:111], a[116:119], a[20:23], v[108:111]
  v_mfma_f32_16x16x32_bf16 v[164:167], a[116:119], a[24:27], v[164:167]
  v_mfma_f32_16x16x32_bf16 v[220:223], a[116:119], a[28:31], v[220:223]
  s_waitcnt vmcnt(13) lgkmcnt(10)
  s_barrier
  v_mfma_f32_16x16x32_bf16 v[0:3], a[64:67], a[32:35], v[0:3]
  ds_read_b64_tr_b16 a[116:117], v229 offset:36032
  s_add_u32 m0, s38, 14336
  v_mfma_f32_16x16x32_bf16 v[56:59], a[64:67], a[36:39], v[56:59]
  buffer_load_dwordx4 v225, s[8:11], s17 offen lds
  v_mfma_f32_16x16x32_bf16 v[112:115], a[64:67], a[40:43], v[112:115]
  ds_read_b64_tr_b16 a[118:119], v229 offset:39616
  v_mfma_f32_16x16x32_bf16 v[168:171], a[64:67], a[44:47], v[168:171]
  ds_read_b64_tr_b16 a[64:65], v229 offset:43008
  ds_read_b64_tr_b16 a[66:67], v229 offset:46592
  v_mfma_f32_16x16x32_bf16 v[4:7], a[68:71], a[32:35], v[4:7]
  v_mfma_f32_16x16x32_bf16 v[60:63], a[68:71], a[36:39], v[60:63]
  v_mfma_f32_16x16x32_bf16 v[116:119], a[68:71], a[40:43], v[116:119]
  v_mfma_f32_16x16x32_bf16 v[172:175], a[68:71], a[44:47], v[172:175]
  buffer_load_dwordx4 a[16:19], v224, s[4:7], s16 offen offset:0 sc1
  v_mfma_f32_16x16x32_bf16 v[8:11], a[72:75], a[32:35], v[8:11]
  ds_read_b64_tr_b16 a[68:69], v229 offset:43040
  ds_read_b64_tr_b16 a[70:71], v229 offset:46624
  v_mfma_f32_16x16x32_bf16 v[64:67], a[72:75], a[36:39], v[64:67]
  v_mfma_f32_16x16x32_bf16 v[120:123], a[72:75], a[40:43], v[120:123]
  v_mfma_f32_16x16x32_bf16 v[176:179], a[72:75], a[44:47], v[176:179]
  ds_read_b64_tr_b16 a[72:73], v229 offset:43072
  ds_read_b64_tr_b16 a[74:75], v229 offset:46656
  v_mfma_f32_16x16x32_bf16 v[12:15], a[76:79], a[32:35], v[12:15]
  v_mfma_f32_16x16x32_bf16 v[68:71], a[76:79], a[36:39], v[68:71]
  v_mfma_f32_16x16x32_bf16 v[124:127], a[76:79], a[40:43], v[124:127]
  buffer_load_dwordx4 v226, s[8:11], s17 offen offset:1024 lds
  v_mfma_f32_16x16x32_bf16 v[180:183], a[76:79], a[44:47], v[180:183]
  ds_read_b64_tr_b16 a[76:77], v229 offset:43104
  ds_read_b64_tr_b16 a[78:79], v229 offset:46688
  v_mfma_f32_16x16x32_bf16 v[16:19], a[80:83], a[32:35], v[16:19]
  v_mfma_f32_16x16x32_bf16 v[72:75], a[80:83], a[36:39], v[72:75]
  v_mfma_f32_16x16x32_bf16 v[128:131], a[80:83], a[40:43], v[128:131]
  v_mfma_f32_16x16x32_bf16 v[184:187], a[80:83], a[44:47], v[184:187]
  ds_read_b64_tr_b16 a[80:81], v229 offset:43136
  ds_read_b64_tr_b16 a[82:83], v229 offset:46720
  v_mfma_f32_16x16x32_bf16 v[20:23], a[84:87], a[32:35], v[20:23]
  v_mfma_f32_16x16x32_bf16 v[76:79], a[84:87], a[36:39], v[76:79]
  buffer_load_dwordx4 a[20:23], v224, s[4:7], s16 offen offset:1024 sc1
  v_mfma_f32_16x16x32_bf16 v[132:135], a[84:87], a[40:43], v[132:135]
  v_mfma_f32_16x16x32_bf16 v[188:191], a[84:87], a[44:47], v[188:191]
  ds_read_b64_tr_b16 a[84:85], v229 offset:43168
  ds_read_b64_tr_b16 a[86:87], v229 offset:46752
  v_mfma_f32_16x16x32_bf16 v[24:27], a[88:91], a[32:35], v[24:27]
  v_mfma_f32_16x16x32_bf16 v[80:83], a[88:91], a[36:39], v[80:83]
  v_mfma_f32_16x16x32_bf16 v[136:139], a[88:91], a[40:43], v[136:139]
  v_mfma_f32_16x16x32_bf16 v[192:195], a[88:91], a[44:47], v[192:195]
  ds_read_b64_tr_b16 a[88:89], v229 offset:43200
  ds_read_b64_tr_b16 a[90:91], v229 offset:46784
  v_mfma_f32_16x16x32_bf16 v[28:31], a[92:95], a[32:35], v[28:31]
  buffer_load_dwordx4 v227, s[8:11], s17 offen offset:2048 lds
  v_mfma_f32_16x16x32_bf16 v[84:87], a[92:95], a[36:39], v[84:87]
  v_mfma_f32_16x16x32_bf16 v[140:143], a[92:95], a[40:43], v[140:143]
  v_mfma_f32_16x16x32_bf16 v[196:199], a[92:95], a[44:47], v[196:199]
  ds_read_b64_tr_b16 a[92:93], v229 offset:50176
  ds_read_b64_tr_b16 a[94:95], v229 offset:53760
  s_waitcnt lgkmcnt(10)
  v_mfma_f32_16x16x32_bf16 v[32:35], a[96:99], a[32:35], v[32:35]
  v_mfma_f32_16x16x32_bf16 v[88:91], a[96:99], a[36:39], v[88:91]
  v_mfma_f32_16x16x32_bf16 v[144:147], a[96:99], a[40:43], v[144:147]
  v_mfma_f32_16x16x32_bf16 v[200:203], a[96:99], a[44:47], v[200:203]
  buffer_load_dwordx4 a[24:27], v224, s[4:7], s16 offen offset:2048 sc1
  v_mfma_f32_16x16x32_bf16 v[36:39], a[100:103], a[32:35], v[36:39]
  ds_read_b64_tr_b16 a[96:97], v229 offset:50208
  ds_read_b64_tr_b16 a[98:99], v229 offset:53792
  v_mfma_f32_16x16x32_bf16 v[92:95], a[100:103], a[36:39], v[92:95]
  v_mfma_f32_16x16x32_bf16 v[148:151], a[100:103], a[40:43], v[148:151]
  v_mfma_f32_16x16x32_bf16 v[204:207], a[100:103], a[44:47], v[204:207]
  ds_read_b64_tr_b16 a[100:101], v229 offset:50240
  ds_read_b64_tr_b16 a[102:103], v229 offset:53824
  v_mfma_f32_16x16x32_bf16 v[40:43], a[104:107], a[32:35], v[40:43]
  v_mfma_f32_16x16x32_bf16 v[96:99], a[104:107], a[36:39], v[96:99]
  v_mfma_f32_16x16x32_bf16 v[152:155], a[104:107], a[40:43], v[152:155]
  s_mov_b32 exec_hi, 0
  buffer_load_dwordx4 v228, s[8:11], s17 offen offset:3072 lds
  s_mov_b32 exec_hi, -1
  v_mfma_f32_16x16x32_bf16 v[208:211], a[104:107], a[44:47], v[208:211]
  ds_read_b64_tr_b16 a[104:105], v229 offset:50272
  s_add_u32 s17, s17, s97
  v_mfma_f32_16x16x32_bf16 v[44:47], a[108:111], a[32:35], v[44:47]
  ds_read_b64_tr_b16 a[106:107], v229 offset:53856
  v_mfma_f32_16x16x32_bf16 v[100:103], a[108:111], a[36:39], v[100:103]
  v_mfma_f32_16x16x32_bf16 v[156:159], a[108:111], a[40:43], v[156:159]
  v_mfma_f32_16x16x32_bf16 v[212:215], a[108:111], a[44:47], v[212:215]
  ds_read_b64_tr_b16 a[108:109], v229 offset:50304
  ds_read_b64_tr_b16 a[110:111], v229 offset:53888
  v_mfma_f32_16x16x32_bf16 v[48:51], a[112:115], a[32:35], v[48:51]
  v_mfma_f32_16x16x32_bf16 v[104:107], a[112:115], a[36:39], v[104:107]
  buffer_load_dwordx4 a[28:31], v224, s[4:7], s16 offen offset:3072 sc1
  v_mfma_f32_16x16x32_bf16 v[160:163], a[112:115], a[40:43], v[160:163]
  s_add_u32 s16, s16, s45
  v_mfma_f32_16x16x32_bf16 v[216:219], a[112:115], a[44:47], v[216:219]
  ds_read_b64_tr_b16 a[112:113], v229 offset:50336
  ds_read_b64_tr_b16 a[114:115], v229 offset:53920
  v_mfma_f32_16x16x32_bf16 v[52:55], a[116:119], a[32:35], v[52:55]
  v_mfma_f32_16x16x32_bf16 v[108:111], a[116:119], a[36:39], v[108:111]
  v_mfma_f32_16x16x32_bf16 v[164:167], a[116:119], a[40:43], v[164:167]
  v_mfma_f32_16x16x32_bf16 v[220:223], a[116:119], a[44:47], v[220:223]
  s_mov_b32 s18, 6
  .p2align 6
L_loop_24:
  s_waitcnt vmcnt(10) lgkmcnt(10)
  s_barrier
  v_mfma_f32_16x16x32_bf16 v[0:3], a[64:67], a[48:51], v[0:3]
  ds_read_b64_tr_b16 a[116:117], v229 offset:50368
  s_add_u32 m0, s38, 28672
  v_mfma_f32_16x16x32_bf16 v[56:59], a[64:67], a[52:55], v[56:59]
  buffer_load_dwordx4 v225, s[8:11], s17 offen lds
  v_mfma_f32_16x16x32_bf16 v[112:115], a[64:67], a[56:59], v[112:115]
  ds_read_b64_tr_b16 a[118:119], v229 offset:53952
  v_mfma_f32_16x16x32_bf16 v[168:171], a[64:67], a[60:63], v[168:171]
  ds_read_b64_tr_b16 a[64:65], v229 offset:0
  ds_read_b64_tr_b16 a[66:67], v229 offset:3584
  v_mfma_f32_16x16x32_bf16 v[4:7], a[68:71], a[48:51], v[4:7]
  v_mfma_f32_16x16x32_bf16 v[60:63], a[68:71], a[52:55], v[60:63]
  v_mfma_f32_16x16x32_bf16 v[116:119], a[68:71], a[56:59], v[116:119]
  v_mfma_f32_16x16x32_bf16 v[172:175], a[68:71], a[60:63], v[172:175]
  buffer_load_dwordx4 a[32:35], v224, s[4:7], s16 offen offset:0 sc1
  v_mfma_f32_16x16x32_bf16 v[8:11], a[72:75], a[48:51], v[8:11]
  ds_read_b64_tr_b16 a[68:69], v229 offset:32
  ds_read_b64_tr_b16 a[70:71], v229 offset:3616
  v_mfma_f32_16x16x32_bf16 v[64:67], a[72:75], a[52:55], v[64:67]
  v_mfma_f32_16x16x32_bf16 v[120:123], a[72:75], a[56:59], v[120:123]
  v_mfma_f32_16x16x32_bf16 v[176:179], a[72:75], a[60:63], v[176:179]
  ds_read_b64_tr_b16 a[72:73], v229 offset:64
  ds_read_b64_tr_b16 a[74:75], v229 offset:3648
  v_mfma_f32_16x16x32_bf16 v[12:15], a[76:79], a[48:51], v[12:15]
  v_mfma_f32_16x16x32_bf16 v[68:71], a[76:79], a[52:55], v[68:71]
  v_mfma_f32_16x16x32_bf16 v[124:127], a[76:79], a[56:59], v[124:127]
  buffer_load_dwordx4 v226, s[8:11], s17 offen offset:1024 lds
  v_mfma_f32_16x16x32_bf16 v[180:183], a[76:79], a[60:63], v[180:183]
  ds_read_b64_tr_b16 a[76:77], v229 offset:96
  ds_read_b64_tr_b16 a[78:79], v229 offset:3680
  v_mfma_f32_16x16x32_bf16 v[16:19], a[80:83], a[48:51], v[16:19]
  v_mfma_f32_16x16x32_bf16 v[72:75], a[80:83], a[52:55], v[72:75]
  v_mfma_f32_16x16x32_bf16 v[128:131], a[80:83], a[56:59], v[128:131]
  v_mfma_f32_16x16x32_bf16 v[184:187], a[80:83], a[60:63], v[184:187]
  ds_read_b64_tr_b16 a[80:81], v229 offset:128
  ds_read_b64_tr_b16 a[82:83], v229 offset:3712
  v_mfma_f32_16x16x32_bf16 v[20:23], a[84:87], a[48:51], v[20:23]
  v_mfma_f32_16x16x32_bf16 v[76:79], a[84:87], a[52:55], v[76:79]
  buffer_load_dwordx4 a[36:39], v224, s[4:7], s16 offen offset:1024 sc1
  v_mfma_f32_16x16x32_bf16 v[132:135], a[84:87], a[56:59], v[132:135]
  v_mfma_f32_16x16x32_bf16 v[188:191], a[84:87], a[60:63], v[188:191]
  ds_read_b64_tr_b16 a[84:85], v229 offset:160
  ds_read_b64_tr_b16 a[86:87], v229 offset:3744
  v_mfma_f32_16x16x32_bf16 v[24:27], a[88:91], a[48:51], v[24:27]
  v_mfma_f32_16x16x32_bf16 v[80:83], a[88:91], a[52:55], v[80:83]
  v_mfma_f32_16x16x32_bf16 v[136:139], a[88:91], a[56:59], v[136:139]
  v_mfma_f32_16x16x32_bf16 v[192:195], a[88:91], a[60:63], v[192:195]
  ds_read_b64_tr_b16 a[88:89], v229 offset:192
  ds_read_b64_tr_b16 a[90:91], v229 offset:3776
  v_mfma_f32_16x16x32_bf16 v[28:31], a[92:95], a[48:51], v[28:31]
  buffer_load_dwordx4 v227, s[8:11], s17 offen offset:2048 lds
  v_mfma_f32_16x16x32_bf16 v[84:87], a[92:95], a[52:55], v[84:87]
  v_mfma_f32_16x16x32_bf16 v[140:143], a[92:95], a[56:59], v[140:143]
  v_mfma_f32_16x16x32_bf16 v[196:199], a[92:95], a[60:63], v[196:199]
  ds_read_b64_tr_b16 a[92:93], v229 offset:7168
  ds_read_b64_tr_b16 a[94:95], v229 offset:10752
  s_waitcnt lgkmcnt(10)
  v_mfma_f32_16x16x32_bf16 v[32:35], a[96:99], a[48:51], v[32:35]
  v_mfma_f32_16x16x32_bf16 v[88:91], a[96:99], a[52:55], v[88:91]
  v_mfma_f32_16x16x32_bf16 v[144:147], a[96:99], a[56:59], v[144:147]
  v_mfma_f32_16x16x32_bf16 v[200:203], a[96:99], a[60:63], v[200:203]
  buffer_load_dwordx4 a[40:43], v224, s[4:7], s16 offen offset:2048 sc1
  v_mfma_f32_16x16x32_bf16 v[36:39], a[100:103], a[48:51], v[36:39]
  ds_read_b64_tr_b16 a[96:97], v229 offset:7200
  ds_read_b64_tr_b16 a[98:99], v229 offset:10784
  v_mfma_f32_16x16x32_bf16 v[92:95], a[100:103], a[52:55], v[92:95]
  v_mfma_f32_16x16x32_bf16 v[148:151], a[100:103], a[56:59], v[148:151]
  v_mfma_f32_16x16x32_bf16 v[204:207], a[100:103], a[60:63], v[204:207]
  ds_read_b64_tr_b16 a[100:101], v229 offset:7232
  ds_read_b64_tr_b16 a[102:103], v229 offset:10816
  v_mfma_f32_16x16x32_bf16 v[40:43], a[104:107], a[48:51], v[40:43]
  v_mfma_f32_16x16x32_bf16 v[96:99], a[104:107], a[52:55], v[96:99]
  v_mfma_f32_16x16x32_bf16 v[152:155], a[104:107], a[56:59], v[152:155]
  s_mov_b32 exec_hi, 0
  buffer_load_dwordx4 v228, s[8:11], s17 offen offset:3072 lds
  s_mov_b32 exec_hi, -1
  v_mfma_f32_16x16x32_bf16 v[208:211], a[104:107], a[60:63], v[208:211]
  ds_read_b64_tr_b16 a[104:105], v229 offset:7264
  s_add_u32 s17, s17, s98
  v_mfma_f32_16x16x32_bf16 v[44:47], a[108:111], a[48:51], v[44:47]
  ds_read_b64_tr_b16 a[106:107], v229 offset:10848
  v_mfma_f32_16x16x32_bf16 v[100:103], a[108:111], a[52:55], v[100:103]
  v_mfma_f32_16x16x32_bf16 v[156:159], a[108:111], a[56:59], v[156:159]
  v_mfma_f32_16x16x32_bf16 v[212:215], a[108:111], a[60:63], v[212:215]
  ds_read_b64_tr_b16 a[108:109], v229 offset:7296
  ds_read_b64_tr_b16 a[110:111], v229 offset:10880
  v_mfma_f32_16x16x32_bf16 v[48:51], a[112:115], a[48:51], v[48:51]
  v_mfma_f32_16x16x32_bf16 v[104:107], a[112:115], a[52:55], v[104:107]
  buffer_load_dwordx4 a[44:47], v224, s[4:7], s16 offen offset:3072 sc1
  v_mfma_f32_16x16x32_bf16 v[160:163], a[112:115], a[56:59], v[160:163]
  s_add_u32 s16, s16, s46
  v_mfma_f32_16x16x32_bf16 v[216:219], a[112:115], a[60:63], v[216:219]
  ds_read_b64_tr_b16 a[112:113], v229 offset:7328
  ds_read_b64_tr_b16 a[114:115], v229 offset:10912
  v_mfma_f32_16x16x32_bf16 v[52:55], a[116:119], a[48:51], v[52:55]
  v_mfma_f32_16x16x32_bf16 v[108:111], a[116:119], a[52:55], v[108:111]
  v_mfma_f32_16x16x32_bf16 v[164:167], a[116:119], a[56:59], v[164:167]
  v_mfma_f32_16x16x32_bf16 v[220:223], a[116:119], a[60:63], v[220:223]
  s_waitcnt vmcnt(9) lgkmcnt(10)
  s_barrier
  v_mfma_f32_16x16x32_bf16 v[0:3], a[64:67], a[0:3], v[0:3]
  ds_read_b64_tr_b16 a[116:117], v229 offset:7360
  s_add_u32 m0, s38, 43008
  v_mfma_f32_16x16x32_bf16 v[56:59], a[64:67], a[4:7], v[56:59]
  buffer_load_dwordx4 v225, s[8:11], s17 offen lds
  v_mfma_f32_16x16x32_bf16 v[112:115], a[64:67], a[8:11], v[112:115]
  ds_read_b64_tr_b16 a[118:119], v229 offset:10944
  v_mfma_f32_16x16x32_bf16 v[168:171], a[64:67], a[12:15], v[168:171]
  ds_read_b64_tr_b16 a[64:65], v229 offset:14336
  ds_read_b64_tr_b16 a[66:67], v229 offset:17920
  v_mfma_f32_16x16x32_bf16 v[4:7], a[68:71], a[0:3], v[4:7]
  v_mfma_f32_16x16x32_bf16 v[60:63], a[68:71], a[4:7], v[60:63]
  v_mfma_f32_16x16x32_bf16 v[116:119], a[68:71], a[8:11], v[116:119]
  v_mfma_f32_16x16x32_bf16 v[172:175], a[68:71], a[12:15], v[172:175]
  buffer_load_dwordx4 a[48:51], v224, s[4:7], s16 offen offset:0 sc1
  v_mfma_f32_16x16x32_bf16 v[8:11], a[72:75], a[0:3], v[8:11]
  ds_read_b64_tr_b16 a[68:69], v229 offset:14368
  ds_read_b64_tr_b16 a[70:71], v229 offset:17952
  v_mfma_f32_16x16x32_bf16 v[64:67], a[72:75], a[4:7], v[64:67]
  v_mfma_f32_16x16x32_bf16 v[120:123], a[72:75], a[8:11], v[120:123]
  v_mfma_f32_16x16x32_bf16 v[176:179], a[72:75], a[12:15], v[176:179]
  ds_read_b64_tr_b16 a[72:73], v229 offset:14400
  ds_read_b64_tr_b16 a[74:75], v229 offset:17984
  v_mfma_f32_16x16x32_bf16 v[12:15], a[76:79], a[0:3], v[12:15]
  v_mfma_f32_16x16x32_bf16 v[68:71], a[76:79], a[4:7], v[68:71]
  v_mfma_f32_16x16x32_bf16 v[124:127], a[76:79], a[8:11], v[124:127]
  buffer_load_dwordx4 v226, s[8:11], s17 offen offset:1024 lds
  v_mfma_f32_16x16x32_bf16 v[180:183], a[76:79], a[12:15], v[180:183]
  ds_read_b64_tr_b16 a[76:77], v229 offset:14432
  ds_read_b64_tr_b16 a[78:79], v229 offset:18016
  v_mfma_f32_16x16x32_bf16 v[16:19], a[80:83], a[0:3], v[16:19]
  v_mfma_f32_16x16x32_bf16 v[72:75], a[80:83], a[4:7], v[72:75]
  v_mfma_f32_16x16x32_bf16 v[128:131], a[80:83], a[8:11], v[128:131]
  v_mfma_f32_16x16x32_bf16 v[184:187], a[80:83], a[12:15], v[184:187]
  ds_read_b64_tr_b16 a[80:81], v229 offset:14464
  ds_read_b64_tr_b16 a[82:83], v229 offset:18048
  v_mfma_f32_16x16x32_bf16 v[20:23], a[84:87], a[0:3], v[20:23]
  v_mfma_f32_16x16x32_bf16 v[76:79], a[84:87], a[4:7], v[76:79]
  buffer_load_dwordx4 a[52:55], v224, s[4:7], s16 offen offset:1024 sc1
  v_mfma_f32_16x16x32_bf16 v[132:135], a[84:87], a[8:11], v[132:135]
  v_mfma_f32_16x16x32_bf16 v[188:191], a[84:87], a[12:15], v[188:191]
  ds_read_b64_tr_b16 a[84:85], v229 offset:14496
  ds_read_b64_tr_b16 a[86:87], v229 offset:18080
  v_mfma_f32_16x16x32_bf16 v[24:27], a[88:91], a[0:3], v[24:27]
  v_mfma_f32_16x16x32_bf16 v[80:83], a[88:91], a[4:7], v[80:83]
  v_mfma_f32_16x16x32_bf16 v[136:139], a[88:91], a[8:11], v[136:139]
  v_mfma_f32_16x16x32_bf16 v[192:195], a[88:91], a[12:15], v[192:195]
  ds_read_b64_tr_b16 a[88:89], v229 offset:14528
  ds_read_b64_tr_b16 a[90:91], v229 offset:18112
  v_mfma_f32_16x16x32_bf16 v[28:31], a[92:95], a[0:3], v[28:31]
  buffer_load_dwordx4 v227, s[8:11], s17 offen offset:2048 lds
  v_mfma_f32_16x16x32_bf16 v[84:87], a[92:95], a[4:7], v[84:87]
  v_mfma_f32_16x16x32_bf16 v[140:143], a[92:95], a[8:11], v[140:143]
  v_mfma_f32_16x16x32_bf16 v[196:199], a[92:95], a[12:15], v[196:199]
  ds_read_b64_tr_b16 a[92:93], v229 offset:21504
  ds_read_b64_tr_b16 a[94:95], v229 offset:25088
  s_waitcnt lgkmcnt(10)
  v_mfma_f32_16x16x32_bf16 v[32:35], a[96:99], a[0:3], v[32:35]
  v_mfma_f32_16x16x32_bf16 v[88:91], a[96:99], a[4:7], v[88:91]
  v_mfma_f32_16x16x32_bf16 v[144:147], a[96:99], a[8:11], v[144:147]
  v_mfma_f32_16x16x32_bf16 v[200:203], a[96:99], a[12:15], v[200:203]
  buffer_load_dwordx4 a[56:59], v224, s[4:7], s16 offen offset:2048 sc1
  v_mfma_f32_16x16x32_bf16 v[36:39], a[100:103], a[0:3], v[36:39]
  ds_read_b64_tr_b16 a[96:97], v229 offset:21536
  ds_read_b64_tr_b16 a[98:99], v229 offset:25120
  v_mfma_f32_16x16x32_bf16 v[92:95], a[100:103], a[4:7], v[92:95]
  v_mfma_f32_16x16x32_bf16 v[148:151], a[100:103], a[8:11], v[148:151]
  v_mfma_f32_16x16x32_bf16 v[204:207], a[100:103], a[12:15], v[204:207]
  ds_read_b64_tr_b16 a[100:101], v229 offset:21568
  ds_read_b64_tr_b16 a[102:103], v229 offset:25152
  v_mfma_f32_16x16x32_bf16 v[40:43], a[104:107], a[0:3], v[40:43]
  v_mfma_f32_16x16x32_bf16 v[96:99], a[104:107], a[4:7], v[96:99]
  v_mfma_f32_16x16x32_bf16 v[152:155], a[104:107], a[8:11], v[152:155]
  s_mov_b32 exec_hi, 0
  buffer_load_dwordx4 v228, s[8:11], s17 offen offset:3072 lds
  s_mov_b32 exec_hi, -1
  v_mfma_f32_16x16x32_bf16 v[208:211], a[104:107], a[12:15], v[208:211]
  ds_read_b64_tr_b16 a[104:105], v229 offset:21600
  s_add_u32 s17, s17, s99
  v_mfma_f32_16x16x32_bf16 v[44:47], a[108:111], a[0:3], v[44:47]
  ds_read_b64_tr_b16 a[106:107], v229 offset:25184
  v_mfma_f32_16x16x32_bf16 v[100:103], a[108:111], a[4:7], v[100:103]
  v_mfma_f32_16x16x32_bf16 v[156:159], a[108:111], a[8:11], v[156:159]
  v_mfma_f32_16x16x32_bf16 v[212:215], a[108:111], a[12:15], v[212:215]
  ds_read_b64_tr_b16 a[108:109], v229 offset:21632
  ds_read_b64_tr_b16 a[110:111], v229 offset:25216
  v_mfma_f32_16x16x32_bf16 v[48:51], a[112:115], a[0:3], v[48:51]
  v_mfma_f32_16x16x32_bf16 v[104:107], a[112:115], a[4:7], v[104:107]
  buffer_load_dwordx4 a[60:63], v224, s[4:7], s16 offen offset:3072 sc1
  v_mfma_f32_16x16x32_bf16 v[160:163], a[112:115], a[8:11], v[160:163]
  s_add_u32 s16, s16, s47
  v_mfma_f32_16x16x32_bf16 v[216:219], a[112:115], a[12:15], v[216:219]
  ds_read_b64_tr_b16 a[112:113], v229 offset:21664
  ds_read_b64_tr_b16 a[114:115], v229 offset:25248
  v_mfma_f32_16x16x32_bf16 v[52:55], a[116:119], a[0:3], v[52:55]
  v_mfma_f32_16x16x32_bf16 v[108:111], a[116:119], a[4:7], v[108:111]
  v_mfma_f32_16x16x32_bf16 v[164:167], a[116:119], a[8:11], v[164:167]
  v_mfma_f32_16x16x32_bf16 v[220:223], a[116:119], a[12:15], v[220:223]
  s_waitcnt vmcnt(9) lgkmcnt(10)
  s_barrier
  v_mfma_f32_16x16x32_bf16 v[0:3], a[64:67], a[16:19], v[0:3]
  ds_read_b64_tr_b16 a[116:117], v229 offset:21696
  s_add_u32 m0, s38, 0
  v_mfma_f32_16x16x32_bf16 v[56:59], a[64:67], a[20:23], v[56:59]
  buffer_load_dwordx4 v225, s[8:11], s17 offen lds
  v_mfma_f32_16x16x32_bf16 v[112:115], a[64:67], a[24:27], v[112:115]
  ds_read_b64_tr_b16 a[118:119], v229 offset:25280
  v_mfma_f32_16x16x32_bf16 v[168:171], a[64:67], a[28:31], v[168:171]
  ds_read_b64_tr_b16 a[64:65], v229 offset:28672
  ds_read_b64_tr_b16 a[66:67], v229 offset:32256
  v_mfma_f32_16x16x32_bf16 v[4:7], a[68:71], a[16:19], v[4:7]
  v_mfma_f32_16x16x32_bf16 v[60:63], a[68:71], a[20:23], v[60:63]
  v_mfma_f32_16x16x32_bf16 v[116:119], a[68:71], a[24:27], v[116:119]
  v_mfma_f32_16x16x32_bf16 v[172:175], a[68:71], a[28:31], v[172:175]
  buffer_load_dwordx4 a[0:3], v224, s[4:7], s16 offen offset:0 sc1
  v_mfma_f32_16x16x32_bf16 v[8:11], a[72:75], a[16:19], v[8:11]
  ds_read_b64_tr_b16 a[68:69], v229 offset:28704
  ds_read_b64_tr_b16 a[70:71], v229 offset:32288
  v_mfma_f32_16x16x32_bf16 v[64:67], a[72:75], a[20:23], v[64:67]
  v_mfma_f32_16x16x32_bf16 v[120:123], a[72:75], a[24:27], v[120:123]
  v_mfma_f32_16x16x32_bf16 v[176:179], a[72:75], a[28:31], v[176:179]
  ds_read_b64_tr_b16 a[72:73], v229 offset:28736
  ds_read_b64_tr_b16 a[74:75], v229 offset:32320
  v_mfma_f32_16x16x32_bf16 v[12:15], a[76:79], a[16:19], v[12:15]
  v_mfma_f32_16x16x32_bf16 v[68:71], a[76:79], a[20:23], v[68:71]
  buffer_load_dwordx4 v226, s[8:11], s17 offen offset:1024 lds
  v_mfma_f32_16x16x32_bf16 v[124:127], a[76:79], a[24:27], v[124:127]
  v_mfma_f32_16x16x32_bf16 v[180:183], a[76:79], a[28:31], v[180:183]
  ds_read_b64_tr_b16 a[76:77], v229 offset:28768
  ds_read_b64_tr_b16 a[78:79], v229 offset:32352
  v_mfma_f32_16x16x32_bf16 v[16:19], a[80:83], a[16:19], v[16:19]
  v_mfma_f32_16x16x32_bf16 v[72:75], a[80:83], a[20:23], v[72:75]
  v_mfma_f32_16x16x32_bf16 v[128:131], a[80:83], a[24:27], v[128:131]
  v_mfma_f32_16x16x32_bf16 v[184:187], a[80:83], a[28:31], v[184:187]
  buffer_load_dwordx4 a[4:7], v224, s[4:7], s16 offen offset:1024 sc1
  v_mfma_f32_16x16x32_bf16 v[20:23], a[84:87], a[16:19], v[20:23]
  ds_read_b64_tr_b16 a[80:81], v229 offset:28800
  ds_read_b64_tr_b16 a[82:83], v229 offset:32384
  v_mfma_f32_16x16x32_bf16 v[76:79], a[84:87], a[20:23], v[76:79]
  v_mfma_f32_16x16x32_bf16 v[132:135], a[84:87], a[24:27], v[132:135]
  v_mfma_f32_16x16x32_bf16 v[188:191], a[84:87], a[28:31], v[188:191]
  ds_read_b64_tr_b16 a[84:85], v229 offset:28832
  ds_read_b64_tr_b16 a[86:87], v229 offset:32416
  v_mfma_f32_16x16x32_bf16 v[24:27], a[88:91], a[16:19], v[24:27]
  v_mfma_f32_16x16x32_bf16 v[80:83], a[88:91], a[20:23], v[80:83]
  buffer_load_dwordx4 v227, s[8:11], s17 offen offset:2048 lds
  v_mfma_f32_16x16x32_bf16 v[136:139], a[88:91], a[24:27], v[136:139]
  v_mfma_f32_16x16x32_bf16 v[192:195], a[88:91], a[28:31], v[192:195]
  ds_read_b64_tr_b16 a[88:89], v229 offset:28864
  ds_read_b64_tr_b16 a[90:91], v229 offset:32448
  v_mfma_f32_16x16x32_bf16 v[28:31], a[92:95], a[16:19], v[28:31]
  v_mfma_f32_16x16x32_bf16 v[84:87], a[92:95], a[20:23], v[84:87]
  v_mfma_f32_16x16x32_bf16 v[140:143], a[92:95], a[24:27], v[140:143]
  v_mfma_f32_16x16x32_bf16 v[196:199], a[92:95], a[28:31], v[196:199]
  buffer_load_dwordx4 a[8:11], v224, s[4:7], s16 offen offset:2048 sc1
  s_waitcnt lgkmcnt(10)
  v_mfma_f32_16x16x32_bf16 v[32:35], a[96:99], a[16:19], v[32:35]
  ds_read_b64_tr_b16 a[92:93], v229 offset:35840
  ds_read_b64_tr_b16 a[94:95], v229 offset:39424
  v_mfma_f32_16x16x32_bf16 v[88:91], a[96:99], a[20:23], v[88:91]
  v_mfma_f32_16x16x32_bf16 v[144:147], a[96:99], a[24:27], v[144:147]
  v_mfma_f32_16x16x32_bf16 v[200:203], a[96:99], a[28:31], v[200:203]
  ds_read_b64_tr_b16 a[96:97], v229 offset:35872
  ds_read_b64_tr_b16 a[98:99], v229 offset:39456
  v_mfma_f32_16x16x32_bf16 v[36:39], a[100:103], a[16:19], v[36:39]
  v_mfma_f32_16x16x32_bf16 v[92:95], a[100:103], a[20:23], v[92:95]
  s_mov_b32 exec_hi, 0
  buffer_load_dwordx4 v228, s[8:11], s17 offen offset:3072 lds
  s_mov_b32 exec_hi, -1
  v_mfma_f32_16x16x32_bf16 v[148:151], a[100:103], a[24:27], v[148:151]
  s_add_u32 s17, s17, s96
  v_mfma_f32_16x16x32_bf16 v[204:207], a[100:103], a[28:31], v[204:207]
  ds_read_b64_tr_b16 a[100:101], v229 offset:35904
  ds_read_b64_tr_b16 a[102:103], v229 offset:39488
  v_mfma_f32_16x16x32_bf16 v[40:43], a[104:107], a[16:19], v[40:43]
  v_mfma_f32_16x16x32_bf16 v[96:99], a[104:107], a[20:23], v[96:99]
  v_mfma_f32_16x16x32_bf16 v[152:155], a[104:107], a[24:27], v[152:155]
  v_mfma_f32_16x16x32_bf16 v[208:211], a[104:107], a[28:31], v[208:211]
  buffer_load_dwordx4 a[12:15], v224, s[4:7], s16 offen offset:3072 sc1
  v_mfma_f32_16x16x32_bf16 v[44:47], a[108:111], a[16:19], v[44:47]
  ds_read_b64_tr_b16 a[104:105], v229 offset:35936
  s_add_u32 s16, s16, s44
  v_mfma_f32_16x16x32_bf16 v[100:103], a[108:111], a[20:23], v[100:103]
  ds_read_b64_tr_b16 a[106:107], v229 offset:39520
  v_mfma_f32_16x16x32_bf16 v[156:159], a[108:111], a[24:27], v[156:159]
  v_mfma_f32_16x16x32_bf16 v[212:215], a[108:111], a[28:31], v[212:215]
  ds_read_b64_tr_b16 a[108:109], v229 offset:35968
  ds_read_b64_tr_b16 a[110:111], v229 offset:39552
  v_mfma_f32_16x16x32_bf16 v[48:51], a[112:115], a[16:19], v[48:51]
  v_mfma_f32_16x16x32_bf16 v[104:107], a[112:115], a[20:23], v[104:107]
  buffer_load_dword v251, v249, s[52:55], s56 offen
  v_mfma_f32_16x16x32_bf16 v[160:163], a[112:115], a[24:27], v[160:163]
  s_add_u32 s56, s56, 524288
  v_mfma_f32_16x16x32_bf16 v[216:219], a[112:115], a[28:31], v[216:219]
  ds_read_b64_tr_b16 a[112:113], v229 offset:36000
  ds_read_b64_tr_b16 a[114:115], v229 offset:39584
  v_mfma_f32_16x16x32_bf16 v[52:55], a[116:119], a[16:19], v[52:55]
  v_mfma_f32_16x16x32_bf16 v[108:111], a[116:119], a[20:23], v[108:111]
  v_mfma_f32_16x16x32_bf16 v[164:167], a[116:119], a[24:27], v[164:167]
  v_mfma_f32_16x16x32_bf16 v[220:223], a[116:119], a[28:31], v[220:223]
  s_waitcnt vmcnt(10) lgkmcnt(10)
  s_barrier
  v_mfma_f32_16x16x32_bf16 v[0:3], a[64:67], a[32:35], v[0:3]
  ds_read_b64_tr_b16 a[116:117], v229 offset:36032
  s_add_u32 m0, s38, 14336
  v_mfma_f32_16x16x32_bf16 v[56:59], a[64:67], a[36:39], v[56:59]
  buffer_load_dwordx4 v225, s[8:11], s17 offen lds
  v_mfma_f32_16x16x32_bf16 v[112:115], a[64:67], a[40:43], v[112:115]
  ds_read_b64_tr_b16 a[118:119], v229 offset:39616
  v_mfma_f32_16x16x32_bf16 v[168:171], a[64:67], a[44:47], v[168:171]
  ds_read_b64_tr_b16 a[64:65], v229 offset:43008
  ds_read_b64_tr_b16 a[66:67], v229 offset:46592
  v_mfma_f32_16x16x32_bf16 v[4:7], a[68:71], a[32:35], v[4:7]
  v_mfma_f32_16x16x32_bf16 v[60:63], a[68:71], a[36:39], v[60:63]
  v_mfma_f32_16x16x32_bf16 v[116:119], a[68:71], a[40:43], v[116:119]
  v_mfma_f32_16x16x32_bf16 v[172:175], a[68:71], a[44:47], v[172:175]
  buffer_load_dwordx4 a[16:19], v224, s[4:7], s16 offen offset:0 sc1
  v_mfma_f32_16x16x32_bf16 v[8:11], a[72:75], a[32:35], v[8:11]
  ds_read_b64_tr_b16 a[68:69], v229 offset:43040
  ds_read_b64_tr_b16 a[70:71], v229 offset:46624
  v_mfma_f32_16x16x32_bf16 v[64:67], a[72:75], a[36:39], v[64:67]
  v_mfma_f32_16x16x32_bf16 v[120:123], a[72:75], a[40:43], v[120:123]
  v_mfma_f32_16x16x32_bf16 v[176:179], a[72:75], a[44:47], v[176:179]
  ds_read_b64_tr_b16 a[72:73], v229 offset:43072
  ds_read_b64_tr_b16 a[74:75], v229 offset:46656
  v_mfma_f32_16x16x32_bf16 v[12:15], a[76:79], a[32:35], v[12:15]
  v_mfma_f32_16x16x32_bf16 v[68:71], a[76:79], a[36:39], v[68:71]
  v_mfma_f32_16x16x32_bf16 v[124:127], a[76:79], a[40:43], v[124:127]
  buffer_load_dwordx4 v226, s[8:11], s17 offen offset:1024 lds
  v_mfma_f32_16x16x32_bf16 v[180:183], a[76:79], a[44:47], v[180:183]
  ds_read_b64_tr_b16 a[76:77], v229 offset:43104
  ds_read_b64_tr_b16 a[78:79], v229 offset:46688
  v_mfma_f32_16x16x32_bf16 v[16:19], a[80:83], a[32:35], v[16:19]
  v_mfma_f32_16x16x32_bf16 v[72:75], a[80:83], a[36:39], v[72:75]
  v_mfma_f32_16x16x32_bf16 v[128:131], a[80:83], a[40:43], v[128:131]
  v_mfma_f32_16x16x32_bf16 v[184:187], a[80:83], a[44:47], v[184:187]
  ds_read_b64_tr_b16 a[80:81], v229 offset:43136
  ds_read_b64_tr_b16 a[82:83], v229 offset:46720
  v_mfma_f32_16x16x32_bf16 v[20:23], a[84:87], a[32:35], v[20:23]
  v_mfma_f32_16x16x32_bf16 v[76:79], a[84:87], a[36:39], v[76:79]
  buffer_load_dwordx4 a[20:23], v224, s[4:7], s16 offen offset:1024 sc1
  v_mfma_f32_16x16x32_bf16 v[132:135], a[84:87], a[40:43], v[132:135]
  v_mfma_f32_16x16x32_bf16 v[188:191], a[84:87], a[44:47], v[188:191]
  ds_read_b64_tr_b16 a[84:85], v229 offset:43168
  ds_read_b64_tr_b16 a[86:87], v229 offset:46752
  v_mfma_f32_16x16x32_bf16 v[24:27], a[88:91], a[32:35], v[24:27]
  v_mfma_f32_16x16x32_bf16 v[80:83], a[88:91], a[36:39], v[80:83]
  v_mfma_f32_16x16x32_bf16 v[136:139], a[88:91], a[40:43], v[136:139]
  v_mfma_f32_16x16x32_bf16 v[192:195], a[88:91], a[44:47], v[192:195]
  ds_read_b64_tr_b16 a[88:89], v229 offset:43200
  ds_read_b64_tr_b16 a[90:91], v229 offset:46784
  v_mfma_f32_16x16x32_bf16 v[28:31], a[92:95], a[32:35], v[28:31]
  buffer_load_dwordx4 v227, s[8:11], s17 offen offset:2048 lds
  v_mfma_f32_16x16x32_bf16 v[84:87], a[92:95], a[36:39], v[84:87]
  v_mfma_f32_16x16x32_bf16 v[140:143], a[92:95], a[40:43], v[140:143]
  v_mfma_f32_16x16x32_bf16 v[196:199], a[92:95], a[44:47], v[196:199]
  ds_read_b64_tr_b16 a[92:93], v229 offset:50176
  ds_read_b64_tr_b16 a[94:95], v229 offset:53760
  s_waitcnt lgkmcnt(10)
  v_mfma_f32_16x16x32_bf16 v[32:35], a[96:99], a[32:35], v[32:35]
  v_mfma_f32_16x16x32_bf16 v[88:91], a[96:99], a[36:39], v[88:91]
  v_mfma_f32_16x16x32_bf16 v[144:147], a[96:99], a[40:43], v[144:147]
  v_mfma_f32_16x16x32_bf16 v[200:203], a[96:99], a[44:47], v[200:203]
  buffer_load_dwordx4 a[24:27], v224, s[4:7], s16 offen offset:2048 sc1
  v_mfma_f32_16x16x32_bf16 v[36:39], a[100:103], a[32:35], v[36:39]
  ds_read_b64_tr_b16 a[96:97], v229 offset:50208
  ds_read_b64_tr_b16 a[98:99], v229 offset:53792
  v_mfma_f32_16x16x32_bf16 v[92:95], a[100:103], a[36:39], v[92:95]
  v_mfma_f32_16x16x32_bf16 v[148:151], a[100:103], a[40:43], v[148:151]
  v_mfma_f32_16x16x32_bf16 v[204:207], a[100:103], a[44:47], v[204:207]
  ds_read_b64_tr_b16 a[100:101], v229 offset:50240
  ds_read_b64_tr_b16 a[102:103], v229 offset:53824
  v_mfma_f32_16x16x32_bf16 v[40:43], a[104:107], a[32:35], v[40:43]
  v_mfma_f32_16x16x32_bf16 v[96:99], a[104:107], a[36:39], v[96:99]
  v_mfma_f32_16x16x32_bf16 v[152:155], a[104:107], a[40:43], v[152:155]
  s_mov_b32 exec_hi, 0
  buffer_load_dwordx4 v228, s[8:11], s17 offen offset:3072 lds
  s_mov_b32 exec_hi, -1
  v_mfma_f32_16x16x32_bf16 v[208:211], a[104:107], a[44:47], v[208:211]
  ds_read_b64_tr_b16 a[104:105], v229 offset:50272
  s_add_u32 s17, s17, s97
  v_mfma_f32_16x16x32_bf16 v[44:47], a[108:111], a[32:35], v[44:47]
  ds_read_b64_tr_b16 a[106:107], v229 offset:53856
  v_mfma_f32_16x16x32_bf16 v[100:103], a[108:111], a[36:39], v[100:103]
  v_mfma_f32_16x16x32_bf16 v[156:159], a[108:111], a[40:43], v[156:159]
  v_mfma_f32_16x16x32_bf16 v[212:215], a[108:111], a[44:47], v[212:215]
  ds_read_b64_tr_b16 a[108:109], v229 offset:50304
  ds_read_b64_tr_b16 a[110:111], v229 offset:53888
  v_mfma_f32_16x16x32_bf16 v[48:51], a[112:115], a[32:35], v[48:51]
  v_mfma_f32_16x16x32_bf16 v[104:107], a[112:115], a[36:39], v[104:107]
  buffer_load_dwordx4 a[28:31], v224, s[4:7], s16 offen offset:3072 sc1
  v_mfma_f32_16x16x32_bf16 v[160:163], a[112:115], a[40:43], v[160:163]
  s_add_u32 s16, s16, s45
  v_mfma_f32_16x16x32_bf16 v[216:219], a[112:115], a[44:47], v[216:219]
  ds_read_b64_tr_b16 a[112:113], v229 offset:50336
  ds_read_b64_tr_b16 a[114:115], v229 offset:53920
  v_mfma_f32_16x16x32_bf16 v[52:55], a[116:119], a[32:35], v[52:55]
  v_mfma_f32_16x16x32_bf16 v[108:111], a[116:119], a[36:39], v[108:111]
  v_mfma_f32_16x16x32_bf16 v[164:167], a[116:119], a[40:43], v[164:167]
  v_mfma_f32_16x16x32_bf16 v[220:223], a[116:119], a[44:47], v[220:223]
  s_sub_u32 s18, s18, 1
  s_cmp_lg_u32 s18, 0
  s_cbranch_scc1 L_loop_24
  s_waitcnt vmcnt(10) lgkmcnt(10)
  s_barrier
  v_mfma_f32_16x16x32_bf16 v[0:3], a[64:67], a[48:51], v[0:3]
  ds_read_b64_tr_b16 a[116:117], v229 offset:50368
  s_add_u32 m0, s38, 28672
  v_mfma_f32_16x16x32_bf16 v[56:59], a[64:67], a[52:55], v[56:59]
  buffer_load_dwordx4 v225, s[8:11], s17 offen lds
  v_mfma_f32_16x16x32_bf16 v[112:115], a[64:67], a[56:59], v[112:115]
  ds_read_b64_tr_b16 a[118:119], v229 offset:53952
  v_mfma_f32_16x16x32_bf16 v[168:171], a[64:67], a[60:63], v[168:171]
  ds_read_b64_tr_b16 a[64:65], v229 offset:0
  ds_read_b64_tr_b16 a[66:67], v229 offset:3584
  v_mfma_f32_16x16x32_bf16 v[4:7], a[68:71], a[48:51], v[4:7]
  v_mfma_f32_16x16x32_bf16 v[60:63], a[68:71], a[52:55], v[60:63]
  v_mfma_f32_16x16x32_bf16 v[116:119], a[68:71], a[56:59], v[116:119]
  v_mfma_f32_16x16x32_bf16 v[172:175], a[68:71], a[60:63], v[172:175]
  buffer_load_dwordx4 a[32:35], v224, s[4:7], s16 offen offset:0 sc1
  v_mfma_f32_16x16x32_bf16 v[8:11], a[72:75], a[48:51], v[8:11]
  ds_read_b64_tr_b16 a[68:69], v229 offset:32
  ds_read_b64_tr_b16 a[70:71], v229 offset:3616
  v_mfma_f32_16x16x32_bf16 v[64:67], a[72:75], a[52:55], v[64:67]
  v_mfma_f32_16x16x32_bf16 v[120:123], a[72:75], a[56:59], v[120:123]
  v_mfma_f32_16x16x32_bf16 v[176:179], a[72:75], a[60:63], v[176:179]
  ds_read_b64_tr_b16 a[72:73], v229 offset:64
  ds_read_b64_tr_b16 a[74:75], v229 offset:3648
  v_mfma_f32_16x16x32_bf16 v[12:15], a[76:79], a[48:51], v[12:15]
  v_mfma_f32_16x16x32_bf16 v[68:71], a[76:79], a[52:55], v[68:71]
  v_mfma_f32_16x16x32_bf16 v[124:127], a[76:79], a[56:59], v[124:127]
  buffer_load_dwordx4 v226, s[8:11], s17 offen offset:1024 lds
  v_mfma_f32_16x16x32_bf16 v[180:183], a[76:79], a[60:63], v[180:183]
  ds_read_b64_tr_b16 a[76:77], v229 offset:96
  ds_read_b64_tr_b16 a[78:79], v229 offset:3680
  v_mfma_f32_16x16x32_bf16 v[16:19], a[80:83], a[48:51], v[16:19]
  v_mfma_f32_16x16x32_bf16 v[72:75], a[80:83], a[52:55], v[72:75]
  v_mfma_f32_16x16x32_bf16 v[128:131], a[80:83], a[56:59], v[128:131]
  v_mfma_f32_16x16x32_bf16 v[184:187], a[80:83], a[60:63], v[184:187]
  ds_read_b64_tr_b16 a[80:81], v229 offset:128
  ds_read_b64_tr_b16 a[82:83], v229 offset:3712
  v_mfma_f32_16x16x32_bf16 v[20:23], a[84:87], a[48:51], v[20:23]
  v_mfma_f32_16x16x32_bf16 v[76:79], a[84:87], a[52:55], v[76:79]
  buffer_load_dwordx4 a[36:39], v224, s[4:7], s16 offen offset:1024 sc1
  v_mfma_f32_16x16x32_bf16 v[132:135], a[84:87], a[56:59], v[132:135]
  v_mfma_f32_16x16x32_bf16 v[188:191], a[84:87], a[60:63], v[188:191]
  ds_read_b64_tr_b16 a[84:85], v229 offset:160
  ds_read_b64_tr_b16 a[86:87], v229 offset:3744
  v_mfma_f32_16x16x32_bf16 v[24:27], a[88:91], a[48:51], v[24:27]
  v_mfma_f32_16x16x32_bf16 v[80:83], a[88:91], a[52:55], v[80:83]
  v_mfma_f32_16x16x32_bf16 v[136:139], a[88:91], a[56:59], v[136:139]
  v_mfma_f32_16x16x32_bf16 v[192:195], a[88:91], a[60:63], v[192:195]
  ds_read_b64_tr_b16 a[88:89], v229 offset:192
  ds_read_b64_tr_b16 a[90:91], v229 offset:3776
  v_mfma_f32_16x16x32_bf16 v[28:31], a[92:95], a[48:51], v[28:31]
  buffer_load_dwordx4 v227, s[8:11], s17 offen offset:2048 lds
  v_mfma_f32_16x16x32_bf16 v[84:87], a[92:95], a[52:55], v[84:87]
  v_mfma_f32_16x16x32_bf16 v[140:143], a[92:95], a[56:59], v[140:143]
  v_mfma_f32_16x16x32_bf16 v[196:199], a[92:95], a[60:63], v[196:199]
  ds_read_b64_tr_b16 a[92:93], v229 offset:7168
  ds_read_b64_tr_b16 a[94:95], v229 offset:10752
  s_waitcnt lgkmcnt(10)
  v_mfma_f32_16x16x32_bf16 v[32:35], a[96:99], a[48:51], v[32:35]
  v_mfma_f32_16x16x32_bf16 v[88:91], a[96:99], a[52:55], v[88:91]
  v_mfma_f32_16x16x32_bf16 v[144:147], a[96:99], a[56:59], v[144:147]
  v_mfma_f32_16x16x32_bf16 v[200:203], a[96:99], a[60:63], v[200:203]
  buffer_load_dwordx4 a[40:43], v224, s[4:7], s16 offen offset:2048 sc1
  v_mfma_f32_16x16x32_bf16 v[36:39], a[100:103], a[48:51], v[36:39]
  ds_read_b64_tr_b16 a[96:97], v229 offset:7200
  ds_read_b64_tr_b16 a[98:99], v229 offset:10784
  v_mfma_f32_16x16x32_bf16 v[92:95], a[100:103], a[52:55], v[92:95]
  v_mfma_f32_16x16x32_bf16 v[148:151], a[100:103], a[56:59], v[148:151]
  v_mfma_f32_16x16x32_bf16 v[204:207], a[100:103], a[60:63], v[204:207]
  ds_read_b64_tr_b16 a[100:101], v229 offset:7232
  ds_read_b64_tr_b16 a[102:103], v229 offset:10816
  v_mfma_f32_16x16x32_bf16 v[40:43], a[104:107], a[48:51], v[40:43]
  v_mfma_f32_16x16x32_bf16 v[96:99], a[104:107], a[52:55], v[96:99]
  v_mfma_f32_16x16x32_bf16 v[152:155], a[104:107], a[56:59], v[152:155]
  s_mov_b32 exec_hi, 0
  buffer_load_dwordx4 v228, s[8:11], s17 offen offset:3072 lds
  s_mov_b32 exec_hi, -1
  v_mfma_f32_16x16x32_bf16 v[208:211], a[104:107], a[60:63], v[208:211]
  ds_read_b64_tr_b16 a[104:105], v229 offset:7264
  s_add_u32 s17, s17, s98
  v_mfma_f32_16x16x32_bf16 v[44:47], a[108:111], a[48:51], v[44:47]
  ds_read_b64_tr_b16 a[106:107], v229 offset:10848
  v_mfma_f32_16x16x32_bf16 v[100:103], a[108:111], a[52:55], v[100:103]
  v_mfma_f32_16x16x32_bf16 v[156:159], a[108:111], a[56:59], v[156:159]
  v_mfma_f32_16x16x32_bf16 v[212:215], a[108:111], a[60:63], v[212:215]
  ds_read_b64_tr_b16 a[108:109], v229 offset:7296
  ds_read_b64_tr_b16 a[110:111], v229 offset:10880
  v_mfma_f32_16x16x32_bf16 v[48:51], a[112:115], a[48:51], v[48:51]
  v_mfma_f32_16x16x32_bf16 v[104:107], a[112:115], a[52:55], v[104:107]
  buffer_load_dwordx4 a[44:47], v224, s[4:7], s16 offen offset:3072 sc1
  v_mfma_f32_16x16x32_bf16 v[160:163], a[112:115], a[56:59], v[160:163]
  s_add_u32 s16, s16, s46
  v_mfma_f32_16x16x32_bf16 v[216:219], a[112:115], a[60:63], v[216:219]
  ds_read_b64_tr_b16 a[112:113], v229 offset:7328
  ds_read_b64_tr_b16 a[114:115], v229 offset:10912
  v_mfma_f32_16x16x32_bf16 v[52:55], a[116:119], a[48:51], v[52:55]
  v_mfma_f32_16x16x32_bf16 v[108:111], a[116:119], a[52:55], v[108:111]
  v_mfma_f32_16x16x32_bf16 v[164:167], a[116:119], a[56:59], v[164:167]
  v_mfma_f32_16x16x32_bf16 v[220:223], a[116:119], a[60:63], v[220:223]
  s_waitcnt vmcnt(9) lgkmcnt(10)
  s_barrier
  v_mfma_f32_16x16x32_bf16 v[0:3], a[64:67], a[0:3], v[0:3]
  ds_read_b64_tr_b16 a[116:117], v229 offset:7360
  s_add_u32 m0, s38, 43008
  v_mfma_f32_16x16x32_bf16 v[56:59], a[64:67], a[4:7], v[56:59]
  buffer_load_dwordx4 v225, s[8:11], s17 offen lds
  v_mfma_f32_16x16x32_bf16 v[112:115], a[64:67], a[8:11], v[112:115]
  ds_read_b64_tr_b16 a[118:119], v229 offset:10944
  v_mfma_f32_16x16x32_bf16 v[168:171], a[64:67], a[12:15], v[168:171]
  ds_read_b64_tr_b16 a[64:65], v229 offset:14336
  ds_read_b64_tr_b16 a[66:67], v229 offset:17920
  v_mfma_f32_16x16x32_bf16 v[4:7], a[68:71], a[0:3], v[4:7]
  v_mfma_f32_16x16x32_bf16 v[60:63], a[68:71], a[4:7], v[60:63]
  v_mfma_f32_16x16x32_bf16 v[116:119], a[68:71], a[8:11], v[116:119]
  v_mfma_f32_16x16x32_bf16 v[172:175], a[68:71], a[12:15], v[172:175]
  buffer_load_dwordx4 a[48:51], v224, s[4:7], s16 offen offset:0 sc1
  v_mfma_f32_16x16x32_bf16 v[8:11], a[72:75], a[0:3], v[8:11]
  ds_read_b64_tr_b16 a[68:69], v229 offset:14368
  ds_read_b64_tr_b16 a[70:71], v229 offset:17952
  v_mfma_f32_16x16x32_bf16 v[64:67], a[72:75], a[4:7], v[64:67]
  v_mfma_f32_16x16x32_bf16 v[120:123], a[72:75], a[8:11], v[120:123]
  v_mfma_f32_16x16x32_bf16 v[176:179], a[72:75], a[12:15], v[176:179]
  ds_read_b64_tr_b16 a[72:73], v229 offset:14400
  ds_read_b64_tr_b16 a[74:75], v229 offset:17984
  v_mfma_f32_16x16x32_bf16 v[12:15], a[76:79], a[0:3], v[12:15]
  v_mfma_f32_16x16x32_bf16 v[68:71], a[76:79], a[4:7], v[68:71]
  buffer_load_dwordx4 v226, s[8:11], s17 offen offset:1024 lds
  v_mfma_f32_16x16x32_bf16 v[124:127], a[76:79], a[8:11], v[124:127]
  v_mfma_f32_16x16x32_bf16 v[180:183], a[76:79], a[12:15], v[180:183]
  ds_read_b64_tr_b16 a[76:77], v229 offset:14432
  ds_read_b64_tr_b16 a[78:79], v229 offset:18016
  v_mfma_f32_16x16x32_bf16 v[16:19], a[80:83], a[0:3], v[16:19]
  v_mfma_f32_16x16x32_bf16 v[72:75], a[80:83], a[4:7], v[72:75]
  v_mfma_f32_16x16x32_bf16 v[128:131], a[80:83], a[8:11], v[128:131]
  v_mfma_f32_16x16x32_bf16 v[184:187], a[80:83], a[12:15], v[184:187]
  buffer_load_dwordx4 a[52:55], v224, s[4:7], s16 offen offset:1024 sc1
  v_mfma_f32_16x16x32_bf16 v[20:23], a[84:87], a[0:3], v[20:23]
  ds_read_b64_tr_b16 a[80:81], v229 offset:14464
  ds_read_b64_tr_b16 a[82:83], v229 offset:18048
  v_mfma_f32_16x16x32_bf16 v[76:79], a[84:87], a[4:7], v[76:79]
  v_mfma_f32_16x16x32_bf16 v[132:135], a[84:87], a[8:11], v[132:135]
  v_mfma_f32_16x16x32_bf16 v[188:191], a[84:87], a[12:15], v[188:191]
  ds_read_b64_tr_b16 a[84:85], v229 offset:14496
  ds_read_b64_tr_b16 a[86:87], v229 offset:18080
  v_mfma_f32_16x16x32_bf16 v[24:27], a[88:91], a[0:3], v[24:27]
  v_mfma_f32_16x16x32_bf16 v[80:83], a[88:91], a[4:7], v[80:83]
  buffer_load_dwordx4 v227, s[8:11], s17 offen offset:2048 lds
  v_mfma_f32_16x16x32_bf16 v[136:139], a[88:91], a[8:11], v[136:139]
  v_mfma_f32_16x16x32_bf16 v[192:195], a[88:91], a[12:15], v[192:195]
  ds_read_b64_tr_b16 a[88:89], v229 offset:14528
  ds_read_b64_tr_b16 a[90:91], v229 offset:18112
  v_mfma_f32_16x16x32_bf16 v[28:31], a[92:95], a[0:3], v[28:31]
  v_mfma_f32_16x16x32_bf16 v[84:87], a[92:95], a[4:7], v[84:87]
  v_mfma_f32_16x16x32_bf16 v[140:143], a[92:95], a[8:11], v[140:143]
  v_mfma_f32_16x16x32_bf16 v[196:199], a[92:95], a[12:15], v[196:199]
  buffer_load_dwordx4 a[56:59], v224, s[4:7], s16 offen offset:2048 sc1
  s_waitcnt lgkmcnt(10)
  v_mfma_f32_16x16x32_bf16 v[32:35], a[96:99], a[0:3], v[32:35]
  ds_read_b64_tr_b16 a[92:93], v229 offset:21504
  ds_read_b64_tr_b16 a[94:95], v229 offset:25088
  v_mfma_f32_16x16x32_bf16 v[88:91], a[96:99], a[4:7], v[88:91]
  v_mfma_f32_16x16x32_bf16 v[144:147], a[96:99], a[8:11], v[144:147]
  v_mfma_f32_16x16x32_bf16 v[200:203], a[96:99], a[12:15], v[200:203]
  ds_read_b64_tr_b16 a[96:97], v229 offset:21536
  ds_read_b64_tr_b16 a[98:99], v229 offset:25120
  v_mfma_f32_16x16x32_bf16 v[36:39], a[100:103], a[0:3], v[36:39]
  v_mfma_f32_16x16x32_bf16 v[92:95], a[100:103], a[4:7], v[92:95]
  s_mov_b32 exec_hi, 0
  buffer_load_dwordx4 v228, s[8:11], s17 offen offset:3072 lds
  s_mov_b32 exec_hi, -1
  v_mfma_f32_16x16x32_bf16 v[148:151], a[100:103], a[8:11], v[148:151]
  s_add_u32 s17, s17, s99
  v_mfma_f32_16x16x32_bf16 v[204:207], a[100:103], a[12:15], v[204:207]
  ds_read_b64_tr_b16 a[100:101], v229 offset:21568
  ds_read_b64_tr_b16 a[102:103], v229 offset:25152
  v_mfma_f32_16x16x32_bf16 v[40:43], a[104:107], a[0:3], v[40:43]
  v_mfma_f32_16x16x32_bf16 v[96:99], a[104:107], a[4:7], v[96:99]
  v_mfma_f32_16x16x32_bf16 v[152:155], a[104:107], a[8:11], v[152:155]
  v_mfma_f32_16x16x32_bf16 v[208:211], a[104:107], a[12:15], v[208:211]
  buffer_load_dwordx4 a[60:63], v224, s[4:7], s16 offen offset:3072 sc1
  v_mfma_f32_16x16x32_bf16 v[44:47], a[108:111], a[0:3], v[44:47]
  ds_read_b64_tr_b16 a[104:105], v229 offset:21600
  s_add_u32 s16, s16, s47
  v_mfma_f32_16x16x32_bf16 v[100:103], a[108:111], a[4:7], v[100:103]
  ds_read_b64_tr_b16 a[106:107], v229 offset:25184
  v_mfma_f32_16x16x32_bf16 v[156:159], a[108:111], a[8:11], v[156:159]
  v_mfma_f32_16x16x32_bf16 v[212:215], a[108:111], a[12:15], v[212:215]
  ds_read_b64_tr_b16 a[108:109], v229 offset:21632
  ds_read_b64_tr_b16 a[110:111], v229 offset:25216
  v_mfma_f32_16x16x32_bf16 v[48:51], a[112:115], a[0:3], v[48:51]
  v_mfma_f32_16x16x32_bf16 v[104:107], a[112:115], a[4:7], v[104:107]
  s_getpc_b64 s[52:53]
  L_pc_23:
  s_add_u32 s52, s52, L_k56_seam-L_pc_23
  s_addc_u32 s53, s53, 0
  s_lshr_b32 s56, s2, 3
  s_lshl_b32 s56, s56, 2
  s_add_u32 s56, s56, s3
  s_lshl_b32 s56, s56, 13
  v_lshlrev_b32 v254, 7, v231
  v_add_u32 v254, s56, v254
  v_min_u32 v254, L_code_end-L_k56_seam-4, v254
  v_mov_b32 v255, s53
  v_add_co_u32 v254, vcc, s52, v254
  s_nop 1
  v_addc_co_u32 v255, vcc, 0, v255, vcc
  global_load_dword v251, v[254:255], off
  v_mfma_f32_16x16x32_bf16 v[160:163], a[112:115], a[8:11], v[160:163]
  v_mfma_f32_16x16x32_bf16 v[216:219], a[112:115], a[12:15], v[216:219]
  ds_read_b64_tr_b16 a[112:113], v229 offset:21664
  ds_read_b64_tr_b16 a[114:115], v229 offset:25248
  v_mfma_f32_16x16x32_bf16 v[52:55], a[116:119], a[0:3], v[52:55]
  v_mfma_f32_16x16x32_bf16 v[108:111], a[116:119], a[4:7], v[108:111]
  v_mfma_f32_16x16x32_bf16 v[164:167], a[116:119], a[8:11], v[164:167]
  v_mfma_f32_16x16x32_bf16 v[220:223], a[116:119], a[12:15], v[220:223]
  s_waitcnt vmcnt(10) lgkmcnt(10)
  s_barrier
  s_lshr_b32 s32, s31, 4
  s_mul_i32 s32, s32, 56
  v_mfma_f32_16x16x32_bf16 v[0:3], a[64:67], a[16:19], v[0:3]
  s_and_b32 s33, s31, 15
  s_add_u32 s34, s33, s32
  v_mfma_f32_16x16x32_bf16 v[56:59], a[64:67], a[20:23], v[56:59]
  s_lshl_b32 s98, s34, 17
  s_add_u32 s99, s98, 2097152
  v_mfma_f32_16x16x32_bf16 v[112:115], a[64:67], a[24:27], v[112:115]
  ds_read_b64_tr_b16 a[116:117], v229 offset:21696
  ds_read_b64_tr_b16 a[118:119], v229 offset:25280
  s_add_u32 s100, s98, 4194304
  s_lshr_b32 s34, s33, 1
  v_mfma_f32_16x16x32_bf16 v[168:171], a[64:67], a[28:31], v[168:171]
  s_add_u32 s34, s34, s32
  s_add_u32 s34, s34, 48
  v_mfma_f32_16x16x32_bf16 v[4:7], a[68:71], a[16:19], v[4:7]
  s_lshl_b32 s101, s34, 17
  s_and_b32 s35, s31, 1
  v_mfma_f32_16x16x32_bf16 v[60:63], a[68:71], a[20:23], v[60:63]
  s_lshl_b32 s35, s35, 10
  s_add_u32 s101, s101, s35
  v_mfma_f32_16x16x32_bf16 v[116:119], a[68:71], a[24:27], v[116:119]
  ds_read_b64_tr_b16 a[64:65], v229 offset:28672
  ds_read_b64_tr_b16 a[66:67], v229 offset:32256
  s_lshl_b32 s92, s30, 2
  s_add_u32 s92, s92, s3
  v_mfma_f32_16x16x32_bf16 v[172:175], a[68:71], a[28:31], v[172:175]
  s_lshl_b32 s92, s92, 5
  s_add_u32 s92, s92, s31
  v_mfma_f32_16x16x32_bf16 v[8:11], a[72:75], a[16:19], v[8:11]
  s_lshl_b32 s92, s92, 6
  s_add_u32 s56, s20, 0x80000
  v_mfma_f32_16x16x32_bf16 v[64:67], a[72:75], a[20:23], v[64:67]
  s_addc_u32 s57, s21, 0
  s_mov_b32 s58, 0x30000
  v_mfma_f32_16x16x32_bf16 v[120:123], a[72:75], a[24:27], v[120:123]
  ds_read_b64_tr_b16 a[68:69], v229 offset:28704
  ds_read_b64_tr_b16 a[70:71], v229 offset:32288
  s_mov_b32 s59, 0x20000
  s_and_b32 s28, s2, 1
  v_mfma_f32_16x16x32_bf16 v[176:179], a[72:75], a[28:31], v[176:179]
  s_lshr_b32 s29, s2, 3
  s_bfe_u32 s30, s2, 0x20001
  v_mfma_f32_16x16x32_bf16 v[12:15], a[76:79], a[16:19], v[12:15]
  s_lshl_b32 s30, s30, 2
  s_and_b32 s31, s29, 3
  v_mfma_f32_16x16x32_bf16 v[68:71], a[76:79], a[20:23], v[68:71]
  s_add_u32 s30, s30, s31
  s_lshr_b32 s29, s29, 2
  v_mfma_f32_16x16x32_bf16 v[124:127], a[76:79], a[24:27], v[124:127]
  ds_read_b64_tr_b16 a[72:73], v229 offset:28736
  ds_read_b64_tr_b16 a[74:75], v229 offset:32320
  s_lshl_b32 s31, s29, 1
  s_add_u32 s31, s31, s28
  v_mfma_f32_16x16x32_bf16 v[180:183], a[76:79], a[28:31], v[180:183]
  s_lshl_b32 s94, s30, 1
  s_lshr_b32 s33, s3, 1
  v_mfma_f32_16x16x32_bf16 v[16:19], a[80:83], a[16:19], v[16:19]
  s_add_u32 s94, s94, s33
  s_lshl_b32 s94, s94, 11
  v_mfma_f32_16x16x32_bf16 v[72:75], a[80:83], a[20:23], v[72:75]
  s_lshl_b32 s33, s28, 10
  s_add_u32 s94, s94, s33
  v_mfma_f32_16x16x32_bf16 v[128:131], a[80:83], a[24:27], v[128:131]
  ds_read_b64_tr_b16 a[76:77], v229 offset:28768
  ds_read_b64_tr_b16 a[78:79], v229 offset:32352
  v_and_b32 v246, 15, v231
  v_lshlrev_b32 v246, 6, v246
  v_mfma_f32_16x16x32_bf16 v[184:187], a[80:83], a[28:31], v[184:187]
  s_lshl_b32 s32, s30, 13
  s_lshl_b32 s33, s3, 11
  v_mfma_f32_16x16x32_bf16 v[20:23], a[84:87], a[16:19], v[20:23]
  s_add_u32 s32, s32, s33
  v_lshlrev_b32 v240, 4, v231
  v_mfma_f32_16x16x32_bf16 v[76:79], a[84:87], a[20:23], v[76:79]
  v_add_u32 v240, s32, v240
  v_add_u32 v241, 131072, v240
  v_mfma_f32_16x16x32_bf16 v[132:135], a[84:87], a[24:27], v[132:135]
  ds_read_b64_tr_b16 a[80:81], v229 offset:28800
  ds_read_b64_tr_b16 a[82:83], v229 offset:32384
  v_lshrrev_b32 v232, 3, v231
  v_and_b32 v233, 6, v232
  v_mfma_f32_16x16x32_bf16 v[188:191], a[84:87], a[28:31], v[188:191]
  v_and_b32 v234, 7, v231
  v_xor_b32 v233, v233, v234
  v_mfma_f32_16x16x32_bf16 v[24:27], a[88:91], a[16:19], v[24:27]
  v_lshlrev_b32 v232, 11, v232
  v_lshl_add_u32 v232, v233, 4, v232
  v_mfma_f32_16x16x32_bf16 v[80:83], a[88:91], a[20:23], v[80:83]
  s_lshl_b32 s32, s3, 15
  s_add_u32 s32, s32, 4096
  v_mfma_f32_16x16x32_bf16 v[136:139], a[88:91], a[24:27], v[136:139]
  ds_read_b64_tr_b16 a[84:85], v229 offset:28832
  ds_read_b64_tr_b16 a[86:87], v229 offset:32416
  s_lshl_b32 s33, s31, 7
  s_add_u32 s34, s32, s33
  v_mfma_f32_16x16x32_bf16 v[192:195], a[88:91], a[28:31], v[192:195]
  s_xor_b32 s33, s33, 128
  s_add_u32 s35, s32, s33
  v_mfma_f32_16x16x32_bf16 v[28:31], a[92:95], a[16:19], v[28:31]
  v_add_u32 v225, s34, v232
  v_add_u32 v226, 15360, v225
  v_mfma_f32_16x16x32_bf16 v[84:87], a[92:95], a[20:23], v[84:87]
  v_add_u32 v227, s35, v232
  v_add_u32 v228, 13312, v227
  v_mfma_f32_16x16x32_bf16 v[140:143], a[92:95], a[24:27], v[140:143]
  ds_read_b64_tr_b16 a[88:89], v229 offset:28864
  ds_read_b64_tr_b16 a[90:91], v229 offset:32448
  v_subrev_u32 v227, 2048, v227
  s_lshl_b32 s38, s3, 12
  v_mfma_f32_16x16x32_bf16 v[196:199], a[92:95], a[28:31], v[196:199]
  s_add_u32 s38, s38, 0
  s_mul_i32 s16, s28, 7340032
  s_waitcnt lgkmcnt(10)
  v_mfma_f32_16x16x32_bf16 v[32:35], a[96:99], a[16:19], v[32:35]
  s_mul_i32 s17, s28, 3670016
  s_lshr_b32 s33, s3, 1
  v_mfma_f32_16x16x32_bf16 v[88:91], a[96:99], a[20:23], v[88:91]
  s_mul_i32 s33, s33, 196608
  s_add_u32 s17, s17, s33
  v_mfma_f32_16x16x32_bf16 v[144:147], a[96:99], a[24:27], v[144:147]
  ds_read_b64_tr_b16 a[92:93], v229 offset:35840
  ds_read_b64_tr_b16 a[94:95], v229 offset:39424
  s_add_u32 s97, s17, s33
  s_add_u32 s97, s97, 196608
  v_mfma_f32_16x16x32_bf16 v[200:203], a[96:99], a[28:31], v[200:203]
  s_lshr_b32 s33, s2, 5
  s_mul_i32 s33, s33, 2
  v_mfma_f32_16x16x32_bf16 v[36:39], a[100:103], a[16:19], v[36:39]
  s_bfe_u32 s34, s2, 0x20003
  s_mul_i32 s34, s34, 1
  v_mfma_f32_16x16x32_bf16 v[92:95], a[100:103], a[20:23], v[92:95]
  s_add_u32 s33, s33, s34
  s_and_b32 s33, s33, 7
  v_mfma_f32_16x16x32_bf16 v[148:151], a[100:103], a[24:27], v[148:151]
  ds_read_b64_tr_b16 a[96:97], v229 offset:35872
  ds_read_b64_tr_b16 a[98:99], v229 offset:39456
  s_mov_b32 s95, s17
  s_add_u32 s93, s17, 3670016
  v_mfma_f32_16x16x32_bf16 v[204:207], a[100:103], a[28:31], v[204:207]
  s_mul_i32 s34, s33, 458752
  s_add_u32 s17, s17, s34
  v_mfma_f32_16x16x32_bf16 v[40:43], a[104:107], a[16:19], v[40:43]
  s_mov_b32 s40, s16
  s_lshl_b32 s41, s33, 18
  v_mfma_f32_16x16x32_bf16 v[96:99], a[104:107], a[20:23], v[96:99]
  s_add_u32 s16, s40, s41
  s_sub_u32 s8, s22, 4096
  v_mfma_f32_16x16x32_bf16 v[152:155], a[104:107], a[24:27], v[152:155]
  ds_read_b64_tr_b16 a[100:101], v229 offset:35904
  ds_read_b64_tr_b16 a[102:103], v229 offset:39488
  s_subb_u32 s9, s23, 0
  s_mov_b32 s10, 7344128
  v_mfma_f32_16x16x32_bf16 v[208:211], a[104:107], a[28:31], v[208:211]
  s_add_u32 s4, s20, 0x1600000
  s_addc_u32 s5, s21, 0
  v_mfma_f32_16x16x32_bf16 v[44:47], a[108:111], a[16:19], v[44:47]
  s_mov_b32 s6, 0xe00000
  s_mov_b32 s7, 0x20000
  v_mfma_f32_16x16x32_bf16 v[100:103], a[108:111], a[20:23], v[100:103]
  v_lshrrev_b32 v232, 2, v231
  v_lshlrev_b32 v232, 7, v232
  v_mfma_f32_16x16x32_bf16 v[156:159], a[108:111], a[24:27], v[156:159]
  ds_read_b64_tr_b16 a[104:105], v229 offset:35936
  ds_read_b64_tr_b16 a[106:107], v229 offset:39520
  v_bfe_u32 v233, v231, 3, 2
  v_lshl_add_u32 v232, v233, 5, v232
  v_mfma_f32_16x16x32_bf16 v[212:215], a[108:111], a[28:31], v[212:215]
  v_and_b32 v233, 3, v231
  v_lshl_add_u32 v232, v233, 3, v232
  v_mfma_f32_16x16x32_bf16 v[48:51], a[112:115], a[16:19], v[48:51]
  v_xor_b32 v242, 0, v232
  v_add_u32 v242, 0, v242
  v_mfma_f32_16x16x32_bf16 v[104:107], a[112:115], a[20:23], v[104:107]
  v_xor_b32 v243, 32, v232
  v_add_u32 v243, 0, v243
  v_mfma_f32_16x16x32_bf16 v[160:163], a[112:115], a[24:27], v[160:163]
  ds_read_b64_tr_b16 a[108:109], v229 offset:35968
  ds_read_b64_tr_b16 a[110:111], v229 offset:39552
  v_xor_b32 v244, 64, v232
  v_add_u32 v244, 0, v244
  v_mfma_f32_16x16x32_bf16 v[216:219], a[112:115], a[28:31], v[216:219]
  v_xor_b32 v245, 96, v232
  v_add_u32 v245, 0, v245
  v_mfma_f32_16x16x32_bf16 v[52:55], a[116:119], a[16:19], v[52:55]
  s_mov_b32 s42, 0xbfb8aa3b
  s_mov_b32 s43, 0xbfb8aa3b
  v_mfma_f32_16x16x32_bf16 v[108:111], a[116:119], a[20:23], v[108:111]
  s_mov_b32 s62, 1.0
  s_mov_b32 s63, 1.0
  v_mfma_f32_16x16x32_bf16 v[164:167], a[116:119], a[24:27], v[164:167]
  ds_read_b64_tr_b16 a[112:113], v229 offset:36000
  ds_read_b64_tr_b16 a[114:115], v229 offset:39584
  v_mfma_f32_16x16x32_bf16 v[220:223], a[116:119], a[28:31], v[220:223]
  s_waitcnt vmcnt(2) lgkmcnt(10)
  s_barrier
  v_mfma_f32_16x16x32_bf16 v[0:3], a[64:67], a[32:35], v[0:3]
  ds_read_b64_tr_b16 a[116:117], v229 offset:36032
  ds_read_b64_tr_b16 a[118:119], v229 offset:39616
  v_mfma_f32_16x16x32_bf16 v[56:59], a[64:67], a[36:39], v[56:59]
  s_add_u32 m0, s38, 0
  s_nop 0
  buffer_load_dwordx4 v225, s[8:11], s17 offen lds
  v_mfma_f32_16x16x32_bf16 v[112:115], a[64:67], a[40:43], v[112:115]
  v_mfma_f32_16x16x32_bf16 v[168:171], a[64:67], a[44:47], v[168:171]
  ds_read_b64_tr_b16 a[64:65], v229 offset:43008
  ds_read_b64_tr_b16 a[66:67], v229 offset:46592
  v_mfma_f32_16x16x32_bf16 v[4:7], a[68:71], a[32:35], v[4:7]
  v_mfma_f32_16x16x32_bf16 v[60:63], a[68:71], a[36:39], v[60:63]
  buffer_load_dwordx4 v226, s[8:11], s17 offen offset:1024 lds
  v_mfma_f32_16x16x32_bf16 v[116:119], a[68:71], a[40:43], v[116:119]
  v_mfma_f32_16x16x32_bf16 v[172:175], a[68:71], a[44:47], v[172:175]
  ds_read_b64_tr_b16 a[68:69], v229 offset:43040
  ds_read_b64_tr_b16 a[70:71], v229 offset:46624
  v_mfma_f32_16x16x32_bf16 v[8:11], a[72:75], a[32:35], v[8:11]
  v_mfma_f32_16x16x32_bf16 v[64:67], a[72:75], a[36:39], v[64:67]
  buffer_load_dwordx4 v227, s[8:11], s17 offen offset:2048 lds
  v_mfma_f32_16x16x32_bf16 v[120:123], a[72:75], a[40:43], v[120:123]
  v_mfma_f32_16x16x32_bf16 v[176:179], a[72:75], a[44:47], v[176:179]
  ds_read_b64_tr_b16 a[72:73], v229 offset:50176
  ds_read_b64_tr_b16 a[74:75], v229 offset:53760
  v_mfma_f32_16x16x32_bf16 v[12:15], a[76:79], a[32:35], v[12:15]
  v_mfma_f32_16x16x32_bf16 v[68:71], a[76:79], a[36:39], v[68:71]
  buffer_load_dwordx4 v228, s[8:11], s17 offen offset:3072 lds
  s_add_u32 s17, s17, 458752
  s_cmp_eq_u32 s17, s93
  s_cselect_b32 s17, s95, s17
  v_mfma_f32_16x16x32_bf16 v[124:127], a[76:79], a[40:43], v[124:127]
  v_mfma_f32_16x16x32_bf16 v[180:183], a[76:79], a[44:47], v[180:183]
  ds_read_b64_tr_b16 a[76:77], v229 offset:50208
  ds_read_b64_tr_b16 a[78:79], v229 offset:53792
  v_mfma_f32_16x16x32_bf16 v[16:19], a[80:83], a[32:35], v[16:19]
  v_mfma_f32_16x16x32_bf16 v[72:75], a[80:83], a[36:39], v[72:75]
  s_add_u32 m0, s38, 16384
  s_nop 0
  buffer_load_dwordx4 v225, s[8:11], s17 offen lds
  v_mfma_f32_16x16x32_bf16 v[128:131], a[80:83], a[40:43], v[128:131]
  v_mfma_f32_16x16x32_bf16 v[184:187], a[80:83], a[44:47], v[184:187]
  ds_read_b64_tr_b16 a[80:81], v229 offset:43072
  ds_read_b64_tr_b16 a[82:83], v229 offset:46656
  v_mfma_f32_16x16x32_bf16 v[20:23], a[84:87], a[32:35], v[20:23]
  v_mfma_f32_16x16x32_bf16 v[76:79], a[84:87], a[36:39], v[76:79]
  buffer_load_dwordx4 v226, s[8:11], s17 offen offset:1024 lds
  v_mfma_f32_16x16x32_bf16 v[132:135], a[84:87], a[40:43], v[132:135]
  v_mfma_f32_16x16x32_bf16 v[188:191], a[84:87], a[44:47], v[188:191]
  ds_read_b64_tr_b16 a[84:85], v229 offset:43104
  ds_read_b64_tr_b16 a[86:87], v229 offset:46688
  v_mfma_f32_16x16x32_bf16 v[24:27], a[88:91], a[32:35], v[24:27]
  v_mfma_f32_16x16x32_bf16 v[80:83], a[88:91], a[36:39], v[80:83]
  buffer_load_dwordx4 v227, s[8:11], s17 offen offset:2048 lds
  v_mfma_f32_16x16x32_bf16 v[136:139], a[88:91], a[40:43], v[136:139]
  v_mfma_f32_16x16x32_bf16 v[192:195], a[88:91], a[44:47], v[192:195]
  ds_read_b64_tr_b16 a[88:89], v229 offset:50240
  ds_read_b64_tr_b16 a[90:91], v229 offset:53824
  v_mfma_f32_16x16x32_bf16 v[28:31], a[92:95], a[32:35], v[28:31]
  v_mfma_f32_16x16x32_bf16 v[84:87], a[92:95], a[36:39], v[84:87]
  buffer_load_dwordx4 v228, s[8:11], s17 offen offset:3072 lds
  s_add_u32 s17, s17, 458752
  s_cmp_eq_u32 s17, s93
  s_cselect_b32 s17, s95, s17
  v_mfma_f32_16x16x32_bf16 v[140:143], a[92:95], a[40:43], v[140:143]
  v_mfma_f32_16x16x32_bf16 v[196:199], a[92:95], a[44:47], v[196:199]
  ds_read_b64_tr_b16 a[92:93], v229 offset:50272
  ds_read_b64_tr_b16 a[94:95], v229 offset:53856
  s_waitcnt lgkmcnt(10)
  v_mfma_f32_16x16x32_bf16 v[32:35], a[96:99], a[32:35], v[32:35]
  v_mfma_f32_16x16x32_bf16 v[88:91], a[96:99], a[36:39], v[88:91]
  s_add_u32 m0, s38, 32768
  s_nop 0
  buffer_load_dwordx4 v225, s[8:11], s17 offen lds
  v_mfma_f32_16x16x32_bf16 v[144:147], a[96:99], a[40:43], v[144:147]
  v_mfma_f32_16x16x32_bf16 v[200:203], a[96:99], a[44:47], v[200:203]
  ds_read_b64_tr_b16 a[96:97], v229 offset:43136
  ds_read_b64_tr_b16 a[98:99], v229 offset:46720
  v_mfma_f32_16x16x32_bf16 v[36:39], a[100:103], a[32:35], v[36:39]
  v_mfma_f32_16x16x32_bf16 v[92:95], a[100:103], a[36:39], v[92:95]
  buffer_load_dwordx4 v226, s[8:11], s17 offen offset:1024 lds
  v_mfma_f32_16x16x32_bf16 v[148:151], a[100:103], a[40:43], v[148:151]
  v_mfma_f32_16x16x32_bf16 v[204:207], a[100:103], a[44:47], v[204:207]
  ds_read_b64_tr_b16 a[100:101], v229 offset:43168
  ds_read_b64_tr_b16 a[102:103], v229 offset:46752
  v_mfma_f32_16x16x32_bf16 v[40:43], a[104:107], a[32:35], v[40:43]
  v_mfma_f32_16x16x32_bf16 v[96:99], a[104:107], a[36:39], v[96:99]
  buffer_load_dwordx4 v227, s[8:11], s17 offen offset:2048 lds
  v_mfma_f32_16x16x32_bf16 v[152:155], a[104:107], a[40:43], v[152:155]
  v_mfma_f32_16x16x32_bf16 v[208:211], a[104:107], a[44:47], v[208:211]
  ds_read_b64_tr_b16 a[104:105], v229 offset:43200
  ds_read_b64_tr_b16 a[106:107], v229 offset:46784
  v_mfma_f32_16x16x32_bf16 v[44:47], a[108:111], a[32:35], v[44:47]
  v_mfma_f32_16x16x32_bf16 v[100:103], a[108:111], a[36:39], v[100:103]
  buffer_load_dwordx4 v228, s[8:11], s17 offen offset:3072 lds
  s_add_u32 s17, s17, 458752
  s_cmp_eq_u32 s17, s93
  s_cselect_b32 s17, s95, s17
  v_mfma_f32_16x16x32_bf16 v[156:159], a[108:111], a[40:43], v[156:159]
  v_mfma_f32_16x16x32_bf16 v[212:215], a[108:111], a[44:47], v[212:215]
  ds_read_b64_tr_b16 a[108:109], v229 offset:50304
  ds_read_b64_tr_b16 a[110:111], v229 offset:53888
  v_mfma_f32_16x16x32_bf16 v[48:51], a[112:115], a[32:35], v[48:51]
  v_mfma_f32_16x16x32_bf16 v[104:107], a[112:115], a[36:39], v[104:107]
  v_mfma_f32_16x16x32_bf16 v[160:163], a[112:115], a[40:43], v[160:163]
  v_mfma_f32_16x16x32_bf16 v[216:219], a[112:115], a[44:47], v[216:219]
  ds_read_b64_tr_b16 a[112:113], v229 offset:50336
  ds_read_b64_tr_b16 a[114:115], v229 offset:53920
  v_mfma_f32_16x16x32_bf16 v[52:55], a[116:119], a[32:35], v[52:55]
  v_mfma_f32_16x16x32_bf16 v[108:111], a[116:119], a[36:39], v[108:111]
  v_mfma_f32_16x16x32_bf16 v[164:167], a[116:119], a[40:43], v[164:167]
  v_mfma_f32_16x16x32_bf16 v[220:223], a[116:119], a[44:47], v[220:223]
  s_waitcnt vmcnt(13) lgkmcnt(10)
  s_barrier
  v_mfma_f32_16x16x32_bf16 v[0:3], a[64:67], a[48:51], v[0:3]
  ds_read_b64_tr_b16 a[116:117], v229 offset:50368
  ds_read_b64_tr_b16 a[118:119], v229 offset:53952
  v_mfma_f32_16x16x32_bf16 v[56:59], a[64:67], a[52:55], v[56:59]
  s_add_u32 m0, s38, 49152
  s_nop 0
  buffer_load_dwordx4 v225, s[8:11], s17 offen lds
  v_mfma_f32_16x16x32_bf16 v[112:115], a[64:67], a[56:59], v[112:115]
  v_mfma_f32_16x16x32_bf16 v[168:171], a[64:67], a[60:63], v[168:171]
  v_mfma_f32_16x16x32_bf16 v[4:7], a[68:71], a[48:51], v[4:7]
  v_mfma_f32_16x16x32_bf16 v[60:63], a[68:71], a[52:55], v[60:63]
  buffer_load_dwordx4 v226, s[8:11], s17 offen offset:1024 lds
  v_mfma_f32_16x16x32_bf16 v[116:119], a[68:71], a[56:59], v[116:119]
  v_mfma_f32_16x16x32_bf16 v[172:175], a[68:71], a[60:63], v[172:175]
  v_mfma_f32_16x16x32_bf16 v[28:31], a[72:75], a[48:51], v[28:31]
  v_mfma_f32_16x16x32_bf16 v[84:87], a[72:75], a[52:55], v[84:87]
  buffer_load_dwordx4 v227, s[8:11], s17 offen offset:2048 lds
  v_mfma_f32_16x16x32_bf16 v[140:143], a[72:75], a[56:59], v[140:143]
  v_mfma_f32_16x16x32_bf16 v[196:199], a[72:75], a[60:63], v[196:199]
  v_mfma_f32_16x16x32_bf16 v[32:35], a[76:79], a[48:51], v[32:35]
  v_mfma_f32_16x16x32_bf16 v[88:91], a[76:79], a[52:55], v[88:91]
  buffer_load_dwordx4 v228, s[8:11], s17 offen offset:3072 lds
  s_add_u32 s17, s17, 458752
  s_cmp_eq_u32 s17, s93
  s_cselect_b32 s17, s95, s17
  v_mfma_f32_16x16x32_bf16 v[144:147], a[76:79], a[56:59], v[144:147]
  v_mfma_f32_16x16x32_bf16 v[200:203], a[76:79], a[60:63], v[200:203]
  v_mfma_f32_16x16x32_bf16 v[8:11], a[80:83], a[48:51], v[8:11]
  v_mfma_f32_16x16x32_bf16 v[64:67], a[80:83], a[52:55], v[64:67]
  s_add_u32 m0, s38, 65536
  s_nop 0
  buffer_load_dwordx4 v225, s[8:11], s17 offen lds
  v_mfma_f32_16x16x32_bf16 v[120:123], a[80:83], a[56:59], v[120:123]
  v_mfma_f32_16x16x32_bf16 v[176:179], a[80:83], a[60:63], v[176:179]
  v_mfma_f32_16x16x32_bf16 v[12:15], a[84:87], a[48:51], v[12:15]
  v_mfma_f32_16x16x32_bf16 v[68:71], a[84:87], a[52:55], v[68:71]
  buffer_load_dwordx4 v226, s[8:11], s17 offen offset:1024 lds
  v_mfma_f32_16x16x32_bf16 v[124:127], a[84:87], a[56:59], v[124:127]
  v_mfma_f32_16x16x32_bf16 v[180:183], a[84:87], a[60:63], v[180:183]
  v_mfma_f32_16x16x32_bf16 v[36:39], a[88:91], a[48:51], v[36:39]
  v_mfma_f32_16x16x32_bf16 v[92:95], a[88:91], a[52:55], v[92:95]
  buffer_load_dwordx4 v227, s[8:11], s17 offen offset:2048 lds
  v_mfma_f32_16x16x32_bf16 v[148:151], a[88:91], a[56:59], v[148:151]
  v_mfma_f32_16x16x32_bf16 v[204:207], a[88:91], a[60:63], v[204:207]
  v_mfma_f32_16x16x32_bf16 v[40:43], a[92:95], a[48:51], v[40:43]
  v_mfma_f32_16x16x32_bf16 v[96:99], a[92:95], a[52:55], v[96:99]
  buffer_load_dwordx4 v228, s[8:11], s17 offen offset:3072 lds
  s_add_u32 s17, s17, 458752
  s_cmp_eq_u32 s17, s93
  s_cselect_b32 s17, s95, s17
  v_mfma_f32_16x16x32_bf16 v[152:155], a[92:95], a[56:59], v[152:155]
  v_mfma_f32_16x16x32_bf16 v[208:211], a[92:95], a[60:63], v[208:211]
  s_waitcnt lgkmcnt(10)
  v_mfma_f32_16x16x32_bf16 v[16:19], a[96:99], a[48:51], v[16:19]
  v_mfma_f32_16x16x32_bf16 v[72:75], a[96:99], a[52:55], v[72:75]
  s_add_u32 m0, s38, 81920
  s_nop 0
  buffer_load_dwordx4 v225, s[8:11], s17 offen lds
  v_mfma_f32_16x16x32_bf16 v[128:131], a[96:99], a[56:59], v[128:131]
  v_mfma_f32_16x16x32_bf16 v[184:187], a[96:99], a[60:63], v[184:187]
  s_waitcnt lgkmcnt(8)
  v_mfma_f32_16x16x32_bf16 v[20:23], a[100:103], a[48:51], v[20:23]
  v_mfma_f32_16x16x32_bf16 v[76:79], a[100:103], a[52:55], v[76:79]
  buffer_load_dwordx4 v226, s[8:11], s17 offen offset:1024 lds
  v_mfma_f32_16x16x32_bf16 v[132:135], a[100:103], a[56:59], v[132:135]
  v_mfma_f32_16x16x32_bf16 v[188:191], a[100:103], a[60:63], v[188:191]
  s_waitcnt lgkmcnt(6)
  v_mfma_f32_16x16x32_bf16 v[24:27], a[104:107], a[48:51], v[24:27]
  v_mfma_f32_16x16x32_bf16 v[80:83], a[104:107], a[52:55], v[80:83]
  buffer_load_dwordx4 v227, s[8:11], s17 offen offset:2048 lds
  v_mfma_f32_16x16x32_bf16 v[136:139], a[104:107], a[56:59], v[136:139]
  v_mfma_f32_16x16x32_bf16 v[192:195], a[104:107], a[60:63], v[192:195]
  s_waitcnt lgkmcnt(4)
  v_mfma_f32_16x16x32_bf16 v[44:47], a[108:111], a[48:51], v[44:47]
  v_mfma_f32_16x16x32_bf16 v[100:103], a[108:111], a[52:55], v[100:103]
  buffer_load_dwordx4 v228, s[8:11], s17 offen offset:3072 lds
  s_add_u32 s17, s17, 458752
  s_cmp_eq_u32 s17, s93
  s_cselect_b32 s17, s95, s17
  v_mfma_f32_16x16x32_bf16 v[156:159], a[108:111], a[56:59], v[156:159]
  v_mfma_f32_16x16x32_bf16 v[212:215], a[108:111], a[60:63], v[212:215]
  s_waitcnt lgkmcnt(2)
  v_mfma_f32_16x16x32_bf16 v[48:51], a[112:115], a[48:51], v[48:51]
  v_mfma_f32_16x16x32_bf16 v[104:107], a[112:115], a[52:55], v[104:107]
  v_mfma_f32_16x16x32_bf16 v[160:163], a[112:115], a[56:59], v[160:163]
  v_mfma_f32_16x16x32_bf16 v[216:219], a[112:115], a[60:63], v[216:219]
  s_waitcnt lgkmcnt(0)
  v_mfma_f32_16x16x32_bf16 v[52:55], a[116:119], a[48:51], v[52:55]
  v_mfma_f32_16x16x32_bf16 v[108:111], a[116:119], a[52:55], v[108:111]
  v_mfma_f32_16x16x32_bf16 v[164:167], a[116:119], a[56:59], v[164:167]
  v_mfma_f32_16x16x32_bf16 v[220:223], a[116:119], a[60:63], v[220:223]
  s_nop 7
  s_nop 1
L_k56_seam:
  v_pk_mul_f32 v[232:233], v[0:1], s[42:43]
  v_pk_mul_f32 v[234:235], v[2:3], s[42:43]
  v_exp_f32 v232, v232
  v_exp_f32 v233, v233
  v_exp_f32 v234, v234
  v_exp_f32 v235, v235
  v_pk_add_f32 v[232:233], v[232:233], s[62:63]
  v_pk_add_f32 v[234:235], v[234:235], s[62:63]
  v_rcp_f32 v232, v232
  v_rcp_f32 v233, v233
  v_rcp_f32 v234, v234
  v_rcp_f32 v235, v235
  v_pk_mul_f32 v[232:233], v[232:233], v[28:29]
  v_pk_mul_f32 v[234:235], v[234:235], v[30:31]
  v_cvt_pk_bf16_f32 v0, v232, v233
  v_cvt_pk_bf16_f32 v1, v234, v235
  v_pk_mul_f32 v[236:237], v[4:5], s[42:43]
  v_pk_mul_f32 v[238:239], v[6:7], s[42:43]
  v_exp_f32 v236, v236
  v_exp_f32 v237, v237
  v_exp_f32 v238, v238
  v_exp_f32 v239, v239
  v_pk_add_f32 v[236:237], v[236:237], s[62:63]
  v_pk_add_f32 v[238:239], v[238:239], s[62:63]
  v_rcp_f32 v236, v236
  v_rcp_f32 v237, v237
  v_rcp_f32 v238, v238
  v_rcp_f32 v239, v239
  v_pk_mul_f32 v[236:237], v[236:237], v[32:33]
  v_pk_mul_f32 v[238:239], v[238:239], v[34:35]
  v_cvt_pk_bf16_f32 v2, v236, v237
  v_cvt_pk_bf16_f32 v3, v238, v239
  buffer_store_dwordx4 v[0:3], v224, s[12:15], s98 offen offset:0 sc1
  v_pk_mul_f32 v[232:233], v[56:57], s[42:43]
  v_pk_mul_f32 v[234:235], v[58:59], s[42:43]
  v_exp_f32 v232, v232
  v_exp_f32 v233, v233
  v_exp_f32 v234, v234
  v_exp_f32 v235, v235
  v_pk_add_f32 v[232:233], v[232:233], s[62:63]
  v_pk_add_f32 v[234:235], v[234:235], s[62:63]
  v_rcp_f32 v232, v232
  v_rcp_f32 v233, v233
  v_rcp_f32 v234, v234
  v_rcp_f32 v235, v235
  v_pk_mul_f32 v[232:233], v[232:233], v[84:85]
  v_pk_mul_f32 v[234:235], v[234:235], v[86:87]
  v_cvt_pk_bf16_f32 v56, v232, v233
  v_cvt_pk_bf16_f32 v57, v234, v235
  v_pk_mul_f32 v[236:237], v[60:61], s[42:43]
  v_pk_mul_f32 v[238:239], v[62:63], s[42:43]
  v_exp_f32 v236, v236
  v_exp_f32 v237, v237
  v_exp_f32 v238, v238
  v_exp_f32 v239, v239
  v_pk_add_f32 v[236:237], v[236:237], s[62:63]
  v_pk_add_f32 v[238:239], v[238:239], s[62:63]
  v_rcp_f32 v236, v236
  v_rcp_f32 v237, v237
  v_rcp_f32 v238, v238
  v_rcp_f32 v239, v239
  v_pk_mul_f32 v[236:237], v[236:237], v[88:89]
  v_pk_mul_f32 v[238:239], v[238:239], v[90:91]
  v_cvt_pk_bf16_f32 v58, v236, v237
  v_cvt_pk_bf16_f32 v59, v238, v239
  buffer_store_dwordx4 v[56:59], v224, s[12:15], s98 offen offset:1024 sc1
  v_pk_mul_f32 v[232:233], v[112:113], s[42:43]
  v_pk_mul_f32 v[234:235], v[114:115], s[42:43]
  v_exp_f32 v232, v232
  v_exp_f32 v233, v233
  v_exp_f32 v234, v234
  v_exp_f32 v235, v235
  v_pk_add_f32 v[232:233], v[232:233], s[62:63]
  v_pk_add_f32 v[234:235], v[234:235], s[62:63]
  v_rcp_f32 v232, v232
  v_rcp_f32 v233, v233
  v_rcp_f32 v234, v234
  v_rcp_f32 v235, v235
  v_pk_mul_f32 v[232:233], v[232:233], v[140:141]
  v_pk_mul_f32 v[234:235], v[234:235], v[142:143]
  v_cvt_pk_bf16_f32 v112, v232, v233
  v_cvt_pk_bf16_f32 v113, v234, v235
  v_pk_mul_f32 v[236:237], v[116:117], s[42:43]
  v_pk_mul_f32 v[238:239], v[118:119], s[42:43]
  v_exp_f32 v236, v236
  v_exp_f32 v237, v237
  v_exp_f32 v238, v238
  v_exp_f32 v239, v239
  v_pk_add_f32 v[236:237], v[236:237], s[62:63]
  v_pk_add_f32 v[238:239], v[238:239], s[62:63]
  v_rcp_f32 v236, v236
  v_rcp_f32 v237, v237
  v_rcp_f32 v238, v238
  v_rcp_f32 v239, v239
  v_pk_mul_f32 v[236:237], v[236:237], v[144:145]
  v_pk_mul_f32 v[238:239], v[238:239], v[146:147]
  v_cvt_pk_bf16_f32 v114, v236, v237
  v_cvt_pk_bf16_f32 v115, v238, v239
  buffer_store_dwordx4 v[112:115], v224, s[12:15], s98 offen offset:2048 sc1
  v_pk_mul_f32 v[232:233], v[168:169], s[42:43]
  v_pk_mul_f32 v[234:235], v[170:171], s[42:43]
  v_exp_f32 v232, v232
  v_exp_f32 v233, v233
  v_exp_f32 v234, v234
  v_exp_f32 v235, v235
  v_pk_add_f32 v[232:233], v[232:233], s[62:63]
  v_pk_add_f32 v[234:235], v[234:235], s[62:63]
  v_rcp_f32 v232, v232
  v_rcp_f32 v233, v233
  v_rcp_f32 v234, v234
  v_rcp_f32 v235, v235
  v_pk_mul_f32 v[232:233], v[232:233], v[196:197]
  v_pk_mul_f32 v[234:235], v[234:235], v[198:199]
  v_cvt_pk_bf16_f32 v168, v232, v233
  v_cvt_pk_bf16_f32 v169, v234, v235
  v_pk_mul_f32 v[236:237], v[172:173], s[42:43]
  v_pk_mul_f32 v[238:239], v[174:175], s[42:43]
  v_exp_f32 v236, v236
  v_exp_f32 v237, v237
  v_exp_f32 v238, v238
  v_exp_f32 v239, v239
  v_pk_add_f32 v[236:237], v[236:237], s[62:63]
  v_pk_add_f32 v[238:239], v[238:239], s[62:63]
  v_rcp_f32 v236, v236
  v_rcp_f32 v237, v237
  v_rcp_f32 v238, v238
  v_rcp_f32 v239, v239
  v_pk_mul_f32 v[236:237], v[236:237], v[200:201]
  v_pk_mul_f32 v[238:239], v[238:239], v[202:203]
  v_cvt_pk_bf16_f32 v170, v236, v237
  v_cvt_pk_bf16_f32 v171, v238, v239
  buffer_store_dwordx4 v[168:171], v224, s[12:15], s98 offen offset:3072 sc1
  v_pk_mul_f32 v[232:233], v[8:9], s[42:43]
  v_pk_mul_f32 v[234:235], v[10:11], s[42:43]
  v_exp_f32 v232, v232
  v_exp_f32 v233, v233
  v_exp_f32 v234, v234
  v_exp_f32 v235, v235
  v_pk_add_f32 v[232:233], v[232:233], s[62:63]
  v_pk_add_f32 v[234:235], v[234:235], s[62:63]
  v_rcp_f32 v232, v232
  v_rcp_f32 v233, v233
  v_rcp_f32 v234, v234
  v_rcp_f32 v235, v235
  v_pk_mul_f32 v[232:233], v[232:233], v[36:37]
  v_pk_mul_f32 v[234:235], v[234:235], v[38:39]
  v_cvt_pk_bf16_f32 v4, v232, v233
  v_cvt_pk_bf16_f32 v5, v234, v235
  v_pk_mul_f32 v[236:237], v[12:13], s[42:43]
  v_pk_mul_f32 v[238:239], v[14:15], s[42:43]
  v_exp_f32 v236, v236
  v_exp_f32 v237, v237
  v_exp_f32 v238, v238
  v_exp_f32 v239, v239
  v_pk_add_f32 v[236:237], v[236:237], s[62:63]
  v_pk_add_f32 v[238:239], v[238:239], s[62:63]
  v_rcp_f32 v236, v236
  v_rcp_f32 v237, v237
  v_rcp_f32 v238, v238
  v_rcp_f32 v239, v239
  v_pk_mul_f32 v[236:237], v[236:237], v[40:41]
  v_pk_mul_f32 v[238:239], v[238:239], v[42:43]
  v_cvt_pk_bf16_f32 v6, v236, v237
  v_cvt_pk_bf16_f32 v7, v238, v239
  v_pk_mul_f32 v[232:233], v[64:65], s[42:43]
  v_pk_mul_f32 v[234:235], v[66:67], s[42:43]
  v_exp_f32 v232, v232
  v_exp_f32 v233, v233
  v_exp_f32 v234, v234
  v_exp_f32 v235, v235
  v_pk_add_f32 v[232:233], v[232:233], s[62:63]
  v_pk_add_f32 v[234:235], v[234:235], s[62:63]
  v_rcp_f32 v232, v232
  v_rcp_f32 v233, v233
  v_rcp_f32 v234, v234
  v_rcp_f32 v235, v235
  v_pk_mul_f32 v[232:233], v[232:233], v[92:93]
  v_pk_mul_f32 v[234:235], v[234:235], v[94:95]
  v_cvt_pk_bf16_f32 v60, v232, v233
  v_cvt_pk_bf16_f32 v61, v234, v235
  v_pk_mul_f32 v[236:237], v[68:69], s[42:43]
  v_pk_mul_f32 v[238:239], v[70:71], s[42:43]
  v_exp_f32 v236, v236
  v_exp_f32 v237, v237
  v_exp_f32 v238, v238
  v_exp_f32 v239, v239
  v_pk_add_f32 v[236:237], v[236:237], s[62:63]
  v_pk_add_f32 v[238:239], v[238:239], s[62:63]
  v_rcp_f32 v236, v236
  v_rcp_f32 v237, v237
  v_rcp_f32 v238, v238
  v_rcp_f32 v239, v239
  v_pk_mul_f32 v[236:237], v[236:237], v[96:97]
  v_pk_mul_f32 v[238:239], v[238:239], v[98:99]
  v_cvt_pk_bf16_f32 v62, v236, v237
  v_cvt_pk_bf16_f32 v63, v238, v239
  v_pk_mul_f32 v[232:233], v[120:121], s[42:43]
  v_pk_mul_f32 v[234:235], v[122:123], s[42:43]
  v_exp_f32 v232, v232
  v_exp_f32 v233, v233
  v_exp_f32 v234, v234
  v_exp_f32 v235, v235
  v_pk_add_f32 v[232:233], v[232:233], s[62:63]
  v_pk_add_f32 v[234:235], v[234:235], s[62:63]
  v_rcp_f32 v232, v232
  v_rcp_f32 v233, v233
  v_rcp_f32 v234, v234
  v_rcp_f32 v235, v235
  v_pk_mul_f32 v[232:233], v[232:233], v[148:149]
  v_pk_mul_f32 v[234:235], v[234:235], v[150:151]
  v_cvt_pk_bf16_f32 v116, v232, v233
  v_cvt_pk_bf16_f32 v117, v234, v235
  v_pk_mul_f32 v[236:237], v[124:125], s[42:43]
  v_pk_mul_f32 v[238:239], v[126:127], s[42:43]
  v_exp_f32 v236, v236
  v_exp_f32 v237, v237
  v_exp_f32 v238, v238
  v_exp_f32 v239, v239
  v_pk_add_f32 v[236:237], v[236:237], s[62:63]
  v_pk_add_f32 v[238:239], v[238:239], s[62:63]
  v_rcp_f32 v236, v236
  v_rcp_f32 v237, v237
  v_rcp_f32 v238, v238
  v_rcp_f32 v239, v239
  v_pk_mul_f32 v[236:237], v[236:237], v[152:153]
  v_pk_mul_f32 v[238:239], v[238:239], v[154:155]
  v_cvt_pk_bf16_f32 v118, v236, v237
  v_cvt_pk_bf16_f32 v119, v238, v239
  s_waitcnt vmcnt(0)
  s_mov_b64 exec, 1
  buffer_store_dword v248, v250, s[56:59], s92 offen sc1
  s_mov_b64 exec, -1
  s_add_u32 s92, s92, 65536
  s_barrier
  v_pk_mul_f32 v[232:233], v[176:177], s[42:43]
  v_pk_mul_f32 v[234:235], v[178:179], s[42:43]
  v_exp_f32 v232, v232
  v_exp_f32 v233, v233
  v_exp_f32 v234, v234
  v_exp_f32 v235, v235
  v_pk_add_f32 v[232:233], v[232:233], s[62:63]
  v_pk_add_f32 v[234:235], v[234:235], s[62:63]
  s_add_u32 m0, s38, 98304
  s_nop 0
  buffer_load_dwordx4 v225, s[8:11], s17 offen lds
  v_rcp_f32 v232, v232
  v_rcp_f32 v233, v233
  v_rcp_f32 v234, v234
  v_rcp_f32 v235, v235
  v_pk_mul_f32 v[232:233], v[232:233], v[204:205]
  v_pk_mul_f32 v[234:235], v[234:235], v[206:207]
  v_cvt_pk_bf16_f32 v172, v232, v233
  v_cvt_pk_bf16_f32 v173, v234, v235
  buffer_load_dwordx4 v226, s[8:11], s17 offen offset:1024 lds
  v_pk_mul_f32 v[236:237], v[180:181], s[42:43]
  v_pk_mul_f32 v[238:239], v[182:183], s[42:43]
  v_exp_f32 v236, v236
  v_exp_f32 v237, v237
  v_exp_f32 v238, v238
  v_exp_f32 v239, v239
  v_pk_add_f32 v[236:237], v[236:237], s[62:63]
  v_pk_add_f32 v[238:239], v[238:239], s[62:63]
  buffer_load_dwordx4 v227, s[8:11], s17 offen offset:2048 lds
  v_rcp_f32 v236, v236
  v_rcp_f32 v237, v237
  v_rcp_f32 v238, v238
  v_rcp_f32 v239, v239
  v_pk_mul_f32 v[236:237], v[236:237], v[208:209]
  v_pk_mul_f32 v[238:239], v[238:239], v[210:211]
  v_cvt_pk_bf16_f32 v174, v236, v237
  v_cvt_pk_bf16_f32 v175, v238, v239
  buffer_load_dwordx4 v228, s[8:11], s17 offen offset:3072 lds
  s_add_u32 s17, s17, 458752
  s_cmp_eq_u32 s17, s93
  s_cselect_b32 s17, s95, s17
  v_pk_mul_f32 v[232:233], v[16:17], s[42:43]
  v_pk_mul_f32 v[234:235], v[18:19], s[42:43]
  v_exp_f32 v232, v232
  v_exp_f32 v233, v233
  v_exp_f32 v234, v234
  v_exp_f32 v235, v235
  v_pk_add_f32 v[232:233], v[232:233], s[62:63]
  v_pk_add_f32 v[234:235], v[234:235], s[62:63]
  s_add_u32 m0, s38, 114688
  s_nop 0
  buffer_load_dwordx4 v225, s[8:11], s17 offen lds
  v_rcp_f32 v232, v232
  v_rcp_f32 v233, v233
  v_rcp_f32 v234, v234
  v_rcp_f32 v235, v235
  v_pk_mul_f32 v[232:233], v[232:233], v[44:45]
  v_pk_mul_f32 v[234:235], v[234:235], v[46:47]
  v_cvt_pk_bf16_f32 v8, v232, v233
  v_cvt_pk_bf16_f32 v9, v234, v235
  buffer_load_dwordx4 v226, s[8:11], s17 offen offset:1024 lds
  v_pk_mul_f32 v[236:237], v[20:21], s[42:43]
  v_pk_mul_f32 v[238:239], v[22:23], s[42:43]
  v_exp_f32 v236, v236
  v_exp_f32 v237, v237
  v_exp_f32 v238, v238
  v_exp_f32 v239, v239
  v_pk_add_f32 v[236:237], v[236:237], s[62:63]
  v_pk_add_f32 v[238:239], v[238:239], s[62:63]
  buffer_load_dwordx4 v227, s[8:11], s17 offen offset:2048 lds
  v_rcp_f32 v236, v236
  v_rcp_f32 v237, v237
  v_rcp_f32 v238, v238
  v_rcp_f32 v239, v239
  v_pk_mul_f32 v[236:237], v[236:237], v[48:49]
  v_pk_mul_f32 v[238:239], v[238:239], v[50:51]
  v_cvt_pk_bf16_f32 v10, v236, v237
  v_cvt_pk_bf16_f32 v11, v238, v239
  buffer_load_dwordx4 v228, s[8:11], s17 offen offset:3072 lds
  s_add_u32 s17, s17, 458752
  s_cmp_eq_u32 s17, s93
  s_cselect_b32 s17, s95, s17
  s_add_u32 s17, s17, 65536
  s_add_u32 s93, s93, 65536
  s_add_u32 s95, s95, 65536
  v_pk_mul_f32 v[232:233], v[72:73], s[42:43]
  v_pk_mul_f32 v[234:235], v[74:75], s[42:43]
  v_exp_f32 v232, v232
  v_exp_f32 v233, v233
  v_exp_f32 v234, v234
  v_exp_f32 v235, v235
  v_pk_add_f32 v[232:233], v[232:233], s[62:63]
  v_pk_add_f32 v[234:235], v[234:235], s[62:63]
  s_add_u32 m0, s38, 131072
  s_nop 0
  buffer_load_dwordx4 v225, s[8:11], s17 offen lds
  v_rcp_f32 v232, v232
  v_rcp_f32 v233, v233
  v_rcp_f32 v234, v234
  v_rcp_f32 v235, v235
  v_pk_mul_f32 v[232:233], v[232:233], v[100:101]
  v_pk_mul_f32 v[234:235], v[234:235], v[102:103]
  v_cvt_pk_bf16_f32 v64, v232, v233
  v_cvt_pk_bf16_f32 v65, v234, v235
  buffer_load_dwordx4 v226, s[8:11], s17 offen offset:1024 lds
  v_pk_mul_f32 v[236:237], v[76:77], s[42:43]
  v_pk_mul_f32 v[238:239], v[78:79], s[42:43]
  v_exp_f32 v236, v236
  v_exp_f32 v237, v237
  v_exp_f32 v238, v238
  v_exp_f32 v239, v239
  v_pk_add_f32 v[236:237], v[236:237], s[62:63]
  v_pk_add_f32 v[238:239], v[238:239], s[62:63]
  buffer_load_dwordx4 v227, s[8:11], s17 offen offset:2048 lds
  v_rcp_f32 v236, v236
  v_rcp_f32 v237, v237
  v_rcp_f32 v238, v238
  v_rcp_f32 v239, v239
  v_pk_mul_f32 v[236:237], v[236:237], v[104:105]
  v_pk_mul_f32 v[238:239], v[238:239], v[106:107]
  v_cvt_pk_bf16_f32 v66, v236, v237
  v_cvt_pk_bf16_f32 v67, v238, v239
  buffer_load_dwordx4 v228, s[8:11], s17 offen offset:3072 lds
  s_add_u32 s17, s17, 458752
  s_cmp_eq_u32 s17, s93
  s_cselect_b32 s17, s95, s17
  v_pk_mul_f32 v[232:233], v[128:129], s[42:43]
  v_pk_mul_f32 v[234:235], v[130:131], s[42:43]
  v_exp_f32 v232, v232
  v_exp_f32 v233, v233
  v_exp_f32 v234, v234
  v_exp_f32 v235, v235
  v_pk_add_f32 v[232:233], v[232:233], s[62:63]
  v_pk_add_f32 v[234:235], v[234:235], s[62:63]
  v_rcp_f32 v232, v232
  v_rcp_f32 v233, v233
  v_rcp_f32 v234, v234
  v_rcp_f32 v235, v235
  v_pk_mul_f32 v[232:233], v[232:233], v[156:157]
  v_pk_mul_f32 v[234:235], v[234:235], v[158:159]
  v_cvt_pk_bf16_f32 v120, v232, v233
  v_cvt_pk_bf16_f32 v121, v234, v235
  v_pk_mul_f32 v[236:237], v[132:133], s[42:43]
  v_pk_mul_f32 v[238:239], v[134:135], s[42:43]
  v_exp_f32 v236, v236
  v_exp_f32 v237, v237
  v_exp_f32 v238, v238
  v_exp_f32 v239, v239
  v_pk_add_f32 v[236:237], v[236:237], s[62:63]
  v_pk_add_f32 v[238:239], v[238:239], s[62:63]
  v_rcp_f32 v236, v236
  v_rcp_f32 v237, v237
  v_rcp_f32 v238, v238
  v_rcp_f32 v239, v239
  v_pk_mul_f32 v[236:237], v[236:237], v[160:161]
  v_pk_mul_f32 v[238:239], v[238:239], v[162:163]
  v_cvt_pk_bf16_f32 v122, v236, v237
  v_cvt_pk_bf16_f32 v123, v238, v239
  v_pk_mul_f32 v[232:233], v[184:185], s[42:43]
  v_pk_mul_f32 v[234:235], v[186:187], s[42:43]
  v_exp_f32 v232, v232
  v_exp_f32 v233, v233
  v_exp_f32 v234, v234
  v_exp_f32 v235, v235
  v_pk_add_f32 v[232:233], v[232:233], s[62:63]
  v_pk_add_f32 v[234:235], v[234:235], s[62:63]
  v_rcp_f32 v232, v232
  v_rcp_f32 v233, v233
  v_rcp_f32 v234, v234
  v_rcp_f32 v235, v235
  v_pk_mul_f32 v[232:233], v[232:233], v[212:213]
  v_pk_mul_f32 v[234:235], v[234:235], v[214:215]
  v_cvt_pk_bf16_f32 v176, v232, v233
  v_cvt_pk_bf16_f32 v177, v234, v235
  v_pk_mul_f32 v[236:237], v[188:189], s[42:43]
  v_pk_mul_f32 v[238:239], v[190:191], s[42:43]
  v_exp_f32 v236, v236
  v_exp_f32 v237, v237
  v_exp_f32 v238, v238
  v_exp_f32 v239, v239
  v_pk_add_f32 v[236:237], v[236:237], s[62:63]
  v_pk_add_f32 v[238:239], v[238:239], s[62:63]
  v_rcp_f32 v236, v236
  v_rcp_f32 v237, v237
  v_rcp_f32 v238, v238
  v_rcp_f32 v239, v239
  v_pk_mul_f32 v[236:237], v[236:237], v[216:217]
  v_pk_mul_f32 v[238:239], v[238:239], v[218:219]
  v_cvt_pk_bf16_f32 v178, v236, v237
  v_cvt_pk_bf16_f32 v179, v238, v239
  buffer_load_dword v247, v246, s[56:59], s94 offen sc1
  buffer_store_dwordx4 v[4:7], v224, s[12:15], s99 offen offset:0 sc1
  buffer_store_dwordx4 v[60:63], v224, s[12:15], s99 offen offset:1024 sc1
  buffer_store_dwordx4 v[116:119], v224, s[12:15], s99 offen offset:2048 sc1
  buffer_store_dwordx4 v[172:175], v224, s[12:15], s99 offen offset:3072 sc1
  v_pk_mul_f32 v[232:233], v[24:25], s[42:43]
  v_pk_mul_f32 v[234:235], v[26:27], s[42:43]
  v_exp_f32 v232, v232
  v_exp_f32 v233, v233
  v_exp_f32 v234, v234
  v_exp_f32 v235, v235
  v_pk_add_f32 v[232:233], v[232:233], s[62:63]
  v_pk_add_f32 v[234:235], v[234:235], s[62:63]
  v_rcp_f32 v232, v232
  v_rcp_f32 v233, v233
  v_rcp_f32 v234, v234
  v_rcp_f32 v235, v235
  v_pk_mul_f32 v[232:233], v[232:233], v[52:53]
  v_pk_mul_f32 v[234:235], v[234:235], v[54:55]
  v_cvt_pk_bf16_f32 v12, v232, v233
  v_cvt_pk_bf16_f32 v13, v234, v235
  v_pk_mul_f32 v[236:237], v[80:81], s[42:43]
  v_pk_mul_f32 v[238:239], v[82:83], s[42:43]
  v_exp_f32 v236, v236
  v_exp_f32 v237, v237
  v_exp_f32 v238, v238
  v_exp_f32 v239, v239
  v_pk_add_f32 v[236:237], v[236:237], s[62:63]
  v_pk_add_f32 v[238:239], v[238:239], s[62:63]
  v_rcp_f32 v236, v236
  v_rcp_f32 v237, v237
  v_rcp_f32 v238, v238
  v_rcp_f32 v239, v239
  v_pk_mul_f32 v[236:237], v[236:237], v[108:109]
  v_pk_mul_f32 v[238:239], v[238:239], v[110:111]
  v_cvt_pk_bf16_f32 v14, v236, v237
  v_cvt_pk_bf16_f32 v15, v238, v239
  v_pk_mul_f32 v[232:233], v[136:137], s[42:43]
  v_pk_mul_f32 v[234:235], v[138:139], s[42:43]
  v_exp_f32 v232, v232
  v_exp_f32 v233, v233
  v_exp_f32 v234, v234
  v_exp_f32 v235, v235
  v_pk_add_f32 v[232:233], v[232:233], s[62:63]
  v_pk_add_f32 v[234:235], v[234:235], s[62:63]
  v_rcp_f32 v232, v232
  v_rcp_f32 v233, v233
  v_rcp_f32 v234, v234
  v_rcp_f32 v235, v235
  v_pk_mul_f32 v[232:233], v[232:233], v[164:165]
  v_pk_mul_f32 v[234:235], v[234:235], v[166:167]
  v_cvt_pk_bf16_f32 v124, v232, v233
  v_cvt_pk_bf16_f32 v125, v234, v235
  v_pk_mul_f32 v[236:237], v[192:193], s[42:43]
  v_pk_mul_f32 v[238:239], v[194:195], s[42:43]
  v_exp_f32 v236, v236
  v_exp_f32 v237, v237
  v_exp_f32 v238, v238
  v_exp_f32 v239, v239
  v_pk_add_f32 v[236:237], v[236:237], s[62:63]
  v_pk_add_f32 v[238:239], v[238:239], s[62:63]
  v_rcp_f32 v236, v236
  v_rcp_f32 v237, v237
  v_rcp_f32 v238, v238
  v_rcp_f32 v239, v239
  v_pk_mul_f32 v[236:237], v[236:237], v[220:221]
  v_pk_mul_f32 v[238:239], v[238:239], v[222:223]
  v_cvt_pk_bf16_f32 v126, v236, v237
  v_cvt_pk_bf16_f32 v127, v238, v239
  s_waitcnt vmcnt(4)
  v_cmp_ne_u32 vcc, s19, v247
  s_nop 1
  s_cmp_lg_u64 vcc, 0
  s_cbranch_scc1 L_slow_25
  L_back_26:
  s_add_u32 s94, s94, 65536
  buffer_load_dwordx4 a[0:3], v240, s[4:7], s16 offen offset:0 sc1
  buffer_load_dwordx4 a[4:7], v240, s[4:7], s16 offen offset:1024 sc1
  buffer_load_dwordx4 a[8:11], v241, s[4:7], s16 offen offset:0 sc1
  buffer_load_dwordx4 a[12:15], v241, s[4:7], s16 offen offset:1024 sc1
  s_add_u32 s41, s41, 262144
  s_bitset0_b32 s41, 21
  s_add_u32 s16, s40, s41
  buffer_load_dwordx4 a[16:19], v240, s[4:7], s16 offen offset:0 sc1
  buffer_load_dwordx4 a[20:23], v240, s[4:7], s16 offen offset:1024 sc1
  buffer_load_dwordx4 a[24:27], v241, s[4:7], s16 offen offset:0 sc1
  buffer_load_dwordx4 a[28:31], v241, s[4:7], s16 offen offset:1024 sc1
  s_add_u32 s41, s41, 262144
  s_bitset0_b32 s41, 21
  s_add_u32 s16, s40, s41
  buffer_load_dwordx4 a[32:35], v240, s[4:7], s16 offen offset:0 sc1
  buffer_load_dwordx4 a[36:39], v240, s[4:7], s16 offen offset:1024 sc1
  buffer_load_dwordx4 a[40:43], v241, s[4:7], s16 offen offset:0 sc1
  buffer_load_dwordx4 a[44:47], v241, s[4:7], s16 offen offset:1024 sc1
  s_add_u32 s41, s41, 262144
  s_bitset0_b32 s41, 21
  s_add_u32 s16, s40, s41
  v_add_u32 v104, 65536, v242
  v_add_u32 v105, 65536, v243
  v_add_u32 v106, 65536, v244
  v_add_u32 v107, 65536, v245
  s_waitcnt vmcnt(54)
  s_barrier
  ds_read_b64_tr_b16 a[80:81], v242 offset:2048
  ds_read_b64_tr_b16 a[82:83], v242 offset:6144
  ds_read_b64_tr_b16 a[84:85], v243 offset:2048
  ds_read_b64_tr_b16 a[86:87], v243 offset:6144
  ds_read_b64_tr_b16 a[88:89], v244 offset:2048
  ds_read_b64_tr_b16 a[90:91], v244 offset:6144
  ds_read_b64_tr_b16 a[92:93], v245 offset:2048
  ds_read_b64_tr_b16 a[94:95], v245 offset:6144
  ds_read_b64_tr_b16 a[112:113], v242 offset:10240
  ds_read_b64_tr_b16 a[114:115], v242 offset:14336
  ds_read_b64_tr_b16 a[116:117], v243 offset:10240
  ds_read_b64_tr_b16 a[118:119], v243 offset:14336
  ds_read_b64_tr_b16 a[120:121], v244 offset:10240
  ds_read_b64_tr_b16 a[122:123], v244 offset:14336
  ds_read_b64_tr_b16 a[124:125], v245 offset:10240
  ds_read_b64_tr_b16 a[126:127], v245 offset:14336
  ds_read_b64_tr_b16 a[64:65], v242 offset:0
  ds_read_b64_tr_b16 a[66:67], v242 offset:4096
  ds_read_b64_tr_b16 a[68:69], v243 offset:0
  ds_read_b64_tr_b16 a[70:71], v243 offset:4096
  ds_read_b64_tr_b16 a[72:73], v244 offset:0
  ds_read_b64_tr_b16 a[74:75], v244 offset:4096
  ds_read_b64_tr_b16 a[76:77], v245 offset:0
  ds_read_b64_tr_b16 a[78:79], v245 offset:4096
  ds_read_b64_tr_b16 a[96:97], v242 offset:8192
  ds_read_b64_tr_b16 a[98:99], v242 offset:12288
  ds_read_b64_tr_b16 a[100:101], v243 offset:8192
  ds_read_b64_tr_b16 a[102:103], v243 offset:12288
  ds_read_b64_tr_b16 a[104:105], v244 offset:8192
  ds_read_b64_tr_b16 a[106:107], v244 offset:12288
  ds_read_b64_tr_b16 a[108:109], v245 offset:8192
  ds_read_b64_tr_b16 a[110:111], v245 offset:12288
  s_waitcnt vmcnt(8) lgkmcnt(10)
  s_barrier
  s_mov_b64 exec, 1
  buffer_store_dword v248, v250, s[56:59], s92 offen sc1
  s_mov_b64 exec, -1
  s_add_u32 s92, s92, 65536
  v_mfma_f32_16x16x32_bf16 v[72:75], a[80:83], a[0:3], 0
  buffer_load_dwordx4 a[48:51], v240, s[4:7], s16 offen offset:0 sc1
  v_mfma_f32_16x16x32_bf16 v[88:91], a[80:83], a[4:7], 0
  ds_read_b64_tr_b16 a[80:81], v242 offset:18432
  ds_read_b64_tr_b16 a[82:83], v242 offset:22528
  v_mfma_f32_16x16x32_bf16 v[76:79], a[84:87], a[0:3], 0
  v_mfma_f32_16x16x32_bf16 v[92:95], a[84:87], a[4:7], 0
  ds_read_b64_tr_b16 a[84:85], v243 offset:18432
  ds_read_b64_tr_b16 a[86:87], v243 offset:22528
  v_mfma_f32_16x16x32_bf16 v[80:83], a[88:91], a[0:3], 0
  v_mfma_f32_16x16x32_bf16 v[96:99], a[88:91], a[4:7], 0
  buffer_load_dwordx4 a[52:55], v240, s[4:7], s16 offen offset:1024 sc1
  v_mfma_f32_16x16x32_bf16 v[84:87], a[92:95], a[0:3], 0
  ds_read_b64_tr_b16 a[88:89], v244 offset:18432
  ds_read_b64_tr_b16 a[90:91], v244 offset:22528
  v_mfma_f32_16x16x32_bf16 v[100:103], a[92:95], a[4:7], 0
  ds_read_b64_tr_b16 a[92:93], v245 offset:18432
  ds_read_b64_tr_b16 a[94:95], v245 offset:22528
  v_mfma_f32_16x16x32_bf16 v[72:75], a[112:115], a[8:11], v[72:75]
  v_mfma_f32_16x16x32_bf16 v[88:91], a[112:115], a[12:15], v[88:91]
  ds_read_b64_tr_b16 a[112:113], v242 offset:26624
  ds_read_b64_tr_b16 a[114:115], v242 offset:30720
  v_mfma_f32_16x16x32_bf16 v[76:79], a[116:119], a[8:11], v[76:79]
  buffer_load_dwordx4 a[56:59], v241, s[4:7], s16 offen offset:0 sc1
  v_mfma_f32_16x16x32_bf16 v[92:95], a[116:119], a[12:15], v[92:95]
  ds_read_b64_tr_b16 a[116:117], v243 offset:26624
  ds_read_b64_tr_b16 a[118:119], v243 offset:30720
  v_mfma_f32_16x16x32_bf16 v[80:83], a[120:123], a[8:11], v[80:83]
  v_mfma_f32_16x16x32_bf16 v[96:99], a[120:123], a[12:15], v[96:99]
  ds_read_b64_tr_b16 a[120:121], v244 offset:26624
  ds_read_b64_tr_b16 a[122:123], v244 offset:30720
  v_mfma_f32_16x16x32_bf16 v[84:87], a[124:127], a[8:11], v[84:87]
  v_mfma_f32_16x16x32_bf16 v[100:103], a[124:127], a[12:15], v[100:103]
  buffer_load_dwordx4 a[60:63], v241, s[4:7], s16 offen offset:1024 sc1
  v_mfma_f32_16x16x32_bf16 v[16:19], a[64:67], a[0:3], 0
  ds_read_b64_tr_b16 a[124:125], v245 offset:26624
  s_add_u32 s41, s41, 262144
  v_mfma_f32_16x16x32_bf16 v[32:35], a[64:67], a[4:7], 0
  ds_read_b64_tr_b16 a[126:127], v245 offset:30720
  s_bitset0_b32 s41, 21
  v_mfma_f32_16x16x32_bf16 v[20:23], a[68:71], a[0:3], 0
  ds_read_b64_tr_b16 a[64:65], v242 offset:16384
  s_add_u32 s16, s40, s41
  v_mfma_f32_16x16x32_bf16 v[36:39], a[68:71], a[4:7], 0
  ds_read_b64_tr_b16 a[66:67], v242 offset:20480
  ds_read_b64_tr_b16 a[68:69], v243 offset:16384
  v_mfma_f32_16x16x32_bf16 v[24:27], a[72:75], a[0:3], 0
  buffer_store_dwordx4 v[8:11], v224, s[12:15], s100 offen offset:0 sc1
  v_mfma_f32_16x16x32_bf16 v[40:43], a[72:75], a[4:7], 0
  ds_read_b64_tr_b16 a[70:71], v243 offset:20480
  ds_read_b64_tr_b16 a[72:73], v244 offset:16384
  s_waitcnt lgkmcnt(10)
  v_mfma_f32_16x16x32_bf16 v[28:31], a[76:79], a[0:3], 0
  ds_read_b64_tr_b16 a[74:75], v244 offset:20480
  v_mfma_f32_16x16x32_bf16 v[44:47], a[76:79], a[4:7], 0
  ds_read_b64_tr_b16 a[76:77], v245 offset:16384
  ds_read_b64_tr_b16 a[78:79], v245 offset:20480
  v_mfma_f32_16x16x32_bf16 v[16:19], a[96:99], a[8:11], v[16:19]
  v_mfma_f32_16x16x32_bf16 v[32:35], a[96:99], a[12:15], v[32:35]
  buffer_store_dwordx4 v[64:67], v224, s[12:15], s100 offen offset:1024 sc1
  v_mfma_f32_16x16x32_bf16 v[20:23], a[100:103], a[8:11], v[20:23]
  ds_read_b64_tr_b16 a[96:97], v242 offset:24576
  ds_read_b64_tr_b16 a[98:99], v242 offset:28672
  v_mfma_f32_16x16x32_bf16 v[36:39], a[100:103], a[12:15], v[36:39]
  ds_read_b64_tr_b16 a[100:101], v243 offset:24576
  ds_read_b64_tr_b16 a[102:103], v243 offset:28672
  v_mfma_f32_16x16x32_bf16 v[24:27], a[104:107], a[8:11], v[24:27]
  v_mfma_f32_16x16x32_bf16 v[40:43], a[104:107], a[12:15], v[40:43]
  ds_read_b64_tr_b16 a[104:105], v244 offset:24576
  ds_read_b64_tr_b16 a[106:107], v244 offset:28672
  v_mfma_f32_16x16x32_bf16 v[28:31], a[108:111], a[8:11], v[28:31]
  v_mfma_f32_16x16x32_bf16 v[44:47], a[108:111], a[12:15], v[44:47]
  s_waitcnt vmcnt(11) lgkmcnt(10)
  s_barrier
  v_mfma_f32_16x16x32_bf16 v[72:75], a[80:83], a[16:19], v[72:75]
  buffer_load_dwordx4 a[0:3], v240, s[4:7], s16 offen offset:0 sc1
  v_mfma_f32_16x16x32_bf16 v[88:91], a[80:83], a[20:23], v[88:91]
  ds_read_b64_tr_b16 a[108:109], v245 offset:24576
  ds_read_b64_tr_b16 a[110:111], v245 offset:28672
  v_mfma_f32_16x16x32_bf16 v[76:79], a[84:87], a[16:19], v[76:79]
  ds_read_b64_tr_b16 a[80:81], v242 offset:34816
  ds_read_b64_tr_b16 a[82:83], v242 offset:38912
  v_mfma_f32_16x16x32_bf16 v[92:95], a[84:87], a[20:23], v[92:95]
  ds_read_b64_tr_b16 a[84:85], v243 offset:34816
  ds_read_b64_tr_b16 a[86:87], v243 offset:38912
  v_mfma_f32_16x16x32_bf16 v[80:83], a[88:91], a[16:19], v[80:83]
  v_mfma_f32_16x16x32_bf16 v[96:99], a[88:91], a[20:23], v[96:99]
  buffer_load_dwordx4 a[4:7], v240, s[4:7], s16 offen offset:1024 sc1
  v_mfma_f32_16x16x32_bf16 v[84:87], a[92:95], a[16:19], v[84:87]
  ds_read_b64_tr_b16 a[88:89], v244 offset:34816
  ds_read_b64_tr_b16 a[90:91], v244 offset:38912
  v_mfma_f32_16x16x32_bf16 v[100:103], a[92:95], a[20:23], v[100:103]
  ds_read_b64_tr_b16 a[92:93], v245 offset:34816
  ds_read_b64_tr_b16 a[94:95], v245 offset:38912
  v_mfma_f32_16x16x32_bf16 v[72:75], a[112:115], a[24:27], v[72:75]
  v_mfma_f32_16x16x32_bf16 v[88:91], a[112:115], a[28:31], v[88:91]
  ds_read_b64_tr_b16 a[112:113], v242 offset:43008
  ds_read_b64_tr_b16 a[114:115], v242 offset:47104
  v_mfma_f32_16x16x32_bf16 v[76:79], a[116:119], a[24:27], v[76:79]
  buffer_load_dwordx4 a[8:11], v241, s[4:7], s16 offen offset:0 sc1
  v_mfma_f32_16x16x32_bf16 v[92:95], a[116:119], a[28:31], v[92:95]
  ds_read_b64_tr_b16 a[116:117], v243 offset:43008
  ds_read_b64_tr_b16 a[118:119], v243 offset:47104
  v_mfma_f32_16x16x32_bf16 v[80:83], a[120:123], a[24:27], v[80:83]
  v_mfma_f32_16x16x32_bf16 v[96:99], a[120:123], a[28:31], v[96:99]
  ds_read_b64_tr_b16 a[120:121], v244 offset:43008
  ds_read_b64_tr_b16 a[122:123], v244 offset:47104
  v_mfma_f32_16x16x32_bf16 v[84:87], a[124:127], a[24:27], v[84:87]
  v_mfma_f32_16x16x32_bf16 v[100:103], a[124:127], a[28:31], v[100:103]
  buffer_load_dwordx4 a[12:15], v241, s[4:7], s16 offen offset:1024 sc1
  v_mfma_f32_16x16x32_bf16 v[16:19], a[64:67], a[16:19], v[16:19]
  ds_read_b64_tr_b16 a[124:125], v245 offset:43008
  s_add_u32 s41, s41, 262144
  v_mfma_f32_16x16x32_bf16 v[32:35], a[64:67], a[20:23], v[32:35]
  ds_read_b64_tr_b16 a[126:127], v245 offset:47104
  s_bitset0_b32 s41, 21
  v_mfma_f32_16x16x32_bf16 v[20:23], a[68:71], a[16:19], v[20:23]
  ds_read_b64_tr_b16 a[64:65], v242 offset:32768
  s_add_u32 s16, s40, s41
  v_mfma_f32_16x16x32_bf16 v[36:39], a[68:71], a[20:23], v[36:39]
  ds_read_b64_tr_b16 a[66:67], v242 offset:36864
  ds_read_b64_tr_b16 a[68:69], v243 offset:32768
  s_waitcnt lgkmcnt(10)
  v_mfma_f32_16x16x32_bf16 v[24:27], a[72:75], a[16:19], v[24:27]
  buffer_store_dwordx4 v[120:123], v224, s[12:15], s100 offen offset:2048 sc1
  v_mfma_f32_16x16x32_bf16 v[40:43], a[72:75], a[20:23], v[40:43]
  ds_read_b64_tr_b16 a[70:71], v243 offset:36864
  ds_read_b64_tr_b16 a[72:73], v244 offset:32768
  v_mfma_f32_16x16x32_bf16 v[28:31], a[76:79], a[16:19], v[28:31]
  ds_read_b64_tr_b16 a[74:75], v244 offset:36864
  v_mfma_f32_16x16x32_bf16 v[44:47], a[76:79], a[20:23], v[44:47]
  ds_read_b64_tr_b16 a[76:77], v245 offset:32768
  ds_read_b64_tr_b16 a[78:79], v245 offset:36864
  v_mfma_f32_16x16x32_bf16 v[16:19], a[96:99], a[24:27], v[16:19]
  v_mfma_f32_16x16x32_bf16 v[32:35], a[96:99], a[28:31], v[32:35]
  buffer_store_dwordx4 v[176:179], v224, s[12:15], s100 offen offset:3072 sc1
  v_mfma_f32_16x16x32_bf16 v[20:23], a[100:103], a[24:27], v[20:23]
  ds_read_b64_tr_b16 a[96:97], v242 offset:40960
  ds_read_b64_tr_b16 a[98:99], v242 offset:45056
  v_mfma_f32_16x16x32_bf16 v[36:39], a[100:103], a[28:31], v[36:39]
  ds_read_b64_tr_b16 a[100:101], v243 offset:40960
  ds_read_b64_tr_b16 a[102:103], v243 offset:45056
  v_mfma_f32_16x16x32_bf16 v[24:27], a[104:107], a[24:27], v[24:27]
  v_mfma_f32_16x16x32_bf16 v[40:43], a[104:107], a[28:31], v[40:43]
  ds_read_b64_tr_b16 a[104:105], v244 offset:40960
  ds_read_b64_tr_b16 a[106:107], v244 offset:45056
  v_mfma_f32_16x16x32_bf16 v[28:31], a[108:111], a[24:27], v[28:31]
  v_mfma_f32_16x16x32_bf16 v[44:47], a[108:111], a[28:31], v[44:47]
  s_waitcnt vmcnt(13) lgkmcnt(10)
  s_barrier
  v_mfma_f32_16x16x32_bf16 v[72:75], a[80:83], a[32:35], v[72:75]
  buffer_load_dwordx4 a[16:19], v240, s[4:7], s16 offen offset:0 sc1
  v_mfma_f32_16x16x32_bf16 v[88:91], a[80:83], a[36:39], v[88:91]
  ds_read_b64_tr_b16 a[108:109], v245 offset:40960
  ds_read_b64_tr_b16 a[110:111], v245 offset:45056
  v_mfma_f32_16x16x32_bf16 v[76:79], a[84:87], a[32:35], v[76:79]
  ds_read_b64_tr_b16 a[80:81], v242 offset:51200
  ds_read_b64_tr_b16 a[82:83], v242 offset:55296
  v_mfma_f32_16x16x32_bf16 v[92:95], a[84:87], a[36:39], v[92:95]
  ds_read_b64_tr_b16 a[84:85], v243 offset:51200
  ds_read_b64_tr_b16 a[86:87], v243 offset:55296
  v_mfma_f32_16x16x32_bf16 v[80:83], a[88:91], a[32:35], v[80:83]
  v_mfma_f32_16x16x32_bf16 v[96:99], a[88:91], a[36:39], v[96:99]
  buffer_load_dwordx4 a[20:23], v240, s[4:7], s16 offen offset:1024 sc1
  v_mfma_f32_16x16x32_bf16 v[84:87], a[92:95], a[32:35], v[84:87]
  ds_read_b64_tr_b16 a[88:89], v244 offset:51200
  ds_read_b64_tr_b16 a[90:91], v244 offset:55296
  v_mfma_f32_16x16x32_bf16 v[100:103], a[92:95], a[36:39], v[100:103]
  ds_read_b64_tr_b16 a[92:93], v245 offset:51200
  ds_read_b64_tr_b16 a[94:95], v245 offset:55296
  v_mfma_f32_16x16x32_bf16 v[72:75], a[112:115], a[40:43], v[72:75]
  v_mfma_f32_16x16x32_bf16 v[88:91], a[112:115], a[44:47], v[88:91]
  ds_read_b64_tr_b16 a[112:113], v242 offset:59392
  ds_read_b64_tr_b16 a[114:115], v242 offset:63488
  v_mfma_f32_16x16x32_bf16 v[76:79], a[116:119], a[40:43], v[76:79]
  buffer_load_dwordx4 a[24:27], v241, s[4:7], s16 offen offset:0 sc1
  v_mfma_f32_16x16x32_bf16 v[92:95], a[116:119], a[44:47], v[92:95]
  ds_read_b64_tr_b16 a[116:117], v243 offset:59392
  ds_read_b64_tr_b16 a[118:119], v243 offset:63488
  v_mfma_f32_16x16x32_bf16 v[80:83], a[120:123], a[40:43], v[80:83]
  v_mfma_f32_16x16x32_bf16 v[96:99], a[120:123], a[44:47], v[96:99]
  ds_read_b64_tr_b16 a[120:121], v244 offset:59392
  ds_read_b64_tr_b16 a[122:123], v244 offset:63488
  v_mfma_f32_16x16x32_bf16 v[84:87], a[124:127], a[40:43], v[84:87]
  v_mfma_f32_16x16x32_bf16 v[100:103], a[124:127], a[44:47], v[100:103]
  buffer_load_dwordx4 a[28:31], v241, s[4:7], s16 offen offset:1024 sc1
  v_mfma_f32_16x16x32_bf16 v[16:19], a[64:67], a[32:35], v[16:19]
  ds_read_b64_tr_b16 a[124:125], v245 offset:59392
  s_add_u32 s41, s41, 262144
  v_mfma_f32_16x16x32_bf16 v[32:35], a[64:67], a[36:39], v[32:35]
  ds_read_b64_tr_b16 a[126:127], v245 offset:63488
  s_bitset0_b32 s41, 21
  v_mfma_f32_16x16x32_bf16 v[20:23], a[68:71], a[32:35], v[20:23]
  ds_read_b64_tr_b16 a[64:65], v242 offset:49152
  s_add_u32 s16, s40, s41
  v_mfma_f32_16x16x32_bf16 v[36:39], a[68:71], a[36:39], v[36:39]
  ds_read_b64_tr_b16 a[66:67], v242 offset:53248
  ds_read_b64_tr_b16 a[68:69], v243 offset:49152
  s_waitcnt lgkmcnt(10)
  v_mfma_f32_16x16x32_bf16 v[24:27], a[72:75], a[32:35], v[24:27]
  buffer_store_dwordx4 v[12:15], v224, s[12:15], s101 offen offset:0 sc1
  v_mfma_f32_16x16x32_bf16 v[40:43], a[72:75], a[36:39], v[40:43]
  ds_read_b64_tr_b16 a[70:71], v243 offset:53248
  ds_read_b64_tr_b16 a[72:73], v244 offset:49152
  v_mfma_f32_16x16x32_bf16 v[28:31], a[76:79], a[32:35], v[28:31]
  ds_read_b64_tr_b16 a[74:75], v244 offset:53248
  v_mfma_f32_16x16x32_bf16 v[44:47], a[76:79], a[36:39], v[44:47]
  ds_read_b64_tr_b16 a[76:77], v245 offset:49152
  ds_read_b64_tr_b16 a[78:79], v245 offset:53248
  v_mfma_f32_16x16x32_bf16 v[16:19], a[96:99], a[40:43], v[16:19]
  v_mfma_f32_16x16x32_bf16 v[32:35], a[96:99], a[44:47], v[32:35]
  buffer_store_dwordx4 v[124:127], v224, s[12:15], s101 offen offset:2048 sc1
  v_mfma_f32_16x16x32_bf16 v[20:23], a[100:103], a[40:43], v[20:23]
  ds_read_b64_tr_b16 a[96:97], v242 offset:57344
  ds_read_b64_tr_b16 a[98:99], v242 offset:61440
  v_mfma_f32_16x16x32_bf16 v[36:39], a[100:103], a[44:47], v[36:39]
  ds_read_b64_tr_b16 a[100:101], v243 offset:57344
  ds_read_b64_tr_b16 a[102:103], v243 offset:61440
  v_mfma_f32_16x16x32_bf16 v[24:27], a[104:107], a[40:43], v[24:27]
  v_mfma_f32_16x16x32_bf16 v[40:43], a[104:107], a[44:47], v[40:43]
  ds_read_b64_tr_b16 a[104:105], v244 offset:57344
  ds_read_b64_tr_b16 a[106:107], v244 offset:61440
  v_mfma_f32_16x16x32_bf16 v[28:31], a[108:111], a[40:43], v[28:31]
  v_mfma_f32_16x16x32_bf16 v[44:47], a[108:111], a[44:47], v[44:47]
  s_waitcnt vmcnt(14) lgkmcnt(10)
  s_barrier
  v_mfma_f32_16x16x32_bf16 v[72:75], a[80:83], a[48:51], v[72:75]
  ds_read_b64_tr_b16 a[108:109], v245 offset:57344
  s_add_u32 m0, s38, 0
  v_mfma_f32_16x16x32_bf16 v[88:91], a[80:83], a[52:55], v[88:91]
  buffer_load_dwordx4 v225, s[8:11], s17 offen lds
  v_mfma_f32_16x16x32_bf16 v[76:79], a[84:87], a[48:51], v[76:79]
  ds_read_b64_tr_b16 a[110:111], v245 offset:61440
  ds_read_b64_tr_b16 a[80:81], v104 offset:2048
  v_mfma_f32_16x16x32_bf16 v[92:95], a[84:87], a[52:55], v[92:95]
  ds_read_b64_tr_b16 a[82:83], v104 offset:6144
  ds_read_b64_tr_b16 a[84:85], v105 offset:2048
  v_mfma_f32_16x16x32_bf16 v[80:83], a[88:91], a[48:51], v[80:83]
  buffer_load_dwordx4 a[32:35], v240, s[4:7], s16 offen offset:0 sc1
  v_mfma_f32_16x16x32_bf16 v[96:99], a[88:91], a[52:55], v[96:99]
  ds_read_b64_tr_b16 a[86:87], v105 offset:6144
  ds_read_b64_tr_b16 a[88:89], v106 offset:2048
  v_mfma_f32_16x16x32_bf16 v[84:87], a[92:95], a[48:51], v[84:87]
  ds_read_b64_tr_b16 a[90:91], v106 offset:6144
  v_mfma_f32_16x16x32_bf16 v[100:103], a[92:95], a[52:55], v[100:103]
  ds_read_b64_tr_b16 a[92:93], v107 offset:2048
  ds_read_b64_tr_b16 a[94:95], v107 offset:6144
  v_mfma_f32_16x16x32_bf16 v[72:75], a[112:115], a[56:59], v[72:75]
  buffer_load_dwordx4 v226, s[8:11], s17 offen offset:1024 lds
  v_mfma_f32_16x16x32_bf16 v[88:91], a[112:115], a[60:63], v[88:91]
  ds_read_b64_tr_b16 a[112:113], v104 offset:10240
  ds_read_b64_tr_b16 a[114:115], v104 offset:14336
  v_mfma_f32_16x16x32_bf16 v[76:79], a[116:119], a[56:59], v[76:79]
  v_mfma_f32_16x16x32_bf16 v[92:95], a[116:119], a[60:63], v[92:95]
  ds_read_b64_tr_b16 a[116:117], v105 offset:10240
  ds_read_b64_tr_b16 a[118:119], v105 offset:14336
  v_mfma_f32_16x16x32_bf16 v[80:83], a[120:123], a[56:59], v[80:83]
  buffer_load_dwordx4 a[36:39], v240, s[4:7], s16 offen offset:1024 sc1
  v_mfma_f32_16x16x32_bf16 v[96:99], a[120:123], a[60:63], v[96:99]
  ds_read_b64_tr_b16 a[120:121], v106 offset:10240
  ds_read_b64_tr_b16 a[122:123], v106 offset:14336
  v_mfma_f32_16x16x32_bf16 v[84:87], a[124:127], a[56:59], v[84:87]
  v_mfma_f32_16x16x32_bf16 v[100:103], a[124:127], a[60:63], v[100:103]
  buffer_load_dword v247, v246, s[56:59], s94 offen sc1
  v_mfma_f32_16x16x32_bf16 v[16:19], a[64:67], a[48:51], v[16:19]
  buffer_load_dwordx4 v227, s[8:11], s17 offen offset:2048 lds
  v_mfma_f32_16x16x32_bf16 v[32:35], a[64:67], a[52:55], v[32:35]
  ds_read_b64_tr_b16 a[124:125], v107 offset:10240
  ds_read_b64_tr_b16 a[126:127], v107 offset:14336
  v_mfma_f32_16x16x32_bf16 v[20:23], a[68:71], a[48:51], v[20:23]
  ds_read_b64_tr_b16 a[64:65], v104 offset:0
  ds_read_b64_tr_b16 a[66:67], v104 offset:4096
  v_mfma_f32_16x16x32_bf16 v[36:39], a[68:71], a[52:55], v[36:39]
  ds_read_b64_tr_b16 a[68:69], v105 offset:0
  ds_read_b64_tr_b16 a[70:71], v105 offset:4096
  s_waitcnt lgkmcnt(10)
  v_mfma_f32_16x16x32_bf16 v[24:27], a[72:75], a[48:51], v[24:27]
  buffer_load_dwordx4 a[40:43], v241, s[4:7], s16 offen offset:0 sc1
  v_mfma_f32_16x16x32_bf16 v[40:43], a[72:75], a[52:55], v[40:43]
  ds_read_b64_tr_b16 a[72:73], v106 offset:0
  ds_read_b64_tr_b16 a[74:75], v106 offset:4096
  v_mfma_f32_16x16x32_bf16 v[28:31], a[76:79], a[48:51], v[28:31]
  v_mfma_f32_16x16x32_bf16 v[44:47], a[76:79], a[52:55], v[44:47]
  buffer_load_dwordx4 v228, s[8:11], s17 offen offset:3072 lds
  v_mfma_f32_16x16x32_bf16 v[16:19], a[96:99], a[56:59], v[16:19]
  ds_read_b64_tr_b16 a[76:77], v107 offset:0
  s_add_u32 s17, s17, 458752
  v_mfma_f32_16x16x32_bf16 v[32:35], a[96:99], a[60:63], v[32:35]
  ds_read_b64_tr_b16 a[78:79], v107 offset:4096
  s_cmp_eq_u32 s17, s93
  v_mfma_f32_16x16x32_bf16 v[20:23], a[100:103], a[56:59], v[20:23]
  ds_read_b64_tr_b16 a[96:97], v104 offset:8192
  s_cselect_b32 s17, s95, s17
  v_mfma_f32_16x16x32_bf16 v[36:39], a[100:103], a[60:63], v[36:39]
  buffer_load_dwordx4 a[44:47], v241, s[4:7], s16 offen offset:1024 sc1
  v_mfma_f32_16x16x32_bf16 v[24:27], a[104:107], a[56:59], v[24:27]
  ds_read_b64_tr_b16 a[98:99], v104 offset:12288
  s_add_u32 s41, s41, 262144
  v_mfma_f32_16x16x32_bf16 v[40:43], a[104:107], a[60:63], v[40:43]
  ds_read_b64_tr_b16 a[100:101], v105 offset:8192
  s_bitset0_b32 s41, 21
  v_mfma_f32_16x16x32_bf16 v[28:31], a[108:111], a[56:59], v[28:31]
  ds_read_b64_tr_b16 a[102:103], v105 offset:12288
  s_add_u32 s16, s40, s41
  v_mfma_f32_16x16x32_bf16 v[44:47], a[108:111], a[60:63], v[44:47]
  s_waitcnt vmcnt(17) lgkmcnt(10)
  s_barrier
  v_mfma_f32_16x16x32_bf16 v[72:75], a[80:83], a[0:3], v[72:75]
  ds_read_b64_tr_b16 a[104:105], v106 offset:8192
  ds_read_b64_tr_b16 a[106:107], v106 offset:12288
  s_add_u32 m0, s38, 16384
  v_mfma_f32_16x16x32_bf16 v[88:91], a[80:83], a[4:7], v[88:91]
  buffer_load_dwordx4 v225, s[8:11], s17 offen lds
  v_mfma_f32_16x16x32_bf16 v[76:79], a[84:87], a[0:3], v[76:79]
  ds_read_b64_tr_b16 a[108:109], v107 offset:8192
  ds_read_b64_tr_b16 a[110:111], v107 offset:12288
  v_add_u32 v124, 131072, v242
  v_mfma_f32_16x16x32_bf16 v[92:95], a[84:87], a[4:7], v[92:95]
  ds_read_b64_tr_b16 a[80:81], v104 offset:18432
  ds_read_b64_tr_b16 a[82:83], v104 offset:22528
  v_mfma_f32_16x16x32_bf16 v[80:83], a[88:91], a[0:3], v[80:83]
  buffer_load_dwordx4 a[48:51], v240, s[4:7], s16 offen offset:0 sc1
  v_mfma_f32_16x16x32_bf16 v[96:99], a[88:91], a[4:7], v[96:99]
  ds_read_b64_tr_b16 a[84:85], v105 offset:18432
  ds_read_b64_tr_b16 a[86:87], v105 offset:22528
  v_mfma_f32_16x16x32_bf16 v[84:87], a[92:95], a[0:3], v[84:87]
  ds_read_b64_tr_b16 a[88:89], v106 offset:18432
  v_add_u32 v125, 131072, v243
  v_mfma_f32_16x16x32_bf16 v[100:103], a[92:95], a[4:7], v[100:103]
  ds_read_b64_tr_b16 a[90:91], v106 offset:22528
  ds_read_b64_tr_b16 a[92:93], v107 offset:18432
  v_mfma_f32_16x16x32_bf16 v[72:75], a[112:115], a[8:11], v[72:75]
  buffer_load_dwordx4 v226, s[8:11], s17 offen offset:1024 lds
  v_mfma_f32_16x16x32_bf16 v[88:91], a[112:115], a[12:15], v[88:91]
  ds_read_b64_tr_b16 a[94:95], v107 offset:22528
  ds_read_b64_tr_b16 a[112:113], v104 offset:26624
  v_mfma_f32_16x16x32_bf16 v[76:79], a[116:119], a[8:11], v[76:79]
  ds_read_b64_tr_b16 a[114:115], v104 offset:30720
  v_add_u32 v126, 131072, v244
  v_mfma_f32_16x16x32_bf16 v[92:95], a[116:119], a[12:15], v[92:95]
  ds_read_b64_tr_b16 a[116:117], v105 offset:26624
  ds_read_b64_tr_b16 a[118:119], v105 offset:30720
  v_mfma_f32_16x16x32_bf16 v[80:83], a[120:123], a[8:11], v[80:83]
  buffer_load_dwordx4 a[52:55], v240, s[4:7], s16 offen offset:1024 sc1
  v_mfma_f32_16x16x32_bf16 v[96:99], a[120:123], a[12:15], v[96:99]
  ds_read_b64_tr_b16 a[120:121], v106 offset:26624
  ds_read_b64_tr_b16 a[122:123], v106 offset:30720
  v_mfma_f32_16x16x32_bf16 v[84:87], a[124:127], a[8:11], v[84:87]
  v_add_u32 v127, 131072, v245
  v_mfma_f32_16x16x32_bf16 v[100:103], a[124:127], a[12:15], v[100:103]
  ds_read_b64_tr_b16 a[124:125], v107 offset:26624
  ds_read_b64_tr_b16 a[126:127], v107 offset:30720
  v_mfma_f32_16x16x32_bf16 v[16:19], a[64:67], a[0:3], v[16:19]
  buffer_load_dwordx4 v227, s[8:11], s17 offen offset:2048 lds
  v_mfma_f32_16x16x32_bf16 v[32:35], a[64:67], a[4:7], v[32:35]
  ds_read_b64_tr_b16 a[64:65], v104 offset:16384
  ds_read_b64_tr_b16 a[66:67], v104 offset:20480
  s_waitcnt lgkmcnt(10)
  v_mfma_f32_16x16x32_bf16 v[20:23], a[68:71], a[0:3], v[20:23]
  v_mfma_f32_16x16x32_bf16 v[36:39], a[68:71], a[4:7], v[36:39]
  ds_read_b64_tr_b16 a[68:69], v105 offset:16384
  ds_read_b64_tr_b16 a[70:71], v105 offset:20480
  v_mfma_f32_16x16x32_bf16 v[24:27], a[72:75], a[0:3], v[24:27]
  buffer_load_dwordx4 a[56:59], v241, s[4:7], s16 offen offset:0 sc1
  v_mfma_f32_16x16x32_bf16 v[40:43], a[72:75], a[4:7], v[40:43]
  ds_read_b64_tr_b16 a[72:73], v106 offset:16384
  ds_read_b64_tr_b16 a[74:75], v106 offset:20480
  v_mfma_f32_16x16x32_bf16 v[28:31], a[76:79], a[0:3], v[28:31]
  buffer_load_dwordx4 v228, s[8:11], s17 offen offset:3072 lds
  v_mfma_f32_16x16x32_bf16 v[44:47], a[76:79], a[4:7], v[44:47]
  ds_read_b64_tr_b16 a[76:77], v107 offset:16384
  s_add_u32 s17, s17, 458752
  v_mfma_f32_16x16x32_bf16 v[16:19], a[96:99], a[8:11], v[16:19]
  ds_read_b64_tr_b16 a[78:79], v107 offset:20480
  s_cmp_eq_u32 s17, s93
  v_mfma_f32_16x16x32_bf16 v[32:35], a[96:99], a[12:15], v[32:35]
  ds_read_b64_tr_b16 a[96:97], v104 offset:24576
  s_cselect_b32 s17, s95, s17
  v_mfma_f32_16x16x32_bf16 v[20:23], a[100:103], a[8:11], v[20:23]
  buffer_load_dwordx4 a[60:63], v241, s[4:7], s16 offen offset:1024 sc1
  v_mfma_f32_16x16x32_bf16 v[36:39], a[100:103], a[12:15], v[36:39]
  ds_read_b64_tr_b16 a[98:99], v104 offset:28672
  s_add_u32 s41, s41, 262144
  v_mfma_f32_16x16x32_bf16 v[24:27], a[104:107], a[8:11], v[24:27]
  ds_read_b64_tr_b16 a[100:101], v105 offset:24576
  s_bitset0_b32 s41, 21
  v_mfma_f32_16x16x32_bf16 v[40:43], a[104:107], a[12:15], v[40:43]
  ds_read_b64_tr_b16 a[102:103], v105 offset:28672
  s_add_u32 s40, s40, 2097152
  v_mfma_f32_16x16x32_bf16 v[28:31], a[108:111], a[8:11], v[28:31]
  ds_read_b64_tr_b16 a[104:105], v106 offset:24576
  s_add_u32 s16, s40, s41
  v_mfma_f32_16x16x32_bf16 v[44:47], a[108:111], a[12:15], v[44:47]
  s_waitcnt vmcnt(12) lgkmcnt(10)
  s_barrier
  v_cmp_ne_u32 vcc, s19, v247
  s_nop 1
  s_cmp_lg_u64 vcc, 0
  s_cbranch_scc1 L_slow_27
  L_back_28:
  s_add_u32 s94, s94, 65536
  v_mfma_f32_16x16x32_bf16 v[72:75], a[80:83], a[16:19], v[72:75]
  ds_read_b64_tr_b16 a[106:107], v106 offset:28672
  buffer_load_dwordx4 a[0:3], v240, s[4:7], s16 offen offset:0 sc1
  v_mfma_f32_16x16x32_bf16 v[88:91], a[80:83], a[20:23], v[88:91]
  ds_read_b64_tr_b16 a[108:109], v107 offset:24576
  ds_read_b64_tr_b16 a[110:111], v107 offset:28672
  v_mfma_f32_16x16x32_bf16 v[76:79], a[84:87], a[16:19], v[76:79]
  ds_read_b64_tr_b16 a[80:81], v104 offset:34816
  ds_read_b64_tr_b16 a[82:83], v104 offset:38912
  v_mfma_f32_16x16x32_bf16 v[92:95], a[84:87], a[20:23], v[92:95]
  ds_read_b64_tr_b16 a[84:85], v105 offset:34816
  ds_read_b64_tr_b16 a[86:87], v105 offset:38912
  v_mfma_f32_16x16x32_bf16 v[80:83], a[88:91], a[16:19], v[80:83]
  v_mfma_f32_16x16x32_bf16 v[96:99], a[88:91], a[20:23], v[96:99]
  ds_read_b64_tr_b16 a[88:89], v106 offset:34816
  ds_read_b64_tr_b16 a[90:91], v106 offset:38912
  v_mfma_f32_16x16x32_bf16 v[84:87], a[92:95], a[16:19], v[84:87]
  v_mfma_f32_16x16x32_bf16 v[100:103], a[92:95], a[20:23], v[100:103]
  buffer_load_dwordx4 a[4:7], v240, s[4:7], s16 offen offset:1024 sc1
  v_mfma_f32_16x16x32_bf16 v[72:75], a[112:115], a[24:27], v[72:75]
  ds_read_b64_tr_b16 a[92:93], v107 offset:34816
  ds_read_b64_tr_b16 a[94:95], v107 offset:38912
  v_mfma_f32_16x16x32_bf16 v[88:91], a[112:115], a[28:31], v[88:91]
  ds_read_b64_tr_b16 a[112:113], v104 offset:43008
  ds_read_b64_tr_b16 a[114:115], v104 offset:47104
  v_mfma_f32_16x16x32_bf16 v[76:79], a[116:119], a[24:27], v[76:79]
  v_mfma_f32_16x16x32_bf16 v[92:95], a[116:119], a[28:31], v[92:95]
  ds_read_b64_tr_b16 a[116:117], v105 offset:43008
  ds_read_b64_tr_b16 a[118:119], v105 offset:47104
  v_mfma_f32_16x16x32_bf16 v[80:83], a[120:123], a[24:27], v[80:83]
  v_mfma_f32_16x16x32_bf16 v[96:99], a[120:123], a[28:31], v[96:99]
  ds_read_b64_tr_b16 a[120:121], v106 offset:43008
  ds_read_b64_tr_b16 a[122:123], v106 offset:47104
  v_mfma_f32_16x16x32_bf16 v[84:87], a[124:127], a[24:27], v[84:87]
  v_mfma_f32_16x16x32_bf16 v[100:103], a[124:127], a[28:31], v[100:103]
  buffer_load_dwordx4 a[8:11], v241, s[4:7], s16 offen offset:0 sc1
  v_mfma_f32_16x16x32_bf16 v[16:19], a[64:67], a[16:19], v[16:19]
  ds_read_b64_tr_b16 a[124:125], v107 offset:43008
  ds_read_b64_tr_b16 a[126:127], v107 offset:47104
  v_mfma_f32_16x16x32_bf16 v[32:35], a[64:67], a[20:23], v[32:35]
  ds_read_b64_tr_b16 a[64:65], v104 offset:32768
  ds_read_b64_tr_b16 a[66:67], v104 offset:36864
  s_waitcnt lgkmcnt(10)
  v_mfma_f32_16x16x32_bf16 v[20:23], a[68:71], a[16:19], v[20:23]
  v_mfma_f32_16x16x32_bf16 v[36:39], a[68:71], a[20:23], v[36:39]
  ds_read_b64_tr_b16 a[68:69], v105 offset:32768
  ds_read_b64_tr_b16 a[70:71], v105 offset:36864
  v_mfma_f32_16x16x32_bf16 v[24:27], a[72:75], a[16:19], v[24:27]
  v_mfma_f32_16x16x32_bf16 v[40:43], a[72:75], a[20:23], v[40:43]
  ds_read_b64_tr_b16 a[72:73], v106 offset:32768
  ds_read_b64_tr_b16 a[74:75], v106 offset:36864
  v_mfma_f32_16x16x32_bf16 v[28:31], a[76:79], a[16:19], v[28:31]
  v_mfma_f32_16x16x32_bf16 v[44:47], a[76:79], a[20:23], v[44:47]
  buffer_load_dwordx4 a[12:15], v241, s[4:7], s16 offen offset:1024 sc1
  v_mfma_f32_16x16x32_bf16 v[16:19], a[96:99], a[24:27], v[16:19]
  ds_read_b64_tr_b16 a[76:77], v107 offset:32768
  s_add_u32 s41, s41, 262144
  v_mfma_f32_16x16x32_bf16 v[32:35], a[96:99], a[28:31], v[32:35]
  ds_read_b64_tr_b16 a[78:79], v107 offset:36864
  s_bitset0_b32 s41, 21
  v_mfma_f32_16x16x32_bf16 v[20:23], a[100:103], a[24:27], v[20:23]
  ds_read_b64_tr_b16 a[96:97], v104 offset:40960
  s_add_u32 s16, s40, s41
  v_mfma_f32_16x16x32_bf16 v[36:39], a[100:103], a[28:31], v[36:39]
  ds_read_b64_tr_b16 a[98:99], v104 offset:45056
  ds_read_b64_tr_b16 a[100:101], v105 offset:40960
  v_mfma_f32_16x16x32_bf16 v[24:27], a[104:107], a[24:27], v[24:27]
  ds_read_b64_tr_b16 a[102:103], v105 offset:45056
  v_mfma_f32_16x16x32_bf16 v[40:43], a[104:107], a[28:31], v[40:43]
  ds_read_b64_tr_b16 a[104:105], v106 offset:40960
  ds_read_b64_tr_b16 a[106:107], v106 offset:45056
  v_mfma_f32_16x16x32_bf16 v[28:31], a[108:111], a[24:27], v[28:31]
  v_mfma_f32_16x16x32_bf16 v[44:47], a[108:111], a[28:31], v[44:47]
  s_waitcnt vmcnt(12) lgkmcnt(10)
  s_barrier
  s_mov_b64 exec, 1
  buffer_store_dword v248, v250, s[56:59], s92 offen sc1
  s_mov_b64 exec, -1
  s_add_u32 s92, s92, 65536
  v_mfma_f32_16x16x32_bf16 v[72:75], a[80:83], a[32:35], v[72:75]
  ds_read_b64_tr_b16 a[108:109], v107 offset:40960
  s_add_u32 m0, s38, 32768
  v_mfma_f32_16x16x32_bf16 v[88:91], a[80:83], a[36:39], v[88:91]
  buffer_load_dwordx4 v225, s[8:11], s17 offen lds
  v_mfma_f32_16x16x32_bf16 v[76:79], a[84:87], a[32:35], v[76:79]
  ds_read_b64_tr_b16 a[110:111], v107 offset:45056
  ds_read_b64_tr_b16 a[80:81], v104 offset:51200
  v_mfma_f32_16x16x32_bf16 v[92:95], a[84:87], a[36:39], v[92:95]
  ds_read_b64_tr_b16 a[82:83], v104 offset:55296
  ds_read_b64_tr_b16 a[84:85], v105 offset:51200
  v_mfma_f32_16x16x32_bf16 v[80:83], a[88:91], a[32:35], v[80:83]
  buffer_load_dwordx4 a[16:19], v240, s[4:7], s16 offen offset:0 sc1
  v_mfma_f32_16x16x32_bf16 v[96:99], a[88:91], a[36:39], v[96:99]
  ds_read_b64_tr_b16 a[86:87], v105 offset:55296
  ds_read_b64_tr_b16 a[88:89], v106 offset:51200
  v_mfma_f32_16x16x32_bf16 v[84:87], a[92:95], a[32:35], v[84:87]
  ds_read_b64_tr_b16 a[90:91], v106 offset:55296
  v_mfma_f32_16x16x32_bf16 v[100:103], a[92:95], a[36:39], v[100:103]
  ds_read_b64_tr_b16 a[92:93], v107 offset:51200
  ds_read_b64_tr_b16 a[94:95], v107 offset:55296
  v_mfma_f32_16x16x32_bf16 v[72:75], a[112:115], a[40:43], v[72:75]
  buffer_load_dwordx4 v226, s[8:11], s17 offen offset:1024 lds
  v_mfma_f32_16x16x32_bf16 v[88:91], a[112:115], a[44:47], v[88:91]
  ds_read_b64_tr_b16 a[112:113], v104 offset:59392
  ds_read_b64_tr_b16 a[114:115], v104 offset:63488
  v_mfma_f32_16x16x32_bf16 v[76:79], a[116:119], a[40:43], v[76:79]
  v_mfma_f32_16x16x32_bf16 v[92:95], a[116:119], a[44:47], v[92:95]
  ds_read_b64_tr_b16 a[116:117], v105 offset:59392
  ds_read_b64_tr_b16 a[118:119], v105 offset:63488
  v_mfma_f32_16x16x32_bf16 v[80:83], a[120:123], a[40:43], v[80:83]
  buffer_load_dwordx4 a[20:23], v240, s[4:7], s16 offen offset:1024 sc1
  v_mfma_f32_16x16x32_bf16 v[96:99], a[120:123], a[44:47], v[96:99]
  ds_read_b64_tr_b16 a[120:121], v106 offset:59392
  ds_read_b64_tr_b16 a[122:123], v106 offset:63488
  v_mfma_f32_16x16x32_bf16 v[84:87], a[124:127], a[40:43], v[84:87]
  v_mfma_f32_16x16x32_bf16 v[100:103], a[124:127], a[44:47], v[100:103]
  ds_read_b64_tr_b16 a[124:125], v107 offset:59392
  ds_read_b64_tr_b16 a[126:127], v107 offset:63488
  v_mfma_f32_16x16x32_bf16 v[16:19], a[64:67], a[32:35], v[16:19]
  buffer_load_dwordx4 v227, s[8:11], s17 offen offset:2048 lds
  v_mfma_f32_16x16x32_bf16 v[32:35], a[64:67], a[36:39], v[32:35]
  ds_read_b64_tr_b16 a[64:65], v104 offset:49152
  ds_read_b64_tr_b16 a[66:67], v104 offset:53248
  v_mfma_f32_16x16x32_bf16 v[20:23], a[68:71], a[32:35], v[20:23]
  v_mfma_f32_16x16x32_bf16 v[36:39], a[68:71], a[36:39], v[36:39]
  ds_read_b64_tr_b16 a[68:69], v105 offset:49152
  ds_read_b64_tr_b16 a[70:71], v105 offset:53248
  s_waitcnt lgkmcnt(10)
  v_mfma_f32_16x16x32_bf16 v[24:27], a[72:75], a[32:35], v[24:27]
  buffer_load_dwordx4 a[24:27], v241, s[4:7], s16 offen offset:0 sc1
  v_mfma_f32_16x16x32_bf16 v[40:43], a[72:75], a[36:39], v[40:43]
  ds_read_b64_tr_b16 a[72:73], v106 offset:49152
  ds_read_b64_tr_b16 a[74:75], v106 offset:53248
  v_mfma_f32_16x16x32_bf16 v[28:31], a[76:79], a[32:35], v[28:31]
  v_mfma_f32_16x16x32_bf16 v[44:47], a[76:79], a[36:39], v[44:47]
  buffer_load_dwordx4 v228, s[8:11], s17 offen offset:3072 lds
  v_mfma_f32_16x16x32_bf16 v[16:19], a[96:99], a[40:43], v[16:19]
  ds_read_b64_tr_b16 a[76:77], v107 offset:49152
  s_add_u32 s17, s17, 458752
  v_mfma_f32_16x16x32_bf16 v[32:35], a[96:99], a[44:47], v[32:35]
  ds_read_b64_tr_b16 a[78:79], v107 offset:53248
  s_cmp_eq_u32 s17, s93
  v_mfma_f32_16x16x32_bf16 v[20:23], a[100:103], a[40:43], v[20:23]
  ds_read_b64_tr_b16 a[96:97], v104 offset:57344
  s_cselect_b32 s17, s95, s17
  v_mfma_f32_16x16x32_bf16 v[36:39], a[100:103], a[44:47], v[36:39]
  buffer_load_dwordx4 a[28:31], v241, s[4:7], s16 offen offset:1024 sc1
  v_mfma_f32_16x16x32_bf16 v[24:27], a[104:107], a[40:43], v[24:27]
  ds_read_b64_tr_b16 a[98:99], v104 offset:61440
  s_add_u32 s41, s41, 262144
  v_mfma_f32_16x16x32_bf16 v[40:43], a[104:107], a[44:47], v[40:43]
  ds_read_b64_tr_b16 a[100:101], v105 offset:57344
  s_bitset0_b32 s41, 21
  v_mfma_f32_16x16x32_bf16 v[28:31], a[108:111], a[40:43], v[28:31]
  ds_read_b64_tr_b16 a[102:103], v105 offset:61440
  s_add_u32 s16, s40, s41
  v_mfma_f32_16x16x32_bf16 v[44:47], a[108:111], a[44:47], v[44:47]
  s_waitcnt vmcnt(13) lgkmcnt(10)
  s_barrier
  v_mfma_f32_16x16x32_bf16 v[72:75], a[80:83], a[48:51], v[72:75]
  ds_read_b64_tr_b16 a[104:105], v106 offset:57344
  ds_read_b64_tr_b16 a[106:107], v106 offset:61440
  s_add_u32 m0, s38, 49152
  v_mfma_f32_16x16x32_bf16 v[88:91], a[80:83], a[52:55], v[88:91]
  buffer_load_dwordx4 v225, s[8:11], s17 offen lds
  v_mfma_f32_16x16x32_bf16 v[76:79], a[84:87], a[48:51], v[76:79]
  ds_read_b64_tr_b16 a[108:109], v107 offset:57344
  ds_read_b64_tr_b16 a[110:111], v107 offset:61440
  v_mfma_f32_16x16x32_bf16 v[92:95], a[84:87], a[52:55], v[92:95]
  ds_read_b64_tr_b16 a[80:81], v124 offset:2048
  ds_read_b64_tr_b16 a[82:83], v124 offset:6144
  v_mfma_f32_16x16x32_bf16 v[80:83], a[88:91], a[48:51], v[80:83]
  buffer_load_dwordx4 a[32:35], v240, s[4:7], s16 offen offset:0 sc1
  v_mfma_f32_16x16x32_bf16 v[96:99], a[88:91], a[52:55], v[96:99]
  ds_read_b64_tr_b16 a[84:85], v125 offset:2048
  ds_read_b64_tr_b16 a[86:87], v125 offset:6144
  v_mfma_f32_16x16x32_bf16 v[84:87], a[92:95], a[48:51], v[84:87]
  ds_read_b64_tr_b16 a[88:89], v126 offset:2048
  ds_read_b64_tr_b16 a[90:91], v126 offset:6144
  v_mfma_f32_16x16x32_bf16 v[100:103], a[92:95], a[52:55], v[100:103]
  ds_read_b64_tr_b16 a[92:93], v127 offset:2048
  ds_read_b64_tr_b16 a[94:95], v127 offset:6144
  v_mfma_f32_16x16x32_bf16 v[72:75], a[112:115], a[56:59], v[72:75]
  buffer_load_dwordx4 v226, s[8:11], s17 offen offset:1024 lds
  v_mfma_f32_16x16x32_bf16 v[88:91], a[112:115], a[60:63], v[88:91]
  ds_read_b64_tr_b16 a[112:113], v124 offset:10240
  ds_read_b64_tr_b16 a[114:115], v124 offset:14336
  v_mfma_f32_16x16x32_bf16 v[76:79], a[116:119], a[56:59], v[76:79]
  v_mfma_f32_16x16x32_bf16 v[92:95], a[116:119], a[60:63], v[92:95]
  ds_read_b64_tr_b16 a[116:117], v125 offset:10240
  ds_read_b64_tr_b16 a[118:119], v125 offset:14336
  v_mfma_f32_16x16x32_bf16 v[80:83], a[120:123], a[56:59], v[80:83]
  buffer_load_dwordx4 a[36:39], v240, s[4:7], s16 offen offset:1024 sc1
  v_mfma_f32_16x16x32_bf16 v[96:99], a[120:123], a[60:63], v[96:99]
  ds_read_b64_tr_b16 a[120:121], v126 offset:10240
  ds_read_b64_tr_b16 a[122:123], v126 offset:14336
  v_mfma_f32_16x16x32_bf16 v[84:87], a[124:127], a[56:59], v[84:87]
  v_mfma_f32_16x16x32_bf16 v[100:103], a[124:127], a[60:63], v[100:103]
  ds_read_b64_tr_b16 a[124:125], v127 offset:10240
  ds_read_b64_tr_b16 a[126:127], v127 offset:14336
  v_mfma_f32_16x16x32_bf16 v[16:19], a[64:67], a[48:51], v[16:19]
  buffer_load_dwordx4 v227, s[8:11], s17 offen offset:2048 lds
  v_mfma_f32_16x16x32_bf16 v[32:35], a[64:67], a[52:55], v[32:35]
  ds_read_b64_tr_b16 a[64:65], v124 offset:0
  ds_read_b64_tr_b16 a[66:67], v124 offset:4096
  s_waitcnt lgkmcnt(10)
  v_mfma_f32_16x16x32_bf16 v[20:23], a[68:71], a[48:51], v[20:23]
  v_mfma_f32_16x16x32_bf16 v[36:39], a[68:71], a[52:55], v[36:39]
  ds_read_b64_tr_b16 a[68:69], v125 offset:0
  ds_read_b64_tr_b16 a[70:71], v125 offset:4096
  v_mfma_f32_16x16x32_bf16 v[24:27], a[72:75], a[48:51], v[24:27]
  buffer_load_dwordx4 a[40:43], v241, s[4:7], s16 offen offset:0 sc1
  v_mfma_f32_16x16x32_bf16 v[40:43], a[72:75], a[52:55], v[40:43]
  ds_read_b64_tr_b16 a[72:73], v126 offset:0
  ds_read_b64_tr_b16 a[74:75], v126 offset:4096
  v_mfma_f32_16x16x32_bf16 v[28:31], a[76:79], a[48:51], v[28:31]
  v_mfma_f32_16x16x32_bf16 v[44:47], a[76:79], a[52:55], v[44:47]
  buffer_load_dwordx4 v228, s[8:11], s17 offen offset:3072 lds
  v_mfma_f32_16x16x32_bf16 v[16:19], a[96:99], a[56:59], v[16:19]
  ds_read_b64_tr_b16 a[76:77], v127 offset:0
  s_add_u32 s17, s17, 458752
  v_mfma_f32_16x16x32_bf16 v[32:35], a[96:99], a[60:63], v[32:35]
  ds_read_b64_tr_b16 a[78:79], v127 offset:4096
  s_cmp_eq_u32 s17, s93
  v_mfma_f32_16x16x32_bf16 v[20:23], a[100:103], a[56:59], v[20:23]
  ds_read_b64_tr_b16 a[96:97], v124 offset:8192
  s_cselect_b32 s17, s95, s17
  v_mfma_f32_16x16x32_bf16 v[36:39], a[100:103], a[60:63], v[36:39]
  buffer_load_dwordx4 a[44:47], v241, s[4:7], s16 offen offset:1024 sc1
  v_mfma_f32_16x16x32_bf16 v[24:27], a[104:107], a[56:59], v[24:27]
  ds_read_b64_tr_b16 a[98:99], v124 offset:12288
  s_add_u32 s41, s41, 262144
  v_mfma_f32_16x16x32_bf16 v[40:43], a[104:107], a[60:63], v[40:43]
  ds_read_b64_tr_b16 a[100:101], v125 offset:8192
  s_bitset0_b32 s41, 21
  v_mfma_f32_16x16x32_bf16 v[28:31], a[108:111], a[56:59], v[28:31]
  ds_read_b64_tr_b16 a[102:103], v125 offset:12288
  s_add_u32 s16, s40, s41
  v_mfma_f32_16x16x32_bf16 v[44:47], a[108:111], a[60:63], v[44:47]
  s_waitcnt vmcnt(17) lgkmcnt(10)
  s_barrier
  v_mfma_f32_16x16x32_bf16 v[72:75], a[80:83], a[0:3], v[72:75]
  ds_read_b64_tr_b16 a[104:105], v126 offset:8192
  ds_read_b64_tr_b16 a[106:107], v126 offset:12288
  s_add_u32 m0, s38, 65536
  v_mfma_f32_16x16x32_bf16 v[88:91], a[80:83], a[4:7], v[88:91]
  buffer_load_dwordx4 v225, s[8:11], s17 offen lds
  v_mfma_f32_16x16x32_bf16 v[76:79], a[84:87], a[0:3], v[76:79]
  ds_read_b64_tr_b16 a[108:109], v127 offset:8192
  ds_read_b64_tr_b16 a[110:111], v127 offset:12288
  v_mfma_f32_16x16x32_bf16 v[92:95], a[84:87], a[4:7], v[92:95]
  ds_read_b64_tr_b16 a[80:81], v242 offset:2048
  ds_read_b64_tr_b16 a[82:83], v242 offset:6144
  v_mfma_f32_16x16x32_bf16 v[80:83], a[88:91], a[0:3], v[80:83]
  buffer_load_dwordx4 a[48:51], v240, s[4:7], s16 offen offset:0 sc1
  v_mfma_f32_16x16x32_bf16 v[96:99], a[88:91], a[4:7], v[96:99]
  ds_read_b64_tr_b16 a[84:85], v243 offset:2048
  ds_read_b64_tr_b16 a[86:87], v243 offset:6144
  v_mfma_f32_16x16x32_bf16 v[84:87], a[92:95], a[0:3], v[84:87]
  ds_read_b64_tr_b16 a[88:89], v244 offset:2048
  ds_read_b64_tr_b16 a[90:91], v244 offset:6144
  v_mfma_f32_16x16x32_bf16 v[100:103], a[92:95], a[4:7], v[100:103]
  ds_read_b64_tr_b16 a[92:93], v245 offset:2048
  ds_read_b64_tr_b16 a[94:95], v245 offset:6144
  v_mfma_f32_16x16x32_bf16 v[72:75], a[112:115], a[8:11], v[72:75]
  buffer_load_dwordx4 v226, s[8:11], s17 offen offset:1024 lds
  v_mfma_f32_16x16x32_bf16 v[88:91], a[112:115], a[12:15], v[88:91]
  ds_read_b64_tr_b16 a[112:113], v242 offset:10240
  ds_read_b64_tr_b16 a[114:115], v242 offset:14336
  v_mfma_f32_16x16x32_bf16 v[76:79], a[116:119], a[8:11], v[76:79]
  v_mfma_f32_16x16x32_bf16 v[92:95], a[116:119], a[12:15], v[92:95]
  ds_read_b64_tr_b16 a[116:117], v243 offset:10240
  ds_read_b64_tr_b16 a[118:119], v243 offset:14336
  v_mfma_f32_16x16x32_bf16 v[80:83], a[120:123], a[8:11], v[80:83]
  buffer_load_dwordx4 a[52:55], v240, s[4:7], s16 offen offset:1024 sc1
  v_mfma_f32_16x16x32_bf16 v[96:99], a[120:123], a[12:15], v[96:99]
  ds_read_b64_tr_b16 a[120:121], v244 offset:10240
  ds_read_b64_tr_b16 a[122:123], v244 offset:14336
  v_mfma_f32_16x16x32_bf16 v[84:87], a[124:127], a[8:11], v[84:87]
  v_mfma_f32_16x16x32_bf16 v[100:103], a[124:127], a[12:15], v[100:103]
  ds_read_b64_tr_b16 a[124:125], v245 offset:10240
  ds_read_b64_tr_b16 a[126:127], v245 offset:14336
  v_mfma_f32_16x16x32_bf16 v[16:19], a[64:67], a[0:3], v[16:19]
  buffer_load_dwordx4 v227, s[8:11], s17 offen offset:2048 lds
  v_mfma_f32_16x16x32_bf16 v[32:35], a[64:67], a[4:7], v[32:35]
  ds_read_b64_tr_b16 a[64:65], v242 offset:0
  ds_read_b64_tr_b16 a[66:67], v242 offset:4096
  s_waitcnt lgkmcnt(10)
  v_mfma_f32_16x16x32_bf16 v[20:23], a[68:71], a[0:3], v[20:23]
  v_mfma_f32_16x16x32_bf16 v[36:39], a[68:71], a[4:7], v[36:39]
  ds_read_b64_tr_b16 a[68:69], v243 offset:0
  ds_read_b64_tr_b16 a[70:71], v243 offset:4096
  v_mfma_f32_16x16x32_bf16 v[24:27], a[72:75], a[0:3], v[24:27]
  buffer_load_dwordx4 a[56:59], v241, s[4:7], s16 offen offset:0 sc1
  v_mfma_f32_16x16x32_bf16 v[40:43], a[72:75], a[4:7], v[40:43]
  ds_read_b64_tr_b16 a[72:73], v244 offset:0
  ds_read_b64_tr_b16 a[74:75], v244 offset:4096
  v_mfma_f32_16x16x32_bf16 v[28:31], a[76:79], a[0:3], v[28:31]
  v_mfma_f32_16x16x32_bf16 v[44:47], a[76:79], a[4:7], v[44:47]
  buffer_load_dwordx4 v228, s[8:11], s17 offen offset:3072 lds
  v_mfma_f32_16x16x32_bf16 v[16:19], a[96:99], a[8:11], v[16:19]
  ds_read_b64_tr_b16 a[76:77], v245 offset:0
  s_add_u32 s17, s17, 458752
  v_mfma_f32_16x16x32_bf16 v[32:35], a[96:99], a[12:15], v[32:35]
  ds_read_b64_tr_b16 a[78:79], v245 offset:4096
  s_cmp_eq_u32 s17, s93
  v_mfma_f32_16x16x32_bf16 v[20:23], a[100:103], a[8:11], v[20:23]
  ds_read_b64_tr_b16 a[96:97], v242 offset:8192
  s_cselect_b32 s17, s95, s17
  v_mfma_f32_16x16x32_bf16 v[36:39], a[100:103], a[12:15], v[36:39]
  buffer_load_dwordx4 a[60:63], v241, s[4:7], s16 offen offset:1024 sc1
  v_mfma_f32_16x16x32_bf16 v[24:27], a[104:107], a[8:11], v[24:27]
  ds_read_b64_tr_b16 a[98:99], v242 offset:12288
  s_add_u32 s41, s41, 262144
  v_mfma_f32_16x16x32_bf16 v[40:43], a[104:107], a[12:15], v[40:43]
  ds_read_b64_tr_b16 a[100:101], v243 offset:8192
  s_bitset0_b32 s41, 21
  v_mfma_f32_16x16x32_bf16 v[28:31], a[108:111], a[8:11], v[28:31]
  ds_read_b64_tr_b16 a[102:103], v243 offset:12288
  s_add_u32 s16, s40, s41
  v_mfma_f32_16x16x32_bf16 v[44:47], a[108:111], a[12:15], v[44:47]
  s_waitcnt vmcnt(16) lgkmcnt(10)
  s_barrier
  v_mfma_f32_16x16x32_bf16 v[72:75], a[80:83], a[16:19], v[72:75]
  ds_read_b64_tr_b16 a[104:105], v244 offset:8192
  ds_read_b64_tr_b16 a[106:107], v244 offset:12288
  s_add_u32 m0, s38, 81920
  v_mfma_f32_16x16x32_bf16 v[88:91], a[80:83], a[20:23], v[88:91]
  buffer_load_dwordx4 v225, s[8:11], s17 offen lds
  v_mfma_f32_16x16x32_bf16 v[76:79], a[84:87], a[16:19], v[76:79]
  ds_read_b64_tr_b16 a[108:109], v245 offset:8192
  ds_read_b64_tr_b16 a[110:111], v245 offset:12288
  v_mfma_f32_16x16x32_bf16 v[92:95], a[84:87], a[20:23], v[92:95]
  ds_read_b64_tr_b16 a[80:81], v242 offset:18432
  ds_read_b64_tr_b16 a[82:83], v242 offset:22528
  v_mfma_f32_16x16x32_bf16 v[80:83], a[88:91], a[16:19], v[80:83]
  buffer_load_dwordx4 a[0:3], v240, s[4:7], s16 offen offset:0 sc1
  v_mfma_f32_16x16x32_bf16 v[96:99], a[88:91], a[20:23], v[96:99]
  ds_read_b64_tr_b16 a[84:85], v243 offset:18432
  ds_read_b64_tr_b16 a[86:87], v243 offset:22528
  v_mfma_f32_16x16x32_bf16 v[84:87], a[92:95], a[16:19], v[84:87]
  ds_read_b64_tr_b16 a[88:89], v244 offset:18432
  ds_read_b64_tr_b16 a[90:91], v244 offset:22528
  v_mfma_f32_16x16x32_bf16 v[100:103], a[92:95], a[20:23], v[100:103]
  ds_read_b64_tr_b16 a[92:93], v245 offset:18432
  ds_read_b64_tr_b16 a[94:95], v245 offset:22528
  v_mfma_f32_16x16x32_bf16 v[72:75], a[112:115], a[24:27], v[72:75]
  buffer_load_dwordx4 v226, s[8:11], s17 offen offset:1024 lds
  v_mfma_f32_16x16x32_bf16 v[88:91], a[112:115], a[28:31], v[88:91]
  ds_read_b64_tr_b16 a[112:113], v242 offset:26624
  ds_read_b64_tr_b16 a[114:115], v242 offset:30720
  v_mfma_f32_16x16x32_bf16 v[76:79], a[116:119], a[24:27], v[76:79]
  v_mfma_f32_16x16x32_bf16 v[92:95], a[116:119], a[28:31], v[92:95]
  ds_read_b64_tr_b16 a[116:117], v243 offset:26624
  ds_read_b64_tr_b16 a[118:119], v243 offset:30720
  v_mfma_f32_16x16x32_bf16 v[80:83], a[120:123], a[24:27], v[80:83]
  buffer_load_dwordx4 a[4:7], v240, s[4:7], s16 offen offset:1024 sc1
  v_mfma_f32_16x16x32_bf16 v[96:99], a[120:123], a[28:31], v[96:99]
  ds_read_b64_tr_b16 a[120:121], v244 offset:26624
  ds_read_b64_tr_b16 a[122:123], v244 offset:30720
  v_mfma_f32_16x16x32_bf16 v[84:87], a[124:127], a[24:27], v[84:87]
  v_mfma_f32_16x16x32_bf16 v[100:103], a[124:127], a[28:31], v[100:103]
  ds_read_b64_tr_b16 a[124:125], v245 offset:26624
  ds_read_b64_tr_b16 a[126:127], v245 offset:30720
  v_mfma_f32_16x16x32_bf16 v[16:19], a[64:67], a[16:19], v[16:19]
  buffer_load_dwordx4 v227, s[8:11], s17 offen offset:2048 lds
  v_mfma_f32_16x16x32_bf16 v[32:35], a[64:67], a[20:23], v[32:35]
  ds_read_b64_tr_b16 a[64:65], v242 offset:16384
  ds_read_b64_tr_b16 a[66:67], v242 offset:20480
  s_waitcnt lgkmcnt(10)
  v_mfma_f32_16x16x32_bf16 v[20:23], a[68:71], a[16:19], v[20:23]
  v_mfma_f32_16x16x32_bf16 v[36:39], a[68:71], a[20:23], v[36:39]
  ds_read_b64_tr_b16 a[68:69], v243 offset:16384
  ds_read_b64_tr_b16 a[70:71], v243 offset:20480
  v_mfma_f32_16x16x32_bf16 v[24:27], a[72:75], a[16:19], v[24:27]
  buffer_load_dwordx4 a[8:11], v241, s[4:7], s16 offen offset:0 sc1
  v_mfma_f32_16x16x32_bf16 v[40:43], a[72:75], a[20:23], v[40:43]
  ds_read_b64_tr_b16 a[72:73], v244 offset:16384
  ds_read_b64_tr_b16 a[74:75], v244 offset:20480
  v_mfma_f32_16x16x32_bf16 v[28:31], a[76:79], a[16:19], v[28:31]
  v_mfma_f32_16x16x32_bf16 v[44:47], a[76:79], a[20:23], v[44:47]
  buffer_load_dwordx4 v228, s[8:11], s17 offen offset:3072 lds
  v_mfma_f32_16x16x32_bf16 v[16:19], a[96:99], a[24:27], v[16:19]
  ds_read_b64_tr_b16 a[76:77], v245 offset:16384
  s_add_u32 s17, s17, 458752
  v_mfma_f32_16x16x32_bf16 v[32:35], a[96:99], a[28:31], v[32:35]
  ds_read_b64_tr_b16 a[78:79], v245 offset:20480
  s_cmp_eq_u32 s17, s93
  v_mfma_f32_16x16x32_bf16 v[20:23], a[100:103], a[24:27], v[20:23]
  ds_read_b64_tr_b16 a[96:97], v242 offset:24576
  s_cselect_b32 s17, s95, s17
  v_mfma_f32_16x16x32_bf16 v[36:39], a[100:103], a[28:31], v[36:39]
  buffer_load_dwordx4 a[12:15], v241, s[4:7], s16 offen offset:1024 sc1
  v_mfma_f32_16x16x32_bf16 v[24:27], a[104:107], a[24:27], v[24:27]
  ds_read_b64_tr_b16 a[98:99], v242 offset:28672
  s_add_u32 s41, s41, 262144
  v_mfma_f32_16x16x32_bf16 v[40:43], a[104:107], a[28:31], v[40:43]
  ds_read_b64_tr_b16 a[100:101], v243 offset:24576
  s_bitset0_b32 s41, 21
  v_mfma_f32_16x16x32_bf16 v[28:31], a[108:111], a[24:27], v[28:31]
  ds_read_b64_tr_b16 a[102:103], v243 offset:28672
  s_add_u32 s16, s40, s41
  v_mfma_f32_16x16x32_bf16 v[44:47], a[108:111], a[28:31], v[44:47]
  s_waitcnt vmcnt(16) lgkmcnt(10)
  s_barrier
  v_mfma_f32_16x16x32_bf16 v[72:75], a[80:83], a[32:35], v[72:75]
  ds_read_b64_tr_b16 a[104:105], v244 offset:24576
  ds_read_b64_tr_b16 a[106:107], v244 offset:28672
  s_add_u32 m0, s38, 98304
  v_mfma_f32_16x16x32_bf16 v[88:91], a[80:83], a[36:39], v[88:91]
  v_accvgpr_read_b32 v0, a128
  buffer_load_dwordx4 v225, s[8:11], s17 offen lds
  v_mfma_f32_16x16x32_bf16 v[76:79], a[84:87], a[32:35], v[76:79]
  ds_read_b64_tr_b16 a[108:109], v245 offset:24576
  ds_read_b64_tr_b16 a[110:111], v245 offset:28672
  v_mfma_f32_16x16x32_bf16 v[92:95], a[84:87], a[36:39], v[92:95]
  ds_read_b64_tr_b16 a[80:81], v242 offset:34816
  v_accvgpr_read_b32 v1, a129
  v_mfma_f32_16x16x32_bf16 v[80:83], a[88:91], a[32:35], v[80:83]
  ds_read_b64_tr_b16 a[82:83], v242 offset:38912
  buffer_load_dwordx4 a[16:19], v240, s[4:7], s16 offen offset:0 sc1
  v_mfma_f32_16x16x32_bf16 v[96:99], a[88:91], a[36:39], v[96:99]
  ds_read_b64_tr_b16 a[84:85], v243 offset:34816
  v_accvgpr_read_b32 v2, a130
  v_mfma_f32_16x16x32_bf16 v[84:87], a[92:95], a[32:35], v[84:87]
  ds_read_b64_tr_b16 a[86:87], v243 offset:38912
  ds_read_b64_tr_b16 a[88:89], v244 offset:34816
  v_mfma_f32_16x16x32_bf16 v[100:103], a[92:95], a[36:39], v[100:103]
  ds_read_b64_tr_b16 a[90:91], v244 offset:38912
  ds_read_b64_tr_b16 a[92:93], v245 offset:34816
  v_mfma_f32_16x16x32_bf16 v[72:75], a[112:115], a[40:43], v[72:75]
  v_accvgpr_read_b32 v3, a131
  buffer_load_dwordx4 v226, s[8:11], s17 offen offset:1024 lds
  v_mfma_f32_16x16x32_bf16 v[88:91], a[112:115], a[44:47], v[88:91]
  ds_read_b64_tr_b16 a[94:95], v245 offset:38912
  ds_read_b64_tr_b16 a[112:113], v242 offset:43008
  v_mfma_f32_16x16x32_bf16 v[76:79], a[116:119], a[40:43], v[76:79]
  ds_read_b64_tr_b16 a[114:115], v242 offset:47104
  v_lshlrev_b32 v192, 16, v0
  v_mfma_f32_16x16x32_bf16 v[92:95], a[116:119], a[44:47], v[92:95]
  ds_read_b64_tr_b16 a[116:117], v243 offset:43008
  ds_read_b64_tr_b16 a[118:119], v243 offset:47104
  v_mfma_f32_16x16x32_bf16 v[80:83], a[120:123], a[40:43], v[80:83]
  v_and_b32 v193, 0xffff0000, v0
  buffer_load_dwordx4 a[20:23], v240, s[4:7], s16 offen offset:1024 sc1
  v_mfma_f32_16x16x32_bf16 v[96:99], a[120:123], a[44:47], v[96:99]
  ds_read_b64_tr_b16 a[120:121], v244 offset:43008
  ds_read_b64_tr_b16 a[122:123], v244 offset:47104
  v_mfma_f32_16x16x32_bf16 v[84:87], a[124:127], a[40:43], v[84:87]
  v_mfma_f32_16x16x32_bf16 v[100:103], a[124:127], a[44:47], v[100:103]
  ds_read_b64_tr_b16 a[124:125], v245 offset:43008
  v_lshlrev_b32 v194, 16, v1
  v_mfma_f32_16x16x32_bf16 v[16:19], a[64:67], a[32:35], v[16:19]
  buffer_load_dwordx4 v227, s[8:11], s17 offen offset:2048 lds
  v_mfma_f32_16x16x32_bf16 v[32:35], a[64:67], a[36:39], v[32:35]
  ds_read_b64_tr_b16 a[126:127], v245 offset:47104
  v_and_b32 v195, 0xffff0000, v1
  s_waitcnt lgkmcnt(10)
  v_mfma_f32_16x16x32_bf16 v[20:23], a[68:71], a[32:35], v[20:23]
  ds_read_b64_tr_b16 a[64:65], v242 offset:32768
  ds_read_b64_tr_b16 a[66:67], v242 offset:36864
  v_mfma_f32_16x16x32_bf16 v[36:39], a[68:71], a[36:39], v[36:39]
  v_lshlrev_b32 v196, 16, v2
  buffer_load_dwordx4 a[24:27], v241, s[4:7], s16 offen offset:0 sc1
  v_mfma_f32_16x16x32_bf16 v[24:27], a[72:75], a[32:35], v[24:27]
  buffer_load_dwordx4 v228, s[8:11], s17 offen offset:3072 lds
  v_mfma_f32_16x16x32_bf16 v[40:43], a[72:75], a[36:39], v[40:43]
  ds_read_b64_tr_b16 a[68:69], v243 offset:32768
  s_add_u32 s17, s17, 458752
  v_mfma_f32_16x16x32_bf16 v[28:31], a[76:79], a[32:35], v[28:31]
  ds_read_b64_tr_b16 a[70:71], v243 offset:36864
  v_and_b32 v197, 0xffff0000, v2
  s_cmp_eq_u32 s17, s93
  v_mfma_f32_16x16x32_bf16 v[44:47], a[76:79], a[36:39], v[44:47]
  ds_read_b64_tr_b16 a[72:73], v244 offset:32768
  s_cselect_b32 s17, s95, s17
  v_mfma_f32_16x16x32_bf16 v[16:19], a[96:99], a[40:43], v[16:19]
  ds_read_b64_tr_b16 a[74:75], v244 offset:36864
  v_lshlrev_b32 v198, 16, v3
  s_add_u32 s17, s17, 65536
  v_mfma_f32_16x16x32_bf16 v[32:35], a[96:99], a[44:47], v[32:35]
  ds_read_b64_tr_b16 a[76:77], v245 offset:32768
  s_add_u32 s93, s93, 65536
  v_mfma_f32_16x16x32_bf16 v[20:23], a[100:103], a[40:43], v[20:23]
  ds_read_b64_tr_b16 a[78:79], v245 offset:36864
  v_and_b32 v199, 0xffff0000, v3
  s_add_u32 s95, s95, 65536
  v_mfma_f32_16x16x32_bf16 v[36:39], a[100:103], a[44:47], v[36:39]
  buffer_load_dwordx4 a[28:31], v241, s[4:7], s16 offen offset:1024 sc1
  v_mfma_f32_16x16x32_bf16 v[24:27], a[104:107], a[40:43], v[24:27]
  ds_read_b64_tr_b16 a[96:97], v242 offset:40960
  ds_read_b64_tr_b16 a[98:99], v242 offset:45056
  s_add_u32 s41, s41, 262144
  v_mfma_f32_16x16x32_bf16 v[40:43], a[104:107], a[44:47], v[40:43]
  ds_read_b64_tr_b16 a[100:101], v243 offset:40960
  s_bitset0_b32 s41, 21
  v_mfma_f32_16x16x32_bf16 v[28:31], a[108:111], a[40:43], v[28:31]
  ds_read_b64_tr_b16 a[102:103], v243 offset:45056
  ds_read_b128 v[56:59], v253 offset:768
  s_add_u32 s16, s40, s41
  v_mfma_f32_16x16x32_bf16 v[44:47], a[108:111], a[44:47], v[44:47]
  s_waitcnt vmcnt(16) lgkmcnt(10)
  s_barrier
  v_mfma_f32_16x16x32_bf16 v[72:75], a[80:83], a[48:51], v[72:75]
  ds_read_b64_tr_b16 a[104:105], v244 offset:40960
  ds_read_b64_tr_b16 a[106:107], v244 offset:45056
  s_add_u32 m0, s38, 114688
  v_mfma_f32_16x16x32_bf16 v[88:91], a[80:83], a[52:55], v[88:91]
  v_accvgpr_read_b32 v4, a132
  buffer_load_dwordx4 v225, s[8:11], s17 offen lds
  v_mfma_f32_16x16x32_bf16 v[76:79], a[84:87], a[48:51], v[76:79]
  ds_read_b64_tr_b16 a[108:109], v245 offset:40960
  ds_read_b64_tr_b16 a[110:111], v245 offset:45056
  v_mfma_f32_16x16x32_bf16 v[92:95], a[84:87], a[52:55], v[92:95]
  ds_read_b64_tr_b16 a[80:81], v242 offset:51200
  v_accvgpr_read_b32 v5, a133
  v_mfma_f32_16x16x32_bf16 v[80:83], a[88:91], a[48:51], v[80:83]
  ds_read_b64_tr_b16 a[82:83], v242 offset:55296
  buffer_load_dwordx4 a[32:35], v240, s[4:7], s16 offen offset:0 sc1
  v_mfma_f32_16x16x32_bf16 v[96:99], a[88:91], a[52:55], v[96:99]
  ds_read_b64_tr_b16 a[84:85], v243 offset:51200
  v_accvgpr_read_b32 v6, a134
  v_mfma_f32_16x16x32_bf16 v[84:87], a[92:95], a[48:51], v[84:87]
  ds_read_b64_tr_b16 a[86:87], v243 offset:55296
  ds_read_b64_tr_b16 a[88:89], v244 offset:51200
  v_mfma_f32_16x16x32_bf16 v[100:103], a[92:95], a[52:55], v[100:103]
  ds_read_b64_tr_b16 a[90:91], v244 offset:55296
  ds_read_b64_tr_b16 a[92:93], v245 offset:51200
  v_mfma_f32_16x16x32_bf16 v[72:75], a[112:115], a[56:59], v[72:75]
  v_accvgpr_read_b32 v7, a135
  buffer_load_dwordx4 v226, s[8:11], s17 offen offset:1024 lds
  v_mfma_f32_16x16x32_bf16 v[88:91], a[112:115], a[60:63], v[88:91]
  ds_read_b64_tr_b16 a[94:95], v245 offset:55296
  ds_read_b64_tr_b16 a[112:113], v242 offset:59392
  v_mfma_f32_16x16x32_bf16 v[76:79], a[116:119], a[56:59], v[76:79]
  ds_read_b64_tr_b16 a[114:115], v242 offset:63488
  v_lshlrev_b32 v200, 16, v4
  v_mfma_f32_16x16x32_bf16 v[92:95], a[116:119], a[60:63], v[92:95]
  ds_read_b64_tr_b16 a[116:117], v243 offset:59392
  ds_read_b64_tr_b16 a[118:119], v243 offset:63488
  v_mfma_f32_16x16x32_bf16 v[80:83], a[120:123], a[56:59], v[80:83]
  v_and_b32 v201, 0xffff0000, v4
  buffer_load_dwordx4 a[36:39], v240, s[4:7], s16 offen offset:1024 sc1
  v_mfma_f32_16x16x32_bf16 v[96:99], a[120:123], a[60:63], v[96:99]
  ds_read_b64_tr_b16 a[120:121], v244 offset:59392
  ds_read_b64_tr_b16 a[122:123], v244 offset:63488
  v_mfma_f32_16x16x32_bf16 v[84:87], a[124:127], a[56:59], v[84:87]
  v_mfma_f32_16x16x32_bf16 v[100:103], a[124:127], a[60:63], v[100:103]
  v_lshlrev_b32 v202, 16, v5
  buffer_load_dword v247, v246, s[56:59], s94 offen sc1
  v_mfma_f32_16x16x32_bf16 v[16:19], a[64:67], a[48:51], v[16:19]
  buffer_load_dwordx4 v227, s[8:11], s17 offen offset:2048 lds
  v_mfma_f32_16x16x32_bf16 v[32:35], a[64:67], a[52:55], v[32:35]
  ds_read_b64_tr_b16 a[124:125], v245 offset:59392
  v_and_b32 v203, 0xffff0000, v5
  s_waitcnt lgkmcnt(10)
  v_mfma_f32_16x16x32_bf16 v[20:23], a[68:71], a[48:51], v[20:23]
  ds_read_b64_tr_b16 a[126:127], v245 offset:63488
  ds_read_b64_tr_b16 a[64:65], v242 offset:49152
  v_mfma_f32_16x16x32_bf16 v[36:39], a[68:71], a[52:55], v[36:39]
  ds_read_b64_tr_b16 a[66:67], v242 offset:53248
  v_lshlrev_b32 v204, 16, v6
  v_mfma_f32_16x16x32_bf16 v[24:27], a[72:75], a[48:51], v[24:27]
  buffer_load_dwordx4 a[40:43], v241, s[4:7], s16 offen offset:0 sc1
  v_mfma_f32_16x16x32_bf16 v[40:43], a[72:75], a[52:55], v[40:43]
  ds_read_b64_tr_b16 a[68:69], v243 offset:49152
  ds_read_b64_tr_b16 a[70:71], v243 offset:53248
  v_mfma_f32_16x16x32_bf16 v[28:31], a[76:79], a[48:51], v[28:31]
  ds_read_b64_tr_b16 a[72:73], v244 offset:49152
  v_and_b32 v205, 0xffff0000, v6
  v_mfma_f32_16x16x32_bf16 v[44:47], a[76:79], a[52:55], v[44:47]
  buffer_load_dwordx4 v228, s[8:11], s17 offen offset:3072 lds
  v_mfma_f32_16x16x32_bf16 v[16:19], a[96:99], a[56:59], v[16:19]
  ds_read_b64_tr_b16 a[74:75], v244 offset:53248
  v_lshlrev_b32 v206, 16, v7
  s_add_u32 s17, s17, 458752
  v_mfma_f32_16x16x32_bf16 v[32:35], a[96:99], a[60:63], v[32:35]
  ds_read_b64_tr_b16 a[76:77], v245 offset:49152
  s_cmp_eq_u32 s17, s93
  v_mfma_f32_16x16x32_bf16 v[20:23], a[100:103], a[56:59], v[20:23]
  ds_read_b64_tr_b16 a[78:79], v245 offset:53248
  v_and_b32 v207, 0xffff0000, v7
  s_cselect_b32 s17, s95, s17
  v_mfma_f32_16x16x32_bf16 v[36:39], a[100:103], a[60:63], v[36:39]
  buffer_load_dwordx4 a[44:47], v241, s[4:7], s16 offen offset:1024 sc1
  v_mfma_f32_16x16x32_bf16 v[24:27], a[104:107], a[56:59], v[24:27]
  ds_read_b64_tr_b16 a[96:97], v242 offset:57344
  ds_read_b64_tr_b16 a[98:99], v242 offset:61440
  s_add_u32 s41, s41, 262144
  v_mfma_f32_16x16x32_bf16 v[40:43], a[104:107], a[60:63], v[40:43]
  ds_read_b64_tr_b16 a[100:101], v243 offset:57344
  s_bitset0_b32 s41, 21
  v_mfma_f32_16x16x32_bf16 v[28:31], a[108:111], a[56:59], v[28:31]
  ds_read_b64_tr_b16 a[102:103], v243 offset:61440
  ds_read_b128 v[60:63], v253 offset:832
  s_add_u32 s16, s40, s41
  v_mfma_f32_16x16x32_bf16 v[44:47], a[108:111], a[60:63], v[44:47]
  s_waitcnt vmcnt(17) lgkmcnt(10)
  s_barrier
  v_mfma_f32_16x16x32_bf16 v[72:75], a[80:83], a[0:3], v[72:75]
  ds_read_b64_tr_b16 a[104:105], v244 offset:57344
  ds_read_b64_tr_b16 a[106:107], v244 offset:61440
  s_add_u32 m0, s38, 131072
  v_mfma_f32_16x16x32_bf16 v[88:91], a[80:83], a[4:7], v[88:91]
  v_accvgpr_read_b32 v8, a136
  buffer_load_dwordx4 v225, s[8:11], s17 offen lds
  v_mfma_f32_16x16x32_bf16 v[76:79], a[84:87], a[0:3], v[76:79]
  ds_read_b64_tr_b16 a[108:109], v245 offset:57344
  ds_read_b64_tr_b16 a[110:111], v245 offset:61440
  v_mfma_f32_16x16x32_bf16 v[92:95], a[84:87], a[4:7], v[92:95]
  ds_read_b64_tr_b16 a[80:81], v104 offset:2048
  v_accvgpr_read_b32 v9, a137
  v_mfma_f32_16x16x32_bf16 v[80:83], a[88:91], a[0:3], v[80:83]
  ds_read_b64_tr_b16 a[82:83], v104 offset:6144
  buffer_load_dwordx4 a[48:51], v240, s[4:7], s16 offen offset:0 sc1
  v_mfma_f32_16x16x32_bf16 v[96:99], a[88:91], a[4:7], v[96:99]
  ds_read_b64_tr_b16 a[84:85], v105 offset:2048
  v_accvgpr_read_b32 v10, a138
  v_mfma_f32_16x16x32_bf16 v[84:87], a[92:95], a[0:3], v[84:87]
  ds_read_b64_tr_b16 a[86:87], v105 offset:6144
  ds_read_b64_tr_b16 a[88:89], v106 offset:2048
  v_mfma_f32_16x16x32_bf16 v[100:103], a[92:95], a[4:7], v[100:103]
  ds_read_b64_tr_b16 a[90:91], v106 offset:6144
  ds_read_b64_tr_b16 a[92:93], v107 offset:2048
  v_mfma_f32_16x16x32_bf16 v[72:75], a[112:115], a[8:11], v[72:75]
  v_accvgpr_read_b32 v11, a139
  buffer_load_dwordx4 v226, s[8:11], s17 offen offset:1024 lds
  v_mfma_f32_16x16x32_bf16 v[88:91], a[112:115], a[12:15], v[88:91]
  ds_read_b64_tr_b16 a[94:95], v107 offset:6144
  ds_read_b64_tr_b16 a[112:113], v104 offset:10240
  v_mfma_f32_16x16x32_bf16 v[76:79], a[116:119], a[8:11], v[76:79]
  ds_read_b64_tr_b16 a[114:115], v104 offset:14336
  v_lshlrev_b32 v208, 16, v8
  v_mfma_f32_16x16x32_bf16 v[92:95], a[116:119], a[12:15], v[92:95]
  ds_read_b64_tr_b16 a[116:117], v105 offset:10240
  ds_read_b64_tr_b16 a[118:119], v105 offset:14336
  v_mfma_f32_16x16x32_bf16 v[80:83], a[120:123], a[8:11], v[80:83]
  v_and_b32 v209, 0xffff0000, v8
  buffer_load_dwordx4 a[52:55], v240, s[4:7], s16 offen offset:1024 sc1
  v_mfma_f32_16x16x32_bf16 v[96:99], a[120:123], a[12:15], v[96:99]
  ds_read_b64_tr_b16 a[120:121], v106 offset:10240
  ds_read_b64_tr_b16 a[122:123], v106 offset:14336
  v_mfma_f32_16x16x32_bf16 v[84:87], a[124:127], a[8:11], v[84:87]
  v_mfma_f32_16x16x32_bf16 v[100:103], a[124:127], a[12:15], v[100:103]
  ds_read_b64_tr_b16 a[124:125], v107 offset:10240
  v_lshlrev_b32 v210, 16, v9
  v_mfma_f32_16x16x32_bf16 v[16:19], a[64:67], a[0:3], v[16:19]
  buffer_load_dwordx4 v227, s[8:11], s17 offen offset:2048 lds
  v_mfma_f32_16x16x32_bf16 v[32:35], a[64:67], a[4:7], v[32:35]
  ds_read_b64_tr_b16 a[126:127], v107 offset:14336
  v_and_b32 v211, 0xffff0000, v9
  s_waitcnt lgkmcnt(10)
  v_mfma_f32_16x16x32_bf16 v[20:23], a[68:71], a[0:3], v[20:23]
  ds_read_b64_tr_b16 a[64:65], v104 offset:0
  ds_read_b64_tr_b16 a[66:67], v104 offset:4096
  v_mfma_f32_16x16x32_bf16 v[36:39], a[68:71], a[4:7], v[36:39]
  ds_read_b64_tr_b16 a[68:69], v105 offset:0
  v_lshlrev_b32 v212, 16, v10
  v_mfma_f32_16x16x32_bf16 v[24:27], a[72:75], a[0:3], v[24:27]
  buffer_load_dwordx4 a[56:59], v241, s[4:7], s16 offen offset:0 sc1
  v_mfma_f32_16x16x32_bf16 v[40:43], a[72:75], a[4:7], v[40:43]
  ds_read_b64_tr_b16 a[70:71], v105 offset:4096
  ds_read_b64_tr_b16 a[72:73], v106 offset:0
  v_mfma_f32_16x16x32_bf16 v[28:31], a[76:79], a[0:3], v[28:31]
  v_and_b32 v213, 0xffff0000, v10
  buffer_load_dwordx4 v228, s[8:11], s17 offen offset:3072 lds
  v_mfma_f32_16x16x32_bf16 v[44:47], a[76:79], a[4:7], v[44:47]
  ds_read_b64_tr_b16 a[74:75], v106 offset:4096
  s_add_u32 s17, s17, 458752
  v_mfma_f32_16x16x32_bf16 v[16:19], a[96:99], a[8:11], v[16:19]
  v_lshlrev_b32 v214, 16, v11
  s_cmp_eq_u32 s17, s93
  v_mfma_f32_16x16x32_bf16 v[32:35], a[96:99], a[12:15], v[32:35]
  ds_read_b64_tr_b16 a[76:77], v107 offset:0
  s_cselect_b32 s17, s95, s17
  v_mfma_f32_16x16x32_bf16 v[20:23], a[100:103], a[8:11], v[20:23]
  ds_read_b64_tr_b16 a[78:79], v107 offset:4096
  v_and_b32 v215, 0xffff0000, v11
  buffer_load_dwordx4 a[60:63], v241, s[4:7], s16 offen offset:1024 sc1
  v_mfma_f32_16x16x32_bf16 v[36:39], a[100:103], a[12:15], v[36:39]
  ds_read_b64_tr_b16 a[96:97], v104 offset:8192
  s_add_u32 s41, s41, 262144
  v_mfma_f32_16x16x32_bf16 v[24:27], a[104:107], a[8:11], v[24:27]
  ds_read_b64_tr_b16 a[98:99], v104 offset:12288
  s_bitset0_b32 s41, 21
  v_mfma_f32_16x16x32_bf16 v[40:43], a[104:107], a[12:15], v[40:43]
  ds_read_b64_tr_b16 a[100:101], v105 offset:8192
  s_add_u32 s40, s40, 2097152
  v_mfma_f32_16x16x32_bf16 v[28:31], a[108:111], a[8:11], v[28:31]
  ds_read_b64_tr_b16 a[102:103], v105 offset:12288
  ds_read_b128 v[64:67], v253 offset:896
  s_add_u32 s16, s40, s41
  v_mfma_f32_16x16x32_bf16 v[44:47], a[108:111], a[12:15], v[44:47]
  s_waitcnt vmcnt(12) lgkmcnt(10)
  s_barrier
  v_cmp_ne_u32 vcc, s19, v247
  s_nop 1
  s_cmp_lg_u64 vcc, 0
  s_cbranch_scc1 L_slow_29
  L_back_30:
  s_add_u32 s94, s94, 65536
  v_mfma_f32_16x16x32_bf16 v[72:75], a[80:83], a[16:19], v[72:75]
  ds_read_b64_tr_b16 a[104:105], v106 offset:8192
  ds_read_b64_tr_b16 a[106:107], v106 offset:12288
  buffer_load_dwordx4 a[0:3], v240, s[4:7], s16 offen offset:0 sc1
  v_mfma_f32_16x16x32_bf16 v[88:91], a[80:83], a[20:23], v[88:91]
  ds_read_b64_tr_b16 a[108:109], v107 offset:8192
  v_accvgpr_read_b32 v12, a140
  v_mfma_f32_16x16x32_bf16 v[76:79], a[84:87], a[16:19], v[76:79]
  ds_read_b64_tr_b16 a[110:111], v107 offset:12288
  ds_read_b64_tr_b16 a[80:81], v104 offset:18432
  v_mfma_f32_16x16x32_bf16 v[92:95], a[84:87], a[20:23], v[92:95]
  ds_read_b64_tr_b16 a[82:83], v104 offset:22528
  v_accvgpr_read_b32 v13, a141
  v_mfma_f32_16x16x32_bf16 v[80:83], a[88:91], a[16:19], v[80:83]
  ds_read_b64_tr_b16 a[84:85], v105 offset:18432
  ds_read_b64_tr_b16 a[86:87], v105 offset:22528
  v_mfma_f32_16x16x32_bf16 v[96:99], a[88:91], a[20:23], v[96:99]
  ds_read_b64_tr_b16 a[88:89], v106 offset:18432
  v_accvgpr_read_b32 v14, a142
  v_mfma_f32_16x16x32_bf16 v[84:87], a[92:95], a[16:19], v[84:87]
  ds_read_b64_tr_b16 a[90:91], v106 offset:22528
  v_mfma_f32_16x16x32_bf16 v[100:103], a[92:95], a[20:23], v[100:103]
  buffer_load_dwordx4 a[4:7], v240, s[4:7], s16 offen offset:1024 sc1
  v_mfma_f32_16x16x32_bf16 v[72:75], a[112:115], a[24:27], v[72:75]
  ds_read_b64_tr_b16 a[92:93], v107 offset:18432
  v_accvgpr_read_b32 v15, a143
  v_mfma_f32_16x16x32_bf16 v[88:91], a[112:115], a[28:31], v[88:91]
  ds_read_b64_tr_b16 a[94:95], v107 offset:22528
  ds_read_b64_tr_b16 a[112:113], v104 offset:26624
  v_mfma_f32_16x16x32_bf16 v[76:79], a[116:119], a[24:27], v[76:79]
  ds_read_b64_tr_b16 a[114:115], v104 offset:30720
  v_lshlrev_b32 v216, 16, v12
  v_mfma_f32_16x16x32_bf16 v[92:95], a[116:119], a[28:31], v[92:95]
  ds_read_b64_tr_b16 a[116:117], v105 offset:26624
  ds_read_b64_tr_b16 a[118:119], v105 offset:30720
  v_mfma_f32_16x16x32_bf16 v[80:83], a[120:123], a[24:27], v[80:83]
  v_and_b32 v217, 0xffff0000, v12
  v_mfma_f32_16x16x32_bf16 v[96:99], a[120:123], a[28:31], v[96:99]
  ds_read_b64_tr_b16 a[120:121], v106 offset:26624
  ds_read_b64_tr_b16 a[122:123], v106 offset:30720
  v_mfma_f32_16x16x32_bf16 v[84:87], a[124:127], a[24:27], v[84:87]
  v_mfma_f32_16x16x32_bf16 v[100:103], a[124:127], a[28:31], v[100:103]
  v_lshlrev_b32 v218, 16, v13
  buffer_load_dwordx4 a[8:11], v241, s[4:7], s16 offen offset:0 sc1
  v_mfma_f32_16x16x32_bf16 v[16:19], a[64:67], a[16:19], v[16:19]
  ds_read_b64_tr_b16 a[124:125], v107 offset:26624
  ds_read_b64_tr_b16 a[126:127], v107 offset:30720
  v_mfma_f32_16x16x32_bf16 v[32:35], a[64:67], a[20:23], v[32:35]
  ds_read_b64_tr_b16 a[64:65], v104 offset:16384
  v_and_b32 v219, 0xffff0000, v13
  s_waitcnt lgkmcnt(10)
  v_mfma_f32_16x16x32_bf16 v[20:23], a[68:71], a[16:19], v[20:23]
  ds_read_b64_tr_b16 a[66:67], v104 offset:20480
  v_mfma_f32_16x16x32_bf16 v[36:39], a[68:71], a[20:23], v[36:39]
  ds_read_b64_tr_b16 a[68:69], v105 offset:16384
  v_lshlrev_b32 v220, 16, v14
  v_mfma_f32_16x16x32_bf16 v[24:27], a[72:75], a[16:19], v[24:27]
  ds_read_b64_tr_b16 a[70:71], v105 offset:20480
  v_mfma_f32_16x16x32_bf16 v[40:43], a[72:75], a[20:23], v[40:43]
  ds_read_b64_tr_b16 a[72:73], v106 offset:16384
  ds_read_b64_tr_b16 a[74:75], v106 offset:20480
  v_mfma_f32_16x16x32_bf16 v[28:31], a[76:79], a[16:19], v[28:31]
  v_and_b32 v221, 0xffff0000, v14
  v_mfma_f32_16x16x32_bf16 v[44:47], a[76:79], a[20:23], v[44:47]
  buffer_load_dwordx4 a[12:15], v241, s[4:7], s16 offen offset:1024 sc1
  v_mfma_f32_16x16x32_bf16 v[16:19], a[96:99], a[24:27], v[16:19]
  v_lshlrev_b32 v222, 16, v15
  s_add_u32 s41, s41, 262144
  v_mfma_f32_16x16x32_bf16 v[32:35], a[96:99], a[28:31], v[32:35]
  ds_read_b64_tr_b16 a[76:77], v107 offset:16384
  s_bitset0_b32 s41, 21
  v_mfma_f32_16x16x32_bf16 v[20:23], a[100:103], a[24:27], v[20:23]
  ds_read_b64_tr_b16 a[78:79], v107 offset:20480
  v_and_b32 v223, 0xffff0000, v15
  s_add_u32 s16, s40, s41
  v_mfma_f32_16x16x32_bf16 v[36:39], a[100:103], a[28:31], v[36:39]
  ds_read_b64_tr_b16 a[96:97], v104 offset:24576
  ds_read_b64_tr_b16 a[98:99], v104 offset:28672
  v_mfma_f32_16x16x32_bf16 v[24:27], a[104:107], a[24:27], v[24:27]
  ds_read_b64_tr_b16 a[100:101], v105 offset:24576
  ds_read_b64_tr_b16 a[102:103], v105 offset:28672
  v_mfma_f32_16x16x32_bf16 v[40:43], a[104:107], a[28:31], v[40:43]
  ds_read_b64_tr_b16 a[104:105], v106 offset:24576
  ds_read_b64_tr_b16 a[106:107], v106 offset:28672
  v_mfma_f32_16x16x32_bf16 v[28:31], a[108:111], a[24:27], v[28:31]
  ds_read_b128 v[68:71], v253 offset:960
  v_mfma_f32_16x16x32_bf16 v[44:47], a[108:111], a[28:31], v[44:47]
  s_waitcnt vmcnt(12) lgkmcnt(10)
  s_barrier
  v_mfma_f32_16x16x32_bf16 v[72:75], a[80:83], a[32:35], v[72:75]
  ds_read_b64_tr_b16 a[108:109], v107 offset:24576
  s_add_u32 m0, s38, 0
  v_mfma_f32_16x16x32_bf16 v[88:91], a[80:83], a[36:39], v[88:91]
  buffer_load_dwordx4 v225, s[8:11], s17 offen lds
  v_mfma_f32_16x16x32_bf16 v[76:79], a[84:87], a[32:35], v[76:79]
  ds_read_b64_tr_b16 a[110:111], v107 offset:28672
  ds_read_b64_tr_b16 a[80:81], v104 offset:34816
  v_mfma_f32_16x16x32_bf16 v[92:95], a[84:87], a[36:39], v[92:95]
  ds_read_b64_tr_b16 a[82:83], v104 offset:38912
  ds_read_b64_tr_b16 a[84:85], v105 offset:34816
  v_mfma_f32_16x16x32_bf16 v[80:83], a[88:91], a[32:35], v[80:83]
  buffer_load_dwordx4 a[16:19], v240, s[4:7], s16 offen offset:0 sc1
  v_mfma_f32_16x16x32_bf16 v[96:99], a[88:91], a[36:39], v[96:99]
  ds_read_b64_tr_b16 a[86:87], v105 offset:38912
  ds_read_b64_tr_b16 a[88:89], v106 offset:34816
  v_mfma_f32_16x16x32_bf16 v[84:87], a[92:95], a[32:35], v[84:87]
  ds_read_b64_tr_b16 a[90:91], v106 offset:38912
  v_mfma_f32_16x16x32_bf16 v[100:103], a[92:95], a[36:39], v[100:103]
  ds_read_b64_tr_b16 a[92:93], v107 offset:34816
  ds_read_b64_tr_b16 a[94:95], v107 offset:38912
  v_mfma_f32_16x16x32_bf16 v[72:75], a[112:115], a[40:43], v[72:75]
  buffer_load_dwordx4 v226, s[8:11], s17 offen offset:1024 lds
  v_mfma_f32_16x16x32_bf16 v[88:91], a[112:115], a[44:47], v[88:91]
  ds_read_b64_tr_b16 a[112:113], v104 offset:43008
  ds_read_b64_tr_b16 a[114:115], v104 offset:47104
  v_mfma_f32_16x16x32_bf16 v[76:79], a[116:119], a[40:43], v[76:79]
  v_mfma_f32_16x16x32_bf16 v[92:95], a[116:119], a[44:47], v[92:95]
  ds_read_b64_tr_b16 a[116:117], v105 offset:43008
  ds_read_b64_tr_b16 a[118:119], v105 offset:47104
  v_mfma_f32_16x16x32_bf16 v[80:83], a[120:123], a[40:43], v[80:83]
  buffer_load_dwordx4 a[20:23], v240, s[4:7], s16 offen offset:1024 sc1
  v_mfma_f32_16x16x32_bf16 v[96:99], a[120:123], a[44:47], v[96:99]
  ds_read_b64_tr_b16 a[120:121], v106 offset:43008
  ds_read_b64_tr_b16 a[122:123], v106 offset:47104
  v_mfma_f32_16x16x32_bf16 v[84:87], a[124:127], a[40:43], v[84:87]
  v_mfma_f32_16x16x32_bf16 v[100:103], a[124:127], a[44:47], v[100:103]
  ds_read_b64_tr_b16 a[124:125], v107 offset:43008
  ds_read_b64_tr_b16 a[126:127], v107 offset:47104
  v_mfma_f32_16x16x32_bf16 v[16:19], a[64:67], a[32:35], v[16:19]
  buffer_load_dwordx4 v227, s[8:11], s17 offen offset:2048 lds
  v_mfma_f32_16x16x32_bf16 v[32:35], a[64:67], a[36:39], v[32:35]
  ds_read_b64_tr_b16 a[64:65], v104 offset:32768
  ds_read_b64_tr_b16 a[66:67], v104 offset:36864
  v_mfma_f32_16x16x32_bf16 v[20:23], a[68:71], a[32:35], v[20:23]
  v_mfma_f32_16x16x32_bf16 v[36:39], a[68:71], a[36:39], v[36:39]
  ds_read_b64_tr_b16 a[68:69], v105 offset:32768
  ds_read_b64_tr_b16 a[70:71], v105 offset:36864
  s_waitcnt lgkmcnt(10)
  v_mfma_f32_16x16x32_bf16 v[24:27], a[72:75], a[32:35], v[24:27]
  buffer_load_dwordx4 a[24:27], v241, s[4:7], s16 offen offset:0 sc1
  v_mfma_f32_16x16x32_bf16 v[40:43], a[72:75], a[36:39], v[40:43]
  ds_read_b64_tr_b16 a[72:73], v106 offset:32768
  ds_read_b64_tr_b16 a[74:75], v106 offset:36864
  v_mfma_f32_16x16x32_bf16 v[28:31], a[76:79], a[32:35], v[28:31]
  v_mfma_f32_16x16x32_bf16 v[44:47], a[76:79], a[36:39], v[44:47]
  buffer_load_dwordx4 v228, s[8:11], s17 offen offset:3072 lds
  v_mfma_f32_16x16x32_bf16 v[16:19], a[96:99], a[40:43], v[16:19]
  ds_read_b64_tr_b16 a[76:77], v107 offset:32768
  s_add_u32 s17, s17, 458752
  v_mfma_f32_16x16x32_bf16 v[32:35], a[96:99], a[44:47], v[32:35]
  ds_read_b64_tr_b16 a[78:79], v107 offset:36864
  s_cmp_eq_u32 s17, s93
  v_mfma_f32_16x16x32_bf16 v[20:23], a[100:103], a[40:43], v[20:23]
  ds_read_b64_tr_b16 a[96:97], v104 offset:40960
  s_cselect_b32 s17, s95, s17
  v_mfma_f32_16x16x32_bf16 v[36:39], a[100:103], a[44:47], v[36:39]
  buffer_load_dwordx4 a[28:31], v241, s[4:7], s16 offen offset:1024 sc1
  v_mfma_f32_16x16x32_bf16 v[24:27], a[104:107], a[40:43], v[24:27]
  ds_read_b64_tr_b16 a[98:99], v104 offset:45056
  s_add_u32 s41, s41, 262144
  v_mfma_f32_16x16x32_bf16 v[40:43], a[104:107], a[44:47], v[40:43]
  ds_read_b64_tr_b16 a[100:101], v105 offset:40960
  s_bitset0_b32 s41, 21
  v_mfma_f32_16x16x32_bf16 v[28:31], a[108:111], a[40:43], v[28:31]
  ds_read_b64_tr_b16 a[102:103], v105 offset:45056
  s_add_u32 s16, s40, s41
  v_mfma_f32_16x16x32_bf16 v[44:47], a[108:111], a[44:47], v[44:47]
  s_waitcnt vmcnt(12) lgkmcnt(10)
  s_barrier
  v_mfma_f32_16x16x32_bf16 v[72:75], a[80:83], a[48:51], v[72:75]
  ds_read_b64_tr_b16 a[104:105], v106 offset:40960
  ds_read_b64_tr_b16 a[106:107], v106 offset:45056
  s_add_u32 m0, s38, 16384
  v_mfma_f32_16x16x32_bf16 v[88:91], a[80:83], a[52:55], v[88:91]
  buffer_load_dwordx4 v225, s[8:11], s17 offen lds
  v_mfma_f32_16x16x32_bf16 v[76:79], a[84:87], a[48:51], v[76:79]
  ds_read_b64_tr_b16 a[108:109], v107 offset:40960
  ds_read_b64_tr_b16 a[110:111], v107 offset:45056
  v_mfma_f32_16x16x32_bf16 v[92:95], a[84:87], a[52:55], v[92:95]
  ds_read_b64_tr_b16 a[80:81], v104 offset:51200
  ds_read_b64_tr_b16 a[82:83], v104 offset:55296
  v_mfma_f32_16x16x32_bf16 v[80:83], a[88:91], a[48:51], v[80:83]
  buffer_load_dwordx4 a[32:35], v240, s[4:7], s16 offen offset:0 sc1
  v_mfma_f32_16x16x32_bf16 v[96:99], a[88:91], a[52:55], v[96:99]
  ds_read_b64_tr_b16 a[84:85], v105 offset:51200
  ds_read_b64_tr_b16 a[86:87], v105 offset:55296
  v_mfma_f32_16x16x32_bf16 v[84:87], a[92:95], a[48:51], v[84:87]
  ds_read_b64_tr_b16 a[88:89], v106 offset:51200
  ds_read_b64_tr_b16 a[90:91], v106 offset:55296
  v_mfma_f32_16x16x32_bf16 v[100:103], a[92:95], a[52:55], v[100:103]
  ds_read_b64_tr_b16 a[92:93], v107 offset:51200
  ds_read_b64_tr_b16 a[94:95], v107 offset:55296
  v_mfma_f32_16x16x32_bf16 v[72:75], a[112:115], a[56:59], v[72:75]
  buffer_load_dwordx4 v226, s[8:11], s17 offen offset:1024 lds
  v_mfma_f32_16x16x32_bf16 v[88:91], a[112:115], a[60:63], v[88:91]
  ds_read_b64_tr_b16 a[112:113], v104 offset:59392
  ds_read_b64_tr_b16 a[114:115], v104 offset:63488
  v_mfma_f32_16x16x32_bf16 v[76:79], a[116:119], a[56:59], v[76:79]
  v_mfma_f32_16x16x32_bf16 v[92:95], a[116:119], a[60:63], v[92:95]
  ds_read_b64_tr_b16 a[116:117], v105 offset:59392
  ds_read_b64_tr_b16 a[118:119], v105 offset:63488
  v_mfma_f32_16x16x32_bf16 v[80:83], a[120:123], a[56:59], v[80:83]
  buffer_load_dwordx4 a[36:39], v240, s[4:7], s16 offen offset:1024 sc1
  v_mfma_f32_16x16x32_bf16 v[96:99], a[120:123], a[60:63], v[96:99]
  ds_read_b64_tr_b16 a[120:121], v106 offset:59392
  ds_read_b64_tr_b16 a[122:123], v106 offset:63488
  v_mfma_f32_16x16x32_bf16 v[84:87], a[124:127], a[56:59], v[84:87]
  v_mfma_f32_16x16x32_bf16 v[100:103], a[124:127], a[60:63], v[100:103]
  ds_read_b64_tr_b16 a[124:125], v107 offset:59392
  ds_read_b64_tr_b16 a[126:127], v107 offset:63488
  v_mfma_f32_16x16x32_bf16 v[16:19], a[64:67], a[48:51], v[16:19]
  buffer_load_dwordx4 v227, s[8:11], s17 offen offset:2048 lds
  v_mfma_f32_16x16x32_bf16 v[32:35], a[64:67], a[52:55], v[32:35]
  ds_read_b64_tr_b16 a[64:65], v104 offset:49152
  ds_read_b64_tr_b16 a[66:67], v104 offset:53248
  s_waitcnt lgkmcnt(10)
  v_mfma_f32_16x16x32_bf16 v[20:23], a[68:71], a[48:51], v[20:23]
  v_mfma_f32_16x16x32_bf16 v[36:39], a[68:71], a[52:55], v[36:39]
  ds_read_b64_tr_b16 a[68:69], v105 offset:49152
  ds_read_b64_tr_b16 a[70:71], v105 offset:53248
  v_mfma_f32_16x16x32_bf16 v[24:27], a[72:75], a[48:51], v[24:27]
  buffer_load_dwordx4 a[40:43], v241, s[4:7], s16 offen offset:0 sc1
  v_mfma_f32_16x16x32_bf16 v[40:43], a[72:75], a[52:55], v[40:43]
  ds_read_b64_tr_b16 a[72:73], v106 offset:49152
  ds_read_b64_tr_b16 a[74:75], v106 offset:53248
  v_mfma_f32_16x16x32_bf16 v[28:31], a[76:79], a[48:51], v[28:31]
  v_mfma_f32_16x16x32_bf16 v[44:47], a[76:79], a[52:55], v[44:47]
  buffer_load_dwordx4 v228, s[8:11], s17 offen offset:3072 lds
  v_mfma_f32_16x16x32_bf16 v[16:19], a[96:99], a[56:59], v[16:19]
  ds_read_b64_tr_b16 a[76:77], v107 offset:49152
  s_add_u32 s17, s17, 458752
  v_mfma_f32_16x16x32_bf16 v[32:35], a[96:99], a[60:63], v[32:35]
  ds_read_b64_tr_b16 a[78:79], v107 offset:53248
  s_cmp_eq_u32 s17, s93
  v_mfma_f32_16x16x32_bf16 v[20:23], a[100:103], a[56:59], v[20:23]
  ds_read_b64_tr_b16 a[96:97], v104 offset:57344
  s_cselect_b32 s17, s95, s17
  v_mfma_f32_16x16x32_bf16 v[36:39], a[100:103], a[60:63], v[36:39]
  buffer_load_dwordx4 a[44:47], v241, s[4:7], s16 offen offset:1024 sc1
  v_mfma_f32_16x16x32_bf16 v[24:27], a[104:107], a[56:59], v[24:27]
  ds_read_b64_tr_b16 a[98:99], v104 offset:61440
  s_add_u32 s41, s41, 262144
  v_mfma_f32_16x16x32_bf16 v[40:43], a[104:107], a[60:63], v[40:43]
  ds_read_b64_tr_b16 a[100:101], v105 offset:57344
  s_bitset0_b32 s41, 21
  v_mfma_f32_16x16x32_bf16 v[28:31], a[108:111], a[56:59], v[28:31]
  ds_read_b64_tr_b16 a[102:103], v105 offset:61440
  s_add_u32 s16, s40, s41
  v_mfma_f32_16x16x32_bf16 v[44:47], a[108:111], a[60:63], v[44:47]
  s_waitcnt vmcnt(16) lgkmcnt(10)
  s_barrier
  v_mfma_f32_16x16x32_bf16 v[72:75], a[80:83], a[0:3], v[72:75]
  ds_read_b64_tr_b16 a[104:105], v106 offset:57344
  ds_read_b64_tr_b16 a[106:107], v106 offset:61440
  s_add_u32 m0, s38, 32768
  v_mfma_f32_16x16x32_bf16 v[88:91], a[80:83], a[4:7], v[88:91]
  buffer_load_dwordx4 v225, s[8:11], s17 offen lds
  v_mfma_f32_16x16x32_bf16 v[76:79], a[84:87], a[0:3], v[76:79]
  ds_read_b64_tr_b16 a[108:109], v107 offset:57344
  ds_read_b64_tr_b16 a[110:111], v107 offset:61440
  v_mfma_f32_16x16x32_bf16 v[92:95], a[84:87], a[4:7], v[92:95]
  ds_read_b64_tr_b16 a[80:81], v124 offset:2048
  ds_read_b64_tr_b16 a[82:83], v124 offset:6144
  v_mfma_f32_16x16x32_bf16 v[80:83], a[88:91], a[0:3], v[80:83]
  buffer_load_dwordx4 a[48:51], v240, s[4:7], s16 offen offset:0 sc1
  v_mfma_f32_16x16x32_bf16 v[96:99], a[88:91], a[4:7], v[96:99]
  ds_read_b64_tr_b16 a[84:85], v125 offset:2048
  ds_read_b64_tr_b16 a[86:87], v125 offset:6144
  v_mfma_f32_16x16x32_bf16 v[84:87], a[92:95], a[0:3], v[84:87]
  ds_read_b64_tr_b16 a[88:89], v126 offset:2048
  ds_read_b64_tr_b16 a[90:91], v126 offset:6144
  v_mfma_f32_16x16x32_bf16 v[100:103], a[92:95], a[4:7], v[100:103]
  ds_read_b64_tr_b16 a[92:93], v127 offset:2048
  ds_read_b64_tr_b16 a[94:95], v127 offset:6144
  v_mfma_f32_16x16x32_bf16 v[72:75], a[112:115], a[8:11], v[72:75]
  buffer_load_dwordx4 v226, s[8:11], s17 offen offset:1024 lds
  v_mfma_f32_16x16x32_bf16 v[88:91], a[112:115], a[12:15], v[88:91]
  ds_read_b64_tr_b16 a[112:113], v124 offset:10240
  ds_read_b64_tr_b16 a[114:115], v124 offset:14336
  v_mfma_f32_16x16x32_bf16 v[76:79], a[116:119], a[8:11], v[76:79]
  v_mfma_f32_16x16x32_bf16 v[92:95], a[116:119], a[12:15], v[92:95]
  ds_read_b64_tr_b16 a[116:117], v125 offset:10240
  ds_read_b64_tr_b16 a[118:119], v125 offset:14336
  v_mfma_f32_16x16x32_bf16 v[80:83], a[120:123], a[8:11], v[80:83]
  buffer_load_dwordx4 a[52:55], v240, s[4:7], s16 offen offset:1024 sc1
  v_mfma_f32_16x16x32_bf16 v[96:99], a[120:123], a[12:15], v[96:99]
  ds_read_b64_tr_b16 a[120:121], v126 offset:10240
  ds_read_b64_tr_b16 a[122:123], v126 offset:14336
  v_mfma_f32_16x16x32_bf16 v[84:87], a[124:127], a[8:11], v[84:87]
  v_mfma_f32_16x16x32_bf16 v[100:103], a[124:127], a[12:15], v[100:103]
  ds_read_b64_tr_b16 a[124:125], v127 offset:10240
  ds_read_b64_tr_b16 a[126:127], v127 offset:14336
  v_mfma_f32_16x16x32_bf16 v[16:19], a[64:67], a[0:3], v[16:19]
  buffer_load_dwordx4 v227, s[8:11], s17 offen offset:2048 lds
  v_mfma_f32_16x16x32_bf16 v[32:35], a[64:67], a[4:7], v[32:35]
  ds_read_b64_tr_b16 a[64:65], v124 offset:0
  ds_read_b64_tr_b16 a[66:67], v124 offset:4096
  s_waitcnt lgkmcnt(10)
  v_mfma_f32_16x16x32_bf16 v[20:23], a[68:71], a[0:3], v[20:23]
  v_mfma_f32_16x16x32_bf16 v[36:39], a[68:71], a[4:7], v[36:39]
  ds_read_b64_tr_b16 a[68:69], v125 offset:0
  ds_read_b64_tr_b16 a[70:71], v125 offset:4096
  v_mfma_f32_16x16x32_bf16 v[24:27], a[72:75], a[0:3], v[24:27]
  buffer_load_dwordx4 a[56:59], v241, s[4:7], s16 offen offset:0 sc1
  v_mfma_f32_16x16x32_bf16 v[40:43], a[72:75], a[4:7], v[40:43]
  ds_read_b64_tr_b16 a[72:73], v126 offset:0
  ds_read_b64_tr_b16 a[74:75], v126 offset:4096
  v_mfma_f32_16x16x32_bf16 v[28:31], a[76:79], a[0:3], v[28:31]
  v_mfma_f32_16x16x32_bf16 v[44:47], a[76:79], a[4:7], v[44:47]
  buffer_load_dwordx4 v228, s[8:11], s17 offen offset:3072 lds
  v_mfma_f32_16x16x32_bf16 v[16:19], a[96:99], a[8:11], v[16:19]
  ds_read_b64_tr_b16 a[76:77], v127 offset:0
  s_add_u32 s17, s17, 458752
  v_mfma_f32_16x16x32_bf16 v[32:35], a[96:99], a[12:15], v[32:35]
  ds_read_b64_tr_b16 a[78:79], v127 offset:4096
  s_cmp_eq_u32 s17, s93
  v_mfma_f32_16x16x32_bf16 v[20:23], a[100:103], a[8:11], v[20:23]
  ds_read_b64_tr_b16 a[96:97], v124 offset:8192
  s_cselect_b32 s17, s95, s17
  v_mfma_f32_16x16x32_bf16 v[36:39], a[100:103], a[12:15], v[36:39]
  buffer_load_dwordx4 a[60:63], v241, s[4:7], s16 offen offset:1024 sc1
  v_mfma_f32_16x16x32_bf16 v[24:27], a[104:107], a[8:11], v[24:27]
  ds_read_b64_tr_b16 a[98:99], v124 offset:12288
  s_add_u32 s41, s41, 262144
  v_mfma_f32_16x16x32_bf16 v[40:43], a[104:107], a[12:15], v[40:43]
  ds_read_b64_tr_b16 a[100:101], v125 offset:8192
  s_bitset0_b32 s41, 21
  v_mfma_f32_16x16x32_bf16 v[28:31], a[108:111], a[8:11], v[28:31]
  ds_read_b64_tr_b16 a[102:103], v125 offset:12288
  s_add_u32 s16, s40, s41
  v_mfma_f32_16x16x32_bf16 v[44:47], a[108:111], a[12:15], v[44:47]
  s_waitcnt vmcnt(16) lgkmcnt(10)
  s_barrier
  v_mfma_f32_16x16x32_bf16 v[72:75], a[80:83], a[16:19], v[72:75]
  ds_read_b64_tr_b16 a[104:105], v126 offset:8192
  ds_read_b64_tr_b16 a[106:107], v126 offset:12288
  s_add_u32 m0, s38, 49152
  v_mfma_f32_16x16x32_bf16 v[88:91], a[80:83], a[20:23], v[88:91]
  buffer_load_dwordx4 v225, s[8:11], s17 offen lds
  v_mfma_f32_16x16x32_bf16 v[76:79], a[84:87], a[16:19], v[76:79]
  ds_read_b64_tr_b16 a[108:109], v127 offset:8192
  ds_read_b64_tr_b16 a[110:111], v127 offset:12288
  v_mfma_f32_16x16x32_bf16 v[92:95], a[84:87], a[20:23], v[92:95]
  ds_read_b64_tr_b16 a[80:81], v242 offset:2048
  ds_read_b64_tr_b16 a[82:83], v242 offset:6144
  v_mfma_f32_16x16x32_bf16 v[80:83], a[88:91], a[16:19], v[80:83]
  buffer_load_dwordx4 a[0:3], v240, s[4:7], s16 offen offset:0 sc1
  v_mfma_f32_16x16x32_bf16 v[96:99], a[88:91], a[20:23], v[96:99]
  ds_read_b64_tr_b16 a[84:85], v243 offset:2048
  ds_read_b64_tr_b16 a[86:87], v243 offset:6144
  v_mfma_f32_16x16x32_bf16 v[84:87], a[92:95], a[16:19], v[84:87]
  ds_read_b64_tr_b16 a[88:89], v244 offset:2048
  ds_read_b64_tr_b16 a[90:91], v244 offset:6144
  v_mfma_f32_16x16x32_bf16 v[100:103], a[92:95], a[20:23], v[100:103]
  ds_read_b64_tr_b16 a[92:93], v245 offset:2048
  ds_read_b64_tr_b16 a[94:95], v245 offset:6144
  v_mfma_f32_16x16x32_bf16 v[72:75], a[112:115], a[24:27], v[72:75]
  buffer_load_dwordx4 v226, s[8:11], s17 offen offset:1024 lds
  v_mfma_f32_16x16x32_bf16 v[88:91], a[112:115], a[28:31], v[88:91]
  ds_read_b64_tr_b16 a[112:113], v242 offset:10240
  ds_read_b64_tr_b16 a[114:115], v242 offset:14336
  v_mfma_f32_16x16x32_bf16 v[76:79], a[116:119], a[24:27], v[76:79]
  v_mfma_f32_16x16x32_bf16 v[92:95], a[116:119], a[28:31], v[92:95]
  ds_read_b64_tr_b16 a[116:117], v243 offset:10240
  ds_read_b64_tr_b16 a[118:119], v243 offset:14336
  v_mfma_f32_16x16x32_bf16 v[80:83], a[120:123], a[24:27], v[80:83]
  buffer_load_dwordx4 a[4:7], v240, s[4:7], s16 offen offset:1024 sc1
  v_mfma_f32_16x16x32_bf16 v[96:99], a[120:123], a[28:31], v[96:99]
  ds_read_b64_tr_b16 a[120:121], v244 offset:10240
  ds_read_b64_tr_b16 a[122:123], v244 offset:14336
  v_mfma_f32_16x16x32_bf16 v[84:87], a[124:127], a[24:27], v[84:87]
  v_mfma_f32_16x16x32_bf16 v[100:103], a[124:127], a[28:31], v[100:103]
  ds_read_b64_tr_b16 a[124:125], v245 offset:10240
  ds_read_b64_tr_b16 a[126:127], v245 offset:14336
  v_mfma_f32_16x16x32_bf16 v[16:19], a[64:67], a[16:19], v[16:19]
  buffer_load_dwordx4 v227, s[8:11], s17 offen offset:2048 lds
  v_mfma_f32_16x16x32_bf16 v[32:35], a[64:67], a[20:23], v[32:35]
  ds_read_b64_tr_b16 a[64:65], v242 offset:0
  ds_read_b64_tr_b16 a[66:67], v242 offset:4096
  s_waitcnt lgkmcnt(10)
  v_mfma_f32_16x16x32_bf16 v[20:23], a[68:71], a[16:19], v[20:23]
  v_mfma_f32_16x16x32_bf16 v[36:39], a[68:71], a[20:23], v[36:39]
  ds_read_b64_tr_b16 a[68:69], v243 offset:0
  ds_read_b64_tr_b16 a[70:71], v243 offset:4096
  v_mfma_f32_16x16x32_bf16 v[24:27], a[72:75], a[16:19], v[24:27]
  buffer_load_dwordx4 a[8:11], v241, s[4:7], s16 offen offset:0 sc1
  v_mfma_f32_16x16x32_bf16 v[40:43], a[72:75], a[20:23], v[40:43]
  ds_read_b64_tr_b16 a[72:73], v244 offset:0
  ds_read_b64_tr_b16 a[74:75], v244 offset:4096
  v_mfma_f32_16x16x32_bf16 v[28:31], a[76:79], a[16:19], v[28:31]
  v_mfma_f32_16x16x32_bf16 v[44:47], a[76:79], a[20:23], v[44:47]
  buffer_load_dwordx4 v228, s[8:11], s17 offen offset:3072 lds
  v_mfma_f32_16x16x32_bf16 v[16:19], a[96:99], a[24:27], v[16:19]
  ds_read_b64_tr_b16 a[76:77], v245 offset:0
  s_add_u32 s17, s17, 458752
  v_mfma_f32_16x16x32_bf16 v[32:35], a[96:99], a[28:31], v[32:35]
  ds_read_b64_tr_b16 a[78:79], v245 offset:4096
  s_cmp_eq_u32 s17, s93
  v_mfma_f32_16x16x32_bf16 v[20:23], a[100:103], a[24:27], v[20:23]
  ds_read_b64_tr_b16 a[96:97], v242 offset:8192
  s_cselect_b32 s17, s95, s17
  v_mfma_f32_16x16x32_bf16 v[36:39], a[100:103], a[28:31], v[36:39]
  buffer_load_dwordx4 a[12:15], v241, s[4:7], s16 offen offset:1024 sc1
  v_mfma_f32_16x16x32_bf16 v[24:27], a[104:107], a[24:27], v[24:27]
  ds_read_b64_tr_b16 a[98:99], v242 offset:12288
  s_add_u32 s41, s41, 262144
  v_mfma_f32_16x16x32_bf16 v[40:43], a[104:107], a[28:31], v[40:43]
  ds_read_b64_tr_b16 a[100:101], v243 offset:8192
  s_bitset0_b32 s41, 21
  v_mfma_f32_16x16x32_bf16 v[28:31], a[108:111], a[24:27], v[28:31]
  ds_read_b64_tr_b16 a[102:103], v243 offset:12288
  s_add_u32 s16, s40, s41
  v_mfma_f32_16x16x32_bf16 v[44:47], a[108:111], a[28:31], v[44:47]
  s_waitcnt vmcnt(16) lgkmcnt(10)
  s_barrier
  v_mfma_f32_16x16x32_bf16 v[72:75], a[80:83], a[32:35], v[72:75]
  ds_read_b64_tr_b16 a[104:105], v244 offset:8192
  ds_read_b64_tr_b16 a[106:107], v244 offset:12288
  s_add_u32 m0, s38, 65536
  v_mfma_f32_16x16x32_bf16 v[88:91], a[80:83], a[36:39], v[88:91]
  buffer_load_dwordx4 v225, s[8:11], s17 offen lds
  v_mfma_f32_16x16x32_bf16 v[76:79], a[84:87], a[32:35], v[76:79]
  ds_read_b64_tr_b16 a[108:109], v245 offset:8192
  ds_read_b64_tr_b16 a[110:111], v245 offset:12288
  v_mfma_f32_16x16x32_bf16 v[92:95], a[84:87], a[36:39], v[92:95]
  ds_read_b64_tr_b16 a[80:81], v242 offset:18432
  ds_read_b64_tr_b16 a[82:83], v242 offset:22528
  v_mfma_f32_16x16x32_bf16 v[80:83], a[88:91], a[32:35], v[80:83]
  buffer_load_dwordx4 a[16:19], v240, s[4:7], s16 offen offset:0 sc1
  v_mfma_f32_16x16x32_bf16 v[96:99], a[88:91], a[36:39], v[96:99]
  ds_read_b64_tr_b16 a[84:85], v243 offset:18432
  ds_read_b64_tr_b16 a[86:87], v243 offset:22528
  v_mfma_f32_16x16x32_bf16 v[84:87], a[92:95], a[32:35], v[84:87]
  ds_read_b64_tr_b16 a[88:89], v244 offset:18432
  ds_read_b64_tr_b16 a[90:91], v244 offset:22528
  v_mfma_f32_16x16x32_bf16 v[100:103], a[92:95], a[36:39], v[100:103]
  ds_read_b64_tr_b16 a[92:93], v245 offset:18432
  ds_read_b64_tr_b16 a[94:95], v245 offset:22528
  v_mfma_f32_16x16x32_bf16 v[72:75], a[112:115], a[40:43], v[72:75]
  buffer_load_dwordx4 v226, s[8:11], s17 offen offset:1024 lds
  v_mfma_f32_16x16x32_bf16 v[88:91], a[112:115], a[44:47], v[88:91]
  ds_read_b64_tr_b16 a[112:113], v242 offset:26624
  ds_read_b64_tr_b16 a[114:115], v242 offset:30720
  v_mfma_f32_16x16x32_bf16 v[76:79], a[116:119], a[40:43], v[76:79]
  v_mfma_f32_16x16x32_bf16 v[92:95], a[116:119], a[44:47], v[92:95]
  ds_read_b64_tr_b16 a[116:117], v243 offset:26624
  ds_read_b64_tr_b16 a[118:119], v243 offset:30720
  v_mfma_f32_16x16x32_bf16 v[80:83], a[120:123], a[40:43], v[80:83]
  buffer_load_dwordx4 a[20:23], v240, s[4:7], s16 offen offset:1024 sc1
  v_mfma_f32_16x16x32_bf16 v[96:99], a[120:123], a[44:47], v[96:99]
  ds_read_b64_tr_b16 a[120:121], v244 offset:26624
  ds_read_b64_tr_b16 a[122:123], v244 offset:30720
  v_mfma_f32_16x16x32_bf16 v[84:87], a[124:127], a[40:43], v[84:87]
  v_mfma_f32_16x16x32_bf16 v[100:103], a[124:127], a[44:47], v[100:103]
  ds_read_b64_tr_b16 a[124:125], v245 offset:26624
  ds_read_b64_tr_b16 a[126:127], v245 offset:30720
  v_mfma_f32_16x16x32_bf16 v[16:19], a[64:67], a[32:35], v[16:19]
  buffer_load_dwordx4 v227, s[8:11], s17 offen offset:2048 lds
  v_mfma_f32_16x16x32_bf16 v[32:35], a[64:67], a[36:39], v[32:35]
  ds_read_b64_tr_b16 a[64:65], v242 offset:16384
  ds_read_b64_tr_b16 a[66:67], v242 offset:20480
  s_waitcnt lgkmcnt(10)
  v_mfma_f32_16x16x32_bf16 v[20:23], a[68:71], a[32:35], v[20:23]
  v_mfma_f32_16x16x32_bf16 v[36:39], a[68:71], a[36:39], v[36:39]
  ds_read_b64_tr_b16 a[68:69], v243 offset:16384
  ds_read_b64_tr_b16 a[70:71], v243 offset:20480
  v_mfma_f32_16x16x32_bf16 v[24:27], a[72:75], a[32:35], v[24:27]
  buffer_load_dwordx4 a[24:27], v241, s[4:7], s16 offen offset:0 sc1
  v_mfma_f32_16x16x32_bf16 v[40:43], a[72:75], a[36:39], v[40:43]
  ds_read_b64_tr_b16 a[72:73], v244 offset:16384
  ds_read_b64_tr_b16 a[74:75], v244 offset:20480
  v_mfma_f32_16x16x32_bf16 v[28:31], a[76:79], a[32:35], v[28:31]
  v_mfma_f32_16x16x32_bf16 v[44:47], a[76:79], a[36:39], v[44:47]
  buffer_load_dwordx4 v228, s[8:11], s17 offen offset:3072 lds
  v_mfma_f32_16x16x32_bf16 v[16:19], a[96:99], a[40:43], v[16:19]
  ds_read_b64_tr_b16 a[76:77], v245 offset:16384
  s_add_u32 s17, s17, 458752
  v_mfma_f32_16x16x32_bf16 v[32:35], a[96:99], a[44:47], v[32:35]
  ds_read_b64_tr_b16 a[78:79], v245 offset:20480
  s_cmp_eq_u32 s17, s93
  v_mfma_f32_16x16x32_bf16 v[20:23], a[100:103], a[40:43], v[20:23]
  ds_read_b64_tr_b16 a[96:97], v242 offset:24576
  s_cselect_b32 s17, s95, s17
  v_mfma_f32_16x16x32_bf16 v[36:39], a[100:103], a[44:47], v[36:39]
  buffer_load_dwordx4 a[28:31], v241, s[4:7], s16 offen offset:1024 sc1
  v_mfma_f32_16x16x32_bf16 v[24:27], a[104:107], a[40:43], v[24:27]
  ds_read_b64_tr_b16 a[98:99], v242 offset:28672
  s_add_u32 s41, s41, 262144
  v_mfma_f32_16x16x32_bf16 v[40:43], a[104:107], a[44:47], v[40:43]
  ds_read_b64_tr_b16 a[100:101], v243 offset:24576
  s_bitset0_b32 s41, 21
  v_mfma_f32_16x16x32_bf16 v[28:31], a[108:111], a[40:43], v[28:31]
  ds_read_b64_tr_b16 a[102:103], v243 offset:28672
  s_add_u32 s16, s40, s41
  v_mfma_f32_16x16x32_bf16 v[44:47], a[108:111], a[44:47], v[44:47]
  s_waitcnt vmcnt(16) lgkmcnt(10)
  s_barrier
  v_mfma_f32_16x16x32_bf16 v[72:75], a[80:83], a[48:51], v[72:75]
  ds_read_b64_tr_b16 a[104:105], v244 offset:24576
  ds_read_b64_tr_b16 a[106:107], v244 offset:28672
  s_add_u32 m0, s38, 81920
  v_mfma_f32_16x16x32_bf16 v[88:91], a[80:83], a[52:55], v[88:91]
  buffer_load_dwordx4 v225, s[8:11], s17 offen lds
  v_mfma_f32_16x16x32_bf16 v[76:79], a[84:87], a[48:51], v[76:79]
  ds_read_b64_tr_b16 a[108:109], v245 offset:24576
  ds_read_b64_tr_b16 a[110:111], v245 offset:28672
  v_mfma_f32_16x16x32_bf16 v[92:95], a[84:87], a[52:55], v[92:95]
  ds_read_b64_tr_b16 a[80:81], v242 offset:34816
  ds_read_b64_tr_b16 a[82:83], v242 offset:38912
  v_mfma_f32_16x16x32_bf16 v[80:83], a[88:91], a[48:51], v[80:83]
  buffer_load_dwordx4 a[32:35], v240, s[4:7], s16 offen offset:0 sc1
  v_mfma_f32_16x16x32_bf16 v[96:99], a[88:91], a[52:55], v[96:99]
  ds_read_b64_tr_b16 a[84:85], v243 offset:34816
  ds_read_b64_tr_b16 a[86:87], v243 offset:38912
  v_mfma_f32_16x16x32_bf16 v[84:87], a[92:95], a[48:51], v[84:87]
  ds_read_b64_tr_b16 a[88:89], v244 offset:34816
  ds_read_b64_tr_b16 a[90:91], v244 offset:38912
  v_mfma_f32_16x16x32_bf16 v[100:103], a[92:95], a[52:55], v[100:103]
  ds_read_b64_tr_b16 a[92:93], v245 offset:34816
  ds_read_b64_tr_b16 a[94:95], v245 offset:38912
  v_mfma_f32_16x16x32_bf16 v[72:75], a[112:115], a[56:59], v[72:75]
  buffer_load_dwordx4 v226, s[8:11], s17 offen offset:1024 lds
  v_mfma_f32_16x16x32_bf16 v[88:91], a[112:115], a[60:63], v[88:91]
  ds_read_b64_tr_b16 a[112:113], v242 offset:43008
  ds_read_b64_tr_b16 a[114:115], v242 offset:47104
  v_mfma_f32_16x16x32_bf16 v[76:79], a[116:119], a[56:59], v[76:79]
  v_mfma_f32_16x16x32_bf16 v[92:95], a[116:119], a[60:63], v[92:95]
  ds_read_b64_tr_b16 a[116:117], v243 offset:43008
  ds_read_b64_tr_b16 a[118:119], v243 offset:47104
  v_mfma_f32_16x16x32_bf16 v[80:83], a[120:123], a[56:59], v[80:83]
  buffer_load_dwordx4 a[36:39], v240, s[4:7], s16 offen offset:1024 sc1
  v_mfma_f32_16x16x32_bf16 v[96:99], a[120:123], a[60:63], v[96:99]
  ds_read_b64_tr_b16 a[120:121], v244 offset:43008
  ds_read_b64_tr_b16 a[122:123], v244 offset:47104
  v_mfma_f32_16x16x32_bf16 v[84:87], a[124:127], a[56:59], v[84:87]
  v_mfma_f32_16x16x32_bf16 v[100:103], a[124:127], a[60:63], v[100:103]
  ds_read_b64_tr_b16 a[124:125], v245 offset:43008
  ds_read_b64_tr_b16 a[126:127], v245 offset:47104
  v_mfma_f32_16x16x32_bf16 v[16:19], a[64:67], a[48:51], v[16:19]
  buffer_load_dwordx4 v227, s[8:11], s17 offen offset:2048 lds
  v_mfma_f32_16x16x32_bf16 v[32:35], a[64:67], a[52:55], v[32:35]
  ds_read_b64_tr_b16 a[64:65], v242 offset:32768
  ds_read_b64_tr_b16 a[66:67], v242 offset:36864
  s_waitcnt lgkmcnt(10)
  v_mfma_f32_16x16x32_bf16 v[20:23], a[68:71], a[48:51], v[20:23]
  v_mfma_f32_16x16x32_bf16 v[36:39], a[68:71], a[52:55], v[36:39]
  ds_read_b64_tr_b16 a[68:69], v243 offset:32768
  ds_read_b64_tr_b16 a[70:71], v243 offset:36864
  v_mfma_f32_16x16x32_bf16 v[24:27], a[72:75], a[48:51], v[24:27]
  buffer_load_dwordx4 a[40:43], v241, s[4:7], s16 offen offset:0 sc1
  v_mfma_f32_16x16x32_bf16 v[40:43], a[72:75], a[52:55], v[40:43]
  ds_read_b64_tr_b16 a[72:73], v244 offset:32768
  ds_read_b64_tr_b16 a[74:75], v244 offset:36864
  v_mfma_f32_16x16x32_bf16 v[28:31], a[76:79], a[48:51], v[28:31]
  v_mfma_f32_16x16x32_bf16 v[44:47], a[76:79], a[52:55], v[44:47]
  ds_read_b64_tr_b16 a[76:77], v245 offset:32768
  ds_read_b64_tr_b16 a[78:79], v245 offset:36864
  v_mfma_f32_16x16x32_bf16 v[16:19], a[96:99], a[56:59], v[16:19]
  buffer_load_dwordx4 v228, s[8:11], s17 offen offset:3072 lds
  v_mfma_f32_16x16x32_bf16 v[32:35], a[96:99], a[60:63], v[32:35]
  ds_read_b64_tr_b16 a[96:97], v242 offset:40960
  s_mov_b32 s17, s97
  v_mfma_f32_16x16x32_bf16 v[20:23], a[100:103], a[56:59], v[20:23]
  ds_read_b64_tr_b16 a[98:99], v242 offset:45056
  v_mfma_f32_16x16x32_bf16 v[36:39], a[100:103], a[60:63], v[36:39]
  buffer_load_dwordx4 a[44:47], v241, s[4:7], s16 offen offset:1024 sc1
  v_mfma_f32_16x16x32_bf16 v[24:27], a[104:107], a[56:59], v[24:27]
  ds_read_b64_tr_b16 a[100:101], v243 offset:40960
  s_add_u32 s41, s41, 262144
  v_mfma_f32_16x16x32_bf16 v[40:43], a[104:107], a[60:63], v[40:43]
  ds_read_b64_tr_b16 a[102:103], v243 offset:45056
  s_bitset0_b32 s41, 21
  v_mfma_f32_16x16x32_bf16 v[28:31], a[108:111], a[56:59], v[28:31]
  ds_read_b64_tr_b16 a[104:105], v244 offset:40960
  s_add_u32 s16, s40, s41
  v_mfma_f32_16x16x32_bf16 v[44:47], a[108:111], a[60:63], v[44:47]
  s_waitcnt vmcnt(16) lgkmcnt(10)
  s_barrier
  v_mfma_f32_16x16x32_bf16 v[72:75], a[80:83], a[0:3], v[72:75]
  ds_read_b64_tr_b16 a[106:107], v244 offset:45056
  s_add_u32 m0, s38, 98304
  v_mfma_f32_16x16x32_bf16 v[88:91], a[80:83], a[4:7], v[88:91]
  buffer_load_dwordx4 v227, s[8:11], s17 offen offset:2048 lds
  v_mfma_f32_16x16x32_bf16 v[76:79], a[84:87], a[0:3], v[76:79]
  ds_read_b64_tr_b16 a[108:109], v245 offset:40960
  ds_read_b64_tr_b16 a[110:111], v245 offset:45056
  v_mfma_f32_16x16x32_bf16 v[92:95], a[84:87], a[4:7], v[92:95]
  ds_read_b64_tr_b16 a[80:81], v242 offset:51200
  ds_read_b64_tr_b16 a[82:83], v242 offset:55296
  v_mfma_f32_16x16x32_bf16 v[80:83], a[88:91], a[0:3], v[80:83]
  buffer_load_dwordx4 a[48:51], v240, s[4:7], s16 offen offset:0 sc1
  v_mfma_f32_16x16x32_bf16 v[96:99], a[88:91], a[4:7], v[96:99]
  ds_read_b64_tr_b16 a[84:85], v243 offset:51200
  ds_read_b64_tr_b16 a[86:87], v243 offset:55296
  v_mfma_f32_16x16x32_bf16 v[84:87], a[92:95], a[0:3], v[84:87]
  ds_read_b64_tr_b16 a[88:89], v244 offset:51200
  ds_read_b64_tr_b16 a[90:91], v244 offset:55296
  v_mfma_f32_16x16x32_bf16 v[100:103], a[92:95], a[4:7], v[100:103]
  ds_read_b64_tr_b16 a[92:93], v245 offset:51200
  ds_read_b64_tr_b16 a[94:95], v245 offset:55296
  v_mfma_f32_16x16x32_bf16 v[72:75], a[112:115], a[8:11], v[72:75]
  buffer_load_dwordx4 v228, s[8:11], s17 offen offset:3072 lds
  v_mfma_f32_16x16x32_bf16 v[88:91], a[112:115], a[12:15], v[88:91]
  ds_read_b64_tr_b16 a[112:113], v242 offset:59392
  s_add_u32 s17, s17, 917504
  v_mfma_f32_16x16x32_bf16 v[76:79], a[116:119], a[8:11], v[76:79]
  ds_read_b64_tr_b16 a[114:115], v242 offset:63488
  v_mfma_f32_16x16x32_bf16 v[92:95], a[116:119], a[12:15], v[92:95]
  ds_read_b64_tr_b16 a[116:117], v243 offset:59392
  ds_read_b64_tr_b16 a[118:119], v243 offset:63488
  v_mfma_f32_16x16x32_bf16 v[80:83], a[120:123], a[8:11], v[80:83]
  buffer_load_dwordx4 a[52:55], v240, s[4:7], s16 offen offset:1024 sc1
  v_mfma_f32_16x16x32_bf16 v[96:99], a[120:123], a[12:15], v[96:99]
  ds_read_b64_tr_b16 a[120:121], v244 offset:59392
  s_add_u32 m0, s38, 96256
  v_mfma_f32_16x16x32_bf16 v[84:87], a[124:127], a[8:11], v[84:87]
  ds_read_b64_tr_b16 a[122:123], v244 offset:63488
  v_mfma_f32_16x16x32_bf16 v[100:103], a[124:127], a[12:15], v[100:103]
  ds_read_b64_tr_b16 a[124:125], v245 offset:59392
  ds_read_b64_tr_b16 a[126:127], v245 offset:63488
  v_mfma_f32_16x16x32_bf16 v[16:19], a[64:67], a[0:3], v[16:19]
  buffer_load_dwordx4 v227, s[8:11], s17 offen offset:2048 lds
  v_mfma_f32_16x16x32_bf16 v[32:35], a[64:67], a[4:7], v[32:35]
  ds_read_b64_tr_b16 a[64:65], v242 offset:49152
  ds_read_b64_tr_b16 a[66:67], v242 offset:53248
  s_waitcnt lgkmcnt(10)
  v_mfma_f32_16x16x32_bf16 v[20:23], a[68:71], a[0:3], v[20:23]
  v_mfma_f32_16x16x32_bf16 v[36:39], a[68:71], a[4:7], v[36:39]
  ds_read_b64_tr_b16 a[68:69], v243 offset:49152
  ds_read_b64_tr_b16 a[70:71], v243 offset:53248
  v_mfma_f32_16x16x32_bf16 v[24:27], a[72:75], a[0:3], v[24:27]
  buffer_load_dwordx4 a[56:59], v241, s[4:7], s16 offen offset:0 sc1
  v_mfma_f32_16x16x32_bf16 v[40:43], a[72:75], a[4:7], v[40:43]
  ds_read_b64_tr_b16 a[72:73], v244 offset:49152
  ds_read_b64_tr_b16 a[74:75], v244 offset:53248
  v_mfma_f32_16x16x32_bf16 v[28:31], a[76:79], a[0:3], v[28:31]
  v_mfma_f32_16x16x32_bf16 v[44:47], a[76:79], a[4:7], v[44:47]
  ds_read_b64_tr_b16 a[76:77], v245 offset:49152
  ds_read_b64_tr_b16 a[78:79], v245 offset:53248
  v_mfma_f32_16x16x32_bf16 v[16:19], a[96:99], a[8:11], v[16:19]
  buffer_load_dwordx4 v228, s[8:11], s17 offen offset:3072 lds
  v_mfma_f32_16x16x32_bf16 v[32:35], a[96:99], a[12:15], v[32:35]
  ds_read_b64_tr_b16 a[96:97], v242 offset:57344
  s_add_u32 s17, s17, 917504
  v_mfma_f32_16x16x32_bf16 v[20:23], a[100:103], a[8:11], v[20:23]
  ds_read_b64_tr_b16 a[98:99], v242 offset:61440
  v_mfma_f32_16x16x32_bf16 v[36:39], a[100:103], a[12:15], v[36:39]
  ds_read_b64_tr_b16 a[100:101], v243 offset:57344
  ds_read_b64_tr_b16 a[102:103], v243 offset:61440
  v_mfma_f32_16x16x32_bf16 v[24:27], a[104:107], a[8:11], v[24:27]
  buffer_load_dwordx4 a[60:63], v241, s[4:7], s16 offen offset:1024 sc1
  v_mfma_f32_16x16x32_bf16 v[40:43], a[104:107], a[12:15], v[40:43]
  ds_read_b64_tr_b16 a[104:105], v244 offset:57344
  s_add_u32 s16, s40, 2097152
  v_mfma_f32_16x16x32_bf16 v[28:31], a[108:111], a[8:11], v[28:31]
  ds_read_b64_tr_b16 a[106:107], v244 offset:61440
  v_mfma_f32_16x16x32_bf16 v[44:47], a[108:111], a[12:15], v[44:47]
  s_waitcnt vmcnt(16) lgkmcnt(10)
  s_barrier
  v_mfma_f32_16x16x32_bf16 v[72:75], a[80:83], a[16:19], v[72:75]
  buffer_load_dwordx4 v[128:131], v240, s[4:7], s16 offen offset:0 sc1
  v_mfma_f32_16x16x32_bf16 v[88:91], a[80:83], a[20:23], v[88:91]
  ds_read_b64_tr_b16 a[108:109], v245 offset:57344
  ds_read_b64_tr_b16 a[110:111], v245 offset:61440
  v_mfma_f32_16x16x32_bf16 v[76:79], a[84:87], a[16:19], v[76:79]
  ds_read_b64_tr_b16 a[80:81], v104 offset:2048
  ds_read_b64_tr_b16 a[82:83], v104 offset:6144
  v_mfma_f32_16x16x32_bf16 v[92:95], a[84:87], a[20:23], v[92:95]
  buffer_load_dwordx4 v[132:135], v240, s[4:7], s16 offen offset:1024 sc1
  v_mfma_f32_16x16x32_bf16 v[80:83], a[88:91], a[16:19], v[80:83]
  ds_read_b64_tr_b16 a[84:85], v105 offset:2048
  ds_read_b64_tr_b16 a[86:87], v105 offset:6144
  v_mfma_f32_16x16x32_bf16 v[96:99], a[88:91], a[20:23], v[96:99]
  ds_read_b64_tr_b16 a[88:89], v106 offset:2048
  ds_read_b64_tr_b16 a[90:91], v106 offset:6144
  v_mfma_f32_16x16x32_bf16 v[84:87], a[92:95], a[16:19], v[84:87]
  v_mfma_f32_16x16x32_bf16 v[100:103], a[92:95], a[20:23], v[100:103]
  buffer_load_dwordx4 v[136:139], v241, s[4:7], s16 offen offset:0 sc1
  v_mfma_f32_16x16x32_bf16 v[72:75], a[112:115], a[24:27], v[72:75]
  ds_read_b64_tr_b16 a[92:93], v107 offset:2048
  ds_read_b64_tr_b16 a[94:95], v107 offset:6144
  v_mfma_f32_16x16x32_bf16 v[88:91], a[112:115], a[28:31], v[88:91]
  ds_read_b64_tr_b16 a[112:113], v104 offset:10240
  ds_read_b64_tr_b16 a[114:115], v104 offset:14336
  v_mfma_f32_16x16x32_bf16 v[76:79], a[116:119], a[24:27], v[76:79]
  v_mfma_f32_16x16x32_bf16 v[92:95], a[116:119], a[28:31], v[92:95]
  buffer_load_dwordx4 v[140:143], v241, s[4:7], s16 offen offset:1024 sc1
  v_mfma_f32_16x16x32_bf16 v[80:83], a[120:123], a[24:27], v[80:83]
  ds_read_b64_tr_b16 a[116:117], v105 offset:10240
  s_add_u32 s16, s16, 262144
  v_mfma_f32_16x16x32_bf16 v[96:99], a[120:123], a[28:31], v[96:99]
  ds_read_b64_tr_b16 a[118:119], v105 offset:14336
  ds_read_b64_tr_b16 a[120:121], v106 offset:10240
  v_mfma_f32_16x16x32_bf16 v[84:87], a[124:127], a[24:27], v[84:87]
  ds_read_b64_tr_b16 a[122:123], v106 offset:14336
  v_mfma_f32_16x16x32_bf16 v[100:103], a[124:127], a[28:31], v[100:103]
  buffer_load_dwordx4 v[144:147], v240, s[4:7], s16 offen offset:0 sc1
  v_mfma_f32_16x16x32_bf16 v[16:19], a[64:67], a[16:19], v[16:19]
  ds_read_b64_tr_b16 a[124:125], v107 offset:10240
  ds_read_b64_tr_b16 a[126:127], v107 offset:14336
  v_mfma_f32_16x16x32_bf16 v[32:35], a[64:67], a[20:23], v[32:35]
  ds_read_b64_tr_b16 a[64:65], v104 offset:0
  ds_read_b64_tr_b16 a[66:67], v104 offset:4096
  v_mfma_f32_16x16x32_bf16 v[20:23], a[68:71], a[16:19], v[20:23]
  v_mfma_f32_16x16x32_bf16 v[36:39], a[68:71], a[20:23], v[36:39]
  buffer_load_dwordx4 v[148:151], v240, s[4:7], s16 offen offset:1024 sc1
  s_waitcnt lgkmcnt(10)
  v_mfma_f32_16x16x32_bf16 v[24:27], a[72:75], a[16:19], v[24:27]
  ds_read_b64_tr_b16 a[68:69], v105 offset:0
  ds_read_b64_tr_b16 a[70:71], v105 offset:4096
  v_mfma_f32_16x16x32_bf16 v[40:43], a[72:75], a[20:23], v[40:43]
  ds_read_b64_tr_b16 a[72:73], v106 offset:0
  ds_read_b64_tr_b16 a[74:75], v106 offset:4096
  v_mfma_f32_16x16x32_bf16 v[28:31], a[76:79], a[16:19], v[28:31]
  v_mfma_f32_16x16x32_bf16 v[44:47], a[76:79], a[20:23], v[44:47]
  buffer_load_dwordx4 v[152:155], v241, s[4:7], s16 offen offset:0 sc1
  v_mfma_f32_16x16x32_bf16 v[16:19], a[96:99], a[24:27], v[16:19]
  ds_read_b64_tr_b16 a[76:77], v107 offset:0
  ds_read_b64_tr_b16 a[78:79], v107 offset:4096
  v_mfma_f32_16x16x32_bf16 v[32:35], a[96:99], a[28:31], v[32:35]
  ds_read_b64_tr_b16 a[96:97], v104 offset:8192
  ds_read_b64_tr_b16 a[98:99], v104 offset:12288
  v_mfma_f32_16x16x32_bf16 v[20:23], a[100:103], a[24:27], v[20:23]
  v_mfma_f32_16x16x32_bf16 v[36:39], a[100:103], a[28:31], v[36:39]
  buffer_load_dwordx4 v[156:159], v241, s[4:7], s16 offen offset:1024 sc1
  v_mfma_f32_16x16x32_bf16 v[24:27], a[104:107], a[24:27], v[24:27]
  ds_read_b64_tr_b16 a[100:101], v105 offset:8192
  s_add_u32 s16, s16, 262144
  v_mfma_f32_16x16x32_bf16 v[40:43], a[104:107], a[28:31], v[40:43]
  ds_read_b64_tr_b16 a[102:103], v105 offset:12288
  ds_read_b64_tr_b16 a[104:105], v106 offset:8192
  v_mfma_f32_16x16x32_bf16 v[28:31], a[108:111], a[24:27], v[28:31]
  ds_read_b64_tr_b16 a[106:107], v106 offset:12288
  v_mfma_f32_16x16x32_bf16 v[44:47], a[108:111], a[28:31], v[44:47]
  s_waitcnt vmcnt(16) lgkmcnt(10)
  s_barrier
  v_mfma_f32_16x16x32_bf16 v[72:75], a[80:83], a[32:35], v[72:75]
  ds_read_b64_tr_b16 a[108:109], v107 offset:8192
  s_add_u32 m0, s38, 114688
  v_mfma_f32_16x16x32_bf16 v[88:91], a[80:83], a[36:39], v[88:91]
  buffer_load_dwordx4 v227, s[8:11], s17 offen offset:2048 lds
  v_mfma_f32_16x16x32_bf16 v[76:79], a[84:87], a[32:35], v[76:79]
  ds_read_b64_tr_b16 a[110:111], v107 offset:12288
  ds_read_b64_tr_b16 a[80:81], v104 offset:18432
  v_mfma_f32_16x16x32_bf16 v[92:95], a[84:87], a[36:39], v[92:95]
  buffer_load_dwordx4 v[160:163], v240, s[4:7], s16 offen offset:0 sc1
  v_mfma_f32_16x16x32_bf16 v[80:83], a[88:91], a[32:35], v[80:83]
  ds_read_b64_tr_b16 a[82:83], v104 offset:22528
  ds_read_b64_tr_b16 a[84:85], v105 offset:18432
  v_mfma_f32_16x16x32_bf16 v[96:99], a[88:91], a[36:39], v[96:99]
  ds_read_b64_tr_b16 a[86:87], v105 offset:22528
  ds_read_b64_tr_b16 a[88:89], v106 offset:18432
  v_mfma_f32_16x16x32_bf16 v[84:87], a[92:95], a[32:35], v[84:87]
  buffer_load_dwordx4 v228, s[8:11], s17 offen offset:3072 lds
  v_mfma_f32_16x16x32_bf16 v[100:103], a[92:95], a[36:39], v[100:103]
  ds_read_b64_tr_b16 a[90:91], v106 offset:22528
  s_add_u32 s17, s17, 917504
  v_mfma_f32_16x16x32_bf16 v[72:75], a[112:115], a[40:43], v[72:75]
  buffer_load_dwordx4 v[164:167], v240, s[4:7], s16 offen offset:1024 sc1
  v_mfma_f32_16x16x32_bf16 v[88:91], a[112:115], a[44:47], v[88:91]
  ds_read_b64_tr_b16 a[92:93], v107 offset:18432
  s_add_u32 m0, s38, 112640
  v_mfma_f32_16x16x32_bf16 v[76:79], a[116:119], a[40:43], v[76:79]
  ds_read_b64_tr_b16 a[94:95], v107 offset:22528
  ds_read_b64_tr_b16 a[112:113], v104 offset:26624
  v_mfma_f32_16x16x32_bf16 v[92:95], a[116:119], a[44:47], v[92:95]
  buffer_load_dwordx4 v227, s[8:11], s17 offen offset:2048 lds
  v_mfma_f32_16x16x32_bf16 v[80:83], a[120:123], a[40:43], v[80:83]
  ds_read_b64_tr_b16 a[114:115], v104 offset:30720
  ds_read_b64_tr_b16 a[116:117], v105 offset:26624
  v_mfma_f32_16x16x32_bf16 v[96:99], a[120:123], a[44:47], v[96:99]
  buffer_load_dwordx4 v[168:171], v241, s[4:7], s16 offen offset:0 sc1
  v_mfma_f32_16x16x32_bf16 v[84:87], a[124:127], a[40:43], v[84:87]
  ds_read_b64_tr_b16 a[118:119], v105 offset:30720
  ds_read_b64_tr_b16 a[120:121], v106 offset:26624
  v_mfma_f32_16x16x32_bf16 v[100:103], a[124:127], a[44:47], v[100:103]
  ds_read_b64_tr_b16 a[122:123], v106 offset:30720
  ds_read_b64_tr_b16 a[124:125], v107 offset:26624
  v_mfma_f32_16x16x32_bf16 v[16:19], a[64:67], a[32:35], v[16:19]
  buffer_load_dwordx4 v228, s[8:11], s17 offen offset:3072 lds
  v_mfma_f32_16x16x32_bf16 v[32:35], a[64:67], a[36:39], v[32:35]
  ds_read_b64_tr_b16 a[126:127], v107 offset:30720
  s_mov_b32 s17, s97
  v_mfma_f32_16x16x32_bf16 v[20:23], a[68:71], a[32:35], v[20:23]
  ds_read_b64_tr_b16 a[64:65], v104 offset:16384
  ds_read_b64_tr_b16 a[66:67], v104 offset:20480
  v_mfma_f32_16x16x32_bf16 v[36:39], a[68:71], a[36:39], v[36:39]
  buffer_load_dwordx4 v[172:175], v241, s[4:7], s16 offen offset:1024 sc1
  s_waitcnt lgkmcnt(10)
  v_mfma_f32_16x16x32_bf16 v[24:27], a[72:75], a[32:35], v[24:27]
  ds_read_b64_tr_b16 a[68:69], v105 offset:16384
  s_add_u32 s16, s16, 262144
  v_mfma_f32_16x16x32_bf16 v[40:43], a[72:75], a[36:39], v[40:43]
  buffer_load_dwordx4 v[176:179], v240, s[4:7], s16 offen offset:0 sc1
  v_mfma_f32_16x16x32_bf16 v[28:31], a[76:79], a[32:35], v[28:31]
  ds_read_b64_tr_b16 a[70:71], v105 offset:20480
  ds_read_b64_tr_b16 a[72:73], v106 offset:16384
  v_mfma_f32_16x16x32_bf16 v[44:47], a[76:79], a[36:39], v[44:47]
  ds_read_b64_tr_b16 a[74:75], v106 offset:20480
  ds_read_b64_tr_b16 a[76:77], v107 offset:16384
  v_mfma_f32_16x16x32_bf16 v[16:19], a[96:99], a[40:43], v[16:19]
  buffer_load_dwordx4 v[180:183], v240, s[4:7], s16 offen offset:1024 sc1
  v_mfma_f32_16x16x32_bf16 v[32:35], a[96:99], a[44:47], v[32:35]
  ds_read_b64_tr_b16 a[78:79], v107 offset:20480
  ds_read_b64_tr_b16 a[96:97], v104 offset:24576
  v_mfma_f32_16x16x32_bf16 v[20:23], a[100:103], a[40:43], v[20:23]
  buffer_load_dwordx4 v[184:187], v241, s[4:7], s16 offen offset:0 sc1
  v_mfma_f32_16x16x32_bf16 v[36:39], a[100:103], a[44:47], v[36:39]
  ds_read_b64_tr_b16 a[98:99], v104 offset:28672
  ds_read_b64_tr_b16 a[100:101], v105 offset:24576
  v_mfma_f32_16x16x32_bf16 v[24:27], a[104:107], a[40:43], v[24:27]
  ds_read_b64_tr_b16 a[102:103], v105 offset:28672
  v_mfma_f32_16x16x32_bf16 v[40:43], a[104:107], a[44:47], v[40:43]
  buffer_load_dwordx4 v[188:191], v241, s[4:7], s16 offen offset:1024 sc1
  v_mfma_f32_16x16x32_bf16 v[28:31], a[108:111], a[40:43], v[28:31]
  ds_read_b64_tr_b16 a[104:105], v106 offset:24576
  s_add_u32 s16, s16, 262144
  v_mfma_f32_16x16x32_bf16 v[44:47], a[108:111], a[44:47], v[44:47]
  s_waitcnt vmcnt(20) lgkmcnt(10)
  s_barrier
  v_mfma_f32_16x16x32_bf16 v[72:75], a[80:83], a[48:51], v[72:75]
  ds_read_b64_tr_b16 a[106:107], v106 offset:28672
  s_add_u32 m0, s38, 133120
  v_mfma_f32_16x16x32_bf16 v[88:91], a[80:83], a[52:55], v[88:91]
  buffer_load_dwordx4 v225, s[8:11], s17 offen offset:0 lds
  v_mfma_f32_16x16x32_bf16 v[76:79], a[84:87], a[48:51], v[76:79]
  ds_read_b64_tr_b16 a[108:109], v107 offset:24576
  ds_read_b64_tr_b16 a[110:111], v107 offset:28672
  v_mfma_f32_16x16x32_bf16 v[92:95], a[84:87], a[52:55], v[92:95]
  ds_read_b64_tr_b16 a[80:81], v104 offset:34816
  ds_read_b64_tr_b16 a[82:83], v104 offset:38912
  v_mfma_f32_16x16x32_bf16 v[80:83], a[88:91], a[48:51], v[80:83]
  ds_read_b64_tr_b16 a[84:85], v105 offset:34816
  ds_read_b64_tr_b16 a[86:87], v105 offset:38912
  v_mfma_f32_16x16x32_bf16 v[96:99], a[88:91], a[52:55], v[96:99]
  ds_read_b64_tr_b16 a[88:89], v106 offset:34816
  ds_read_b64_tr_b16 a[90:91], v106 offset:38912
  v_mfma_f32_16x16x32_bf16 v[84:87], a[92:95], a[48:51], v[84:87]
  v_mfma_f32_16x16x32_bf16 v[100:103], a[92:95], a[52:55], v[100:103]
  ds_read_b64_tr_b16 a[92:93], v107 offset:34816
  ds_read_b64_tr_b16 a[94:95], v107 offset:38912
  v_mfma_f32_16x16x32_bf16 v[72:75], a[112:115], a[56:59], v[72:75]
  buffer_load_dwordx4 v226, s[8:11], s17 offen offset:1024 lds
  v_mfma_f32_16x16x32_bf16 v[88:91], a[112:115], a[60:63], v[88:91]
  ds_read_b64_tr_b16 a[112:113], v104 offset:43008
  s_add_u32 s17, s17, 917504
  v_mfma_f32_16x16x32_bf16 v[76:79], a[116:119], a[56:59], v[76:79]
  ds_read_b64_tr_b16 a[114:115], v104 offset:47104
  s_add_u32 m0, s38, 131072
  v_mfma_f32_16x16x32_bf16 v[92:95], a[116:119], a[60:63], v[92:95]
  ds_read_b64_tr_b16 a[116:117], v105 offset:43008
  ds_read_b64_tr_b16 a[118:119], v105 offset:47104
  v_mfma_f32_16x16x32_bf16 v[80:83], a[120:123], a[56:59], v[80:83]
  v_mfma_f32_16x16x32_bf16 v[96:99], a[120:123], a[60:63], v[96:99]
  ds_read_b64_tr_b16 a[120:121], v106 offset:43008
  ds_read_b64_tr_b16 a[122:123], v106 offset:47104
  v_mfma_f32_16x16x32_bf16 v[84:87], a[124:127], a[56:59], v[84:87]
  v_mfma_f32_16x16x32_bf16 v[100:103], a[124:127], a[60:63], v[100:103]
  ds_read_b64_tr_b16 a[124:125], v107 offset:43008
  ds_read_b64_tr_b16 a[126:127], v107 offset:47104
  v_mfma_f32_16x16x32_bf16 v[16:19], a[64:67], a[48:51], v[16:19]
  buffer_load_dwordx4 v225, s[8:11], s17 offen offset:0 lds
  v_mfma_f32_16x16x32_bf16 v[32:35], a[64:67], a[52:55], v[32:35]
  ds_read_b64_tr_b16 a[64:65], v104 offset:32768
  ds_read_b64_tr_b16 a[66:67], v104 offset:36864
  s_waitcnt lgkmcnt(10)
  v_mfma_f32_16x16x32_bf16 v[20:23], a[68:71], a[48:51], v[20:23]
  v_mfma_f32_16x16x32_bf16 v[36:39], a[68:71], a[52:55], v[36:39]
  ds_read_b64_tr_b16 a[68:69], v105 offset:32768
  ds_read_b64_tr_b16 a[70:71], v105 offset:36864
  v_mfma_f32_16x16x32_bf16 v[24:27], a[72:75], a[48:51], v[24:27]
  v_mfma_f32_16x16x32_bf16 v[40:43], a[72:75], a[52:55], v[40:43]
  ds_read_b64_tr_b16 a[72:73], v106 offset:32768
  ds_read_b64_tr_b16 a[74:75], v106 offset:36864
  v_mfma_f32_16x16x32_bf16 v[28:31], a[76:79], a[48:51], v[28:31]
  v_mfma_f32_16x16x32_bf16 v[44:47], a[76:79], a[52:55], v[44:47]
  ds_read_b64_tr_b16 a[76:77], v107 offset:32768
  ds_read_b64_tr_b16 a[78:79], v107 offset:36864
  v_mfma_f32_16x16x32_bf16 v[16:19], a[96:99], a[56:59], v[16:19]
  buffer_load_dwordx4 v226, s[8:11], s17 offen offset:1024 lds
  v_mfma_f32_16x16x32_bf16 v[32:35], a[96:99], a[60:63], v[32:35]
  ds_read_b64_tr_b16 a[96:97], v104 offset:40960
  s_add_u32 s17, s17, 917504
  v_mfma_f32_16x16x32_bf16 v[20:23], a[100:103], a[56:59], v[20:23]
  ds_read_b64_tr_b16 a[98:99], v104 offset:45056
  v_mfma_f32_16x16x32_bf16 v[36:39], a[100:103], a[60:63], v[36:39]
  ds_read_b64_tr_b16 a[100:101], v105 offset:40960
  ds_read_b64_tr_b16 a[102:103], v105 offset:45056
  v_mfma_f32_16x16x32_bf16 v[24:27], a[104:107], a[56:59], v[24:27]
  v_mfma_f32_16x16x32_bf16 v[40:43], a[104:107], a[60:63], v[40:43]
  ds_read_b64_tr_b16 a[104:105], v106 offset:40960
  ds_read_b64_tr_b16 a[106:107], v106 offset:45056
  v_mfma_f32_16x16x32_bf16 v[28:31], a[108:111], a[56:59], v[28:31]
  v_mfma_f32_16x16x32_bf16 v[44:47], a[108:111], a[60:63], v[44:47]
  s_waitcnt vmcnt(9) lgkmcnt(10)
  s_barrier
  v_swap_b32 v130, v132
  v_swap_b32 v131, v133
  v_swap_b32 v138, v140
  v_swap_b32 v139, v141
  v_swap_b32 v146, v148
  v_swap_b32 v147, v149
  v_swap_b32 v154, v156
  v_swap_b32 v155, v157
  s_nop 1
  v_mfma_f32_16x16x32_bf16 v[72:75], a[80:83], v[128:131], v[72:75]
  ds_read_b64_tr_b16 a[108:109], v107 offset:40960
  s_add_u32 m0, s38, 2048
  v_mfma_f32_16x16x32_bf16 v[88:91], a[80:83], v[132:135], v[88:91]
  buffer_load_dwordx4 v225, s[8:11], s17 offen offset:0 lds
  v_mfma_f32_16x16x32_bf16 v[76:79], a[84:87], v[128:131], v[76:79]
  ds_read_b64_tr_b16 a[110:111], v107 offset:45056
  ds_read_b64_tr_b16 a[80:81], v104 offset:51200
  v_mfma_f32_16x16x32_bf16 v[92:95], a[84:87], v[132:135], v[92:95]
  ds_read_b64_tr_b16 a[82:83], v104 offset:55296
  ds_read_b64_tr_b16 a[84:85], v105 offset:51200
  v_mfma_f32_16x16x32_bf16 v[80:83], a[88:91], v[128:131], v[80:83]
  ds_read_b64_tr_b16 a[86:87], v105 offset:55296
  v_mfma_f32_16x16x32_bf16 v[96:99], a[88:91], v[132:135], v[96:99]
  ds_read_b64_tr_b16 a[88:89], v106 offset:51200
  ds_read_b64_tr_b16 a[90:91], v106 offset:55296
  v_mfma_f32_16x16x32_bf16 v[84:87], a[92:95], v[128:131], v[84:87]
  v_mfma_f32_16x16x32_bf16 v[100:103], a[92:95], v[132:135], v[100:103]
  ds_read_b64_tr_b16 a[92:93], v107 offset:51200
  ds_read_b64_tr_b16 a[94:95], v107 offset:55296
  v_mfma_f32_16x16x32_bf16 v[72:75], a[112:115], v[136:139], v[72:75]
  buffer_load_dwordx4 v226, s[8:11], s17 offen offset:1024 lds
  v_mfma_f32_16x16x32_bf16 v[88:91], a[112:115], v[140:143], v[88:91]
  ds_read_b64_tr_b16 a[112:113], v104 offset:59392
  s_add_u32 s17, s17, 917504
  v_mfma_f32_16x16x32_bf16 v[76:79], a[116:119], v[136:139], v[76:79]
  ds_read_b64_tr_b16 a[114:115], v104 offset:63488
  s_add_u32 m0, s38, 0
  v_mfma_f32_16x16x32_bf16 v[92:95], a[116:119], v[140:143], v[92:95]
  ds_read_b64_tr_b16 a[116:117], v105 offset:59392
  ds_read_b64_tr_b16 a[118:119], v105 offset:63488
  v_mfma_f32_16x16x32_bf16 v[80:83], a[120:123], v[136:139], v[80:83]
  v_mfma_f32_16x16x32_bf16 v[96:99], a[120:123], v[140:143], v[96:99]
  ds_read_b64_tr_b16 a[120:121], v106 offset:59392
  ds_read_b64_tr_b16 a[122:123], v106 offset:63488
  v_mfma_f32_16x16x32_bf16 v[84:87], a[124:127], v[136:139], v[84:87]
  v_mfma_f32_16x16x32_bf16 v[100:103], a[124:127], v[140:143], v[100:103]
  ds_read_b64_tr_b16 a[124:125], v107 offset:59392
  ds_read_b64_tr_b16 a[126:127], v107 offset:63488
  v_mfma_f32_16x16x32_bf16 v[72:75], a[64:67], v[144:147], v[72:75]
  buffer_load_dwordx4 v225, s[8:11], s17 offen offset:0 lds
  v_mfma_f32_16x16x32_bf16 v[88:91], a[64:67], v[148:151], v[88:91]
  ds_read_b64_tr_b16 a[64:65], v104 offset:49152
  ds_read_b64_tr_b16 a[66:67], v104 offset:53248
  v_mfma_f32_16x16x32_bf16 v[76:79], a[68:71], v[144:147], v[76:79]
  v_mfma_f32_16x16x32_bf16 v[92:95], a[68:71], v[148:151], v[92:95]
  ds_read_b64_tr_b16 a[68:69], v105 offset:49152
  ds_read_b64_tr_b16 a[70:71], v105 offset:53248
  s_waitcnt lgkmcnt(10)
  v_mfma_f32_16x16x32_bf16 v[80:83], a[72:75], v[144:147], v[80:83]
  v_mfma_f32_16x16x32_bf16 v[96:99], a[72:75], v[148:151], v[96:99]
  ds_read_b64_tr_b16 a[72:73], v106 offset:49152
  ds_read_b64_tr_b16 a[74:75], v106 offset:53248
  v_mfma_f32_16x16x32_bf16 v[84:87], a[76:79], v[144:147], v[84:87]
  v_mfma_f32_16x16x32_bf16 v[100:103], a[76:79], v[148:151], v[100:103]
  ds_read_b64_tr_b16 a[76:77], v107 offset:49152
  ds_read_b64_tr_b16 a[78:79], v107 offset:53248
  v_mfma_f32_16x16x32_bf16 v[72:75], a[96:99], v[152:155], v[72:75]
  buffer_load_dwordx4 v226, s[8:11], s17 offen offset:1024 lds
  v_mfma_f32_16x16x32_bf16 v[88:91], a[96:99], v[156:159], v[88:91]
  ds_read_b64_tr_b16 a[96:97], v104 offset:57344
  s_add_u32 s17, s17, 917504
  v_mfma_f32_16x16x32_bf16 v[76:79], a[100:103], v[152:155], v[76:79]
  s_add_u32 s52, s20, 0xe00000
  s_addc_u32 s53, s21, 0
  s_mov_b32 s54, 0x800000
  s_mov_b32 s55, 0x20000
  v_lshlrev_b32 v50, 4, v231
  s_lshl_b32 s36, s2, 2
  s_add_u32 s36, s36, s3
  s_xor_b32 s37, s36, 4
  s_lshl_b32 s39, s37, 13
  s_lshl_b32 s36, s36, 13
  s_mov_b32 s43, 0x8000
  s_mov_b32 s44, s90
  s_mov_b32 s45, s91
  s_mov_b32 s46, 0x400000
  s_mov_b32 s47, 0x20000
  v_mfma_f32_16x16x32_bf16 v[92:95], a[100:103], v[156:159], v[92:95]
  ds_read_b64_tr_b16 a[98:99], v104 offset:61440
  ds_read_b64_tr_b16 a[100:101], v105 offset:57344
  v_mfma_f32_16x16x32_bf16 v[80:83], a[104:107], v[152:155], v[80:83]
  ds_read_b64_tr_b16 a[102:103], v105 offset:61440
  v_mfma_f32_16x16x32_bf16 v[96:99], a[104:107], v[156:159], v[96:99]
  ds_read_b64_tr_b16 a[104:105], v106 offset:57344
  ds_read_b64_tr_b16 a[106:107], v106 offset:61440
  v_mfma_f32_16x16x32_bf16 v[84:87], a[108:111], v[152:155], v[84:87]
  v_mfma_f32_16x16x32_bf16 v[100:103], a[108:111], v[156:159], v[100:103]
  s_waitcnt vmcnt(4) lgkmcnt(10)
  s_barrier
  v_swap_b32 v162, v164
  v_swap_b32 v163, v165
  v_swap_b32 v170, v172
  v_swap_b32 v171, v173
  v_swap_b32 v178, v180
  v_swap_b32 v179, v181
  v_swap_b32 v186, v188
  v_swap_b32 v187, v189
  s_nop 1
  v_mfma_f32_16x16x32_bf16 v[72:75], a[80:83], v[160:163], v[72:75]
  ds_read_b64_tr_b16 a[108:109], v107 offset:57344
  ds_read_b64_tr_b16 a[110:111], v107 offset:61440
  v_mfma_f32_16x16x32_bf16 v[88:91], a[80:83], v[164:167], v[88:91]
  ds_read_b64_tr_b16 a[80:81], v124 offset:2048
  ds_read_b64_tr_b16 a[82:83], v124 offset:6144
  v_mfma_f32_16x16x32_bf16 v[76:79], a[84:87], v[160:163], v[76:79]
  v_mfma_f32_16x16x32_bf16 v[92:95], a[84:87], v[164:167], v[92:95]
  ds_read_b64_tr_b16 a[84:85], v125 offset:2048
  ds_read_b64_tr_b16 a[86:87], v125 offset:6144
  v_mfma_f32_16x16x32_bf16 v[80:83], a[88:91], v[160:163], v[80:83]
  v_mfma_f32_16x16x32_bf16 v[96:99], a[88:91], v[164:167], v[96:99]
  ds_read_b64_tr_b16 a[88:89], v126 offset:2048
  ds_read_b64_tr_b16 a[90:91], v126 offset:6144
  v_mfma_f32_16x16x32_bf16 v[84:87], a[92:95], v[160:163], v[84:87]
  v_mfma_f32_16x16x32_bf16 v[100:103], a[92:95], v[164:167], v[100:103]
  ds_read_b64_tr_b16 a[92:93], v127 offset:2048
  ds_read_b64_tr_b16 a[94:95], v127 offset:6144
  v_mfma_f32_16x16x32_bf16 v[72:75], a[112:115], v[168:171], v[72:75]
  v_mfma_f32_16x16x32_bf16 v[88:91], a[112:115], v[172:175], v[88:91]
  ds_read_b64_tr_b16 a[112:113], v124 offset:10240
  ds_read_b64_tr_b16 a[114:115], v124 offset:14336
  v_mfma_f32_16x16x32_bf16 v[76:79], a[116:119], v[168:171], v[76:79]
  v_mfma_f32_16x16x32_bf16 v[92:95], a[116:119], v[172:175], v[92:95]
  ds_read_b64_tr_b16 a[116:117], v125 offset:10240
  ds_read_b64_tr_b16 a[118:119], v125 offset:14336
  v_mfma_f32_16x16x32_bf16 v[80:83], a[120:123], v[168:171], v[80:83]
  v_mfma_f32_16x16x32_bf16 v[96:99], a[120:123], v[172:175], v[96:99]
  ds_read_b64_tr_b16 a[120:121], v126 offset:10240
  ds_read_b64_tr_b16 a[122:123], v126 offset:14336
  v_mfma_f32_16x16x32_bf16 v[84:87], a[124:127], v[168:171], v[84:87]
  v_mfma_f32_16x16x32_bf16 v[100:103], a[124:127], v[172:175], v[100:103]
  ds_read_b64_tr_b16 a[124:125], v127 offset:10240
  ds_read_b64_tr_b16 a[126:127], v127 offset:14336
  v_mfma_f32_16x16x32_bf16 v[72:75], a[64:67], v[176:179], v[72:75]
  v_mfma_f32_16x16x32_bf16 v[88:91], a[64:67], v[180:183], v[88:91]
  ds_read_b64_tr_b16 a[64:65], v124 offset:0
  ds_read_b64_tr_b16 a[66:67], v124 offset:4096
  v_mfma_f32_16x16x32_bf16 v[76:79], a[68:71], v[176:179], v[76:79]
  v_mfma_f32_16x16x32_bf16 v[92:95], a[68:71], v[180:183], v[92:95]
  ds_read_b64_tr_b16 a[68:69], v125 offset:0
  ds_read_b64_tr_b16 a[70:71], v125 offset:4096
  s_waitcnt lgkmcnt(10)
  v_mfma_f32_16x16x32_bf16 v[80:83], a[72:75], v[176:179], v[80:83]
  v_mfma_f32_16x16x32_bf16 v[96:99], a[72:75], v[180:183], v[96:99]
  ds_read_b64_tr_b16 a[72:73], v126 offset:0
  ds_read_b64_tr_b16 a[74:75], v126 offset:4096
  v_mfma_f32_16x16x32_bf16 v[84:87], a[76:79], v[176:179], v[84:87]
  v_mfma_f32_16x16x32_bf16 v[100:103], a[76:79], v[180:183], v[100:103]
  ds_read_b64_tr_b16 a[76:77], v127 offset:0
  ds_read_b64_tr_b16 a[78:79], v127 offset:4096
  v_mfma_f32_16x16x32_bf16 v[72:75], a[96:99], v[184:187], v[72:75]
  v_mfma_f32_16x16x32_bf16 v[88:91], a[96:99], v[188:191], v[88:91]
  ds_read_b64_tr_b16 a[96:97], v124 offset:8192
  ds_read_b64_tr_b16 a[98:99], v124 offset:12288
  v_mfma_f32_16x16x32_bf16 v[76:79], a[100:103], v[184:187], v[76:79]
  v_mfma_f32_16x16x32_bf16 v[92:95], a[100:103], v[188:191], v[92:95]
  ds_read_b64_tr_b16 a[100:101], v125 offset:8192
  ds_read_b64_tr_b16 a[102:103], v125 offset:12288
  v_mfma_f32_16x16x32_bf16 v[80:83], a[104:107], v[184:187], v[80:83]
  v_mfma_f32_16x16x32_bf16 v[96:99], a[104:107], v[188:191], v[96:99]
  ds_read_b64_tr_b16 a[104:105], v126 offset:8192
  ds_read_b64_tr_b16 a[106:107], v126 offset:12288
  v_mfma_f32_16x16x32_bf16 v[84:87], a[108:111], v[184:187], v[84:87]
  v_mfma_f32_16x16x32_bf16 v[100:103], a[108:111], v[188:191], v[100:103]
  s_waitcnt vmcnt(0) lgkmcnt(10)
  s_barrier
  v_mfma_f32_16x16x32_bf16 v[16:19], a[80:83], v[128:131], v[16:19]
  ds_read_b64_tr_b16 a[108:109], v127 offset:8192
  ds_read_b64_tr_b16 a[110:111], v127 offset:12288
  v_mfma_f32_16x16x32_bf16 v[32:35], a[80:83], v[132:135], v[32:35]
  ds_read_b64_tr_b16 a[80:81], v242 offset:2048
  ds_read_b64_tr_b16 a[82:83], v242 offset:6144
  v_mfma_f32_16x16x32_bf16 v[20:23], a[84:87], v[128:131], v[20:23]
  v_mfma_f32_16x16x32_bf16 v[36:39], a[84:87], v[132:135], v[36:39]
  v_cvt_pk_bf16_f32 v108, v72, v73
  v_cvt_pk_bf16_f32 v109, v74, v75
  v_cvt_pk_bf16_f32 v110, v76, v77
  v_cvt_pk_bf16_f32 v111, v78, v79
  buffer_store_dwordx4 v[108:111], v50, s[52:55], s39 offen offset:0 sc1
  v_mfma_f32_16x16x32_bf16 v[24:27], a[88:91], v[128:131], v[24:27]
  v_cvt_pk_bf16_f32 v116, v88, v89
  v_cvt_pk_bf16_f32 v117, v90, v91
  v_cvt_pk_bf16_f32 v118, v92, v93
  v_cvt_pk_bf16_f32 v119, v94, v95
  buffer_store_dwordx4 v[116:119], v50, s[52:55], s39 offen offset:2048 sc1
  v_mfma_f32_16x16x32_bf16 v[40:43], a[88:91], v[132:135], v[40:43]
  ds_read_b64_tr_b16 a[84:85], v243 offset:2048
  ds_read_b64_tr_b16 a[86:87], v243 offset:6144
  v_mfma_f32_16x16x32_bf16 v[28:31], a[92:95], v[128:131], v[28:31]
  ds_read_b64_tr_b16 a[88:89], v244 offset:2048
  ds_read_b64_tr_b16 a[90:91], v244 offset:6144
  v_mfma_f32_16x16x32_bf16 v[44:47], a[92:95], v[132:135], v[44:47]
  v_cvt_pk_bf16_f32 v112, v80, v81
  v_cvt_pk_bf16_f32 v113, v82, v83
  v_cvt_pk_bf16_f32 v114, v84, v85
  v_cvt_pk_bf16_f32 v115, v86, v87
  buffer_store_dwordx4 v[112:115], v50, s[52:55], s39 offen offset:1024 sc1
  v_mfma_f32_16x16x32_bf16 v[16:19], a[112:115], v[136:139], v[16:19]
  v_cvt_pk_bf16_f32 v120, v96, v97
  v_cvt_pk_bf16_f32 v121, v98, v99
  v_cvt_pk_bf16_f32 v122, v100, v101
  v_cvt_pk_bf16_f32 v123, v102, v103
  buffer_store_dwordx4 v[120:123], v50, s[52:55], s39 offen offset:3072 sc1
  v_mfma_f32_16x16x32_bf16 v[32:35], a[112:115], v[140:143], v[32:35]
  ds_read_b64_tr_b16 a[92:93], v245 offset:2048
  ds_read_b64_tr_b16 a[94:95], v245 offset:6144
  v_mfma_f32_16x16x32_bf16 v[20:23], a[116:119], v[136:139], v[20:23]
  ds_read_b64_tr_b16 a[112:113], v242 offset:10240
  ds_read_b64_tr_b16 a[114:115], v242 offset:14336
  v_mfma_f32_16x16x32_bf16 v[36:39], a[116:119], v[140:143], v[36:39]
  ds_read_b64_tr_b16 a[116:117], v243 offset:10240
  ds_read_b64_tr_b16 a[118:119], v243 offset:14336
  v_mfma_f32_16x16x32_bf16 v[24:27], a[120:123], v[136:139], v[24:27]
  v_mfma_f32_16x16x32_bf16 v[40:43], a[120:123], v[140:143], v[40:43]
  ds_read_b64_tr_b16 a[120:121], v244 offset:10240
  ds_read_b64_tr_b16 a[122:123], v244 offset:14336
  v_mfma_f32_16x16x32_bf16 v[28:31], a[124:127], v[136:139], v[28:31]
  v_mfma_f32_16x16x32_bf16 v[44:47], a[124:127], v[140:143], v[44:47]
  ds_read_b64_tr_b16 a[124:125], v245 offset:10240
  ds_read_b64_tr_b16 a[126:127], v245 offset:14336
  v_mfma_f32_16x16x32_bf16 v[16:19], a[64:67], v[144:147], v[16:19]
  v_mfma_f32_16x16x32_bf16 v[32:35], a[64:67], v[148:151], v[32:35]
  ds_read_b64_tr_b16 a[64:65], v242 offset:0
  ds_read_b64_tr_b16 a[66:67], v242 offset:4096
  v_mfma_f32_16x16x32_bf16 v[20:23], a[68:71], v[144:147], v[20:23]
  v_mfma_f32_16x16x32_bf16 v[36:39], a[68:71], v[148:151], v[36:39]
  ds_read_b64_tr_b16 a[68:69], v243 offset:0
  ds_read_b64_tr_b16 a[70:71], v243 offset:4096
  s_waitcnt lgkmcnt(10)
  v_mfma_f32_16x16x32_bf16 v[24:27], a[72:75], v[144:147], v[24:27]
  v_mfma_f32_16x16x32_bf16 v[40:43], a[72:75], v[148:151], v[40:43]
  ds_read_b64_tr_b16 a[72:73], v244 offset:0
  ds_read_b64_tr_b16 a[74:75], v244 offset:4096
  v_mfma_f32_16x16x32_bf16 v[28:31], a[76:79], v[144:147], v[28:31]
  v_mfma_f32_16x16x32_bf16 v[44:47], a[76:79], v[148:151], v[44:47]
  ds_read_b64_tr_b16 a[76:77], v245 offset:0
  ds_read_b64_tr_b16 a[78:79], v245 offset:4096
  v_mfma_f32_16x16x32_bf16 v[16:19], a[96:99], v[152:155], v[16:19]
  v_mfma_f32_16x16x32_bf16 v[32:35], a[96:99], v[156:159], v[32:35]
  ds_read_b64_tr_b16 a[96:97], v242 offset:8192
  ds_read_b64_tr_b16 a[98:99], v242 offset:12288
  v_mfma_f32_16x16x32_bf16 v[20:23], a[100:103], v[152:155], v[20:23]
  v_mfma_f32_16x16x32_bf16 v[36:39], a[100:103], v[156:159], v[36:39]
  ds_read_b64_tr_b16 a[100:101], v243 offset:8192
  ds_read_b64_tr_b16 a[102:103], v243 offset:12288
  v_mfma_f32_16x16x32_bf16 v[24:27], a[104:107], v[152:155], v[24:27]
  v_mfma_f32_16x16x32_bf16 v[40:43], a[104:107], v[156:159], v[40:43]
  ds_read_b64_tr_b16 a[104:105], v244 offset:8192
  ds_read_b64_tr_b16 a[106:107], v244 offset:12288
  v_mfma_f32_16x16x32_bf16 v[28:31], a[108:111], v[152:155], v[28:31]
  v_mfma_f32_16x16x32_bf16 v[44:47], a[108:111], v[156:159], v[44:47]
  s_waitcnt vmcnt(63) lgkmcnt(10)
  s_barrier
  v_mfma_f32_16x16x32_bf16 v[16:19], a[80:83], v[160:163], v[16:19]
  ds_read_b64_tr_b16 a[108:109], v245 offset:8192
  ds_read_b64_tr_b16 a[110:111], v245 offset:12288
  v_mfma_f32_16x16x32_bf16 v[32:35], a[80:83], v[164:167], v[32:35]
  v_mfma_f32_16x16x32_bf16 v[20:23], a[84:87], v[160:163], v[20:23]
  v_mfma_f32_16x16x32_bf16 v[36:39], a[84:87], v[164:167], v[36:39]
  v_mfma_f32_16x16x32_bf16 v[24:27], a[88:91], v[160:163], v[24:27]
  v_mfma_f32_16x16x32_bf16 v[40:43], a[88:91], v[164:167], v[40:43]
  v_mfma_f32_16x16x32_bf16 v[28:31], a[92:95], v[160:163], v[28:31]
  v_mfma_f32_16x16x32_bf16 v[44:47], a[92:95], v[164:167], v[44:47]
  v_mfma_f32_16x16x32_bf16 v[16:19], a[112:115], v[168:171], v[16:19]
  v_mfma_f32_16x16x32_bf16 v[32:35], a[112:115], v[172:175], v[32:35]
  v_mfma_f32_16x16x32_bf16 v[20:23], a[116:119], v[168:171], v[20:23]
  v_mfma_f32_16x16x32_bf16 v[36:39], a[116:119], v[172:175], v[36:39]
  v_mfma_f32_16x16x32_bf16 v[24:27], a[120:123], v[168:171], v[24:27]
  v_mfma_f32_16x16x32_bf16 v[40:43], a[120:123], v[172:175], v[40:43]
  v_mfma_f32_16x16x32_bf16 v[28:31], a[124:127], v[168:171], v[28:31]
  v_mfma_f32_16x16x32_bf16 v[44:47], a[124:127], v[172:175], v[44:47]
  v_mfma_f32_16x16x32_bf16 v[16:19], a[64:67], v[176:179], v[16:19]
  v_mfma_f32_16x16x32_bf16 v[32:35], a[64:67], v[180:183], v[32:35]
  v_mfma_f32_16x16x32_bf16 v[20:23], a[68:71], v[176:179], v[20:23]
  v_mfma_f32_16x16x32_bf16 v[36:39], a[68:71], v[180:183], v[36:39]
  buffer_load_dwordx4 v[108:111], v50, s[52:55], s36 offen offset:0 sc1
  s_waitcnt lgkmcnt(10)
  v_mfma_f32_16x16x32_bf16 v[24:27], a[72:75], v[176:179], v[24:27]
  buffer_load_dwordx4 v[112:115], v50, s[52:55], s36 offen offset:1024 sc1
  v_mfma_f32_16x16x32_bf16 v[40:43], a[72:75], v[180:183], v[40:43]
  buffer_load_dwordx4 v[116:119], v50, s[52:55], s36 offen offset:2048 sc1
  s_waitcnt lgkmcnt(8)
  v_mfma_f32_16x16x32_bf16 v[28:31], a[76:79], v[176:179], v[28:31]
  buffer_load_dwordx4 v[120:123], v50, s[52:55], s36 offen offset:3072 sc1
  v_mfma_f32_16x16x32_bf16 v[44:47], a[76:79], v[180:183], v[44:47]
  s_waitcnt lgkmcnt(6)
  v_mfma_f32_16x16x32_bf16 v[16:19], a[96:99], v[184:187], v[16:19]
  v_mfma_f32_16x16x32_bf16 v[32:35], a[96:99], v[188:191], v[32:35]
  s_waitcnt lgkmcnt(4)
  v_mfma_f32_16x16x32_bf16 v[20:23], a[100:103], v[184:187], v[20:23]
  v_mfma_f32_16x16x32_bf16 v[36:39], a[100:103], v[188:191], v[36:39]
  s_waitcnt lgkmcnt(2)
  v_mfma_f32_16x16x32_bf16 v[24:27], a[104:107], v[184:187], v[24:27]
  v_mfma_f32_16x16x32_bf16 v[40:43], a[104:107], v[188:191], v[40:43]
  s_waitcnt lgkmcnt(0)
  v_mfma_f32_16x16x32_bf16 v[28:31], a[108:111], v[184:187], v[28:31]
  v_mfma_f32_16x16x32_bf16 v[44:47], a[108:111], v[188:191], v[44:47]
  s_nop 7
  s_nop 1
  s_waitcnt lgkmcnt(0)
  v_pk_fma_f32 v[192:193], v[16:17], v[56:57], v[192:193]
  v_pk_fma_f32 v[194:195], v[18:19], v[58:59], v[194:195]
  v_pk_fma_f32 v[196:197], v[20:21], v[60:61], v[196:197]
  v_pk_fma_f32 v[198:199], v[22:23], v[62:63], v[198:199]
  v_pk_fma_f32 v[200:201], v[24:25], v[64:65], v[200:201]
  v_pk_fma_f32 v[202:203], v[26:27], v[66:67], v[202:203]
  v_pk_fma_f32 v[204:205], v[28:29], v[68:69], v[204:205]
  v_pk_fma_f32 v[206:207], v[30:31], v[70:71], v[206:207]
  v_pk_fma_f32 v[208:209], v[32:33], v[56:57], v[208:209]
  v_pk_fma_f32 v[210:211], v[34:35], v[58:59], v[210:211]
  v_pk_fma_f32 v[212:213], v[36:37], v[60:61], v[212:213]
  v_pk_fma_f32 v[214:215], v[38:39], v[62:63], v[214:215]
  v_pk_fma_f32 v[216:217], v[40:41], v[64:65], v[216:217]
  v_pk_fma_f32 v[218:219], v[42:43], v[66:67], v[218:219]
  v_pk_fma_f32 v[220:221], v[44:45], v[68:69], v[220:221]
  v_pk_fma_f32 v[222:223], v[46:47], v[70:71], v[222:223]
  s_mov_b32 s60, 262144
  s_branch L_chk_33
L_poll_31:
  buffer_load_dwordx4 v[108:111], v50, s[52:55], s36 offen offset:0 sc1
  buffer_load_dwordx4 v[112:115], v50, s[52:55], s36 offen offset:1024 sc1
  buffer_load_dwordx4 v[116:119], v50, s[52:55], s36 offen offset:2048 sc1
  buffer_load_dwordx4 v[120:123], v50, s[52:55], s36 offen offset:3072 sc1
L_chk_33:
  s_waitcnt vmcnt(3)
  v_max3_u32 v51, v108, v109, v110
  v_max_u32 v51, v51, v111
  s_waitcnt vmcnt(2)
  v_max3_u32 v51, v51, v112, v113
  v_max3_u32 v51, v51, v114, v115
  s_waitcnt vmcnt(1)
  v_max3_u32 v51, v51, v116, v117
  v_max3_u32 v51, v51, v118, v119
  s_waitcnt vmcnt(0)
  v_max3_u32 v51, v51, v120, v121
  v_max3_u32 v51, v51, v122, v123
  v_cmp_eq_u32 vcc, -1, v51
  s_nop 1
  s_cmp_eq_u64 vcc, 0
  s_cbranch_scc1 L_ready_32
  s_sub_u32 s60, s60, 1
  s_cmp_lg_u32 s60, 0
  s_cbranch_scc1 L_poll_31
L_ready_32:
  v_lshlrev_b32 v72, 16, v108
  v_and_b32 v73, 0xffff0000, v108
  v_lshlrev_b32 v74, 16, v109
  v_and_b32 v75, 0xffff0000, v109
  v_pk_fma_f32 v[192:193], v[72:73], v[56:57], v[192:193]
  v_pk_fma_f32 v[194:195], v[74:75], v[58:59], v[194:195]
  v_cvt_pk_bf16_f32 v0, v192, v193
  v_cvt_pk_bf16_f32 v1, v194, v195
  v_lshlrev_b32 v76, 16, v110
  v_and_b32 v77, 0xffff0000, v110
  v_lshlrev_b32 v78, 16, v111
  v_and_b32 v79, 0xffff0000, v111
  v_pk_fma_f32 v[196:197], v[76:77], v[60:61], v[196:197]
  v_pk_fma_f32 v[198:199], v[78:79], v[62:63], v[198:199]
  v_cvt_pk_bf16_f32 v2, v196, v197
  v_cvt_pk_bf16_f32 v3, v198, v199
  s_nop 1
  v_permlane16_swap_b32 v0, v2
  v_permlane16_swap_b32 v1, v3
  s_nop 1
  buffer_store_dwordx4 v[0:3], v252, s[44:47], 0 offen offset:0 sc1
  v_lshlrev_b32 v80, 16, v112
  v_and_b32 v81, 0xffff0000, v112
  v_lshlrev_b32 v82, 16, v113
  v_and_b32 v83, 0xffff0000, v113
  v_pk_fma_f32 v[200:201], v[80:81], v[64:65], v[200:201]
  v_pk_fma_f32 v[202:203], v[82:83], v[66:67], v[202:203]
  v_cvt_pk_bf16_f32 v4, v200, v201
  v_cvt_pk_bf16_f32 v5, v202, v203
  v_lshlrev_b32 v84, 16, v114
  v_and_b32 v85, 0xffff0000, v114
  v_lshlrev_b32 v86, 16, v115
  v_and_b32 v87, 0xffff0000, v115
  v_pk_fma_f32 v[204:205], v[84:85], v[68:69], v[204:205]
  v_pk_fma_f32 v[206:207], v[86:87], v[70:71], v[206:207]
  v_cvt_pk_bf16_f32 v6, v204, v205
  v_cvt_pk_bf16_f32 v7, v206, v207
  s_nop 1
  v_permlane16_swap_b32 v4, v6
  v_permlane16_swap_b32 v5, v7
  s_nop 1
  buffer_store_dwordx4 v[4:7], v252, s[44:47], 0 offen offset:64 sc1
  v_lshlrev_b32 v88, 16, v116
  v_and_b32 v89, 0xffff0000, v116
  v_lshlrev_b32 v90, 16, v117
  v_and_b32 v91, 0xffff0000, v117
  v_pk_fma_f32 v[208:209], v[88:89], v[56:57], v[208:209]
  v_pk_fma_f32 v[210:211], v[90:91], v[58:59], v[210:211]
  v_cvt_pk_bf16_f32 v8, v208, v209
  v_cvt_pk_bf16_f32 v9, v210, v211
  v_lshlrev_b32 v92, 16, v118
  v_and_b32 v93, 0xffff0000, v118
  v_lshlrev_b32 v94, 16, v119
  v_and_b32 v95, 0xffff0000, v119
  v_pk_fma_f32 v[212:213], v[92:93], v[60:61], v[212:213]
  v_pk_fma_f32 v[214:215], v[94:95], v[62:63], v[214:215]
  v_cvt_pk_bf16_f32 v10, v212, v213
  v_cvt_pk_bf16_f32 v11, v214, v215
  s_nop 1
  v_permlane16_swap_b32 v8, v10
  v_permlane16_swap_b32 v9, v11
  s_nop 1
  buffer_store_dwordx4 v[8:11], v252, s[44:47], s43 offen offset:0 sc1
  v_lshlrev_b32 v96, 16, v120
  v_and_b32 v97, 0xffff0000, v120
  v_lshlrev_b32 v98, 16, v121
  v_and_b32 v99, 0xffff0000, v121
  v_pk_fma_f32 v[216:217], v[96:97], v[64:65], v[216:217]
  v_pk_fma_f32 v[218:219], v[98:99], v[66:67], v[218:219]
  v_cvt_pk_bf16_f32 v12, v216, v217
  v_cvt_pk_bf16_f32 v13, v218, v219
  v_lshlrev_b32 v100, 16, v122
  v_and_b32 v101, 0xffff0000, v122
  v_lshlrev_b32 v102, 16, v123
  v_and_b32 v103, 0xffff0000, v123
  v_pk_fma_f32 v[220:221], v[100:101], v[68:69], v[220:221]
  v_pk_fma_f32 v[222:223], v[102:103], v[70:71], v[222:223]
  v_cvt_pk_bf16_f32 v14, v220, v221
  v_cvt_pk_bf16_f32 v15, v222, v223
  s_nop 1
  v_permlane16_swap_b32 v12, v14
  v_permlane16_swap_b32 v13, v15
  s_nop 1
  buffer_store_dwordx4 v[12:15], v252, s[44:47], s43 offen offset:64 sc1
  s_endpgm
L_slow_9:
  s_mov_b32 s33, 262144
L_spin_34:
  buffer_load_dword v127, v126, s[64:67], 0 offen sc1
  s_waitcnt vmcnt(0)
  v_cmp_ne_u32 vcc, s19, v127
  s_nop 1
  s_cmp_eq_u64 vcc, 0
  s_cbranch_scc1 L_back_10
  s_sub_u32 s33, s33, 1
  s_cmp_lg_u32 s33, 0
  s_cbranch_scc1 L_spin_34
  s_branch L_back_10
L_vslow_11:
  s_mov_b32 s33, 262144
L_spin_35:
  buffer_load_dwordx4 v[250:253], v254, s[12:15], s68 offen sc1
  s_waitcnt vmcnt(0)
  v_xor_b32 v168, s48, v250
  v_xor_b32 v169, s49, v251
  v_xor_b32 v170, s50, v252
  v_xor_b32 v171, s51, v253
  v_or3_b32 v172, v168, v169, v170
  v_or_b32 v172, v172, v171
  v_and_b32 v172, 0xff, v172
  v_cmp_ne_u32 vcc, 0, v172
  s_nop 1
  s_cmp_eq_u64 vcc, 0
  s_cbranch_scc1 L_vback_12
  s_sub_u32 s33, s33, 1
  s_cmp_lg_u32 s33, 0
  s_cbranch_scc1 L_spin_35
  s_branch L_vback_12
L_slow_21:
  s_mov_b32 s69, 262144
L_spin_36:
  buffer_load_dword v247, v246, s[64:67], s68 offen sc1
  s_waitcnt vmcnt(0)
  v_cmp_ne_u32 vcc, s19, v247
  s_nop 1
  s_cmp_eq_u64 vcc, 0
  s_cbranch_scc1 L_back_22
  s_sub_u32 s69, s69, 1
  s_cmp_lg_u32 s69, 0
  s_cbranch_scc1 L_spin_36
  s_branch L_back_22
L_slow_25:
  s_mov_b32 s60, 262144
L_spin_37:
  buffer_load_dword v247, v246, s[56:59], s94 offen sc1
  s_waitcnt vmcnt(0)
  v_cmp_ne_u32 vcc, s19, v247
  s_nop 1
  s_cmp_eq_u64 vcc, 0
  s_cbranch_scc1 L_back_26
  s_sub_u32 s60, s60, 1
  s_cmp_lg_u32 s60, 0
  s_cbranch_scc1 L_spin_37
  s_branch L_back_26
L_slow_27:
  s_mov_b32 s60, 262144
L_spin_38:
  buffer_load_dword v247, v246, s[56:59], s94 offen sc1
  s_waitcnt vmcnt(0)
  v_cmp_ne_u32 vcc, s19, v247
  s_nop 1
  s_cmp_eq_u64 vcc, 0
  s_cbranch_scc1 L_back_28
  s_sub_u32 s60, s60, 1
  s_cmp_lg_u32 s60, 0
  s_cbranch_scc1 L_spin_38
  s_branch L_back_28
L_slow_29:
  s_mov_b32 s60, 262144
L_spin_39:
  buffer_load_dword v247, v246, s[56:59], s94 offen sc1
  s_waitcnt vmcnt(0)
  v_cmp_ne_u32 vcc, s19, v247
  s_nop 1
  s_cmp_eq_u64 vcc, 0
  s_cbranch_scc1 L_back_30
  s_sub_u32 s60, s60, 1
  s_cmp_lg_u32 s60, 0
  s_cbranch_scc1 L_spin_39
  s_branch L_back_30
L_end_1:
  s_endpgm
L_code_end:
  s_endpgm
.section .rodata,"a"
.p2align 6
.amdhsa_kernel adaLN_cond__sliding_local_dilated__glu_gated_glu__prompt_kernel
  .amdhsa_next_free_vgpr 512
  .amdhsa_next_free_sgpr 102
  .amdhsa_accum_offset 256
  .amdhsa_group_segment_fixed_size 0
  .amdhsa_kernarg_size 96
  .amdhsa_user_sgpr_count 2
  .amdhsa_user_sgpr_kernarg_segment_ptr 1
  .amdhsa_system_sgpr_workgroup_id_x 1
  .amdhsa_float_denorm_mode_32 3
.end_amdhsa_kernel
```

```asm
; @launch grid=(256,1,1) block=(256,1,1) lds=163840
.amdgcn_target "amdgcn-amd-amdhsa--gfx950"
.text
.globl adaLN_cond__sliding_local_dilated__glu_gated_glu__prompt_kernel
.p2align 8
.type adaLN_cond__sliding_local_dilated__glu_gated_glu__prompt_kernel,@function
adaLN_cond__sliding_local_dilated__glu_gated_glu__prompt_kernel:
  s_cmp_ge_u32 s2, 256
  s_cbranch_scc1 L_end_1
  s_load_dwordx2 s[44:45], s[0:1], 56
  s_load_dwordx2 s[52:53], s[0:1], 64
  s_load_dwordx2 s[12:13], s[0:1], 0
  s_load_dwordx2 s[20:21], s[0:1], 88
  s_load_dwordx2 s[8:9], s[0:1], 8
  s_getpc_b64 s[58:59]
  v_and_b32 v86, 31, v0
  v_lshlrev_b32 v86, 7, v86
  global_load_dword v131, v86, s[58:59] offset:128
  v_lshrrev_b32 v110, 6, v0
  v_and_b32 v104, 63, v0
  s_nop 0
  v_readfirstlane_b32 s3, v110
  s_and_b32 s29, s2, 3
  s_and_b32 s28, s2, 4
  s_lshl_b32 s28, s28, 3
  s_lshr_b32 s31, s2, 3
  s_or_b32 s28, s28, s31
  v_lshrrev_b32 v1, 2, v104
  v_mul_u32_u24 v1, 12288, v1
  v_and_b32 v66, 3, v104
  v_lshl_add_u32 v1, v66, 4, v1
  v_lshlrev_b32 v2, 1, v0
  s_lshl2_add_u32 s30, s29, s3
  s_mul_i32 s50, s30, 786432
  s_lshl_b32 s31, s28, 6
  s_add_u32 s35, s50, s31
  s_lshl_b32 s34, s29, 9
  s_lshl_b32 s31, s3, 12
  s_add_u32 m0, s31, 79872
  v_and_b32 v66, 7, v104
  v_lshlrev_b32 v3, 11, v66
  v_lshrrev_b32 v67, 3, v104
  v_lshl_add_u32 v3, v67, 4, v3
  s_lshl2_add_u32 s37, s28, s29
  s_lshl_b32 s36, s37, 14
  s_lshl_b32 s31, s3, 9
  s_add_u32 s36, s36, s31
  s_movk_i32 s46, 2048
  s_mov_b32 s47, 0x20000
  s_mov_b32 s54, 12582912
  s_mov_b32 s55, 0x20000
  s_mov_b32 s14, 4194304
  s_mov_b32 s15, 0x20000
  s_waitcnt lgkmcnt(0)
  s_load_dword s19, s[20:21], 0x40000
  buffer_load_ushort v4, v2, s[44:47], s34 offen
  buffer_load_dwordx4 v1, s[52:55], s35 offen offset:0 lds
  s_add_u32 s35, s35, 195584
  buffer_load_dwordx4 v1, s[52:55], s35 offen offset:1024 lds
  s_add_u32 s35, s35, 195584
  buffer_load_dwordx4 v1, s[52:55], s35 offen offset:2048 lds
  s_add_u32 s35, s35, 195584
  buffer_load_dwordx4 v1, s[52:55], s35 offen offset:3072 lds
  s_barrier
  buffer_load_dwordx4 v[8:11], v3, s[12:15], s36 offen offset:0
  buffer_load_dwordx4 v[12:15], v3, s[12:15], s36 offen offset:128
  buffer_load_dwordx4 v[16:19], v3, s[12:15], s36 offen offset:256
  buffer_load_dwordx4 v[20:23], v3, s[12:15], s36 offen offset:384
  s_load_dwordx2 s[24:25], s[0:1], 16
  s_load_dwordx4 s[60:63], s[0:1], 32
  s_load_dwordx2 s[22:23], s[0:1], 48
  s_load_dwordx2 s[90:91], s[0:1], 72
  s_mov_b64 s[26:27], s[12:13]
  s_bfe_u32 s30, s2, 0x10002
  s_xor_b32 s30, s30, 1
  s_lshl_b32 s30, s30, 3
  s_bfe_u32 s31, s2, 0x30003
  s_add_u32 s30, s30, s31
  s_bfe_u32 s31, s2, 0x20000
  s_lshl_b32 s31, s31, 2
  s_lshr_b32 s34, s2, 6
  s_add_u32 s31, s31, s34
  v_and_b32 v111, 2, v67
  v_xor_b32 v111, v111, v66
  v_mul_u32_u24 v129, 12288, v67
  v_lshl_add_u32 v129, v111, 4, v129
  s_and_b32 s33, s3, 1
  s_lshl_b32 s33, s33, 2
  v_xor_b32 v111, s33, v111
  v_mul_u32_u24 v110, 6144, v67
  v_lshl_add_u32 v110, v111, 4, v110
  s_mul_i32 s32, s3, 49152
  s_lshl_b32 s33, s31, 7
  s_add_u32 s32, s32, s33
  v_add_u32 v107, s32, v110
  v_add_u32 v108, 1024, v107
  v_add_u32 v109, 2048, v107
  s_mul_i32 s38, s3, 3072
  s_and_b32 s33, s30, 7
  s_mul_i32 s16, s33, 131072
  s_mul_i32 s17, s33, 196608
  s_mov_b32 s10, 1572864
  s_mov_b32 s11, 0x20000
  s_barrier
  s_getpc_b64 s[100:101]
  L_pc_2:
  s_add_u32 s100, s100, L_gemm_a-L_pc_2
  s_addc_u32 s101, s101, 0
  s_lshr_b32 s33, s2, 3
  s_lshl_b32 s33, s33, 2
  s_add_u32 s33, s33, s3
  s_lshl_b32 s33, s33, 13
  v_lshlrev_b32 v200, 7, v104
  v_add_u32 v200, s33, v200
  v_min_u32 v200, L_code_end-L_gemm_a-4, v200
  v_mov_b32 v201, s101
  v_add_co_u32 v200, vcc, s100, v200
  s_nop 1
  v_addc_co_u32 v201, vcc, 0, v201, vcc
  global_load_dword v131, v[200:201], off
  v_lshrrev_b32 v68, 4, v104
  v_bfe_u32 v69, v104, 2, 2
  v_lshl_add_u32 v69, v68, 3, v69
  v_and_b32 v70, 3, v104
  v_lshlrev_b32 v70, 3, v70
  s_lshl_b32 s33, s3, 5
  s_add_u32 s33, s33, 106496
  v_add_u32 v70, s33, v70
  v_lshl_add_u32 v5, v69, 6, v70
  v_subrev_u32 v5, 26624, v5
  v_lshl_add_u32 v196, v69, 7, v70
  v_and_b32 v70, 8, v104
  v_lshlrev_b32 v70, 2, v70
  v_xor_b32 v196, v196, v70
  v_lshlrev_b32 v255, 4, v68
  v_add_u32 v197, 147456, v255
  v_and_b32 v70, 15, v104
  v_lshl_or_b32 v255, v70, 24, v255
  v_mov_b32 v198, 0xffffff00
  v_add_u32 v2, 147456, v2
  s_mov_b32 s12, s20
  s_mov_b32 s13, s21
  s_mov_b32 s14, 0x18000
  s_mov_b32 s15, 0x20000
  s_mul_i32 s96, s29, 24576
  s_lshl_b32 s33, s3, 6
  s_add_u32 s96, s96, s33
  s_lshl_b32 s33, s28, 7
  s_add_u32 s34, s96, s33
  s_add_u32 s96, s34, s33
  s_add_u32 s96, s96, 8192
  s_add_u32 s50, s50, s33
  s_add_u32 s50, s50, 4096
  s_lshl_b32 s51, s3, 13
  s_add_u32 s51, s51, 106496
  s_waitcnt vmcnt(9)
  v_lshlrev_b32 v4, 16, v4
  v_mul_f32 v6, 0xbfb8aa3b, v4
  v_exp_f32 v6, v6
  s_nop 0
  v_add_f32 v6, 1.0, v6
  v_rcp_f32 v6, v6
  s_nop 0
  v_mul_f32 v4, v4, v6
  v_cvt_pk_bf16_f32 v4, v4, v4
  ds_write_b16 v2, v4
  s_waitcnt vmcnt(5) lgkmcnt(0)
  s_barrier
  s_mul_i32 s19, s19, 0x9e3779b1
  s_add_u32 s19, s19, 0x7f4a7c15
  s_bfe_u32 s40, s19, 0x80000
  s_bfe_u32 s41, s19, 0x80008
  s_bfe_u32 s42, s19, 0x80010
  s_bfe_u32 s43, s19, 0x80018
  s_cmp_ge_u32 s3, 2
  s_cbranch_scc1 L_nog_3
  ds_read_b64_tr_b16 a[64:65], v5 offset:0
  ds_read_b64_tr_b16 a[66:67], v5 offset:256
  ds_read_b128 a[68:71], v197 offset:0
  ds_read_b64_tr_b16 a[72:73], v5 offset:2048
  ds_read_b64_tr_b16 a[74:75], v5 offset:2304
  ds_read_b128 a[76:79], v197 offset:64
  ds_read_b64_tr_b16 a[80:81], v5 offset:4096
  ds_read_b64_tr_b16 a[82:83], v5 offset:4352
  ds_read_b128 a[84:87], v197 offset:128
  ds_read_b64_tr_b16 a[88:89], v5 offset:6144
  ds_read_b64_tr_b16 a[90:91], v5 offset:6400
  ds_read_b128 a[92:95], v197 offset:192
  ds_read_b64_tr_b16 a[96:97], v5 offset:8192
  ds_read_b64_tr_b16 a[98:99], v5 offset:8448
  ds_read_b128 a[100:103], v197 offset:256
  s_waitcnt lgkmcnt(12)
  v_mfma_f32_16x16x32_bf16 v[192:195], a[64:67], a[68:71], 0
  ds_read_b64_tr_b16 a[104:105], v5 offset:10240
  ds_read_b64_tr_b16 a[106:107], v5 offset:10496
  ds_read_b128 a[108:111], v197 offset:320
  s_waitcnt lgkmcnt(12)
  v_mfma_f32_16x16x32_bf16 v[192:195], a[72:75], a[76:79], v[192:195]
  ds_read_b64_tr_b16 a[112:113], v5 offset:12288
  ds_read_b64_tr_b16 a[114:115], v5 offset:12544
  ds_read_b128 a[116:119], v197 offset:384
  s_waitcnt lgkmcnt(12)
  v_mfma_f32_16x16x32_bf16 v[192:195], a[80:83], a[84:87], v[192:195]
  ds_read_b64_tr_b16 a[120:121], v5 offset:14336
  ds_read_b64_tr_b16 a[122:123], v5 offset:14592
  ds_read_b128 a[124:127], v197 offset:448
  s_waitcnt lgkmcnt(12)
  v_mfma_f32_16x16x32_bf16 v[192:195], a[88:91], a[92:95], v[192:195]
  s_waitcnt lgkmcnt(9)
  v_mfma_f32_16x16x32_bf16 v[192:195], a[96:99], a[100:103], v[192:195]
  s_waitcnt lgkmcnt(6)
  v_mfma_f32_16x16x32_bf16 v[192:195], a[104:107], a[108:111], v[192:195]
  s_waitcnt lgkmcnt(3)
  v_mfma_f32_16x16x32_bf16 v[192:195], a[112:115], a[116:119], v[192:195]
  s_waitcnt lgkmcnt(0)
  v_mfma_f32_16x16x32_bf16 v[192:195], a[120:123], a[124:127], v[192:195]
  s_nop 7
  v_and_or_b32 v192, v192, v198, s40
  v_and_or_b32 v193, v193, v198, s41
  v_and_or_b32 v194, v194, v198, s42
  v_and_or_b32 v195, v195, v198, s43
  buffer_store_dwordx4 v[192:195], v255, s[12:15], s34 offen sc1
L_nog_3:
  s_waitcnt vmcnt(1)
  v_lshlrev_b32 v24, 16, v8
  v_and_b32 v25, 0xffff0000, v8
  v_lshlrev_b32 v26, 16, v9
  v_and_b32 v27, 0xffff0000, v9
  v_lshlrev_b32 v28, 16, v10
  v_and_b32 v29, 0xffff0000, v10
  v_lshlrev_b32 v30, 16, v11
  v_and_b32 v31, 0xffff0000, v11
  v_lshlrev_b32 v32, 16, v12
  v_and_b32 v33, 0xffff0000, v12
  v_lshlrev_b32 v34, 16, v13
  v_and_b32 v35, 0xffff0000, v13
  v_lshlrev_b32 v36, 16, v14
  v_and_b32 v37, 0xffff0000, v14
  v_lshlrev_b32 v38, 16, v15
  v_and_b32 v39, 0xffff0000, v15
  v_lshlrev_b32 v40, 16, v16
  v_and_b32 v41, 0xffff0000, v16
  v_lshlrev_b32 v42, 16, v17
  v_and_b32 v43, 0xffff0000, v17
  v_lshlrev_b32 v44, 16, v18
  v_and_b32 v45, 0xffff0000, v18
  v_lshlrev_b32 v46, 16, v19
  v_and_b32 v47, 0xffff0000, v19
  v_lshlrev_b32 v48, 16, v20
  v_and_b32 v49, 0xffff0000, v20
  v_lshlrev_b32 v50, 16, v21
  v_and_b32 v51, 0xffff0000, v21
  v_lshlrev_b32 v52, 16, v22
  v_and_b32 v53, 0xffff0000, v22
  v_lshlrev_b32 v54, 16, v23
  v_and_b32 v55, 0xffff0000, v23
  v_pk_add_f32 v[56:57], v[24:25], v[26:27]
  v_pk_mul_f32 v[58:59], v[24:25], v[24:25]
  v_pk_mul_f32 v[60:61], v[26:27], v[26:27]
  v_pk_add_f32 v[56:57], v[56:57], v[28:29]
  v_pk_fma_f32 v[58:59], v[28:29], v[28:29], v[58:59]
  v_pk_add_f32 v[56:57], v[56:57], v[30:31]
  v_pk_fma_f32 v[60:61], v[30:31], v[30:31], v[60:61]
  v_pk_add_f32 v[56:57], v[56:57], v[32:33]
  v_pk_fma_f32 v[58:59], v[32:33], v[32:33], v[58:59]
  v_pk_add_f32 v[56:57], v[56:57], v[34:35]
  v_pk_fma_f32 v[60:61], v[34:35], v[34:35], v[60:61]
  v_pk_add_f32 v[56:57], v[56:57], v[36:37]
  v_pk_fma_f32 v[58:59], v[36:37], v[36:37], v[58:59]
  v_pk_add_f32 v[56:57], v[56:57], v[38:39]
  v_pk_fma_f32 v[60:61], v[38:39], v[38:39], v[60:61]
  v_pk_add_f32 v[56:57], v[56:57], v[40:41]
  v_pk_fma_f32 v[58:59], v[40:41], v[40:41], v[58:59]
  v_pk_add_f32 v[56:57], v[56:57], v[42:43]
  v_pk_fma_f32 v[60:61], v[42:43], v[42:43], v[60:61]
  v_pk_add_f32 v[56:57], v[56:57], v[44:45]
  v_pk_fma_f32 v[58:59], v[44:45], v[44:45], v[58:59]
  v_pk_add_f32 v[56:57], v[56:57], v[46:47]
  v_pk_fma_f32 v[60:61], v[46:47], v[46:47], v[60:61]
  v_pk_add_f32 v[56:57], v[56:57], v[48:49]
  v_pk_fma_f32 v[58:59], v[48:49], v[48:49], v[58:59]
  v_pk_add_f32 v[56:57], v[56:57], v[50:51]
  v_pk_fma_f32 v[60:61], v[50:51], v[50:51], v[60:61]
  v_pk_add_f32 v[56:57], v[56:57], v[52:53]
  v_pk_fma_f32 v[58:59], v[52:53], v[52:53], v[58:59]
  v_pk_add_f32 v[56:57], v[56:57], v[54:55]
  v_pk_fma_f32 v[60:61], v[54:55], v[54:55], v[60:61]
  v_pk_add_f32 v[58:59], v[58:59], v[60:61]
  v_add_f32 v56, v56, v57
  v_add_f32 v57, v58, v59
  s_nop 1
  v_add_f32_dpp v56, v56, v56 row_ror:8 row_mask:0xf bank_mask:0xf
  v_add_f32_dpp v57, v57, v57 row_ror:8 row_mask:0xf bank_mask:0xf
  v_mov_b32 v58, v56
  v_mov_b32 v59, v57
  s_nop 1
  v_permlane16_swap_b32 v58, v56
  v_permlane16_swap_b32 v59, v57
  s_nop 1
  v_add_f32 v56, v56, v58
  v_add_f32 v57, v57, v59
  v_mov_b32 v58, v56
  v_mov_b32 v59, v57
  s_nop 1
  v_permlane32_swap_b32 v58, v56
  v_permlane32_swap_b32 v59, v57
  s_nop 1
  v_add_f32 v56, v56, v58
  v_add_f32 v57, v57, v59
  v_lshlrev_b32 v68, 5, v66
  v_add_u32 v68, 147968, v68
  s_lshl_b32 s33, s3, 3
  v_add_u32 v69, s33, v68
  ds_write_b64 v69, v[56:57]
  v_lshlrev_b32 v119, 4, v104
  s_lshl_b32 s33, s3, 10
  v_add_u32 v1, s33, v119
  v_add_u32 v2, 4096, v1
  s_lshl_b32 s33, s3, 11
  s_add_u32 s33, s33, 139264
  v_add_u32 v3, s33, v119
  v_lshlrev_b32 v4, 5, v67
  v_add_u32 v4, s33, v4
  v_lshrrev_b32 v5, 5, v104
  v_lshlrev_b32 v5, 17, v5
  v_and_b32 v70, 3, v67
  v_lshl_add_u32 v5, v70, 8, v5
  v_lshl_add_u32 v5, v66, 4, v5
  s_waitcnt lgkmcnt(0)
  s_barrier
  ds_read_b128 v[132:135], v68 offset:0
  ds_read_b128 v[136:139], v68 offset:16
  s_add_u32 m0, s38, 0
  s_nop 0
  buffer_load_dwordx4 v107, s[8:11], s17 offen lds
  buffer_load_dwordx4 v108, s[8:11], s17 offen offset:1024 lds
  buffer_load_dwordx4 v109, s[8:11], s17 offen offset:2048 lds
  s_add_u32 s17, s17, 196608
  s_cmp_eq_u32 s17, s10
  s_cselect_b32 s17, 0, s17
  s_mov_b32 s32, 24576
  s_mov_b32 s35, 49152
  s_mov_b32 s36, 73728
  s_add_u32 s4, s20, 0x200000
  s_addc_u32 s5, s21, 0
  s_mov_b32 s6, 0x400000
  s_mov_b32 s7, 0x20000
  s_add_u32 s64, s20, 0xc0000
  s_addc_u32 s65, s21, 0
  s_mov_b32 s66, 0x20000
  s_mov_b32 s67, 0x20000
  s_waitcnt lgkmcnt(0)
  v_pk_add_f32 v[132:133], v[132:133], v[134:135]
  v_pk_add_f32 v[136:137], v[136:137], v[138:139]
  v_pk_add_f32 v[132:133], v[132:133], v[136:137]
  v_mul_f32 v56, 0x3a800000, v132
  v_mul_f32 v60, 0x3a800000, v133
  v_fma_f32 v60, -v56, v56, v60
  v_max_f32 v60, 0, v60
  buffer_load_dwordx4 v[72:75], v1, s[12:15], 0 offen sc1
  buffer_load_dwordx4 v[76:79], v1, s[12:15], s32 offen sc1
  buffer_load_dwordx4 v[80:83], v1, s[12:15], s35 offen sc1
  buffer_load_dwordx4 v[84:87], v1, s[12:15], s36 offen sc1
  buffer_load_dwordx4 v[88:91], v2, s[12:15], 0 offen sc1
  buffer_load_dwordx4 v[92:95], v2, s[12:15], s32 offen sc1
  buffer_load_dwordx4 v[96:99], v2, s[12:15], s35 offen sc1
  buffer_load_dwordx4 v[100:103], v2, s[12:15], s36 offen sc1
  v_cvt_pk_bf16_f32 v64, v56, v60
  v_lshlrev_b32 v56, 16, v64
  v_and_b32 v60, 0xffff0000, v64
  v_add_f32 v60, 0x3727c5ac, v60
  v_cvt_pk_bf16_f32 v64, v60, v61
  v_lshlrev_b32 v60, 16, v64
  v_and_b32 v61, 0xffff0000, v64
  v_sqrt_f32 v60, v60
  s_nop 0
  v_cvt_pk_bf16_f32 v64, v60, v61
  v_lshlrev_b32 v60, 16, v64
  v_and_b32 v61, 0xffff0000, v64
  v_rcp_f32 v60, v60
  v_mov_b32 v57, v56
  s_nop 0
  v_mov_b32 v61, v60
  v_pk_add_f32 v[24:25], v[24:25], v[56:57] neg_lo:[0,1] neg_hi:[0,1]
  v_pk_add_f32 v[26:27], v[26:27], v[56:57] neg_lo:[0,1] neg_hi:[0,1]
  v_pk_add_f32 v[28:29], v[28:29], v[56:57] neg_lo:[0,1] neg_hi:[0,1]
  v_pk_add_f32 v[30:31], v[30:31], v[56:57] neg_lo:[0,1] neg_hi:[0,1]
  v_pk_add_f32 v[32:33], v[32:33], v[56:57] neg_lo:[0,1] neg_hi:[0,1]
  v_pk_add_f32 v[34:35], v[34:35], v[56:57] neg_lo:[0,1] neg_hi:[0,1]
  v_pk_add_f32 v[36:37], v[36:37], v[56:57] neg_lo:[0,1] neg_hi:[0,1]
  v_pk_add_f32 v[38:39], v[38:39], v[56:57] neg_lo:[0,1] neg_hi:[0,1]
  v_pk_add_f32 v[40:41], v[40:41], v[56:57] neg_lo:[0,1] neg_hi:[0,1]
  v_pk_add_f32 v[42:43], v[42:43], v[56:57] neg_lo:[0,1] neg_hi:[0,1]
  v_pk_add_f32 v[44:45], v[44:45], v[56:57] neg_lo:[0,1] neg_hi:[0,1]
  v_pk_add_f32 v[46:47], v[46:47], v[56:57] neg_lo:[0,1] neg_hi:[0,1]
  v_pk_add_f32 v[48:49], v[48:49], v[56:57] neg_lo:[0,1] neg_hi:[0,1]
  v_pk_add_f32 v[50:51], v[50:51], v[56:57] neg_lo:[0,1] neg_hi:[0,1]
  v_pk_add_f32 v[52:53], v[52:53], v[56:57] neg_lo:[0,1] neg_hi:[0,1]
  v_pk_add_f32 v[54:55], v[54:55], v[56:57] neg_lo:[0,1] neg_hi:[0,1]
  v_pk_mul_f32 v[24:25], v[24:25], v[60:61]
  v_pk_mul_f32 v[26:27], v[26:27], v[60:61]
  v_pk_mul_f32 v[28:29], v[28:29], v[60:61]
  v_pk_mul_f32 v[30:31], v[30:31], v[60:61]
  v_pk_mul_f32 v[32:33], v[32:33], v[60:61]
  v_pk_mul_f32 v[34:35], v[34:35], v[60:61]
  v_pk_mul_f32 v[36:37], v[36:37], v[60:61]
  v_pk_mul_f32 v[38:39], v[38:39], v[60:61]
  v_pk_mul_f32 v[40:41], v[40:41], v[60:61]
  v_pk_mul_f32 v[42:43], v[42:43], v[60:61]
  v_pk_mul_f32 v[44:45], v[44:45], v[60:61]
  v_pk_mul_f32 v[46:47], v[46:47], v[60:61]
  v_pk_mul_f32 v[48:49], v[48:49], v[60:61]
  v_pk_mul_f32 v[50:51], v[50:51], v[60:61]
  v_pk_mul_f32 v[52:53], v[52:53], v[60:61]
  v_pk_mul_f32 v[54:55], v[54:55], v[60:61]
  s_lshl_b32 s39, s3, 8
  s_add_u32 s39, s39, 12288
  s_lshl_b32 s33, s30, 6
  s_lshl_b32 s34, s3, 4
  s_add_u32 s34, s34, s33
  s_max_u32 s33, s33, 8
  s_sub_u32 s33, s33, 8
  v_add_u32 v110, s33, v66
  v_add_u32 v126, s34, v104
  v_cmp_lt_u32 vcc, 15, v104
  s_nop 1
  v_cndmask_b32 v126, v126, v110, vcc
  s_mov_b32 s33, 0
  v_and_b32 v128, 0, v126
  v_add_u32 v128, s33, v128
  v_and_b32 v128, 3, v128
  v_and_or_b32 v128, v126, -4, v128
  v_lshlrev_b32 v126, 6, v126
  v_lshlrev_b32 v128, 6, v128
  s_lshl_b32 s34, s30, 13
  s_lshl_b32 s33, s3, 11
  s_add_u32 s34, s34, s33
  v_add_u32 v105, s34, v119
  s_lshl_b32 s34, s30, 3
  s_max_u32 s34, s34, 1
  s_sub_u32 s34, s34, 1
  s_lshl_b32 s34, s34, 10
  s_lshl_b32 s33, s3, 8
  s_add_u32 s34, s34, s33
  v_lshlrev_b32 v106, 2, v104
  v_add_u32 v106, s34, v106
  v_lshrrev_b32 v110, 4, v104
  v_mul_u32_u24 v110, 3072, v110
  v_bfe_u32 v111, v104, 2, 2
  v_lshl_add_u32 v110, v111, 7, v110
  v_bfe_u32 v111, v104, 3, 2
  v_lshl_add_u32 v110, v111, 5, v110
  v_and_b32 v111, 3, v104
  v_lshl_add_u32 v114, v111, 3, v110
  v_xor_b32 v115, 32, v114
  v_xor_b32 v116, 64, v114
  v_xor_b32 v117, 96, v114
  s_lshl_b32 s33, s3, 5
  v_xor_b32 v118, s33, v114
  v_add_u32 v120, 53248, v114
  v_add_u32 v121, 53248, v115
  v_add_u32 v122, 53248, v116
  v_add_u32 v123, 53248, v117
  v_add_u32 v124, 53248, v118
  v_add_u32 v125, 53248, v119
  v_and_b32 v110, 14, v104
  v_lshrrev_b32 v111, 4, v104
  v_lshlrev_b32 v111, 2, v111
  v_cmp_le_u32 s[44:45], v111, v110
  v_add_u32 v111, 2, v111
  v_cmp_le_u32 s[46:47], v111, v110
  v_and_b32 v110, 1, v104
  v_cmp_eq_u32 s[48:49], 1, v110
  s_lshl_b32 s56, s3, 20
  s_lshr_b32 s33, s37, 1
  s_lshl_b32 s33, s33, 10
  s_add_u32 s56, s56, s33
  s_and_b32 s33, s37, 1
  s_lshl_b32 s33, s33, 7
  s_add_u32 s56, s56, s33
  s_add_u32 s57, s56, 262144
  s_add_u32 s58, s56, 524288
  s_add_u32 s59, s56, 786432
  s_lshl2_add_u32 s37, s37, s3
  s_lshl_b32 s37, s37, 6
  s_mov_b32 s33, 262144
L_mod_4:
  s_waitcnt vmcnt(7)
  v_xor_b32 v72, s40, v72
  v_xor_b32 v73, s41, v73
  v_xor_b32 v74, s42, v74
  v_xor_b32 v75, s43, v75
  v_or3_b32 v66, v72, v73, v74
  v_or_b32 v66, v66, v75
  s_waitcnt vmcnt(6)
  v_xor_b32 v76, s40, v76
  v_xor_b32 v77, s41, v77
  v_xor_b32 v78, s42, v78
  v_xor_b32 v79, s43, v79
  v_or3_b32 v66, v66, v76, v77
  v_or3_b32 v66, v66, v78, v79
  s_waitcnt vmcnt(5)
  v_xor_b32 v80, s40, v80
  v_xor_b32 v81, s41, v81
  v_xor_b32 v82, s42, v82
  v_xor_b32 v83, s43, v83
  v_or3_b32 v66, v66, v80, v81
  v_or3_b32 v66, v66, v82, v83
  s_waitcnt vmcnt(4)
  v_xor_b32 v84, s40, v84
  v_xor_b32 v85, s41, v85
  v_xor_b32 v86, s42, v86
  v_xor_b32 v87, s43, v87
  v_or3_b32 v66, v66, v84, v85
  v_or3_b32 v66, v66, v86, v87
  s_waitcnt vmcnt(3)
  v_xor_b32 v88, s40, v88
  v_xor_b32 v89, s41, v89
  v_xor_b32 v90, s42, v90
  v_xor_b32 v91, s43, v91
  v_or3_b32 v66, v66, v88, v89
  v_or3_b32 v66, v66, v90, v91
  s_waitcnt vmcnt(2)
  v_xor_b32 v92, s40, v92
  v_xor_b32 v93, s41, v93
  v_xor_b32 v94, s42, v94
  v_xor_b32 v95, s43, v95
  v_or3_b32 v66, v66, v92, v93
  v_or3_b32 v66, v66, v94, v95
  s_waitcnt vmcnt(1)
  v_xor_b32 v96, s40, v96
  v_xor_b32 v97, s41, v97
  v_xor_b32 v98, s42, v98
  v_xor_b32 v99, s43, v99
  v_or3_b32 v66, v66, v96, v97
  v_or3_b32 v66, v66, v98, v99
  s_waitcnt vmcnt(0)
  v_xor_b32 v100, s40, v100
  v_xor_b32 v101, s41, v101
  v_xor_b32 v102, s42, v102
  v_xor_b32 v103, s43, v103
  v_or3_b32 v66, v66, v100, v101
  v_or3_b32 v66, v66, v102, v103
  v_and_b32 v66, 0xff, v66
  v_cmp_ne_u32 vcc, 0, v66
  s_nop 1
  s_cmp_eq_u64 vcc, 0
  s_cbranch_scc1 L_mok_5
  s_mov_b64 exec, vcc
  buffer_load_dwordx4 v[72:75], v1, s[12:15], 0 offen sc1
  buffer_load_dwordx4 v[76:79], v1, s[12:15], s32 offen sc1
  buffer_load_dwordx4 v[80:83], v1, s[12:15], s35 offen sc1
  buffer_load_dwordx4 v[84:87], v1, s[12:15], s36 offen sc1
  buffer_load_dwordx4 v[88:91], v2, s[12:15], 0 offen sc1
  buffer_load_dwordx4 v[92:95], v2, s[12:15], s32 offen sc1
  buffer_load_dwordx4 v[96:99], v2, s[12:15], s35 offen sc1
  buffer_load_dwordx4 v[100:103], v2, s[12:15], s36 offen sc1
  s_sub_u32 s33, s33, 1
  s_cmp_lg_u32 s33, 0
  s_cbranch_scc1 L_mod_4
  s_waitcnt vmcnt(0)
L_mok_5:
  s_mov_b64 exec, -1
  v_pk_add_f32 v[72:73], v[72:73], v[80:81]
  v_pk_add_f32 v[74:75], v[74:75], v[82:83]
  v_pk_add_f32 v[76:77], v[76:77], v[84:85]
  v_pk_add_f32 v[78:79], v[78:79], v[86:87]
  v_pk_add_f32 v[88:89], v[88:89], v[96:97]
  v_pk_add_f32 v[90:91], v[90:91], v[98:99]
  v_pk_add_f32 v[92:93], v[92:93], v[100:101]
  v_pk_add_f32 v[94:95], v[94:95], v[102:103]
  v_pk_add_f32 v[72:73], v[72:73], v[76:77]
  v_pk_add_f32 v[74:75], v[74:75], v[78:79]
  v_pk_add_f32 v[88:89], v[88:89], v[92:93]
  v_pk_add_f32 v[90:91], v[90:91], v[94:95]
  v_cvt_pk_bf16_f32 v80, v72, v73
  v_lshlrev_b32 v72, 16, v80
  v_and_b32 v73, 0xffff0000, v80
  v_cvt_pk_bf16_f32 v81, v74, v75
  v_lshlrev_b32 v74, 16, v81
  v_and_b32 v75, 0xffff0000, v81
  v_cvt_pk_bf16_f32 v82, v88, v89
  v_lshlrev_b32 v88, 16, v82
  v_and_b32 v89, 0xffff0000, v82
  v_cvt_pk_bf16_f32 v83, v90, v91
  v_lshlrev_b32 v90, 16, v83
  v_and_b32 v91, 0xffff0000, v83
  ds_write_b128 v3, v[72:75]
  v_add_f32 v88, 1.0, v88
  v_add_f32 v89, 1.0, v89
  v_add_f32 v90, 1.0, v90
  v_add_f32 v91, 1.0, v91
  v_cvt_pk_bf16_f32 v80, v88, v89
  v_lshlrev_b32 v88, 16, v80
  v_and_b32 v89, 0xffff0000, v80
  v_cvt_pk_bf16_f32 v81, v90, v91
  v_lshlrev_b32 v90, 16, v81
  v_and_b32 v91, 0xffff0000, v81
  ds_write_b128 v3, v[88:91] offset:1024
  ds_read_b128 v[132:135], v4 offset:0
  ds_read_b128 v[164:167], v4 offset:1024
  ds_read_b128 v[136:139], v4 offset:16
  ds_read_b128 v[168:171], v4 offset:1040
  ds_read_b128 v[140:143], v4 offset:256
  ds_read_b128 v[172:175], v4 offset:1280
  ds_read_b128 v[144:147], v4 offset:272
  ds_read_b128 v[176:179], v4 offset:1296
  ds_read_b128 v[148:151], v4 offset:512
  ds_read_b128 v[180:183], v4 offset:1536
  ds_read_b128 v[152:155], v4 offset:528
  ds_read_b128 v[184:187], v4 offset:1552
  s_waitcnt lgkmcnt(8)
  ds_read_b128 v[156:159], v4 offset:768
  ds_read_b128 v[188:191], v4 offset:1792
  ds_read_b128 v[160:163], v4 offset:784
  ds_read_b128 v[192:195], v4 offset:1808
  s_waitcnt lgkmcnt(12)
  v_pk_fma_f32 v[24:25], v[24:25], v[164:165], v[132:133]
  v_pk_fma_f32 v[26:27], v[26:27], v[166:167], v[134:135]
  v_pk_fma_f32 v[28:29], v[28:29], v[168:169], v[136:137]
  v_pk_fma_f32 v[30:31], v[30:31], v[170:171], v[138:139]
  v_cvt_pk_bf16_f32 v8, v24, v25
  v_cvt_pk_bf16_f32 v9, v26, v27
  v_cvt_pk_bf16_f32 v10, v28, v29
  v_cvt_pk_bf16_f32 v11, v30, v31
  buffer_store_dwordx4 v[8:11], v5, s[4:7], s56 offen sc1
  s_waitcnt lgkmcnt(8)
  v_pk_fma_f32 v[32:33], v[32:33], v[172:173], v[140:141]
  v_pk_fma_f32 v[34:35], v[34:35], v[174:175], v[142:143]
  v_pk_fma_f32 v[36:37], v[36:37], v[176:177], v[144:145]
  v_pk_fma_f32 v[38:39], v[38:39], v[178:179], v[146:147]
  v_cvt_pk_bf16_f32 v12, v32, v33
  v_cvt_pk_bf16_f32 v13, v34, v35
  v_cvt_pk_bf16_f32 v14, v36, v37
  v_cvt_pk_bf16_f32 v15, v38, v39
  buffer_store_dwordx4 v[12:15], v5, s[4:7], s57 offen sc1
  s_waitcnt lgkmcnt(4)
  v_pk_fma_f32 v[40:41], v[40:41], v[180:181], v[148:149]
  v_pk_fma_f32 v[42:43], v[42:43], v[182:183], v[150:151]
  v_pk_fma_f32 v[44:45], v[44:45], v[184:185], v[152:153]
  v_pk_fma_f32 v[46:47], v[46:47], v[186:187], v[154:155]
  v_cvt_pk_bf16_f32 v16, v40, v41
  v_cvt_pk_bf16_f32 v17, v42, v43
  v_cvt_pk_bf16_f32 v18, v44, v45
  v_cvt_pk_bf16_f32 v19, v46, v47
  buffer_store_dwordx4 v[16:19], v5, s[4:7], s58 offen sc1
  s_waitcnt lgkmcnt(0)
  v_pk_fma_f32 v[48:49], v[48:49], v[188:189], v[156:157]
  v_pk_fma_f32 v[50:51], v[50:51], v[190:191], v[158:159]
  v_pk_fma_f32 v[52:53], v[52:53], v[192:193], v[160:161]
  v_pk_fma_f32 v[54:55], v[54:55], v[194:195], v[162:163]
  v_cvt_pk_bf16_f32 v20, v48, v49
  v_cvt_pk_bf16_f32 v21, v50, v51
  v_cvt_pk_bf16_f32 v22, v52, v53
  v_cvt_pk_bf16_f32 v23, v54, v55
  buffer_store_dwordx4 v[20:23], v5, s[4:7], s59 offen sc1
  v_mov_b32 v7, s19
  v_lshlrev_b32 v6, 2, v104
  s_waitcnt vmcnt(0)
  s_mov_b64 exec, 1
  buffer_store_dword v7, v6, s[64:67], s37 offen sc1
  s_mov_b64 exec, -1
  s_barrier
  s_add_u32 m0, s38, 13312
  s_nop 0
  buffer_load_dwordx4 v107, s[8:11], s17 offen lds
  buffer_load_dwordx4 v108, s[8:11], s17 offen offset:1024 lds
  buffer_load_dwordx4 v109, s[8:11], s17 offen offset:2048 lds
  s_add_u32 s17, s17, 196608
  s_cmp_eq_u32 s17, s10
  s_cselect_b32 s17, 0, s17
  s_add_u32 m0, s38, 26624
  s_nop 0
  buffer_load_dwordx4 v107, s[8:11], s17 offen lds
  buffer_load_dwordx4 v108, s[8:11], s17 offen offset:1024 lds
  buffer_load_dwordx4 v109, s[8:11], s17 offen offset:2048 lds
  s_add_u32 s17, s17, 196608
  s_cmp_eq_u32 s17, s10
  s_cselect_b32 s17, 0, s17
  s_add_u32 m0, s38, 39936
  s_nop 0
  buffer_load_dwordx4 v107, s[8:11], s17 offen lds
  buffer_load_dwordx4 v108, s[8:11], s17 offen offset:1024 lds
  buffer_load_dwordx4 v109, s[8:11], s17 offen offset:2048 lds
  s_add_u32 s17, s17, 196608
  s_cmp_eq_u32 s17, s10
  s_cselect_b32 s17, 0, s17
  s_add_u32 m0, s38, 53248
  s_nop 0
  buffer_load_dwordx4 v107, s[8:11], s17 offen lds
  buffer_load_dwordx4 v108, s[8:11], s17 offen offset:1024 lds
  buffer_load_dwordx4 v109, s[8:11], s17 offen offset:2048 lds
  s_add_u32 s17, s17, 196608
  s_cmp_eq_u32 s17, s10
  s_cselect_b32 s17, 0, s17
  s_add_u32 m0, s38, 66560
  s_nop 0
  buffer_load_dwordx4 v107, s[8:11], s17 offen lds
  buffer_load_dwordx4 v108, s[8:11], s17 offen offset:1024 lds
  buffer_load_dwordx4 v109, s[8:11], s17 offen offset:2048 lds
  s_add_u32 s17, s17, 196608
  s_cmp_eq_u32 s17, s10
  s_cselect_b32 s17, 0, s17
  s_add_u32 m0, s38, 79872
  s_nop 0
  buffer_load_dwordx4 v107, s[8:11], s17 offen lds
  buffer_load_dwordx4 v108, s[8:11], s17 offen offset:1024 lds
  buffer_load_dwordx4 v109, s[8:11], s17 offen offset:2048 lds
  s_add_u32 s17, s17, 196608
  s_cmp_eq_u32 s17, s10
  s_cselect_b32 s17, 0, s17
L_slow_6:
  s_mov_b32 s33, 262144
L_spin_8:
  buffer_load_dword v127, v128, s[64:67], 0 offen sc1
  s_waitcnt vmcnt(0)
  v_cmp_ne_u32 vcc, s19, v127
  s_nop 1
  s_cmp_eq_u64 vcc, 0
  s_cbranch_scc1 L_back_7
  s_sub_u32 s33, s33, 1
  s_cmp_lg_u32 s33, 0
  s_cbranch_scc1 L_spin_8
  s_branch L_back_7
L_back_7:
L_gemm_a:
  s_mov_b32 s6, 1048576
  s_add_u32 m0, s39, 0
  s_nop 0
  buffer_load_dword v106, s[4:7], s16 offen sc1 lds
  buffer_load_dwordx4 a[0:3], v105, s[4:7], s16 offen sc1
  buffer_load_dwordx4 a[4:7], v105, s[4:7], s16 offen offset:1024 sc1
  s_add_u32 s16, s16, 131072
  s_bitset0_b32 s16, 20
  s_add_u32 m0, s39, 13312
  s_nop 0
  buffer_load_dword v106, s[4:7], s16 offen sc1 lds
  buffer_load_dwordx4 a[8:11], v105, s[4:7], s16 offen sc1
  buffer_load_dwordx4 a[12:15], v105, s[4:7], s16 offen offset:1024 sc1
  s_add_u32 s16, s16, 131072
  s_bitset0_b32 s16, 20
  s_add_u32 m0, s39, 26624
  s_nop 0
  buffer_load_dword v106, s[4:7], s16 offen sc1 lds
  buffer_load_dwordx4 a[16:19], v105, s[4:7], s16 offen sc1
  buffer_load_dwordx4 a[20:23], v105, s[4:7], s16 offen offset:1024 sc1
  s_add_u32 s16, s16, 131072
  s_bitset0_b32 s16, 20
  s_bitcmp1_b32 s3, 0
  s_cselect_b32 s56, s62, s60
  s_cselect_b32 s57, s63, s61
  s_mov_b32 s58, 7340032
  s_mov_b32 s59, 0x20000
  s_lshl_b32 s97, s2, 1
  s_lshr_b32 s33, s3, 1
  s_add_u32 s97, s97, s33
  s_lshl_b32 s97, s97, 10
  v_lshrrev_b32 v110, 3, v104
  v_min_u32 v130, 1, v110
  v_lshlrev_b32 v130, 19, v130
  v_and_b32 v112, 7, v104
  v_lshl_add_u32 v130, v112, 7, v130
  s_bfe_u32 s36, s2, 0x20001
  s_lshl_b32 s36, s36, 2
  s_bfe_u32 s33, s2, 0x20003
  s_add_u32 s36, s36, s33
  s_lshr_b32 s37, s2, 5
  s_lshl_b32 s37, s37, 1
  s_and_b32 s33, s2, 1
  s_add_u32 s37, s37, s33
  s_and_b32 s33, s36, 3
  s_lshl_b32 s98, s33, 19
  v_and_b32 v111, 6, v110
  v_and_b32 v112, 7, v104
  v_xor_b32 v111, v111, v112
  v_lshlrev_b32 v110, 11, v110
  v_lshl_add_u32 v110, v111, 4, v110
  s_lshl_b32 s32, s3, 15
  s_lshl_b32 s33, s37, 7
  s_add_u32 s32, s32, s33
  v_add_u32 v248, s32, v110
  v_add_u32 v249, 15360, v248
  v_mov_b32 v244, -1
  v_mov_b32 v245, -1
  v_mov_b32 v246, -1
  v_mov_b32 v247, -1
  s_add_u32 s92, s20, 0xe00000
  s_addc_u32 s93, s21, 0
  s_mov_b32 s94, 0x800000
  s_mov_b32 s95, 0x20000
  s_lshl_b32 s35, s2, 2
  s_add_u32 s35, s35, s3
  s_lshl_b32 s35, s35, 12
  v_lshrrev_b32 v254, 4, v104
  s_movk_i32 s33, 24576
  v_mul_u32_u24 v254, s33, v254
  v_and_b32 v110, 15, v104
  v_lshl_add_u32 v254, v110, 4, v254
  v_and_b32 v110, 15, v104
  v_lshlrev_b32 v128, 11, v110
  v_bfe_u32 v112, v104, 4, 1
  v_lshl_add_u32 v128, v112, 5, v128
  v_lshrrev_b32 v112, 5, v104
  v_lshl_add_u32 v128, v112, 4, v128
  s_lshl_b32 s32, s36, 18
  s_lshl_b32 s33, s3, 16
  s_add_u32 s32, s32, s33
  s_lshl_b32 s33, s37, 7
  s_add_u32 s32, s32, s33
  v_add_u32 v128, s32, v128
  s_waitcnt vmcnt(6)
  s_barrier
  ds_read_b64_tr_b16 a[180:181], v118 offset:1024
  ds_read_b64_tr_b16 a[182:183], v118 offset:1536
  ds_read_b128 a[188:191], v119 offset:12288
  ds_read_b64_tr_b16 a[184:185], v118 offset:2048
  ds_read_b64_tr_b16 a[186:187], v118 offset:2560
  ds_read_b64_tr_b16 a[132:133], v114 offset:0
  ds_read_b64_tr_b16 a[134:135], v114 offset:512
  ds_read_b64_tr_b16 a[136:137], v115 offset:0
  ds_read_b64_tr_b16 a[138:139], v115 offset:512
  ds_read_b64_tr_b16 a[140:141], v116 offset:0
  ds_read_b64_tr_b16 a[142:143], v116 offset:512
  ds_read_b64_tr_b16 a[144:145], v117 offset:0
  ds_read_b64_tr_b16 a[146:147], v117 offset:512
  ds_read_b64_tr_b16 a[148:149], v114 offset:1024
  ds_read_b64_tr_b16 a[150:151], v114 offset:1536
  ds_read_b64_tr_b16 a[152:153], v115 offset:1024
  ds_read_b64_tr_b16 a[154:155], v115 offset:1536
  ds_read_b64_tr_b16 a[156:157], v116 offset:1024
  ds_read_b64_tr_b16 a[158:159], v116 offset:1536
  ds_read_b64_tr_b16 a[160:161], v117 offset:1024
  ds_read_b64_tr_b16 a[162:163], v117 offset:1536
  ds_read_b64_tr_b16 a[164:165], v114 offset:2048
  ds_read_b64_tr_b16 a[166:167], v114 offset:2560
  ds_read_b64_tr_b16 a[168:169], v115 offset:2048
  ds_read_b64_tr_b16 a[170:171], v115 offset:2560
  ds_read_b64_tr_b16 a[172:173], v116 offset:2048
  ds_read_b64_tr_b16 a[174:175], v116 offset:2560
  ds_read_b64_tr_b16 a[176:177], v117 offset:2048
  ds_read_b64_tr_b16 a[178:179], v117 offset:2560
  s_waitcnt vmcnt(3) lgkmcnt(10)
  s_barrier
  v_mfma_f32_16x16x32_bf16 v[96:99], a[180:183], a[188:191], 0
  ds_read_b64_tr_b16 a[180:181], v118 offset:14336
  s_add_u32 m0, s39, 39936
  v_mfma_f32_16x16x32_bf16 v[100:103], a[188:191], a[184:187], 0
  buffer_load_dword v106, s[4:7], s16 offen sc1 lds
  v_mfma_f32_16x16x32_bf16 v[0:3], a[132:135], a[0:3], 0
  buffer_load_dwordx4 a[24:27], v105, s[4:7], s16 offen sc1
  v_mfma_f32_16x16x32_bf16 v[48:51], a[132:135], a[4:7], 0
  ds_read_b64_tr_b16 a[182:183], v118 offset:14848
  buffer_load_dwordx4 a[28:31], v105, s[4:7], s16 offen offset:1024 sc1
  v_mfma_f32_16x16x32_bf16 v[4:7], a[136:139], a[0:3], 0
  ds_read_b128 a[188:191], v119 offset:25600
  ds_read_b64_tr_b16 a[184:185], v118 offset:15360
  ds_read_b64_tr_b16 a[186:187], v118 offset:15872
  s_add_u32 s16, s16, 131072
  v_mfma_f32_16x16x32_bf16 v[52:55], a[136:139], a[4:7], 0
  ds_read_b64_tr_b16 a[132:133], v114 offset:13312
  s_bitset0_b32 s16, 20
  v_mfma_f32_16x16x32_bf16 v[8:11], a[140:143], a[0:3], 0
  ds_read_b64_tr_b16 a[134:135], v114 offset:13824
  s_add_u32 m0, s39, 53248
  v_mfma_f32_16x16x32_bf16 v[56:59], a[140:143], a[4:7], 0
  buffer_load_dword v106, s[4:7], s16 offen sc1 lds
  v_mfma_f32_16x16x32_bf16 v[12:15], a[144:147], a[0:3], 0
  ds_read_b64_tr_b16 a[136:137], v115 offset:13312
  ds_read_b64_tr_b16 a[138:139], v115 offset:13824
  buffer_load_dwordx4 a[32:35], v105, s[4:7], s16 offen sc1
  v_mfma_f32_16x16x32_bf16 v[60:63], a[144:147], a[4:7], 0
  buffer_load_dwordx4 a[36:39], v105, s[4:7], s16 offen offset:1024 sc1
  v_mfma_f32_16x16x32_bf16 v[16:19], a[148:151], a[0:3], 0
  ds_read_b64_tr_b16 a[140:141], v116 offset:13312
  ds_read_b64_tr_b16 a[142:143], v116 offset:13824
  s_add_u32 s16, s16, 131072
  v_mfma_f32_16x16x32_bf16 v[64:67], a[148:151], a[4:7], 0
  ds_read_b64_tr_b16 a[144:145], v117 offset:13312
  s_bitset0_b32 s16, 20
  v_mfma_f32_16x16x32_bf16 v[20:23], a[152:155], a[0:3], 0
  ds_read_b64_tr_b16 a[146:147], v117 offset:13824
  s_add_u32 m0, s39, 66560
  v_mfma_f32_16x16x32_bf16 v[68:71], a[152:155], a[4:7], 0
  buffer_load_dword v106, s[4:7], s16 offen sc1 lds
  v_mfma_f32_16x16x32_bf16 v[24:27], a[156:159], a[0:3], 0
  ds_read_b64_tr_b16 a[148:149], v114 offset:14336
  ds_read_b64_tr_b16 a[150:151], v114 offset:14848
  buffer_load_dwordx4 a[40:43], v105, s[4:7], s16 offen sc1
  v_mfma_f32_16x16x32_bf16 v[72:75], a[156:159], a[4:7], 0
  buffer_load_dwordx4 a[44:47], v105, s[4:7], s16 offen offset:1024 sc1
  s_waitcnt lgkmcnt(10)
  v_mfma_f32_16x16x32_bf16 v[28:31], a[160:163], a[0:3], 0
  ds_read_b64_tr_b16 a[152:153], v115 offset:14336
  ds_read_b64_tr_b16 a[154:155], v115 offset:14848
  s_add_u32 s16, s16, 131072
  v_mfma_f32_16x16x32_bf16 v[76:79], a[160:163], a[4:7], 0
  ds_read_b64_tr_b16 a[156:157], v116 offset:14336
  s_bitset0_b32 s16, 20
  v_mfma_f32_16x16x32_bf16 v[32:35], a[0:3], a[164:167], 0
  ds_read_b64_tr_b16 a[158:159], v116 offset:14848
  s_add_u32 m0, s39, 79872
  v_mfma_f32_16x16x32_bf16 v[80:83], a[4:7], a[164:167], 0
  buffer_load_dword v106, s[4:7], s16 offen sc1 lds
  v_mfma_f32_16x16x32_bf16 v[36:39], a[0:3], a[168:171], 0
  ds_read_b64_tr_b16 a[160:161], v117 offset:14336
  ds_read_b64_tr_b16 a[162:163], v117 offset:14848
  buffer_load_dwordx4 a[48:51], v105, s[4:7], s16 offen sc1
  v_mfma_f32_16x16x32_bf16 v[84:87], a[4:7], a[168:171], 0
  buffer_load_dwordx4 a[52:55], v105, s[4:7], s16 offen offset:1024 sc1
  v_mfma_f32_16x16x32_bf16 v[40:43], a[0:3], a[172:175], 0
  ds_read_b64_tr_b16 a[164:165], v114 offset:15360
  ds_read_b64_tr_b16 a[166:167], v114 offset:15872
  s_add_u32 s16, s16, 131072
  v_mfma_f32_16x16x32_bf16 v[88:91], a[4:7], a[172:175], 0
  ds_read_b64_tr_b16 a[168:169], v115 offset:15360
  s_bitset0_b32 s16, 20
  v_mfma_f32_16x16x32_bf16 v[44:47], a[0:3], a[176:179], 0
  ds_read_b64_tr_b16 a[170:171], v115 offset:15872
  ds_read_b64_tr_b16 a[172:173], v116 offset:15360
  v_mfma_f32_16x16x32_bf16 v[92:95], a[4:7], a[176:179], 0
  s_waitcnt vmcnt(12) lgkmcnt(10)
  s_barrier
  v_mfma_f32_16x16x32_bf16 v[96:99], a[180:183], a[188:191], v[96:99]
  ds_read_b64_tr_b16 a[174:175], v116 offset:15872
  s_add_u32 m0, s38, 93184
  v_mfma_f32_16x16x32_bf16 v[100:103], a[188:191], a[184:187], v[100:103]
  buffer_load_dwordx4 v107, s[8:11], s17 offen lds
  v_mfma_f32_16x16x32_bf16 v[0:3], a[132:135], a[8:11], v[0:3]
  ds_read_b64_tr_b16 a[176:177], v117 offset:15360
  ds_read_b64_tr_b16 a[178:179], v117 offset:15872
  v_mfma_f32_16x16x32_bf16 v[48:51], a[132:135], a[12:15], v[48:51]
  ds_read_b64_tr_b16 a[180:181], v118 offset:27648
  ds_read_b64_tr_b16 a[182:183], v118 offset:28160
  buffer_load_dword v127, v126, s[64:67], 0 offen sc1
  v_mfma_f32_16x16x32_bf16 v[4:7], a[136:139], a[8:11], v[4:7]
  ds_read_b128 a[188:191], v119 offset:38912
  ds_read_b64_tr_b16 a[184:185], v118 offset:28672
  ds_read_b64_tr_b16 a[186:187], v118 offset:29184
  buffer_load_dwordx4 v108, s[8:11], s17 offen offset:1024 lds
  v_mfma_f32_16x16x32_bf16 v[52:55], a[136:139], a[12:15], v[52:55]
  buffer_load_dwordx4 v109, s[8:11], s17 offen offset:2048 lds
  v_mfma_f32_16x16x32_bf16 v[8:11], a[140:143], a[8:11], v[8:11]
  ds_read_b64_tr_b16 a[132:133], v114 offset:26624
  ds_read_b64_tr_b16 a[134:135], v114 offset:27136
  v_mfma_f32_16x16x32_bf16 v[56:59], a[140:143], a[12:15], v[56:59]
  ds_read_b64_tr_b16 a[136:137], v115 offset:26624
  s_add_u32 s17, s17, 196608
  v_mfma_f32_16x16x32_bf16 v[12:15], a[144:147], a[8:11], v[12:15]
  ds_read_b64_tr_b16 a[138:139], v115 offset:27136
  s_cmp_eq_u32 s17, s10
  s_cselect_b32 s17, 0, s17
  v_mfma_f32_16x16x32_bf16 v[60:63], a[144:147], a[12:15], v[60:63]
  ds_read_b64_tr_b16 a[140:141], v116 offset:26624
  ds_read_b64_tr_b16 a[142:143], v116 offset:27136
  v_mfma_f32_16x16x32_bf16 v[16:19], a[148:151], a[8:11], v[16:19]
  s_add_u32 s8, s8, s10
  s_addc_u32 s9, s9, 0
  v_mfma_f32_16x16x32_bf16 v[64:67], a[148:151], a[12:15], v[64:67]
  ds_read_b64_tr_b16 a[144:145], v117 offset:26624
  ds_read_b64_tr_b16 a[146:147], v117 offset:27136
  s_waitcnt lgkmcnt(10)
  v_mfma_f32_16x16x32_bf16 v[20:23], a[152:155], a[8:11], v[20:23]
  ds_read_b64_tr_b16 a[148:149], v114 offset:27648
  s_add_u32 m0, s39, 93184
  v_mfma_f32_16x16x32_bf16 v[68:71], a[152:155], a[12:15], v[68:71]
  s_add_u32 s40, s20, 0x40000
  s_addc_u32 s41, s21, 0
  s_mov_b32 s42, 0x0
  s_mov_b32 s43, 0x20000
  s_or_b32 s33, s2, s3
  s_cmp_eq_u32 s33, 0
  s_cselect_b32 s42, 4, 0
  v_mov_b32 v192, s19
  buffer_store_dword v192, v119, s[40:43], 0 offen sc1
  v_mfma_f32_16x16x32_bf16 v[24:27], a[156:159], a[8:11], v[24:27]
  ds_read_b64_tr_b16 a[150:151], v114 offset:28160
  buffer_load_dword v106, s[4:7], s16 offen sc1 lds
  v_mfma_f32_16x16x32_bf16 v[72:75], a[156:159], a[12:15], v[72:75]
  ds_read_b64_tr_b16 a[152:153], v115 offset:27648
  ds_read_b64_tr_b16 a[154:155], v115 offset:28160
  v_mfma_f32_16x16x32_bf16 v[28:31], a[160:163], a[8:11], v[28:31]
  buffer_load_dwordx4 a[56:59], v105, s[4:7], s16 offen sc1
  v_mfma_f32_16x16x32_bf16 v[76:79], a[160:163], a[12:15], v[76:79]
  buffer_load_dwordx4 a[60:63], v105, s[4:7], s16 offen offset:1024 sc1
  v_mfma_f32_16x16x32_bf16 v[32:35], a[8:11], a[164:167], v[32:35]
  ds_read_b64_tr_b16 a[156:157], v116 offset:27648
  ds_read_b64_tr_b16 a[158:159], v116 offset:28160
  v_mfma_f32_16x16x32_bf16 v[80:83], a[12:15], a[164:167], v[80:83]
  ds_read_b64_tr_b16 a[160:161], v117 offset:27648
  s_add_u32 s16, s16, 131072
  v_mfma_f32_16x16x32_bf16 v[36:39], a[8:11], a[168:171], v[36:39]
  ds_read_b64_tr_b16 a[162:163], v117 offset:28160
  ds_read_b64_tr_b16 a[164:165], v114 offset:28672
  v_mfma_f32_16x16x32_bf16 v[84:87], a[12:15], a[168:171], v[84:87]
  ds_read_b64_tr_b16 a[166:167], v114 offset:29184
  s_bitset0_b32 s16, 20
  v_mfma_f32_16x16x32_bf16 v[40:43], a[8:11], a[172:175], v[40:43]
  ds_read_b64_tr_b16 a[168:169], v115 offset:28672
  ds_read_b64_tr_b16 a[170:171], v115 offset:29184
  v_mfma_f32_16x16x32_bf16 v[88:91], a[12:15], a[172:175], v[88:91]
  s_add_u32 s4, s4, s6
  s_addc_u32 s5, s5, 0
  v_mfma_f32_16x16x32_bf16 v[44:47], a[8:11], a[176:179], v[44:47]
  ds_read_b64_tr_b16 a[172:173], v116 offset:28672
  ds_read_b64_tr_b16 a[174:175], v116 offset:29184
  v_mfma_f32_16x16x32_bf16 v[92:95], a[12:15], a[176:179], v[92:95]
  s_waitcnt vmcnt(6) lgkmcnt(10)
  s_barrier
  v_cmp_ne_u32 vcc, s19, v127
  s_nop 1
  s_cmp_lg_u64 vcc, 0
  s_cbranch_scc1 L_slow_9
  L_back_10:
  v_mfma_f32_16x16x32_bf16 v[96:99], a[180:183], a[188:191], v[96:99]
  s_add_u32 m0, s39, 0
  s_nop 0
  buffer_load_dword v106, s[4:7], s16 offen sc1 lds
  v_mfma_f32_16x16x32_bf16 v[100:103], a[188:191], a[184:187], v[100:103]
  buffer_load_dwordx4 a[0:3], v105, s[4:7], s16 offen sc1
  v_mfma_f32_16x16x32_bf16 v[0:3], a[132:135], a[16:19], v[0:3]
  ds_read_b64_tr_b16 a[176:177], v117 offset:28672
  ds_read_b64_tr_b16 a[178:179], v117 offset:29184
  buffer_load_dwordx4 a[4:7], v105, s[4:7], s16 offen offset:1024 sc1
  v_mfma_f32_16x16x32_bf16 v[48:51], a[132:135], a[20:23], v[48:51]
  ds_read_b64_tr_b16 a[180:181], v118 offset:40960
  ds_read_b64_tr_b16 a[182:183], v118 offset:41472
  s_add_u32 s16, s16, 131072
  v_mfma_f32_16x16x32_bf16 v[4:7], a[136:139], a[16:19], v[4:7]
  ds_read_b128 a[188:191], v119 offset:52224
  ds_read_b64_tr_b16 a[184:185], v118 offset:41984
  ds_read_b64_tr_b16 a[186:187], v118 offset:42496
  s_bitset0_b32 s16, 20
  v_mfma_f32_16x16x32_bf16 v[52:55], a[136:139], a[20:23], v[52:55]
  ds_read_b64_tr_b16 a[132:133], v114 offset:39936
  s_add_u32 m0, s38, 0
  v_mfma_f32_16x16x32_bf16 v[8:11], a[140:143], a[16:19], v[8:11]
  ds_read_b64_tr_b16 a[134:135], v114 offset:40448
  buffer_load_dwordx4 v107, s[8:11], s17 offen lds
  buffer_load_dwordx4 v108, s[8:11], s17 offen offset:1024 lds
  v_mfma_f32_16x16x32_bf16 v[56:59], a[140:143], a[20:23], v[56:59]
  buffer_load_dwordx4 v109, s[8:11], s17 offen offset:2048 lds
  v_mfma_f32_16x16x32_bf16 v[12:15], a[144:147], a[16:19], v[12:15]
  ds_read_b64_tr_b16 a[136:137], v115 offset:39936
  ds_read_b64_tr_b16 a[138:139], v115 offset:40448
  s_add_u32 s17, s17, 196608
  v_mfma_f32_16x16x32_bf16 v[60:63], a[144:147], a[20:23], v[60:63]
  ds_read_b64_tr_b16 a[140:141], v116 offset:39936
  s_cmp_eq_u32 s17, s10
  v_mfma_f32_16x16x32_bf16 v[16:19], a[148:151], a[16:19], v[16:19]
  ds_read_b64_tr_b16 a[142:143], v116 offset:40448
  s_cselect_b32 s17, 0, s17
  v_mfma_f32_16x16x32_bf16 v[64:67], a[148:151], a[20:23], v[64:67]
  ds_read_b64_tr_b16 a[144:145], v117 offset:39936
  s_mov_b32 m0, s51
  v_mfma_f32_16x16x32_bf16 v[20:23], a[152:155], a[16:19], v[20:23]
  ds_read_b64_tr_b16 a[146:147], v117 offset:40448
  s_add_u32 s51, s51, 1024
  buffer_load_dwordx4 v129, s[52:55], s50 offen nt lds
  v_mfma_f32_16x16x32_bf16 v[68:71], a[152:155], a[20:23], v[68:71]
  ds_read_b64_tr_b16 a[148:149], v114 offset:40960
  s_add_u32 s50, s50, 98304
  s_waitcnt lgkmcnt(10)
  v_mfma_f32_16x16x32_bf16 v[24:27], a[156:159], a[16:19], v[24:27]
  ds_read_b64_tr_b16 a[150:151], v114 offset:41472
  s_mov_b32 m0, s51
  v_mfma_f32_16x16x32_bf16 v[72:75], a[156:159], a[20:23], v[72:75]
  ds_read_b64_tr_b16 a[152:153], v115 offset:40960
  s_add_u32 s51, s51, 1024
  v_mfma_f32_16x16x32_bf16 v[28:31], a[160:163], a[16:19], v[28:31]
  ds_read_b64_tr_b16 a[154:155], v115 offset:41472
  buffer_load_dwordx4 v129, s[52:55], s50 offen nt lds
  v_mfma_f32_16x16x32_bf16 v[76:79], a[160:163], a[20:23], v[76:79]
  ds_read_b64_tr_b16 a[156:157], v116 offset:40960
  s_add_u32 s50, s50, 98304
  v_mfma_f32_16x16x32_bf16 v[32:35], a[16:19], a[164:167], v[32:35]
  ds_read_b64_tr_b16 a[158:159], v116 offset:41472
  s_mov_b32 m0, s51
  s_add_u32 s51, s51, 1024
  v_mfma_f32_16x16x32_bf16 v[80:83], a[20:23], a[164:167], v[80:83]
  buffer_load_dwordx4 v129, s[52:55], s50 offen nt lds
  v_mfma_f32_16x16x32_bf16 v[36:39], a[16:19], a[168:171], v[36:39]
  ds_read_b64_tr_b16 a[160:161], v117 offset:40960
  ds_read_b64_tr_b16 a[162:163], v117 offset:41472
  s_add_u32 s50, s50, 98304
  v_mfma_f32_16x16x32_bf16 v[84:87], a[20:23], a[168:171], v[84:87]
  ds_read_b64_tr_b16 a[164:165], v114 offset:41984
  s_mov_b32 m0, s51
  v_mfma_f32_16x16x32_bf16 v[40:43], a[16:19], a[172:175], v[40:43]
  ds_read_b64_tr_b16 a[166:167], v114 offset:42496
  s_add_u32 s51, s51, 1024
  v_mfma_f32_16x16x32_bf16 v[88:91], a[20:23], a[172:175], v[88:91]
  buffer_load_dwordx4 v129, s[52:55], s50 offen nt lds
  v_mfma_f32_16x16x32_bf16 v[44:47], a[16:19], a[176:179], v[44:47]
  ds_read_b64_tr_b16 a[168:169], v115 offset:41984
  ds_read_b64_tr_b16 a[170:171], v115 offset:42496
  s_add_u32 s50, s50, 98304
  v_mfma_f32_16x16x32_bf16 v[92:95], a[20:23], a[176:179], v[92:95]
  s_waitcnt vmcnt(24) lgkmcnt(10)
  s_barrier
  v_mfma_f32_16x16x32_bf16 v[96:99], a[180:183], a[188:191], v[96:99]
  ds_read_b64_tr_b16 a[172:173], v116 offset:41984
  ds_read_b64_tr_b16 a[174:175], v116 offset:42496
  v_mfma_f32_16x16x32_bf16 v[100:103], a[188:191], a[184:187], v[100:103]
  ds_read_b64_tr_b16 a[176:177], v117 offset:41984
  ds_read_b64_tr_b16 a[178:179], v117 offset:42496
  v_mfma_f32_16x16x32_bf16 v[0:3], a[132:135], a[24:27], v[0:3]
  ds_read_b64_tr_b16 a[180:181], v124 offset:1024
  ds_read_b64_tr_b16 a[182:183], v124 offset:1536
  v_mfma_f32_16x16x32_bf16 v[48:51], a[132:135], a[28:31], v[48:51]
  ds_read_b128 a[188:191], v125 offset:12288
  ds_read_b64_tr_b16 a[184:185], v124 offset:2048
  v_mfma_f32_16x16x32_bf16 v[4:7], a[136:139], a[24:27], v[4:7]
  ds_read_b64_tr_b16 a[186:187], v124 offset:2560
  ds_read_b64_tr_b16 a[132:133], v120 offset:0
  v_mfma_f32_16x16x32_bf16 v[52:55], a[136:139], a[28:31], v[52:55]
  ds_read_b64_tr_b16 a[134:135], v120 offset:512
  ds_read_b64_tr_b16 a[136:137], v121 offset:0
  v_mfma_f32_16x16x32_bf16 v[8:11], a[140:143], a[24:27], v[8:11]
  ds_read_b64_tr_b16 a[138:139], v121 offset:512
  v_mfma_f32_16x16x32_bf16 v[56:59], a[140:143], a[28:31], v[56:59]
  ds_read_b64_tr_b16 a[140:141], v122 offset:0
  ds_read_b64_tr_b16 a[142:143], v122 offset:512
  v_mfma_f32_16x16x32_bf16 v[12:15], a[144:147], a[24:27], v[12:15]
  v_mfma_f32_16x16x32_bf16 v[60:63], a[144:147], a[28:31], v[60:63]
  ds_read_b64_tr_b16 a[144:145], v123 offset:0
  ds_read_b64_tr_b16 a[146:147], v123 offset:512
  v_mfma_f32_16x16x32_bf16 v[16:19], a[148:151], a[24:27], v[16:19]
  v_mfma_f32_16x16x32_bf16 v[64:67], a[148:151], a[28:31], v[64:67]
  ds_read_b64_tr_b16 a[148:149], v120 offset:1024
  ds_read_b64_tr_b16 a[150:151], v120 offset:1536
  s_waitcnt lgkmcnt(10)
  v_mfma_f32_16x16x32_bf16 v[20:23], a[152:155], a[24:27], v[20:23]
  v_mfma_f32_16x16x32_bf16 v[68:71], a[152:155], a[28:31], v[68:71]
  ds_read_b64_tr_b16 a[152:153], v121 offset:1024
  ds_read_b64_tr_b16 a[154:155], v121 offset:1536
  v_mfma_f32_16x16x32_bf16 v[24:27], a[156:159], a[24:27], v[24:27]
  v_mfma_f32_16x16x32_bf16 v[72:75], a[156:159], a[28:31], v[72:75]
  ds_read_b64_tr_b16 a[156:157], v122 offset:1024
  ds_read_b64_tr_b16 a[158:159], v122 offset:1536
  v_mfma_f32_16x16x32_bf16 v[28:31], a[160:163], a[24:27], v[28:31]
  v_mfma_f32_16x16x32_bf16 v[76:79], a[160:163], a[28:31], v[76:79]
  ds_read_b64_tr_b16 a[160:161], v123 offset:1024
  ds_read_b64_tr_b16 a[162:163], v123 offset:1536
  v_mfma_f32_16x16x32_bf16 v[32:35], a[24:27], a[164:167], v[32:35]
  v_mfma_f32_16x16x32_bf16 v[80:83], a[28:31], a[164:167], v[80:83]
  ds_read_b64_tr_b16 a[164:165], v120 offset:2048
  ds_read_b64_tr_b16 a[166:167], v120 offset:2560
  v_mfma_f32_16x16x32_bf16 v[36:39], a[24:27], a[168:171], v[36:39]
  v_mfma_f32_16x16x32_bf16 v[84:87], a[28:31], a[168:171], v[84:87]
  ds_read_b64_tr_b16 a[168:169], v121 offset:2048
  ds_read_b64_tr_b16 a[170:171], v121 offset:2560
  v_mfma_f32_16x16x32_bf16 v[40:43], a[24:27], a[172:175], v[40:43]
  v_mfma_f32_16x16x32_bf16 v[88:91], a[28:31], a[172:175], v[88:91]
  ds_read_b64_tr_b16 a[172:173], v122 offset:2048
  ds_read_b64_tr_b16 a[174:175], v122 offset:2560
  v_mfma_f32_16x16x32_bf16 v[44:47], a[24:27], a[176:179], v[44:47]
  v_mfma_f32_16x16x32_bf16 v[92:95], a[28:31], a[176:179], v[92:95]
  s_waitcnt vmcnt(21) lgkmcnt(10)
  s_barrier
  v_mfma_f32_16x16x32_bf16 v[96:99], a[180:183], a[188:191], v[96:99]
  buffer_store_dwordx4 v[244:247], v119, s[92:95], s35 offen offset:0 sc1
  v_mfma_f32_16x16x32_bf16 v[100:103], a[188:191], a[184:187], v[100:103]
  ds_read_b64_tr_b16 a[176:177], v123 offset:2048
  ds_read_b64_tr_b16 a[178:179], v123 offset:2560
  v_mfma_f32_16x16x32_bf16 v[0:3], a[132:135], a[32:35], v[0:3]
  ds_read_b64_tr_b16 a[180:181], v124 offset:14336
  ds_read_b64_tr_b16 a[182:183], v124 offset:14848
  v_mfma_f32_16x16x32_bf16 v[48:51], a[132:135], a[36:39], v[48:51]
  ds_read_b128 a[188:191], v125 offset:25600
  ds_read_b64_tr_b16 a[184:185], v124 offset:15360
  v_mfma_f32_16x16x32_bf16 v[4:7], a[136:139], a[32:35], v[4:7]
  ds_read_b64_tr_b16 a[186:187], v124 offset:15872
  ds_read_b64_tr_b16 a[132:133], v120 offset:13312
  v_mfma_f32_16x16x32_bf16 v[52:55], a[136:139], a[36:39], v[52:55]
  ds_read_b64_tr_b16 a[134:135], v120 offset:13824
  ds_read_b64_tr_b16 a[136:137], v121 offset:13312
  v_mfma_f32_16x16x32_bf16 v[8:11], a[140:143], a[32:35], v[8:11]
  ds_read_b64_tr_b16 a[138:139], v121 offset:13824
  v_mfma_f32_16x16x32_bf16 v[56:59], a[140:143], a[36:39], v[56:59]
  ds_read_b64_tr_b16 a[140:141], v122 offset:13312
  ds_read_b64_tr_b16 a[142:143], v122 offset:13824
  v_mfma_f32_16x16x32_bf16 v[12:15], a[144:147], a[32:35], v[12:15]
  v_mfma_f32_16x16x32_bf16 v[60:63], a[144:147], a[36:39], v[60:63]
  ds_read_b64_tr_b16 a[144:145], v123 offset:13312
  ds_read_b64_tr_b16 a[146:147], v123 offset:13824
  v_mfma_f32_16x16x32_bf16 v[16:19], a[148:151], a[32:35], v[16:19]
  v_mfma_f32_16x16x32_bf16 v[64:67], a[148:151], a[36:39], v[64:67]
  ds_read_b64_tr_b16 a[148:149], v120 offset:14336
  ds_read_b64_tr_b16 a[150:151], v120 offset:14848
  v_mfma_f32_16x16x32_bf16 v[20:23], a[152:155], a[32:35], v[20:23]
  v_mfma_f32_16x16x32_bf16 v[68:71], a[152:155], a[36:39], v[68:71]
  ds_read_b64_tr_b16 a[152:153], v121 offset:14336
  ds_read_b64_tr_b16 a[154:155], v121 offset:14848
  s_waitcnt lgkmcnt(10)
  v_mfma_f32_16x16x32_bf16 v[24:27], a[156:159], a[32:35], v[24:27]
  v_mfma_f32_16x16x32_bf16 v[72:75], a[156:159], a[36:39], v[72:75]
  ds_read_b64_tr_b16 a[156:157], v122 offset:14336
  ds_read_b64_tr_b16 a[158:159], v122 offset:14848
  v_mfma_f32_16x16x32_bf16 v[28:31], a[160:163], a[32:35], v[28:31]
  v_mfma_f32_16x16x32_bf16 v[76:79], a[160:163], a[36:39], v[76:79]
  ds_read_b64_tr_b16 a[160:161], v123 offset:14336
  ds_read_b64_tr_b16 a[162:163], v123 offset:14848
  v_mfma_f32_16x16x32_bf16 v[32:35], a[32:35], a[164:167], v[32:35]
  v_mfma_f32_16x16x32_bf16 v[80:83], a[36:39], a[164:167], v[80:83]
  ds_read_b64_tr_b16 a[164:165], v120 offset:15360
  ds_read_b64_tr_b16 a[166:167], v120 offset:15872
  v_mfma_f32_16x16x32_bf16 v[36:39], a[32:35], a[168:171], v[36:39]
  v_mfma_f32_16x16x32_bf16 v[84:87], a[36:39], a[168:171], v[84:87]
  ds_read_b64_tr_b16 a[168:169], v121 offset:15360
  ds_read_b64_tr_b16 a[170:171], v121 offset:15872
  v_mfma_f32_16x16x32_bf16 v[40:43], a[32:35], a[172:175], v[40:43]
  v_mfma_f32_16x16x32_bf16 v[88:91], a[36:39], a[172:175], v[88:91]
  ds_read_b64_tr_b16 a[172:173], v122 offset:15360
  ds_read_b64_tr_b16 a[174:175], v122 offset:15872
  v_mfma_f32_16x16x32_bf16 v[44:47], a[32:35], a[176:179], v[44:47]
  v_mfma_f32_16x16x32_bf16 v[92:95], a[36:39], a[176:179], v[92:95]
  s_waitcnt vmcnt(19) lgkmcnt(10)
  s_barrier
  v_mfma_f32_16x16x32_bf16 v[96:99], a[180:183], a[188:191], v[96:99]
  ds_read_b64_tr_b16 a[176:177], v123 offset:15360
  s_add_u32 m0, s38, 13312
  v_mfma_f32_16x16x32_bf16 v[100:103], a[188:191], a[184:187], v[100:103]
  buffer_load_dwordx4 v107, s[8:11], s17 offen lds
  v_mfma_f32_16x16x32_bf16 v[0:3], a[132:135], a[40:43], v[0:3]
  ds_read_b64_tr_b16 a[178:179], v123 offset:15872
  buffer_load_dwordx4 v108, s[8:11], s17 offen offset:1024 lds
  v_mfma_f32_16x16x32_bf16 v[48:51], a[132:135], a[44:47], v[48:51]
  ds_read_b64_tr_b16 a[180:181], v124 offset:27648
  ds_read_b64_tr_b16 a[182:183], v124 offset:28160
  buffer_load_dwordx4 v109, s[8:11], s17 offen offset:2048 lds
  v_mfma_f32_16x16x32_bf16 v[4:7], a[136:139], a[40:43], v[4:7]
  ds_read_b128 a[188:191], v125 offset:38912
  ds_read_b64_tr_b16 a[184:185], v124 offset:28672
  ds_read_b64_tr_b16 a[186:187], v124 offset:29184
  v_mfma_f32_16x16x32_bf16 v[52:55], a[136:139], a[44:47], v[52:55]
  ds_read_b64_tr_b16 a[132:133], v120 offset:26624
  s_add_u32 s17, s17, 196608
  v_mfma_f32_16x16x32_bf16 v[8:11], a[140:143], a[40:43], v[8:11]
  ds_read_b64_tr_b16 a[134:135], v120 offset:27136
  s_cmp_eq_u32 s17, s10
  v_mfma_f32_16x16x32_bf16 v[56:59], a[140:143], a[44:47], v[56:59]
  ds_read_b64_tr_b16 a[136:137], v121 offset:26624
  s_cselect_b32 s17, 0, s17
  v_mfma_f32_16x16x32_bf16 v[12:15], a[144:147], a[40:43], v[12:15]
  ds_read_b64_tr_b16 a[138:139], v121 offset:27136
  s_add_u32 m0, s39, 13312
  v_mfma_f32_16x16x32_bf16 v[60:63], a[144:147], a[44:47], v[60:63]
  ds_read_b64_tr_b16 a[140:141], v122 offset:26624
  ds_read_b64_tr_b16 a[142:143], v122 offset:27136
  v_mfma_f32_16x16x32_bf16 v[16:19], a[148:151], a[40:43], v[16:19]
  buffer_load_dword v106, s[4:7], s16 offen sc1 lds
  v_mfma_f32_16x16x32_bf16 v[64:67], a[148:151], a[44:47], v[64:67]
  buffer_load_dwordx4 a[8:11], v105, s[4:7], s16 offen sc1
  v_mfma_f32_16x16x32_bf16 v[20:23], a[152:155], a[40:43], v[20:23]
  ds_read_b64_tr_b16 a[144:145], v123 offset:26624
  ds_read_b64_tr_b16 a[146:147], v123 offset:27136
  buffer_load_dwordx4 a[12:15], v105, s[4:7], s16 offen offset:1024 sc1
  v_mfma_f32_16x16x32_bf16 v[68:71], a[152:155], a[44:47], v[68:71]
  ds_read_b64_tr_b16 a[148:149], v120 offset:27648
  s_add_u32 s16, s16, 131072
  s_waitcnt lgkmcnt(10)
  v_mfma_f32_16x16x32_bf16 v[24:27], a[156:159], a[40:43], v[24:27]
  ds_read_b64_tr_b16 a[150:151], v120 offset:28160
  ds_read_b64_tr_b16 a[152:153], v121 offset:27648
  v_mfma_f32_16x16x32_bf16 v[72:75], a[156:159], a[44:47], v[72:75]
  ds_read_b64_tr_b16 a[154:155], v121 offset:28160
  s_bitset0_b32 s16, 20
  v_mfma_f32_16x16x32_bf16 v[28:31], a[160:163], a[40:43], v[28:31]
  ds_read_b64_tr_b16 a[156:157], v122 offset:27648
  s_add_u32 m0, s38, 26624
  v_mfma_f32_16x16x32_bf16 v[76:79], a[160:163], a[44:47], v[76:79]
  buffer_load_dwordx4 v107, s[8:11], s17 offen lds
  v_mfma_f32_16x16x32_bf16 v[32:35], a[40:43], a[164:167], v[32:35]
  ds_read_b64_tr_b16 a[158:159], v122 offset:28160
  buffer_load_dwordx4 v108, s[8:11], s17 offen offset:1024 lds
  v_mfma_f32_16x16x32_bf16 v[80:83], a[44:47], a[164:167], v[80:83]
  ds_read_b64_tr_b16 a[160:161], v123 offset:27648
  ds_read_b64_tr_b16 a[162:163], v123 offset:28160
  v_mfma_f32_16x16x32_bf16 v[36:39], a[40:43], a[168:171], v[36:39]
  buffer_load_dwordx4 v109, s[8:11], s17 offen offset:2048 lds
  v_mfma_f32_16x16x32_bf16 v[84:87], a[44:47], a[168:171], v[84:87]
  ds_read_b64_tr_b16 a[164:165], v120 offset:28672
  s_add_u32 s17, s17, 196608
  v_mfma_f32_16x16x32_bf16 v[40:43], a[40:43], a[172:175], v[40:43]
  ds_read_b64_tr_b16 a[166:167], v120 offset:29184
  s_cmp_eq_u32 s17, s10
  v_mfma_f32_16x16x32_bf16 v[88:91], a[44:47], a[172:175], v[88:91]
  ds_read_b64_tr_b16 a[168:169], v121 offset:28672
  s_cselect_b32 s17, 0, s17
  v_mfma_f32_16x16x32_bf16 v[44:47], a[40:43], a[176:179], v[44:47]
  ds_read_b64_tr_b16 a[170:171], v121 offset:29184
  ds_read_b64_tr_b16 a[172:173], v122 offset:28672
  v_mfma_f32_16x16x32_bf16 v[92:95], a[44:47], a[176:179], v[92:95]
  s_waitcnt vmcnt(20) lgkmcnt(10)
  s_barrier
  v_mfma_f32_16x16x32_bf16 v[96:99], a[180:183], a[188:191], v[96:99]
  ds_read_b64_tr_b16 a[174:175], v122 offset:29184
  s_add_u32 m0, s39, 26624
  v_mfma_f32_16x16x32_bf16 v[100:103], a[188:191], a[184:187], v[100:103]
  buffer_load_dword v106, s[4:7], s16 offen sc1 lds
  v_mfma_f32_16x16x32_bf16 v[0:3], a[132:135], a[48:51], v[0:3]
  ds_read_b64_tr_b16 a[176:177], v123 offset:28672
  ds_read_b64_tr_b16 a[178:179], v123 offset:29184
  buffer_load_dwordx4 a[16:19], v105, s[4:7], s16 offen sc1
  v_mfma_f32_16x16x32_bf16 v[48:51], a[132:135], a[52:55], v[48:51]
  ds_read_b64_tr_b16 a[180:181], v124 offset:40960
  ds_read_b64_tr_b16 a[182:183], v124 offset:41472
  buffer_load_dwordx4 a[20:23], v105, s[4:7], s16 offen offset:1024 sc1
  v_mfma_f32_16x16x32_bf16 v[4:7], a[136:139], a[48:51], v[4:7]
  ds_read_b128 a[188:191], v125 offset:52224
  ds_read_b64_tr_b16 a[184:185], v124 offset:41984
  ds_read_b64_tr_b16 a[186:187], v124 offset:42496
  v_mfma_f32_16x16x32_bf16 v[52:55], a[136:139], a[52:55], v[52:55]
  ds_read_b64_tr_b16 a[132:133], v120 offset:39936
  s_add_u32 s16, s16, 131072
  v_mfma_f32_16x16x32_bf16 v[8:11], a[140:143], a[48:51], v[8:11]
  ds_read_b64_tr_b16 a[134:135], v120 offset:40448
  s_bitset0_b32 s16, 20
  v_mfma_f32_16x16x32_bf16 v[56:59], a[140:143], a[52:55], v[56:59]
  ds_read_b64_tr_b16 a[136:137], v121 offset:39936
  s_add_u32 m0, s38, 39936
  v_mfma_f32_16x16x32_bf16 v[12:15], a[144:147], a[48:51], v[12:15]
  ds_read_b64_tr_b16 a[138:139], v121 offset:40448
  ds_read_b64_tr_b16 a[140:141], v122 offset:39936
  v_mfma_f32_16x16x32_bf16 v[60:63], a[144:147], a[52:55], v[60:63]
  buffer_load_dwordx4 v107, s[8:11], s17 offen lds
  v_mfma_f32_16x16x32_bf16 v[16:19], a[148:151], a[48:51], v[16:19]
  ds_read_b64_tr_b16 a[142:143], v122 offset:40448
  buffer_load_dwordx4 v108, s[8:11], s17 offen offset:1024 lds
  v_mfma_f32_16x16x32_bf16 v[64:67], a[148:151], a[52:55], v[64:67]
  buffer_load_dwordx4 v109, s[8:11], s17 offen offset:2048 lds
  s_waitcnt lgkmcnt(10)
  v_mfma_f32_16x16x32_bf16 v[20:23], a[152:155], a[48:51], v[20:23]
  ds_read_b64_tr_b16 a[144:145], v123 offset:39936
  ds_read_b64_tr_b16 a[146:147], v123 offset:40448
  v_mfma_f32_16x16x32_bf16 v[68:71], a[152:155], a[52:55], v[68:71]
  ds_read_b64_tr_b16 a[148:149], v120 offset:40960
  s_add_u32 s17, s17, 196608
  v_mfma_f32_16x16x32_bf16 v[24:27], a[156:159], a[48:51], v[24:27]
  ds_read_b64_tr_b16 a[150:151], v120 offset:41472
  s_cmp_eq_u32 s17, s10
  v_mfma_f32_16x16x32_bf16 v[72:75], a[156:159], a[52:55], v[72:75]
  ds_read_b64_tr_b16 a[152:153], v121 offset:40960
  s_cselect_b32 s17, 0, s17
  v_mfma_f32_16x16x32_bf16 v[28:31], a[160:163], a[48:51], v[28:31]
  ds_read_b64_tr_b16 a[154:155], v121 offset:41472
  ds_read_b64_tr_b16 a[156:157], v122 offset:40960
  v_mfma_f32_16x16x32_bf16 v[76:79], a[160:163], a[52:55], v[76:79]
  ds_read_b64_tr_b16 a[158:159], v122 offset:41472
  s_add_u32 m0, s39, 39936
  v_mfma_f32_16x16x32_bf16 v[32:35], a[48:51], a[164:167], v[32:35]
  buffer_load_dword v106, s[4:7], s16 offen sc1 lds
  v_mfma_f32_16x16x32_bf16 v[80:83], a[52:55], a[164:167], v[80:83]
  buffer_load_dwordx4 a[24:27], v105, s[4:7], s16 offen sc1
  v_mfma_f32_16x16x32_bf16 v[36:39], a[48:51], a[168:171], v[36:39]
  ds_read_b64_tr_b16 a[160:161], v123 offset:40960
  ds_read_b64_tr_b16 a[162:163], v123 offset:41472
  v_mfma_f32_16x16x32_bf16 v[84:87], a[52:55], a[168:171], v[84:87]
  buffer_load_dwordx4 a[28:31], v105, s[4:7], s16 offen offset:1024 sc1
  v_mfma_f32_16x16x32_bf16 v[40:43], a[48:51], a[172:175], v[40:43]
  ds_read_b64_tr_b16 a[164:165], v120 offset:41984
  ds_read_b64_tr_b16 a[166:167], v120 offset:42496
  s_add_u32 s16, s16, 131072
  v_mfma_f32_16x16x32_bf16 v[88:91], a[52:55], a[172:175], v[88:91]
  ds_read_b64_tr_b16 a[168:169], v121 offset:41984
  s_bitset0_b32 s16, 20
  v_mfma_f32_16x16x32_bf16 v[44:47], a[48:51], a[176:179], v[44:47]
  ds_read_b64_tr_b16 a[170:171], v121 offset:42496
  ds_read_b64_tr_b16 a[172:173], v122 offset:41984
  v_mfma_f32_16x16x32_bf16 v[92:95], a[52:55], a[176:179], v[92:95]
  s_waitcnt vmcnt(23) lgkmcnt(10)
  s_barrier
  v_mfma_f32_16x16x32_bf16 v[96:99], a[180:183], a[188:191], v[96:99]
  ds_read_b64_tr_b16 a[174:175], v122 offset:42496
  s_add_u32 m0, s38, 53248
  v_mfma_f32_16x16x32_bf16 v[100:103], a[188:191], a[184:187], v[100:103]
  buffer_load_dwordx4 v107, s[8:11], s17 offen lds
  v_mfma_f32_16x16x32_bf16 v[0:3], a[132:135], a[56:59], v[0:3]
  ds_read_b64_tr_b16 a[176:177], v123 offset:41984
  ds_read_b64_tr_b16 a[178:179], v123 offset:42496
  buffer_load_dwordx4 v108, s[8:11], s17 offen offset:1024 lds
  v_mfma_f32_16x16x32_bf16 v[48:51], a[132:135], a[60:63], v[48:51]
  ds_read_b64_tr_b16 a[180:181], v118 offset:1024
  ds_read_b64_tr_b16 a[182:183], v118 offset:1536
  buffer_load_dwordx4 v109, s[8:11], s17 offen offset:2048 lds
  v_mfma_f32_16x16x32_bf16 v[4:7], a[136:139], a[56:59], v[4:7]
  ds_read_b128 a[188:191], v119 offset:12288
  ds_read_b64_tr_b16 a[184:185], v118 offset:2048
  ds_read_b64_tr_b16 a[186:187], v118 offset:2560
  v_mfma_f32_16x16x32_bf16 v[52:55], a[136:139], a[60:63], v[52:55]
  ds_read_b64_tr_b16 a[132:133], v114 offset:0
  s_add_u32 s17, s17, 196608
  v_mfma_f32_16x16x32_bf16 v[8:11], a[140:143], a[56:59], v[8:11]
  ds_read_b64_tr_b16 a[134:135], v114 offset:512
  s_cmp_eq_u32 s17, s10
  v_mfma_f32_16x16x32_bf16 v[56:59], a[140:143], a[60:63], v[56:59]
  ds_read_b64_tr_b16 a[136:137], v115 offset:0
  s_cselect_b32 s17, 0, s17
  v_mfma_f32_16x16x32_bf16 v[12:15], a[144:147], a[56:59], v[12:15]
  ds_read_b64_tr_b16 a[138:139], v115 offset:512
  s_add_u32 m0, s39, 53248
  v_mfma_f32_16x16x32_bf16 v[60:63], a[144:147], a[60:63], v[60:63]
  ds_read_b64_tr_b16 a[140:141], v116 offset:0
  ds_read_b64_tr_b16 a[142:143], v116 offset:512
  v_mfma_f32_16x16x32_bf16 v[16:19], a[148:151], a[56:59], v[16:19]
  buffer_load_dword v106, s[4:7], s16 offen sc1 lds
  v_mfma_f32_16x16x32_bf16 v[64:67], a[148:151], a[60:63], v[64:67]
  buffer_load_dwordx4 a[32:35], v105, s[4:7], s16 offen sc1
  s_waitcnt lgkmcnt(10)
  v_mfma_f32_16x16x32_bf16 v[20:23], a[152:155], a[56:59], v[20:23]
  ds_read_b64_tr_b16 a[144:145], v117 offset:0
  ds_read_b64_tr_b16 a[146:147], v117 offset:512
  buffer_load_dwordx4 a[36:39], v105, s[4:7], s16 offen offset:1024 sc1
  v_mfma_f32_16x16x32_bf16 v[68:71], a[152:155], a[60:63], v[68:71]
  ds_read_b64_tr_b16 a[148:149], v114 offset:1024
  s_add_u32 s16, s16, 131072
  v_mfma_f32_16x16x32_bf16 v[24:27], a[156:159], a[56:59], v[24:27]
  ds_read_b64_tr_b16 a[150:151], v114 offset:1536
  ds_read_b64_tr_b16 a[152:153], v115 offset:1024
  v_mfma_f32_16x16x32_bf16 v[72:75], a[156:159], a[60:63], v[72:75]
  ds_read_b64_tr_b16 a[154:155], v115 offset:1536
  s_bitset0_b32 s16, 20
  v_mfma_f32_16x16x32_bf16 v[28:31], a[160:163], a[56:59], v[28:31]
  ds_read_b64_tr_b16 a[156:157], v116 offset:1024
  s_add_u32 m0, s38, 66560
  v_mfma_f32_16x16x32_bf16 v[76:79], a[160:163], a[60:63], v[76:79]
  buffer_load_dwordx4 v107, s[8:11], s17 offen lds
  v_mfma_f32_16x16x32_bf16 v[32:35], a[56:59], a[164:167], v[32:35]
  ds_read_b64_tr_b16 a[158:159], v116 offset:1536
  buffer_load_dwordx4 v108, s[8:11], s17 offen offset:1024 lds
  v_mfma_f32_16x16x32_bf16 v[80:83], a[60:63], a[164:167], v[80:83]
  ds_read_b64_tr_b16 a[160:161], v117 offset:1024
  ds_read_b64_tr_b16 a[162:163], v117 offset:1536
  v_mfma_f32_16x16x32_bf16 v[36:39], a[56:59], a[168:171], v[36:39]
  buffer_load_dwordx4 v109, s[8:11], s17 offen offset:2048 lds
  v_mfma_f32_16x16x32_bf16 v[84:87], a[60:63], a[168:171], v[84:87]
  ds_read_b64_tr_b16 a[164:165], v114 offset:2048
  s_add_u32 s17, s17, 196608
  v_mfma_f32_16x16x32_bf16 v[40:43], a[56:59], a[172:175], v[40:43]
  ds_read_b64_tr_b16 a[166:167], v114 offset:2560
  s_cmp_eq_u32 s17, s10
  v_mfma_f32_16x16x32_bf16 v[88:91], a[60:63], a[172:175], v[88:91]
  ds_read_b64_tr_b16 a[168:169], v115 offset:2048
  s_cselect_b32 s17, 0, s17
  v_mfma_f32_16x16x32_bf16 v[44:47], a[56:59], a[176:179], v[44:47]
  ds_read_b64_tr_b16 a[170:171], v115 offset:2560
  ds_read_b64_tr_b16 a[172:173], v116 offset:2048
  v_mfma_f32_16x16x32_bf16 v[92:95], a[60:63], a[176:179], v[92:95]
  s_waitcnt vmcnt(21) lgkmcnt(10)
  s_barrier
  v_mfma_f32_16x16x32_bf16 v[96:99], a[180:183], a[188:191], v[96:99]
  ds_read_b64_tr_b16 a[174:175], v116 offset:2560
  s_add_u32 m0, s39, 66560
  v_mfma_f32_16x16x32_bf16 v[100:103], a[188:191], a[184:187], v[100:103]
  buffer_load_dword v106, s[4:7], s16 offen sc1 lds
  v_mfma_f32_16x16x32_bf16 v[0:3], a[132:135], a[0:3], v[0:3]
  ds_read_b64_tr_b16 a[176:177], v117 offset:2048
  ds_read_b64_tr_b16 a[178:179], v117 offset:2560
  buffer_load_dwordx4 a[40:43], v105, s[4:7], s16 offen sc1
  v_mfma_f32_16x16x32_bf16 v[48:51], a[132:135], a[4:7], v[48:51]
  ds_read_b64_tr_b16 a[180:181], v118 offset:14336
  ds_read_b64_tr_b16 a[182:183], v118 offset:14848
  buffer_load_dwordx4 a[44:47], v105, s[4:7], s16 offen offset:1024 sc1
  v_mfma_f32_16x16x32_bf16 v[4:7], a[136:139], a[0:3], v[4:7]
  ds_read_b128 a[188:191], v119 offset:25600
  ds_read_b64_tr_b16 a[184:185], v118 offset:15360
  ds_read_b64_tr_b16 a[186:187], v118 offset:15872
  v_mfma_f32_16x16x32_bf16 v[52:55], a[136:139], a[4:7], v[52:55]
  ds_read_b64_tr_b16 a[132:133], v114 offset:13312
  s_add_u32 s16, s16, 131072
  v_mfma_f32_16x16x32_bf16 v[8:11], a[140:143], a[0:3], v[8:11]
  ds_read_b64_tr_b16 a[134:135], v114 offset:13824
  s_bitset0_b32 s16, 20
  v_mfma_f32_16x16x32_bf16 v[56:59], a[140:143], a[4:7], v[56:59]
  ds_read_b64_tr_b16 a[136:137], v115 offset:13312
  s_add_u32 m0, s38, 79872
  v_mfma_f32_16x16x32_bf16 v[12:15], a[144:147], a[0:3], v[12:15]
  ds_read_b64_tr_b16 a[138:139], v115 offset:13824
  buffer_load_dwordx4 v107, s[8:11], s17 offen lds
  v_mfma_f32_16x16x32_bf16 v[60:63], a[144:147], a[4:7], v[60:63]
  ds_read_b64_tr_b16 a[140:141], v116 offset:13312
  ds_read_b64_tr_b16 a[142:143], v116 offset:13824
  v_mfma_f32_16x16x32_bf16 v[16:19], a[148:151], a[0:3], v[16:19]
  buffer_load_dwordx4 v108, s[8:11], s17 offen offset:1024 lds
  v_mfma_f32_16x16x32_bf16 v[64:67], a[148:151], a[4:7], v[64:67]
  buffer_load_dwordx4 v109, s[8:11], s17 offen offset:2048 lds
  s_waitcnt lgkmcnt(10)
  v_mfma_f32_16x16x32_bf16 v[20:23], a[152:155], a[0:3], v[20:23]
  ds_read_b64_tr_b16 a[144:145], v117 offset:13312
  ds_read_b64_tr_b16 a[146:147], v117 offset:13824
  s_add_u32 s17, s17, 196608
  v_mfma_f32_16x16x32_bf16 v[68:71], a[152:155], a[4:7], v[68:71]
  ds_read_b64_tr_b16 a[148:149], v114 offset:14336
  s_cmp_eq_u32 s17, s10
  v_mfma_f32_16x16x32_bf16 v[24:27], a[156:159], a[0:3], v[24:27]
  ds_read_b64_tr_b16 a[150:151], v114 offset:14848
  ds_read_b64_tr_b16 a[152:153], v115 offset:14336
  v_mfma_f32_16x16x32_bf16 v[72:75], a[156:159], a[4:7], v[72:75]
  ds_read_b64_tr_b16 a[154:155], v115 offset:14848
  s_cselect_b32 s17, 0, s17
  v_mfma_f32_16x16x32_bf16 v[28:31], a[160:163], a[0:3], v[28:31]
  ds_read_b64_tr_b16 a[156:157], v116 offset:14336
  s_add_u32 m0, s39, 79872
  v_mfma_f32_16x16x32_bf16 v[76:79], a[160:163], a[4:7], v[76:79]
  buffer_load_dword v106, s[4:7], s16 offen sc1 lds
  v_mfma_f32_16x16x32_bf16 v[32:35], a[0:3], a[164:167], v[32:35]
  ds_read_b64_tr_b16 a[158:159], v116 offset:14848
  buffer_load_dwordx4 a[48:51], v105, s[4:7], s16 offen sc1
  v_mfma_f32_16x16x32_bf16 v[80:83], a[4:7], a[164:167], v[80:83]
  ds_read_b64_tr_b16 a[160:161], v117 offset:14336
  ds_read_b64_tr_b16 a[162:163], v117 offset:14848
  v_mfma_f32_16x16x32_bf16 v[36:39], a[0:3], a[168:171], v[36:39]
  buffer_load_dwordx4 a[52:55], v105, s[4:7], s16 offen offset:1024 sc1
  v_mfma_f32_16x16x32_bf16 v[84:87], a[4:7], a[168:171], v[84:87]
  ds_read_b64_tr_b16 a[164:165], v114 offset:15360
  s_add_u32 s16, s16, 131072
  v_mfma_f32_16x16x32_bf16 v[40:43], a[0:3], a[172:175], v[40:43]
  ds_read_b64_tr_b16 a[166:167], v114 offset:15872
  s_bitset0_b32 s16, 20
  v_mfma_f32_16x16x32_bf16 v[88:91], a[4:7], a[172:175], v[88:91]
  buffer_store_dwordx4 v[244:247], v119, s[92:95], s35 offen offset:1024 sc1
  v_mfma_f32_16x16x32_bf16 v[44:47], a[0:3], a[176:179], v[44:47]
  ds_read_b64_tr_b16 a[168:169], v115 offset:15360
  ds_read_b64_tr_b16 a[170:171], v115 offset:15872
  v_mfma_f32_16x16x32_bf16 v[92:95], a[4:7], a[176:179], v[92:95]
  s_waitcnt vmcnt(25) lgkmcnt(10)
  s_barrier
  v_mfma_f32_16x16x32_bf16 v[96:99], a[180:183], a[188:191], v[96:99]
  ds_read_b64_tr_b16 a[172:173], v116 offset:15360
  ds_read_b64_tr_b16 a[174:175], v116 offset:15872
  s_add_u32 m0, s38, 93184
  v_mfma_f32_16x16x32_bf16 v[100:103], a[188:191], a[184:187], v[100:103]
  buffer_load_dwordx4 v107, s[8:11], s17 offen lds
  v_mfma_f32_16x16x32_bf16 v[0:3], a[132:135], a[8:11], v[0:3]
  ds_read_b64_tr_b16 a[176:177], v117 offset:15360
  ds_read_b64_tr_b16 a[178:179], v117 offset:15872
  buffer_load_dwordx4 v108, s[8:11], s17 offen offset:1024 lds
  v_mfma_f32_16x16x32_bf16 v[48:51], a[132:135], a[12:15], v[48:51]
  ds_read_b64_tr_b16 a[180:181], v118 offset:27648
  ds_read_b64_tr_b16 a[182:183], v118 offset:28160
  buffer_load_dwordx4 v109, s[8:11], s17 offen offset:2048 lds
  v_mfma_f32_16x16x32_bf16 v[4:7], a[136:139], a[8:11], v[4:7]
  ds_read_b128 a[188:191], v119 offset:38912
  ds_read_b64_tr_b16 a[184:185], v118 offset:28672
  ds_read_b64_tr_b16 a[186:187], v118 offset:29184
  s_add_u32 s17, s17, 196608
  v_mfma_f32_16x16x32_bf16 v[52:55], a[136:139], a[12:15], v[52:55]
  ds_read_b64_tr_b16 a[132:133], v114 offset:26624
  s_cmp_eq_u32 s17, s10
  v_mfma_f32_16x16x32_bf16 v[8:11], a[140:143], a[8:11], v[8:11]
  ds_read_b64_tr_b16 a[134:135], v114 offset:27136
  ds_read_b64_tr_b16 a[136:137], v115 offset:26624
  v_mfma_f32_16x16x32_bf16 v[56:59], a[140:143], a[12:15], v[56:59]
  ds_read_b64_tr_b16 a[138:139], v115 offset:27136
  s_cselect_b32 s17, 0, s17
  v_mfma_f32_16x16x32_bf16 v[12:15], a[144:147], a[8:11], v[12:15]
  s_add_u32 s8, s8, s10
  s_addc_u32 s9, s9, 0
  v_mfma_f32_16x16x32_bf16 v[60:63], a[144:147], a[12:15], v[60:63]
  ds_read_b64_tr_b16 a[140:141], v116 offset:26624
  s_add_u32 m0, s39, 93184
  v_mfma_f32_16x16x32_bf16 v[16:19], a[148:151], a[8:11], v[16:19]
  ds_read_b64_tr_b16 a[142:143], v116 offset:27136
  buffer_load_dword v106, s[4:7], s16 offen sc1 lds
  v_mfma_f32_16x16x32_bf16 v[64:67], a[148:151], a[12:15], v[64:67]
  buffer_load_dwordx4 a[56:59], v105, s[4:7], s16 offen sc1
  s_waitcnt lgkmcnt(10)
  v_mfma_f32_16x16x32_bf16 v[20:23], a[152:155], a[8:11], v[20:23]
  ds_read_b64_tr_b16 a[144:145], v117 offset:26624
  ds_read_b64_tr_b16 a[146:147], v117 offset:27136
  v_mfma_f32_16x16x32_bf16 v[68:71], a[152:155], a[12:15], v[68:71]
  buffer_load_dwordx4 a[60:63], v105, s[4:7], s16 offen offset:1024 sc1
  v_mfma_f32_16x16x32_bf16 v[24:27], a[156:159], a[8:11], v[24:27]
  ds_read_b64_tr_b16 a[148:149], v114 offset:27648
  ds_read_b64_tr_b16 a[150:151], v114 offset:28160
  s_add_u32 s16, s16, 131072
  v_mfma_f32_16x16x32_bf16 v[72:75], a[156:159], a[12:15], v[72:75]
  ds_read_b64_tr_b16 a[152:153], v115 offset:27648
  s_bitset0_b32 s16, 20
  v_mfma_f32_16x16x32_bf16 v[28:31], a[160:163], a[8:11], v[28:31]
  ds_read_b64_tr_b16 a[154:155], v115 offset:28160
  s_add_u32 s4, s4, s6
  s_addc_u32 s5, s5, 0
  v_mfma_f32_16x16x32_bf16 v[76:79], a[160:163], a[12:15], v[76:79]
  ds_read_b64_tr_b16 a[156:157], v116 offset:27648
  s_add_u32 m0, s39, 0
  v_mfma_f32_16x16x32_bf16 v[32:35], a[8:11], a[164:167], v[32:35]
  ds_read_b64_tr_b16 a[158:159], v116 offset:28160
  ds_read_b64_tr_b16 a[160:161], v117 offset:27648
  v_mfma_f32_16x16x32_bf16 v[80:83], a[12:15], a[164:167], v[80:83]
  buffer_load_dword v106, s[4:7], s16 offen sc1 lds
  v_mfma_f32_16x16x32_bf16 v[36:39], a[8:11], a[168:171], v[36:39]
  ds_read_b64_tr_b16 a[162:163], v117 offset:28160
  buffer_load_dwordx4 a[0:3], v105, s[4:7], s16 offen sc1
  v_mfma_f32_16x16x32_bf16 v[84:87], a[12:15], a[168:171], v[84:87]
  buffer_load_dwordx4 a[4:7], v105, s[4:7], s16 offen offset:1024 sc1
  v_mfma_f32_16x16x32_bf16 v[40:43], a[8:11], a[172:175], v[40:43]
  ds_read_b64_tr_b16 a[164:165], v114 offset:28672
  ds_read_b64_tr_b16 a[166:167], v114 offset:29184
  s_add_u32 s16, s16, 131072
  v_mfma_f32_16x16x32_bf16 v[88:91], a[12:15], a[172:175], v[88:91]
  ds_read_b64_tr_b16 a[168:169], v115 offset:28672
  s_bitset0_b32 s16, 20
  v_mfma_f32_16x16x32_bf16 v[44:47], a[8:11], a[176:179], v[44:47]
  ds_read_b64_tr_b16 a[170:171], v115 offset:29184
  ds_read_b64_tr_b16 a[172:173], v116 offset:28672
  v_mfma_f32_16x16x32_bf16 v[92:95], a[12:15], a[176:179], v[92:95]
  s_waitcnt vmcnt(28) lgkmcnt(10)
  s_barrier
  v_mfma_f32_16x16x32_bf16 v[96:99], a[180:183], a[188:191], v[96:99]
  ds_read_b64_tr_b16 a[174:175], v116 offset:29184
  s_add_u32 m0, s39, 13312
  s_nop 0
  buffer_load_dword v106, s[4:7], s16 offen sc1 lds
  v_mfma_f32_16x16x32_bf16 v[100:103], a[188:191], a[184:187], v[100:103]
  buffer_load_dwordx4 a[8:11], v105, s[4:7], s16 offen sc1
  v_mfma_f32_16x16x32_bf16 v[0:3], a[132:135], a[16:19], v[0:3]
  ds_read_b64_tr_b16 a[176:177], v117 offset:28672
  ds_read_b64_tr_b16 a[178:179], v117 offset:29184
  buffer_load_dwordx4 a[12:15], v105, s[4:7], s16 offen offset:1024 sc1
  v_mfma_f32_16x16x32_bf16 v[48:51], a[132:135], a[20:23], v[48:51]
  ds_read_b64_tr_b16 a[180:181], v118 offset:40960
  ds_read_b64_tr_b16 a[182:183], v118 offset:41472
  s_add_u32 s16, s16, 131072
  v_mfma_f32_16x16x32_bf16 v[4:7], a[136:139], a[16:19], v[4:7]
  ds_read_b128 a[188:191], v119 offset:52224
  ds_read_b64_tr_b16 a[184:185], v118 offset:41984
  ds_read_b64_tr_b16 a[186:187], v118 offset:42496
  s_bitset0_b32 s16, 20
  v_mfma_f32_16x16x32_bf16 v[52:55], a[136:139], a[20:23], v[52:55]
  s_add_u32 m0, s38, 0
  s_nop 0
  buffer_load_dwordx4 v107, s[8:11], s17 offen lds
  v_mfma_f32_16x16x32_bf16 v[8:11], a[140:143], a[16:19], v[8:11]
  ds_read_b64_tr_b16 a[132:133], v114 offset:39936
  ds_read_b64_tr_b16 a[134:135], v114 offset:40448
  buffer_load_dwordx4 v108, s[8:11], s17 offen offset:1024 lds
  v_mfma_f32_16x16x32_bf16 v[56:59], a[140:143], a[20:23], v[56:59]
  buffer_load_dwordx4 v109, s[8:11], s17 offen offset:2048 lds
  v_mfma_f32_16x16x32_bf16 v[12:15], a[144:147], a[16:19], v[12:15]
  ds_read_b64_tr_b16 a[136:137], v115 offset:39936
  ds_read_b64_tr_b16 a[138:139], v115 offset:40448
  s_add_u32 s17, s17, 196608
  v_mfma_f32_16x16x32_bf16 v[60:63], a[144:147], a[20:23], v[60:63]
  ds_read_b64_tr_b16 a[140:141], v116 offset:39936
  s_cmp_eq_u32 s17, s10
  v_mfma_f32_16x16x32_bf16 v[16:19], a[148:151], a[16:19], v[16:19]
  ds_read_b64_tr_b16 a[142:143], v116 offset:40448
  s_cselect_b32 s17, 0, s17
  s_mov_b32 m0, s51
  v_mfma_f32_16x16x32_bf16 v[64:67], a[148:151], a[20:23], v[64:67]
  ds_read_b64_tr_b16 a[144:145], v117 offset:39936
  s_add_u32 s51, s51, 1024
  s_waitcnt lgkmcnt(10)
  v_mfma_f32_16x16x32_bf16 v[20:23], a[152:155], a[16:19], v[20:23]
  ds_read_b64_tr_b16 a[146:147], v117 offset:40448
  buffer_load_dwordx4 v129, s[52:55], s50 offen nt lds
  v_mfma_f32_16x16x32_bf16 v[68:71], a[152:155], a[20:23], v[68:71]
  ds_read_b64_tr_b16 a[148:149], v114 offset:40960
  s_add_u32 s50, s50, 98304
  v_mfma_f32_16x16x32_bf16 v[24:27], a[156:159], a[16:19], v[24:27]
  ds_read_b64_tr_b16 a[150:151], v114 offset:41472
  s_mov_b32 m0, s51
  v_mfma_f32_16x16x32_bf16 v[72:75], a[156:159], a[20:23], v[72:75]
  s_add_u32 s51, s51, 1024
  buffer_load_dwordx4 v129, s[52:55], s50 offen nt lds
  v_mfma_f32_16x16x32_bf16 v[28:31], a[160:163], a[16:19], v[28:31]
  ds_read_b64_tr_b16 a[152:153], v115 offset:40960
  ds_read_b64_tr_b16 a[154:155], v115 offset:41472
  s_add_u32 s50, s50, 98304
  v_mfma_f32_16x16x32_bf16 v[76:79], a[160:163], a[20:23], v[76:79]
  ds_read_b64_tr_b16 a[156:157], v116 offset:40960
  s_mov_b32 m0, s51
  v_mfma_f32_16x16x32_bf16 v[32:35], a[16:19], a[164:167], v[32:35]
  ds_read_b64_tr_b16 a[158:159], v116 offset:41472
  s_add_u32 s51, s51, 1024
  v_mfma_f32_16x16x32_bf16 v[80:83], a[20:23], a[164:167], v[80:83]
  buffer_load_dwordx4 v129, s[52:55], s50 offen nt lds
  v_mfma_f32_16x16x32_bf16 v[36:39], a[16:19], a[168:171], v[36:39]
  ds_read_b64_tr_b16 a[160:161], v117 offset:40960
  ds_read_b64_tr_b16 a[162:163], v117 offset:41472
  s_add_u32 s50, s50, 98304
  s_mov_b32 m0, s51
  v_mfma_f32_16x16x32_bf16 v[84:87], a[20:23], a[168:171], v[84:87]
  ds_read_b64_tr_b16 a[164:165], v114 offset:41984
  s_add_u32 s51, s51, 1024
  v_mfma_f32_16x16x32_bf16 v[40:43], a[16:19], a[172:175], v[40:43]
  ds_read_b64_tr_b16 a[166:167], v114 offset:42496
  buffer_load_dwordx4 v129, s[52:55], s50 offen nt lds
  v_mfma_f32_16x16x32_bf16 v[88:91], a[20:23], a[172:175], v[88:91]
  ds_read_b64_tr_b16 a[168:169], v115 offset:41984
  s_add_u32 s50, s50, 98304
  v_mfma_f32_16x16x32_bf16 v[44:47], a[16:19], a[176:179], v[44:47]
  ds_read_b64_tr_b16 a[170:171], v115 offset:42496
  s_mov_b32 s40, s20
  s_mov_b32 s41, s21
  s_mov_b32 s42, 0x200000
  s_mov_b32 s43, 0x20000
  v_min_u32 v200, 9, v104
  v_lshlrev_b32 v201, 16, v200
  v_add_u32 v201, 524288, v201
  v_lshlrev_b32 v202, 7, v200
  s_lshl2_add_u32 s33, s2, s3
  s_mul_i32 s32, s33, 448
  s_add_u32 s32, s32, 1572096
  v_add_u32 v202, s32, v202
  v_cmp_le_u32 vcc, 6, v104
  s_lshl_b32 s33, s33, 6
  s_nop 0
  v_cndmask_b32 v201, v201, v202, vcc
  buffer_load_dword v131, v201, s[40:43], s33 offen
  v_mfma_f32_16x16x32_bf16 v[92:95], a[20:23], a[176:179], v[92:95]
  s_waitcnt vmcnt(33) lgkmcnt(10)
  s_barrier
  v_mfma_f32_16x16x32_bf16 v[96:99], a[180:183], a[188:191], v[96:99]
  ds_read_b64_tr_b16 a[172:173], v116 offset:41984
  ds_read_b64_tr_b16 a[174:175], v116 offset:42496
  v_mfma_f32_16x16x32_bf16 v[100:103], a[188:191], a[184:187], v[100:103]
  ds_read_b64_tr_b16 a[176:177], v117 offset:41984
  ds_read_b64_tr_b16 a[178:179], v117 offset:42496
  v_mfma_f32_16x16x32_bf16 v[0:3], a[132:135], a[24:27], v[0:3]
  ds_read_b64_tr_b16 a[180:181], v124 offset:1024
  ds_read_b64_tr_b16 a[182:183], v124 offset:1536
  v_mfma_f32_16x16x32_bf16 v[48:51], a[132:135], a[28:31], v[48:51]
  ds_read_b128 a[188:191], v125 offset:12288
  ds_read_b64_tr_b16 a[184:185], v124 offset:2048
  v_mfma_f32_16x16x32_bf16 v[4:7], a[136:139], a[24:27], v[4:7]
  ds_read_b64_tr_b16 a[186:187], v124 offset:2560
  ds_read_b64_tr_b16 a[132:133], v120 offset:0
  v_mfma_f32_16x16x32_bf16 v[52:55], a[136:139], a[28:31], v[52:55]
  ds_read_b64_tr_b16 a[134:135], v120 offset:512
  ds_read_b64_tr_b16 a[136:137], v121 offset:0
  v_mfma_f32_16x16x32_bf16 v[8:11], a[140:143], a[24:27], v[8:11]
  ds_read_b64_tr_b16 a[138:139], v121 offset:512
  v_mfma_f32_16x16x32_bf16 v[56:59], a[140:143], a[28:31], v[56:59]
  ds_read_b64_tr_b16 a[140:141], v122 offset:0
  ds_read_b64_tr_b16 a[142:143], v122 offset:512
  v_mfma_f32_16x16x32_bf16 v[12:15], a[144:147], a[24:27], v[12:15]
  v_mfma_f32_16x16x32_bf16 v[60:63], a[144:147], a[28:31], v[60:63]
  ds_read_b64_tr_b16 a[144:145], v123 offset:0
  ds_read_b64_tr_b16 a[146:147], v123 offset:512
  v_mfma_f32_16x16x32_bf16 v[16:19], a[148:151], a[24:27], v[16:19]
  v_mfma_f32_16x16x32_bf16 v[64:67], a[148:151], a[28:31], v[64:67]
  ds_read_b64_tr_b16 a[148:149], v120 offset:1024
  ds_read_b64_tr_b16 a[150:151], v120 offset:1536
  s_waitcnt lgkmcnt(10)
  v_mfma_f32_16x16x32_bf16 v[20:23], a[152:155], a[24:27], v[20:23]
  v_mfma_f32_16x16x32_bf16 v[68:71], a[152:155], a[28:31], v[68:71]
  ds_read_b64_tr_b16 a[152:153], v121 offset:1024
  ds_read_b64_tr_b16 a[154:155], v121 offset:1536
  v_mfma_f32_16x16x32_bf16 v[24:27], a[156:159], a[24:27], v[24:27]
  v_mfma_f32_16x16x32_bf16 v[72:75], a[156:159], a[28:31], v[72:75]
  ds_read_b64_tr_b16 a[156:157], v122 offset:1024
  ds_read_b64_tr_b16 a[158:159], v122 offset:1536
  v_mfma_f32_16x16x32_bf16 v[28:31], a[160:163], a[24:27], v[28:31]
  v_mfma_f32_16x16x32_bf16 v[76:79], a[160:163], a[28:31], v[76:79]
  ds_read_b64_tr_b16 a[160:161], v123 offset:1024
  ds_read_b64_tr_b16 a[162:163], v123 offset:1536
  v_mfma_f32_16x16x32_bf16 v[32:35], a[24:27], a[164:167], v[32:35]
  v_mfma_f32_16x16x32_bf16 v[80:83], a[28:31], a[164:167], v[80:83]
  ds_read_b64_tr_b16 a[164:165], v120 offset:2048
  ds_read_b64_tr_b16 a[166:167], v120 offset:2560
  v_mfma_f32_16x16x32_bf16 v[36:39], a[24:27], a[168:171], v[36:39]
  v_mfma_f32_16x16x32_bf16 v[84:87], a[28:31], a[168:171], v[84:87]
  ds_read_b64_tr_b16 a[168:169], v121 offset:2048
  ds_read_b64_tr_b16 a[170:171], v121 offset:2560
  v_mfma_f32_16x16x32_bf16 v[40:43], a[24:27], a[172:175], v[40:43]
  v_mfma_f32_16x16x32_bf16 v[88:91], a[28:31], a[172:175], v[88:91]
  ds_read_b64_tr_b16 a[172:173], v122 offset:2048
  ds_read_b64_tr_b16 a[174:175], v122 offset:2560
  v_mfma_f32_16x16x32_bf16 v[44:47], a[24:27], a[176:179], v[44:47]
  v_mfma_f32_16x16x32_bf16 v[92:95], a[28:31], a[176:179], v[92:95]
  s_waitcnt vmcnt(27) lgkmcnt(10)
  s_barrier
  v_mfma_f32_16x16x32_bf16 v[96:99], a[180:183], a[188:191], v[96:99]
  buffer_store_dwordx4 v[244:247], v119, s[92:95], s35 offen offset:2048 sc1
  v_mfma_f32_16x16x32_bf16 v[100:103], a[188:191], a[184:187], v[100:103]
  ds_read_b64_tr_b16 a[176:177], v123 offset:2048
  ds_read_b64_tr_b16 a[178:179], v123 offset:2560
  v_mfma_f32_16x16x32_bf16 v[0:3], a[132:135], a[32:35], v[0:3]
  ds_read_b64_tr_b16 a[180:181], v124 offset:14336
  ds_read_b64_tr_b16 a[182:183], v124 offset:14848
  v_mfma_f32_16x16x32_bf16 v[48:51], a[132:135], a[36:39], v[48:51]
  ds_read_b128 a[188:191], v125 offset:25600
  ds_read_b64_tr_b16 a[184:185], v124 offset:15360
  v_mfma_f32_16x16x32_bf16 v[4:7], a[136:139], a[32:35], v[4:7]
  ds_read_b64_tr_b16 a[186:187], v124 offset:15872
  ds_read_b64_tr_b16 a[132:133], v120 offset:13312
  v_mfma_f32_16x16x32_bf16 v[52:55], a[136:139], a[36:39], v[52:55]
  ds_read_b64_tr_b16 a[134:135], v120 offset:13824
  ds_read_b64_tr_b16 a[136:137], v121 offset:13312
  v_mfma_f32_16x16x32_bf16 v[8:11], a[140:143], a[32:35], v[8:11]
  ds_read_b64_tr_b16 a[138:139], v121 offset:13824
  v_mfma_f32_16x16x32_bf16 v[56:59], a[140:143], a[36:39], v[56:59]
  ds_read_b64_tr_b16 a[140:141], v122 offset:13312
  ds_read_b64_tr_b16 a[142:143], v122 offset:13824
  v_mfma_f32_16x16x32_bf16 v[12:15], a[144:147], a[32:35], v[12:15]
  v_mfma_f32_16x16x32_bf16 v[60:63], a[144:147], a[36:39], v[60:63]
  ds_read_b64_tr_b16 a[144:145], v123 offset:13312
  ds_read_b64_tr_b16 a[146:147], v123 offset:13824
  v_mfma_f32_16x16x32_bf16 v[16:19], a[148:151], a[32:35], v[16:19]
  v_mfma_f32_16x16x32_bf16 v[64:67], a[148:151], a[36:39], v[64:67]
  ds_read_b64_tr_b16 a[148:149], v120 offset:14336
  ds_read_b64_tr_b16 a[150:151], v120 offset:14848
  v_mfma_f32_16x16x32_bf16 v[20:23], a[152:155], a[32:35], v[20:23]
  v_mfma_f32_16x16x32_bf16 v[68:71], a[152:155], a[36:39], v[68:71]
  ds_read_b64_tr_b16 a[152:153], v121 offset:14336
  ds_read_b64_tr_b16 a[154:155], v121 offset:14848
  s_waitcnt lgkmcnt(10)
  v_mfma_f32_16x16x32_bf16 v[24:27], a[156:159], a[32:35], v[24:27]
  v_mfma_f32_16x16x32_bf16 v[72:75], a[156:159], a[36:39], v[72:75]
  ds_read_b64_tr_b16 a[156:157], v122 offset:14336
  ds_read_b64_tr_b16 a[158:159], v122 offset:14848
  v_mfma_f32_16x16x32_bf16 v[28:31], a[160:163], a[32:35], v[28:31]
  v_mfma_f32_16x16x32_bf16 v[76:79], a[160:163], a[36:39], v[76:79]
  ds_read_b64_tr_b16 a[160:161], v123 offset:14336
  ds_read_b64_tr_b16 a[162:163], v123 offset:14848
  v_mfma_f32_16x16x32_bf16 v[32:35], a[32:35], a[164:167], v[32:35]
  v_mfma_f32_16x16x32_bf16 v[80:83], a[36:39], a[164:167], v[80:83]
  ds_read_b64_tr_b16 a[164:165], v120 offset:15360
  ds_read_b64_tr_b16 a[166:167], v120 offset:15872
  v_mfma_f32_16x16x32_bf16 v[36:39], a[32:35], a[168:171], v[36:39]
  v_mfma_f32_16x16x32_bf16 v[84:87], a[36:39], a[168:171], v[84:87]
  ds_read_b64_tr_b16 a[168:169], v121 offset:15360
  ds_read_b64_tr_b16 a[170:171], v121 offset:15872
  v_mfma_f32_16x16x32_bf16 v[40:43], a[32:35], a[172:175], v[40:43]
  v_mfma_f32_16x16x32_bf16 v[88:91], a[36:39], a[172:175], v[88:91]
  ds_read_b64_tr_b16 a[172:173], v122 offset:15360
  ds_read_b64_tr_b16 a[174:175], v122 offset:15872
  v_mfma_f32_16x16x32_bf16 v[44:47], a[32:35], a[176:179], v[44:47]
  v_mfma_f32_16x16x32_bf16 v[92:95], a[36:39], a[176:179], v[92:95]
  s_waitcnt vmcnt(22) lgkmcnt(10)
  s_barrier
  v_mfma_f32_16x16x32_bf16 v[96:99], a[180:183], a[188:191], v[96:99]
  ds_read_b64_tr_b16 a[176:177], v123 offset:15360
  s_add_u32 m0, s38, 13312
  v_mfma_f32_16x16x32_bf16 v[100:103], a[188:191], a[184:187], v[100:103]
  buffer_load_dwordx4 v107, s[8:11], s17 offen lds
  v_mfma_f32_16x16x32_bf16 v[0:3], a[132:135], a[40:43], v[0:3]
  ds_read_b64_tr_b16 a[178:179], v123 offset:15872
  buffer_load_dwordx4 v108, s[8:11], s17 offen offset:1024 lds
  v_mfma_f32_16x16x32_bf16 v[48:51], a[132:135], a[44:47], v[48:51]
  ds_read_b64_tr_b16 a[180:181], v124 offset:27648
  ds_read_b64_tr_b16 a[182:183], v124 offset:28160
  buffer_load_dwordx4 v109, s[8:11], s17 offen offset:2048 lds
  v_mfma_f32_16x16x32_bf16 v[4:7], a[136:139], a[40:43], v[4:7]
  ds_read_b128 a[188:191], v125 offset:38912
  ds_read_b64_tr_b16 a[184:185], v124 offset:28672
  ds_read_b64_tr_b16 a[186:187], v124 offset:29184
  v_mfma_f32_16x16x32_bf16 v[52:55], a[136:139], a[44:47], v[52:55]
  ds_read_b64_tr_b16 a[132:133], v120 offset:26624
  s_add_u32 s17, s17, 196608
  v_mfma_f32_16x16x32_bf16 v[8:11], a[140:143], a[40:43], v[8:11]
  ds_read_b64_tr_b16 a[134:135], v120 offset:27136
  s_cmp_eq_u32 s17, s10
  v_mfma_f32_16x16x32_bf16 v[56:59], a[140:143], a[44:47], v[56:59]
  ds_read_b64_tr_b16 a[136:137], v121 offset:26624
  s_cselect_b32 s17, 0, s17
  v_mfma_f32_16x16x32_bf16 v[12:15], a[144:147], a[40:43], v[12:15]
  ds_read_b64_tr_b16 a[138:139], v121 offset:27136
  s_add_u32 m0, s38, 26624
  v_mfma_f32_16x16x32_bf16 v[60:63], a[144:147], a[44:47], v[60:63]
  ds_read_b64_tr_b16 a[140:141], v122 offset:26624
  ds_read_b64_tr_b16 a[142:143], v122 offset:27136
  v_mfma_f32_16x16x32_bf16 v[16:19], a[148:151], a[40:43], v[16:19]
  buffer_load_dwordx4 v107, s[8:11], s17 offen lds
  v_mfma_f32_16x16x32_bf16 v[64:67], a[148:151], a[44:47], v[64:67]
  buffer_load_dwordx4 v108, s[8:11], s17 offen offset:1024 lds
  v_mfma_f32_16x16x32_bf16 v[20:23], a[152:155], a[40:43], v[20:23]
  ds_read_b64_tr_b16 a[144:145], v123 offset:26624
  ds_read_b64_tr_b16 a[146:147], v123 offset:27136
  buffer_load_dwordx4 v109, s[8:11], s17 offen offset:2048 lds
  v_mfma_f32_16x16x32_bf16 v[68:71], a[152:155], a[44:47], v[68:71]
  ds_read_b64_tr_b16 a[148:149], v120 offset:27648
  s_add_u32 s17, s17, 196608
  s_waitcnt lgkmcnt(10)
  v_mfma_f32_16x16x32_bf16 v[24:27], a[156:159], a[40:43], v[24:27]
  ds_read_b64_tr_b16 a[150:151], v120 offset:28160
  ds_read_b64_tr_b16 a[152:153], v121 offset:27648
  v_mfma_f32_16x16x32_bf16 v[72:75], a[156:159], a[44:47], v[72:75]
  ds_read_b64_tr_b16 a[154:155], v121 offset:28160
  s_cmp_eq_u32 s17, s10
  v_mfma_f32_16x16x32_bf16 v[28:31], a[160:163], a[40:43], v[28:31]
  ds_read_b64_tr_b16 a[156:157], v122 offset:27648
  s_cselect_b32 s17, 0, s17
  v_mfma_f32_16x16x32_bf16 v[76:79], a[160:163], a[44:47], v[76:79]
  ds_read_b64_tr_b16 a[158:159], v122 offset:28160
  s_add_u32 m0, s39, 26624
  v_mfma_f32_16x16x32_bf16 v[32:35], a[40:43], a[164:167], v[32:35]
  buffer_load_dword v106, s[4:7], s16 offen sc1 lds
  v_mfma_f32_16x16x32_bf16 v[80:83], a[44:47], a[164:167], v[80:83]
  ds_read_b64_tr_b16 a[160:161], v123 offset:27648
  ds_read_b64_tr_b16 a[162:163], v123 offset:28160
  v_mfma_f32_16x16x32_bf16 v[36:39], a[40:43], a[168:171], v[36:39]
  buffer_load_dwordx4 a[16:19], v105, s[4:7], s16 offen sc1
  v_mfma_f32_16x16x32_bf16 v[84:87], a[44:47], a[168:171], v[84:87]
  buffer_load_dwordx4 a[20:23], v105, s[4:7], s16 offen offset:1024 sc1
  v_mfma_f32_16x16x32_bf16 v[40:43], a[40:43], a[172:175], v[40:43]
  ds_read_b64_tr_b16 a[164:165], v120 offset:28672
  ds_read_b64_tr_b16 a[166:167], v120 offset:29184
  s_add_u32 s16, s16, 131072
  v_mfma_f32_16x16x32_bf16 v[88:91], a[44:47], a[172:175], v[88:91]
  ds_read_b64_tr_b16 a[168:169], v121 offset:28672
  s_bitset0_b32 s16, 20
  v_mfma_f32_16x16x32_bf16 v[44:47], a[40:43], a[176:179], v[44:47]
  ds_read_b64_tr_b16 a[170:171], v121 offset:29184
  ds_read_b64_tr_b16 a[172:173], v122 offset:28672
  v_mfma_f32_16x16x32_bf16 v[92:95], a[44:47], a[176:179], v[92:95]
  s_waitcnt vmcnt(10) lgkmcnt(10)
  s_barrier
  v_mfma_f32_16x16x32_bf16 v[96:99], a[180:183], a[188:191], v[96:99]
  ds_read_b64_tr_b16 a[174:175], v122 offset:29184
  s_add_u32 m0, s38, 39936
  v_mfma_f32_16x16x32_bf16 v[100:103], a[188:191], a[184:187], v[100:103]
  ds_read_b64_tr_b16 a[64:65], v196 offset:0
  buffer_load_dwordx4 v107, s[8:11], s17 offen lds
  v_mfma_f32_16x16x32_bf16 v[0:3], a[132:135], a[48:51], v[0:3]
  ds_read_b64_tr_b16 a[176:177], v123 offset:28672
  ds_read_b64_tr_b16 a[178:179], v123 offset:29184
  buffer_load_dwordx4 v108, s[8:11], s17 offen offset:1024 lds
  v_mfma_f32_16x16x32_bf16 v[48:51], a[132:135], a[52:55], v[48:51]
  ds_read_b64_tr_b16 a[180:181], v124 offset:40960
  ds_read_b64_tr_b16 a[182:183], v124 offset:41472
  ds_read_b64_tr_b16 a[66:67], v196 offset:512
  buffer_load_dwordx4 v109, s[8:11], s17 offen offset:2048 lds
  v_mfma_f32_16x16x32_bf16 v[4:7], a[136:139], a[48:51], v[4:7]
  ds_read_b128 a[188:191], v125 offset:52224
  ds_read_b64_tr_b16 a[184:185], v124 offset:41984
  ds_read_b64_tr_b16 a[186:187], v124 offset:42496
  s_add_u32 s17, s17, 196608
  v_mfma_f32_16x16x32_bf16 v[52:55], a[136:139], a[52:55], v[52:55]
  ds_read_b128 a[68:71], v197 offset:0
  s_cmp_eq_u32 s17, s10
  v_mfma_f32_16x16x32_bf16 v[8:11], a[140:143], a[48:51], v[8:11]
  ds_read_b64_tr_b16 a[132:133], v120 offset:39936
  ds_read_b64_tr_b16 a[134:135], v120 offset:40448
  s_cselect_b32 s17, 0, s17
  v_mfma_f32_16x16x32_bf16 v[56:59], a[140:143], a[52:55], v[56:59]
  ds_read_b64_tr_b16 a[72:73], v196 offset:4096
  s_add_u32 m0, s39, 39936
  v_mfma_f32_16x16x32_bf16 v[12:15], a[144:147], a[48:51], v[12:15]
  ds_read_b64_tr_b16 a[136:137], v121 offset:39936
  ds_read_b64_tr_b16 a[138:139], v121 offset:40448
  buffer_load_dword v106, s[4:7], s16 offen sc1 lds
  v_mfma_f32_16x16x32_bf16 v[60:63], a[144:147], a[52:55], v[60:63]
  ds_read_b64_tr_b16 a[74:75], v196 offset:4608
  buffer_load_dwordx4 a[24:27], v105, s[4:7], s16 offen sc1
  v_mfma_f32_16x16x32_bf16 v[16:19], a[148:151], a[48:51], v[16:19]
  ds_read_b64_tr_b16 a[140:141], v122 offset:39936
  ds_read_b64_tr_b16 a[142:143], v122 offset:40448
  buffer_load_dwordx4 a[28:31], v105, s[4:7], s16 offen offset:1024 sc1
  v_mfma_f32_16x16x32_bf16 v[64:67], a[148:151], a[52:55], v[64:67]
  ds_read_b128 a[76:79], v197 offset:64
  s_add_u32 s16, s16, 131072
  s_waitcnt lgkmcnt(10)
  v_mfma_f32_16x16x32_bf16 v[20:23], a[152:155], a[48:51], v[20:23]
  ds_read_b64_tr_b16 a[144:145], v123 offset:39936
  ds_read_b64_tr_b16 a[146:147], v123 offset:40448
  s_bitset0_b32 s16, 20
  v_mfma_f32_16x16x32_bf16 v[68:71], a[152:155], a[52:55], v[68:71]
  ds_read_b64_tr_b16 a[80:81], v196 offset:8192
  s_add_u32 m0, s38, 53248
  v_mfma_f32_16x16x32_bf16 v[24:27], a[156:159], a[48:51], v[24:27]
  ds_read_b64_tr_b16 a[148:149], v120 offset:40960
  ds_read_b64_tr_b16 a[150:151], v120 offset:41472
  buffer_load_dwordx4 v107, s[8:11], s17 offen lds
  v_mfma_f32_16x16x32_bf16 v[72:75], a[156:159], a[52:55], v[72:75]
  ds_read_b64_tr_b16 a[82:83], v196 offset:8704
  buffer_load_dwordx4 v108, s[8:11], s17 offen offset:1024 lds
  v_mfma_f32_16x16x32_bf16 v[28:31], a[160:163], a[48:51], v[28:31]
  ds_read_b64_tr_b16 a[152:153], v121 offset:40960
  ds_read_b64_tr_b16 a[154:155], v121 offset:41472
  buffer_load_dwordx4 v109, s[8:11], s17 offen offset:2048 lds
  v_mfma_f32_16x16x32_bf16 v[76:79], a[160:163], a[52:55], v[76:79]
  ds_read_b128 a[84:87], v197 offset:128
  s_add_u32 s17, s17, 196608
  v_mfma_f32_16x16x32_bf16 v[32:35], a[48:51], a[164:167], v[32:35]
  ds_read_b64_tr_b16 a[156:157], v122 offset:40960
  ds_read_b64_tr_b16 a[158:159], v122 offset:41472
  s_cmp_eq_u32 s17, s10
  v_mfma_f32_16x16x32_bf16 v[80:83], a[52:55], a[164:167], v[80:83]
  ds_read_b64_tr_b16 a[88:89], v196 offset:12288
  s_cselect_b32 s17, 0, s17
  v_mfma_f32_16x16x32_bf16 v[36:39], a[48:51], a[168:171], v[36:39]
  ds_read_b64_tr_b16 a[160:161], v123 offset:40960
  ds_read_b64_tr_b16 a[162:163], v123 offset:41472
  s_mov_b32 s52, s24
  v_mfma_f32_16x16x32_bf16 v[84:87], a[52:55], a[168:171], v[84:87]
  ds_read_b64_tr_b16 a[90:91], v196 offset:12800
  s_mov_b32 s53, s25
  v_mfma_f32_16x16x32_bf16 v[40:43], a[48:51], a[172:175], v[40:43]
  ds_read_b64_tr_b16 a[164:165], v120 offset:41984
  ds_read_b64_tr_b16 a[166:167], v120 offset:42496
  s_mov_b32 s54, 0x200000
  v_mfma_f32_16x16x32_bf16 v[88:91], a[52:55], a[172:175], v[88:91]
  ds_read_b128 a[92:95], v197 offset:192
  s_mov_b32 s55, 0x20000
  v_mfma_f32_16x16x32_bf16 v[44:47], a[48:51], a[176:179], v[44:47]
  ds_read_b64_tr_b16 a[168:169], v121 offset:41984
  ds_read_b64_tr_b16 a[170:171], v121 offset:42496
  s_lshl_b32 s51, s3, 11
  v_mfma_f32_16x16x32_bf16 v[92:95], a[52:55], a[176:179], v[92:95]
  s_waitcnt vmcnt(24) lgkmcnt(10)
  s_barrier
  v_mfma_f32_16x16x32_bf16 v[96:99], a[180:183], a[188:191], v[96:99]
  ds_read_b64_tr_b16 a[172:173], v122 offset:41984
  ds_read_b64_tr_b16 a[174:175], v122 offset:42496
  s_add_u32 m0, s39, 53248
  v_mfma_f32_16x16x32_bf16 v[100:103], a[188:191], a[184:187], v[100:103]
  ds_read_b64_tr_b16 a[96:97], v196 offset:16384
  buffer_load_dword v106, s[4:7], s16 offen sc1 lds
  v_mfma_f32_16x16x32_bf16 v[0:3], a[132:135], a[56:59], v[0:3]
  ds_read_b64_tr_b16 a[176:177], v123 offset:41984
  ds_read_b64_tr_b16 a[178:179], v123 offset:42496
  v_mfma_f32_16x16x32_bf16 v[192:195], a[64:67], a[68:71], 0
  buffer_load_dwordx4 a[32:35], v105, s[4:7], s16 offen sc1
  v_mfma_f32_16x16x32_bf16 v[48:51], a[132:135], a[60:63], v[48:51]
  ds_read_b64_tr_b16 a[180:181], v118 offset:1024
  ds_read_b64_tr_b16 a[182:183], v118 offset:1536
  ds_read_b64_tr_b16 a[98:99], v196 offset:16896
  v_mfma_f32_16x16x32_bf16 v[4:7], a[136:139], a[56:59], v[4:7]
  ds_read_b128 a[188:191], v119 offset:12288
  ds_read_b64_tr_b16 a[184:185], v118 offset:2048
  ds_read_b64_tr_b16 a[186:187], v118 offset:2560
  buffer_load_dwordx4 a[36:39], v105, s[4:7], s16 offen offset:1024 sc1
  v_mfma_f32_16x16x32_bf16 v[52:55], a[136:139], a[60:63], v[52:55]
  ds_read_b128 a[100:103], v197 offset:256
  s_add_u32 s16, s16, 131072
  v_mfma_f32_16x16x32_bf16 v[8:11], a[140:143], a[56:59], v[8:11]
  ds_read_b64_tr_b16 a[132:133], v114 offset:0
  ds_read_b64_tr_b16 a[134:135], v114 offset:512
  s_bitset0_b32 s16, 20
  v_mfma_f32_16x16x32_bf16 v[56:59], a[140:143], a[60:63], v[56:59]
  ds_read_b64_tr_b16 a[104:105], v196 offset:20480
  s_add_u32 m0, s38, 66560
  v_mfma_f32_16x16x32_bf16 v[12:15], a[144:147], a[56:59], v[12:15]
  ds_read_b64_tr_b16 a[136:137], v115 offset:0
  ds_read_b64_tr_b16 a[138:139], v115 offset:512
  v_mfma_f32_16x16x32_bf16 v[192:195], a[72:75], a[76:79], v[192:195]
  v_mfma_f32_16x16x32_bf16 v[60:63], a[144:147], a[60:63], v[60:63]
  ds_read_b64_tr_b16 a[106:107], v196 offset:20992
  buffer_load_dwordx4 v107, s[8:11], s17 offen lds
  v_mfma_f32_16x16x32_bf16 v[16:19], a[148:151], a[56:59], v[16:19]
  ds_read_b64_tr_b16 a[140:141], v116 offset:0
  ds_read_b64_tr_b16 a[142:143], v116 offset:512
  buffer_load_dwordx4 v108, s[8:11], s17 offen offset:1024 lds
  v_mfma_f32_16x16x32_bf16 v[64:67], a[148:151], a[60:63], v[64:67]
  ds_read_b64_tr_b16 a[144:145], v117 offset:0
  ds_read_b128 a[108:111], v197 offset:320
  v_mfma_f32_16x16x32_bf16 v[20:23], a[152:155], a[56:59], v[20:23]
  ds_read_b64_tr_b16 a[146:147], v117 offset:512
  buffer_load_dwordx4 v109, s[8:11], s17 offen offset:2048 lds
  v_mfma_f32_16x16x32_bf16 v[68:71], a[152:155], a[60:63], v[68:71]
  ds_read_b64_tr_b16 a[112:113], v196 offset:24576
  s_add_u32 s17, s17, 196608
  s_waitcnt lgkmcnt(10)
  v_mfma_f32_16x16x32_bf16 v[24:27], a[156:159], a[56:59], v[24:27]
  ds_read_b64_tr_b16 a[148:149], v114 offset:1024
  ds_read_b64_tr_b16 a[150:151], v114 offset:1536
  v_mfma_f32_16x16x32_bf16 v[192:195], a[80:83], a[84:87], v[192:195]
  s_cmp_eq_u32 s17, s10
  v_mfma_f32_16x16x32_bf16 v[72:75], a[156:159], a[60:63], v[72:75]
  ds_read_b64_tr_b16 a[152:153], v115 offset:1024
  ds_read_b64_tr_b16 a[114:115], v196 offset:25088
  v_mfma_f32_16x16x32_bf16 v[28:31], a[160:163], a[56:59], v[28:31]
  ds_read_b64_tr_b16 a[154:155], v115 offset:1536
  s_cselect_b32 s17, 0, s17
  v_mfma_f32_16x16x32_bf16 v[76:79], a[160:163], a[60:63], v[76:79]
  ds_read_b128 a[116:119], v197 offset:384
  s_add_u32 m0, s39, 66560
  v_mfma_f32_16x16x32_bf16 v[32:35], a[56:59], a[164:167], v[32:35]
  ds_read_b64_tr_b16 a[156:157], v116 offset:1024
  ds_read_b64_tr_b16 a[158:159], v116 offset:1536
  buffer_load_dword v106, s[4:7], s16 offen sc1 lds
  v_mfma_f32_16x16x32_bf16 v[80:83], a[60:63], a[164:167], v[80:83]
  ds_read_b64_tr_b16 a[120:121], v196 offset:28672
  buffer_load_dwordx4 a[40:43], v105, s[4:7], s16 offen sc1
  v_mfma_f32_16x16x32_bf16 v[36:39], a[56:59], a[168:171], v[36:39]
  ds_read_b64_tr_b16 a[160:161], v117 offset:1024
  ds_read_b64_tr_b16 a[162:163], v117 offset:1536
  v_mfma_f32_16x16x32_bf16 v[192:195], a[88:91], a[92:95], v[192:195]
  v_mfma_f32_16x16x32_bf16 v[84:87], a[60:63], a[168:171], v[84:87]
  ds_read_b64_tr_b16 a[122:123], v196 offset:29184
  buffer_load_dwordx4 a[44:47], v105, s[4:7], s16 offen offset:1024 sc1
  v_mfma_f32_16x16x32_bf16 v[40:43], a[56:59], a[172:175], v[40:43]
  ds_read_b64_tr_b16 a[164:165], v114 offset:2048
  ds_read_b64_tr_b16 a[166:167], v114 offset:2560
  s_add_u32 s16, s16, 131072
  v_mfma_f32_16x16x32_bf16 v[88:91], a[60:63], a[172:175], v[88:91]
  ds_read_b64_tr_b16 a[168:169], v115 offset:2048
  ds_read_b128 a[124:127], v197 offset:448
  v_mfma_f32_16x16x32_bf16 v[44:47], a[56:59], a[176:179], v[44:47]
  ds_read_b64_tr_b16 a[170:171], v115 offset:2560
  s_bitset0_b32 s16, 20
  v_mfma_f32_16x16x32_bf16 v[92:95], a[60:63], a[176:179], v[92:95]
  s_waitcnt vmcnt(24) lgkmcnt(10)
  s_barrier
  v_mfma_f32_16x16x32_bf16 v[96:99], a[180:183], a[188:191], v[96:99]
  ds_read_b64_tr_b16 a[172:173], v116 offset:2048
  ds_read_b64_tr_b16 a[174:175], v116 offset:2560
  s_add_u32 m0, s38, 79872
  v_mfma_f32_16x16x32_bf16 v[100:103], a[188:191], a[184:187], v[100:103]
  buffer_load_dwordx4 v107, s[8:11], s17 offen lds
  v_mfma_f32_16x16x32_bf16 v[0:3], a[132:135], a[0:3], v[0:3]
  ds_read_b64_tr_b16 a[176:177], v117 offset:2048
  ds_read_b64_tr_b16 a[178:179], v117 offset:2560
  v_mfma_f32_16x16x32_bf16 v[192:195], a[96:99], a[100:103], v[192:195]
  buffer_load_dwordx4 v108, s[8:11], s17 offen offset:1024 lds
  v_mfma_f32_16x16x32_bf16 v[48:51], a[132:135], a[4:7], v[48:51]
  ds_read_b64_tr_b16 a[180:181], v118 offset:14336
  ds_read_b64_tr_b16 a[182:183], v118 offset:14848
  buffer_load_dwordx4 v109, s[8:11], s17 offen offset:2048 lds
  v_mfma_f32_16x16x32_bf16 v[4:7], a[136:139], a[0:3], v[4:7]
  ds_read_b128 a[188:191], v119 offset:25600
  ds_read_b64_tr_b16 a[184:185], v118 offset:15360
  ds_read_b64_tr_b16 a[186:187], v118 offset:15872
  s_add_u32 s17, s17, 196608
  v_mfma_f32_16x16x32_bf16 v[52:55], a[136:139], a[4:7], v[52:55]
  ds_read_b64_tr_b16 a[132:133], v114 offset:13312
  s_cmp_eq_u32 s17, s10
  v_mfma_f32_16x16x32_bf16 v[8:11], a[140:143], a[0:3], v[8:11]
  ds_read_b64_tr_b16 a[134:135], v114 offset:13824
  s_cselect_b32 s17, 0, s17
  v_mfma_f32_16x16x32_bf16 v[56:59], a[140:143], a[4:7], v[56:59]
  ds_read_b64_tr_b16 a[136:137], v115 offset:13312
  s_add_u32 m0, s39, 79872
  v_mfma_f32_16x16x32_bf16 v[12:15], a[144:147], a[0:3], v[12:15]
  ds_read_b64_tr_b16 a[138:139], v115 offset:13824
  v_mfma_f32_16x16x32_bf16 v[192:195], a[104:107], a[108:111], v[192:195]
  v_mfma_f32_16x16x32_bf16 v[60:63], a[144:147], a[4:7], v[60:63]
  buffer_load_dword v106, s[4:7], s16 offen sc1 lds
  v_mfma_f32_16x16x32_bf16 v[16:19], a[148:151], a[0:3], v[16:19]
  ds_read_b64_tr_b16 a[140:141], v116 offset:13312
  ds_read_b64_tr_b16 a[142:143], v116 offset:13824
  buffer_load_dwordx4 a[48:51], v105, s[4:7], s16 offen sc1
  v_mfma_f32_16x16x32_bf16 v[64:67], a[148:151], a[4:7], v[64:67]
  buffer_load_dwordx4 a[52:55], v105, s[4:7], s16 offen offset:1024 sc1
  v_mfma_f32_16x16x32_bf16 v[20:23], a[152:155], a[0:3], v[20:23]
  ds_read_b64_tr_b16 a[144:145], v117 offset:13312
  ds_read_b64_tr_b16 a[146:147], v117 offset:13824
  s_add_u32 s16, s16, 131072
  v_mfma_f32_16x16x32_bf16 v[68:71], a[152:155], a[4:7], v[68:71]
  ds_read_b64_tr_b16 a[148:149], v114 offset:14336
  s_bitset0_b32 s16, 20
  s_waitcnt lgkmcnt(10)
  v_mfma_f32_16x16x32_bf16 v[24:27], a[156:159], a[0:3], v[24:27]
  ds_read_b64_tr_b16 a[150:151], v114 offset:14848
  v_mfma_f32_16x16x32_bf16 v[192:195], a[112:115], a[116:119], v[192:195]
  s_add_u32 m0, s38, 93184
  v_mfma_f32_16x16x32_bf16 v[72:75], a[156:159], a[4:7], v[72:75]
  buffer_load_dwordx4 v107, s[8:11], s17 offen lds
  v_mfma_f32_16x16x32_bf16 v[28:31], a[160:163], a[0:3], v[28:31]
  ds_read_b64_tr_b16 a[152:153], v115 offset:14336
  ds_read_b64_tr_b16 a[154:155], v115 offset:14848
  v_mfma_f32_16x16x32_bf16 v[76:79], a[160:163], a[4:7], v[76:79]
  buffer_load_dwordx4 v108, s[8:11], s17 offen offset:1024 lds
  v_mfma_f32_16x16x32_bf16 v[32:35], a[0:3], a[164:167], v[32:35]
  ds_read_b64_tr_b16 a[156:157], v116 offset:14336
  ds_read_b64_tr_b16 a[158:159], v116 offset:14848
  buffer_load_dwordx4 v109, s[8:11], s17 offen offset:2048 lds
  v_mfma_f32_16x16x32_bf16 v[80:83], a[4:7], a[164:167], v[80:83]
  ds_read_b64_tr_b16 a[160:161], v117 offset:14336
  s_add_u32 s17, s17, 196608
  v_mfma_f32_16x16x32_bf16 v[36:39], a[0:3], a[168:171], v[36:39]
  ds_read_b64_tr_b16 a[162:163], v117 offset:14848
  v_mfma_f32_16x16x32_bf16 v[192:195], a[120:123], a[124:127], v[192:195]
  s_cmp_eq_u32 s17, s10
  v_mfma_f32_16x16x32_bf16 v[84:87], a[4:7], a[168:171], v[84:87]
  ds_read_b64_tr_b16 a[164:165], v114 offset:15360
  s_cselect_b32 s17, 0, s17
  v_mfma_f32_16x16x32_bf16 v[40:43], a[0:3], a[172:175], v[40:43]
  ds_read_b64_tr_b16 a[166:167], v114 offset:15872
  s_add_u32 s8, s8, s10
  s_addc_u32 s9, s9, 0
  v_mfma_f32_16x16x32_bf16 v[88:91], a[4:7], a[172:175], v[88:91]
  buffer_store_dwordx4 v[244:247], v119, s[92:95], s35 offen offset:3072 sc1
  v_mfma_f32_16x16x32_bf16 v[44:47], a[0:3], a[176:179], v[44:47]
  ds_read_b64_tr_b16 a[168:169], v115 offset:15360
  ds_read_b64_tr_b16 a[170:171], v115 offset:15872
  v_mfma_f32_16x16x32_bf16 v[92:95], a[4:7], a[176:179], v[92:95]
  s_waitcnt vmcnt(28) lgkmcnt(10)
  s_barrier
  v_mfma_f32_16x16x32_bf16 v[96:99], a[180:183], a[188:191], v[96:99]
  ds_read_b64_tr_b16 a[172:173], v116 offset:15360
  ds_read_b64_tr_b16 a[174:175], v116 offset:15872
  s_add_u32 m0, s39, 93184
  v_mfma_f32_16x16x32_bf16 v[100:103], a[188:191], a[184:187], v[100:103]
  buffer_load_dword v106, s[4:7], s16 offen sc1 lds
  v_mfma_f32_16x16x32_bf16 v[0:3], a[132:135], a[8:11], v[0:3]
  ds_read_b64_tr_b16 a[176:177], v117 offset:15360
  ds_read_b64_tr_b16 a[178:179], v117 offset:15872
  v_mfma_f32_16x16x32_bf16 v[48:51], a[132:135], a[12:15], v[48:51]
  ds_read_b64_tr_b16 a[180:181], v118 offset:27648
  ds_read_b64_tr_b16 a[182:183], v118 offset:28160
  buffer_load_dwordx4 a[56:59], v105, s[4:7], s16 offen sc1
  v_mfma_f32_16x16x32_bf16 v[4:7], a[136:139], a[8:11], v[4:7]
  ds_read_b128 a[188:191], v119 offset:38912
  ds_read_b64_tr_b16 a[184:185], v118 offset:28672
  ds_read_b64_tr_b16 a[186:187], v118 offset:29184
  v_mfma_f32_16x16x32_bf16 v[52:55], a[136:139], a[12:15], v[52:55]
  s_bfe_u32 s40, s19, 0x80000
  s_bfe_u32 s41, s19, 0x80008
  s_bfe_u32 s42, s19, 0x80010
  s_bfe_u32 s43, s19, 0x80018
  v_and_or_b32 v192, v192, v198, s40
  v_and_or_b32 v193, v193, v198, s41
  v_and_or_b32 v194, v194, v198, s42
  v_and_or_b32 v195, v195, v198, s43
  buffer_store_dwordx4 v[192:195], v255, s[12:15], s96 offen sc1
  v_mfma_f32_16x16x32_bf16 v[8:11], a[140:143], a[8:11], v[8:11]
  ds_read_b64_tr_b16 a[132:133], v114 offset:26624
  ds_read_b64_tr_b16 a[134:135], v114 offset:27136
  buffer_load_dwordx4 a[60:63], v105, s[4:7], s16 offen offset:1024 sc1
  v_mfma_f32_16x16x32_bf16 v[56:59], a[140:143], a[12:15], v[56:59]
  ds_read_b64_tr_b16 a[136:137], v115 offset:26624
  s_add_u32 s16, s16, 131072
  v_mfma_f32_16x16x32_bf16 v[12:15], a[144:147], a[8:11], v[12:15]
  ds_read_b64_tr_b16 a[138:139], v115 offset:27136
  ds_read_b64_tr_b16 a[140:141], v116 offset:26624
  v_mfma_f32_16x16x32_bf16 v[60:63], a[144:147], a[12:15], v[60:63]
  ds_read_b64_tr_b16 a[142:143], v116 offset:27136
  s_bitset0_b32 s16, 20
  v_mfma_f32_16x16x32_bf16 v[16:19], a[148:151], a[8:11], v[16:19]
  ds_read_b64_tr_b16 a[144:145], v117 offset:26624
  ds_read_b64_tr_b16 a[146:147], v117 offset:27136
  v_mfma_f32_16x16x32_bf16 v[64:67], a[148:151], a[12:15], v[64:67]
  s_add_u32 s4, s4, s6
  s_addc_u32 s5, s5, 0
  s_waitcnt lgkmcnt(10)
  v_mfma_f32_16x16x32_bf16 v[20:23], a[152:155], a[8:11], v[20:23]
  ds_read_b64_tr_b16 a[148:149], v114 offset:27648
  ds_read_b64_tr_b16 a[150:151], v114 offset:28160
  v_mfma_f32_16x16x32_bf16 v[68:71], a[152:155], a[12:15], v[68:71]
  ds_read_b64_tr_b16 a[152:153], v115 offset:27648
  s_add_u32 m0, s39, 0
  v_mfma_f32_16x16x32_bf16 v[24:27], a[156:159], a[8:11], v[24:27]
  ds_read_b64_tr_b16 a[154:155], v115 offset:28160
  v_mfma_f32_16x16x32_bf16 v[72:75], a[156:159], a[12:15], v[72:75]
  buffer_load_dword v106, s[4:7], s16 offen sc1 lds
  v_mfma_f32_16x16x32_bf16 v[28:31], a[160:163], a[8:11], v[28:31]
  ds_read_b64_tr_b16 a[156:157], v116 offset:27648
  ds_read_b64_tr_b16 a[158:159], v116 offset:28160
  v_mfma_f32_16x16x32_bf16 v[76:79], a[160:163], a[12:15], v[76:79]
  buffer_load_dwordx4 a[0:3], v105, s[4:7], s16 offen sc1
  v_mfma_f32_16x16x32_bf16 v[32:35], a[8:11], a[164:167], v[32:35]
  ds_read_b64_tr_b16 a[160:161], v117 offset:27648
  ds_read_b64_tr_b16 a[162:163], v117 offset:28160
  v_mfma_f32_16x16x32_bf16 v[80:83], a[12:15], a[164:167], v[80:83]
  buffer_load_dwordx4 a[4:7], v105, s[4:7], s16 offen offset:1024 sc1
  v_mfma_f32_16x16x32_bf16 v[36:39], a[8:11], a[168:171], v[36:39]
  ds_read_b64_tr_b16 a[164:165], v114 offset:28672
  ds_read_b64_tr_b16 a[166:167], v114 offset:29184
  v_mfma_f32_16x16x32_bf16 v[84:87], a[12:15], a[168:171], v[84:87]
  ds_read_b64_tr_b16 a[168:169], v115 offset:28672
  s_add_u32 s16, s16, 131072
  v_mfma_f32_16x16x32_bf16 v[40:43], a[8:11], a[172:175], v[40:43]
  ds_read_b64_tr_b16 a[170:171], v115 offset:29184
  v_mfma_f32_16x16x32_bf16 v[88:91], a[12:15], a[172:175], v[88:91]
  ds_read_b64_tr_b16 a[172:173], v116 offset:28672
  s_bitset0_b32 s16, 20
  v_mfma_f32_16x16x32_bf16 v[44:47], a[8:11], a[176:179], v[44:47]
  ds_read_b64_tr_b16 a[174:175], v116 offset:29184
  v_mfma_f32_16x16x32_bf16 v[92:95], a[12:15], a[176:179], v[92:95]
  s_waitcnt vmcnt(29) lgkmcnt(10)
  s_barrier
  v_mfma_f32_16x16x32_bf16 v[96:99], a[180:183], a[188:191], v[96:99]
  ds_read_b64_tr_b16 a[176:177], v117 offset:28672
  s_add_u32 m0, s39, 13312
  v_mfma_f32_16x16x32_bf16 v[100:103], a[188:191], a[184:187], v[100:103]
  buffer_load_dword v106, s[4:7], s16 offen sc1 lds
  v_mfma_f32_16x16x32_bf16 v[0:3], a[132:135], a[16:19], v[0:3]
  ds_read_b64_tr_b16 a[178:179], v117 offset:29184
  buffer_load_dwordx4 a[8:11], v105, s[4:7], s16 offen sc1
  v_mfma_f32_16x16x32_bf16 v[48:51], a[132:135], a[20:23], v[48:51]
  ds_read_b64_tr_b16 a[180:181], v118 offset:40960
  ds_read_b64_tr_b16 a[182:183], v118 offset:41472
  buffer_load_dwordx4 a[12:15], v105, s[4:7], s16 offen offset:1024 sc1
  v_mfma_f32_16x16x32_bf16 v[4:7], a[136:139], a[16:19], v[4:7]
  ds_read_b128 a[188:191], v119 offset:52224
  ds_read_b64_tr_b16 a[184:185], v118 offset:41984
  ds_read_b64_tr_b16 a[186:187], v118 offset:42496
  v_mfma_f32_16x16x32_bf16 v[52:55], a[136:139], a[20:23], v[52:55]
  ds_read_b64_tr_b16 a[132:133], v114 offset:39936
  s_add_u32 s16, s16, 131072
  v_mfma_f32_16x16x32_bf16 v[8:11], a[140:143], a[16:19], v[8:11]
  ds_read_b64_tr_b16 a[134:135], v114 offset:40448
  s_bitset0_b32 s16, 20
  v_mfma_f32_16x16x32_bf16 v[56:59], a[140:143], a[20:23], v[56:59]
  ds_read_b64_tr_b16 a[136:137], v115 offset:39936
  s_add_u32 m0, s38, 0
  v_mfma_f32_16x16x32_bf16 v[12:15], a[144:147], a[16:19], v[12:15]
  ds_read_b64_tr_b16 a[138:139], v115 offset:40448
  ds_read_b64_tr_b16 a[140:141], v116 offset:39936
  v_mfma_f32_16x16x32_bf16 v[60:63], a[144:147], a[20:23], v[60:63]
  buffer_load_dwordx4 v107, s[8:11], s17 offen lds
  v_mfma_f32_16x16x32_bf16 v[16:19], a[148:151], a[16:19], v[16:19]
  ds_read_b64_tr_b16 a[142:143], v116 offset:40448
  buffer_load_dwordx4 v108, s[8:11], s17 offen offset:1024 lds
  v_mfma_f32_16x16x32_bf16 v[64:67], a[148:151], a[20:23], v[64:67]
  buffer_load_dwordx4 v109, s[8:11], s17 offen offset:2048 lds
  v_mfma_f32_16x16x32_bf16 v[20:23], a[152:155], a[16:19], v[20:23]
  ds_read_b64_tr_b16 a[144:145], v117 offset:39936
  ds_read_b64_tr_b16 a[146:147], v117 offset:40448
  v_mfma_f32_16x16x32_bf16 v[68:71], a[152:155], a[20:23], v[68:71]
  ds_read_b64_tr_b16 a[148:149], v114 offset:40960
  s_add_u32 s17, s17, 196608
  s_waitcnt lgkmcnt(10)
  v_mfma_f32_16x16x32_bf16 v[24:27], a[156:159], a[16:19], v[24:27]
  ds_read_b64_tr_b16 a[150:151], v114 offset:41472
  s_cmp_eq_u32 s17, s10
  v_mfma_f32_16x16x32_bf16 v[72:75], a[156:159], a[20:23], v[72:75]
  ds_read_b64_tr_b16 a[152:153], v115 offset:40960
  s_cselect_b32 s17, 0, s17
  v_mfma_f32_16x16x32_bf16 v[28:31], a[160:163], a[16:19], v[28:31]
  ds_read_b64_tr_b16 a[154:155], v115 offset:41472
  ds_read_b64_tr_b16 a[156:157], v116 offset:40960
  v_mfma_f32_16x16x32_bf16 v[76:79], a[160:163], a[20:23], v[76:79]
  buffer_load_dword v131, v130, s[56:59], s97 offen
  v_mfma_f32_16x16x32_bf16 v[32:35], a[16:19], a[164:167], v[32:35]
  ds_read_b64_tr_b16 a[158:159], v116 offset:41472
  s_add_u32 m0, s51, 106496
  v_mfma_f32_16x16x32_bf16 v[80:83], a[20:23], a[164:167], v[80:83]
  ds_read_b64_tr_b16 a[160:161], v117 offset:40960
  s_add_u32 s50, s98, 1703936
  v_mfma_f32_16x16x32_bf16 v[36:39], a[16:19], a[168:171], v[36:39]
  ds_read_b64_tr_b16 a[162:163], v117 offset:41472
  ds_read_b64_tr_b16 a[164:165], v114 offset:41984
  v_mfma_f32_16x16x32_bf16 v[84:87], a[20:23], a[168:171], v[84:87]
  ds_read_b64_tr_b16 a[166:167], v114 offset:42496
  s_bitset0_b32 s50, 21
  v_mfma_f32_16x16x32_bf16 v[40:43], a[16:19], a[172:175], v[40:43]
  buffer_load_dwordx4 v248, s[52:55], s50 offen lds
  v_mfma_f32_16x16x32_bf16 v[88:91], a[20:23], a[172:175], v[88:91]
  buffer_load_dwordx4 v249, s[52:55], s50 offen offset:1024 lds
  v_mfma_f32_16x16x32_bf16 v[44:47], a[16:19], a[176:179], v[44:47]
  ds_read_b64_tr_b16 a[168:169], v115 offset:41984
  ds_read_b64_tr_b16 a[170:171], v115 offset:42496
  v_mfma_f32_16x16x32_bf16 v[92:95], a[20:23], a[176:179], v[92:95]
  s_waitcnt vmcnt(32) lgkmcnt(10)
  s_barrier
  v_mfma_f32_16x16x32_bf16 v[96:99], a[180:183], a[188:191], v[96:99]
  ds_read_b64_tr_b16 a[172:173], v116 offset:41984
  ds_read_b64_tr_b16 a[174:175], v116 offset:42496
  v_mfma_f32_16x16x32_bf16 v[100:103], a[188:191], a[184:187], v[100:103]
  ds_read_b64_tr_b16 a[176:177], v117 offset:41984
  ds_read_b64_tr_b16 a[178:179], v117 offset:42496
  v_mfma_f32_16x16x32_bf16 v[0:3], a[132:135], a[24:27], v[0:3]
  ds_read_b64_tr_b16 a[180:181], v124 offset:1024
  ds_read_b64_tr_b16 a[182:183], v124 offset:1536
  v_mfma_f32_16x16x32_bf16 v[48:51], a[132:135], a[28:31], v[48:51]
  ds_read_b128 a[188:191], v125 offset:12288
  ds_read_b64_tr_b16 a[184:185], v124 offset:2048
  v_mfma_f32_16x16x32_bf16 v[4:7], a[136:139], a[24:27], v[4:7]
  ds_read_b64_tr_b16 a[186:187], v124 offset:2560
  ds_read_b64_tr_b16 a[132:133], v120 offset:0
  v_mfma_f32_16x16x32_bf16 v[52:55], a[136:139], a[28:31], v[52:55]
  ds_read_b64_tr_b16 a[134:135], v120 offset:512
  ds_read_b64_tr_b16 a[136:137], v121 offset:0
  v_mfma_f32_16x16x32_bf16 v[8:11], a[140:143], a[24:27], v[8:11]
  ds_read_b64_tr_b16 a[138:139], v121 offset:512
  v_mfma_f32_16x16x32_bf16 v[56:59], a[140:143], a[28:31], v[56:59]
  ds_read_b64_tr_b16 a[140:141], v122 offset:0
  ds_read_b64_tr_b16 a[142:143], v122 offset:512
  v_mfma_f32_16x16x32_bf16 v[12:15], a[144:147], a[24:27], v[12:15]
  v_mfma_f32_16x16x32_bf16 v[60:63], a[144:147], a[28:31], v[60:63]
  ds_read_b64_tr_b16 a[144:145], v123 offset:0
  ds_read_b64_tr_b16 a[146:147], v123 offset:512
  v_mfma_f32_16x16x32_bf16 v[16:19], a[148:151], a[24:27], v[16:19]
  v_mfma_f32_16x16x32_bf16 v[64:67], a[148:151], a[28:31], v[64:67]
  ds_read_b64_tr_b16 a[148:149], v120 offset:1024
  ds_read_b64_tr_b16 a[150:151], v120 offset:1536
  s_waitcnt lgkmcnt(10)
  v_mfma_f32_16x16x32_bf16 v[20:23], a[152:155], a[24:27], v[20:23]
  v_mfma_f32_16x16x32_bf16 v[68:71], a[152:155], a[28:31], v[68:71]
  ds_read_b64_tr_b16 a[152:153], v121 offset:1024
  ds_read_b64_tr_b16 a[154:155], v121 offset:1536
  v_mfma_f32_16x16x32_bf16 v[24:27], a[156:159], a[24:27], v[24:27]
  v_mfma_f32_16x16x32_bf16 v[72:75], a[156:159], a[28:31], v[72:75]
  ds_read_b64_tr_b16 a[156:157], v122 offset:1024
  ds_read_b64_tr_b16 a[158:159], v122 offset:1536
  v_mfma_f32_16x16x32_bf16 v[28:31], a[160:163], a[24:27], v[28:31]
  v_mfma_f32_16x16x32_bf16 v[76:79], a[160:163], a[28:31], v[76:79]
  ds_read_b64_tr_b16 a[160:161], v123 offset:1024
  ds_read_b64_tr_b16 a[162:163], v123 offset:1536
  v_mfma_f32_16x16x32_bf16 v[32:35], a[24:27], a[164:167], v[32:35]
  v_mfma_f32_16x16x32_bf16 v[80:83], a[28:31], a[164:167], v[80:83]
  ds_read_b64_tr_b16 a[164:165], v120 offset:2048
  ds_read_b64_tr_b16 a[166:167], v120 offset:2560
  v_mfma_f32_16x16x32_bf16 v[36:39], a[24:27], a[168:171], v[36:39]
  v_mfma_f32_16x16x32_bf16 v[84:87], a[28:31], a[168:171], v[84:87]
  ds_read_b64_tr_b16 a[168:169], v121 offset:2048
  ds_read_b64_tr_b16 a[170:171], v121 offset:2560
  v_mfma_f32_16x16x32_bf16 v[40:43], a[24:27], a[172:175], v[40:43]
  v_mfma_f32_16x16x32_bf16 v[88:91], a[28:31], a[172:175], v[88:91]
  ds_read_b64_tr_b16 a[172:173], v122 offset:2048
  ds_read_b64_tr_b16 a[174:175], v122 offset:2560
  v_mfma_f32_16x16x32_bf16 v[44:47], a[24:27], a[176:179], v[44:47]
  v_mfma_f32_16x16x32_bf16 v[92:95], a[28:31], a[176:179], v[92:95]
  s_waitcnt vmcnt(26) lgkmcnt(10)
  s_barrier
  v_mfma_f32_16x16x32_bf16 v[96:99], a[180:183], a[188:191], v[96:99]
  ds_read_b64_tr_b16 a[176:177], v123 offset:2048
  ds_read_b64_tr_b16 a[178:179], v123 offset:2560
  v_mfma_f32_16x16x32_bf16 v[100:103], a[188:191], a[184:187], v[100:103]
  ds_read_b64_tr_b16 a[180:181], v124 offset:14336
  ds_read_b64_tr_b16 a[182:183], v124 offset:14848
  v_mfma_f32_16x16x32_bf16 v[0:3], a[132:135], a[32:35], v[0:3]
  ds_read_b128 a[188:191], v125 offset:25600
  ds_read_b64_tr_b16 a[184:185], v124 offset:15360
  v_mfma_f32_16x16x32_bf16 v[48:51], a[132:135], a[36:39], v[48:51]
  ds_read_b64_tr_b16 a[186:187], v124 offset:15872
  ds_read_b64_tr_b16 a[132:133], v120 offset:13312
  v_mfma_f32_16x16x32_bf16 v[4:7], a[136:139], a[32:35], v[4:7]
  ds_read_b64_tr_b16 a[134:135], v120 offset:13824
  v_mfma_f32_16x16x32_bf16 v[52:55], a[136:139], a[36:39], v[52:55]
  ds_read_b64_tr_b16 a[136:137], v121 offset:13312
  ds_read_b64_tr_b16 a[138:139], v121 offset:13824
  v_mfma_f32_16x16x32_bf16 v[8:11], a[140:143], a[32:35], v[8:11]
  v_mfma_f32_16x16x32_bf16 v[56:59], a[140:143], a[36:39], v[56:59]
  ds_read_b64_tr_b16 a[140:141], v122 offset:13312
  ds_read_b64_tr_b16 a[142:143], v122 offset:13824
  v_mfma_f32_16x16x32_bf16 v[12:15], a[144:147], a[32:35], v[12:15]
  v_mfma_f32_16x16x32_bf16 v[60:63], a[144:147], a[36:39], v[60:63]
  ds_read_b64_tr_b16 a[144:145], v123 offset:13312
  ds_read_b64_tr_b16 a[146:147], v123 offset:13824
  v_mfma_f32_16x16x32_bf16 v[16:19], a[148:151], a[32:35], v[16:19]
  v_mfma_f32_16x16x32_bf16 v[64:67], a[148:151], a[36:39], v[64:67]
  ds_read_b64_tr_b16 a[148:149], v120 offset:14336
  ds_read_b64_tr_b16 a[150:151], v120 offset:14848
  v_mfma_f32_16x16x32_bf16 v[20:23], a[152:155], a[32:35], v[20:23]
  v_mfma_f32_16x16x32_bf16 v[68:71], a[152:155], a[36:39], v[68:71]
  ds_read_b64_tr_b16 a[152:153], v121 offset:14336
  ds_read_b64_tr_b16 a[154:155], v121 offset:14848
  s_waitcnt lgkmcnt(10)
  v_mfma_f32_16x16x32_bf16 v[24:27], a[156:159], a[32:35], v[24:27]
  v_mfma_f32_16x16x32_bf16 v[72:75], a[156:159], a[36:39], v[72:75]
  ds_read_b64_tr_b16 a[156:157], v122 offset:14336
  ds_read_b64_tr_b16 a[158:159], v122 offset:14848
  v_mfma_f32_16x16x32_bf16 v[28:31], a[160:163], a[32:35], v[28:31]
  v_mfma_f32_16x16x32_bf16 v[76:79], a[160:163], a[36:39], v[76:79]
  ds_read_b64_tr_b16 a[160:161], v123 offset:14336
  ds_read_b64_tr_b16 a[162:163], v123 offset:14848
  v_mfma_f32_16x16x32_bf16 v[32:35], a[32:35], a[164:167], v[32:35]
  v_mfma_f32_16x16x32_bf16 v[80:83], a[36:39], a[164:167], v[80:83]
  ds_read_b64_tr_b16 a[164:165], v120 offset:15360
  ds_read_b64_tr_b16 a[166:167], v120 offset:15872
  v_mfma_f32_16x16x32_bf16 v[36:39], a[32:35], a[168:171], v[36:39]
  v_mfma_f32_16x16x32_bf16 v[84:87], a[36:39], a[168:171], v[84:87]
  ds_read_b64_tr_b16 a[168:169], v121 offset:15360
  ds_read_b64_tr_b16 a[170:171], v121 offset:15872
  v_mfma_f32_16x16x32_bf16 v[40:43], a[32:35], a[172:175], v[40:43]
  v_mfma_f32_16x16x32_bf16 v[88:91], a[36:39], a[172:175], v[88:91]
  ds_read_b64_tr_b16 a[172:173], v122 offset:15360
  ds_read_b64_tr_b16 a[174:175], v122 offset:15872
  v_mfma_f32_16x16x32_bf16 v[44:47], a[32:35], a[176:179], v[44:47]
  v_mfma_f32_16x16x32_bf16 v[92:95], a[36:39], a[176:179], v[92:95]
  s_waitcnt vmcnt(20) lgkmcnt(10)
  s_barrier
  v_mfma_f32_16x16x32_bf16 v[96:99], a[180:183], a[188:191], v[96:99]
  ds_read_b64_tr_b16 a[176:177], v123 offset:15360
  s_add_u32 m0, s38, 13312
  v_mfma_f32_16x16x32_bf16 v[100:103], a[188:191], a[184:187], v[100:103]
  buffer_load_dwordx4 v107, s[8:11], s17 offen lds
  v_mfma_f32_16x16x32_bf16 v[0:3], a[132:135], a[40:43], v[0:3]
  ds_read_b64_tr_b16 a[178:179], v123 offset:15872
  buffer_load_dwordx4 v108, s[8:11], s17 offen offset:1024 lds
  v_mfma_f32_16x16x32_bf16 v[48:51], a[132:135], a[44:47], v[48:51]
  ds_read_b64_tr_b16 a[180:181], v124 offset:27648
  ds_read_b64_tr_b16 a[182:183], v124 offset:28160
  buffer_load_dwordx4 v109, s[8:11], s17 offen offset:2048 lds
  v_mfma_f32_16x16x32_bf16 v[4:7], a[136:139], a[40:43], v[4:7]
  ds_read_b128 a[188:191], v125 offset:38912
  ds_read_b64_tr_b16 a[184:185], v124 offset:28672
  ds_read_b64_tr_b16 a[186:187], v124 offset:29184
  v_mfma_f32_16x16x32_bf16 v[52:55], a[136:139], a[44:47], v[52:55]
  ds_read_b64_tr_b16 a[132:133], v120 offset:26624
  s_add_u32 s17, s17, 196608
  v_mfma_f32_16x16x32_bf16 v[8:11], a[140:143], a[40:43], v[8:11]
  ds_read_b64_tr_b16 a[134:135], v120 offset:27136
  s_cmp_eq_u32 s17, s10
  v_mfma_f32_16x16x32_bf16 v[56:59], a[140:143], a[44:47], v[56:59]
  ds_read_b64_tr_b16 a[136:137], v121 offset:26624
  s_cselect_b32 s17, 0, s17
  v_mfma_f32_16x16x32_bf16 v[12:15], a[144:147], a[40:43], v[12:15]
  ds_read_b64_tr_b16 a[138:139], v121 offset:27136
  s_add_u32 m0, s38, 26624
  v_mfma_f32_16x16x32_bf16 v[60:63], a[144:147], a[44:47], v[60:63]
  ds_read_b64_tr_b16 a[140:141], v122 offset:26624
  ds_read_b64_tr_b16 a[142:143], v122 offset:27136
  v_mfma_f32_16x16x32_bf16 v[16:19], a[148:151], a[40:43], v[16:19]
  buffer_load_dwordx4 v107, s[8:11], s17 offen lds
  v_mfma_f32_16x16x32_bf16 v[64:67], a[148:151], a[44:47], v[64:67]
  buffer_load_dwordx4 v108, s[8:11], s17 offen offset:1024 lds
  v_mfma_f32_16x16x32_bf16 v[20:23], a[152:155], a[40:43], v[20:23]
  ds_read_b64_tr_b16 a[144:145], v123 offset:26624
  ds_read_b64_tr_b16 a[146:147], v123 offset:27136
  buffer_load_dwordx4 v109, s[8:11], s17 offen offset:2048 lds
  v_mfma_f32_16x16x32_bf16 v[68:71], a[152:155], a[44:47], v[68:71]
  ds_read_b64_tr_b16 a[148:149], v120 offset:27648
  s_add_u32 s17, s17, 196608
  s_waitcnt lgkmcnt(10)
  v_mfma_f32_16x16x32_bf16 v[24:27], a[156:159], a[40:43], v[24:27]
  ds_read_b64_tr_b16 a[150:151], v120 offset:28160
  ds_read_b64_tr_b16 a[152:153], v121 offset:27648
  v_mfma_f32_16x16x32_bf16 v[72:75], a[156:159], a[44:47], v[72:75]
  ds_read_b64_tr_b16 a[154:155], v121 offset:28160
  s_cmp_eq_u32 s17, s10
  v_mfma_f32_16x16x32_bf16 v[28:31], a[160:163], a[40:43], v[28:31]
  ds_read_b64_tr_b16 a[156:157], v122 offset:27648
  s_cselect_b32 s17, 0, s17
  v_mfma_f32_16x16x32_bf16 v[76:79], a[160:163], a[44:47], v[76:79]
  ds_read_b64_tr_b16 a[158:159], v122 offset:28160
  s_add_u32 m0, s39, 26624
  v_mfma_f32_16x16x32_bf16 v[32:35], a[40:43], a[164:167], v[32:35]
  buffer_load_dword v106, s[4:7], s16 offen sc1 lds
  v_mfma_f32_16x16x32_bf16 v[80:83], a[44:47], a[164:167], v[80:83]
  ds_read_b64_tr_b16 a[160:161], v123 offset:27648
  ds_read_b64_tr_b16 a[162:163], v123 offset:28160
  v_mfma_f32_16x16x32_bf16 v[36:39], a[40:43], a[168:171], v[36:39]
  buffer_load_dwordx4 a[16:19], v105, s[4:7], s16 offen sc1
  v_mfma_f32_16x16x32_bf16 v[84:87], a[44:47], a[168:171], v[84:87]
  buffer_load_dwordx4 a[20:23], v105, s[4:7], s16 offen offset:1024 sc1
  v_mfma_f32_16x16x32_bf16 v[40:43], a[40:43], a[172:175], v[40:43]
  ds_read_b64_tr_b16 a[164:165], v120 offset:28672
  ds_read_b64_tr_b16 a[166:167], v120 offset:29184
  s_add_u32 s16, s16, 131072
  v_mfma_f32_16x16x32_bf16 v[88:91], a[44:47], a[172:175], v[88:91]
  ds_read_b64_tr_b16 a[168:169], v121 offset:28672
  s_bitset0_b32 s16, 20
  v_mfma_f32_16x16x32_bf16 v[44:47], a[40:43], a[176:179], v[44:47]
  ds_read_b64_tr_b16 a[170:171], v121 offset:29184
  ds_read_b64_tr_b16 a[172:173], v122 offset:28672
  v_mfma_f32_16x16x32_bf16 v[92:95], a[44:47], a[176:179], v[92:95]
  s_waitcnt vmcnt(21) lgkmcnt(10)
  s_barrier
  v_mfma_f32_16x16x32_bf16 v[96:99], a[180:183], a[188:191], v[96:99]
  ds_read_b64_tr_b16 a[174:175], v122 offset:29184
  s_add_u32 m0, s38, 39936
  v_mfma_f32_16x16x32_bf16 v[100:103], a[188:191], a[184:187], v[100:103]
  buffer_load_dwordx4 v107, s[8:11], s17 offen lds
  v_mfma_f32_16x16x32_bf16 v[0:3], a[132:135], a[48:51], v[0:3]
  ds_read_b64_tr_b16 a[176:177], v123 offset:28672
  ds_read_b64_tr_b16 a[178:179], v123 offset:29184
  buffer_load_dwordx4 v108, s[8:11], s17 offen offset:1024 lds
  v_mfma_f32_16x16x32_bf16 v[48:51], a[132:135], a[52:55], v[48:51]
  ds_read_b64_tr_b16 a[180:181], v124 offset:40960
  ds_read_b64_tr_b16 a[182:183], v124 offset:41472
  buffer_load_dwordx4 v109, s[8:11], s17 offen offset:2048 lds
  v_mfma_f32_16x16x32_bf16 v[4:7], a[136:139], a[48:51], v[4:7]
  ds_read_b128 a[188:191], v125 offset:52224
  ds_read_b64_tr_b16 a[184:185], v124 offset:41984
  ds_read_b64_tr_b16 a[186:187], v124 offset:42496
  v_mfma_f32_16x16x32_bf16 v[52:55], a[136:139], a[52:55], v[52:55]
  ds_read_b64_tr_b16 a[132:133], v120 offset:39936
  s_add_u32 s17, s17, 196608
  v_mfma_f32_16x16x32_bf16 v[8:11], a[140:143], a[48:51], v[8:11]
  ds_read_b64_tr_b16 a[134:135], v120 offset:40448
  s_cmp_eq_u32 s17, s10
  v_mfma_f32_16x16x32_bf16 v[56:59], a[140:143], a[52:55], v[56:59]
  ds_read_b64_tr_b16 a[136:137], v121 offset:39936
  s_cselect_b32 s17, 0, s17
  v_mfma_f32_16x16x32_bf16 v[12:15], a[144:147], a[48:51], v[12:15]
  ds_read_b64_tr_b16 a[138:139], v121 offset:40448
  s_add_u32 m0, s39, 39936
  v_mfma_f32_16x16x32_bf16 v[60:63], a[144:147], a[52:55], v[60:63]
  ds_read_b64_tr_b16 a[140:141], v122 offset:39936
  ds_read_b64_tr_b16 a[142:143], v122 offset:40448
  v_mfma_f32_16x16x32_bf16 v[16:19], a[148:151], a[48:51], v[16:19]
  buffer_load_dword v106, s[4:7], s16 offen sc1 lds
  v_mfma_f32_16x16x32_bf16 v[64:67], a[148:151], a[52:55], v[64:67]
  buffer_load_dwordx4 a[24:27], v105, s[4:7], s16 offen sc1
  s_waitcnt lgkmcnt(10)
  v_mfma_f32_16x16x32_bf16 v[20:23], a[152:155], a[48:51], v[20:23]
  ds_read_b64_tr_b16 a[144:145], v123 offset:39936
  ds_read_b64_tr_b16 a[146:147], v123 offset:40448
  buffer_load_dwordx4 a[28:31], v105, s[4:7], s16 offen offset:1024 sc1
  v_mfma_f32_16x16x32_bf16 v[68:71], a[152:155], a[52:55], v[68:71]
  ds_read_b64_tr_b16 a[148:149], v120 offset:40960
  s_add_u32 s16, s16, 131072
  v_mfma_f32_16x16x32_bf16 v[24:27], a[156:159], a[48:51], v[24:27]
  ds_read_b64_tr_b16 a[150:151], v120 offset:41472
  ds_read_b64_tr_b16 a[152:153], v121 offset:40960
  v_mfma_f32_16x16x32_bf16 v[72:75], a[156:159], a[52:55], v[72:75]
  ds_read_b64_tr_b16 a[154:155], v121 offset:41472
  s_bitset0_b32 s16, 20
  v_mfma_f32_16x16x32_bf16 v[28:31], a[160:163], a[48:51], v[28:31]
  ds_read_b64_tr_b16 a[156:157], v122 offset:40960
  s_add_u32 m0, s38, 53248
  v_mfma_f32_16x16x32_bf16 v[76:79], a[160:163], a[52:55], v[76:79]
  buffer_load_dwordx4 v107, s[8:11], s17 offen lds
  v_mfma_f32_16x16x32_bf16 v[32:35], a[48:51], a[164:167], v[32:35]
  ds_read_b64_tr_b16 a[158:159], v122 offset:41472
  buffer_load_dwordx4 v108, s[8:11], s17 offen offset:1024 lds
  v_mfma_f32_16x16x32_bf16 v[80:83], a[52:55], a[164:167], v[80:83]
  ds_read_b64_tr_b16 a[160:161], v123 offset:40960
  ds_read_b64_tr_b16 a[162:163], v123 offset:41472
  v_mfma_f32_16x16x32_bf16 v[36:39], a[48:51], a[168:171], v[36:39]
  buffer_load_dwordx4 v109, s[8:11], s17 offen offset:2048 lds
  v_mfma_f32_16x16x32_bf16 v[84:87], a[52:55], a[168:171], v[84:87]
  ds_read_b64_tr_b16 a[164:165], v120 offset:41984
  s_add_u32 s17, s17, 196608
  v_mfma_f32_16x16x32_bf16 v[40:43], a[48:51], a[172:175], v[40:43]
  ds_read_b64_tr_b16 a[166:167], v120 offset:42496
  s_cmp_eq_u32 s17, s10
  v_mfma_f32_16x16x32_bf16 v[88:91], a[52:55], a[172:175], v[88:91]
  ds_read_b64_tr_b16 a[168:169], v121 offset:41984
  s_cselect_b32 s17, 0, s17
  v_mfma_f32_16x16x32_bf16 v[44:47], a[48:51], a[176:179], v[44:47]
  ds_read_b64_tr_b16 a[170:171], v121 offset:42496
  ds_read_b64_tr_b16 a[172:173], v122 offset:41984
  v_mfma_f32_16x16x32_bf16 v[92:95], a[52:55], a[176:179], v[92:95]
  s_waitcnt vmcnt(21) lgkmcnt(10)
  s_barrier
  v_mfma_f32_16x16x32_bf16 v[96:99], a[180:183], a[188:191], v[96:99]
  ds_read_b64_tr_b16 a[174:175], v122 offset:42496
  s_add_u32 m0, s39, 53248
  v_mfma_f32_16x16x32_bf16 v[100:103], a[188:191], a[184:187], v[100:103]
  buffer_load_dword v106, s[4:7], s16 offen sc1 lds
  v_mfma_f32_16x16x32_bf16 v[0:3], a[132:135], a[56:59], v[0:3]
  ds_read_b64_tr_b16 a[176:177], v123 offset:41984
  ds_read_b64_tr_b16 a[178:179], v123 offset:42496
  buffer_load_dwordx4 a[32:35], v105, s[4:7], s16 offen sc1
  v_mfma_f32_16x16x32_bf16 v[48:51], a[132:135], a[60:63], v[48:51]
  ds_read_b64_tr_b16 a[180:181], v118 offset:1024
  ds_read_b64_tr_b16 a[182:183], v118 offset:1536
  buffer_load_dwordx4 a[36:39], v105, s[4:7], s16 offen offset:1024 sc1
  v_mfma_f32_16x16x32_bf16 v[4:7], a[136:139], a[56:59], v[4:7]
  ds_read_b128 a[188:191], v119 offset:12288
  ds_read_b64_tr_b16 a[184:185], v118 offset:2048
  ds_read_b64_tr_b16 a[186:187], v118 offset:2560
  v_mfma_f32_16x16x32_bf16 v[52:55], a[136:139], a[60:63], v[52:55]
  ds_read_b64_tr_b16 a[132:133], v114 offset:0
  s_add_u32 s16, s16, 131072
  v_mfma_f32_16x16x32_bf16 v[8:11], a[140:143], a[56:59], v[8:11]
  ds_read_b64_tr_b16 a[134:135], v114 offset:512
  s_bitset0_b32 s16, 20
  v_mfma_f32_16x16x32_bf16 v[56:59], a[140:143], a[60:63], v[56:59]
  ds_read_b64_tr_b16 a[136:137], v115 offset:0
  s_add_u32 m0, s38, 66560
  v_mfma_f32_16x16x32_bf16 v[12:15], a[144:147], a[56:59], v[12:15]
  ds_read_b64_tr_b16 a[138:139], v115 offset:512
  ds_read_b64_tr_b16 a[140:141], v116 offset:0
  v_mfma_f32_16x16x32_bf16 v[60:63], a[144:147], a[60:63], v[60:63]
  buffer_load_dwordx4 v107, s[8:11], s17 offen lds
  v_mfma_f32_16x16x32_bf16 v[16:19], a[148:151], a[56:59], v[16:19]
  ds_read_b64_tr_b16 a[142:143], v116 offset:512
  buffer_load_dwordx4 v108, s[8:11], s17 offen offset:1024 lds
  v_mfma_f32_16x16x32_bf16 v[64:67], a[148:151], a[60:63], v[64:67]
  buffer_load_dwordx4 v109, s[8:11], s17 offen offset:2048 lds
  s_waitcnt lgkmcnt(10)
  v_mfma_f32_16x16x32_bf16 v[20:23], a[152:155], a[56:59], v[20:23]
  ds_read_b64_tr_b16 a[144:145], v117 offset:0
  ds_read_b64_tr_b16 a[146:147], v117 offset:512
  v_mfma_f32_16x16x32_bf16 v[68:71], a[152:155], a[60:63], v[68:71]
  ds_read_b64_tr_b16 a[148:149], v114 offset:1024
  s_add_u32 s17, s17, 196608
  v_mfma_f32_16x16x32_bf16 v[24:27], a[156:159], a[56:59], v[24:27]
  ds_read_b64_tr_b16 a[150:151], v114 offset:1536
  s_cmp_eq_u32 s17, s10
  v_mfma_f32_16x16x32_bf16 v[72:75], a[156:159], a[60:63], v[72:75]
  ds_read_b64_tr_b16 a[152:153], v115 offset:1024
  s_cselect_b32 s17, 0, s17
  v_mfma_f32_16x16x32_bf16 v[28:31], a[160:163], a[56:59], v[28:31]
  ds_read_b64_tr_b16 a[154:155], v115 offset:1536
  ds_read_b64_tr_b16 a[156:157], v116 offset:1024
  v_mfma_f32_16x16x32_bf16 v[76:79], a[160:163], a[60:63], v[76:79]
  ds_read_b64_tr_b16 a[158:159], v116 offset:1536
  s_add_u32 m0, s39, 66560
  v_mfma_f32_16x16x32_bf16 v[32:35], a[56:59], a[164:167], v[32:35]
  buffer_load_dword v106, s[4:7], s16 offen sc1 lds
  v_mfma_f32_16x16x32_bf16 v[80:83], a[60:63], a[164:167], v[80:83]
  buffer_load_dwordx4 a[40:43], v105, s[4:7], s16 offen sc1
  v_mfma_f32_16x16x32_bf16 v[36:39], a[56:59], a[168:171], v[36:39]
  ds_read_b64_tr_b16 a[160:161], v117 offset:1024
  ds_read_b64_tr_b16 a[162:163], v117 offset:1536
  v_mfma_f32_16x16x32_bf16 v[84:87], a[60:63], a[168:171], v[84:87]
  buffer_load_dwordx4 a[44:47], v105, s[4:7], s16 offen offset:1024 sc1
  v_mfma_f32_16x16x32_bf16 v[40:43], a[56:59], a[172:175], v[40:43]
  ds_read_b64_tr_b16 a[164:165], v114 offset:2048
  ds_read_b64_tr_b16 a[166:167], v114 offset:2560
  s_add_u32 s16, s16, 131072
  v_mfma_f32_16x16x32_bf16 v[88:91], a[60:63], a[172:175], v[88:91]
  ds_read_b64_tr_b16 a[168:169], v115 offset:2048
  s_bitset0_b32 s16, 20
  v_mfma_f32_16x16x32_bf16 v[44:47], a[56:59], a[176:179], v[44:47]
  ds_read_b64_tr_b16 a[170:171], v115 offset:2560
  ds_read_b64_tr_b16 a[172:173], v116 offset:2048
  v_mfma_f32_16x16x32_bf16 v[92:95], a[60:63], a[176:179], v[92:95]
  s_waitcnt vmcnt(24) lgkmcnt(10)
  s_barrier
  v_mfma_f32_16x16x32_bf16 v[96:99], a[180:183], a[188:191], v[96:99]
  ds_read_b64_tr_b16 a[174:175], v116 offset:2560
  s_add_u32 m0, s38, 79872
  v_mfma_f32_16x16x32_bf16 v[100:103], a[188:191], a[184:187], v[100:103]
  buffer_load_dwordx4 v107, s[8:11], s17 offen lds
  v_mfma_f32_16x16x32_bf16 v[0:3], a[132:135], a[0:3], v[0:3]
  ds_read_b64_tr_b16 a[176:177], v117 offset:2048
  ds_read_b64_tr_b16 a[178:179], v117 offset:2560
  buffer_load_dwordx4 v108, s[8:11], s17 offen offset:1024 lds
  v_mfma_f32_16x16x32_bf16 v[48:51], a[132:135], a[4:7], v[48:51]
  ds_read_b64_tr_b16 a[180:181], v118 offset:14336
  ds_read_b64_tr_b16 a[182:183], v118 offset:14848
  buffer_load_dwordx4 v109, s[8:11], s17 offen offset:2048 lds
  v_mfma_f32_16x16x32_bf16 v[4:7], a[136:139], a[0:3], v[4:7]
  ds_read_b128 a[188:191], v119 offset:25600
  ds_read_b64_tr_b16 a[184:185], v118 offset:15360
  ds_read_b64_tr_b16 a[186:187], v118 offset:15872
  v_mfma_f32_16x16x32_bf16 v[52:55], a[136:139], a[4:7], v[52:55]
  ds_read_b64_tr_b16 a[132:133], v114 offset:13312
  s_add_u32 s17, s17, 196608
  v_mfma_f32_16x16x32_bf16 v[8:11], a[140:143], a[0:3], v[8:11]
  ds_read_b64_tr_b16 a[134:135], v114 offset:13824
  s_cmp_eq_u32 s17, s10
  v_mfma_f32_16x16x32_bf16 v[56:59], a[140:143], a[4:7], v[56:59]
  ds_read_b64_tr_b16 a[136:137], v115 offset:13312
  s_cselect_b32 s17, 0, s17
  v_mfma_f32_16x16x32_bf16 v[12:15], a[144:147], a[0:3], v[12:15]
  ds_read_b64_tr_b16 a[138:139], v115 offset:13824
  s_add_u32 m0, s39, 79872
  v_mfma_f32_16x16x32_bf16 v[60:63], a[144:147], a[4:7], v[60:63]
  ds_read_b64_tr_b16 a[140:141], v116 offset:13312
  ds_read_b64_tr_b16 a[142:143], v116 offset:13824
  v_mfma_f32_16x16x32_bf16 v[16:19], a[148:151], a[0:3], v[16:19]
  buffer_load_dword v106, s[4:7], s16 offen sc1 lds
  v_mfma_f32_16x16x32_bf16 v[64:67], a[148:151], a[4:7], v[64:67]
  buffer_load_dwordx4 a[48:51], v105, s[4:7], s16 offen sc1
  s_waitcnt lgkmcnt(10)
  v_mfma_f32_16x16x32_bf16 v[20:23], a[152:155], a[0:3], v[20:23]
  ds_read_b64_tr_b16 a[144:145], v117 offset:13312
  ds_read_b64_tr_b16 a[146:147], v117 offset:13824
  buffer_load_dwordx4 a[52:55], v105, s[4:7], s16 offen offset:1024 sc1
  v_mfma_f32_16x16x32_bf16 v[68:71], a[152:155], a[4:7], v[68:71]
  ds_read_b64_tr_b16 a[148:149], v114 offset:14336
  s_add_u32 s16, s16, 131072
  v_mfma_f32_16x16x32_bf16 v[24:27], a[156:159], a[0:3], v[24:27]
  ds_read_b64_tr_b16 a[150:151], v114 offset:14848
  ds_read_b64_tr_b16 a[152:153], v115 offset:14336
  v_mfma_f32_16x16x32_bf16 v[72:75], a[156:159], a[4:7], v[72:75]
  ds_read_b64_tr_b16 a[154:155], v115 offset:14848
  s_bitset0_b32 s16, 20
  v_mfma_f32_16x16x32_bf16 v[28:31], a[160:163], a[0:3], v[28:31]
  ds_read_b64_tr_b16 a[156:157], v116 offset:14336
  s_add_u32 m0, s38, 93184
  v_mfma_f32_16x16x32_bf16 v[76:79], a[160:163], a[4:7], v[76:79]
  buffer_load_dwordx4 v107, s[8:11], s17 offen lds
  v_mfma_f32_16x16x32_bf16 v[32:35], a[0:3], a[164:167], v[32:35]
  ds_read_b64_tr_b16 a[158:159], v116 offset:14848
  buffer_load_dwordx4 v108, s[8:11], s17 offen offset:1024 lds
  v_mfma_f32_16x16x32_bf16 v[80:83], a[4:7], a[164:167], v[80:83]
  ds_read_b64_tr_b16 a[160:161], v117 offset:14336
  ds_read_b64_tr_b16 a[162:163], v117 offset:14848
  v_mfma_f32_16x16x32_bf16 v[36:39], a[0:3], a[168:171], v[36:39]
  buffer_load_dwordx4 v109, s[8:11], s17 offen offset:2048 lds
  v_mfma_f32_16x16x32_bf16 v[84:87], a[4:7], a[168:171], v[84:87]
  ds_read_b64_tr_b16 a[164:165], v114 offset:15360
  s_add_u32 s17, s17, 196608
  v_mfma_f32_16x16x32_bf16 v[40:43], a[0:3], a[172:175], v[40:43]
  ds_read_b64_tr_b16 a[166:167], v114 offset:15872
  s_cmp_eq_u32 s17, s10
  v_mfma_f32_16x16x32_bf16 v[88:91], a[4:7], a[172:175], v[88:91]
  ds_read_b64_tr_b16 a[168:169], v115 offset:15360
  s_cselect_b32 s17, 0, s17
  v_mfma_f32_16x16x32_bf16 v[44:47], a[0:3], a[176:179], v[44:47]
  ds_read_b64_tr_b16 a[170:171], v115 offset:15872
  ds_read_b64_tr_b16 a[172:173], v116 offset:15360
  v_mfma_f32_16x16x32_bf16 v[92:95], a[4:7], a[176:179], v[92:95]
  s_waitcnt vmcnt(27) lgkmcnt(10)
  s_barrier
  v_mfma_f32_16x16x32_bf16 v[96:99], a[180:183], a[188:191], v[96:99]
  ds_read_b64_tr_b16 a[174:175], v116 offset:15872
  s_add_u32 m0, s39, 93184
  v_mfma_f32_16x16x32_bf16 v[100:103], a[188:191], a[184:187], v[100:103]
  buffer_load_dword v106, s[4:7], s16 offen sc1 lds
  v_mfma_f32_16x16x32_bf16 v[0:3], a[132:135], a[8:11], v[0:3]
  ds_read_b64_tr_b16 a[176:177], v117 offset:15360
  ds_read_b64_tr_b16 a[178:179], v117 offset:15872
  buffer_load_dwordx4 a[56:59], v105, s[4:7], s16 offen sc1
  v_mfma_f32_16x16x32_bf16 v[48:51], a[132:135], a[12:15], v[48:51]
  ds_read_b64_tr_b16 a[180:181], v118 offset:27648
  ds_read_b64_tr_b16 a[182:183], v118 offset:28160
  buffer_load_dwordx4 a[60:63], v105, s[4:7], s16 offen offset:1024 sc1
  v_mfma_f32_16x16x32_bf16 v[4:7], a[136:139], a[8:11], v[4:7]
  ds_read_b128 a[188:191], v119 offset:38912
  ds_read_b64_tr_b16 a[184:185], v118 offset:28672
  ds_read_b64_tr_b16 a[186:187], v118 offset:29184
  s_add_u32 s16, s16, 131072
  v_mfma_f32_16x16x32_bf16 v[52:55], a[136:139], a[12:15], v[52:55]
  ds_read_b64_tr_b16 a[132:133], v114 offset:26624
  s_bitset0_b32 s16, 20
  v_mfma_f32_16x16x32_bf16 v[8:11], a[140:143], a[8:11], v[8:11]
  ds_read_b64_tr_b16 a[134:135], v114 offset:27136
  ds_read_b64_tr_b16 a[136:137], v115 offset:26624
  v_mfma_f32_16x16x32_bf16 v[56:59], a[140:143], a[12:15], v[56:59]
  ds_read_b64_tr_b16 a[138:139], v115 offset:27136
  s_add_u32 m0, s51, 0
  v_mfma_f32_16x16x32_bf16 v[12:15], a[144:147], a[8:11], v[12:15]
  ds_read_b64_tr_b16 a[140:141], v116 offset:26624
  s_add_u32 s50, s98, 0
  v_mfma_f32_16x16x32_bf16 v[60:63], a[144:147], a[12:15], v[60:63]
  ds_read_b64_tr_b16 a[142:143], v116 offset:27136
  s_bitset0_b32 s50, 21
  v_mfma_f32_16x16x32_bf16 v[16:19], a[148:151], a[8:11], v[16:19]
  buffer_load_dwordx4 v248, s[52:55], s50 offen lds
  v_mfma_f32_16x16x32_bf16 v[64:67], a[148:151], a[12:15], v[64:67]
  buffer_load_dwordx4 v249, s[52:55], s50 offen offset:1024 lds
  s_waitcnt lgkmcnt(10)
  v_mfma_f32_16x16x32_bf16 v[20:23], a[152:155], a[8:11], v[20:23]
  ds_read_b64_tr_b16 a[144:145], v117 offset:26624
  ds_read_b64_tr_b16 a[146:147], v117 offset:27136
  v_mfma_f32_16x16x32_bf16 v[68:71], a[152:155], a[12:15], v[68:71]
  ds_read_b64_tr_b16 a[148:149], v114 offset:27648
  s_add_u32 m0, s51, 114688
  v_mfma_f32_16x16x32_bf16 v[24:27], a[156:159], a[8:11], v[24:27]
  ds_read_b64_tr_b16 a[150:151], v114 offset:28160
  s_add_u32 s50, s98, 1835008
  v_mfma_f32_16x16x32_bf16 v[72:75], a[156:159], a[12:15], v[72:75]
  ds_read_b64_tr_b16 a[152:153], v115 offset:27648
  s_bitset0_b32 s50, 21
  v_mfma_f32_16x16x32_bf16 v[28:31], a[160:163], a[8:11], v[28:31]
  ds_read_b64_tr_b16 a[154:155], v115 offset:28160
  buffer_load_dwordx4 v248, s[52:55], s50 offen lds
  v_mfma_f32_16x16x32_bf16 v[76:79], a[160:163], a[12:15], v[76:79]
  buffer_load_dwordx4 v249, s[52:55], s50 offen offset:1024 lds
  v_mfma_f32_16x16x32_bf16 v[32:35], a[8:11], a[164:167], v[32:35]
  ds_read_b64_tr_b16 a[156:157], v116 offset:27648
  ds_read_b64_tr_b16 a[158:159], v116 offset:28160
  v_mfma_f32_16x16x32_bf16 v[80:83], a[12:15], a[164:167], v[80:83]
  ds_read_b64_tr_b16 a[160:161], v117 offset:27648
  s_add_u32 m0, s51, 122880
  v_mfma_f32_16x16x32_bf16 v[36:39], a[8:11], a[168:171], v[36:39]
  ds_read_b64_tr_b16 a[162:163], v117 offset:28160
  s_add_u32 s50, s98, 1966080
  v_mfma_f32_16x16x32_bf16 v[84:87], a[12:15], a[168:171], v[84:87]
  ds_read_b64_tr_b16 a[164:165], v114 offset:28672
  s_bitset0_b32 s50, 21
  v_mfma_f32_16x16x32_bf16 v[40:43], a[8:11], a[172:175], v[40:43]
  ds_read_b64_tr_b16 a[166:167], v114 offset:29184
  buffer_load_dwordx4 v248, s[52:55], s50 offen lds
  v_mfma_f32_16x16x32_bf16 v[88:91], a[12:15], a[172:175], v[88:91]
  buffer_load_dwordx4 v249, s[52:55], s50 offen offset:1024 lds
  v_mfma_f32_16x16x32_bf16 v[44:47], a[8:11], a[176:179], v[44:47]
  ds_read_b64_tr_b16 a[168:169], v115 offset:28672
  ds_read_b64_tr_b16 a[170:171], v115 offset:29184
  v_mfma_f32_16x16x32_bf16 v[92:95], a[12:15], a[176:179], v[92:95]
  s_waitcnt vmcnt(30) lgkmcnt(10)
  s_barrier
  v_mfma_f32_16x16x32_bf16 v[96:99], a[180:183], a[188:191], v[96:99]
  ds_read_b64_tr_b16 a[172:173], v116 offset:28672
  ds_read_b64_tr_b16 a[174:175], v116 offset:29184
  s_add_u32 m0, s51, 8192
  v_mfma_f32_16x16x32_bf16 v[100:103], a[188:191], a[184:187], v[100:103]
  ds_read_b64_tr_b16 a[176:177], v117 offset:28672
  ds_read_b64_tr_b16 a[178:179], v117 offset:29184
  v_mfma_f32_16x16x32_bf16 v[0:3], a[132:135], a[16:19], v[0:3]
  ds_read_b64_tr_b16 a[180:181], v118 offset:40960
  s_add_u32 s50, s98, 131072
  v_mfma_f32_16x16x32_bf16 v[48:51], a[132:135], a[20:23], v[48:51]
  ds_read_b64_tr_b16 a[182:183], v118 offset:41472
  ds_read_b128 a[188:191], v119 offset:52224
  v_mfma_f32_16x16x32_bf16 v[4:7], a[136:139], a[16:19], v[4:7]
  ds_read_b64_tr_b16 a[184:185], v118 offset:41984
  ds_read_b64_tr_b16 a[186:187], v118 offset:42496
  v_mfma_f32_16x16x32_bf16 v[52:55], a[136:139], a[20:23], v[52:55]
  ds_read_b64_tr_b16 a[132:133], v114 offset:39936
  s_bitset0_b32 s50, 21
  v_mfma_f32_16x16x32_bf16 v[8:11], a[140:143], a[16:19], v[8:11]
  ds_read_b64_tr_b16 a[134:135], v114 offset:40448
  ds_read_b64_tr_b16 a[136:137], v115 offset:39936
  v_mfma_f32_16x16x32_bf16 v[56:59], a[140:143], a[20:23], v[56:59]
  buffer_load_dwordx4 v248, s[52:55], s50 offen lds
  v_mfma_f32_16x16x32_bf16 v[12:15], a[144:147], a[16:19], v[12:15]
  ds_read_b64_tr_b16 a[138:139], v115 offset:40448
  ds_read_b64_tr_b16 a[140:141], v116 offset:39936
  v_mfma_f32_16x16x32_bf16 v[60:63], a[144:147], a[20:23], v[60:63]
  ds_read_b64_tr_b16 a[142:143], v116 offset:40448
  ds_read_b64_tr_b16 a[144:145], v117 offset:39936
  v_mfma_f32_16x16x32_bf16 v[16:19], a[148:151], a[16:19], v[16:19]
  buffer_load_dwordx4 v249, s[52:55], s50 offen offset:1024 lds
  v_mfma_f32_16x16x32_bf16 v[64:67], a[148:151], a[20:23], v[64:67]
  ds_read_b64_tr_b16 a[146:147], v117 offset:40448
  ds_read_b64_tr_b16 a[148:149], v114 offset:40960
  s_waitcnt lgkmcnt(10)
  v_mfma_f32_16x16x32_bf16 v[20:23], a[152:155], a[16:19], v[20:23]
  ds_read_b64_tr_b16 a[150:151], v114 offset:41472
  s_add_u32 m0, s51, 16384
  v_mfma_f32_16x16x32_bf16 v[68:71], a[152:155], a[20:23], v[68:71]
  ds_read_b64_tr_b16 a[152:153], v115 offset:40960
  ds_read_b64_tr_b16 a[154:155], v115 offset:41472
  v_mfma_f32_16x16x32_bf16 v[24:27], a[156:159], a[16:19], v[24:27]
  v_mfma_f32_16x16x32_bf16 v[72:75], a[156:159], a[20:23], v[72:75]
  ds_read_b64_tr_b16 a[156:157], v116 offset:40960
  s_add_u32 s50, s98, 262144
  v_mfma_f32_16x16x32_bf16 v[28:31], a[160:163], a[16:19], v[28:31]
  ds_read_b64_tr_b16 a[158:159], v116 offset:41472
  v_mfma_f32_16x16x32_bf16 v[76:79], a[160:163], a[20:23], v[76:79]
  ds_read_b64_tr_b16 a[160:161], v117 offset:40960
  s_bitset0_b32 s50, 21
  v_mfma_f32_16x16x32_bf16 v[32:35], a[16:19], a[164:167], v[32:35]
  ds_read_b64_tr_b16 a[162:163], v117 offset:41472
  v_mfma_f32_16x16x32_bf16 v[80:83], a[20:23], a[164:167], v[80:83]
  ds_read_b64_tr_b16 a[164:165], v114 offset:41984
  ds_read_b64_tr_b16 a[166:167], v114 offset:42496
  v_mfma_f32_16x16x32_bf16 v[36:39], a[16:19], a[168:171], v[36:39]
  buffer_load_dwordx4 v248, s[52:55], s50 offen lds
  v_mfma_f32_16x16x32_bf16 v[84:87], a[20:23], a[168:171], v[84:87]
  ds_read_b64_tr_b16 a[168:169], v115 offset:41984
  ds_read_b64_tr_b16 a[170:171], v115 offset:42496
  v_mfma_f32_16x16x32_bf16 v[40:43], a[16:19], a[172:175], v[40:43]
  buffer_load_dwordx4 v249, s[52:55], s50 offen offset:1024 lds
  v_mfma_f32_16x16x32_bf16 v[88:91], a[20:23], a[172:175], v[88:91]
  ds_read_b64_tr_b16 a[172:173], v116 offset:41984
  ds_read_b64_tr_b16 a[174:175], v116 offset:42496
  v_mfma_f32_16x16x32_bf16 v[44:47], a[16:19], a[176:179], v[44:47]
  v_mfma_f32_16x16x32_bf16 v[92:95], a[20:23], a[176:179], v[92:95]
  s_waitcnt vmcnt(28) lgkmcnt(10)
  s_barrier
  v_mfma_f32_16x16x32_bf16 v[96:99], a[180:183], a[188:191], v[96:99]
  ds_read_b64_tr_b16 a[176:177], v117 offset:41984
  s_add_u32 m0, s51, 24576
  v_mfma_f32_16x16x32_bf16 v[100:103], a[188:191], a[184:187], v[100:103]
  ds_read_b64_tr_b16 a[178:179], v117 offset:42496
  ds_read_b64_tr_b16 a[180:181], v124 offset:1024
  v_mfma_f32_16x16x32_bf16 v[0:3], a[132:135], a[24:27], v[0:3]
  ds_read_b64_tr_b16 a[182:183], v124 offset:1536
  ds_read_b128 a[188:191], v125 offset:12288
  v_mfma_f32_16x16x32_bf16 v[48:51], a[132:135], a[28:31], v[48:51]
  ds_read_b64_tr_b16 a[184:185], v124 offset:2048
  ds_read_b64_tr_b16 a[186:187], v124 offset:2560
  v_mfma_f32_16x16x32_bf16 v[4:7], a[136:139], a[24:27], v[4:7]
  ds_read_b64_tr_b16 a[132:133], v120 offset:0
  ds_read_b64_tr_b16 a[134:135], v120 offset:512
  v_mfma_f32_16x16x32_bf16 v[52:55], a[136:139], a[28:31], v[52:55]
  ds_read_b64_tr_b16 a[136:137], v121 offset:0
  s_add_u32 s50, s98, 393216
  v_mfma_f32_16x16x32_bf16 v[8:11], a[140:143], a[24:27], v[8:11]
  ds_read_b64_tr_b16 a[138:139], v121 offset:512
  v_mfma_f32_16x16x32_bf16 v[56:59], a[140:143], a[28:31], v[56:59]
  ds_read_b64_tr_b16 a[140:141], v122 offset:0
  ds_read_b64_tr_b16 a[142:143], v122 offset:512
  v_mfma_f32_16x16x32_bf16 v[12:15], a[144:147], a[24:27], v[12:15]
  v_mfma_f32_16x16x32_bf16 v[60:63], a[144:147], a[28:31], v[60:63]
  ds_read_b64_tr_b16 a[144:145], v123 offset:0
  ds_read_b64_tr_b16 a[146:147], v123 offset:512
  v_mfma_f32_16x16x32_bf16 v[16:19], a[148:151], a[24:27], v[16:19]
  s_bitset0_b32 s50, 21
  v_mfma_f32_16x16x32_bf16 v[64:67], a[148:151], a[28:31], v[64:67]
  ds_read_b64_tr_b16 a[148:149], v120 offset:1024
  ds_read_b64_tr_b16 a[150:151], v120 offset:1536
  v_mfma_f32_16x16x32_bf16 v[20:23], a[152:155], a[24:27], v[20:23]
  v_mfma_f32_16x16x32_bf16 v[68:71], a[152:155], a[28:31], v[68:71]
  ds_read_b64_tr_b16 a[152:153], v121 offset:1024
  ds_read_b64_tr_b16 a[154:155], v121 offset:1536
  s_waitcnt lgkmcnt(10)
  v_mfma_f32_16x16x32_bf16 v[24:27], a[156:159], a[24:27], v[24:27]
  v_mfma_f32_16x16x32_bf16 v[72:75], a[156:159], a[28:31], v[72:75]
  buffer_load_dwordx4 v248, s[52:55], s50 offen lds
  v_mfma_f32_16x16x32_bf16 v[28:31], a[160:163], a[24:27], v[28:31]
  ds_read_b64_tr_b16 a[156:157], v122 offset:1024
  ds_read_b64_tr_b16 a[158:159], v122 offset:1536
  v_mfma_f32_16x16x32_bf16 v[76:79], a[160:163], a[28:31], v[76:79]
  ds_read_b64_tr_b16 a[160:161], v123 offset:1024
  ds_read_b64_tr_b16 a[162:163], v123 offset:1536
  v_mfma_f32_16x16x32_bf16 v[32:35], a[24:27], a[164:167], v[32:35]
  v_mfma_f32_16x16x32_bf16 v[80:83], a[28:31], a[164:167], v[80:83]
  ds_read_b64_tr_b16 a[164:165], v120 offset:2048
  ds_read_b64_tr_b16 a[166:167], v120 offset:2560
  v_mfma_f32_16x16x32_bf16 v[36:39], a[24:27], a[168:171], v[36:39]
  buffer_load_dwordx4 v249, s[52:55], s50 offen offset:1024 lds
  v_mfma_f32_16x16x32_bf16 v[84:87], a[28:31], a[168:171], v[84:87]
  ds_read_b64_tr_b16 a[168:169], v121 offset:2048
  ds_read_b64_tr_b16 a[170:171], v121 offset:2560
  v_mfma_f32_16x16x32_bf16 v[40:43], a[24:27], a[172:175], v[40:43]
  v_mfma_f32_16x16x32_bf16 v[88:91], a[28:31], a[172:175], v[88:91]
  ds_read_b64_tr_b16 a[172:173], v122 offset:2048
  ds_read_b64_tr_b16 a[174:175], v122 offset:2560
  v_mfma_f32_16x16x32_bf16 v[44:47], a[24:27], a[176:179], v[44:47]
  v_mfma_f32_16x16x32_bf16 v[92:95], a[28:31], a[176:179], v[92:95]
  s_waitcnt vmcnt(24) lgkmcnt(10)
  s_barrier
  v_mfma_f32_16x16x32_bf16 v[96:99], a[180:183], a[188:191], v[96:99]
  ds_read_b64_tr_b16 a[176:177], v123 offset:2048
  s_add_u32 m0, s51, 32768
  v_mfma_f32_16x16x32_bf16 v[100:103], a[188:191], a[184:187], v[100:103]
  ds_read_b64_tr_b16 a[178:179], v123 offset:2560
  s_add_u32 s50, s98, 524288
  v_mfma_f32_16x16x32_bf16 v[0:3], a[132:135], a[32:35], v[0:3]
  ds_read_b64_tr_b16 a[180:181], v124 offset:14336
  ds_read_b64_tr_b16 a[182:183], v124 offset:14848
  v_mfma_f32_16x16x32_bf16 v[48:51], a[132:135], a[36:39], v[48:51]
  ds_read_b128 a[188:191], v125 offset:25600
  s_bitset0_b32 s50, 21
  v_mfma_f32_16x16x32_bf16 v[4:7], a[136:139], a[32:35], v[4:7]
  ds_read_b64_tr_b16 a[184:185], v124 offset:15360
  ds_read_b64_tr_b16 a[186:187], v124 offset:15872
  v_mfma_f32_16x16x32_bf16 v[52:55], a[136:139], a[36:39], v[52:55]
  buffer_load_dwordx4 v248, s[52:55], s50 offen lds
  v_mfma_f32_16x16x32_bf16 v[8:11], a[140:143], a[32:35], v[8:11]
  ds_read_b64_tr_b16 a[132:133], v120 offset:13312
  ds_read_b64_tr_b16 a[134:135], v120 offset:13824
  buffer_load_dwordx4 v249, s[52:55], s50 offen offset:1024 lds
  v_mfma_f32_16x16x32_bf16 v[56:59], a[140:143], a[36:39], v[56:59]
  ds_read_b64_tr_b16 a[136:137], v121 offset:13312
  ds_read_b64_tr_b16 a[138:139], v121 offset:13824
  v_mfma_f32_16x16x32_bf16 v[12:15], a[144:147], a[32:35], v[12:15]
  ds_read_b64_tr_b16 a[140:141], v122 offset:13312
  s_add_u32 m0, s51, 40960
  v_mfma_f32_16x16x32_bf16 v[60:63], a[144:147], a[36:39], v[60:63]
  ds_read_b64_tr_b16 a[142:143], v122 offset:13824
  ds_read_b64_tr_b16 a[144:145], v123 offset:13312
  v_mfma_f32_16x16x32_bf16 v[16:19], a[148:151], a[32:35], v[16:19]
  ds_read_b64_tr_b16 a[146:147], v123 offset:13824
  s_add_u32 s50, s98, 655360
  v_mfma_f32_16x16x32_bf16 v[64:67], a[148:151], a[36:39], v[64:67]
  ds_read_b64_tr_b16 a[148:149], v120 offset:14336
  s_bitset0_b32 s50, 21
  v_mfma_f32_16x16x32_bf16 v[20:23], a[152:155], a[32:35], v[20:23]
  ds_read_b64_tr_b16 a[150:151], v120 offset:14848
  v_mfma_f32_16x16x32_bf16 v[68:71], a[152:155], a[36:39], v[68:71]
  buffer_load_dwordx4 v248, s[52:55], s50 offen lds
  s_waitcnt lgkmcnt(10)
  v_mfma_f32_16x16x32_bf16 v[24:27], a[156:159], a[32:35], v[24:27]
  ds_read_b64_tr_b16 a[152:153], v121 offset:14336
  ds_read_b64_tr_b16 a[154:155], v121 offset:14848
  v_mfma_f32_16x16x32_bf16 v[72:75], a[156:159], a[36:39], v[72:75]
  buffer_load_dwordx4 v249, s[52:55], s50 offen offset:1024 lds
  v_mfma_f32_16x16x32_bf16 v[28:31], a[160:163], a[32:35], v[28:31]
  ds_read_b64_tr_b16 a[156:157], v122 offset:14336
  s_lshl_b32 s34, s37, 8
  v_mfma_f32_16x16x32_bf16 v[76:79], a[160:163], a[36:39], v[76:79]
  ds_read_b64_tr_b16 a[158:159], v122 offset:14848
  ds_read_b64_tr_b16 a[160:161], v123 offset:14336
  v_mfma_f32_16x16x32_bf16 v[32:35], a[32:35], a[164:167], v[32:35]
  ds_read_b64_tr_b16 a[162:163], v123 offset:14848
  s_lshl_b32 s33, s3, 12
  v_mfma_f32_16x16x32_bf16 v[80:83], a[36:39], a[164:167], v[80:83]
  ds_read_b64_tr_b16 a[164:165], v120 offset:15360
  ds_read_b64_tr_b16 a[166:167], v120 offset:15872
  v_mfma_f32_16x16x32_bf16 v[36:39], a[32:35], a[168:171], v[36:39]
  s_add_u32 s34, s34, s33
  v_mfma_f32_16x16x32_bf16 v[84:87], a[36:39], a[168:171], v[84:87]
  ds_read_b64_tr_b16 a[168:169], v121 offset:15360
  s_add_u32 s68, s34, 8192
  v_mfma_f32_16x16x32_bf16 v[40:43], a[32:35], a[172:175], v[40:43]
  ds_read_b64_tr_b16 a[170:171], v121 offset:15872
  v_mfma_f32_16x16x32_bf16 v[88:91], a[36:39], a[172:175], v[88:91]
  buffer_load_dwordx4 v[250:253], v254, s[12:15], s68 offen sc1
  v_mfma_f32_16x16x32_bf16 v[44:47], a[32:35], a[176:179], v[44:47]
  ds_read_b64_tr_b16 a[172:173], v122 offset:15360
  ds_read_b64_tr_b16 a[174:175], v122 offset:15872
  v_mfma_f32_16x16x32_bf16 v[92:95], a[36:39], a[176:179], v[92:95]
  s_waitcnt vmcnt(23) lgkmcnt(10)
  s_barrier
  v_mfma_f32_16x16x32_bf16 v[96:99], a[180:183], a[188:191], v[96:99]
  ds_read_b64_tr_b16 a[176:177], v123 offset:15360
  s_add_u32 m0, s51, 49152
  v_mfma_f32_16x16x32_bf16 v[100:103], a[188:191], a[184:187], v[100:103]
  ds_read_b64_tr_b16 a[178:179], v123 offset:15872
  s_add_u32 s50, s98, 786432
  v_mfma_f32_16x16x32_bf16 v[0:3], a[132:135], a[40:43], v[0:3]
  ds_read_b64_tr_b16 a[180:181], v124 offset:27648
  s_bitset0_b32 s50, 21
  v_mfma_f32_16x16x32_bf16 v[48:51], a[132:135], a[44:47], v[48:51]
  ds_read_b64_tr_b16 a[182:183], v124 offset:28160
  buffer_load_dwordx4 v248, s[52:55], s50 offen lds
  v_mfma_f32_16x16x32_bf16 v[4:7], a[136:139], a[40:43], v[4:7]
  ds_read_b128 a[188:191], v125 offset:38912
  ds_read_b64_tr_b16 a[184:185], v124 offset:28672
  ds_read_b64_tr_b16 a[186:187], v124 offset:29184
  v_mfma_f32_16x16x32_bf16 v[52:55], a[136:139], a[44:47], v[52:55]
  buffer_load_dwordx4 v249, s[52:55], s50 offen offset:1024 lds
  v_mfma_f32_16x16x32_bf16 v[8:11], a[140:143], a[40:43], v[8:11]
  ds_read_b64_tr_b16 a[132:133], v120 offset:26624
  ds_read_b64_tr_b16 a[134:135], v120 offset:27136
  s_add_u32 m0, s51, 57344
  v_mfma_f32_16x16x32_bf16 v[56:59], a[140:143], a[44:47], v[56:59]
  ds_read_b64_tr_b16 a[136:137], v121 offset:26624
  s_add_u32 s50, s98, 917504
  v_mfma_f32_16x16x32_bf16 v[12:15], a[144:147], a[40:43], v[12:15]
  ds_read_b64_tr_b16 a[138:139], v121 offset:27136
  ds_read_b64_tr_b16 a[140:141], v122 offset:26624
  v_mfma_f32_16x16x32_bf16 v[60:63], a[144:147], a[44:47], v[60:63]
  ds_read_b64_tr_b16 a[142:143], v122 offset:27136
  s_bitset0_b32 s50, 21
  v_mfma_f32_16x16x32_bf16 v[16:19], a[148:151], a[40:43], v[16:19]
  buffer_load_dwordx4 v248, s[52:55], s50 offen lds
  v_mfma_f32_16x16x32_bf16 v[64:67], a[148:151], a[44:47], v[64:67]
  buffer_load_dwordx4 v249, s[52:55], s50 offen offset:1024 lds
  v_mfma_f32_16x16x32_bf16 v[20:23], a[152:155], a[40:43], v[20:23]
  ds_read_b64_tr_b16 a[144:145], v123 offset:26624
  ds_read_b64_tr_b16 a[146:147], v123 offset:27136
  v_mfma_f32_16x16x32_bf16 v[68:71], a[152:155], a[44:47], v[68:71]
  ds_read_b64_tr_b16 a[148:149], v120 offset:27648
  s_mov_b32 s56, s26
  s_waitcnt lgkmcnt(10)
  v_mfma_f32_16x16x32_bf16 v[24:27], a[156:159], a[40:43], v[24:27]
  ds_read_b64_tr_b16 a[150:151], v120 offset:28160
  s_mov_b32 s57, s27
  v_mfma_f32_16x16x32_bf16 v[72:75], a[156:159], a[44:47], v[72:75]
  ds_read_b64_tr_b16 a[152:153], v121 offset:27648
  s_mov_b32 s58, 0x400000
  v_mfma_f32_16x16x32_bf16 v[28:31], a[160:163], a[40:43], v[28:31]
  ds_read_b64_tr_b16 a[154:155], v121 offset:28160
  ds_read_b64_tr_b16 a[156:157], v122 offset:27648
  v_mfma_f32_16x16x32_bf16 v[76:79], a[160:163], a[44:47], v[76:79]
  ds_read_b64_tr_b16 a[158:159], v122 offset:28160
  s_mov_b32 s59, 0x20000
  v_mfma_f32_16x16x32_bf16 v[32:35], a[40:43], a[164:167], v[32:35]
  ds_read_b64_tr_b16 a[160:161], v123 offset:27648
  s_mov_b32 s33, 0x8000
  v_mfma_f32_16x16x32_bf16 v[80:83], a[44:47], a[164:167], v[80:83]
  buffer_load_dwordx4 a[240:243], v128, s[56:59], 0 offen offset:0
  v_mfma_f32_16x16x32_bf16 v[36:39], a[40:43], a[168:171], v[36:39]
  ds_read_b64_tr_b16 a[162:163], v123 offset:28160
  ds_read_b64_tr_b16 a[164:165], v120 offset:28672
  v_mfma_f32_16x16x32_bf16 v[84:87], a[44:47], a[168:171], v[84:87]
  buffer_load_dwordx4 a[244:247], v128, s[56:59], 0 offen offset:64
  v_mfma_f32_16x16x32_bf16 v[40:43], a[40:43], a[172:175], v[40:43]
  ds_read_b64_tr_b16 a[166:167], v120 offset:29184
  buffer_load_dwordx4 a[248:251], v128, s[56:59], s33 offen offset:0
  v_mfma_f32_16x16x32_bf16 v[88:91], a[44:47], a[172:175], v[88:91]
  buffer_load_dwordx4 a[252:255], v128, s[56:59], s33 offen offset:64
  v_mfma_f32_16x16x32_bf16 v[44:47], a[40:43], a[176:179], v[44:47]
  ds_read_b64_tr_b16 a[168:169], v121 offset:28672
  ds_read_b64_tr_b16 a[170:171], v121 offset:29184
  v_mfma_f32_16x16x32_bf16 v[92:95], a[44:47], a[176:179], v[92:95]
  s_waitcnt vmcnt(25) lgkmcnt(10)
  s_barrier
  v_mfma_f32_16x16x32_bf16 v[96:99], a[180:183], a[188:191], v[96:99]
  ds_read_b64_tr_b16 a[172:173], v122 offset:28672
  ds_read_b64_tr_b16 a[174:175], v122 offset:29184
  s_add_u32 m0, s51, 65536
  v_mfma_f32_16x16x32_bf16 v[100:103], a[188:191], a[184:187], v[100:103]
  ds_read_b64_tr_b16 a[176:177], v123 offset:28672
  ds_read_b64_tr_b16 a[178:179], v123 offset:29184
  v_mfma_f32_16x16x32_bf16 v[0:3], a[132:135], a[48:51], v[0:3]
  ds_read_b64_tr_b16 a[180:181], v124 offset:40960
  ds_read_b64_tr_b16 a[182:183], v124 offset:41472
  v_mfma_f32_16x16x32_bf16 v[48:51], a[132:135], a[52:55], v[48:51]
  ds_read_b128 a[188:191], v125 offset:52224
  ds_read_b64_tr_b16 a[184:185], v124 offset:41984
  v_mfma_f32_16x16x32_bf16 v[4:7], a[136:139], a[48:51], v[4:7]
  ds_read_b64_tr_b16 a[186:187], v124 offset:42496
  ds_read_b64_tr_b16 a[132:133], v120 offset:39936
  v_mfma_f32_16x16x32_bf16 v[52:55], a[136:139], a[52:55], v[52:55]
  ds_read_b64_tr_b16 a[134:135], v120 offset:40448
  s_add_u32 s50, s98, 1048576
  v_mfma_f32_16x16x32_bf16 v[8:11], a[140:143], a[48:51], v[8:11]
  ds_read_b64_tr_b16 a[136:137], v121 offset:39936
  ds_read_b64_tr_b16 a[138:139], v121 offset:40448
  v_mfma_f32_16x16x32_bf16 v[56:59], a[140:143], a[52:55], v[56:59]
  ds_read_b64_tr_b16 a[140:141], v122 offset:39936
  ds_read_b64_tr_b16 a[142:143], v122 offset:40448
  v_mfma_f32_16x16x32_bf16 v[12:15], a[144:147], a[48:51], v[12:15]
  v_mfma_f32_16x16x32_bf16 v[60:63], a[144:147], a[52:55], v[60:63]
  ds_read_b64_tr_b16 a[144:145], v123 offset:39936
  ds_read_b64_tr_b16 a[146:147], v123 offset:40448
  v_mfma_f32_16x16x32_bf16 v[16:19], a[148:151], a[48:51], v[16:19]
  s_bitset0_b32 s50, 21
  v_mfma_f32_16x16x32_bf16 v[64:67], a[148:151], a[52:55], v[64:67]
  ds_read_b64_tr_b16 a[148:149], v120 offset:40960
  ds_read_b64_tr_b16 a[150:151], v120 offset:41472
  s_waitcnt lgkmcnt(10)
  v_mfma_f32_16x16x32_bf16 v[20:23], a[152:155], a[48:51], v[20:23]
  v_mfma_f32_16x16x32_bf16 v[68:71], a[152:155], a[52:55], v[68:71]
  ds_read_b64_tr_b16 a[152:153], v121 offset:40960
  ds_read_b64_tr_b16 a[154:155], v121 offset:41472
  v_mfma_f32_16x16x32_bf16 v[24:27], a[156:159], a[48:51], v[24:27]
  v_mfma_f32_16x16x32_bf16 v[72:75], a[156:159], a[52:55], v[72:75]
  buffer_load_dwordx4 v248, s[52:55], s50 offen lds
  v_mfma_f32_16x16x32_bf16 v[28:31], a[160:163], a[48:51], v[28:31]
  ds_read_b64_tr_b16 a[156:157], v122 offset:40960
  ds_read_b64_tr_b16 a[158:159], v122 offset:41472
  v_mfma_f32_16x16x32_bf16 v[76:79], a[160:163], a[52:55], v[76:79]
  ds_read_b64_tr_b16 a[160:161], v123 offset:40960
  ds_read_b64_tr_b16 a[162:163], v123 offset:41472
  v_mfma_f32_16x16x32_bf16 v[32:35], a[48:51], a[164:167], v[32:35]
  v_mfma_f32_16x16x32_bf16 v[80:83], a[52:55], a[164:167], v[80:83]
  s_add_u32 s4, s20, 0x600000
  s_addc_u32 s5, s21, 0
  s_mov_b32 s6, 0x400000
  s_mov_b32 s7, 0x20000
  s_lshl_b32 s33, s3, 12
  s_add_u32 s33, s33, 139264
  v_add_u32 v110, s33, v119
  s_lshr_b32 s33, s3, 1
  s_lshl_b32 s33, s33, 10
  s_and_b32 s34, s3, 1
  s_lshl_b32 s34, s34, 3
  s_add_u32 s33, s33, s34
  s_add_u32 s33, s33, 139264
  v_add_u32 v111, s33, v119
  v_mfma_f32_16x16x32_bf16 v[36:39], a[48:51], a[168:171], v[36:39]
  buffer_load_dwordx4 v249, s[52:55], s50 offen offset:1024 lds
  v_mfma_f32_16x16x32_bf16 v[84:87], a[52:55], a[168:171], v[84:87]
  ds_read_b64_tr_b16 a[164:165], v120 offset:41984
  ds_read_b64_tr_b16 a[166:167], v120 offset:42496
  v_mfma_f32_16x16x32_bf16 v[40:43], a[48:51], a[172:175], v[40:43]
  ds_read_b64_tr_b16 a[168:169], v121 offset:41984
  ds_read_b64_tr_b16 a[170:171], v121 offset:42496
  v_mfma_f32_16x16x32_bf16 v[88:91], a[52:55], a[172:175], v[88:91]
  ds_read_b64_tr_b16 a[172:173], v122 offset:41984
  ds_read_b64_tr_b16 a[174:175], v122 offset:42496
  v_mfma_f32_16x16x32_bf16 v[44:47], a[48:51], a[176:179], v[44:47]
  v_mfma_f32_16x16x32_bf16 v[92:95], a[52:55], a[176:179], v[92:95]
  s_waitcnt vmcnt(27) lgkmcnt(10)
  s_barrier
  v_mfma_f32_16x16x32_bf16 v[96:99], a[180:183], a[188:191], v[96:99]
  ds_read_b64_tr_b16 a[176:177], v123 offset:41984
  ds_read_b64_tr_b16 a[178:179], v123 offset:42496
  v_mfma_f32_16x16x32_bf16 v[100:103], a[188:191], a[184:187], v[100:103]
  v_mfma_f32_16x16x32_bf16 v[64:67], a[148:151], a[60:63], v[64:67]
  v_mfma_f32_16x16x32_bf16 v[68:71], a[152:155], a[60:63], v[68:71]
  s_waitcnt lgkmcnt(10)
  v_mfma_f32_16x16x32_bf16 v[72:75], a[156:159], a[60:63], v[72:75]
  s_waitcnt lgkmcnt(8)
  v_mfma_f32_16x16x32_bf16 v[76:79], a[160:163], a[60:63], v[76:79]
  v_mfma_f32_16x16x32_bf16 v[16:19], a[148:151], a[56:59], v[16:19]
  v_mfma_f32_16x16x32_bf16 v[20:23], a[152:155], a[56:59], v[20:23]
  v_mfma_f32_16x16x32_bf16 v[24:27], a[156:159], a[56:59], v[24:27]
  v_mfma_f32_16x16x32_bf16 v[28:31], a[160:163], a[56:59], v[28:31]
  v_cvt_pk_bf16_f32 v196, v96, v97
  v_cvt_pk_bf16_f32 v197, v98, v99
  s_waitcnt lgkmcnt(6)
  v_mfma_f32_16x16x32_bf16 v[80:83], a[60:63], a[164:167], v[80:83]
  v_cvt_pk_bf16_f32 v198, v100, v101
  v_cvt_pk_bf16_f32 v199, v102, v103
  s_waitcnt lgkmcnt(4)
  v_mfma_f32_16x16x32_bf16 v[84:87], a[60:63], a[168:171], v[84:87]
  ds_write_b64 v111, v[196:197]
  ds_write_b64 v111, v[198:199] offset:2048
  s_waitcnt lgkmcnt(4)
  v_mfma_f32_16x16x32_bf16 v[88:91], a[60:63], a[172:175], v[88:91]
  v_cvt_pk_bf16_f32 v164, v64, v65
  v_cvt_pk_bf16_f32 v165, v66, v67
  s_waitcnt lgkmcnt(2)
  v_mfma_f32_16x16x32_bf16 v[92:95], a[60:63], a[176:179], v[92:95]
  v_cvt_pk_bf16_f32 v166, v68, v69
  v_cvt_pk_bf16_f32 v167, v70, v71
  v_mfma_f32_16x16x32_bf16 v[48:51], a[132:135], a[60:63], v[48:51]
  v_cvt_pk_bf16_f32 v168, v72, v73
  v_cvt_pk_bf16_f32 v169, v74, v75
  v_mfma_f32_16x16x32_bf16 v[52:55], a[136:139], a[60:63], v[52:55]
  v_cvt_pk_bf16_f32 v170, v76, v77
  v_cvt_pk_bf16_f32 v171, v78, v79
  v_mfma_f32_16x16x32_bf16 v[56:59], a[140:143], a[60:63], v[56:59]
  ds_write_b128 v110, v[164:167] offset:4096
  ds_write_b128 v110, v[168:171] offset:5120
  v_mfma_f32_16x16x32_bf16 v[60:63], a[144:147], a[60:63], v[60:63]
  v_cvt_pk_bf16_f32 v176, v80, v81
  v_cvt_pk_bf16_f32 v177, v82, v83
  v_mfma_f32_16x16x32_bf16 v[0:3], a[132:135], a[56:59], v[0:3]
  v_cvt_pk_bf16_f32 v182, v84, v85
  v_cvt_pk_bf16_f32 v183, v86, v87
  v_mfma_f32_16x16x32_bf16 v[4:7], a[136:139], a[56:59], v[4:7]
  v_cvt_pk_bf16_f32 v188, v88, v89
  v_cvt_pk_bf16_f32 v189, v90, v91
  v_mfma_f32_16x16x32_bf16 v[8:11], a[140:143], a[56:59], v[8:11]
  v_cvt_pk_bf16_f32 v194, v92, v93
  v_cvt_pk_bf16_f32 v195, v94, v95
  v_mfma_f32_16x16x32_bf16 v[12:15], a[144:147], a[56:59], v[12:15]
  ds_write_b64 v110, v[176:177] offset:6144
  ds_write_b64 v110, v[182:183] offset:6152
  v_mfma_f32_16x16x32_bf16 v[32:35], a[56:59], a[164:167], v[32:35]
  ds_write_b64 v110, v[188:189] offset:7168
  ds_write_b64 v110, v[194:195] offset:7176
  v_mfma_f32_16x16x32_bf16 v[36:39], a[56:59], a[168:171], v[36:39]
  v_cvt_pk_bf16_f32 v156, v16, v17
  v_cvt_pk_bf16_f32 v157, v18, v19
  v_mfma_f32_16x16x32_bf16 v[40:43], a[56:59], a[172:175], v[40:43]
  v_cvt_pk_bf16_f32 v158, v20, v21
  v_cvt_pk_bf16_f32 v159, v22, v23
  v_mfma_f32_16x16x32_bf16 v[44:47], a[56:59], a[176:179], v[44:47]
L_att:
  v_cvt_pk_bf16_f32 v160, v24, v25
  v_cvt_pk_bf16_f32 v161, v26, v27
  v_cvt_pk_bf16_f32 v162, v28, v29
  v_cvt_pk_bf16_f32 v163, v30, v31
  v_cvt_pk_bf16_f32 v140, v48, v49
  v_cvt_pk_bf16_f32 v141, v50, v51
  v_cvt_pk_bf16_f32 v142, v52, v53
  v_cvt_pk_bf16_f32 v143, v54, v55
  v_cvt_pk_bf16_f32 v144, v56, v57
  v_cvt_pk_bf16_f32 v145, v58, v59
  v_cvt_pk_bf16_f32 v146, v60, v61
  v_cvt_pk_bf16_f32 v147, v62, v63
  s_waitcnt lgkmcnt(0)
  s_barrier
  ds_read_b128 v[148:151], v110 offset:0
  ds_read_b64 v[172:173], v110 offset:2048
  ds_read_b64 v[178:179], v110 offset:2056
  ds_read_b128 v[152:155], v110 offset:1024
  ds_read_b64 v[184:185], v110 offset:3072
  ds_read_b64 v[190:191], v110 offset:3080
  v_mfma_f32_16x16x32_bf16 v[200:203], v[156:159], v[140:143], 0
  v_mfma_f32_16x16x32_bf16 v[204:207], v[164:167], v[140:143], 0
  v_mfma_f32_16x16x32_bf16 v[208:211], v[160:163], v[144:147], 0
  v_mfma_f32_16x16x32_bf16 v[212:215], v[168:171], v[144:147], 0
  v_cvt_pk_bf16_f32 v132, v0, v1
  v_cvt_pk_bf16_f32 v133, v2, v3
  v_cvt_pk_bf16_f32 v134, v4, v5
  v_cvt_pk_bf16_f32 v135, v6, v7
  v_cvt_pk_bf16_f32 v136, v8, v9
  v_cvt_pk_bf16_f32 v137, v10, v11
  v_cvt_pk_bf16_f32 v138, v12, v13
  v_cvt_pk_bf16_f32 v139, v14, v15
  s_or_b32 s33, s30, s3
  s_cmp_eq_u32 s33, 0
  s_cselect_b32 s33, 0xf149f2ca, 0
  v_mov_b32 v232, s33
  v_cndmask_b32_e64 v120, v232, 0, s[44:45]
  v_cndmask_b32_e64 v121, v232, 0, s[46:47]
  v_and_b32 v122, 1, v104
  v_lshlrev_b32 v122, 4, v122
  s_waitcnt lgkmcnt(0)
  v_mfma_f32_16x16x32_bf16 v[216:219], v[148:151], v[132:135], 0
  v_mfma_f32_16x16x32_bf16 v[220:223], v[156:159], v[132:135], 0
  v_mfma_f32_16x16x32_bf16 v[224:227], v[152:155], v[136:139], 0
  v_mfma_f32_16x16x32_bf16 v[228:231], v[160:163], v[136:139], 0
  v_cvt_pk_bf16_f32 v174, v32, v33
  v_cvt_pk_bf16_f32 v175, v34, v35
  v_cvt_pk_bf16_f32 v180, v36, v37
  v_cvt_pk_bf16_f32 v181, v38, v39
  v_cvt_pk_bf16_f32 v186, v40, v41
  v_cvt_pk_bf16_f32 v187, v42, v43
  v_cvt_pk_bf16_f32 v192, v44, v45
  v_cvt_pk_bf16_f32 v193, v46, v47
  s_mov_b32 s40, 0x3e8293ee
  v_cndmask_b32_e64 v200, v200, v201, s[48:49]
  v_cndmask_b32_e64 v202, v202, v203, s[48:49]
  v_cndmask_b32_e64 v204, v204, v205, s[48:49]
  v_cndmask_b32_e64 v206, v206, v207, s[48:49]
  v_cndmask_b32_e64 v208, v208, v209, s[48:49]
  v_cndmask_b32_e64 v210, v210, v211, s[48:49]
  v_cndmask_b32_e64 v212, v212, v213, s[48:49]
  v_cndmask_b32_e64 v214, v214, v215, s[48:49]
  v_cndmask_b32_e64 v216, v216, v217, s[48:49]
  v_cndmask_b32_e64 v218, v218, v219, s[48:49]
  v_cndmask_b32_e64 v220, v220, v221, s[48:49]
  v_cndmask_b32_e64 v222, v222, v223, s[48:49]
  v_cndmask_b32_e64 v224, v224, v225, s[48:49]
  v_cndmask_b32_e64 v226, v226, v227, s[48:49]
  v_cndmask_b32_e64 v228, v228, v229, s[48:49]
  v_cndmask_b32_e64 v230, v230, v231, s[48:49]
  v_cndmask_b32_e64 v200, v200, v204, s[44:45]
  v_cndmask_b32_e64 v201, v202, v206, s[46:47]
  v_cndmask_b32_e64 v208, v208, v212, s[44:45]
  v_cndmask_b32_e64 v209, v210, v214, s[46:47]
  v_cndmask_b32_e64 v216, v216, v220, s[44:45]
  v_cndmask_b32_e64 v217, v218, v222, s[46:47]
  v_cndmask_b32_e64 v224, v224, v228, s[44:45]
  v_cndmask_b32_e64 v225, v226, v230, s[46:47]
  v_mul_f32 v200, s40, v200
  v_mul_f32 v201, s40, v201
  v_mul_f32 v208, s40, v208
  v_mul_f32 v209, s40, v209
  v_fma_f32 v216, v216, s40, v120
  v_fma_f32 v217, v217, s40, v121
  v_fma_f32 v224, v224, s40, v120
  v_fma_f32 v225, v225, s40, v121
  v_max_f32 v232, v200, v201
  v_max_f32 v233, v208, v209
  v_max_f32 v234, v216, v217
  v_max_f32 v235, v224, v225
  v_mov_b32 v236, v232
  v_mov_b32 v237, v233
  v_mov_b32 v238, v234
  v_mov_b32 v239, v235
  s_nop 1
  v_permlane16_swap_b32 v236, v232
  v_permlane16_swap_b32 v237, v233
  v_permlane16_swap_b32 v238, v234
  v_permlane16_swap_b32 v239, v235
  s_nop 1
  v_max_f32 v232, v232, v236
  v_max_f32 v233, v233, v237
  v_max_f32 v234, v234, v238
  v_max_f32 v235, v235, v239
  v_mov_b32 v236, v232
  v_mov_b32 v237, v233
  v_mov_b32 v238, v234
  v_mov_b32 v239, v235
  s_nop 1
  v_permlane32_swap_b32 v236, v232
  v_permlane32_swap_b32 v237, v233
  v_permlane32_swap_b32 v238, v234
  v_permlane32_swap_b32 v239, v235
  s_nop 1
  v_max_f32 v232, v232, v236
  v_max_f32 v233, v233, v237
  v_max_f32 v234, v234, v238
  v_max_f32 v235, v235, v239
  v_sub_f32 v200, v200, v232
  v_sub_f32 v201, v201, v232
  v_sub_f32 v208, v208, v233
  v_sub_f32 v209, v209, v233
  v_sub_f32 v216, v216, v234
  v_sub_f32 v217, v217, v234
  v_sub_f32 v224, v224, v235
  v_sub_f32 v225, v225, v235
  v_exp_f32 v200, v200
  v_exp_f32 v201, v201
  v_exp_f32 v208, v208
  v_exp_f32 v209, v209
  v_exp_f32 v216, v216
  v_exp_f32 v217, v217
  v_exp_f32 v224, v224
  v_exp_f32 v225, v225
  s_nop 0
  v_add_f32 v232, v200, v201
  v_add_f32 v233, v208, v209
  v_add_f32 v234, v216, v217
  v_add_f32 v235, v224, v225
  v_mov_b32 v236, v232
  v_mov_b32 v237, v233
  v_mov_b32 v238, v234
  v_mov_b32 v239, v235
  s_nop 1
  v_permlane16_swap_b32 v236, v232
  v_permlane16_swap_b32 v237, v233
  v_permlane16_swap_b32 v238, v234
  v_permlane16_swap_b32 v239, v235
  s_nop 1
  v_add_f32 v232, v232, v236
  v_add_f32 v233, v233, v237
  v_add_f32 v234, v234, v238
  v_add_f32 v235, v235, v239
  v_mov_b32 v236, v232
  v_mov_b32 v237, v233
  v_mov_b32 v238, v234
  v_mov_b32 v239, v235
  s_nop 1
  v_permlane32_swap_b32 v236, v232
  v_permlane32_swap_b32 v237, v233
  v_permlane32_swap_b32 v238, v234
  v_permlane32_swap_b32 v239, v235
  s_nop 1
  v_add_f32 v232, v232, v236
  v_add_f32 v233, v233, v237
  v_add_f32 v234, v234, v238
  v_add_f32 v235, v235, v239
  v_rcp_f32 v232, v232
  v_rcp_f32 v233, v233
  v_rcp_f32 v234, v234
  v_rcp_f32 v235, v235
  s_nop 0
  v_mul_f32 v200, v200, v232
  v_mul_f32 v201, v201, v232
  v_mul_f32 v208, v208, v233
  v_mul_f32 v209, v209, v233
  v_mul_f32 v216, v216, v234
  v_mul_f32 v217, v217, v234
  v_mul_f32 v224, v224, v235
  v_mul_f32 v225, v225, v235
  v_cvt_pk_bf16_f32 v200, v200, 0
  v_cvt_pk_bf16_f32 v201, v201, 0
  v_cvt_pk_bf16_f32 v208, v208, 0
  v_cvt_pk_bf16_f32 v209, v209, 0
  v_cvt_pk_bf16_f32 v216, v216, 0
  v_cvt_pk_bf16_f32 v217, v217, 0
  v_cvt_pk_bf16_f32 v224, v224, 0
  v_cvt_pk_bf16_f32 v225, v225, 0
  v_lshlrev_b32 v200, v122, v200
  v_lshlrev_b32 v201, v122, v201
  v_lshlrev_b32 v208, v122, v208
  v_lshlrev_b32 v209, v122, v209
  v_lshlrev_b32 v216, v122, v216
  v_lshlrev_b32 v217, v122, v217
  v_lshlrev_b32 v224, v122, v224
  v_lshlrev_b32 v225, v122, v225
  v_cndmask_b32_e64 v132, v200, 0, s[44:45]
  v_cndmask_b32_e64 v134, 0, v200, s[44:45]
  v_cndmask_b32_e64 v133, v201, 0, s[46:47]
  v_cndmask_b32_e64 v135, 0, v201, s[46:47]
  v_cndmask_b32_e64 v136, v208, 0, s[44:45]
  v_cndmask_b32_e64 v138, 0, v208, s[44:45]
  v_cndmask_b32_e64 v137, v209, 0, s[46:47]
  v_cndmask_b32_e64 v139, 0, v209, s[46:47]
  v_cndmask_b32_e64 v140, v216, 0, s[44:45]
  v_cndmask_b32_e64 v142, 0, v216, s[44:45]
  v_cndmask_b32_e64 v141, v217, 0, s[46:47]
  v_cndmask_b32_e64 v143, 0, v217, s[46:47]
  v_cndmask_b32_e64 v144, v224, 0, s[44:45]
  v_cndmask_b32_e64 v146, 0, v224, s[44:45]
  v_cndmask_b32_e64 v145, v225, 0, s[46:47]
  v_cndmask_b32_e64 v147, 0, v225, s[46:47]
  s_nop 1
  v_mfma_f32_16x16x32_bf16 v[200:203], v[174:177], v[132:135], 0
  v_mfma_f32_16x16x32_bf16 v[204:207], v[180:183], v[132:135], 0
  v_mfma_f32_16x16x32_bf16 v[208:211], v[186:189], v[136:139], 0
  v_mfma_f32_16x16x32_bf16 v[212:215], v[192:195], v[136:139], 0
  v_mfma_f32_16x16x32_bf16 v[216:219], v[172:175], v[140:143], 0
  v_mfma_f32_16x16x32_bf16 v[220:223], v[178:181], v[140:143], 0
  v_mfma_f32_16x16x32_bf16 v[224:227], v[184:187], v[144:147], 0
  v_mfma_f32_16x16x32_bf16 v[228:231], v[190:193], v[144:147], 0
  s_lshl_b32 s41, s31, 18
  s_add_u32 s42, s41, 131072
  s_nop 1
  v_cvt_pk_bf16_f32 v148, v200, v201
  v_cvt_pk_bf16_f32 v149, v202, v203
  v_cvt_pk_bf16_f32 v150, v204, v205
  v_cvt_pk_bf16_f32 v151, v206, v207
  buffer_store_dwordx4 v[148:151], v105, s[4:7], s41 offen offset:1024 sc1
  v_cvt_pk_bf16_f32 v152, v208, v209
  v_cvt_pk_bf16_f32 v153, v210, v211
  v_cvt_pk_bf16_f32 v154, v212, v213
  v_cvt_pk_bf16_f32 v155, v214, v215
  buffer_store_dwordx4 v[152:155], v105, s[4:7], s42 offen offset:1024 sc1
  v_cvt_pk_bf16_f32 v156, v216, v217
  v_cvt_pk_bf16_f32 v157, v218, v219
  v_cvt_pk_bf16_f32 v158, v220, v221
  v_cvt_pk_bf16_f32 v159, v222, v223
  buffer_store_dwordx4 v[156:159], v105, s[4:7], s41 offen offset:0 sc1
  s_nop 0
  v_cvt_pk_bf16_f32 v160, v224, v225
  v_cvt_pk_bf16_f32 v161, v226, v227
  v_cvt_pk_bf16_f32 v162, v228, v229
  v_cvt_pk_bf16_f32 v163, v230, v231
  buffer_store_dwordx4 v[160:163], v105, s[4:7], s42 offen offset:0 sc1
  s_lshl_b32 s69, s30, 2
  s_add_u32 s69, s69, s3
  s_lshl_b32 s69, s69, 4
  s_add_u32 s69, s69, s31
  s_add_u32 s69, s69, 1024
  s_lshl_b32 s69, s69, 6
  s_mov_b32 s30, s36
  s_mov_b32 s31, s37
  s_mov_b32 s49, s98
  v_mov_b32 v32, v104
  v_mov_b32 v231, v104
  v_mov_b32 v43, v128
  v_and_b32 v44, 15, v32
  s_lshl_b32 s32, s30, 13
  s_lshl_b32 s33, s3, 11
  s_add_u32 s32, s32, s33
  v_lshlrev_b32 v80, 4, v32
  v_add_u32 v33, s32, v80
  v_add_u32 v34, 131072, v33
  s_lshl_b32 s16, s98, 1
  s_lshl_b32 s32, s30, 2
  s_add_u32 s32, s32, s3
  s_lshl_b32 s32, s32, 4
  s_add_u32 s32, s32, 1024
  v_add_u32 v45, s32, v44
  v_lshlrev_b32 v45, 6, v45
  v_mov_b32 v158, s19
  v_mov_b32 v159, s19
  v_lshlrev_b32 v46, 2, v32
  s_bfe_u32 s44, s19, 0x80000
  s_bfe_u32 s45, s19, 0x80008
  s_bfe_u32 s46, s19, 0x80010
  s_bfe_u32 s47, s19, 0x80018
  s_mov_b32 s92, s30
  s_mov_b32 s93, s31
  s_and_b32 s28, s2, 7
  s_lshr_b32 s29, s2, 3
  s_lshr_b32 s30, s28, 2
  s_xor_b32 s30, s30, 1
  s_lshl_b32 s30, s30, 2
  s_and_b32 s31, s29, 3
  s_add_u32 s30, s30, s31
  s_and_b32 s31, s28, 3
  s_lshl_b32 s31, s31, 3
  s_lshr_b32 s29, s29, 2
  s_add_u32 s31, s31, s29
  s_lshl_b32 s32, s30, 14
  s_lshl_b32 s33, s3, 12
  s_add_u32 s32, s32, s33
  v_lshlrev_b32 v224, 4, v231
  v_add_u32 v224, s32, v224
  s_and_b32 s33, s3, 1
  s_mul_i32 s34, s33, 114688
  s_mul_i32 s35, s31, 224
  s_add_u32 s34, s34, s35
  s_movk_i32 s36, 4682
  s_movk_i32 s37, 7168
  s_and_b32 s39, s31, 1
  s_lshl_b32 s39, s39, 1
  v_add_u32 v234, 0, v231
  v_mul_u32_u24 v235, s36, v234
  v_lshrrev_b32 v235, 16, v235
  v_mul_u32_u24 v236, 14, v235
  v_sub_u32 v236, v234, v236
  v_add_u32 v236, s39, v236
  v_subrev_u32 v237, 14, v236
  v_min_u32 v236, v236, v237
  v_mul_u32_u24 v235, s37, v235
  v_lshl_add_u32 v235, v236, 4, v235
  v_add_u32 v235, s34, v235
  v_subrev_u32 v225, 0, v235
  v_add_u32 v234, 64, v231
  v_mul_u32_u24 v235, s36, v234
  v_lshrrev_b32 v235, 16, v235
  v_mul_u32_u24 v236, 14, v235
  v_sub_u32 v236, v234, v236
  v_add_u32 v236, s39, v236
  v_subrev_u32 v237, 14, v236
  v_min_u32 v236, v236, v237
  v_mul_u32_u24 v235, s37, v235
  v_lshl_add_u32 v235, v236, 4, v235
  v_add_u32 v235, s34, v235
  v_subrev_u32 v226, 1024, v235
  v_add_u32 v234, 128, v231
  v_mul_u32_u24 v235, s36, v234
  v_lshrrev_b32 v235, 16, v235
  v_mul_u32_u24 v236, 14, v235
  v_sub_u32 v236, v234, v236
  v_add_u32 v236, s39, v236
  v_subrev_u32 v237, 14, v236
  v_min_u32 v236, v236, v237
  v_mul_u32_u24 v235, s37, v235
  v_lshl_add_u32 v235, v236, 4, v235
  v_add_u32 v235, s34, v235
  v_subrev_u32 v227, 2048, v235
  v_add_u32 v234, 192, v231
  v_mul_u32_u24 v235, s36, v234
  v_lshrrev_b32 v235, 16, v235
  v_mul_u32_u24 v236, 14, v235
  v_sub_u32 v236, v234, v236
  v_add_u32 v236, s39, v236
  v_subrev_u32 v237, 14, v236
  v_min_u32 v236, v236, v237
  v_mul_u32_u24 v235, s37, v235
  v_lshl_add_u32 v235, v236, 4, v235
  v_add_u32 v235, s34, v235
  v_subrev_u32 v228, 3072, v235
  s_mov_b32 s94, s30
  s_mov_b32 s95, s31
  s_mov_b32 s30, s92
  s_mov_b32 s31, s93
  s_mul_i32 s38, s3, 3584
  s_add_u32 s38, s38, 98304
  s_bfe_u32 s33, s2, 0x20003
  s_mul_i32 s17, s33, 229376
  s_cmp_eq_u32 s33, 3
  s_cselect_b32 s96, -3, 1
  s_mul_i32 s96, s96, 229376
  s_cmp_eq_u32 s33, 2
  s_cselect_b32 s97, -3, 1
  s_mul_i32 s97, s97, 229376
  s_cmp_eq_u32 s33, 1
  s_cselect_b32 s98, -3, 1
  s_mul_i32 s98, s98, 229376
  s_cmp_eq_u32 s33, 0
  s_cselect_b32 s99, 1, 5
  s_mul_i32 s99, s99, 229376
  s_cmp_lt_u32 s3, 2
  s_cselect_b32 s8, s60, s62
  s_cselect_b32 s9, s61, s63
  s_mov_b32 s10, 7340032
  s_mov_b32 s11, 0x20000
  s_waitcnt vmcnt(0)
  s_mov_b64 exec, 1
  buffer_store_dword v158, v46, s[64:67], s69 offen sc1
  s_mov_b64 exec, -1
  s_add_u32 m0, s51, 73728
  s_add_u32 s50, s49, 1179648
  s_bitset0_b32 s50, 21
  buffer_load_dwordx4 v248, s[52:55], s50 offen lds
  buffer_load_dwordx4 v249, s[52:55], s50 offen offset:1024 lds
  s_add_u32 m0, s51, 81920
  s_add_u32 s50, s49, 1310720
  s_bitset0_b32 s50, 21
  buffer_load_dwordx4 v248, s[52:55], s50 offen lds
  buffer_load_dwordx4 v249, s[52:55], s50 offen offset:1024 lds
  s_add_u32 m0, s51, 90112
  s_add_u32 s50, s49, 1441792
  s_bitset0_b32 s50, 21
  buffer_load_dwordx4 v248, s[52:55], s50 offen lds
  buffer_load_dwordx4 v249, s[52:55], s50 offen offset:1024 lds
  s_add_u32 m0, s51, 98304
  s_add_u32 s50, s49, 1572864
  s_bitset0_b32 s50, 21
  buffer_load_dwordx4 v248, s[52:55], s50 offen lds
  buffer_load_dwordx4 v249, s[52:55], s50 offen offset:1024 lds
  v_xor_b32 v168, s44, v250
  v_xor_b32 v169, s45, v251
  v_xor_b32 v170, s46, v252
  v_xor_b32 v171, s47, v253
  v_or3_b32 v172, v168, v169, v170
  v_or_b32 v172, v172, v171
  v_and_b32 v172, 0xff, v172
  v_cmp_ne_u32 vcc, 0, v172
  s_nop 1
  s_cmp_lg_u64 vcc, 0
  s_cbranch_scc1 L_vslow_11
L_vback_12:
  v_mov_b32 v172, v168
  v_mov_b32 v173, v169
  v_mov_b32 v174, v170
  v_mov_b32 v175, v171
  s_nop 1
  v_permlane16_swap_b32 v172, v168
  v_permlane16_swap_b32 v173, v169
  v_permlane16_swap_b32 v174, v170
  v_permlane16_swap_b32 v175, v171
  s_nop 1
  v_add_f32 v168, v168, v172
  v_add_f32 v169, v169, v173
  v_add_f32 v170, v170, v174
  v_add_f32 v171, v171, v175
  v_mov_b32 v172, v168
  v_mov_b32 v173, v169
  v_mov_b32 v174, v170
  v_mov_b32 v175, v171
  s_nop 1
  v_permlane32_swap_b32 v172, v168
  v_permlane32_swap_b32 v173, v169
  v_permlane32_swap_b32 v174, v170
  v_permlane32_swap_b32 v175, v171
  s_nop 1
  v_add_f32 v168, v168, v172
  v_add_f32 v169, v169, v173
  v_add_f32 v170, v170, v174
  v_add_f32 v171, v171, v175
  v_cvt_pk_bf16_f32 v172, v168, v169
  v_lshlrev_b32 v168, 16, v172
  v_and_b32 v169, 0xffff0000, v172
  v_cvt_pk_bf16_f32 v173, v170, v171
  v_lshlrev_b32 v170, 16, v173
  v_and_b32 v171, 0xffff0000, v173
  s_cmp_eq_u32 s3, 2
  s_cselect_b32 s33, 1.0, 0
  v_add_f32 v168, s33, v168
  v_add_f32 v169, s33, v169
  v_add_f32 v170, s33, v170
  v_add_f32 v171, s33, v171
  v_cvt_pk_bf16_f32 v172, v168, v169
  v_lshlrev_b32 v168, 16, v172
  v_and_b32 v169, 0xffff0000, v172
  v_cvt_pk_bf16_f32 v173, v170, v171
  v_lshlrev_b32 v170, 16, v173
  v_and_b32 v171, 0xffff0000, v173
  v_lshlrev_b32 v172, 4, v44
  s_lshl_b32 s33, s3, 8
  s_add_u32 s33, s33, 162816
  v_add_u32 v172, s33, v172
  ds_write_b128 v172, v[168:171]
  v_lshrrev_b32 v82, 2, v32
  v_lshlrev_b32 v82, 7, v82
  v_bfe_u32 v81, v32, 3, 2
  v_lshl_add_u32 v82, v81, 5, v82
  v_and_b32 v81, 3, v32
  v_lshl_add_u32 v35, v81, 3, v82
  v_xor_b32 v36, 32, v35
  v_xor_b32 v37, 64, v35
  v_xor_b32 v38, 96, v35
  v_add_u32 v39, 65536, v35
  v_add_u32 v40, 65536, v36
  v_add_u32 v41, 65536, v37
  v_add_u32 v42, 65536, v38
  v_lshrrev_b32 v47, 4, v32
  v_lshlrev_b32 v46, 4, v47
  v_add_u32 v253, 162816, v46
  s_waitcnt vmcnt(0) lgkmcnt(0)
  s_waitcnt vmcnt(63)
  s_barrier
  ds_read_b64_tr_b16 v[88:89], v35 offset:0
  ds_read_b64_tr_b16 v[90:91], v35 offset:2048
  ds_read_b64_tr_b16 v[92:93], v36 offset:0
  ds_read_b64_tr_b16 v[94:95], v36 offset:2048
  ds_read_b64_tr_b16 v[96:97], v37 offset:0
  ds_read_b64_tr_b16 v[98:99], v37 offset:2048
  ds_read_b64_tr_b16 v[100:101], v38 offset:0
  ds_read_b64_tr_b16 v[102:103], v38 offset:2048
  ds_read_b64_tr_b16 v[104:105], v35 offset:4096
  ds_read_b64_tr_b16 v[106:107], v35 offset:6144
  ds_read_b64_tr_b16 v[108:109], v36 offset:4096
  ds_read_b64_tr_b16 v[110:111], v36 offset:6144
  ds_read_b64_tr_b16 v[112:113], v37 offset:4096
  ds_read_b64_tr_b16 v[114:115], v37 offset:6144
  ds_read_b64_tr_b16 v[116:117], v38 offset:4096
  ds_read_b64_tr_b16 v[118:119], v38 offset:6144
  ds_read_b128 v[64:67], v253 offset:0
  ds_read_b128 v[68:71], v253 offset:64
  ds_read_b128 v[72:75], v253 offset:128
  ds_read_b128 v[76:79], v253 offset:192
  ds_read_b128 v[168:171], v253 offset:256
  ds_read_b128 v[172:175], v253 offset:320
  ds_read_b128 v[176:179], v253 offset:384
  ds_read_b128 v[180:183], v253 offset:448
  ds_read_b128 v[184:187], v253 offset:512
  ds_read_b128 v[188:191], v253 offset:576
  ds_read_b128 v[192:195], v253 offset:640
  ds_read_b128 v[196:199], v253 offset:704
  buffer_load_dword v87, v45, s[64:67], 0 offen sc1
  v_mov_b32 v252, v43
  v_accvgpr_read_b32 v48, a240
  v_accvgpr_read_b32 v49, a241
  v_accvgpr_read_b32 v50, a242
  v_accvgpr_read_b32 v51, a243
  v_accvgpr_read_b32 v52, a244
  v_accvgpr_read_b32 v53, a245
  v_accvgpr_read_b32 v54, a246
  v_accvgpr_read_b32 v55, a247
  v_accvgpr_read_b32 v56, a248
  v_accvgpr_read_b32 v57, a249
  v_accvgpr_read_b32 v58, a250
  v_accvgpr_read_b32 v59, a251
  v_accvgpr_read_b32 v60, a252
  v_accvgpr_read_b32 v61, a253
  v_accvgpr_read_b32 v62, a254
  v_accvgpr_read_b32 v63, a255
  s_lshl_b32 s41, s31, 18
  s_add_u32 s42, s41, 131072
  v_permlane16_swap_b32 v48, v50
  v_permlane16_swap_b32 v49, v51
  v_permlane16_swap_b32 v52, v54
  v_permlane16_swap_b32 v53, v55
  v_permlane16_swap_b32 v56, v58
  v_permlane16_swap_b32 v57, v59
  v_permlane16_swap_b32 v60, v62
  v_permlane16_swap_b32 v61, v63
  v_lshlrev_b32 v120, 16, v48
  v_and_b32 v121, 0xffff0000, v48
  v_lshlrev_b32 v122, 16, v49
  v_and_b32 v123, 0xffff0000, v49
  v_lshlrev_b32 v124, 16, v50
  v_and_b32 v125, 0xffff0000, v50
  v_lshlrev_b32 v126, 16, v51
  v_and_b32 v127, 0xffff0000, v51
  v_lshlrev_b32 v128, 16, v52
  v_and_b32 v129, 0xffff0000, v52
  v_lshlrev_b32 v130, 16, v53
  v_and_b32 v131, 0xffff0000, v53
  v_lshlrev_b32 v132, 16, v54
  v_and_b32 v133, 0xffff0000, v54
  v_lshlrev_b32 v134, 16, v55
  v_and_b32 v135, 0xffff0000, v55
  v_lshlrev_b32 v136, 16, v56
  v_and_b32 v137, 0xffff0000, v56
  v_lshlrev_b32 v138, 16, v57
  v_and_b32 v139, 0xffff0000, v57
  v_lshlrev_b32 v140, 16, v58
  v_and_b32 v141, 0xffff0000, v58
  v_lshlrev_b32 v142, 16, v59
  v_and_b32 v143, 0xffff0000, v59
  v_lshlrev_b32 v144, 16, v60
  v_and_b32 v145, 0xffff0000, v60
  v_lshlrev_b32 v146, 16, v61
  v_and_b32 v147, 0xffff0000, v61
  v_lshlrev_b32 v148, 16, v62
  v_and_b32 v149, 0xffff0000, v62
  v_lshlrev_b32 v150, 16, v63
  v_and_b32 v151, 0xffff0000, v63
  s_add_u32 s52, s20, 0x180000
  s_addc_u32 s53, s21, 0
  s_mov_b32 s54, 0x80000
  s_mov_b32 s55, 0x20000
  s_lshl2_add_u32 s56, s30, s3
  s_lshl_b32 s56, s56, 12
  s_lshl_b32 s57, s31, 8
  s_add_u32 s57, s57, s56
  v_mov_b32 v81, 0xffffff00
  s_mov_b32 s33, 262144
L_spin_15:
  s_waitcnt vmcnt(0)
  v_cmp_ne_u32 vcc, s19, v87
  s_nop 1
  s_and_b32 s32, vcc_lo, 0xffff
  s_cbranch_scc0 L_rdy_16
  buffer_load_dword v87, v45, s[64:67], 0 offen sc1
  s_sub_u32 s33, s33, 1
  s_cmp_lg_u32 s33, 0
  s_cbranch_scc1 L_spin_15
L_rdy_16:
  buffer_load_dwordx4 a[0:3], v33, s[4:7], s16 offen offset:0 sc1
  buffer_load_dwordx4 a[4:7], v33, s[4:7], s16 offen offset:1024 sc1
  buffer_load_dwordx4 a[8:11], v34, s[4:7], s16 offen offset:0 sc1
  buffer_load_dwordx4 a[12:15], v34, s[4:7], s16 offen offset:1024 sc1
  s_add_u32 s16, s16, 262144
  s_bitset0_b32 s16, 22
  buffer_load_dwordx4 a[16:19], v33, s[4:7], s16 offen offset:0 sc1
  buffer_load_dwordx4 a[20:23], v33, s[4:7], s16 offen offset:1024 sc1
  buffer_load_dwordx4 a[24:27], v34, s[4:7], s16 offen offset:0 sc1
  buffer_load_dwordx4 a[28:31], v34, s[4:7], s16 offen offset:1024 sc1
  s_add_u32 s16, s16, 262144
  s_bitset0_b32 s16, 22
  buffer_load_dwordx4 a[32:35], v33, s[4:7], s16 offen offset:0 sc1
  buffer_load_dwordx4 a[36:39], v33, s[4:7], s16 offen offset:1024 sc1
  buffer_load_dwordx4 a[40:43], v34, s[4:7], s16 offen offset:0 sc1
  buffer_load_dwordx4 a[44:47], v34, s[4:7], s16 offen offset:1024 sc1
  s_add_u32 s16, s16, 262144
  s_bitset0_b32 s16, 22
  buffer_load_dwordx4 a[48:51], v33, s[4:7], s16 offen offset:0 sc1
  buffer_load_dwordx4 a[52:55], v33, s[4:7], s16 offen offset:1024 sc1
  buffer_load_dwordx4 a[56:59], v34, s[4:7], s16 offen offset:0 sc1
  buffer_load_dwordx4 a[60:63], v34, s[4:7], s16 offen offset:1024 sc1
  s_add_u32 s16, s16, 262144
  s_bitset0_b32 s16, 22
  s_waitcnt vmcnt(12) lgkmcnt(10)
  v_mfma_f32_16x16x32_bf16 v[0:3], v[88:91], a[0:3], 0
  buffer_load_dwordx4 a[64:67], v33, s[4:7], s16 offen offset:0 sc1
  v_mfma_f32_16x16x32_bf16 v[16:19], v[88:91], a[4:7], 0
  ds_read_b64_tr_b16 v[88:89], v35 offset:8192
  ds_read_b64_tr_b16 v[90:91], v35 offset:10240
  v_mfma_f32_16x16x32_bf16 v[4:7], v[92:95], a[0:3], 0
  buffer_load_dwordx4 a[68:71], v33, s[4:7], s16 offen offset:1024 sc1
  v_mfma_f32_16x16x32_bf16 v[20:23], v[92:95], a[4:7], 0
  ds_read_b64_tr_b16 v[92:93], v36 offset:8192
  ds_read_b64_tr_b16 v[94:95], v36 offset:10240
  v_mfma_f32_16x16x32_bf16 v[8:11], v[96:99], a[0:3], 0
  v_mfma_f32_16x16x32_bf16 v[24:27], v[96:99], a[4:7], 0
  buffer_load_dwordx4 a[72:75], v34, s[4:7], s16 offen offset:0 sc1
  v_mfma_f32_16x16x32_bf16 v[12:15], v[100:103], a[0:3], 0
  ds_read_b64_tr_b16 v[96:97], v37 offset:8192
  ds_read_b64_tr_b16 v[98:99], v37 offset:10240
  v_mfma_f32_16x16x32_bf16 v[28:31], v[100:103], a[4:7], 0
  buffer_load_dwordx4 a[76:79], v34, s[4:7], s16 offen offset:1024 sc1
  v_mfma_f32_16x16x32_bf16 v[0:3], v[104:107], a[8:11], v[0:3]
  ds_read_b64_tr_b16 v[100:101], v38 offset:8192
  ds_read_b64_tr_b16 v[102:103], v38 offset:10240
  v_mfma_f32_16x16x32_bf16 v[16:19], v[104:107], a[12:15], v[16:19]
  ds_read_b64_tr_b16 v[104:105], v35 offset:12288
  ds_read_b64_tr_b16 v[106:107], v35 offset:14336
  v_mfma_f32_16x16x32_bf16 v[4:7], v[108:111], a[8:11], v[4:7]
  s_add_u32 s16, s16, 262144
  v_mfma_f32_16x16x32_bf16 v[20:23], v[108:111], a[12:15], v[20:23]
  ds_read_b64_tr_b16 v[108:109], v36 offset:12288
  ds_read_b64_tr_b16 v[110:111], v36 offset:14336
  v_mfma_f32_16x16x32_bf16 v[8:11], v[112:115], a[8:11], v[8:11]
  s_bitset0_b32 s16, 22
  v_mfma_f32_16x16x32_bf16 v[24:27], v[112:115], a[12:15], v[24:27]
  ds_read_b64_tr_b16 v[112:113], v37 offset:12288
  ds_read_b64_tr_b16 v[114:115], v37 offset:14336
  v_mfma_f32_16x16x32_bf16 v[12:15], v[116:119], a[8:11], v[12:15]
  v_mfma_f32_16x16x32_bf16 v[28:31], v[116:119], a[12:15], v[28:31]
  s_waitcnt vmcnt(12) lgkmcnt(10)
  ds_read_b64_tr_b16 v[116:117], v38 offset:12288
  v_mfma_f32_16x16x32_bf16 v[0:3], v[88:91], a[16:19], v[0:3]
  buffer_load_dwordx4 a[80:83], v33, s[4:7], s16 offen offset:0 sc1
  v_mfma_f32_16x16x32_bf16 v[16:19], v[88:91], a[20:23], v[16:19]
  ds_read_b64_tr_b16 v[118:119], v38 offset:14336
  ds_read_b64_tr_b16 v[88:89], v35 offset:16384
  v_mfma_f32_16x16x32_bf16 v[4:7], v[92:95], a[16:19], v[4:7]
  buffer_load_dwordx4 a[84:87], v33, s[4:7], s16 offen offset:1024 sc1
  v_mfma_f32_16x16x32_bf16 v[20:23], v[92:95], a[20:23], v[20:23]
  ds_read_b64_tr_b16 v[90:91], v35 offset:18432
  ds_read_b64_tr_b16 v[92:93], v36 offset:16384
  s_waitcnt lgkmcnt(10)
  v_mfma_f32_16x16x32_bf16 v[8:11], v[96:99], a[16:19], v[8:11]
  ds_read_b64_tr_b16 v[94:95], v36 offset:18432
  v_mfma_f32_16x16x32_bf16 v[24:27], v[96:99], a[20:23], v[24:27]
  buffer_load_dwordx4 a[88:91], v34, s[4:7], s16 offen offset:0 sc1
  v_mfma_f32_16x16x32_bf16 v[12:15], v[100:103], a[16:19], v[12:15]
  ds_read_b64_tr_b16 v[96:97], v37 offset:16384
  ds_read_b64_tr_b16 v[98:99], v37 offset:18432
  v_mfma_f32_16x16x32_bf16 v[28:31], v[100:103], a[20:23], v[28:31]
  buffer_load_dwordx4 a[92:95], v34, s[4:7], s16 offen offset:1024 sc1
  s_waitcnt lgkmcnt(10)
  v_mfma_f32_16x16x32_bf16 v[0:3], v[104:107], a[24:27], v[0:3]
  ds_read_b64_tr_b16 v[100:101], v38 offset:16384
  ds_read_b64_tr_b16 v[102:103], v38 offset:18432
  v_mfma_f32_16x16x32_bf16 v[16:19], v[104:107], a[28:31], v[16:19]
  ds_read_b64_tr_b16 v[104:105], v35 offset:20480
  ds_read_b64_tr_b16 v[106:107], v35 offset:22528
  v_mfma_f32_16x16x32_bf16 v[4:7], v[108:111], a[24:27], v[4:7]
  s_add_u32 s16, s16, 262144
  v_mfma_f32_16x16x32_bf16 v[20:23], v[108:111], a[28:31], v[20:23]
  ds_read_b64_tr_b16 v[108:109], v36 offset:20480
  ds_read_b64_tr_b16 v[110:111], v36 offset:22528
  s_waitcnt lgkmcnt(10)
  v_mfma_f32_16x16x32_bf16 v[8:11], v[112:115], a[24:27], v[8:11]
  s_bitset0_b32 s16, 22
  v_mfma_f32_16x16x32_bf16 v[24:27], v[112:115], a[28:31], v[24:27]
  ds_read_b64_tr_b16 v[112:113], v37 offset:20480
  ds_read_b64_tr_b16 v[114:115], v37 offset:22528
  v_mfma_f32_16x16x32_bf16 v[12:15], v[116:119], a[24:27], v[12:15]
  v_mfma_f32_16x16x32_bf16 v[28:31], v[116:119], a[28:31], v[28:31]
  s_waitcnt vmcnt(12) lgkmcnt(10)
  ds_read_b64_tr_b16 v[116:117], v38 offset:20480
  v_mfma_f32_16x16x32_bf16 v[0:3], v[88:91], a[32:35], v[0:3]
  buffer_load_dwordx4 a[96:99], v33, s[4:7], s16 offen offset:0 sc1
  v_mfma_f32_16x16x32_bf16 v[16:19], v[88:91], a[36:39], v[16:19]
  ds_read_b64_tr_b16 v[118:119], v38 offset:22528
  ds_read_b64_tr_b16 v[88:89], v35 offset:24576
  v_mfma_f32_16x16x32_bf16 v[4:7], v[92:95], a[32:35], v[4:7]
  buffer_load_dwordx4 a[100:103], v33, s[4:7], s16 offen offset:1024 sc1
  v_mfma_f32_16x16x32_bf16 v[20:23], v[92:95], a[36:39], v[20:23]
  ds_read_b64_tr_b16 v[90:91], v35 offset:26624
  ds_read_b64_tr_b16 v[92:93], v36 offset:24576
  s_waitcnt lgkmcnt(10)
  v_mfma_f32_16x16x32_bf16 v[8:11], v[96:99], a[32:35], v[8:11]
  ds_read_b64_tr_b16 v[94:95], v36 offset:26624
  v_mfma_f32_16x16x32_bf16 v[24:27], v[96:99], a[36:39], v[24:27]
  buffer_load_dwordx4 a[104:107], v34, s[4:7], s16 offen offset:0 sc1
  v_mfma_f32_16x16x32_bf16 v[12:15], v[100:103], a[32:35], v[12:15]
  ds_read_b64_tr_b16 v[96:97], v37 offset:24576
  ds_read_b64_tr_b16 v[98:99], v37 offset:26624
  v_mfma_f32_16x16x32_bf16 v[28:31], v[100:103], a[36:39], v[28:31]
  buffer_load_dwordx4 a[108:111], v34, s[4:7], s16 offen offset:1024 sc1
  s_waitcnt lgkmcnt(10)
  v_mfma_f32_16x16x32_bf16 v[0:3], v[104:107], a[40:43], v[0:3]
  ds_read_b64_tr_b16 v[100:101], v38 offset:24576
  ds_read_b64_tr_b16 v[102:103], v38 offset:26624
  v_mfma_f32_16x16x32_bf16 v[16:19], v[104:107], a[44:47], v[16:19]
  ds_read_b64_tr_b16 v[104:105], v35 offset:28672
  ds_read_b64_tr_b16 v[106:107], v35 offset:30720
  v_mfma_f32_16x16x32_bf16 v[4:7], v[108:111], a[40:43], v[4:7]
  s_add_u32 s16, s16, 262144
  v_mfma_f32_16x16x32_bf16 v[20:23], v[108:111], a[44:47], v[20:23]
  ds_read_b64_tr_b16 v[108:109], v36 offset:28672
  ds_read_b64_tr_b16 v[110:111], v36 offset:30720
  s_waitcnt lgkmcnt(10)
  v_mfma_f32_16x16x32_bf16 v[8:11], v[112:115], a[40:43], v[8:11]
  s_bitset0_b32 s16, 22
  v_mfma_f32_16x16x32_bf16 v[24:27], v[112:115], a[44:47], v[24:27]
  ds_read_b64_tr_b16 v[112:113], v37 offset:28672
  ds_read_b64_tr_b16 v[114:115], v37 offset:30720
  v_mfma_f32_16x16x32_bf16 v[12:15], v[116:119], a[40:43], v[12:15]
  v_mfma_f32_16x16x32_bf16 v[28:31], v[116:119], a[44:47], v[28:31]
  s_waitcnt vmcnt(12) lgkmcnt(10)
  ds_read_b64_tr_b16 v[116:117], v38 offset:28672
  v_mfma_f32_16x16x32_bf16 v[0:3], v[88:91], a[48:51], v[0:3]
  buffer_load_dwordx4 a[112:115], v33, s[4:7], s16 offen offset:0 sc1
  v_mfma_f32_16x16x32_bf16 v[16:19], v[88:91], a[52:55], v[16:19]
  ds_read_b64_tr_b16 v[118:119], v38 offset:30720
  ds_read_b64_tr_b16 v[88:89], v35 offset:32768
  v_mfma_f32_16x16x32_bf16 v[4:7], v[92:95], a[48:51], v[4:7]
  buffer_load_dwordx4 a[116:119], v33, s[4:7], s16 offen offset:1024 sc1
  v_mfma_f32_16x16x32_bf16 v[20:23], v[92:95], a[52:55], v[20:23]
  ds_read_b64_tr_b16 v[90:91], v35 offset:34816
  ds_read_b64_tr_b16 v[92:93], v36 offset:32768
  s_waitcnt lgkmcnt(10)
  v_mfma_f32_16x16x32_bf16 v[8:11], v[96:99], a[48:51], v[8:11]
  ds_read_b64_tr_b16 v[94:95], v36 offset:34816
  v_mfma_f32_16x16x32_bf16 v[24:27], v[96:99], a[52:55], v[24:27]
  buffer_load_dwordx4 a[120:123], v34, s[4:7], s16 offen offset:0 sc1
  v_mfma_f32_16x16x32_bf16 v[12:15], v[100:103], a[48:51], v[12:15]
  ds_read_b64_tr_b16 v[96:97], v37 offset:32768
  ds_read_b64_tr_b16 v[98:99], v37 offset:34816
  v_mfma_f32_16x16x32_bf16 v[28:31], v[100:103], a[52:55], v[28:31]
  buffer_load_dwordx4 a[124:127], v34, s[4:7], s16 offen offset:1024 sc1
  s_waitcnt lgkmcnt(10)
  v_mfma_f32_16x16x32_bf16 v[0:3], v[104:107], a[56:59], v[0:3]
  ds_read_b64_tr_b16 v[100:101], v38 offset:32768
  ds_read_b64_tr_b16 v[102:103], v38 offset:34816
  v_mfma_f32_16x16x32_bf16 v[16:19], v[104:107], a[60:63], v[16:19]
  ds_read_b64_tr_b16 v[104:105], v35 offset:36864
  ds_read_b64_tr_b16 v[106:107], v35 offset:38912
  v_mfma_f32_16x16x32_bf16 v[4:7], v[108:111], a[56:59], v[4:7]
  s_add_u32 s16, s16, 262144
  v_mfma_f32_16x16x32_bf16 v[20:23], v[108:111], a[60:63], v[20:23]
  ds_read_b64_tr_b16 v[108:109], v36 offset:36864
  ds_read_b64_tr_b16 v[110:111], v36 offset:38912
  s_waitcnt lgkmcnt(10)
  v_mfma_f32_16x16x32_bf16 v[8:11], v[112:115], a[56:59], v[8:11]
  s_bitset0_b32 s16, 22
  v_mfma_f32_16x16x32_bf16 v[24:27], v[112:115], a[60:63], v[24:27]
  ds_read_b64_tr_b16 v[112:113], v37 offset:36864
  ds_read_b64_tr_b16 v[114:115], v37 offset:38912
  v_mfma_f32_16x16x32_bf16 v[12:15], v[116:119], a[56:59], v[12:15]
  v_mfma_f32_16x16x32_bf16 v[28:31], v[116:119], a[60:63], v[28:31]
  s_waitcnt vmcnt(12) lgkmcnt(10)
  ds_read_b64_tr_b16 v[116:117], v38 offset:36864
  v_mfma_f32_16x16x32_bf16 v[0:3], v[88:91], a[64:67], v[0:3]
  buffer_load_dwordx4 a[0:3], v33, s[4:7], s16 offen offset:0 sc1
  v_mfma_f32_16x16x32_bf16 v[16:19], v[88:91], a[68:71], v[16:19]
  ds_read_b64_tr_b16 v[118:119], v38 offset:38912
  ds_read_b64_tr_b16 v[88:89], v35 offset:40960
  v_mfma_f32_16x16x32_bf16 v[4:7], v[92:95], a[64:67], v[4:7]
  buffer_load_dwordx4 a[4:7], v33, s[4:7], s16 offen offset:1024 sc1
  v_mfma_f32_16x16x32_bf16 v[20:23], v[92:95], a[68:71], v[20:23]
  ds_read_b64_tr_b16 v[90:91], v35 offset:43008
  ds_read_b64_tr_b16 v[92:93], v36 offset:40960
  s_waitcnt lgkmcnt(10)
  v_mfma_f32_16x16x32_bf16 v[8:11], v[96:99], a[64:67], v[8:11]
  ds_read_b64_tr_b16 v[94:95], v36 offset:43008
  v_mfma_f32_16x16x32_bf16 v[24:27], v[96:99], a[68:71], v[24:27]
  buffer_load_dwordx4 a[8:11], v34, s[4:7], s16 offen offset:0 sc1
  v_mfma_f32_16x16x32_bf16 v[12:15], v[100:103], a[64:67], v[12:15]
  ds_read_b64_tr_b16 v[96:97], v37 offset:40960
  ds_read_b64_tr_b16 v[98:99], v37 offset:43008
  v_mfma_f32_16x16x32_bf16 v[28:31], v[100:103], a[68:71], v[28:31]
  buffer_load_dwordx4 a[12:15], v34, s[4:7], s16 offen offset:1024 sc1
  s_waitcnt lgkmcnt(10)
  v_mfma_f32_16x16x32_bf16 v[0:3], v[104:107], a[72:75], v[0:3]
  ds_read_b64_tr_b16 v[100:101], v38 offset:40960
  ds_read_b64_tr_b16 v[102:103], v38 offset:43008
  v_mfma_f32_16x16x32_bf16 v[16:19], v[104:107], a[76:79], v[16:19]
  ds_read_b64_tr_b16 v[104:105], v35 offset:45056
  ds_read_b64_tr_b16 v[106:107], v35 offset:47104
  v_mfma_f32_16x16x32_bf16 v[4:7], v[108:111], a[72:75], v[4:7]
  s_add_u32 s16, s16, 262144
  v_mfma_f32_16x16x32_bf16 v[20:23], v[108:111], a[76:79], v[20:23]
  ds_read_b64_tr_b16 v[108:109], v36 offset:45056
  ds_read_b64_tr_b16 v[110:111], v36 offset:47104
  s_waitcnt lgkmcnt(10)
  v_mfma_f32_16x16x32_bf16 v[8:11], v[112:115], a[72:75], v[8:11]
  s_bitset0_b32 s16, 22
  v_mfma_f32_16x16x32_bf16 v[24:27], v[112:115], a[76:79], v[24:27]
  ds_read_b64_tr_b16 v[112:113], v37 offset:45056
  ds_read_b64_tr_b16 v[114:115], v37 offset:47104
  v_mfma_f32_16x16x32_bf16 v[12:15], v[116:119], a[72:75], v[12:15]
  v_mfma_f32_16x16x32_bf16 v[28:31], v[116:119], a[76:79], v[28:31]
  s_waitcnt vmcnt(12) lgkmcnt(10)
  ds_read_b64_tr_b16 v[116:117], v38 offset:45056
  v_mfma_f32_16x16x32_bf16 v[0:3], v[88:91], a[80:83], v[0:3]
  buffer_load_dwordx4 a[16:19], v33, s[4:7], s16 offen offset:0 sc1
  v_mfma_f32_16x16x32_bf16 v[16:19], v[88:91], a[84:87], v[16:19]
  ds_read_b64_tr_b16 v[118:119], v38 offset:47104
  ds_read_b64_tr_b16 v[88:89], v35 offset:49152
  v_mfma_f32_16x16x32_bf16 v[4:7], v[92:95], a[80:83], v[4:7]
  buffer_load_dwordx4 a[20:23], v33, s[4:7], s16 offen offset:1024 sc1
  v_mfma_f32_16x16x32_bf16 v[20:23], v[92:95], a[84:87], v[20:23]
  ds_read_b64_tr_b16 v[90:91], v35 offset:51200
  ds_read_b64_tr_b16 v[92:93], v36 offset:49152
  s_waitcnt lgkmcnt(10)
  v_mfma_f32_16x16x32_bf16 v[8:11], v[96:99], a[80:83], v[8:11]
  ds_read_b64_tr_b16 v[94:95], v36 offset:51200
  v_mfma_f32_16x16x32_bf16 v[24:27], v[96:99], a[84:87], v[24:27]
  buffer_load_dwordx4 a[24:27], v34, s[4:7], s16 offen offset:0 sc1
  v_mfma_f32_16x16x32_bf16 v[12:15], v[100:103], a[80:83], v[12:15]
  ds_read_b64_tr_b16 v[96:97], v37 offset:49152
  ds_read_b64_tr_b16 v[98:99], v37 offset:51200
  v_mfma_f32_16x16x32_bf16 v[28:31], v[100:103], a[84:87], v[28:31]
  buffer_load_dwordx4 a[28:31], v34, s[4:7], s16 offen offset:1024 sc1
  s_waitcnt lgkmcnt(10)
  v_mfma_f32_16x16x32_bf16 v[0:3], v[104:107], a[88:91], v[0:3]
  ds_read_b64_tr_b16 v[100:101], v38 offset:49152
  ds_read_b64_tr_b16 v[102:103], v38 offset:51200
  v_mfma_f32_16x16x32_bf16 v[16:19], v[104:107], a[92:95], v[16:19]
  ds_read_b64_tr_b16 v[104:105], v35 offset:53248
  ds_read_b64_tr_b16 v[106:107], v35 offset:55296
  v_mfma_f32_16x16x32_bf16 v[4:7], v[108:111], a[88:91], v[4:7]
  s_add_u32 s16, s16, 262144
  v_mfma_f32_16x16x32_bf16 v[20:23], v[108:111], a[92:95], v[20:23]
  ds_read_b64_tr_b16 v[108:109], v36 offset:53248
  ds_read_b64_tr_b16 v[110:111], v36 offset:55296
  s_waitcnt lgkmcnt(10)
  v_mfma_f32_16x16x32_bf16 v[8:11], v[112:115], a[88:91], v[8:11]
  s_bitset0_b32 s16, 22
  v_mfma_f32_16x16x32_bf16 v[24:27], v[112:115], a[92:95], v[24:27]
  ds_read_b64_tr_b16 v[112:113], v37 offset:53248
  ds_read_b64_tr_b16 v[114:115], v37 offset:55296
  v_mfma_f32_16x16x32_bf16 v[12:15], v[116:119], a[88:91], v[12:15]
  v_mfma_f32_16x16x32_bf16 v[28:31], v[116:119], a[92:95], v[28:31]
  s_waitcnt vmcnt(12) lgkmcnt(10)
  ds_read_b64_tr_b16 v[116:117], v38 offset:53248
  v_mfma_f32_16x16x32_bf16 v[0:3], v[88:91], a[96:99], v[0:3]
  buffer_load_dwordx4 a[32:35], v33, s[4:7], s16 offen offset:0 sc1
  v_mfma_f32_16x16x32_bf16 v[16:19], v[88:91], a[100:103], v[16:19]
  ds_read_b64_tr_b16 v[118:119], v38 offset:55296
  ds_read_b64_tr_b16 v[88:89], v35 offset:57344
  v_mfma_f32_16x16x32_bf16 v[4:7], v[92:95], a[96:99], v[4:7]
  buffer_load_dwordx4 a[36:39], v33, s[4:7], s16 offen offset:1024 sc1
  v_mfma_f32_16x16x32_bf16 v[20:23], v[92:95], a[100:103], v[20:23]
  ds_read_b64_tr_b16 v[90:91], v35 offset:59392
  ds_read_b64_tr_b16 v[92:93], v36 offset:57344
  s_waitcnt lgkmcnt(10)
  v_mfma_f32_16x16x32_bf16 v[8:11], v[96:99], a[96:99], v[8:11]
  ds_read_b64_tr_b16 v[94:95], v36 offset:59392
  v_mfma_f32_16x16x32_bf16 v[24:27], v[96:99], a[100:103], v[24:27]
  buffer_load_dwordx4 a[40:43], v34, s[4:7], s16 offen offset:0 sc1
  v_mfma_f32_16x16x32_bf16 v[12:15], v[100:103], a[96:99], v[12:15]
  ds_read_b64_tr_b16 v[96:97], v37 offset:57344
  ds_read_b64_tr_b16 v[98:99], v37 offset:59392
  v_mfma_f32_16x16x32_bf16 v[28:31], v[100:103], a[100:103], v[28:31]
  buffer_load_dwordx4 a[44:47], v34, s[4:7], s16 offen offset:1024 sc1
  s_waitcnt lgkmcnt(10)
  v_mfma_f32_16x16x32_bf16 v[0:3], v[104:107], a[104:107], v[0:3]
  ds_read_b64_tr_b16 v[100:101], v38 offset:57344
  ds_read_b64_tr_b16 v[102:103], v38 offset:59392
  v_mfma_f32_16x16x32_bf16 v[16:19], v[104:107], a[108:111], v[16:19]
  ds_read_b64_tr_b16 v[104:105], v35 offset:61440
  ds_read_b64_tr_b16 v[106:107], v35 offset:63488
  v_mfma_f32_16x16x32_bf16 v[4:7], v[108:111], a[104:107], v[4:7]
  s_add_u32 s16, s16, 262144
  v_mfma_f32_16x16x32_bf16 v[20:23], v[108:111], a[108:111], v[20:23]
  ds_read_b64_tr_b16 v[108:109], v36 offset:61440
  ds_read_b64_tr_b16 v[110:111], v36 offset:63488
  s_waitcnt lgkmcnt(10)
  v_mfma_f32_16x16x32_bf16 v[8:11], v[112:115], a[104:107], v[8:11]
  s_bitset0_b32 s16, 22
  v_mfma_f32_16x16x32_bf16 v[24:27], v[112:115], a[108:111], v[24:27]
  ds_read_b64_tr_b16 v[112:113], v37 offset:61440
  ds_read_b64_tr_b16 v[114:115], v37 offset:63488
  v_mfma_f32_16x16x32_bf16 v[12:15], v[116:119], a[104:107], v[12:15]
  v_mfma_f32_16x16x32_bf16 v[28:31], v[116:119], a[108:111], v[28:31]
  s_waitcnt vmcnt(12) lgkmcnt(10)
  ds_read_b64_tr_b16 v[116:117], v38 offset:61440
  v_mfma_f32_16x16x32_bf16 v[0:3], v[88:91], a[112:115], v[0:3]
  buffer_load_dwordx4 a[48:51], v33, s[4:7], s16 offen offset:0 sc1
  v_mfma_f32_16x16x32_bf16 v[16:19], v[88:91], a[116:119], v[16:19]
  ds_read_b64_tr_b16 v[118:119], v38 offset:63488
  ds_read_b64_tr_b16 v[88:89], v39 offset:0
  v_mfma_f32_16x16x32_bf16 v[4:7], v[92:95], a[112:115], v[4:7]
  buffer_load_dwordx4 a[52:55], v33, s[4:7], s16 offen offset:1024 sc1
  v_mfma_f32_16x16x32_bf16 v[20:23], v[92:95], a[116:119], v[20:23]
  ds_read_b64_tr_b16 v[90:91], v39 offset:2048
  ds_read_b64_tr_b16 v[92:93], v40 offset:0
  s_waitcnt lgkmcnt(10)
  v_mfma_f32_16x16x32_bf16 v[8:11], v[96:99], a[112:115], v[8:11]
  ds_read_b64_tr_b16 v[94:95], v40 offset:2048
  v_mfma_f32_16x16x32_bf16 v[24:27], v[96:99], a[116:119], v[24:27]
  buffer_load_dwordx4 a[56:59], v34, s[4:7], s16 offen offset:0 sc1
  v_mfma_f32_16x16x32_bf16 v[12:15], v[100:103], a[112:115], v[12:15]
  ds_read_b64_tr_b16 v[96:97], v41 offset:0
  ds_read_b64_tr_b16 v[98:99], v41 offset:2048
  v_mfma_f32_16x16x32_bf16 v[28:31], v[100:103], a[116:119], v[28:31]
  buffer_load_dwordx4 a[60:63], v34, s[4:7], s16 offen offset:1024 sc1
  s_waitcnt lgkmcnt(10)
  v_mfma_f32_16x16x32_bf16 v[0:3], v[104:107], a[120:123], v[0:3]
  ds_read_b64_tr_b16 v[100:101], v42 offset:0
  ds_read_b64_tr_b16 v[102:103], v42 offset:2048
  v_mfma_f32_16x16x32_bf16 v[16:19], v[104:107], a[124:127], v[16:19]
  ds_read_b64_tr_b16 v[104:105], v39 offset:4096
  ds_read_b64_tr_b16 v[106:107], v39 offset:6144
  v_mfma_f32_16x16x32_bf16 v[4:7], v[108:111], a[120:123], v[4:7]
  s_add_u32 s16, s16, 262144
  v_mfma_f32_16x16x32_bf16 v[20:23], v[108:111], a[124:127], v[20:23]
  ds_read_b64_tr_b16 v[108:109], v40 offset:4096
  ds_read_b64_tr_b16 v[110:111], v40 offset:6144
  s_waitcnt lgkmcnt(10)
  v_mfma_f32_16x16x32_bf16 v[8:11], v[112:115], a[120:123], v[8:11]
  s_bitset0_b32 s16, 22
  v_mfma_f32_16x16x32_bf16 v[24:27], v[112:115], a[124:127], v[24:27]
  ds_read_b64_tr_b16 v[112:113], v41 offset:4096
  ds_read_b64_tr_b16 v[114:115], v41 offset:6144
  v_mfma_f32_16x16x32_bf16 v[12:15], v[116:119], a[120:123], v[12:15]
  v_mfma_f32_16x16x32_bf16 v[28:31], v[116:119], a[124:127], v[28:31]
  s_waitcnt vmcnt(12) lgkmcnt(10)
  ds_read_b64_tr_b16 v[116:117], v42 offset:4096
  v_mfma_f32_16x16x32_bf16 v[0:3], v[88:91], a[0:3], v[0:3]
  buffer_load_dwordx4 a[64:67], v33, s[4:7], s16 offen offset:0 sc1
  v_mfma_f32_16x16x32_bf16 v[16:19], v[88:91], a[4:7], v[16:19]
  ds_read_b64_tr_b16 v[118:119], v42 offset:6144
  ds_read_b64_tr_b16 v[88:89], v39 offset:8192
  v_mfma_f32_16x16x32_bf16 v[4:7], v[92:95], a[0:3], v[4:7]
  buffer_load_dwordx4 a[68:71], v33, s[4:7], s16 offen offset:1024 sc1
  v_mfma_f32_16x16x32_bf16 v[20:23], v[92:95], a[4:7], v[20:23]
  ds_read_b64_tr_b16 v[90:91], v39 offset:10240
  ds_read_b64_tr_b16 v[92:93], v40 offset:8192
  s_waitcnt lgkmcnt(10)
  v_mfma_f32_16x16x32_bf16 v[8:11], v[96:99], a[0:3], v[8:11]
  ds_read_b64_tr_b16 v[94:95], v40 offset:10240
  v_mfma_f32_16x16x32_bf16 v[24:27], v[96:99], a[4:7], v[24:27]
  buffer_load_dwordx4 a[72:75], v34, s[4:7], s16 offen offset:0 sc1
  v_mfma_f32_16x16x32_bf16 v[12:15], v[100:103], a[0:3], v[12:15]
  ds_read_b64_tr_b16 v[96:97], v41 offset:8192
  ds_read_b64_tr_b16 v[98:99], v41 offset:10240
  v_mfma_f32_16x16x32_bf16 v[28:31], v[100:103], a[4:7], v[28:31]
  buffer_load_dwordx4 a[76:79], v34, s[4:7], s16 offen offset:1024 sc1
  s_waitcnt lgkmcnt(10)
  v_mfma_f32_16x16x32_bf16 v[0:3], v[104:107], a[8:11], v[0:3]
  ds_read_b64_tr_b16 v[100:101], v42 offset:8192
  ds_read_b64_tr_b16 v[102:103], v42 offset:10240
  v_mfma_f32_16x16x32_bf16 v[16:19], v[104:107], a[12:15], v[16:19]
  ds_read_b64_tr_b16 v[104:105], v39 offset:12288
  ds_read_b64_tr_b16 v[106:107], v39 offset:14336
  v_mfma_f32_16x16x32_bf16 v[4:7], v[108:111], a[8:11], v[4:7]
  s_add_u32 s16, s16, 262144
  v_mfma_f32_16x16x32_bf16 v[20:23], v[108:111], a[12:15], v[20:23]
  ds_read_b64_tr_b16 v[108:109], v40 offset:12288
  ds_read_b64_tr_b16 v[110:111], v40 offset:14336
  s_waitcnt lgkmcnt(10)
  v_mfma_f32_16x16x32_bf16 v[8:11], v[112:115], a[8:11], v[8:11]
  s_bitset0_b32 s16, 22
  v_mfma_f32_16x16x32_bf16 v[24:27], v[112:115], a[12:15], v[24:27]
  ds_read_b64_tr_b16 v[112:113], v41 offset:12288
  ds_read_b64_tr_b16 v[114:115], v41 offset:14336
  v_mfma_f32_16x16x32_bf16 v[12:15], v[116:119], a[8:11], v[12:15]
  v_mfma_f32_16x16x32_bf16 v[28:31], v[116:119], a[12:15], v[28:31]
  s_waitcnt vmcnt(12) lgkmcnt(10)
  ds_read_b64_tr_b16 v[116:117], v42 offset:12288
  v_mfma_f32_16x16x32_bf16 v[0:3], v[88:91], a[16:19], v[0:3]
  buffer_load_dwordx4 a[80:83], v33, s[4:7], s16 offen offset:0 sc1
  v_mfma_f32_16x16x32_bf16 v[16:19], v[88:91], a[20:23], v[16:19]
  ds_read_b64_tr_b16 v[118:119], v42 offset:14336
  ds_read_b64_tr_b16 v[88:89], v39 offset:16384
  v_mfma_f32_16x16x32_bf16 v[4:7], v[92:95], a[16:19], v[4:7]
  buffer_load_dwordx4 a[84:87], v33, s[4:7], s16 offen offset:1024 sc1
  v_mfma_f32_16x16x32_bf16 v[20:23], v[92:95], a[20:23], v[20:23]
  ds_read_b64_tr_b16 v[90:91], v39 offset:18432
  ds_read_b64_tr_b16 v[92:93], v40 offset:16384
  s_waitcnt lgkmcnt(10)
  v_mfma_f32_16x16x32_bf16 v[8:11], v[96:99], a[16:19], v[8:11]
  ds_read_b64_tr_b16 v[94:95], v40 offset:18432
  v_mfma_f32_16x16x32_bf16 v[24:27], v[96:99], a[20:23], v[24:27]
  buffer_load_dwordx4 a[88:91], v34, s[4:7], s16 offen offset:0 sc1
  v_mfma_f32_16x16x32_bf16 v[12:15], v[100:103], a[16:19], v[12:15]
  ds_read_b64_tr_b16 v[96:97], v41 offset:16384
  ds_read_b64_tr_b16 v[98:99], v41 offset:18432
  v_mfma_f32_16x16x32_bf16 v[28:31], v[100:103], a[20:23], v[28:31]
  buffer_load_dwordx4 a[92:95], v34, s[4:7], s16 offen offset:1024 sc1
  s_waitcnt lgkmcnt(10)
  v_mfma_f32_16x16x32_bf16 v[0:3], v[104:107], a[24:27], v[0:3]
  ds_read_b64_tr_b16 v[100:101], v42 offset:16384
  ds_read_b64_tr_b16 v[102:103], v42 offset:18432
  v_mfma_f32_16x16x32_bf16 v[16:19], v[104:107], a[28:31], v[16:19]
  ds_read_b64_tr_b16 v[104:105], v39 offset:20480
  ds_read_b64_tr_b16 v[106:107], v39 offset:22528
  v_mfma_f32_16x16x32_bf16 v[4:7], v[108:111], a[24:27], v[4:7]
  s_add_u32 s16, s16, 262144
  v_mfma_f32_16x16x32_bf16 v[20:23], v[108:111], a[28:31], v[20:23]
  ds_read_b64_tr_b16 v[108:109], v40 offset:20480
  ds_read_b64_tr_b16 v[110:111], v40 offset:22528
  s_waitcnt lgkmcnt(10)
  v_mfma_f32_16x16x32_bf16 v[8:11], v[112:115], a[24:27], v[8:11]
  s_bitset0_b32 s16, 22
  v_mfma_f32_16x16x32_bf16 v[24:27], v[112:115], a[28:31], v[24:27]
  ds_read_b64_tr_b16 v[112:113], v41 offset:20480
  ds_read_b64_tr_b16 v[114:115], v41 offset:22528
  v_mfma_f32_16x16x32_bf16 v[12:15], v[116:119], a[24:27], v[12:15]
  v_mfma_f32_16x16x32_bf16 v[28:31], v[116:119], a[28:31], v[28:31]
  s_waitcnt vmcnt(12) lgkmcnt(10)
  ds_read_b64_tr_b16 v[116:117], v42 offset:20480
  v_mfma_f32_16x16x32_bf16 v[0:3], v[88:91], a[32:35], v[0:3]
  buffer_load_dwordx4 a[96:99], v33, s[4:7], s16 offen offset:0 sc1
  v_mfma_f32_16x16x32_bf16 v[16:19], v[88:91], a[36:39], v[16:19]
  ds_read_b64_tr_b16 v[118:119], v42 offset:22528
  ds_read_b64_tr_b16 v[88:89], v39 offset:24576
  v_mfma_f32_16x16x32_bf16 v[4:7], v[92:95], a[32:35], v[4:7]
  buffer_load_dwordx4 a[100:103], v33, s[4:7], s16 offen offset:1024 sc1
  v_mfma_f32_16x16x32_bf16 v[20:23], v[92:95], a[36:39], v[20:23]
  ds_read_b64_tr_b16 v[90:91], v39 offset:26624
  ds_read_b64_tr_b16 v[92:93], v40 offset:24576
  s_waitcnt lgkmcnt(10)
  v_mfma_f32_16x16x32_bf16 v[8:11], v[96:99], a[32:35], v[8:11]
  ds_read_b64_tr_b16 v[94:95], v40 offset:26624
  v_mfma_f32_16x16x32_bf16 v[24:27], v[96:99], a[36:39], v[24:27]
  buffer_load_dwordx4 a[104:107], v34, s[4:7], s16 offen offset:0 sc1
  v_mfma_f32_16x16x32_bf16 v[12:15], v[100:103], a[32:35], v[12:15]
  ds_read_b64_tr_b16 v[96:97], v41 offset:24576
  ds_read_b64_tr_b16 v[98:99], v41 offset:26624
  v_mfma_f32_16x16x32_bf16 v[28:31], v[100:103], a[36:39], v[28:31]
  buffer_load_dwordx4 a[108:111], v34, s[4:7], s16 offen offset:1024 sc1
  s_waitcnt lgkmcnt(10)
  v_mfma_f32_16x16x32_bf16 v[0:3], v[104:107], a[40:43], v[0:3]
  ds_read_b64_tr_b16 v[100:101], v42 offset:24576
  ds_read_b64_tr_b16 v[102:103], v42 offset:26624
  v_mfma_f32_16x16x32_bf16 v[16:19], v[104:107], a[44:47], v[16:19]
  ds_read_b64_tr_b16 v[104:105], v39 offset:28672
  ds_read_b64_tr_b16 v[106:107], v39 offset:30720
  v_mfma_f32_16x16x32_bf16 v[4:7], v[108:111], a[40:43], v[4:7]
  s_add_u32 s16, s16, 262144
  v_mfma_f32_16x16x32_bf16 v[20:23], v[108:111], a[44:47], v[20:23]
  ds_read_b64_tr_b16 v[108:109], v40 offset:28672
  ds_read_b64_tr_b16 v[110:111], v40 offset:30720
  s_waitcnt lgkmcnt(10)
  v_mfma_f32_16x16x32_bf16 v[8:11], v[112:115], a[40:43], v[8:11]
  s_bitset0_b32 s16, 22
  v_mfma_f32_16x16x32_bf16 v[24:27], v[112:115], a[44:47], v[24:27]
  ds_read_b64_tr_b16 v[112:113], v41 offset:28672
  ds_read_b64_tr_b16 v[114:115], v41 offset:30720
  v_mfma_f32_16x16x32_bf16 v[12:15], v[116:119], a[40:43], v[12:15]
  v_mfma_f32_16x16x32_bf16 v[28:31], v[116:119], a[44:47], v[28:31]
  s_waitcnt vmcnt(12) lgkmcnt(10)
  ds_read_b64_tr_b16 v[116:117], v42 offset:28672
  v_mfma_f32_16x16x32_bf16 v[0:3], v[88:91], a[48:51], v[0:3]
  buffer_load_dwordx4 a[112:115], v33, s[4:7], s16 offen offset:0 sc1
  v_mfma_f32_16x16x32_bf16 v[16:19], v[88:91], a[52:55], v[16:19]
  ds_read_b64_tr_b16 v[118:119], v42 offset:30720
  ds_read_b64_tr_b16 v[88:89], v39 offset:32768
  v_mfma_f32_16x16x32_bf16 v[4:7], v[92:95], a[48:51], v[4:7]
  buffer_load_dwordx4 a[116:119], v33, s[4:7], s16 offen offset:1024 sc1
  v_mfma_f32_16x16x32_bf16 v[20:23], v[92:95], a[52:55], v[20:23]
  ds_read_b64_tr_b16 v[90:91], v39 offset:34816
  ds_read_b64_tr_b16 v[92:93], v40 offset:32768
  s_waitcnt lgkmcnt(10)
  v_mfma_f32_16x16x32_bf16 v[8:11], v[96:99], a[48:51], v[8:11]
  ds_read_b64_tr_b16 v[94:95], v40 offset:34816
  v_mfma_f32_16x16x32_bf16 v[24:27], v[96:99], a[52:55], v[24:27]
  buffer_load_dwordx4 a[120:123], v34, s[4:7], s16 offen offset:0 sc1
  v_mfma_f32_16x16x32_bf16 v[12:15], v[100:103], a[48:51], v[12:15]
  ds_read_b64_tr_b16 v[96:97], v41 offset:32768
  ds_read_b64_tr_b16 v[98:99], v41 offset:34816
  v_mfma_f32_16x16x32_bf16 v[28:31], v[100:103], a[52:55], v[28:31]
  buffer_load_dwordx4 a[124:127], v34, s[4:7], s16 offen offset:1024 sc1
  s_waitcnt lgkmcnt(10)
  v_mfma_f32_16x16x32_bf16 v[0:3], v[104:107], a[56:59], v[0:3]
  ds_read_b64_tr_b16 v[100:101], v42 offset:32768
  ds_read_b64_tr_b16 v[102:103], v42 offset:34816
  v_mfma_f32_16x16x32_bf16 v[16:19], v[104:107], a[60:63], v[16:19]
  ds_read_b64_tr_b16 v[104:105], v39 offset:36864
  ds_read_b64_tr_b16 v[106:107], v39 offset:38912
  v_mfma_f32_16x16x32_bf16 v[4:7], v[108:111], a[56:59], v[4:7]
  s_add_u32 s16, s16, 262144
  v_mfma_f32_16x16x32_bf16 v[20:23], v[108:111], a[60:63], v[20:23]
  ds_read_b64_tr_b16 v[108:109], v40 offset:36864
  ds_read_b64_tr_b16 v[110:111], v40 offset:38912
  s_waitcnt lgkmcnt(10)
  v_mfma_f32_16x16x32_bf16 v[8:11], v[112:115], a[56:59], v[8:11]
  s_bitset0_b32 s16, 22
  v_mfma_f32_16x16x32_bf16 v[24:27], v[112:115], a[60:63], v[24:27]
  ds_read_b64_tr_b16 v[112:113], v41 offset:36864
  ds_read_b64_tr_b16 v[114:115], v41 offset:38912
  v_mfma_f32_16x16x32_bf16 v[12:15], v[116:119], a[56:59], v[12:15]
  v_mfma_f32_16x16x32_bf16 v[28:31], v[116:119], a[60:63], v[28:31]
  s_waitcnt vmcnt(12) lgkmcnt(10)
  ds_read_b64_tr_b16 v[116:117], v42 offset:36864
  v_mfma_f32_16x16x32_bf16 v[0:3], v[88:91], a[64:67], v[0:3]
  ds_read_b64_tr_b16 v[118:119], v42 offset:38912
  v_mfma_f32_16x16x32_bf16 v[16:19], v[88:91], a[68:71], v[16:19]
  ds_read_b64_tr_b16 v[88:89], v39 offset:40960
  ds_read_b64_tr_b16 v[90:91], v39 offset:43008
  v_mfma_f32_16x16x32_bf16 v[4:7], v[92:95], a[64:67], v[4:7]
  v_mfma_f32_16x16x32_bf16 v[20:23], v[92:95], a[68:71], v[20:23]
  ds_read_b64_tr_b16 v[92:93], v40 offset:40960
  ds_read_b64_tr_b16 v[94:95], v40 offset:43008
  s_waitcnt lgkmcnt(10)
  v_mfma_f32_16x16x32_bf16 v[8:11], v[96:99], a[64:67], v[8:11]
  v_mfma_f32_16x16x32_bf16 v[24:27], v[96:99], a[68:71], v[24:27]
  ds_read_b64_tr_b16 v[96:97], v41 offset:40960
  ds_read_b64_tr_b16 v[98:99], v41 offset:43008
  v_mfma_f32_16x16x32_bf16 v[12:15], v[100:103], a[64:67], v[12:15]
  v_mfma_f32_16x16x32_bf16 v[28:31], v[100:103], a[68:71], v[28:31]
  ds_read_b64_tr_b16 v[100:101], v42 offset:40960
  ds_read_b64_tr_b16 v[102:103], v42 offset:43008
  v_mfma_f32_16x16x32_bf16 v[0:3], v[104:107], a[72:75], v[0:3]
  v_mfma_f32_16x16x32_bf16 v[16:19], v[104:107], a[76:79], v[16:19]
  ds_read_b64_tr_b16 v[104:105], v39 offset:45056
  ds_read_b64_tr_b16 v[106:107], v39 offset:47104
  s_waitcnt lgkmcnt(10)
  v_mfma_f32_16x16x32_bf16 v[4:7], v[108:111], a[72:75], v[4:7]
  v_mfma_f32_16x16x32_bf16 v[20:23], v[108:111], a[76:79], v[20:23]
  ds_read_b64_tr_b16 v[108:109], v40 offset:45056
  ds_read_b64_tr_b16 v[110:111], v40 offset:47104
  v_mfma_f32_16x16x32_bf16 v[8:11], v[112:115], a[72:75], v[8:11]
  v_mfma_f32_16x16x32_bf16 v[24:27], v[112:115], a[76:79], v[24:27]
  ds_read_b64_tr_b16 v[112:113], v41 offset:45056
  ds_read_b64_tr_b16 v[114:115], v41 offset:47104
  v_mfma_f32_16x16x32_bf16 v[12:15], v[116:119], a[72:75], v[12:15]
  v_mfma_f32_16x16x32_bf16 v[28:31], v[116:119], a[76:79], v[28:31]
  s_waitcnt vmcnt(8) lgkmcnt(10)
  ds_read_b64_tr_b16 v[116:117], v42 offset:45056
  v_mfma_f32_16x16x32_bf16 v[0:3], v[88:91], a[80:83], v[0:3]
  ds_read_b64_tr_b16 v[118:119], v42 offset:47104
  v_mfma_f32_16x16x32_bf16 v[16:19], v[88:91], a[84:87], v[16:19]
  ds_read_b64_tr_b16 v[88:89], v39 offset:49152
  ds_read_b64_tr_b16 v[90:91], v39 offset:51200
  v_mfma_f32_16x16x32_bf16 v[4:7], v[92:95], a[80:83], v[4:7]
  v_mfma_f32_16x16x32_bf16 v[20:23], v[92:95], a[84:87], v[20:23]
  ds_read_b64_tr_b16 v[92:93], v40 offset:49152
  ds_read_b64_tr_b16 v[94:95], v40 offset:51200
  s_waitcnt lgkmcnt(10)
  v_mfma_f32_16x16x32_bf16 v[8:11], v[96:99], a[80:83], v[8:11]
  v_mfma_f32_16x16x32_bf16 v[24:27], v[96:99], a[84:87], v[24:27]
  ds_read_b64_tr_b16 v[96:97], v41 offset:49152
  ds_read_b64_tr_b16 v[98:99], v41 offset:51200
  v_mfma_f32_16x16x32_bf16 v[12:15], v[100:103], a[80:83], v[12:15]
  v_mfma_f32_16x16x32_bf16 v[28:31], v[100:103], a[84:87], v[28:31]
  ds_read_b64_tr_b16 v[100:101], v42 offset:49152
  ds_read_b64_tr_b16 v[102:103], v42 offset:51200
  v_mfma_f32_16x16x32_bf16 v[0:3], v[104:107], a[88:91], v[0:3]
  v_mfma_f32_16x16x32_bf16 v[16:19], v[104:107], a[92:95], v[16:19]
  ds_read_b64_tr_b16 v[104:105], v39 offset:53248
  ds_read_b64_tr_b16 v[106:107], v39 offset:55296
  s_waitcnt lgkmcnt(10)
  v_mfma_f32_16x16x32_bf16 v[4:7], v[108:111], a[88:91], v[4:7]
  v_mfma_f32_16x16x32_bf16 v[20:23], v[108:111], a[92:95], v[20:23]
  ds_read_b64_tr_b16 v[108:109], v40 offset:53248
  ds_read_b64_tr_b16 v[110:111], v40 offset:55296
  v_mfma_f32_16x16x32_bf16 v[8:11], v[112:115], a[88:91], v[8:11]
  v_mfma_f32_16x16x32_bf16 v[24:27], v[112:115], a[92:95], v[24:27]
  ds_read_b64_tr_b16 v[112:113], v41 offset:53248
  ds_read_b64_tr_b16 v[114:115], v41 offset:55296
  v_mfma_f32_16x16x32_bf16 v[12:15], v[116:119], a[88:91], v[12:15]
  v_mfma_f32_16x16x32_bf16 v[28:31], v[116:119], a[92:95], v[28:31]
  s_waitcnt vmcnt(4) lgkmcnt(10)
  ds_read_b64_tr_b16 v[116:117], v42 offset:53248
  v_mfma_f32_16x16x32_bf16 v[0:3], v[88:91], a[96:99], v[0:3]
  ds_read_b64_tr_b16 v[118:119], v42 offset:55296
  v_mfma_f32_16x16x32_bf16 v[16:19], v[88:91], a[100:103], v[16:19]
  ds_read_b64_tr_b16 v[88:89], v39 offset:57344
  ds_read_b64_tr_b16 v[90:91], v39 offset:59392
  v_mfma_f32_16x16x32_bf16 v[4:7], v[92:95], a[96:99], v[4:7]
  v_mfma_f32_16x16x32_bf16 v[20:23], v[92:95], a[100:103], v[20:23]
  ds_read_b64_tr_b16 v[92:93], v40 offset:57344
  ds_read_b64_tr_b16 v[94:95], v40 offset:59392
  s_waitcnt lgkmcnt(10)
  v_mfma_f32_16x16x32_bf16 v[8:11], v[96:99], a[96:99], v[8:11]
  v_mfma_f32_16x16x32_bf16 v[24:27], v[96:99], a[100:103], v[24:27]
  ds_read_b64_tr_b16 v[96:97], v41 offset:57344
  ds_read_b64_tr_b16 v[98:99], v41 offset:59392
  v_mfma_f32_16x16x32_bf16 v[12:15], v[100:103], a[96:99], v[12:15]
  v_mfma_f32_16x16x32_bf16 v[28:31], v[100:103], a[100:103], v[28:31]
  ds_read_b64_tr_b16 v[100:101], v42 offset:57344
  ds_read_b64_tr_b16 v[102:103], v42 offset:59392
  v_mfma_f32_16x16x32_bf16 v[0:3], v[104:107], a[104:107], v[0:3]
  v_mfma_f32_16x16x32_bf16 v[16:19], v[104:107], a[108:111], v[16:19]
  ds_read_b64_tr_b16 v[104:105], v39 offset:61440
  ds_read_b64_tr_b16 v[106:107], v39 offset:63488
  s_waitcnt lgkmcnt(10)
  v_mfma_f32_16x16x32_bf16 v[4:7], v[108:111], a[104:107], v[4:7]
  v_mfma_f32_16x16x32_bf16 v[20:23], v[108:111], a[108:111], v[20:23]
  ds_read_b64_tr_b16 v[108:109], v40 offset:61440
  ds_read_b64_tr_b16 v[110:111], v40 offset:63488
  v_mfma_f32_16x16x32_bf16 v[8:11], v[112:115], a[104:107], v[8:11]
  v_mfma_f32_16x16x32_bf16 v[24:27], v[112:115], a[108:111], v[24:27]
  ds_read_b64_tr_b16 v[112:113], v41 offset:61440
  ds_read_b64_tr_b16 v[114:115], v41 offset:63488
  v_mfma_f32_16x16x32_bf16 v[12:15], v[116:119], a[104:107], v[12:15]
  v_mfma_f32_16x16x32_bf16 v[28:31], v[116:119], a[108:111], v[28:31]
  s_waitcnt vmcnt(0) lgkmcnt(10)
  ds_read_b64_tr_b16 v[116:117], v42 offset:61440
  v_mfma_f32_16x16x32_bf16 v[0:3], v[88:91], a[112:115], v[0:3]
  ds_read_b64_tr_b16 v[118:119], v42 offset:63488
  v_mfma_f32_16x16x32_bf16 v[16:19], v[88:91], a[116:119], v[16:19]
  v_mfma_f32_16x16x32_bf16 v[4:7], v[92:95], a[112:115], v[4:7]
  v_mfma_f32_16x16x32_bf16 v[20:23], v[92:95], a[116:119], v[20:23]
  s_waitcnt lgkmcnt(10)
  v_mfma_f32_16x16x32_bf16 v[8:11], v[96:99], a[112:115], v[8:11]
  v_mfma_f32_16x16x32_bf16 v[24:27], v[96:99], a[116:119], v[24:27]
  s_waitcnt lgkmcnt(8)
  v_mfma_f32_16x16x32_bf16 v[12:15], v[100:103], a[112:115], v[12:15]
  v_mfma_f32_16x16x32_bf16 v[28:31], v[100:103], a[116:119], v[28:31]
  s_waitcnt lgkmcnt(6)
  v_mfma_f32_16x16x32_bf16 v[0:3], v[104:107], a[120:123], v[0:3]
  v_mfma_f32_16x16x32_bf16 v[16:19], v[104:107], a[124:127], v[16:19]
  s_waitcnt lgkmcnt(4)
  v_mfma_f32_16x16x32_bf16 v[4:7], v[108:111], a[120:123], v[4:7]
  v_mfma_f32_16x16x32_bf16 v[20:23], v[108:111], a[124:127], v[20:23]
  s_waitcnt lgkmcnt(2)
  v_mfma_f32_16x16x32_bf16 v[8:11], v[112:115], a[120:123], v[8:11]
  v_mfma_f32_16x16x32_bf16 v[24:27], v[112:115], a[124:127], v[24:27]
  s_waitcnt lgkmcnt(0)
  v_mfma_f32_16x16x32_bf16 v[12:15], v[116:119], a[120:123], v[12:15]
  v_mfma_f32_16x16x32_bf16 v[28:31], v[116:119], a[124:127], v[28:31]
  s_nop 7
  s_nop 1
  s_barrier
  v_pk_fma_f32 v[120:121], v[0:1], v[64:65], v[120:121]
  v_pk_fma_f32 v[122:123], v[2:3], v[66:67], v[122:123]
  v_pk_fma_f32 v[124:125], v[4:5], v[68:69], v[124:125]
  v_pk_fma_f32 v[126:127], v[6:7], v[70:71], v[126:127]
  v_pk_fma_f32 v[128:129], v[8:9], v[72:73], v[128:129]
  v_pk_fma_f32 v[130:131], v[10:11], v[74:75], v[130:131]
  v_pk_fma_f32 v[132:133], v[12:13], v[76:77], v[132:133]
  v_pk_fma_f32 v[134:135], v[14:15], v[78:79], v[134:135]
  v_pk_fma_f32 v[136:137], v[16:17], v[64:65], v[136:137]
  v_pk_fma_f32 v[138:139], v[18:19], v[66:67], v[138:139]
  v_pk_fma_f32 v[140:141], v[20:21], v[68:69], v[140:141]
  v_pk_fma_f32 v[142:143], v[22:23], v[70:71], v[142:143]
  v_pk_fma_f32 v[144:145], v[24:25], v[72:73], v[144:145]
  v_pk_fma_f32 v[146:147], v[26:27], v[74:75], v[146:147]
  v_pk_fma_f32 v[148:149], v[28:29], v[76:77], v[148:149]
  v_pk_fma_f32 v[150:151], v[30:31], v[78:79], v[150:151]
  v_pk_mul_f32 v[160:161], v[120:121], v[120:121]
  v_pk_mul_f32 v[162:163], v[136:137], v[136:137]
  v_pk_fma_f32 v[160:161], v[122:123], v[122:123], v[160:161]
  v_pk_add_f32 v[152:153], v[120:121], v[122:123]
  v_pk_fma_f32 v[162:163], v[138:139], v[138:139], v[162:163]
  v_pk_add_f32 v[154:155], v[136:137], v[138:139]
  v_pk_fma_f32 v[160:161], v[124:125], v[124:125], v[160:161]
  v_pk_add_f32 v[152:153], v[152:153], v[124:125]
  v_pk_fma_f32 v[162:163], v[140:141], v[140:141], v[162:163]
  v_pk_add_f32 v[154:155], v[154:155], v[140:141]
  v_pk_fma_f32 v[160:161], v[126:127], v[126:127], v[160:161]
  v_pk_add_f32 v[152:153], v[152:153], v[126:127]
  v_pk_fma_f32 v[162:163], v[142:143], v[142:143], v[162:163]
  v_pk_add_f32 v[154:155], v[154:155], v[142:143]
  v_pk_fma_f32 v[160:161], v[128:129], v[128:129], v[160:161]
  v_pk_add_f32 v[152:153], v[152:153], v[128:129]
  v_pk_fma_f32 v[162:163], v[144:145], v[144:145], v[162:163]
  v_pk_add_f32 v[154:155], v[154:155], v[144:145]
  v_pk_fma_f32 v[160:161], v[130:131], v[130:131], v[160:161]
  v_pk_add_f32 v[152:153], v[152:153], v[130:131]
  v_pk_fma_f32 v[162:163], v[146:147], v[146:147], v[162:163]
  v_pk_add_f32 v[154:155], v[154:155], v[146:147]
  v_pk_fma_f32 v[160:161], v[132:133], v[132:133], v[160:161]
  v_pk_add_f32 v[152:153], v[152:153], v[132:133]
  v_pk_fma_f32 v[162:163], v[148:149], v[148:149], v[162:163]
  v_pk_add_f32 v[154:155], v[154:155], v[148:149]
  v_pk_fma_f32 v[160:161], v[134:135], v[134:135], v[160:161]
  v_pk_add_f32 v[152:153], v[152:153], v[134:135]
  v_pk_fma_f32 v[162:163], v[150:151], v[150:151], v[162:163]
  v_pk_add_f32 v[154:155], v[154:155], v[150:151]
  v_add_f32 v152, v152, v153
  v_add_f32 v153, v160, v161
  v_add_f32 v154, v154, v155
  v_add_f32 v155, v162, v163
  v_mov_b32 v160, v152
  v_mov_b32 v161, v153
  v_mov_b32 v162, v154
  v_mov_b32 v163, v155
  s_nop 1
  v_permlane16_swap_b32 v160, v152
  v_permlane16_swap_b32 v161, v153
  v_permlane16_swap_b32 v162, v154
  v_permlane16_swap_b32 v163, v155
  s_nop 1
  v_add_f32 v152, v152, v160
  v_add_f32 v153, v153, v161
  v_add_f32 v154, v154, v162
  v_add_f32 v155, v155, v163
  v_mov_b32 v160, v152
  v_mov_b32 v161, v153
  v_mov_b32 v162, v154
  v_mov_b32 v163, v155
  s_nop 1
  v_permlane32_swap_b32 v160, v152
  v_permlane32_swap_b32 v161, v153
  v_permlane32_swap_b32 v162, v154
  v_permlane32_swap_b32 v163, v155
  s_nop 1
  v_add_f32 v152, v152, v160
  v_add_f32 v153, v153, v161
  v_add_f32 v154, v154, v162
  v_add_f32 v155, v155, v163
  v_mul_f32 v160, 0xbc800000, v152
  v_mul_f32 v161, 0xbc800000, v154
  v_fmac_f32 v153, v160, v152
  v_fmac_f32 v155, v161, v154
  v_and_or_b32 v156, v152, v81, s44
  v_and_or_b32 v157, v153, v81, s45
  v_and_or_b32 v158, v154, v81, s46
  v_and_or_b32 v159, v155, v81, s47
  s_mov_b64 exec, 0xffff
  buffer_store_dwordx4 v[156:159], v80, s[52:55], s57 offen sc1
  s_mov_b64 exec, -1
  s_add_u32 m0, s38, 0
  s_nop 0
  buffer_load_dwordx4 v225, s[8:11], s17 offen lds
  buffer_load_dwordx4 v226, s[8:11], s17 offen offset:1024 lds
  buffer_load_dwordx4 v227, s[8:11], s17 offen offset:2048 lds
  s_mov_b32 exec_hi, 0
  buffer_load_dwordx4 v228, s[8:11], s17 offen offset:3072 lds
  s_mov_b32 exec_hi, -1
  s_add_u32 s17, s17, s96
  s_add_u32 m0, s38, 14336
  s_nop 0
  buffer_load_dwordx4 v225, s[8:11], s17 offen lds
  buffer_load_dwordx4 v226, s[8:11], s17 offen offset:1024 lds
  buffer_load_dwordx4 v227, s[8:11], s17 offen offset:2048 lds
  s_mov_b32 exec_hi, 0
  buffer_load_dwordx4 v228, s[8:11], s17 offen offset:3072 lds
  s_mov_b32 exec_hi, -1
  s_add_u32 s17, s17, s97
  s_add_u32 m0, s38, 28672
  s_nop 0
  buffer_load_dwordx4 v225, s[8:11], s17 offen lds
  buffer_load_dwordx4 v226, s[8:11], s17 offen offset:1024 lds
  buffer_load_dwordx4 v227, s[8:11], s17 offen offset:2048 lds
  s_mov_b32 exec_hi, 0
  buffer_load_dwordx4 v228, s[8:11], s17 offen offset:3072 lds
  s_mov_b32 exec_hi, -1
  s_add_u32 s17, s17, s98
  v_cvt_pk_bf16_f32 v48, v120, v121
  v_cvt_pk_bf16_f32 v49, v122, v123
  v_cvt_pk_bf16_f32 v50, v124, v125
  v_cvt_pk_bf16_f32 v51, v126, v127
  v_cvt_pk_bf16_f32 v52, v128, v129
  v_cvt_pk_bf16_f32 v53, v130, v131
  v_cvt_pk_bf16_f32 v54, v132, v133
  v_cvt_pk_bf16_f32 v55, v134, v135
  v_cvt_pk_bf16_f32 v56, v136, v137
  v_cvt_pk_bf16_f32 v57, v138, v139
  v_cvt_pk_bf16_f32 v58, v140, v141
  v_cvt_pk_bf16_f32 v59, v142, v143
  v_cvt_pk_bf16_f32 v60, v144, v145
  v_cvt_pk_bf16_f32 v61, v146, v147
  v_cvt_pk_bf16_f32 v62, v148, v149
  v_cvt_pk_bf16_f32 v63, v150, v151
  v_accvgpr_write_b32 a128, v48
  v_lshlrev_b32 v0, 16, v48
  v_and_b32 v1, 0xffff0000, v48
  v_accvgpr_write_b32 a129, v49
  v_lshlrev_b32 v2, 16, v49
  v_and_b32 v3, 0xffff0000, v49
  v_accvgpr_write_b32 a130, v50
  v_lshlrev_b32 v4, 16, v50
  v_and_b32 v5, 0xffff0000, v50
  v_accvgpr_write_b32 a131, v51
  v_lshlrev_b32 v6, 16, v51
  v_and_b32 v7, 0xffff0000, v51
  v_accvgpr_write_b32 a132, v52
  v_lshlrev_b32 v8, 16, v52
  v_and_b32 v9, 0xffff0000, v52
  v_accvgpr_write_b32 a133, v53
  v_lshlrev_b32 v10, 16, v53
  v_and_b32 v11, 0xffff0000, v53
  v_accvgpr_write_b32 a134, v54
  v_lshlrev_b32 v12, 16, v54
  v_and_b32 v13, 0xffff0000, v54
  v_accvgpr_write_b32 a135, v55
  v_lshlrev_b32 v14, 16, v55
  v_and_b32 v15, 0xffff0000, v55
  v_accvgpr_write_b32 a136, v56
  v_lshlrev_b32 v16, 16, v56
  v_and_b32 v17, 0xffff0000, v56
  v_accvgpr_write_b32 a137, v57
  v_lshlrev_b32 v18, 16, v57
  v_and_b32 v19, 0xffff0000, v57
  v_accvgpr_write_b32 a138, v58
  v_lshlrev_b32 v20, 16, v58
  v_and_b32 v21, 0xffff0000, v58
  v_accvgpr_write_b32 a139, v59
  v_lshlrev_b32 v22, 16, v59
  v_and_b32 v23, 0xffff0000, v59
  v_accvgpr_write_b32 a140, v60
  v_lshlrev_b32 v24, 16, v60
  v_and_b32 v25, 0xffff0000, v60
  v_accvgpr_write_b32 a141, v61
  v_lshlrev_b32 v26, 16, v61
  v_and_b32 v27, 0xffff0000, v61
  v_accvgpr_write_b32 a142, v62
  v_lshlrev_b32 v28, 16, v62
  v_and_b32 v29, 0xffff0000, v62
  v_accvgpr_write_b32 a143, v63
  v_lshlrev_b32 v30, 16, v63
  v_and_b32 v31, 0xffff0000, v63
  s_add_u32 s48, s20, 0xa00000
  s_addc_u32 s49, s21, 0
  s_mov_b32 s50, 0x400000
  s_mov_b32 s51, 0x20000
  s_mov_b32 s59, 262144
L_poll_17:
  buffer_load_dwordx4 v[88:91], v80, s[52:55], s56 offen offset:0 sc1
  buffer_load_dwordx4 v[92:95], v80, s[52:55], s56 offen offset:1024 sc1
  buffer_load_dwordx4 v[96:99], v80, s[52:55], s56 offen offset:2048 sc1
  buffer_load_dwordx4 v[100:103], v80, s[52:55], s56 offen offset:3072 sc1
  s_waitcnt vmcnt(3)
  v_xor_b32 v88, s44, v88
  v_xor_b32 v89, s45, v89
  v_xor_b32 v90, s46, v90
  v_xor_b32 v91, s47, v91
  v_or3_b32 v160, v88, v89, v90
  v_or_b32 v160, v160, v91
  s_waitcnt vmcnt(2)
  v_xor_b32 v92, s44, v92
  v_xor_b32 v93, s45, v93
  v_xor_b32 v94, s46, v94
  v_xor_b32 v95, s47, v95
  v_or3_b32 v160, v160, v92, v93
  v_or3_b32 v160, v160, v94, v95
  s_waitcnt vmcnt(1)
  v_xor_b32 v96, s44, v96
  v_xor_b32 v97, s45, v97
  v_xor_b32 v98, s46, v98
  v_xor_b32 v99, s47, v99
  v_or3_b32 v160, v160, v96, v97
  v_or3_b32 v160, v160, v98, v99
  s_waitcnt vmcnt(0)
  v_xor_b32 v100, s44, v100
  v_xor_b32 v101, s45, v101
  v_xor_b32 v102, s46, v102
  v_xor_b32 v103, s47, v103
  v_or3_b32 v160, v160, v100, v101
  v_or3_b32 v160, v160, v102, v103
  v_and_b32 v160, 0xff, v160
  v_cmp_ne_u32 vcc, 0, v160
  s_nop 1
  s_cmp_eq_u64 vcc, 0
  s_cbranch_scc1 L_ready_18
  s_sub_u32 s59, s59, 1
  s_cmp_lg_u32 s59, 0
  s_cbranch_scc1 L_poll_17
L_ready_18:
  v_mul_f32 v104, 0x3c800000, v88
  v_mul_f32 v105, 0x3c800000, v90
  v_mul_f32 v106, 0x3c800000, v92
  v_mul_f32 v107, 0x3c800000, v94
  v_mul_f32 v108, 0x3c800000, v96
  v_mul_f32 v109, 0x3c800000, v98
  v_mul_f32 v110, 0x3c800000, v100
  v_mul_f32 v111, 0x3c800000, v102
  v_fmac_f32 v89, v104, v88
  v_fmac_f32 v91, v105, v90
  v_fmac_f32 v93, v106, v92
  v_fmac_f32 v95, v107, v94
  v_fmac_f32 v97, v108, v96
  v_fmac_f32 v99, v109, v98
  v_fmac_f32 v101, v110, v100
  v_fmac_f32 v103, v111, v102
  v_pk_add_f32 v[152:153], v[88:89], v[92:93]
  v_pk_add_f32 v[160:161], v[96:97], v[100:101]
  v_pk_add_f32 v[154:155], v[90:91], v[94:95]
  v_pk_add_f32 v[162:163], v[98:99], v[102:103]
  v_pk_add_f32 v[152:153], v[152:153], v[160:161]
  v_pk_add_f32 v[154:155], v[154:155], v[162:163]
  v_mov_b32 v160, v152
  v_mov_b32 v161, v153
  v_mov_b32 v162, v154
  v_mov_b32 v163, v155
  s_nop 1
  v_permlane16_swap_b32 v160, v152
  v_permlane16_swap_b32 v161, v153
  v_permlane16_swap_b32 v162, v154
  v_permlane16_swap_b32 v163, v155
  s_nop 1
  v_add_f32 v152, v152, v160
  v_add_f32 v153, v153, v161
  v_add_f32 v154, v154, v162
  v_add_f32 v155, v155, v163
  v_mov_b32 v160, v152
  v_mov_b32 v161, v153
  v_mov_b32 v162, v154
  v_mov_b32 v163, v155
  s_nop 1
  v_permlane32_swap_b32 v160, v152
  v_permlane32_swap_b32 v161, v153
  v_permlane32_swap_b32 v162, v154
  v_permlane32_swap_b32 v163, v155
  s_nop 1
  v_add_f32 v152, v152, v160
  v_add_f32 v153, v153, v161
  v_add_f32 v154, v154, v162
  v_add_f32 v155, v155, v163
  v_mul_f32 v120, 0x3a800000, v152
  v_mul_f32 v124, 0x3a800000, v153
  v_mul_f32 v132, 0x3a800000, v154
  v_mul_f32 v136, 0x3a800000, v155
  v_fma_f32 v124, -v120, v120, v124
  v_fma_f32 v136, -v132, v132, v136
  v_max_f32 v124, 0, v124
  v_max_f32 v136, 0, v136
  v_cvt_pk_bf16_f32 v128, v120, v124
  v_lshlrev_b32 v120, 16, v128
  v_and_b32 v124, 0xffff0000, v128
  v_add_f32 v124, 0x3727c5ac, v124
  v_cvt_pk_bf16_f32 v128, v124, v125
  v_lshlrev_b32 v124, 16, v128
  v_and_b32 v125, 0xffff0000, v128
  v_sqrt_f32 v124, v124
  s_nop 0
  v_cvt_pk_bf16_f32 v128, v124, v125
  v_lshlrev_b32 v124, 16, v128
  v_and_b32 v125, 0xffff0000, v128
  v_rcp_f32 v124, v124
  v_mov_b32 v121, v120
  s_nop 0
  v_mov_b32 v125, v124
  v_cvt_pk_bf16_f32 v140, v132, v136
  v_lshlrev_b32 v132, 16, v140
  v_and_b32 v136, 0xffff0000, v140
  v_add_f32 v136, 0x3727c5ac, v136
  v_cvt_pk_bf16_f32 v140, v136, v137
  v_lshlrev_b32 v136, 16, v140
  v_and_b32 v137, 0xffff0000, v140
  v_sqrt_f32 v136, v136
  s_nop 0
  v_cvt_pk_bf16_f32 v140, v136, v137
  v_lshlrev_b32 v136, 16, v140
  v_and_b32 v137, 0xffff0000, v140
  v_rcp_f32 v136, v136
  v_mov_b32 v133, v132
  s_nop 0
  v_mov_b32 v137, v136
  v_pk_add_f32 v[0:1], v[0:1], v[120:121] neg_lo:[0,1] neg_hi:[0,1]
  v_pk_add_f32 v[2:3], v[2:3], v[120:121] neg_lo:[0,1] neg_hi:[0,1]
  v_pk_add_f32 v[4:5], v[4:5], v[120:121] neg_lo:[0,1] neg_hi:[0,1]
  v_pk_add_f32 v[6:7], v[6:7], v[120:121] neg_lo:[0,1] neg_hi:[0,1]
  v_pk_add_f32 v[8:9], v[8:9], v[120:121] neg_lo:[0,1] neg_hi:[0,1]
  v_pk_add_f32 v[10:11], v[10:11], v[120:121] neg_lo:[0,1] neg_hi:[0,1]
  v_pk_add_f32 v[12:13], v[12:13], v[120:121] neg_lo:[0,1] neg_hi:[0,1]
  v_pk_add_f32 v[14:15], v[14:15], v[120:121] neg_lo:[0,1] neg_hi:[0,1]
  v_pk_mul_f32 v[0:1], v[0:1], v[124:125]
  v_pk_mul_f32 v[2:3], v[2:3], v[124:125]
  v_pk_mul_f32 v[4:5], v[4:5], v[124:125]
  v_pk_mul_f32 v[6:7], v[6:7], v[124:125]
  v_pk_mul_f32 v[8:9], v[8:9], v[124:125]
  v_pk_mul_f32 v[10:11], v[10:11], v[124:125]
  v_pk_mul_f32 v[12:13], v[12:13], v[124:125]
  v_pk_mul_f32 v[14:15], v[14:15], v[124:125]
  v_pk_fma_f32 v[0:1], v[0:1], v[184:185], v[168:169]
  v_pk_fma_f32 v[2:3], v[2:3], v[186:187], v[170:171]
  v_pk_fma_f32 v[4:5], v[4:5], v[188:189], v[172:173]
  v_pk_fma_f32 v[6:7], v[6:7], v[190:191], v[174:175]
  v_pk_fma_f32 v[8:9], v[8:9], v[192:193], v[176:177]
  v_pk_fma_f32 v[10:11], v[10:11], v[194:195], v[178:179]
  v_pk_fma_f32 v[12:13], v[12:13], v[196:197], v[180:181]
  v_pk_fma_f32 v[14:15], v[14:15], v[198:199], v[182:183]
  v_cvt_pk_bf16_f32 v88, v0, v1
  v_cvt_pk_bf16_f32 v89, v2, v3
  v_cvt_pk_bf16_f32 v90, v4, v5
  v_cvt_pk_bf16_f32 v91, v6, v7
  v_cvt_pk_bf16_f32 v92, v8, v9
  v_cvt_pk_bf16_f32 v93, v10, v11
  v_cvt_pk_bf16_f32 v94, v12, v13
  v_cvt_pk_bf16_f32 v95, v14, v15
  buffer_store_dwordx4 v[88:91], v33, s[48:51], s41 offen offset:0 sc1
  buffer_store_dwordx4 v[92:95], v33, s[48:51], s42 offen offset:0 sc1
  v_pk_add_f32 v[16:17], v[16:17], v[132:133] neg_lo:[0,1] neg_hi:[0,1]
  v_pk_add_f32 v[18:19], v[18:19], v[132:133] neg_lo:[0,1] neg_hi:[0,1]
  v_pk_add_f32 v[20:21], v[20:21], v[132:133] neg_lo:[0,1] neg_hi:[0,1]
  v_pk_add_f32 v[22:23], v[22:23], v[132:133] neg_lo:[0,1] neg_hi:[0,1]
  v_pk_add_f32 v[24:25], v[24:25], v[132:133] neg_lo:[0,1] neg_hi:[0,1]
  v_pk_add_f32 v[26:27], v[26:27], v[132:133] neg_lo:[0,1] neg_hi:[0,1]
  v_pk_add_f32 v[28:29], v[28:29], v[132:133] neg_lo:[0,1] neg_hi:[0,1]
  v_pk_add_f32 v[30:31], v[30:31], v[132:133] neg_lo:[0,1] neg_hi:[0,1]
  v_pk_mul_f32 v[16:17], v[16:17], v[136:137]
  v_pk_mul_f32 v[18:19], v[18:19], v[136:137]
  v_pk_mul_f32 v[20:21], v[20:21], v[136:137]
  v_pk_mul_f32 v[22:23], v[22:23], v[136:137]
  v_pk_mul_f32 v[24:25], v[24:25], v[136:137]
  v_pk_mul_f32 v[26:27], v[26:27], v[136:137]
  v_pk_mul_f32 v[28:29], v[28:29], v[136:137]
  v_pk_mul_f32 v[30:31], v[30:31], v[136:137]
  v_pk_fma_f32 v[16:17], v[16:17], v[184:185], v[168:169]
  v_pk_fma_f32 v[18:19], v[18:19], v[186:187], v[170:171]
  v_pk_fma_f32 v[20:21], v[20:21], v[188:189], v[172:173]
  v_pk_fma_f32 v[22:23], v[22:23], v[190:191], v[174:175]
  v_pk_fma_f32 v[24:25], v[24:25], v[192:193], v[176:177]
  v_pk_fma_f32 v[26:27], v[26:27], v[194:195], v[178:179]
  v_pk_fma_f32 v[28:29], v[28:29], v[196:197], v[180:181]
  v_pk_fma_f32 v[30:31], v[30:31], v[198:199], v[182:183]
  v_cvt_pk_bf16_f32 v96, v16, v17
  v_cvt_pk_bf16_f32 v97, v18, v19
  v_cvt_pk_bf16_f32 v98, v20, v21
  v_cvt_pk_bf16_f32 v99, v22, v23
  v_cvt_pk_bf16_f32 v100, v24, v25
  v_cvt_pk_bf16_f32 v101, v26, v27
  v_cvt_pk_bf16_f32 v102, v28, v29
  v_cvt_pk_bf16_f32 v103, v30, v31
  buffer_store_dwordx4 v[96:99], v33, s[48:51], s41 offen offset:1024 sc1
  buffer_store_dwordx4 v[100:103], v33, s[48:51], s42 offen offset:1024 sc1
  s_add_u32 s64, s20, 0xb0000
  s_addc_u32 s65, s21, 0
  s_mov_b32 s66, 0x10000
  s_mov_b32 s67, 0x20000
  s_lshl_b32 s32, s30, 2
  s_add_u32 s32, s32, s3
  s_lshl_b32 s32, s32, 4
  s_add_u32 s32, s32, s31
  s_lshl_b32 s32, s32, 6
  s_mov_b32 s30, s94
  s_mov_b32 s31, s95
  s_lshl_b32 s33, s30, 2
  s_add_u32 s33, s33, s3
  s_lshl_b32 s68, s33, 11
  v_lshlrev_b32 v250, 2, v231
  v_mov_b32 v248, s19
  v_and_b32 v246, 31, v231
  v_and_b32 v245, 17, v246
  v_lshlrev_b32 v245, 6, v245
  v_lshlrev_b32 v246, 6, v246
  s_mov_b64 s[24:25], s[60:61]
  s_mov_b64 s[26:27], s[62:63]
  s_add_u32 s4, s20, 0xa00000
  s_addc_u32 s5, s21, 0
  s_mov_b32 s6, 0x400000
  s_mov_b32 s7, 0x20000
  s_bfe_u32 s33, s2, 0x20003
  s_mul_i32 s16, s33, 131072
  s_cmp_eq_u32 s33, 3
  s_cselect_b32 s44, -3, 1
  s_mul_i32 s44, s44, 131072
  s_cmp_eq_u32 s33, 2
  s_cselect_b32 s45, -3, 1
  s_mul_i32 s45, s45, 131072
  s_cmp_eq_u32 s33, 1
  s_cselect_b32 s46, -3, 1
  s_mul_i32 s46, s46, 131072
  s_cmp_eq_u32 s33, 0
  s_cselect_b32 s47, 1, 5
  s_mul_i32 s47, s47, 131072
  s_waitcnt vmcnt(0)
  s_mov_b64 exec, 1
  buffer_store_dword v248, v250, s[64:67], s32 offen sc1
  s_mov_b64 exec, -1
  s_mov_b32 s34, 262144
L_spin_19:
  buffer_load_dword v247, v245, s[64:67], s68 offen sc1
  s_waitcnt vmcnt(0)
  v_cmp_ne_u32 vcc, s19, v247
  s_nop 1
  s_cmp_eq_u64 vcc, 0
  s_cbranch_scc1 L_rdy_20
  s_sub_u32 s34, s34, 1
  s_cmp_lg_u32 s34, 0
  s_cbranch_scc1 L_spin_19
L_rdy_20:
  buffer_load_dwordx4 a[0:3], v224, s[4:7], s16 offen offset:0 sc1
  buffer_load_dwordx4 a[4:7], v224, s[4:7], s16 offen offset:1024 sc1
  buffer_load_dwordx4 a[8:11], v224, s[4:7], s16 offen offset:2048 sc1
  buffer_load_dwordx4 a[12:15], v224, s[4:7], s16 offen offset:3072 sc1
  s_add_u32 s16, s16, s44
  buffer_load_dwordx4 a[16:19], v224, s[4:7], s16 offen offset:0 sc1
  buffer_load_dwordx4 a[20:23], v224, s[4:7], s16 offen offset:1024 sc1
  buffer_load_dwordx4 a[24:27], v224, s[4:7], s16 offen offset:2048 sc1
  buffer_load_dwordx4 a[28:31], v224, s[4:7], s16 offen offset:3072 sc1
  s_add_u32 s16, s16, s45
  s_bitcmp1_b32 s3, 0
  s_cselect_b32 s52, s26, s24
  s_cselect_b32 s53, s27, s25
  s_cselect_b32 s60, 3670016, 0
  s_mov_b32 s54, 7340032
  s_mov_b32 s55, 0x20000
  s_lshl_b32 s56, s2, 1
  s_lshr_b32 s59, s3, 1
  s_add_u32 s56, s56, s59
  s_lshl_b32 s56, s56, 10
  s_add_u32 s60, s60, s56
  s_add_u32 s56, s56, 1048576
  s_mov_b32 s59, 0
  v_lshrrev_b32 v249, 3, v231
  v_lshlrev_b32 v249, 7, v249
  v_and_b32 v251, 0, v231
  v_lshl_add_u32 v249, v251, 19, v249
  s_mov_b32 s52, s22
  s_mov_b32 s53, s23
  s_mov_b32 s56, s60
  s_add_u32 s12, s20, 0x1600000
  s_addc_u32 s13, s21, 0
  s_mov_b32 s14, 0xe00000
  s_mov_b32 s15, 0x20000
  v_lshrrev_b32 v234, 2, v231
  v_mul_u32_u24 v234, 224, v234
  v_and_b32 v235, 3, v231
  v_lshl_add_u32 v229, v235, 3, v234
  v_add_u32 v229, 98304, v229
  v_add_u32 v230, 57344, v229
  s_waitcnt vmcnt(16)
  s_barrier
  ds_read_b64_tr_b16 a[64:65], v229 offset:0
  ds_read_b64_tr_b16 a[66:67], v229 offset:3584
  ds_read_b64_tr_b16 a[68:69], v229 offset:32
  ds_read_b64_tr_b16 a[70:71], v229 offset:3616
  ds_read_b64_tr_b16 a[72:73], v229 offset:64
  ds_read_b64_tr_b16 a[74:75], v229 offset:3648
  ds_read_b64_tr_b16 a[76:77], v229 offset:96
  ds_read_b64_tr_b16 a[78:79], v229 offset:3680
  ds_read_b64_tr_b16 a[80:81], v229 offset:128
  ds_read_b64_tr_b16 a[82:83], v229 offset:3712
  ds_read_b64_tr_b16 a[84:85], v229 offset:160
  ds_read_b64_tr_b16 a[86:87], v229 offset:3744
  ds_read_b64_tr_b16 a[88:89], v229 offset:192
  ds_read_b64_tr_b16 a[90:91], v229 offset:3776
  ds_read_b64_tr_b16 a[92:93], v229 offset:7168
  ds_read_b64_tr_b16 a[94:95], v229 offset:10752
  ds_read_b64_tr_b16 a[96:97], v229 offset:7200
  ds_read_b64_tr_b16 a[98:99], v229 offset:10784
  ds_read_b64_tr_b16 a[100:101], v229 offset:7232
  ds_read_b64_tr_b16 a[102:103], v229 offset:10816
  ds_read_b64_tr_b16 a[104:105], v229 offset:7264
  ds_read_b64_tr_b16 a[106:107], v229 offset:10848
  ds_read_b64_tr_b16 a[108:109], v229 offset:7296
  ds_read_b64_tr_b16 a[110:111], v229 offset:10880
  ds_read_b64_tr_b16 a[112:113], v229 offset:7328
  ds_read_b64_tr_b16 a[114:115], v229 offset:10912
  ds_read_b64_tr_b16 a[116:117], v229 offset:7360
  ds_read_b64_tr_b16 a[118:119], v229 offset:10944
  s_waitcnt vmcnt(4) lgkmcnt(10)
  s_barrier
  buffer_load_dword v247, v246, s[64:67], s68 offen sc1
  v_mfma_f32_16x16x32_bf16 v[0:3], a[64:67], a[0:3], 0
  s_add_u32 m0, s38, 43008
  v_mfma_f32_16x16x32_bf16 v[56:59], a[64:67], a[4:7], 0
  buffer_load_dwordx4 v225, s[8:11], s17 offen lds
  v_mfma_f32_16x16x32_bf16 v[112:115], a[64:67], a[8:11], 0
  v_mfma_f32_16x16x32_bf16 v[168:171], a[64:67], a[12:15], 0
  ds_read_b64_tr_b16 a[64:65], v229 offset:14336
  ds_read_b64_tr_b16 a[66:67], v229 offset:17920
  v_mfma_f32_16x16x32_bf16 v[4:7], a[68:71], a[0:3], 0
  v_mfma_f32_16x16x32_bf16 v[60:63], a[68:71], a[4:7], 0
  buffer_load_dwordx4 a[32:35], v224, s[4:7], s16 offen offset:0 sc1
  v_mfma_f32_16x16x32_bf16 v[116:119], a[68:71], a[8:11], 0
  v_mfma_f32_16x16x32_bf16 v[172:175], a[68:71], a[12:15], 0
  ds_read_b64_tr_b16 a[68:69], v229 offset:14368
  ds_read_b64_tr_b16 a[70:71], v229 offset:17952
  v_mfma_f32_16x16x32_bf16 v[8:11], a[72:75], a[0:3], 0
  v_mfma_f32_16x16x32_bf16 v[64:67], a[72:75], a[4:7], 0
  v_mfma_f32_16x16x32_bf16 v[120:123], a[72:75], a[8:11], 0
  buffer_load_dwordx4 v226, s[8:11], s17 offen offset:1024 lds
  v_mfma_f32_16x16x32_bf16 v[176:179], a[72:75], a[12:15], 0
  ds_read_b64_tr_b16 a[72:73], v229 offset:14400
  ds_read_b64_tr_b16 a[74:75], v229 offset:17984
  v_mfma_f32_16x16x32_bf16 v[12:15], a[76:79], a[0:3], 0
  v_mfma_f32_16x16x32_bf16 v[68:71], a[76:79], a[4:7], 0
  v_mfma_f32_16x16x32_bf16 v[124:127], a[76:79], a[8:11], 0
  buffer_load_dwordx4 a[36:39], v224, s[4:7], s16 offen offset:1024 sc1
  v_mfma_f32_16x16x32_bf16 v[180:183], a[76:79], a[12:15], 0
  ds_read_b64_tr_b16 a[76:77], v229 offset:14432
  ds_read_b64_tr_b16 a[78:79], v229 offset:18016
  v_mfma_f32_16x16x32_bf16 v[16:19], a[80:83], a[0:3], 0
  v_mfma_f32_16x16x32_bf16 v[72:75], a[80:83], a[4:7], 0
  v_mfma_f32_16x16x32_bf16 v[128:131], a[80:83], a[8:11], 0
  v_mfma_f32_16x16x32_bf16 v[184:187], a[80:83], a[12:15], 0
  buffer_load_dwordx4 v227, s[8:11], s17 offen offset:2048 lds
  v_mfma_f32_16x16x32_bf16 v[20:23], a[84:87], a[0:3], 0
  ds_read_b64_tr_b16 a[80:81], v229 offset:14464
  ds_read_b64_tr_b16 a[82:83], v229 offset:18048
  v_mfma_f32_16x16x32_bf16 v[76:79], a[84:87], a[4:7], 0
  v_mfma_f32_16x16x32_bf16 v[132:135], a[84:87], a[8:11], 0
  v_mfma_f32_16x16x32_bf16 v[188:191], a[84:87], a[12:15], 0
  buffer_load_dwordx4 a[40:43], v224, s[4:7], s16 offen offset:2048 sc1
  v_mfma_f32_16x16x32_bf16 v[24:27], a[88:91], a[0:3], 0
  ds_read_b64_tr_b16 a[84:85], v229 offset:14496
  ds_read_b64_tr_b16 a[86:87], v229 offset:18080
  v_mfma_f32_16x16x32_bf16 v[80:83], a[88:91], a[4:7], 0
  v_mfma_f32_16x16x32_bf16 v[136:139], a[88:91], a[8:11], 0
  v_mfma_f32_16x16x32_bf16 v[192:195], a[88:91], a[12:15], 0
  ds_read_b64_tr_b16 a[88:89], v229 offset:14528
  ds_read_b64_tr_b16 a[90:91], v229 offset:18112
  v_mfma_f32_16x16x32_bf16 v[28:31], a[92:95], a[0:3], 0
  s_mov_b32 exec_hi, 0
  buffer_load_dwordx4 v228, s[8:11], s17 offen offset:3072 lds
  s_mov_b32 exec_hi, -1
  v_mfma_f32_16x16x32_bf16 v[84:87], a[92:95], a[4:7], 0
  s_add_u32 s17, s17, s99
  v_mfma_f32_16x16x32_bf16 v[140:143], a[92:95], a[8:11], 0
  v_mfma_f32_16x16x32_bf16 v[196:199], a[92:95], a[12:15], 0
  ds_read_b64_tr_b16 a[92:93], v229 offset:21504
  ds_read_b64_tr_b16 a[94:95], v229 offset:25088
  v_mfma_f32_16x16x32_bf16 v[32:35], a[96:99], a[0:3], 0
  v_mfma_f32_16x16x32_bf16 v[88:91], a[96:99], a[4:7], 0
  buffer_load_dwordx4 a[44:47], v224, s[4:7], s16 offen offset:3072 sc1
  v_mfma_f32_16x16x32_bf16 v[144:147], a[96:99], a[8:11], 0
  s_add_u32 s16, s16, s46
  v_mfma_f32_16x16x32_bf16 v[200:203], a[96:99], a[12:15], 0
  ds_read_b64_tr_b16 a[96:97], v229 offset:21536
  ds_read_b64_tr_b16 a[98:99], v229 offset:25120
  s_waitcnt lgkmcnt(10)
  v_mfma_f32_16x16x32_bf16 v[36:39], a[100:103], a[0:3], 0
  v_mfma_f32_16x16x32_bf16 v[92:95], a[100:103], a[4:7], 0
  buffer_load_dwordx4 a[48:51], v224, s[4:7], s16 offen offset:0 sc1
  v_mfma_f32_16x16x32_bf16 v[148:151], a[100:103], a[8:11], 0
  v_mfma_f32_16x16x32_bf16 v[204:207], a[100:103], a[12:15], 0
  ds_read_b64_tr_b16 a[100:101], v229 offset:21568
  ds_read_b64_tr_b16 a[102:103], v229 offset:25152
  v_mfma_f32_16x16x32_bf16 v[40:43], a[104:107], a[0:3], 0
  v_mfma_f32_16x16x32_bf16 v[96:99], a[104:107], a[4:7], 0
  v_mfma_f32_16x16x32_bf16 v[152:155], a[104:107], a[8:11], 0
  buffer_load_dwordx4 a[52:55], v224, s[4:7], s16 offen offset:1024 sc1
  v_mfma_f32_16x16x32_bf16 v[208:211], a[104:107], a[12:15], 0
  ds_read_b64_tr_b16 a[104:105], v229 offset:21600
  ds_read_b64_tr_b16 a[106:107], v229 offset:25184
  v_mfma_f32_16x16x32_bf16 v[44:47], a[108:111], a[0:3], 0
  v_mfma_f32_16x16x32_bf16 v[100:103], a[108:111], a[4:7], 0
  v_mfma_f32_16x16x32_bf16 v[156:159], a[108:111], a[8:11], 0
  buffer_load_dwordx4 a[56:59], v224, s[4:7], s16 offen offset:2048 sc1
  v_mfma_f32_16x16x32_bf16 v[212:215], a[108:111], a[12:15], 0
  ds_read_b64_tr_b16 a[108:109], v229 offset:21632
  ds_read_b64_tr_b16 a[110:111], v229 offset:25216
  v_mfma_f32_16x16x32_bf16 v[48:51], a[112:115], a[0:3], 0
  v_mfma_f32_16x16x32_bf16 v[104:107], a[112:115], a[4:7], 0
  v_mfma_f32_16x16x32_bf16 v[160:163], a[112:115], a[8:11], 0
  v_mfma_f32_16x16x32_bf16 v[216:219], a[112:115], a[12:15], 0
  buffer_load_dwordx4 a[60:63], v224, s[4:7], s16 offen offset:3072 sc1
  v_mfma_f32_16x16x32_bf16 v[52:55], a[116:119], a[0:3], 0
  ds_read_b64_tr_b16 a[112:113], v229 offset:21664
  s_add_u32 s16, s16, s47
  v_mfma_f32_16x16x32_bf16 v[108:111], a[116:119], a[4:7], 0
  ds_read_b64_tr_b16 a[114:115], v229 offset:25248
  v_mfma_f32_16x16x32_bf16 v[164:167], a[116:119], a[8:11], 0
  v_mfma_f32_16x16x32_bf16 v[220:223], a[116:119], a[12:15], 0
  s_waitcnt vmcnt(12) lgkmcnt(10)
  s_barrier
  v_cmp_ne_u32 vcc, s19, v247
  s_nop 1
  s_cmp_lg_u64 vcc, 0
  s_cbranch_scc1 L_slow_21
  L_back_22:
  v_mfma_f32_16x16x32_bf16 v[0:3], a[64:67], a[16:19], v[0:3]
  ds_read_b64_tr_b16 a[116:117], v229 offset:21696
  s_add_u32 m0, s38, 0
  v_mfma_f32_16x16x32_bf16 v[56:59], a[64:67], a[20:23], v[56:59]
  buffer_load_dwordx4 v225, s[8:11], s17 offen lds
  v_mfma_f32_16x16x32_bf16 v[112:115], a[64:67], a[24:27], v[112:115]
  ds_read_b64_tr_b16 a[118:119], v229 offset:25280
  v_mfma_f32_16x16x32_bf16 v[168:171], a[64:67], a[28:31], v[168:171]
  ds_read_b64_tr_b16 a[64:65], v229 offset:28672
  ds_read_b64_tr_b16 a[66:67], v229 offset:32256
  v_mfma_f32_16x16x32_bf16 v[4:7], a[68:71], a[16:19], v[4:7]
  v_mfma_f32_16x16x32_bf16 v[60:63], a[68:71], a[20:23], v[60:63]
  v_mfma_f32_16x16x32_bf16 v[116:119], a[68:71], a[24:27], v[116:119]
  v_mfma_f32_16x16x32_bf16 v[172:175], a[68:71], a[28:31], v[172:175]
  buffer_load_dwordx4 a[0:3], v224, s[4:7], s16 offen offset:0 sc1
  v_mfma_f32_16x16x32_bf16 v[8:11], a[72:75], a[16:19], v[8:11]
  ds_read_b64_tr_b16 a[68:69], v229 offset:28704
  ds_read_b64_tr_b16 a[70:71], v229 offset:32288
  v_mfma_f32_16x16x32_bf16 v[64:67], a[72:75], a[20:23], v[64:67]
  v_mfma_f32_16x16x32_bf16 v[120:123], a[72:75], a[24:27], v[120:123]
  v_mfma_f32_16x16x32_bf16 v[176:179], a[72:75], a[28:31], v[176:179]
  ds_read_b64_tr_b16 a[72:73], v229 offset:28736
  ds_read_b64_tr_b16 a[74:75], v229 offset:32320
  v_mfma_f32_16x16x32_bf16 v[12:15], a[76:79], a[16:19], v[12:15]
  v_mfma_f32_16x16x32_bf16 v[68:71], a[76:79], a[20:23], v[68:71]
  buffer_load_dwordx4 v226, s[8:11], s17 offen offset:1024 lds
  v_mfma_f32_16x16x32_bf16 v[124:127], a[76:79], a[24:27], v[124:127]
  v_mfma_f32_16x16x32_bf16 v[180:183], a[76:79], a[28:31], v[180:183]
  ds_read_b64_tr_b16 a[76:77], v229 offset:28768
  ds_read_b64_tr_b16 a[78:79], v229 offset:32352
  v_mfma_f32_16x16x32_bf16 v[16:19], a[80:83], a[16:19], v[16:19]
  v_mfma_f32_16x16x32_bf16 v[72:75], a[80:83], a[20:23], v[72:75]
  v_mfma_f32_16x16x32_bf16 v[128:131], a[80:83], a[24:27], v[128:131]
  v_mfma_f32_16x16x32_bf16 v[184:187], a[80:83], a[28:31], v[184:187]
  buffer_load_dwordx4 a[4:7], v224, s[4:7], s16 offen offset:1024 sc1
  v_mfma_f32_16x16x32_bf16 v[20:23], a[84:87], a[16:19], v[20:23]
  ds_read_b64_tr_b16 a[80:81], v229 offset:28800
  ds_read_b64_tr_b16 a[82:83], v229 offset:32384
  v_mfma_f32_16x16x32_bf16 v[76:79], a[84:87], a[20:23], v[76:79]
  v_mfma_f32_16x16x32_bf16 v[132:135], a[84:87], a[24:27], v[132:135]
  v_mfma_f32_16x16x32_bf16 v[188:191], a[84:87], a[28:31], v[188:191]
  ds_read_b64_tr_b16 a[84:85], v229 offset:28832
  ds_read_b64_tr_b16 a[86:87], v229 offset:32416
  v_mfma_f32_16x16x32_bf16 v[24:27], a[88:91], a[16:19], v[24:27]
  v_mfma_f32_16x16x32_bf16 v[80:83], a[88:91], a[20:23], v[80:83]
  buffer_load_dwordx4 v227, s[8:11], s17 offen offset:2048 lds
  v_mfma_f32_16x16x32_bf16 v[136:139], a[88:91], a[24:27], v[136:139]
  v_mfma_f32_16x16x32_bf16 v[192:195], a[88:91], a[28:31], v[192:195]
  ds_read_b64_tr_b16 a[88:89], v229 offset:28864
  ds_read_b64_tr_b16 a[90:91], v229 offset:32448
  v_mfma_f32_16x16x32_bf16 v[28:31], a[92:95], a[16:19], v[28:31]
  v_mfma_f32_16x16x32_bf16 v[84:87], a[92:95], a[20:23], v[84:87]
  v_mfma_f32_16x16x32_bf16 v[140:143], a[92:95], a[24:27], v[140:143]
  v_mfma_f32_16x16x32_bf16 v[196:199], a[92:95], a[28:31], v[196:199]
  buffer_load_dwordx4 a[8:11], v224, s[4:7], s16 offen offset:2048 sc1
  s_waitcnt lgkmcnt(10)
  v_mfma_f32_16x16x32_bf16 v[32:35], a[96:99], a[16:19], v[32:35]
  ds_read_b64_tr_b16 a[92:93], v229 offset:35840
  ds_read_b64_tr_b16 a[94:95], v229 offset:39424
  v_mfma_f32_16x16x32_bf16 v[88:91], a[96:99], a[20:23], v[88:91]
  v_mfma_f32_16x16x32_bf16 v[144:147], a[96:99], a[24:27], v[144:147]
  v_mfma_f32_16x16x32_bf16 v[200:203], a[96:99], a[28:31], v[200:203]
  ds_read_b64_tr_b16 a[96:97], v229 offset:35872
  ds_read_b64_tr_b16 a[98:99], v229 offset:39456
  v_mfma_f32_16x16x32_bf16 v[36:39], a[100:103], a[16:19], v[36:39]
  v_mfma_f32_16x16x32_bf16 v[92:95], a[100:103], a[20:23], v[92:95]
  s_mov_b32 exec_hi, 0
  buffer_load_dwordx4 v228, s[8:11], s17 offen offset:3072 lds
  s_mov_b32 exec_hi, -1
  v_mfma_f32_16x16x32_bf16 v[148:151], a[100:103], a[24:27], v[148:151]
  s_add_u32 s17, s17, s96
  v_mfma_f32_16x16x32_bf16 v[204:207], a[100:103], a[28:31], v[204:207]
  ds_read_b64_tr_b16 a[100:101], v229 offset:35904
  ds_read_b64_tr_b16 a[102:103], v229 offset:39488
  v_mfma_f32_16x16x32_bf16 v[40:43], a[104:107], a[16:19], v[40:43]
  v_mfma_f32_16x16x32_bf16 v[96:99], a[104:107], a[20:23], v[96:99]
  v_mfma_f32_16x16x32_bf16 v[152:155], a[104:107], a[24:27], v[152:155]
  v_mfma_f32_16x16x32_bf16 v[208:211], a[104:107], a[28:31], v[208:211]
  buffer_load_dwordx4 a[12:15], v224, s[4:7], s16 offen offset:3072 sc1
  v_mfma_f32_16x16x32_bf16 v[44:47], a[108:111], a[16:19], v[44:47]
  ds_read_b64_tr_b16 a[104:105], v229 offset:35936
  s_add_u32 s16, s16, s44
  v_mfma_f32_16x16x32_bf16 v[100:103], a[108:111], a[20:23], v[100:103]
  ds_read_b64_tr_b16 a[106:107], v229 offset:39520
  v_mfma_f32_16x16x32_bf16 v[156:159], a[108:111], a[24:27], v[156:159]
  v_mfma_f32_16x16x32_bf16 v[212:215], a[108:111], a[28:31], v[212:215]
  ds_read_b64_tr_b16 a[108:109], v229 offset:35968
  ds_read_b64_tr_b16 a[110:111], v229 offset:39552
  v_mfma_f32_16x16x32_bf16 v[48:51], a[112:115], a[16:19], v[48:51]
  v_mfma_f32_16x16x32_bf16 v[104:107], a[112:115], a[20:23], v[104:107]
  buffer_load_dword v251, v249, s[52:55], s56 offen
  v_mfma_f32_16x16x32_bf16 v[160:163], a[112:115], a[24:27], v[160:163]
  s_add_u32 s56, s56, 524288
  v_mfma_f32_16x16x32_bf16 v[216:219], a[112:115], a[28:31], v[216:219]
  ds_read_b64_tr_b16 a[112:113], v229 offset:36000
  ds_read_b64_tr_b16 a[114:115], v229 offset:39584
  v_mfma_f32_16x16x32_bf16 v[52:55], a[116:119], a[16:19], v[52:55]
  v_mfma_f32_16x16x32_bf16 v[108:111], a[116:119], a[20:23], v[108:111]
  v_mfma_f32_16x16x32_bf16 v[164:167], a[116:119], a[24:27], v[164:167]
  v_mfma_f32_16x16x32_bf16 v[220:223], a[116:119], a[28:31], v[220:223]
  s_waitcnt vmcnt(13) lgkmcnt(10)
  s_barrier
  v_mfma_f32_16x16x32_bf16 v[0:3], a[64:67], a[32:35], v[0:3]
  ds_read_b64_tr_b16 a[116:117], v229 offset:36032
  s_add_u32 m0, s38, 14336
  v_mfma_f32_16x16x32_bf16 v[56:59], a[64:67], a[36:39], v[56:59]
  buffer_load_dwordx4 v225, s[8:11], s17 offen lds
  v_mfma_f32_16x16x32_bf16 v[112:115], a[64:67], a[40:43], v[112:115]
  ds_read_b64_tr_b16 a[118:119], v229 offset:39616
  v_mfma_f32_16x16x32_bf16 v[168:171], a[64:67], a[44:47], v[168:171]
  ds_read_b64_tr_b16 a[64:65], v229 offset:43008
  ds_read_b64_tr_b16 a[66:67], v229 offset:46592
  v_mfma_f32_16x16x32_bf16 v[4:7], a[68:71], a[32:35], v[4:7]
  v_mfma_f32_16x16x32_bf16 v[60:63], a[68:71], a[36:39], v[60:63]
  v_mfma_f32_16x16x32_bf16 v[116:119], a[68:71], a[40:43], v[116:119]
  v_mfma_f32_16x16x32_bf16 v[172:175], a[68:71], a[44:47], v[172:175]
  buffer_load_dwordx4 a[16:19], v224, s[4:7], s16 offen offset:0 sc1
  v_mfma_f32_16x16x32_bf16 v[8:11], a[72:75], a[32:35], v[8:11]
  ds_read_b64_tr_b16 a[68:69], v229 offset:43040
  ds_read_b64_tr_b16 a[70:71], v229 offset:46624
  v_mfma_f32_16x16x32_bf16 v[64:67], a[72:75], a[36:39], v[64:67]
  v_mfma_f32_16x16x32_bf16 v[120:123], a[72:75], a[40:43], v[120:123]
  v_mfma_f32_16x16x32_bf16 v[176:179], a[72:75], a[44:47], v[176:179]
  ds_read_b64_tr_b16 a[72:73], v229 offset:43072
  ds_read_b64_tr_b16 a[74:75], v229 offset:46656
  v_mfma_f32_16x16x32_bf16 v[12:15], a[76:79], a[32:35], v[12:15]
  v_mfma_f32_16x16x32_bf16 v[68:71], a[76:79], a[36:39], v[68:71]
  v_mfma_f32_16x16x32_bf16 v[124:127], a[76:79], a[40:43], v[124:127]
  buffer_load_dwordx4 v226, s[8:11], s17 offen offset:1024 lds
  v_mfma_f32_16x16x32_bf16 v[180:183], a[76:79], a[44:47], v[180:183]
  ds_read_b64_tr_b16 a[76:77], v229 offset:43104
  ds_read_b64_tr_b16 a[78:79], v229 offset:46688
  v_mfma_f32_16x16x32_bf16 v[16:19], a[80:83], a[32:35], v[16:19]
  v_mfma_f32_16x16x32_bf16 v[72:75], a[80:83], a[36:39], v[72:75]
  v_mfma_f32_16x16x32_bf16 v[128:131], a[80:83], a[40:43], v[128:131]
  v_mfma_f32_16x16x32_bf16 v[184:187], a[80:83], a[44:47], v[184:187]
  ds_read_b64_tr_b16 a[80:81], v229 offset:43136
  ds_read_b64_tr_b16 a[82:83], v229 offset:46720
  v_mfma_f32_16x16x32_bf16 v[20:23], a[84:87], a[32:35], v[20:23]
  v_mfma_f32_16x16x32_bf16 v[76:79], a[84:87], a[36:39], v[76:79]
  buffer_load_dwordx4 a[20:23], v224, s[4:7], s16 offen offset:1024 sc1
  v_mfma_f32_16x16x32_bf16 v[132:135], a[84:87], a[40:43], v[132:135]
  v_mfma_f32_16x16x32_bf16 v[188:191], a[84:87], a[44:47], v[188:191]
  ds_read_b64_tr_b16 a[84:85], v229 offset:43168
  ds_read_b64_tr_b16 a[86:87], v229 offset:46752
  v_mfma_f32_16x16x32_bf16 v[24:27], a[88:91], a[32:35], v[24:27]
  v_mfma_f32_16x16x32_bf16 v[80:83], a[88:91], a[36:39], v[80:83]
  v_mfma_f32_16x16x32_bf16 v[136:139], a[88:91], a[40:43], v[136:139]
  v_mfma_f32_16x16x32_bf16 v[192:195], a[88:91], a[44:47], v[192:195]
  ds_read_b64_tr_b16 a[88:89], v229 offset:43200
  ds_read_b64_tr_b16 a[90:91], v229 offset:46784
  v_mfma_f32_16x16x32_bf16 v[28:31], a[92:95], a[32:35], v[28:31]
  buffer_load_dwordx4 v227, s[8:11], s17 offen offset:2048 lds
  v_mfma_f32_16x16x32_bf16 v[84:87], a[92:95], a[36:39], v[84:87]
  v_mfma_f32_16x16x32_bf16 v[140:143], a[92:95], a[40:43], v[140:143]
  v_mfma_f32_16x16x32_bf16 v[196:199], a[92:95], a[44:47], v[196:199]
  ds_read_b64_tr_b16 a[92:93], v229 offset:50176
  ds_read_b64_tr_b16 a[94:95], v229 offset:53760
  s_waitcnt lgkmcnt(10)
  v_mfma_f32_16x16x32_bf16 v[32:35], a[96:99], a[32:35], v[32:35]
  v_mfma_f32_16x16x32_bf16 v[88:91], a[96:99], a[36:39], v[88:91]
  v_mfma_f32_16x16x32_bf16 v[144:147], a[96:99], a[40:43], v[144:147]
  v_mfma_f32_16x16x32_bf16 v[200:203], a[96:99], a[44:47], v[200:203]
  buffer_load_dwordx4 a[24:27], v224, s[4:7], s16 offen offset:2048 sc1
  v_mfma_f32_16x16x32_bf16 v[36:39], a[100:103], a[32:35], v[36:39]
  ds_read_b64_tr_b16 a[96:97], v229 offset:50208
  ds_read_b64_tr_b16 a[98:99], v229 offset:53792
  v_mfma_f32_16x16x32_bf16 v[92:95], a[100:103], a[36:39], v[92:95]
  v_mfma_f32_16x16x32_bf16 v[148:151], a[100:103], a[40:43], v[148:151]
  v_mfma_f32_16x16x32_bf16 v[204:207], a[100:103], a[44:47], v[204:207]
  ds_read_b64_tr_b16 a[100:101], v229 offset:50240
  ds_read_b64_tr_b16 a[102:103], v229 offset:53824
  v_mfma_f32_16x16x32_bf16 v[40:43], a[104:107], a[32:35], v[40:43]
  v_mfma_f32_16x16x32_bf16 v[96:99], a[104:107], a[36:39], v[96:99]
  v_mfma_f32_16x16x32_bf16 v[152:155], a[104:107], a[40:43], v[152:155]
  s_mov_b32 exec_hi, 0
  buffer_load_dwordx4 v228, s[8:11], s17 offen offset:3072 lds
  s_mov_b32 exec_hi, -1
  v_mfma_f32_16x16x32_bf16 v[208:211], a[104:107], a[44:47], v[208:211]
  ds_read_b64_tr_b16 a[104:105], v229 offset:50272
  s_add_u32 s17, s17, s97
  v_mfma_f32_16x16x32_bf16 v[44:47], a[108:111], a[32:35], v[44:47]
  ds_read_b64_tr_b16 a[106:107], v229 offset:53856
  v_mfma_f32_16x16x32_bf16 v[100:103], a[108:111], a[36:39], v[100:103]
  v_mfma_f32_16x16x32_bf16 v[156:159], a[108:111], a[40:43], v[156:159]
  v_mfma_f32_16x16x32_bf16 v[212:215], a[108:111], a[44:47], v[212:215]
  ds_read_b64_tr_b16 a[108:109], v229 offset:50304
  ds_read_b64_tr_b16 a[110:111], v229 offset:53888
  v_mfma_f32_16x16x32_bf16 v[48:51], a[112:115], a[32:35], v[48:51]
  v_mfma_f32_16x16x32_bf16 v[104:107], a[112:115], a[36:39], v[104:107]
  buffer_load_dwordx4 a[28:31], v224, s[4:7], s16 offen offset:3072 sc1
  v_mfma_f32_16x16x32_bf16 v[160:163], a[112:115], a[40:43], v[160:163]
  s_add_u32 s16, s16, s45
  v_mfma_f32_16x16x32_bf16 v[216:219], a[112:115], a[44:47], v[216:219]
  ds_read_b64_tr_b16 a[112:113], v229 offset:50336
  ds_read_b64_tr_b16 a[114:115], v229 offset:53920
  v_mfma_f32_16x16x32_bf16 v[52:55], a[116:119], a[32:35], v[52:55]
  v_mfma_f32_16x16x32_bf16 v[108:111], a[116:119], a[36:39], v[108:111]
  v_mfma_f32_16x16x32_bf16 v[164:167], a[116:119], a[40:43], v[164:167]
  v_mfma_f32_16x16x32_bf16 v[220:223], a[116:119], a[44:47], v[220:223]
  s_mov_b32 s18, 6
  .p2align 6
L_loop_24:
  s_waitcnt vmcnt(10) lgkmcnt(10)
  s_barrier
  v_mfma_f32_16x16x32_bf16 v[0:3], a[64:67], a[48:51], v[0:3]
  ds_read_b64_tr_b16 a[116:117], v229 offset:50368
  s_add_u32 m0, s38, 28672
  v_mfma_f32_16x16x32_bf16 v[56:59], a[64:67], a[52:55], v[56:59]
  buffer_load_dwordx4 v225, s[8:11], s17 offen lds
  v_mfma_f32_16x16x32_bf16 v[112:115], a[64:67], a[56:59], v[112:115]
  ds_read_b64_tr_b16 a[118:119], v229 offset:53952
  v_mfma_f32_16x16x32_bf16 v[168:171], a[64:67], a[60:63], v[168:171]
  ds_read_b64_tr_b16 a[64:65], v229 offset:0
  ds_read_b64_tr_b16 a[66:67], v229 offset:3584
  v_mfma_f32_16x16x32_bf16 v[4:7], a[68:71], a[48:51], v[4:7]
  v_mfma_f32_16x16x32_bf16 v[60:63], a[68:71], a[52:55], v[60:63]
  v_mfma_f32_16x16x32_bf16 v[116:119], a[68:71], a[56:59], v[116:119]
  v_mfma_f32_16x16x32_bf16 v[172:175], a[68:71], a[60:63], v[172:175]
  buffer_load_dwordx4 a[32:35], v224, s[4:7], s16 offen offset:0 sc1
  v_mfma_f32_16x16x32_bf16 v[8:11], a[72:75], a[48:51], v[8:11]
  ds_read_b64_tr_b16 a[68:69], v229 offset:32
  ds_read_b64_tr_b16 a[70:71], v229 offset:3616
  v_mfma_f32_16x16x32_bf16 v[64:67], a[72:75], a[52:55], v[64:67]
  v_mfma_f32_16x16x32_bf16 v[120:123], a[72:75], a[56:59], v[120:123]
  v_mfma_f32_16x16x32_bf16 v[176:179], a[72:75], a[60:63], v[176:179]
  ds_read_b64_tr_b16 a[72:73], v229 offset:64
  ds_read_b64_tr_b16 a[74:75], v229 offset:3648
  v_mfma_f32_16x16x32_bf16 v[12:15], a[76:79], a[48:51], v[12:15]
  v_mfma_f32_16x16x32_bf16 v[68:71], a[76:79], a[52:55], v[68:71]
  v_mfma_f32_16x16x32_bf16 v[124:127], a[76:79], a[56:59], v[124:127]
  buffer_load_dwordx4 v226, s[8:11], s17 offen offset:1024 lds
  v_mfma_f32_16x16x32_bf16 v[180:183], a[76:79], a[60:63], v[180:183]
  ds_read_b64_tr_b16 a[76:77], v229 offset:96
  ds_read_b64_tr_b16 a[78:79], v229 offset:3680
  v_mfma_f32_16x16x32_bf16 v[16:19], a[80:83], a[48:51], v[16:19]
  v_mfma_f32_16x16x32_bf16 v[72:75], a[80:83], a[52:55], v[72:75]
  v_mfma_f32_16x16x32_bf16 v[128:131], a[80:83], a[56:59], v[128:131]
  v_mfma_f32_16x16x32_bf16 v[184:187], a[80:83], a[60:63], v[184:187]
  ds_read_b64_tr_b16 a[80:81], v229 offset:128
  ds_read_b64_tr_b16 a[82:83], v229 offset:3712
  v_mfma_f32_16x16x32_bf16 v[20:23], a[84:87], a[48:51], v[20:23]
  v_mfma_f32_16x16x32_bf16 v[76:79], a[84:87], a[52:55], v[76:79]
  buffer_load_dwordx4 a[36:39], v224, s[4:7], s16 offen offset:1024 sc1
  v_mfma_f32_16x16x32_bf16 v[132:135], a[84:87], a[56:59], v[132:135]
  v_mfma_f32_16x16x32_bf16 v[188:191], a[84:87], a[60:63], v[188:191]
  ds_read_b64_tr_b16 a[84:85], v229 offset:160
  ds_read_b64_tr_b16 a[86:87], v229 offset:3744
  v_mfma_f32_16x16x32_bf16 v[24:27], a[88:91], a[48:51], v[24:27]
  v_mfma_f32_16x16x32_bf16 v[80:83], a[88:91], a[52:55], v[80:83]
  v_mfma_f32_16x16x32_bf16 v[136:139], a[88:91], a[56:59], v[136:139]
  v_mfma_f32_16x16x32_bf16 v[192:195], a[88:91], a[60:63], v[192:195]
  ds_read_b64_tr_b16 a[88:89], v229 offset:192
  ds_read_b64_tr_b16 a[90:91], v229 offset:3776
  v_mfma_f32_16x16x32_bf16 v[28:31], a[92:95], a[48:51], v[28:31]
  buffer_load_dwordx4 v227, s[8:11], s17 offen offset:2048 lds
  v_mfma_f32_16x16x32_bf16 v[84:87], a[92:95], a[52:55], v[84:87]
  v_mfma_f32_16x16x32_bf16 v[140:143], a[92:95], a[56:59], v[140:143]
  v_mfma_f32_16x16x32_bf16 v[196:199], a[92:95], a[60:63], v[196:199]
  ds_read_b64_tr_b16 a[92:93], v229 offset:7168
  ds_read_b64_tr_b16 a[94:95], v229 offset:10752
  s_waitcnt lgkmcnt(10)
  v_mfma_f32_16x16x32_bf16 v[32:35], a[96:99], a[48:51], v[32:35]
  v_mfma_f32_16x16x32_bf16 v[88:91], a[96:99], a[52:55], v[88:91]
  v_mfma_f32_16x16x32_bf16 v[144:147], a[96:99], a[56:59], v[144:147]
  v_mfma_f32_16x16x32_bf16 v[200:203], a[96:99], a[60:63], v[200:203]
  buffer_load_dwordx4 a[40:43], v224, s[4:7], s16 offen offset:2048 sc1
  v_mfma_f32_16x16x32_bf16 v[36:39], a[100:103], a[48:51], v[36:39]
  ds_read_b64_tr_b16 a[96:97], v229 offset:7200
  ds_read_b64_tr_b16 a[98:99], v229 offset:10784
  v_mfma_f32_16x16x32_bf16 v[92:95], a[100:103], a[52:55], v[92:95]
  v_mfma_f32_16x16x32_bf16 v[148:151], a[100:103], a[56:59], v[148:151]
  v_mfma_f32_16x16x32_bf16 v[204:207], a[100:103], a[60:63], v[204:207]
  ds_read_b64_tr_b16 a[100:101], v229 offset:7232
  ds_read_b64_tr_b16 a[102:103], v229 offset:10816
  v_mfma_f32_16x16x32_bf16 v[40:43], a[104:107], a[48:51], v[40:43]
  v_mfma_f32_16x16x32_bf16 v[96:99], a[104:107], a[52:55], v[96:99]
  v_mfma_f32_16x16x32_bf16 v[152:155], a[104:107], a[56:59], v[152:155]
  s_mov_b32 exec_hi, 0
  buffer_load_dwordx4 v228, s[8:11], s17 offen offset:3072 lds
  s_mov_b32 exec_hi, -1
  v_mfma_f32_16x16x32_bf16 v[208:211], a[104:107], a[60:63], v[208:211]
  ds_read_b64_tr_b16 a[104:105], v229 offset:7264
  s_add_u32 s17, s17, s98
  v_mfma_f32_16x16x32_bf16 v[44:47], a[108:111], a[48:51], v[44:47]
  ds_read_b64_tr_b16 a[106:107], v229 offset:10848
  v_mfma_f32_16x16x32_bf16 v[100:103], a[108:111], a[52:55], v[100:103]
  v_mfma_f32_16x16x32_bf16 v[156:159], a[108:111], a[56:59], v[156:159]
  v_mfma_f32_16x16x32_bf16 v[212:215], a[108:111], a[60:63], v[212:215]
  ds_read_b64_tr_b16 a[108:109], v229 offset:7296
  ds_read_b64_tr_b16 a[110:111], v229 offset:10880
  v_mfma_f32_16x16x32_bf16 v[48:51], a[112:115], a[48:51], v[48:51]
  v_mfma_f32_16x16x32_bf16 v[104:107], a[112:115], a[52:55], v[104:107]
  buffer_load_dwordx4 a[44:47], v224, s[4:7], s16 offen offset:3072 sc1
  v_mfma_f32_16x16x32_bf16 v[160:163], a[112:115], a[56:59], v[160:163]
  s_add_u32 s16, s16, s46
  v_mfma_f32_16x16x32_bf16 v[216:219], a[112:115], a[60:63], v[216:219]
  ds_read_b64_tr_b16 a[112:113], v229 offset:7328
  ds_read_b64_tr_b16 a[114:115], v229 offset:10912
  v_mfma_f32_16x16x32_bf16 v[52:55], a[116:119], a[48:51], v[52:55]
  v_mfma_f32_16x16x32_bf16 v[108:111], a[116:119], a[52:55], v[108:111]
  v_mfma_f32_16x16x32_bf16 v[164:167], a[116:119], a[56:59], v[164:167]
  v_mfma_f32_16x16x32_bf16 v[220:223], a[116:119], a[60:63], v[220:223]
  s_waitcnt vmcnt(9) lgkmcnt(10)
  s_barrier
  v_mfma_f32_16x16x32_bf16 v[0:3], a[64:67], a[0:3], v[0:3]
  ds_read_b64_tr_b16 a[116:117], v229 offset:7360
  s_add_u32 m0, s38, 43008
  v_mfma_f32_16x16x32_bf16 v[56:59], a[64:67], a[4:7], v[56:59]
  buffer_load_dwordx4 v225, s[8:11], s17 offen lds
  v_mfma_f32_16x16x32_bf16 v[112:115], a[64:67], a[8:11], v[112:115]
  ds_read_b64_tr_b16 a[118:119], v229 offset:10944
  v_mfma_f32_16x16x32_bf16 v[168:171], a[64:67], a[12:15], v[168:171]
  ds_read_b64_tr_b16 a[64:65], v229 offset:14336
  ds_read_b64_tr_b16 a[66:67], v229 offset:17920
  v_mfma_f32_16x16x32_bf16 v[4:7], a[68:71], a[0:3], v[4:7]
  v_mfma_f32_16x16x32_bf16 v[60:63], a[68:71], a[4:7], v[60:63]
  v_mfma_f32_16x16x32_bf16 v[116:119], a[68:71], a[8:11], v[116:119]
  v_mfma_f32_16x16x32_bf16 v[172:175], a[68:71], a[12:15], v[172:175]
  buffer_load_dwordx4 a[48:51], v224, s[4:7], s16 offen offset:0 sc1
  v_mfma_f32_16x16x32_bf16 v[8:11], a[72:75], a[0:3], v[8:11]
  ds_read_b64_tr_b16 a[68:69], v229 offset:14368
  ds_read_b64_tr_b16 a[70:71], v229 offset:17952
  v_mfma_f32_16x16x32_bf16 v[64:67], a[72:75], a[4:7], v[64:67]
  v_mfma_f32_16x16x32_bf16 v[120:123], a[72:75], a[8:11], v[120:123]
  v_mfma_f32_16x16x32_bf16 v[176:179], a[72:75], a[12:15], v[176:179]
  ds_read_b64_tr_b16 a[72:73], v229 offset:14400
  ds_read_b64_tr_b16 a[74:75], v229 offset:17984
  v_mfma_f32_16x16x32_bf16 v[12:15], a[76:79], a[0:3], v[12:15]
  v_mfma_f32_16x16x32_bf16 v[68:71], a[76:79], a[4:7], v[68:71]
  v_mfma_f32_16x16x32_bf16 v[124:127], a[76:79], a[8:11], v[124:127]
  buffer_load_dwordx4 v226, s[8:11], s17 offen offset:1024 lds
  v_mfma_f32_16x16x32_bf16 v[180:183], a[76:79], a[12:15], v[180:183]
  ds_read_b64_tr_b16 a[76:77], v229 offset:14432
  ds_read_b64_tr_b16 a[78:79], v229 offset:18016
  v_mfma_f32_16x16x32_bf16 v[16:19], a[80:83], a[0:3], v[16:19]
  v_mfma_f32_16x16x32_bf16 v[72:75], a[80:83], a[4:7], v[72:75]
  v_mfma_f32_16x16x32_bf16 v[128:131], a[80:83], a[8:11], v[128:131]
  v_mfma_f32_16x16x32_bf16 v[184:187], a[80:83], a[12:15], v[184:187]
  ds_read_b64_tr_b16 a[80:81], v229 offset:14464
  ds_read_b64_tr_b16 a[82:83], v229 offset:18048
  v_mfma_f32_16x16x32_bf16 v[20:23], a[84:87], a[0:3], v[20:23]
  v_mfma_f32_16x16x32_bf16 v[76:79], a[84:87], a[4:7], v[76:79]
  buffer_load_dwordx4 a[52:55], v224, s[4:7], s16 offen offset:1024 sc1
  v_mfma_f32_16x16x32_bf16 v[132:135], a[84:87], a[8:11], v[132:135]
  v_mfma_f32_16x16x32_bf16 v[188:191], a[84:87], a[12:15], v[188:191]
  ds_read_b64_tr_b16 a[84:85], v229 offset:14496
  ds_read_b64_tr_b16 a[86:87], v229 offset:18080
  v_mfma_f32_16x16x32_bf16 v[24:27], a[88:91], a[0:3], v[24:27]
  v_mfma_f32_16x16x32_bf16 v[80:83], a[88:91], a[4:7], v[80:83]
  v_mfma_f32_16x16x32_bf16 v[136:139], a[88:91], a[8:11], v[136:139]
  v_mfma_f32_16x16x32_bf16 v[192:195], a[88:91], a[12:15], v[192:195]
  ds_read_b64_tr_b16 a[88:89], v229 offset:14528
  ds_read_b64_tr_b16 a[90:91], v229 offset:18112
  v_mfma_f32_16x16x32_bf16 v[28:31], a[92:95], a[0:3], v[28:31]
  buffer_load_dwordx4 v227, s[8:11], s17 offen offset:2048 lds
  v_mfma_f32_16x16x32_bf16 v[84:87], a[92:95], a[4:7], v[84:87]
  v_mfma_f32_16x16x32_bf16 v[140:143], a[92:95], a[8:11], v[140:143]
  v_mfma_f32_16x16x32_bf16 v[196:199], a[92:95], a[12:15], v[196:199]
  ds_read_b64_tr_b16 a[92:93], v229 offset:21504
  ds_read_b64_tr_b16 a[94:95], v229 offset:25088
  s_waitcnt lgkmcnt(10)
  v_mfma_f32_16x16x32_bf16 v[32:35], a[96:99], a[0:3], v[32:35]
  v_mfma_f32_16x16x32_bf16 v[88:91], a[96:99], a[4:7], v[88:91]
  v_mfma_f32_16x16x32_bf16 v[144:147], a[96:99], a[8:11], v[144:147]
  v_mfma_f32_16x16x32_bf16 v[200:203], a[96:99], a[12:15], v[200:203]
  buffer_load_dwordx4 a[56:59], v224, s[4:7], s16 offen offset:2048 sc1
  v_mfma_f32_16x16x32_bf16 v[36:39], a[100:103], a[0:3], v[36:39]
  ds_read_b64_tr_b16 a[96:97], v229 offset:21536
  ds_read_b64_tr_b16 a[98:99], v229 offset:25120
  v_mfma_f32_16x16x32_bf16 v[92:95], a[100:103], a[4:7], v[92:95]
  v_mfma_f32_16x16x32_bf16 v[148:151], a[100:103], a[8:11], v[148:151]
  v_mfma_f32_16x16x32_bf16 v[204:207], a[100:103], a[12:15], v[204:207]
  ds_read_b64_tr_b16 a[100:101], v229 offset:21568
  ds_read_b64_tr_b16 a[102:103], v229 offset:25152
  v_mfma_f32_16x16x32_bf16 v[40:43], a[104:107], a[0:3], v[40:43]
  v_mfma_f32_16x16x32_bf16 v[96:99], a[104:107], a[4:7], v[96:99]
  v_mfma_f32_16x16x32_bf16 v[152:155], a[104:107], a[8:11], v[152:155]
  s_mov_b32 exec_hi, 0
  buffer_load_dwordx4 v228, s[8:11], s17 offen offset:3072 lds
  s_mov_b32 exec_hi, -1
  v_mfma_f32_16x16x32_bf16 v[208:211], a[104:107], a[12:15], v[208:211]
  ds_read_b64_tr_b16 a[104:105], v229 offset:21600
  s_add_u32 s17, s17, s99
  v_mfma_f32_16x16x32_bf16 v[44:47], a[108:111], a[0:3], v[44:47]
  ds_read_b64_tr_b16 a[106:107], v229 offset:25184
  v_mfma_f32_16x16x32_bf16 v[100:103], a[108:111], a[4:7], v[100:103]
  v_mfma_f32_16x16x32_bf16 v[156:159], a[108:111], a[8:11], v[156:159]
  v_mfma_f32_16x16x32_bf16 v[212:215], a[108:111], a[12:15], v[212:215]
  ds_read_b64_tr_b16 a[108:109], v229 offset:21632
  ds_read_b64_tr_b16 a[110:111], v229 offset:25216
  v_mfma_f32_16x16x32_bf16 v[48:51], a[112:115], a[0:3], v[48:51]
  v_mfma_f32_16x16x32_bf16 v[104:107], a[112:115], a[4:7], v[104:107]
  buffer_load_dwordx4 a[60:63], v224, s[4:7], s16 offen offset:3072 sc1
  v_mfma_f32_16x16x32_bf16 v[160:163], a[112:115], a[8:11], v[160:163]
  s_add_u32 s16, s16, s47
  v_mfma_f32_16x16x32_bf16 v[216:219], a[112:115], a[12:15], v[216:219]
  ds_read_b64_tr_b16 a[112:113], v229 offset:21664
  ds_read_b64_tr_b16 a[114:115], v229 offset:25248
  v_mfma_f32_16x16x32_bf16 v[52:55], a[116:119], a[0:3], v[52:55]
  v_mfma_f32_16x16x32_bf16 v[108:111], a[116:119], a[4:7], v[108:111]
  v_mfma_f32_16x16x32_bf16 v[164:167], a[116:119], a[8:11], v[164:167]
  v_mfma_f32_16x16x32_bf16 v[220:223], a[116:119], a[12:15], v[220:223]
  s_waitcnt vmcnt(9) lgkmcnt(10)
  s_barrier
  v_mfma_f32_16x16x32_bf16 v[0:3], a[64:67], a[16:19], v[0:3]
  ds_read_b64_tr_b16 a[116:117], v229 offset:21696
  s_add_u32 m0, s38, 0
  v_mfma_f32_16x16x32_bf16 v[56:59], a[64:67], a[20:23], v[56:59]
  buffer_load_dwordx4 v225, s[8:11], s17 offen lds
  v_mfma_f32_16x16x32_bf16 v[112:115], a[64:67], a[24:27], v[112:115]
  ds_read_b64_tr_b16 a[118:119], v229 offset:25280
  v_mfma_f32_16x16x32_bf16 v[168:171], a[64:67], a[28:31], v[168:171]
  ds_read_b64_tr_b16 a[64:65], v229 offset:28672
  ds_read_b64_tr_b16 a[66:67], v229 offset:32256
  v_mfma_f32_16x16x32_bf16 v[4:7], a[68:71], a[16:19], v[4:7]
  v_mfma_f32_16x16x32_bf16 v[60:63], a[68:71], a[20:23], v[60:63]
  v_mfma_f32_16x16x32_bf16 v[116:119], a[68:71], a[24:27], v[116:119]
  v_mfma_f32_16x16x32_bf16 v[172:175], a[68:71], a[28:31], v[172:175]
  buffer_load_dwordx4 a[0:3], v224, s[4:7], s16 offen offset:0 sc1
  v_mfma_f32_16x16x32_bf16 v[8:11], a[72:75], a[16:19], v[8:11]
  ds_read_b64_tr_b16 a[68:69], v229 offset:28704
  ds_read_b64_tr_b16 a[70:71], v229 offset:32288
  v_mfma_f32_16x16x32_bf16 v[64:67], a[72:75], a[20:23], v[64:67]
  v_mfma_f32_16x16x32_bf16 v[120:123], a[72:75], a[24:27], v[120:123]
  v_mfma_f32_16x16x32_bf16 v[176:179], a[72:75], a[28:31], v[176:179]
  ds_read_b64_tr_b16 a[72:73], v229 offset:28736
  ds_read_b64_tr_b16 a[74:75], v229 offset:32320
  v_mfma_f32_16x16x32_bf16 v[12:15], a[76:79], a[16:19], v[12:15]
  v_mfma_f32_16x16x32_bf16 v[68:71], a[76:79], a[20:23], v[68:71]
  buffer_load_dwordx4 v226, s[8:11], s17 offen offset:1024 lds
  v_mfma_f32_16x16x32_bf16 v[124:127], a[76:79], a[24:27], v[124:127]
  v_mfma_f32_16x16x32_bf16 v[180:183], a[76:79], a[28:31], v[180:183]
  ds_read_b64_tr_b16 a[76:77], v229 offset:28768
  ds_read_b64_tr_b16 a[78:79], v229 offset:32352
  v_mfma_f32_16x16x32_bf16 v[16:19], a[80:83], a[16:19], v[16:19]
  v_mfma_f32_16x16x32_bf16 v[72:75], a[80:83], a[20:23], v[72:75]
  v_mfma_f32_16x16x32_bf16 v[128:131], a[80:83], a[24:27], v[128:131]
  v_mfma_f32_16x16x32_bf16 v[184:187], a[80:83], a[28:31], v[184:187]
  buffer_load_dwordx4 a[4:7], v224, s[4:7], s16 offen offset:1024 sc1
  v_mfma_f32_16x16x32_bf16 v[20:23], a[84:87], a[16:19], v[20:23]
  ds_read_b64_tr_b16 a[80:81], v229 offset:28800
  ds_read_b64_tr_b16 a[82:83], v229 offset:32384
  v_mfma_f32_16x16x32_bf16 v[76:79], a[84:87], a[20:23], v[76:79]
  v_mfma_f32_16x16x32_bf16 v[132:135], a[84:87], a[24:27], v[132:135]
  v_mfma_f32_16x16x32_bf16 v[188:191], a[84:87], a[28:31], v[188:191]
  ds_read_b64_tr_b16 a[84:85], v229 offset:28832
  ds_read_b64_tr_b16 a[86:87], v229 offset:32416
  v_mfma_f32_16x16x32_bf16 v[24:27], a[88:91], a[16:19], v[24:27]
  v_mfma_f32_16x16x32_bf16 v[80:83], a[88:91], a[20:23], v[80:83]
  buffer_load_dwordx4 v227, s[8:11], s17 offen offset:2048 lds
  v_mfma_f32_16x16x32_bf16 v[136:139], a[88:91], a[24:27], v[136:139]
  v_mfma_f32_16x16x32_bf16 v[192:195], a[88:91], a[28:31], v[192:195]
  ds_read_b64_tr_b16 a[88:89], v229 offset:28864
  ds_read_b64_tr_b16 a[90:91], v229 offset:32448
  v_mfma_f32_16x16x32_bf16 v[28:31], a[92:95], a[16:19], v[28:31]
  v_mfma_f32_16x16x32_bf16 v[84:87], a[92:95], a[20:23], v[84:87]
  v_mfma_f32_16x16x32_bf16 v[140:143], a[92:95], a[24:27], v[140:143]
  v_mfma_f32_16x16x32_bf16 v[196:199], a[92:95], a[28:31], v[196:199]
  buffer_load_dwordx4 a[8:11], v224, s[4:7], s16 offen offset:2048 sc1
  s_waitcnt lgkmcnt(10)
  v_mfma_f32_16x16x32_bf16 v[32:35], a[96:99], a[16:19], v[32:35]
  ds_read_b64_tr_b16 a[92:93], v229 offset:35840
  ds_read_b64_tr_b16 a[94:95], v229 offset:39424
  v_mfma_f32_16x16x32_bf16 v[88:91], a[96:99], a[20:23], v[88:91]
  v_mfma_f32_16x16x32_bf16 v[144:147], a[96:99], a[24:27], v[144:147]
  v_mfma_f32_16x16x32_bf16 v[200:203], a[96:99], a[28:31], v[200:203]
  ds_read_b64_tr_b16 a[96:97], v229 offset:35872
  ds_read_b64_tr_b16 a[98:99], v229 offset:39456
  v_mfma_f32_16x16x32_bf16 v[36:39], a[100:103], a[16:19], v[36:39]
  v_mfma_f32_16x16x32_bf16 v[92:95], a[100:103], a[20:23], v[92:95]
  s_mov_b32 exec_hi, 0
  buffer_load_dwordx4 v228, s[8:11], s17 offen offset:3072 lds
  s_mov_b32 exec_hi, -1
  v_mfma_f32_16x16x32_bf16 v[148:151], a[100:103], a[24:27], v[148:151]
  s_add_u32 s17, s17, s96
  v_mfma_f32_16x16x32_bf16 v[204:207], a[100:103], a[28:31], v[204:207]
  ds_read_b64_tr_b16 a[100:101], v229 offset:35904
  ds_read_b64_tr_b16 a[102:103], v229 offset:39488
  v_mfma_f32_16x16x32_bf16 v[40:43], a[104:107], a[16:19], v[40:43]
  v_mfma_f32_16x16x32_bf16 v[96:99], a[104:107], a[20:23], v[96:99]
  v_mfma_f32_16x16x32_bf16 v[152:155], a[104:107], a[24:27], v[152:155]
  v_mfma_f32_16x16x32_bf16 v[208:211], a[104:107], a[28:31], v[208:211]
  buffer_load_dwordx4 a[12:15], v224, s[4:7], s16 offen offset:3072 sc1
  v_mfma_f32_16x16x32_bf16 v[44:47], a[108:111], a[16:19], v[44:47]
  ds_read_b64_tr_b16 a[104:105], v229 offset:35936
  s_add_u32 s16, s16, s44
  v_mfma_f32_16x16x32_bf16 v[100:103], a[108:111], a[20:23], v[100:103]
  ds_read_b64_tr_b16 a[106:107], v229 offset:39520
  v_mfma_f32_16x16x32_bf16 v[156:159], a[108:111], a[24:27], v[156:159]
  v_mfma_f32_16x16x32_bf16 v[212:215], a[108:111], a[28:31], v[212:215]
  ds_read_b64_tr_b16 a[108:109], v229 offset:35968
  ds_read_b64_tr_b16 a[110:111], v229 offset:39552
  v_mfma_f32_16x16x32_bf16 v[48:51], a[112:115], a[16:19], v[48:51]
  v_mfma_f32_16x16x32_bf16 v[104:107], a[112:115], a[20:23], v[104:107]
  buffer_load_dword v251, v249, s[52:55], s56 offen
  v_mfma_f32_16x16x32_bf16 v[160:163], a[112:115], a[24:27], v[160:163]
  s_add_u32 s56, s56, 524288
  v_mfma_f32_16x16x32_bf16 v[216:219], a[112:115], a[28:31], v[216:219]
  ds_read_b64_tr_b16 a[112:113], v229 offset:36000
  ds_read_b64_tr_b16 a[114:115], v229 offset:39584
  v_mfma_f32_16x16x32_bf16 v[52:55], a[116:119], a[16:19], v[52:55]
  v_mfma_f32_16x16x32_bf16 v[108:111], a[116:119], a[20:23], v[108:111]
  v_mfma_f32_16x16x32_bf16 v[164:167], a[116:119], a[24:27], v[164:167]
  v_mfma_f32_16x16x32_bf16 v[220:223], a[116:119], a[28:31], v[220:223]
  s_waitcnt vmcnt(10) lgkmcnt(10)
  s_barrier
  v_mfma_f32_16x16x32_bf16 v[0:3], a[64:67], a[32:35], v[0:3]
  ds_read_b64_tr_b16 a[116:117], v229 offset:36032
  s_add_u32 m0, s38, 14336
  v_mfma_f32_16x16x32_bf16 v[56:59], a[64:67], a[36:39], v[56:59]
  buffer_load_dwordx4 v225, s[8:11], s17 offen lds
  v_mfma_f32_16x16x32_bf16 v[112:115], a[64:67], a[40:43], v[112:115]
  ds_read_b64_tr_b16 a[118:119], v229 offset:39616
  v_mfma_f32_16x16x32_bf16 v[168:171], a[64:67], a[44:47], v[168:171]
  ds_read_b64_tr_b16 a[64:65], v229 offset:43008
  ds_read_b64_tr_b16 a[66:67], v229 offset:46592
  v_mfma_f32_16x16x32_bf16 v[4:7], a[68:71], a[32:35], v[4:7]
  v_mfma_f32_16x16x32_bf16 v[60:63], a[68:71], a[36:39], v[60:63]
  v_mfma_f32_16x16x32_bf16 v[116:119], a[68:71], a[40:43], v[116:119]
  v_mfma_f32_16x16x32_bf16 v[172:175], a[68:71], a[44:47], v[172:175]
  buffer_load_dwordx4 a[16:19], v224, s[4:7], s16 offen offset:0 sc1
  v_mfma_f32_16x16x32_bf16 v[8:11], a[72:75], a[32:35], v[8:11]
  ds_read_b64_tr_b16 a[68:69], v229 offset:43040
  ds_read_b64_tr_b16 a[70:71], v229 offset:46624
  v_mfma_f32_16x16x32_bf16 v[64:67], a[72:75], a[36:39], v[64:67]
  v_mfma_f32_16x16x32_bf16 v[120:123], a[72:75], a[40:43], v[120:123]
  v_mfma_f32_16x16x32_bf16 v[176:179], a[72:75], a[44:47], v[176:179]
  ds_read_b64_tr_b16 a[72:73], v229 offset:43072
  ds_read_b64_tr_b16 a[74:75], v229 offset:46656
  v_mfma_f32_16x16x32_bf16 v[12:15], a[76:79], a[32:35], v[12:15]
  v_mfma_f32_16x16x32_bf16 v[68:71], a[76:79], a[36:39], v[68:71]
  v_mfma_f32_16x16x32_bf16 v[124:127], a[76:79], a[40:43], v[124:127]
  buffer_load_dwordx4 v226, s[8:11], s17 offen offset:1024 lds
  v_mfma_f32_16x16x32_bf16 v[180:183], a[76:79], a[44:47], v[180:183]
  ds_read_b64_tr_b16 a[76:77], v229 offset:43104
  ds_read_b64_tr_b16 a[78:79], v229 offset:46688
  v_mfma_f32_16x16x32_bf16 v[16:19], a[80:83], a[32:35], v[16:19]
  v_mfma_f32_16x16x32_bf16 v[72:75], a[80:83], a[36:39], v[72:75]
  v_mfma_f32_16x16x32_bf16 v[128:131], a[80:83], a[40:43], v[128:131]
  v_mfma_f32_16x16x32_bf16 v[184:187], a[80:83], a[44:47], v[184:187]
  ds_read_b64_tr_b16 a[80:81], v229 offset:43136
  ds_read_b64_tr_b16 a[82:83], v229 offset:46720
  v_mfma_f32_16x16x32_bf16 v[20:23], a[84:87], a[32:35], v[20:23]
  v_mfma_f32_16x16x32_bf16 v[76:79], a[84:87], a[36:39], v[76:79]
  buffer_load_dwordx4 a[20:23], v224, s[4:7], s16 offen offset:1024 sc1
  v_mfma_f32_16x16x32_bf16 v[132:135], a[84:87], a[40:43], v[132:135]
  v_mfma_f32_16x16x32_bf16 v[188:191], a[84:87], a[44:47], v[188:191]
  ds_read_b64_tr_b16 a[84:85], v229 offset:43168
  ds_read_b64_tr_b16 a[86:87], v229 offset:46752
  v_mfma_f32_16x16x32_bf16 v[24:27], a[88:91], a[32:35], v[24:27]
  v_mfma_f32_16x16x32_bf16 v[80:83], a[88:91], a[36:39], v[80:83]
  v_mfma_f32_16x16x32_bf16 v[136:139], a[88:91], a[40:43], v[136:139]
  v_mfma_f32_16x16x32_bf16 v[192:195], a[88:91], a[44:47], v[192:195]
  ds_read_b64_tr_b16 a[88:89], v229 offset:43200
  ds_read_b64_tr_b16 a[90:91], v229 offset:46784
  v_mfma_f32_16x16x32_bf16 v[28:31], a[92:95], a[32:35], v[28:31]
  buffer_load_dwordx4 v227, s[8:11], s17 offen offset:2048 lds
  v_mfma_f32_16x16x32_bf16 v[84:87], a[92:95], a[36:39], v[84:87]
  v_mfma_f32_16x16x32_bf16 v[140:143], a[92:95], a[40:43], v[140:143]
  v_mfma_f32_16x16x32_bf16 v[196:199], a[92:95], a[44:47], v[196:199]
  ds_read_b64_tr_b16 a[92:93], v229 offset:50176
  ds_read_b64_tr_b16 a[94:95], v229 offset:53760
  s_waitcnt lgkmcnt(10)
  v_mfma_f32_16x16x32_bf16 v[32:35], a[96:99], a[32:35], v[32:35]
  v_mfma_f32_16x16x32_bf16 v[88:91], a[96:99], a[36:39], v[88:91]
  v_mfma_f32_16x16x32_bf16 v[144:147], a[96:99], a[40:43], v[144:147]
  v_mfma_f32_16x16x32_bf16 v[200:203], a[96:99], a[44:47], v[200:203]
  buffer_load_dwordx4 a[24:27], v224, s[4:7], s16 offen offset:2048 sc1
  v_mfma_f32_16x16x32_bf16 v[36:39], a[100:103], a[32:35], v[36:39]
  ds_read_b64_tr_b16 a[96:97], v229 offset:50208
  ds_read_b64_tr_b16 a[98:99], v229 offset:53792
  v_mfma_f32_16x16x32_bf16 v[92:95], a[100:103], a[36:39], v[92:95]
  v_mfma_f32_16x16x32_bf16 v[148:151], a[100:103], a[40:43], v[148:151]
  v_mfma_f32_16x16x32_bf16 v[204:207], a[100:103], a[44:47], v[204:207]
  ds_read_b64_tr_b16 a[100:101], v229 offset:50240
  ds_read_b64_tr_b16 a[102:103], v229 offset:53824
  v_mfma_f32_16x16x32_bf16 v[40:43], a[104:107], a[32:35], v[40:43]
  v_mfma_f32_16x16x32_bf16 v[96:99], a[104:107], a[36:39], v[96:99]
  v_mfma_f32_16x16x32_bf16 v[152:155], a[104:107], a[40:43], v[152:155]
  s_mov_b32 exec_hi, 0
  buffer_load_dwordx4 v228, s[8:11], s17 offen offset:3072 lds
  s_mov_b32 exec_hi, -1
  v_mfma_f32_16x16x32_bf16 v[208:211], a[104:107], a[44:47], v[208:211]
  ds_read_b64_tr_b16 a[104:105], v229 offset:50272
  s_add_u32 s17, s17, s97
  v_mfma_f32_16x16x32_bf16 v[44:47], a[108:111], a[32:35], v[44:47]
  ds_read_b64_tr_b16 a[106:107], v229 offset:53856
  v_mfma_f32_16x16x32_bf16 v[100:103], a[108:111], a[36:39], v[100:103]
  v_mfma_f32_16x16x32_bf16 v[156:159], a[108:111], a[40:43], v[156:159]
  v_mfma_f32_16x16x32_bf16 v[212:215], a[108:111], a[44:47], v[212:215]
  ds_read_b64_tr_b16 a[108:109], v229 offset:50304
  ds_read_b64_tr_b16 a[110:111], v229 offset:53888
  v_mfma_f32_16x16x32_bf16 v[48:51], a[112:115], a[32:35], v[48:51]
  v_mfma_f32_16x16x32_bf16 v[104:107], a[112:115], a[36:39], v[104:107]
  buffer_load_dwordx4 a[28:31], v224, s[4:7], s16 offen offset:3072 sc1
  v_mfma_f32_16x16x32_bf16 v[160:163], a[112:115], a[40:43], v[160:163]
  s_add_u32 s16, s16, s45
  v_mfma_f32_16x16x32_bf16 v[216:219], a[112:115], a[44:47], v[216:219]
  ds_read_b64_tr_b16 a[112:113], v229 offset:50336
  ds_read_b64_tr_b16 a[114:115], v229 offset:53920
  v_mfma_f32_16x16x32_bf16 v[52:55], a[116:119], a[32:35], v[52:55]
  v_mfma_f32_16x16x32_bf16 v[108:111], a[116:119], a[36:39], v[108:111]
  v_mfma_f32_16x16x32_bf16 v[164:167], a[116:119], a[40:43], v[164:167]
  v_mfma_f32_16x16x32_bf16 v[220:223], a[116:119], a[44:47], v[220:223]
  s_sub_u32 s18, s18, 1
  s_cmp_lg_u32 s18, 0
  s_cbranch_scc1 L_loop_24
  s_waitcnt vmcnt(10) lgkmcnt(10)
  s_barrier
  v_mfma_f32_16x16x32_bf16 v[0:3], a[64:67], a[48:51], v[0:3]
  ds_read_b64_tr_b16 a[116:117], v229 offset:50368
  s_add_u32 m0, s38, 28672
  v_mfma_f32_16x16x32_bf16 v[56:59], a[64:67], a[52:55], v[56:59]
  buffer_load_dwordx4 v225, s[8:11], s17 offen lds
  v_mfma_f32_16x16x32_bf16 v[112:115], a[64:67], a[56:59], v[112:115]
  ds_read_b64_tr_b16 a[118:119], v229 offset:53952
  v_mfma_f32_16x16x32_bf16 v[168:171], a[64:67], a[60:63], v[168:171]
  ds_read_b64_tr_b16 a[64:65], v229 offset:0
  ds_read_b64_tr_b16 a[66:67], v229 offset:3584
  v_mfma_f32_16x16x32_bf16 v[4:7], a[68:71], a[48:51], v[4:7]
  v_mfma_f32_16x16x32_bf16 v[60:63], a[68:71], a[52:55], v[60:63]
  v_mfma_f32_16x16x32_bf16 v[116:119], a[68:71], a[56:59], v[116:119]
  v_mfma_f32_16x16x32_bf16 v[172:175], a[68:71], a[60:63], v[172:175]
  buffer_load_dwordx4 a[32:35], v224, s[4:7], s16 offen offset:0 sc1
  v_mfma_f32_16x16x32_bf16 v[8:11], a[72:75], a[48:51], v[8:11]
  ds_read_b64_tr_b16 a[68:69], v229 offset:32
  ds_read_b64_tr_b16 a[70:71], v229 offset:3616
  v_mfma_f32_16x16x32_bf16 v[64:67], a[72:75], a[52:55], v[64:67]
  v_mfma_f32_16x16x32_bf16 v[120:123], a[72:75], a[56:59], v[120:123]
  v_mfma_f32_16x16x32_bf16 v[176:179], a[72:75], a[60:63], v[176:179]
  ds_read_b64_tr_b16 a[72:73], v229 offset:64
  ds_read_b64_tr_b16 a[74:75], v229 offset:3648
  v_mfma_f32_16x16x32_bf16 v[12:15], a[76:79], a[48:51], v[12:15]
  v_mfma_f32_16x16x32_bf16 v[68:71], a[76:79], a[52:55], v[68:71]
  v_mfma_f32_16x16x32_bf16 v[124:127], a[76:79], a[56:59], v[124:127]
  buffer_load_dwordx4 v226, s[8:11], s17 offen offset:1024 lds
  v_mfma_f32_16x16x32_bf16 v[180:183], a[76:79], a[60:63], v[180:183]
  ds_read_b64_tr_b16 a[76:77], v229 offset:96
  ds_read_b64_tr_b16 a[78:79], v229 offset:3680
  v_mfma_f32_16x16x32_bf16 v[16:19], a[80:83], a[48:51], v[16:19]
  v_mfma_f32_16x16x32_bf16 v[72:75], a[80:83], a[52:55], v[72:75]
  v_mfma_f32_16x16x32_bf16 v[128:131], a[80:83], a[56:59], v[128:131]
  v_mfma_f32_16x16x32_bf16 v[184:187], a[80:83], a[60:63], v[184:187]
  ds_read_b64_tr_b16 a[80:81], v229 offset:128
  ds_read_b64_tr_b16 a[82:83], v229 offset:3712
  v_mfma_f32_16x16x32_bf16 v[20:23], a[84:87], a[48:51], v[20:23]
  v_mfma_f32_16x16x32_bf16 v[76:79], a[84:87], a[52:55], v[76:79]
  buffer_load_dwordx4 a[36:39], v224, s[4:7], s16 offen offset:1024 sc1
  v_mfma_f32_16x16x32_bf16 v[132:135], a[84:87], a[56:59], v[132:135]
  v_mfma_f32_16x16x32_bf16 v[188:191], a[84:87], a[60:63], v[188:191]
  ds_read_b64_tr_b16 a[84:85], v229 offset:160
  ds_read_b64_tr_b16 a[86:87], v229 offset:3744
  v_mfma_f32_16x16x32_bf16 v[24:27], a[88:91], a[48:51], v[24:27]
  v_mfma_f32_16x16x32_bf16 v[80:83], a[88:91], a[52:55], v[80:83]
  v_mfma_f32_16x16x32_bf16 v[136:139], a[88:91], a[56:59], v[136:139]
  v_mfma_f32_16x16x32_bf16 v[192:195], a[88:91], a[60:63], v[192:195]
  ds_read_b64_tr_b16 a[88:89], v229 offset:192
  ds_read_b64_tr_b16 a[90:91], v229 offset:3776
  v_mfma_f32_16x16x32_bf16 v[28:31], a[92:95], a[48:51], v[28:31]
  buffer_load_dwordx4 v227, s[8:11], s17 offen offset:2048 lds
  v_mfma_f32_16x16x32_bf16 v[84:87], a[92:95], a[52:55], v[84:87]
  v_mfma_f32_16x16x32_bf16 v[140:143], a[92:95], a[56:59], v[140:143]
  v_mfma_f32_16x16x32_bf16 v[196:199], a[92:95], a[60:63], v[196:199]
  ds_read_b64_tr_b16 a[92:93], v229 offset:7168
  ds_read_b64_tr_b16 a[94:95], v229 offset:10752
  s_waitcnt lgkmcnt(10)
  v_mfma_f32_16x16x32_bf16 v[32:35], a[96:99], a[48:51], v[32:35]
  v_mfma_f32_16x16x32_bf16 v[88:91], a[96:99], a[52:55], v[88:91]
  v_mfma_f32_16x16x32_bf16 v[144:147], a[96:99], a[56:59], v[144:147]
  v_mfma_f32_16x16x32_bf16 v[200:203], a[96:99], a[60:63], v[200:203]
  buffer_load_dwordx4 a[40:43], v224, s[4:7], s16 offen offset:2048 sc1
  v_mfma_f32_16x16x32_bf16 v[36:39], a[100:103], a[48:51], v[36:39]
  ds_read_b64_tr_b16 a[96:97], v229 offset:7200
  ds_read_b64_tr_b16 a[98:99], v229 offset:10784
  v_mfma_f32_16x16x32_bf16 v[92:95], a[100:103], a[52:55], v[92:95]
  v_mfma_f32_16x16x32_bf16 v[148:151], a[100:103], a[56:59], v[148:151]
  v_mfma_f32_16x16x32_bf16 v[204:207], a[100:103], a[60:63], v[204:207]
  ds_read_b64_tr_b16 a[100:101], v229 offset:7232
  ds_read_b64_tr_b16 a[102:103], v229 offset:10816
  v_mfma_f32_16x16x32_bf16 v[40:43], a[104:107], a[48:51], v[40:43]
  v_mfma_f32_16x16x32_bf16 v[96:99], a[104:107], a[52:55], v[96:99]
  v_mfma_f32_16x16x32_bf16 v[152:155], a[104:107], a[56:59], v[152:155]
  s_mov_b32 exec_hi, 0
  buffer_load_dwordx4 v228, s[8:11], s17 offen offset:3072 lds
  s_mov_b32 exec_hi, -1
  v_mfma_f32_16x16x32_bf16 v[208:211], a[104:107], a[60:63], v[208:211]
  ds_read_b64_tr_b16 a[104:105], v229 offset:7264
  s_add_u32 s17, s17, s98
  v_mfma_f32_16x16x32_bf16 v[44:47], a[108:111], a[48:51], v[44:47]
  ds_read_b64_tr_b16 a[106:107], v229 offset:10848
  v_mfma_f32_16x16x32_bf16 v[100:103], a[108:111], a[52:55], v[100:103]
  v_mfma_f32_16x16x32_bf16 v[156:159], a[108:111], a[56:59], v[156:159]
  v_mfma_f32_16x16x32_bf16 v[212:215], a[108:111], a[60:63], v[212:215]
  ds_read_b64_tr_b16 a[108:109], v229 offset:7296
  ds_read_b64_tr_b16 a[110:111], v229 offset:10880
  v_mfma_f32_16x16x32_bf16 v[48:51], a[112:115], a[48:51], v[48:51]
  v_mfma_f32_16x16x32_bf16 v[104:107], a[112:115], a[52:55], v[104:107]
  buffer_load_dwordx4 a[44:47], v224, s[4:7], s16 offen offset:3072 sc1
  v_mfma_f32_16x16x32_bf16 v[160:163], a[112:115], a[56:59], v[160:163]
  s_add_u32 s16, s16, s46
  v_mfma_f32_16x16x32_bf16 v[216:219], a[112:115], a[60:63], v[216:219]
  ds_read_b64_tr_b16 a[112:113], v229 offset:7328
  ds_read_b64_tr_b16 a[114:115], v229 offset:10912
  v_mfma_f32_16x16x32_bf16 v[52:55], a[116:119], a[48:51], v[52:55]
  v_mfma_f32_16x16x32_bf16 v[108:111], a[116:119], a[52:55], v[108:111]
  v_mfma_f32_16x16x32_bf16 v[164:167], a[116:119], a[56:59], v[164:167]
  v_mfma_f32_16x16x32_bf16 v[220:223], a[116:119], a[60:63], v[220:223]
  s_waitcnt vmcnt(9) lgkmcnt(10)
  s_barrier
  v_mfma_f32_16x16x32_bf16 v[0:3], a[64:67], a[0:3], v[0:3]
  ds_read_b64_tr_b16 a[116:117], v229 offset:7360
  s_add_u32 m0, s38, 43008
  v_mfma_f32_16x16x32_bf16 v[56:59], a[64:67], a[4:7], v[56:59]
  buffer_load_dwordx4 v225, s[8:11], s17 offen lds
  v_mfma_f32_16x16x32_bf16 v[112:115], a[64:67], a[8:11], v[112:115]
  ds_read_b64_tr_b16 a[118:119], v229 offset:10944
  v_mfma_f32_16x16x32_bf16 v[168:171], a[64:67], a[12:15], v[168:171]
  ds_read_b64_tr_b16 a[64:65], v229 offset:14336
  ds_read_b64_tr_b16 a[66:67], v229 offset:17920
  v_mfma_f32_16x16x32_bf16 v[4:7], a[68:71], a[0:3], v[4:7]
  v_mfma_f32_16x16x32_bf16 v[60:63], a[68:71], a[4:7], v[60:63]
  v_mfma_f32_16x16x32_bf16 v[116:119], a[68:71], a[8:11], v[116:119]
  v_mfma_f32_16x16x32_bf16 v[172:175], a[68:71], a[12:15], v[172:175]
  buffer_load_dwordx4 a[48:51], v224, s[4:7], s16 offen offset:0 sc1
  v_mfma_f32_16x16x32_bf16 v[8:11], a[72:75], a[0:3], v[8:11]
  ds_read_b64_tr_b16 a[68:69], v229 offset:14368
  ds_read_b64_tr_b16 a[70:71], v229 offset:17952
  v_mfma_f32_16x16x32_bf16 v[64:67], a[72:75], a[4:7], v[64:67]
  v_mfma_f32_16x16x32_bf16 v[120:123], a[72:75], a[8:11], v[120:123]
  v_mfma_f32_16x16x32_bf16 v[176:179], a[72:75], a[12:15], v[176:179]
  ds_read_b64_tr_b16 a[72:73], v229 offset:14400
  ds_read_b64_tr_b16 a[74:75], v229 offset:17984
  v_mfma_f32_16x16x32_bf16 v[12:15], a[76:79], a[0:3], v[12:15]
  v_mfma_f32_16x16x32_bf16 v[68:71], a[76:79], a[4:7], v[68:71]
  buffer_load_dwordx4 v226, s[8:11], s17 offen offset:1024 lds
  v_mfma_f32_16x16x32_bf16 v[124:127], a[76:79], a[8:11], v[124:127]
  v_mfma_f32_16x16x32_bf16 v[180:183], a[76:79], a[12:15], v[180:183]
  ds_read_b64_tr_b16 a[76:77], v229 offset:14432
  ds_read_b64_tr_b16 a[78:79], v229 offset:18016
  v_mfma_f32_16x16x32_bf16 v[16:19], a[80:83], a[0:3], v[16:19]
  v_mfma_f32_16x16x32_bf16 v[72:75], a[80:83], a[4:7], v[72:75]
  v_mfma_f32_16x16x32_bf16 v[128:131], a[80:83], a[8:11], v[128:131]
  v_mfma_f32_16x16x32_bf16 v[184:187], a[80:83], a[12:15], v[184:187]
  buffer_load_dwordx4 a[52:55], v224, s[4:7], s16 offen offset:1024 sc1
  v_mfma_f32_16x16x32_bf16 v[20:23], a[84:87], a[0:3], v[20:23]
  ds_read_b64_tr_b16 a[80:81], v229 offset:14464
  ds_read_b64_tr_b16 a[82:83], v229 offset:18048
  v_mfma_f32_16x16x32_bf16 v[76:79], a[84:87], a[4:7], v[76:79]
  v_mfma_f32_16x16x32_bf16 v[132:135], a[84:87], a[8:11], v[132:135]
  v_mfma_f32_16x16x32_bf16 v[188:191], a[84:87], a[12:15], v[188:191]
  ds_read_b64_tr_b16 a[84:85], v229 offset:14496
  ds_read_b64_tr_b16 a[86:87], v229 offset:18080
  v_mfma_f32_16x16x32_bf16 v[24:27], a[88:91], a[0:3], v[24:27]
  v_mfma_f32_16x16x32_bf16 v[80:83], a[88:91], a[4:7], v[80:83]
  buffer_load_dwordx4 v227, s[8:11], s17 offen offset:2048 lds
  v_mfma_f32_16x16x32_bf16 v[136:139], a[88:91], a[8:11], v[136:139]
  v_mfma_f32_16x16x32_bf16 v[192:195], a[88:91], a[12:15], v[192:195]
  ds_read_b64_tr_b16 a[88:89], v229 offset:14528
  ds_read_b64_tr_b16 a[90:91], v229 offset:18112
  v_mfma_f32_16x16x32_bf16 v[28:31], a[92:95], a[0:3], v[28:31]
  v_mfma_f32_16x16x32_bf16 v[84:87], a[92:95], a[4:7], v[84:87]
  v_mfma_f32_16x16x32_bf16 v[140:143], a[92:95], a[8:11], v[140:143]
  v_mfma_f32_16x16x32_bf16 v[196:199], a[92:95], a[12:15], v[196:199]
  buffer_load_dwordx4 a[56:59], v224, s[4:7], s16 offen offset:2048 sc1
  s_waitcnt lgkmcnt(10)
  v_mfma_f32_16x16x32_bf16 v[32:35], a[96:99], a[0:3], v[32:35]
  ds_read_b64_tr_b16 a[92:93], v229 offset:21504
  ds_read_b64_tr_b16 a[94:95], v229 offset:25088
  v_mfma_f32_16x16x32_bf16 v[88:91], a[96:99], a[4:7], v[88:91]
  v_mfma_f32_16x16x32_bf16 v[144:147], a[96:99], a[8:11], v[144:147]
  v_mfma_f32_16x16x32_bf16 v[200:203], a[96:99], a[12:15], v[200:203]
  ds_read_b64_tr_b16 a[96:97], v229 offset:21536
  ds_read_b64_tr_b16 a[98:99], v229 offset:25120
  v_mfma_f32_16x16x32_bf16 v[36:39], a[100:103], a[0:3], v[36:39]
  v_mfma_f32_16x16x32_bf16 v[92:95], a[100:103], a[4:7], v[92:95]
  s_mov_b32 exec_hi, 0
  buffer_load_dwordx4 v228, s[8:11], s17 offen offset:3072 lds
  s_mov_b32 exec_hi, -1
  v_mfma_f32_16x16x32_bf16 v[148:151], a[100:103], a[8:11], v[148:151]
  s_add_u32 s17, s17, s99
  v_mfma_f32_16x16x32_bf16 v[204:207], a[100:103], a[12:15], v[204:207]
  ds_read_b64_tr_b16 a[100:101], v229 offset:21568
  ds_read_b64_tr_b16 a[102:103], v229 offset:25152
  v_mfma_f32_16x16x32_bf16 v[40:43], a[104:107], a[0:3], v[40:43]
  v_mfma_f32_16x16x32_bf16 v[96:99], a[104:107], a[4:7], v[96:99]
  v_mfma_f32_16x16x32_bf16 v[152:155], a[104:107], a[8:11], v[152:155]
  v_mfma_f32_16x16x32_bf16 v[208:211], a[104:107], a[12:15], v[208:211]
  buffer_load_dwordx4 a[60:63], v224, s[4:7], s16 offen offset:3072 sc1
  v_mfma_f32_16x16x32_bf16 v[44:47], a[108:111], a[0:3], v[44:47]
  ds_read_b64_tr_b16 a[104:105], v229 offset:21600
  s_add_u32 s16, s16, s47
  v_mfma_f32_16x16x32_bf16 v[100:103], a[108:111], a[4:7], v[100:103]
  ds_read_b64_tr_b16 a[106:107], v229 offset:25184
  v_mfma_f32_16x16x32_bf16 v[156:159], a[108:111], a[8:11], v[156:159]
  v_mfma_f32_16x16x32_bf16 v[212:215], a[108:111], a[12:15], v[212:215]
  ds_read_b64_tr_b16 a[108:109], v229 offset:21632
  ds_read_b64_tr_b16 a[110:111], v229 offset:25216
  v_mfma_f32_16x16x32_bf16 v[48:51], a[112:115], a[0:3], v[48:51]
  v_mfma_f32_16x16x32_bf16 v[104:107], a[112:115], a[4:7], v[104:107]
  s_getpc_b64 s[52:53]
  L_pc_23:
  s_add_u32 s52, s52, L_k56_seam-L_pc_23
  s_addc_u32 s53, s53, 0
  s_lshr_b32 s56, s2, 3
  s_lshl_b32 s56, s56, 2
  s_add_u32 s56, s56, s3
  s_lshl_b32 s56, s56, 13
  v_lshlrev_b32 v254, 7, v231
  v_add_u32 v254, s56, v254
  v_min_u32 v254, L_code_end-L_k56_seam-4, v254
  v_mov_b32 v255, s53
  v_add_co_u32 v254, vcc, s52, v254
  s_nop 1
  v_addc_co_u32 v255, vcc, 0, v255, vcc
  global_load_dword v251, v[254:255], off
  v_mfma_f32_16x16x32_bf16 v[160:163], a[112:115], a[8:11], v[160:163]
  v_mfma_f32_16x16x32_bf16 v[216:219], a[112:115], a[12:15], v[216:219]
  ds_read_b64_tr_b16 a[112:113], v229 offset:21664
  ds_read_b64_tr_b16 a[114:115], v229 offset:25248
  v_mfma_f32_16x16x32_bf16 v[52:55], a[116:119], a[0:3], v[52:55]
  v_mfma_f32_16x16x32_bf16 v[108:111], a[116:119], a[4:7], v[108:111]
  v_mfma_f32_16x16x32_bf16 v[164:167], a[116:119], a[8:11], v[164:167]
  v_mfma_f32_16x16x32_bf16 v[220:223], a[116:119], a[12:15], v[220:223]
  s_waitcnt vmcnt(10) lgkmcnt(10)
  s_barrier
  s_lshr_b32 s32, s31, 4
  s_mul_i32 s32, s32, 56
  v_mfma_f32_16x16x32_bf16 v[0:3], a[64:67], a[16:19], v[0:3]
  s_and_b32 s33, s31, 15
  s_add_u32 s34, s33, s32
  v_mfma_f32_16x16x32_bf16 v[56:59], a[64:67], a[20:23], v[56:59]
  s_lshl_b32 s98, s34, 17
  s_add_u32 s99, s98, 2097152
  v_mfma_f32_16x16x32_bf16 v[112:115], a[64:67], a[24:27], v[112:115]
  ds_read_b64_tr_b16 a[116:117], v229 offset:21696
  ds_read_b64_tr_b16 a[118:119], v229 offset:25280
  s_add_u32 s100, s98, 4194304
  s_lshr_b32 s34, s33, 1
  v_mfma_f32_16x16x32_bf16 v[168:171], a[64:67], a[28:31], v[168:171]
  s_add_u32 s34, s34, s32
  s_add_u32 s34, s34, 48
  v_mfma_f32_16x16x32_bf16 v[4:7], a[68:71], a[16:19], v[4:7]
  s_lshl_b32 s101, s34, 17
  s_and_b32 s35, s31, 1
  v_mfma_f32_16x16x32_bf16 v[60:63], a[68:71], a[20:23], v[60:63]
  s_lshl_b32 s35, s35, 10
  s_add_u32 s101, s101, s35
  v_mfma_f32_16x16x32_bf16 v[116:119], a[68:71], a[24:27], v[116:119]
  ds_read_b64_tr_b16 a[64:65], v229 offset:28672
  ds_read_b64_tr_b16 a[66:67], v229 offset:32256
  s_lshl_b32 s92, s30, 2
  s_add_u32 s92, s92, s3
  v_mfma_f32_16x16x32_bf16 v[172:175], a[68:71], a[28:31], v[172:175]
  s_lshl_b32 s92, s92, 5
  s_add_u32 s92, s92, s31
  v_mfma_f32_16x16x32_bf16 v[8:11], a[72:75], a[16:19], v[8:11]
  s_lshl_b32 s92, s92, 6
  s_add_u32 s56, s20, 0x80000
  v_mfma_f32_16x16x32_bf16 v[64:67], a[72:75], a[20:23], v[64:67]
  s_addc_u32 s57, s21, 0
  s_mov_b32 s58, 0x30000
  v_mfma_f32_16x16x32_bf16 v[120:123], a[72:75], a[24:27], v[120:123]
  ds_read_b64_tr_b16 a[68:69], v229 offset:28704
  ds_read_b64_tr_b16 a[70:71], v229 offset:32288
  s_mov_b32 s59, 0x20000
  s_and_b32 s28, s2, 1
  v_mfma_f32_16x16x32_bf16 v[176:179], a[72:75], a[28:31], v[176:179]
  s_lshr_b32 s29, s2, 3
  s_bfe_u32 s30, s2, 0x20001
  v_mfma_f32_16x16x32_bf16 v[12:15], a[76:79], a[16:19], v[12:15]
  s_lshl_b32 s30, s30, 2
  s_and_b32 s31, s29, 3
  v_mfma_f32_16x16x32_bf16 v[68:71], a[76:79], a[20:23], v[68:71]
  s_add_u32 s30, s30, s31
  s_lshr_b32 s29, s29, 2
  v_mfma_f32_16x16x32_bf16 v[124:127], a[76:79], a[24:27], v[124:127]
  ds_read_b64_tr_b16 a[72:73], v229 offset:28736
  ds_read_b64_tr_b16 a[74:75], v229 offset:32320
  s_lshl_b32 s31, s29, 1
  s_add_u32 s31, s31, s28
  v_mfma_f32_16x16x32_bf16 v[180:183], a[76:79], a[28:31], v[180:183]
  s_lshl_b32 s94, s30, 1
  s_lshr_b32 s33, s3, 1
  v_mfma_f32_16x16x32_bf16 v[16:19], a[80:83], a[16:19], v[16:19]
  s_add_u32 s94, s94, s33
  s_lshl_b32 s94, s94, 11
  v_mfma_f32_16x16x32_bf16 v[72:75], a[80:83], a[20:23], v[72:75]
  s_lshl_b32 s33, s28, 10
  s_add_u32 s94, s94, s33
  v_mfma_f32_16x16x32_bf16 v[128:131], a[80:83], a[24:27], v[128:131]
  ds_read_b64_tr_b16 a[76:77], v229 offset:28768
  ds_read_b64_tr_b16 a[78:79], v229 offset:32352
  v_and_b32 v246, 15, v231
  v_lshlrev_b32 v246, 6, v246
  v_mfma_f32_16x16x32_bf16 v[184:187], a[80:83], a[28:31], v[184:187]
  s_lshl_b32 s32, s30, 13
  s_lshl_b32 s33, s3, 11
  v_mfma_f32_16x16x32_bf16 v[20:23], a[84:87], a[16:19], v[20:23]
  s_add_u32 s32, s32, s33
  v_lshlrev_b32 v240, 4, v231
  v_mfma_f32_16x16x32_bf16 v[76:79], a[84:87], a[20:23], v[76:79]
  v_add_u32 v240, s32, v240
  v_add_u32 v241, 131072, v240
  v_mfma_f32_16x16x32_bf16 v[132:135], a[84:87], a[24:27], v[132:135]
  ds_read_b64_tr_b16 a[80:81], v229 offset:28800
  ds_read_b64_tr_b16 a[82:83], v229 offset:32384
  v_lshrrev_b32 v232, 3, v231
  v_and_b32 v233, 6, v232
  v_mfma_f32_16x16x32_bf16 v[188:191], a[84:87], a[28:31], v[188:191]
  v_and_b32 v234, 7, v231
  v_xor_b32 v233, v233, v234
  v_mfma_f32_16x16x32_bf16 v[24:27], a[88:91], a[16:19], v[24:27]
  v_lshlrev_b32 v232, 11, v232
  v_lshl_add_u32 v232, v233, 4, v232
  v_mfma_f32_16x16x32_bf16 v[80:83], a[88:91], a[20:23], v[80:83]
  s_lshl_b32 s32, s3, 15
  s_add_u32 s32, s32, 4096
  v_mfma_f32_16x16x32_bf16 v[136:139], a[88:91], a[24:27], v[136:139]
  ds_read_b64_tr_b16 a[84:85], v229 offset:28832
  ds_read_b64_tr_b16 a[86:87], v229 offset:32416
  s_lshl_b32 s33, s31, 7
  s_add_u32 s34, s32, s33
  v_mfma_f32_16x16x32_bf16 v[192:195], a[88:91], a[28:31], v[192:195]
  s_xor_b32 s33, s33, 128
  s_add_u32 s35, s32, s33
  v_mfma_f32_16x16x32_bf16 v[28:31], a[92:95], a[16:19], v[28:31]
  v_add_u32 v225, s34, v232
  v_add_u32 v226, 15360, v225
  v_mfma_f32_16x16x32_bf16 v[84:87], a[92:95], a[20:23], v[84:87]
  v_add_u32 v227, s35, v232
  v_add_u32 v228, 13312, v227
  v_mfma_f32_16x16x32_bf16 v[140:143], a[92:95], a[24:27], v[140:143]
  ds_read_b64_tr_b16 a[88:89], v229 offset:28864
  ds_read_b64_tr_b16 a[90:91], v229 offset:32448
  v_subrev_u32 v227, 2048, v227
  s_lshl_b32 s38, s3, 12
  v_mfma_f32_16x16x32_bf16 v[196:199], a[92:95], a[28:31], v[196:199]
  s_add_u32 s38, s38, 0
  s_mul_i32 s16, s28, 7340032
  s_waitcnt lgkmcnt(10)
  v_mfma_f32_16x16x32_bf16 v[32:35], a[96:99], a[16:19], v[32:35]
  s_mul_i32 s17, s28, 3670016
  s_lshr_b32 s33, s3, 1
  v_mfma_f32_16x16x32_bf16 v[88:91], a[96:99], a[20:23], v[88:91]
  s_mul_i32 s33, s33, 196608
  s_add_u32 s17, s17, s33
  v_mfma_f32_16x16x32_bf16 v[144:147], a[96:99], a[24:27], v[144:147]
  ds_read_b64_tr_b16 a[92:93], v229 offset:35840
  ds_read_b64_tr_b16 a[94:95], v229 offset:39424
  s_add_u32 s97, s17, s33
  s_add_u32 s97, s97, 196608
  v_mfma_f32_16x16x32_bf16 v[200:203], a[96:99], a[28:31], v[200:203]
  s_lshr_b32 s33, s2, 5
  s_mul_i32 s33, s33, 2
  v_mfma_f32_16x16x32_bf16 v[36:39], a[100:103], a[16:19], v[36:39]
  s_bfe_u32 s34, s2, 0x20003
  s_mul_i32 s34, s34, 1
  v_mfma_f32_16x16x32_bf16 v[92:95], a[100:103], a[20:23], v[92:95]
  s_add_u32 s33, s33, s34
  s_and_b32 s33, s33, 7
  v_mfma_f32_16x16x32_bf16 v[148:151], a[100:103], a[24:27], v[148:151]
  ds_read_b64_tr_b16 a[96:97], v229 offset:35872
  ds_read_b64_tr_b16 a[98:99], v229 offset:39456
  s_mov_b32 s95, s17
  s_add_u32 s93, s17, 3670016
  v_mfma_f32_16x16x32_bf16 v[204:207], a[100:103], a[28:31], v[204:207]
  s_mul_i32 s34, s33, 458752
  s_add_u32 s17, s17, s34
  v_mfma_f32_16x16x32_bf16 v[40:43], a[104:107], a[16:19], v[40:43]
  s_mov_b32 s40, s16
  s_lshl_b32 s41, s33, 18
  v_mfma_f32_16x16x32_bf16 v[96:99], a[104:107], a[20:23], v[96:99]
  s_add_u32 s16, s40, s41
  s_sub_u32 s8, s22, 4096
  v_mfma_f32_16x16x32_bf16 v[152:155], a[104:107], a[24:27], v[152:155]
  ds_read_b64_tr_b16 a[100:101], v229 offset:35904
  ds_read_b64_tr_b16 a[102:103], v229 offset:39488
  s_subb_u32 s9, s23, 0
  s_mov_b32 s10, 7344128
  v_mfma_f32_16x16x32_bf16 v[208:211], a[104:107], a[28:31], v[208:211]
  s_add_u32 s4, s20, 0x1600000
  s_addc_u32 s5, s21, 0
  v_mfma_f32_16x16x32_bf16 v[44:47], a[108:111], a[16:19], v[44:47]
  s_mov_b32 s6, 0xe00000
  s_mov_b32 s7, 0x20000
  v_mfma_f32_16x16x32_bf16 v[100:103], a[108:111], a[20:23], v[100:103]
  v_lshrrev_b32 v232, 2, v231
  v_lshlrev_b32 v232, 7, v232
  v_mfma_f32_16x16x32_bf16 v[156:159], a[108:111], a[24:27], v[156:159]
  ds_read_b64_tr_b16 a[104:105], v229 offset:35936
  ds_read_b64_tr_b16 a[106:107], v229 offset:39520
  v_bfe_u32 v233, v231, 3, 2
  v_lshl_add_u32 v232, v233, 5, v232
  v_mfma_f32_16x16x32_bf16 v[212:215], a[108:111], a[28:31], v[212:215]
  v_and_b32 v233, 3, v231
  v_lshl_add_u32 v232, v233, 3, v232
  v_mfma_f32_16x16x32_bf16 v[48:51], a[112:115], a[16:19], v[48:51]
  v_xor_b32 v242, 0, v232
  v_add_u32 v242, 0, v242
  v_mfma_f32_16x16x32_bf16 v[104:107], a[112:115], a[20:23], v[104:107]
  v_xor_b32 v243, 32, v232
  v_add_u32 v243, 0, v243
  v_mfma_f32_16x16x32_bf16 v[160:163], a[112:115], a[24:27], v[160:163]
  ds_read_b64_tr_b16 a[108:109], v229 offset:35968
  ds_read_b64_tr_b16 a[110:111], v229 offset:39552
  v_xor_b32 v244, 64, v232
  v_add_u32 v244, 0, v244
  v_mfma_f32_16x16x32_bf16 v[216:219], a[112:115], a[28:31], v[216:219]
  v_xor_b32 v245, 96, v232
  v_add_u32 v245, 0, v245
  v_mfma_f32_16x16x32_bf16 v[52:55], a[116:119], a[16:19], v[52:55]
  s_mov_b32 s42, 0xbfb8aa3b
  s_mov_b32 s43, 0xbfb8aa3b
  v_mfma_f32_16x16x32_bf16 v[108:111], a[116:119], a[20:23], v[108:111]
  s_mov_b32 s62, 1.0
  s_mov_b32 s63, 1.0
  v_mfma_f32_16x16x32_bf16 v[164:167], a[116:119], a[24:27], v[164:167]
  ds_read_b64_tr_b16 a[112:113], v229 offset:36000
  ds_read_b64_tr_b16 a[114:115], v229 offset:39584
  v_mfma_f32_16x16x32_bf16 v[220:223], a[116:119], a[28:31], v[220:223]
  s_waitcnt vmcnt(2) lgkmcnt(10)
  s_barrier
  v_mfma_f32_16x16x32_bf16 v[0:3], a[64:67], a[32:35], v[0:3]
  ds_read_b64_tr_b16 a[116:117], v229 offset:36032
  ds_read_b64_tr_b16 a[118:119], v229 offset:39616
  v_mfma_f32_16x16x32_bf16 v[56:59], a[64:67], a[36:39], v[56:59]
  s_add_u32 m0, s38, 0
  s_nop 0
  buffer_load_dwordx4 v225, s[8:11], s17 offen lds
  v_mfma_f32_16x16x32_bf16 v[112:115], a[64:67], a[40:43], v[112:115]
  v_mfma_f32_16x16x32_bf16 v[168:171], a[64:67], a[44:47], v[168:171]
  ds_read_b64_tr_b16 a[64:65], v229 offset:43008
  ds_read_b64_tr_b16 a[66:67], v229 offset:46592
  v_mfma_f32_16x16x32_bf16 v[4:7], a[68:71], a[32:35], v[4:7]
  v_mfma_f32_16x16x32_bf16 v[60:63], a[68:71], a[36:39], v[60:63]
  buffer_load_dwordx4 v226, s[8:11], s17 offen offset:1024 lds
  v_mfma_f32_16x16x32_bf16 v[116:119], a[68:71], a[40:43], v[116:119]
  v_mfma_f32_16x16x32_bf16 v[172:175], a[68:71], a[44:47], v[172:175]
  ds_read_b64_tr_b16 a[68:69], v229 offset:43040
  ds_read_b64_tr_b16 a[70:71], v229 offset:46624
  v_mfma_f32_16x16x32_bf16 v[8:11], a[72:75], a[32:35], v[8:11]
  v_mfma_f32_16x16x32_bf16 v[64:67], a[72:75], a[36:39], v[64:67]
  buffer_load_dwordx4 v227, s[8:11], s17 offen offset:2048 lds
  v_mfma_f32_16x16x32_bf16 v[120:123], a[72:75], a[40:43], v[120:123]
  v_mfma_f32_16x16x32_bf16 v[176:179], a[72:75], a[44:47], v[176:179]
  ds_read_b64_tr_b16 a[72:73], v229 offset:50176
  ds_read_b64_tr_b16 a[74:75], v229 offset:53760
  v_mfma_f32_16x16x32_bf16 v[12:15], a[76:79], a[32:35], v[12:15]
  v_mfma_f32_16x16x32_bf16 v[68:71], a[76:79], a[36:39], v[68:71]
  buffer_load_dwordx4 v228, s[8:11], s17 offen offset:3072 lds
  s_add_u32 s17, s17, 458752
  s_cmp_eq_u32 s17, s93
  s_cselect_b32 s17, s95, s17
  v_mfma_f32_16x16x32_bf16 v[124:127], a[76:79], a[40:43], v[124:127]
  v_mfma_f32_16x16x32_bf16 v[180:183], a[76:79], a[44:47], v[180:183]
  ds_read_b64_tr_b16 a[76:77], v229 offset:50208
  ds_read_b64_tr_b16 a[78:79], v229 offset:53792
  v_mfma_f32_16x16x32_bf16 v[16:19], a[80:83], a[32:35], v[16:19]
  v_mfma_f32_16x16x32_bf16 v[72:75], a[80:83], a[36:39], v[72:75]
  s_add_u32 m0, s38, 16384
  s_nop 0
  buffer_load_dwordx4 v225, s[8:11], s17 offen lds
  v_mfma_f32_16x16x32_bf16 v[128:131], a[80:83], a[40:43], v[128:131]
  v_mfma_f32_16x16x32_bf16 v[184:187], a[80:83], a[44:47], v[184:187]
  ds_read_b64_tr_b16 a[80:81], v229 offset:43072
  ds_read_b64_tr_b16 a[82:83], v229 offset:46656
  v_mfma_f32_16x16x32_bf16 v[20:23], a[84:87], a[32:35], v[20:23]
  v_mfma_f32_16x16x32_bf16 v[76:79], a[84:87], a[36:39], v[76:79]
  buffer_load_dwordx4 v226, s[8:11], s17 offen offset:1024 lds
  v_mfma_f32_16x16x32_bf16 v[132:135], a[84:87], a[40:43], v[132:135]
  v_mfma_f32_16x16x32_bf16 v[188:191], a[84:87], a[44:47], v[188:191]
  ds_read_b64_tr_b16 a[84:85], v229 offset:43104
  ds_read_b64_tr_b16 a[86:87], v229 offset:46688
  v_mfma_f32_16x16x32_bf16 v[24:27], a[88:91], a[32:35], v[24:27]
  v_mfma_f32_16x16x32_bf16 v[80:83], a[88:91], a[36:39], v[80:83]
  buffer_load_dwordx4 v227, s[8:11], s17 offen offset:2048 lds
  v_mfma_f32_16x16x32_bf16 v[136:139], a[88:91], a[40:43], v[136:139]
  v_mfma_f32_16x16x32_bf16 v[192:195], a[88:91], a[44:47], v[192:195]
  ds_read_b64_tr_b16 a[88:89], v229 offset:50240
  ds_read_b64_tr_b16 a[90:91], v229 offset:53824
  v_mfma_f32_16x16x32_bf16 v[28:31], a[92:95], a[32:35], v[28:31]
  v_mfma_f32_16x16x32_bf16 v[84:87], a[92:95], a[36:39], v[84:87]
  buffer_load_dwordx4 v228, s[8:11], s17 offen offset:3072 lds
  s_add_u32 s17, s17, 458752
  s_cmp_eq_u32 s17, s93
  s_cselect_b32 s17, s95, s17
  v_mfma_f32_16x16x32_bf16 v[140:143], a[92:95], a[40:43], v[140:143]
  v_mfma_f32_16x16x32_bf16 v[196:199], a[92:95], a[44:47], v[196:199]
  ds_read_b64_tr_b16 a[92:93], v229 offset:50272
  ds_read_b64_tr_b16 a[94:95], v229 offset:53856
  s_waitcnt lgkmcnt(10)
  v_mfma_f32_16x16x32_bf16 v[32:35], a[96:99], a[32:35], v[32:35]
  v_mfma_f32_16x16x32_bf16 v[88:91], a[96:99], a[36:39], v[88:91]
  s_add_u32 m0, s38, 32768
  s_nop 0
  buffer_load_dwordx4 v225, s[8:11], s17 offen lds
  v_mfma_f32_16x16x32_bf16 v[144:147], a[96:99], a[40:43], v[144:147]
  v_mfma_f32_16x16x32_bf16 v[200:203], a[96:99], a[44:47], v[200:203]
  ds_read_b64_tr_b16 a[96:97], v229 offset:43136
  ds_read_b64_tr_b16 a[98:99], v229 offset:46720
  v_mfma_f32_16x16x32_bf16 v[36:39], a[100:103], a[32:35], v[36:39]
  v_mfma_f32_16x16x32_bf16 v[92:95], a[100:103], a[36:39], v[92:95]
  buffer_load_dwordx4 v226, s[8:11], s17 offen offset:1024 lds
  v_mfma_f32_16x16x32_bf16 v[148:151], a[100:103], a[40:43], v[148:151]
  v_mfma_f32_16x16x32_bf16 v[204:207], a[100:103], a[44:47], v[204:207]
  ds_read_b64_tr_b16 a[100:101], v229 offset:43168
  ds_read_b64_tr_b16 a[102:103], v229 offset:46752
  v_mfma_f32_16x16x32_bf16 v[40:43], a[104:107], a[32:35], v[40:43]
  v_mfma_f32_16x16x32_bf16 v[96:99], a[104:107], a[36:39], v[96:99]
  buffer_load_dwordx4 v227, s[8:11], s17 offen offset:2048 lds
  v_mfma_f32_16x16x32_bf16 v[152:155], a[104:107], a[40:43], v[152:155]
  v_mfma_f32_16x16x32_bf16 v[208:211], a[104:107], a[44:47], v[208:211]
  ds_read_b64_tr_b16 a[104:105], v229 offset:43200
  ds_read_b64_tr_b16 a[106:107], v229 offset:46784
  v_mfma_f32_16x16x32_bf16 v[44:47], a[108:111], a[32:35], v[44:47]
  v_mfma_f32_16x16x32_bf16 v[100:103], a[108:111], a[36:39], v[100:103]
  buffer_load_dwordx4 v228, s[8:11], s17 offen offset:3072 lds
  s_add_u32 s17, s17, 458752
  s_cmp_eq_u32 s17, s93
  s_cselect_b32 s17, s95, s17
  v_mfma_f32_16x16x32_bf16 v[156:159], a[108:111], a[40:43], v[156:159]
  v_mfma_f32_16x16x32_bf16 v[212:215], a[108:111], a[44:47], v[212:215]
  ds_read_b64_tr_b16 a[108:109], v229 offset:50304
  ds_read_b64_tr_b16 a[110:111], v229 offset:53888
  v_mfma_f32_16x16x32_bf16 v[48:51], a[112:115], a[32:35], v[48:51]
  v_mfma_f32_16x16x32_bf16 v[104:107], a[112:115], a[36:39], v[104:107]
  v_mfma_f32_16x16x32_bf16 v[160:163], a[112:115], a[40:43], v[160:163]
  v_mfma_f32_16x16x32_bf16 v[216:219], a[112:115], a[44:47], v[216:219]
  ds_read_b64_tr_b16 a[112:113], v229 offset:50336
  ds_read_b64_tr_b16 a[114:115], v229 offset:53920
  v_mfma_f32_16x16x32_bf16 v[52:55], a[116:119], a[32:35], v[52:55]
  v_mfma_f32_16x16x32_bf16 v[108:111], a[116:119], a[36:39], v[108:111]
  v_mfma_f32_16x16x32_bf16 v[164:167], a[116:119], a[40:43], v[164:167]
  v_mfma_f32_16x16x32_bf16 v[220:223], a[116:119], a[44:47], v[220:223]
  s_waitcnt vmcnt(13) lgkmcnt(10)
  s_barrier
  v_mfma_f32_16x16x32_bf16 v[0:3], a[64:67], a[48:51], v[0:3]
  ds_read_b64_tr_b16 a[116:117], v229 offset:50368
  ds_read_b64_tr_b16 a[118:119], v229 offset:53952
  v_mfma_f32_16x16x32_bf16 v[56:59], a[64:67], a[52:55], v[56:59]
  s_add_u32 m0, s38, 49152
  s_nop 0
  buffer_load_dwordx4 v225, s[8:11], s17 offen lds
  v_mfma_f32_16x16x32_bf16 v[112:115], a[64:67], a[56:59], v[112:115]
  v_mfma_f32_16x16x32_bf16 v[168:171], a[64:67], a[60:63], v[168:171]
  v_mfma_f32_16x16x32_bf16 v[4:7], a[68:71], a[48:51], v[4:7]
  v_mfma_f32_16x16x32_bf16 v[60:63], a[68:71], a[52:55], v[60:63]
  buffer_load_dwordx4 v226, s[8:11], s17 offen offset:1024 lds
  v_mfma_f32_16x16x32_bf16 v[116:119], a[68:71], a[56:59], v[116:119]
  v_mfma_f32_16x16x32_bf16 v[172:175], a[68:71], a[60:63], v[172:175]
  v_mfma_f32_16x16x32_bf16 v[28:31], a[72:75], a[48:51], v[28:31]
  v_mfma_f32_16x16x32_bf16 v[84:87], a[72:75], a[52:55], v[84:87]
  buffer_load_dwordx4 v227, s[8:11], s17 offen offset:2048 lds
  v_mfma_f32_16x16x32_bf16 v[140:143], a[72:75], a[56:59], v[140:143]
  v_mfma_f32_16x16x32_bf16 v[196:199], a[72:75], a[60:63], v[196:199]
  v_mfma_f32_16x16x32_bf16 v[32:35], a[76:79], a[48:51], v[32:35]
  v_mfma_f32_16x16x32_bf16 v[88:91], a[76:79], a[52:55], v[88:91]
  buffer_load_dwordx4 v228, s[8:11], s17 offen offset:3072 lds
  s_add_u32 s17, s17, 458752
  s_cmp_eq_u32 s17, s93
  s_cselect_b32 s17, s95, s17
  v_mfma_f32_16x16x32_bf16 v[144:147], a[76:79], a[56:59], v[144:147]
  v_mfma_f32_16x16x32_bf16 v[200:203], a[76:79], a[60:63], v[200:203]
  v_mfma_f32_16x16x32_bf16 v[8:11], a[80:83], a[48:51], v[8:11]
  v_mfma_f32_16x16x32_bf16 v[64:67], a[80:83], a[52:55], v[64:67]
  s_add_u32 m0, s38, 65536
  s_nop 0
  buffer_load_dwordx4 v225, s[8:11], s17 offen lds
  v_mfma_f32_16x16x32_bf16 v[120:123], a[80:83], a[56:59], v[120:123]
  v_mfma_f32_16x16x32_bf16 v[176:179], a[80:83], a[60:63], v[176:179]
  v_mfma_f32_16x16x32_bf16 v[12:15], a[84:87], a[48:51], v[12:15]
  v_mfma_f32_16x16x32_bf16 v[68:71], a[84:87], a[52:55], v[68:71]
  buffer_load_dwordx4 v226, s[8:11], s17 offen offset:1024 lds
  v_mfma_f32_16x16x32_bf16 v[124:127], a[84:87], a[56:59], v[124:127]
  v_mfma_f32_16x16x32_bf16 v[180:183], a[84:87], a[60:63], v[180:183]
  v_mfma_f32_16x16x32_bf16 v[36:39], a[88:91], a[48:51], v[36:39]
  v_mfma_f32_16x16x32_bf16 v[92:95], a[88:91], a[52:55], v[92:95]
  buffer_load_dwordx4 v227, s[8:11], s17 offen offset:2048 lds
  v_mfma_f32_16x16x32_bf16 v[148:151], a[88:91], a[56:59], v[148:151]
  v_mfma_f32_16x16x32_bf16 v[204:207], a[88:91], a[60:63], v[204:207]
  v_mfma_f32_16x16x32_bf16 v[40:43], a[92:95], a[48:51], v[40:43]
  v_mfma_f32_16x16x32_bf16 v[96:99], a[92:95], a[52:55], v[96:99]
  buffer_load_dwordx4 v228, s[8:11], s17 offen offset:3072 lds
  s_add_u32 s17, s17, 458752
  s_cmp_eq_u32 s17, s93
  s_cselect_b32 s17, s95, s17
  v_mfma_f32_16x16x32_bf16 v[152:155], a[92:95], a[56:59], v[152:155]
  v_mfma_f32_16x16x32_bf16 v[208:211], a[92:95], a[60:63], v[208:211]
  s_waitcnt lgkmcnt(10)
  v_mfma_f32_16x16x32_bf16 v[16:19], a[96:99], a[48:51], v[16:19]
  v_mfma_f32_16x16x32_bf16 v[72:75], a[96:99], a[52:55], v[72:75]
  s_add_u32 m0, s38, 81920
  s_nop 0
  buffer_load_dwordx4 v225, s[8:11], s17 offen lds
  v_mfma_f32_16x16x32_bf16 v[128:131], a[96:99], a[56:59], v[128:131]
  v_mfma_f32_16x16x32_bf16 v[184:187], a[96:99], a[60:63], v[184:187]
  s_waitcnt lgkmcnt(8)
  v_mfma_f32_16x16x32_bf16 v[20:23], a[100:103], a[48:51], v[20:23]
  v_mfma_f32_16x16x32_bf16 v[76:79], a[100:103], a[52:55], v[76:79]
  buffer_load_dwordx4 v226, s[8:11], s17 offen offset:1024 lds
  v_mfma_f32_16x16x32_bf16 v[132:135], a[100:103], a[56:59], v[132:135]
  v_mfma_f32_16x16x32_bf16 v[188:191], a[100:103], a[60:63], v[188:191]
  s_waitcnt lgkmcnt(6)
  v_mfma_f32_16x16x32_bf16 v[24:27], a[104:107], a[48:51], v[24:27]
  v_mfma_f32_16x16x32_bf16 v[80:83], a[104:107], a[52:55], v[80:83]
  buffer_load_dwordx4 v227, s[8:11], s17 offen offset:2048 lds
  v_mfma_f32_16x16x32_bf16 v[136:139], a[104:107], a[56:59], v[136:139]
  v_mfma_f32_16x16x32_bf16 v[192:195], a[104:107], a[60:63], v[192:195]
  s_waitcnt lgkmcnt(4)
  v_mfma_f32_16x16x32_bf16 v[44:47], a[108:111], a[48:51], v[44:47]
  v_mfma_f32_16x16x32_bf16 v[100:103], a[108:111], a[52:55], v[100:103]
  buffer_load_dwordx4 v228, s[8:11], s17 offen offset:3072 lds
  s_add_u32 s17, s17, 458752
  s_cmp_eq_u32 s17, s93
  s_cselect_b32 s17, s95, s17
  v_mfma_f32_16x16x32_bf16 v[156:159], a[108:111], a[56:59], v[156:159]
  v_mfma_f32_16x16x32_bf16 v[212:215], a[108:111], a[60:63], v[212:215]
  s_waitcnt lgkmcnt(2)
  v_mfma_f32_16x16x32_bf16 v[48:51], a[112:115], a[48:51], v[48:51]
  v_mfma_f32_16x16x32_bf16 v[104:107], a[112:115], a[52:55], v[104:107]
  v_mfma_f32_16x16x32_bf16 v[160:163], a[112:115], a[56:59], v[160:163]
  v_mfma_f32_16x16x32_bf16 v[216:219], a[112:115], a[60:63], v[216:219]
  s_waitcnt lgkmcnt(0)
  v_mfma_f32_16x16x32_bf16 v[52:55], a[116:119], a[48:51], v[52:55]
  v_mfma_f32_16x16x32_bf16 v[108:111], a[116:119], a[52:55], v[108:111]
  v_mfma_f32_16x16x32_bf16 v[164:167], a[116:119], a[56:59], v[164:167]
  v_mfma_f32_16x16x32_bf16 v[220:223], a[116:119], a[60:63], v[220:223]
  s_nop 7
  s_nop 1
L_k56_seam:
  v_pk_mul_f32 v[232:233], v[0:1], s[42:43]
  v_pk_mul_f32 v[234:235], v[2:3], s[42:43]
  v_exp_f32 v232, v232
  v_exp_f32 v233, v233
  v_exp_f32 v234, v234
  v_exp_f32 v235, v235
  v_pk_add_f32 v[232:233], v[232:233], s[62:63]
  v_pk_add_f32 v[234:235], v[234:235], s[62:63]
  v_rcp_f32 v232, v232
  v_rcp_f32 v233, v233
  v_rcp_f32 v234, v234
  v_rcp_f32 v235, v235
  v_pk_mul_f32 v[232:233], v[232:233], v[28:29]
  v_pk_mul_f32 v[234:235], v[234:235], v[30:31]
  v_cvt_pk_bf16_f32 v0, v232, v233
  v_cvt_pk_bf16_f32 v1, v234, v235
  v_pk_mul_f32 v[236:237], v[4:5], s[42:43]
  v_pk_mul_f32 v[238:239], v[6:7], s[42:43]
  v_exp_f32 v236, v236
  v_exp_f32 v237, v237
  v_exp_f32 v238, v238
  v_exp_f32 v239, v239
  v_pk_add_f32 v[236:237], v[236:237], s[62:63]
  v_pk_add_f32 v[238:239], v[238:239], s[62:63]
  v_rcp_f32 v236, v236
  v_rcp_f32 v237, v237
  v_rcp_f32 v238, v238
  v_rcp_f32 v239, v239
  v_pk_mul_f32 v[236:237], v[236:237], v[32:33]
  v_pk_mul_f32 v[238:239], v[238:239], v[34:35]
  v_cvt_pk_bf16_f32 v2, v236, v237
  v_cvt_pk_bf16_f32 v3, v238, v239
  buffer_store_dwordx4 v[0:3], v224, s[12:15], s98 offen offset:0 sc1
  v_pk_mul_f32 v[232:233], v[56:57], s[42:43]
  v_pk_mul_f32 v[234:235], v[58:59], s[42:43]
  v_exp_f32 v232, v232
  v_exp_f32 v233, v233
  v_exp_f32 v234, v234
  v_exp_f32 v235, v235
  v_pk_add_f32 v[232:233], v[232:233], s[62:63]
  v_pk_add_f32 v[234:235], v[234:235], s[62:63]
  v_rcp_f32 v232, v232
  v_rcp_f32 v233, v233
  v_rcp_f32 v234, v234
  v_rcp_f32 v235, v235
  v_pk_mul_f32 v[232:233], v[232:233], v[84:85]
  v_pk_mul_f32 v[234:235], v[234:235], v[86:87]
  v_cvt_pk_bf16_f32 v56, v232, v233
  v_cvt_pk_bf16_f32 v57, v234, v235
  v_pk_mul_f32 v[236:237], v[60:61], s[42:43]
  v_pk_mul_f32 v[238:239], v[62:63], s[42:43]
  v_exp_f32 v236, v236
  v_exp_f32 v237, v237
  v_exp_f32 v238, v238
  v_exp_f32 v239, v239
  v_pk_add_f32 v[236:237], v[236:237], s[62:63]
  v_pk_add_f32 v[238:239], v[238:239], s[62:63]
  v_rcp_f32 v236, v236
  v_rcp_f32 v237, v237
  v_rcp_f32 v238, v238
  v_rcp_f32 v239, v239
  v_pk_mul_f32 v[236:237], v[236:237], v[88:89]
  v_pk_mul_f32 v[238:239], v[238:239], v[90:91]
  v_cvt_pk_bf16_f32 v58, v236, v237
  v_cvt_pk_bf16_f32 v59, v238, v239
  buffer_store_dwordx4 v[56:59], v224, s[12:15], s98 offen offset:1024 sc1
  v_pk_mul_f32 v[232:233], v[112:113], s[42:43]
  v_pk_mul_f32 v[234:235], v[114:115], s[42:43]
  v_exp_f32 v232, v232
  v_exp_f32 v233, v233
  v_exp_f32 v234, v234
  v_exp_f32 v235, v235
  v_pk_add_f32 v[232:233], v[232:233], s[62:63]
  v_pk_add_f32 v[234:235], v[234:235], s[62:63]
  v_rcp_f32 v232, v232
  v_rcp_f32 v233, v233
  v_rcp_f32 v234, v234
  v_rcp_f32 v235, v235
  v_pk_mul_f32 v[232:233], v[232:233], v[140:141]
  v_pk_mul_f32 v[234:235], v[234:235], v[142:143]
  v_cvt_pk_bf16_f32 v112, v232, v233
  v_cvt_pk_bf16_f32 v113, v234, v235
  v_pk_mul_f32 v[236:237], v[116:117], s[42:43]
  v_pk_mul_f32 v[238:239], v[118:119], s[42:43]
  v_exp_f32 v236, v236
  v_exp_f32 v237, v237
  v_exp_f32 v238, v238
  v_exp_f32 v239, v239
  v_pk_add_f32 v[236:237], v[236:237], s[62:63]
  v_pk_add_f32 v[238:239], v[238:239], s[62:63]
  v_rcp_f32 v236, v236
  v_rcp_f32 v237, v237
  v_rcp_f32 v238, v238
  v_rcp_f32 v239, v239
  v_pk_mul_f32 v[236:237], v[236:237], v[144:145]
  v_pk_mul_f32 v[238:239], v[238:239], v[146:147]
  v_cvt_pk_bf16_f32 v114, v236, v237
  v_cvt_pk_bf16_f32 v115, v238, v239
  buffer_store_dwordx4 v[112:115], v224, s[12:15], s98 offen offset:2048 sc1
  v_pk_mul_f32 v[232:233], v[168:169], s[42:43]
  v_pk_mul_f32 v[234:235], v[170:171], s[42:43]
  v_exp_f32 v232, v232
  v_exp_f32 v233, v233
  v_exp_f32 v234, v234
  v_exp_f32 v235, v235
  v_pk_add_f32 v[232:233], v[232:233], s[62:63]
  v_pk_add_f32 v[234:235], v[234:235], s[62:63]
  v_rcp_f32 v232, v232
  v_rcp_f32 v233, v233
  v_rcp_f32 v234, v234
  v_rcp_f32 v235, v235
  v_pk_mul_f32 v[232:233], v[232:233], v[196:197]
  v_pk_mul_f32 v[234:235], v[234:235], v[198:199]
  v_cvt_pk_bf16_f32 v168, v232, v233
  v_cvt_pk_bf16_f32 v169, v234, v235
  v_pk_mul_f32 v[236:237], v[172:173], s[42:43]
  v_pk_mul_f32 v[238:239], v[174:175], s[42:43]
  v_exp_f32 v236, v236
  v_exp_f32 v237, v237
  v_exp_f32 v238, v238
  v_exp_f32 v239, v239
  v_pk_add_f32 v[236:237], v[236:237], s[62:63]
  v_pk_add_f32 v[238:239], v[238:239], s[62:63]
  v_rcp_f32 v236, v236
  v_rcp_f32 v237, v237
  v_rcp_f32 v238, v238
  v_rcp_f32 v239, v239
  v_pk_mul_f32 v[236:237], v[236:237], v[200:201]
  v_pk_mul_f32 v[238:239], v[238:239], v[202:203]
  v_cvt_pk_bf16_f32 v170, v236, v237
  v_cvt_pk_bf16_f32 v171, v238, v239
  buffer_store_dwordx4 v[168:171], v224, s[12:15], s98 offen offset:3072 sc1
  v_pk_mul_f32 v[232:233], v[8:9], s[42:43]
  v_pk_mul_f32 v[234:235], v[10:11], s[42:43]
  v_exp_f32 v232, v232
  v_exp_f32 v233, v233
  v_exp_f32 v234, v234
  v_exp_f32 v235, v235
  v_pk_add_f32 v[232:233], v[232:233], s[62:63]
  v_pk_add_f32 v[234:235], v[234:235], s[62:63]
  v_rcp_f32 v232, v232
  v_rcp_f32 v233, v233
  v_rcp_f32 v234, v234
  v_rcp_f32 v235, v235
  v_pk_mul_f32 v[232:233], v[232:233], v[36:37]
  v_pk_mul_f32 v[234:235], v[234:235], v[38:39]
  v_cvt_pk_bf16_f32 v4, v232, v233
  v_cvt_pk_bf16_f32 v5, v234, v235
  v_pk_mul_f32 v[236:237], v[12:13], s[42:43]
  v_pk_mul_f32 v[238:239], v[14:15], s[42:43]
  v_exp_f32 v236, v236
  v_exp_f32 v237, v237
  v_exp_f32 v238, v238
  v_exp_f32 v239, v239
  v_pk_add_f32 v[236:237], v[236:237], s[62:63]
  v_pk_add_f32 v[238:239], v[238:239], s[62:63]
  v_rcp_f32 v236, v236
  v_rcp_f32 v237, v237
  v_rcp_f32 v238, v238
  v_rcp_f32 v239, v239
  v_pk_mul_f32 v[236:237], v[236:237], v[40:41]
  v_pk_mul_f32 v[238:239], v[238:239], v[42:43]
  v_cvt_pk_bf16_f32 v6, v236, v237
  v_cvt_pk_bf16_f32 v7, v238, v239
  v_pk_mul_f32 v[232:233], v[64:65], s[42:43]
  v_pk_mul_f32 v[234:235], v[66:67], s[42:43]
  v_exp_f32 v232, v232
  v_exp_f32 v233, v233
  v_exp_f32 v234, v234
  v_exp_f32 v235, v235
  v_pk_add_f32 v[232:233], v[232:233], s[62:63]
  v_pk_add_f32 v[234:235], v[234:235], s[62:63]
  v_rcp_f32 v232, v232
  v_rcp_f32 v233, v233
  v_rcp_f32 v234, v234
  v_rcp_f32 v235, v235
  v_pk_mul_f32 v[232:233], v[232:233], v[92:93]
  v_pk_mul_f32 v[234:235], v[234:235], v[94:95]
  v_cvt_pk_bf16_f32 v60, v232, v233
  v_cvt_pk_bf16_f32 v61, v234, v235
  v_pk_mul_f32 v[236:237], v[68:69], s[42:43]
  v_pk_mul_f32 v[238:239], v[70:71], s[42:43]
  v_exp_f32 v236, v236
  v_exp_f32 v237, v237
  v_exp_f32 v238, v238
  v_exp_f32 v239, v239
  v_pk_add_f32 v[236:237], v[236:237], s[62:63]
  v_pk_add_f32 v[238:239], v[238:239], s[62:63]
  v_rcp_f32 v236, v236
  v_rcp_f32 v237, v237
  v_rcp_f32 v238, v238
  v_rcp_f32 v239, v239
  v_pk_mul_f32 v[236:237], v[236:237], v[96:97]
  v_pk_mul_f32 v[238:239], v[238:239], v[98:99]
  v_cvt_pk_bf16_f32 v62, v236, v237
  v_cvt_pk_bf16_f32 v63, v238, v239
  v_pk_mul_f32 v[232:233], v[120:121], s[42:43]
  v_pk_mul_f32 v[234:235], v[122:123], s[42:43]
  v_exp_f32 v232, v232
  v_exp_f32 v233, v233
  v_exp_f32 v234, v234
  v_exp_f32 v235, v235
  v_pk_add_f32 v[232:233], v[232:233], s[62:63]
  v_pk_add_f32 v[234:235], v[234:235], s[62:63]
  v_rcp_f32 v232, v232
  v_rcp_f32 v233, v233
  v_rcp_f32 v234, v234
  v_rcp_f32 v235, v235
  v_pk_mul_f32 v[232:233], v[232:233], v[148:149]
  v_pk_mul_f32 v[234:235], v[234:235], v[150:151]
  v_cvt_pk_bf16_f32 v116, v232, v233
  v_cvt_pk_bf16_f32 v117, v234, v235
  v_pk_mul_f32 v[236:237], v[124:125], s[42:43]
  v_pk_mul_f32 v[238:239], v[126:127], s[42:43]
  v_exp_f32 v236, v236
  v_exp_f32 v237, v237
  v_exp_f32 v238, v238
  v_exp_f32 v239, v239
  v_pk_add_f32 v[236:237], v[236:237], s[62:63]
  v_pk_add_f32 v[238:239], v[238:239], s[62:63]
  v_rcp_f32 v236, v236
  v_rcp_f32 v237, v237
  v_rcp_f32 v238, v238
  v_rcp_f32 v239, v239
  v_pk_mul_f32 v[236:237], v[236:237], v[152:153]
  v_pk_mul_f32 v[238:239], v[238:239], v[154:155]
  v_cvt_pk_bf16_f32 v118, v236, v237
  v_cvt_pk_bf16_f32 v119, v238, v239
  s_waitcnt vmcnt(0)
  s_mov_b64 exec, 1
  buffer_store_dword v248, v250, s[56:59], s92 offen sc1
  s_mov_b64 exec, -1
  s_add_u32 s92, s92, 65536
  s_barrier
  v_pk_mul_f32 v[232:233], v[176:177], s[42:43]
  v_pk_mul_f32 v[234:235], v[178:179], s[42:43]
  v_exp_f32 v232, v232
  v_exp_f32 v233, v233
  v_exp_f32 v234, v234
  v_exp_f32 v235, v235
  v_pk_add_f32 v[232:233], v[232:233], s[62:63]
  v_pk_add_f32 v[234:235], v[234:235], s[62:63]
  s_add_u32 m0, s38, 98304
  s_nop 0
  buffer_load_dwordx4 v225, s[8:11], s17 offen lds
  v_rcp_f32 v232, v232
  v_rcp_f32 v233, v233
  v_rcp_f32 v234, v234
  v_rcp_f32 v235, v235
  v_pk_mul_f32 v[232:233], v[232:233], v[204:205]
  v_pk_mul_f32 v[234:235], v[234:235], v[206:207]
  v_cvt_pk_bf16_f32 v172, v232, v233
  v_cvt_pk_bf16_f32 v173, v234, v235
  buffer_load_dwordx4 v226, s[8:11], s17 offen offset:1024 lds
  v_pk_mul_f32 v[236:237], v[180:181], s[42:43]
  v_pk_mul_f32 v[238:239], v[182:183], s[42:43]
  v_exp_f32 v236, v236
  v_exp_f32 v237, v237
  v_exp_f32 v238, v238
  v_exp_f32 v239, v239
  v_pk_add_f32 v[236:237], v[236:237], s[62:63]
  v_pk_add_f32 v[238:239], v[238:239], s[62:63]
  buffer_load_dwordx4 v227, s[8:11], s17 offen offset:2048 lds
  v_rcp_f32 v236, v236
  v_rcp_f32 v237, v237
  v_rcp_f32 v238, v238
  v_rcp_f32 v239, v239
  v_pk_mul_f32 v[236:237], v[236:237], v[208:209]
  v_pk_mul_f32 v[238:239], v[238:239], v[210:211]
  v_cvt_pk_bf16_f32 v174, v236, v237
  v_cvt_pk_bf16_f32 v175, v238, v239
  buffer_load_dwordx4 v228, s[8:11], s17 offen offset:3072 lds
  s_add_u32 s17, s17, 458752
  s_cmp_eq_u32 s17, s93
  s_cselect_b32 s17, s95, s17
  v_pk_mul_f32 v[232:233], v[16:17], s[42:43]
  v_pk_mul_f32 v[234:235], v[18:19], s[42:43]
  v_exp_f32 v232, v232
  v_exp_f32 v233, v233
  v_exp_f32 v234, v234
  v_exp_f32 v235, v235
  v_pk_add_f32 v[232:233], v[232:233], s[62:63]
  v_pk_add_f32 v[234:235], v[234:235], s[62:63]
  s_add_u32 m0, s38, 114688
  s_nop 0
  buffer_load_dwordx4 v225, s[8:11], s17 offen lds
  v_rcp_f32 v232, v232
  v_rcp_f32 v233, v233
  v_rcp_f32 v234, v234
  v_rcp_f32 v235, v235
  v_pk_mul_f32 v[232:233], v[232:233], v[44:45]
  v_pk_mul_f32 v[234:235], v[234:235], v[46:47]
  v_cvt_pk_bf16_f32 v8, v232, v233
  v_cvt_pk_bf16_f32 v9, v234, v235
  buffer_load_dwordx4 v226, s[8:11], s17 offen offset:1024 lds
  v_pk_mul_f32 v[236:237], v[20:21], s[42:43]
  v_pk_mul_f32 v[238:239], v[22:23], s[42:43]
  v_exp_f32 v236, v236
  v_exp_f32 v237, v237
  v_exp_f32 v238, v238
  v_exp_f32 v239, v239
  v_pk_add_f32 v[236:237], v[236:237], s[62:63]
  v_pk_add_f32 v[238:239], v[238:239], s[62:63]
  buffer_load_dwordx4 v227, s[8:11], s17 offen offset:2048 lds
  v_rcp_f32 v236, v236
  v_rcp_f32 v237, v237
  v_rcp_f32 v238, v238
  v_rcp_f32 v239, v239
  v_pk_mul_f32 v[236:237], v[236:237], v[48:49]
  v_pk_mul_f32 v[238:239], v[238:239], v[50:51]
  v_cvt_pk_bf16_f32 v10, v236, v237
  v_cvt_pk_bf16_f32 v11, v238, v239
  buffer_load_dwordx4 v228, s[8:11], s17 offen offset:3072 lds
  s_add_u32 s17, s17, 458752
  s_cmp_eq_u32 s17, s93
  s_cselect_b32 s17, s95, s17
  s_add_u32 s17, s17, 65536
  s_add_u32 s93, s93, 65536
  s_add_u32 s95, s95, 65536
  v_pk_mul_f32 v[232:233], v[72:73], s[42:43]
  v_pk_mul_f32 v[234:235], v[74:75], s[42:43]
  v_exp_f32 v232, v232
  v_exp_f32 v233, v233
  v_exp_f32 v234, v234
  v_exp_f32 v235, v235
  v_pk_add_f32 v[232:233], v[232:233], s[62:63]
  v_pk_add_f32 v[234:235], v[234:235], s[62:63]
  s_add_u32 m0, s38, 131072
  s_nop 0
  buffer_load_dwordx4 v225, s[8:11], s17 offen lds
  v_rcp_f32 v232, v232
  v_rcp_f32 v233, v233
  v_rcp_f32 v234, v234
  v_rcp_f32 v235, v235
  v_pk_mul_f32 v[232:233], v[232:233], v[100:101]
  v_pk_mul_f32 v[234:235], v[234:235], v[102:103]
  v_cvt_pk_bf16_f32 v64, v232, v233
  v_cvt_pk_bf16_f32 v65, v234, v235
  buffer_load_dwordx4 v226, s[8:11], s17 offen offset:1024 lds
  v_pk_mul_f32 v[236:237], v[76:77], s[42:43]
  v_pk_mul_f32 v[238:239], v[78:79], s[42:43]
  v_exp_f32 v236, v236
  v_exp_f32 v237, v237
  v_exp_f32 v238, v238
  v_exp_f32 v239, v239
  v_pk_add_f32 v[236:237], v[236:237], s[62:63]
  v_pk_add_f32 v[238:239], v[238:239], s[62:63]
  buffer_load_dwordx4 v227, s[8:11], s17 offen offset:2048 lds
  v_rcp_f32 v236, v236
  v_rcp_f32 v237, v237
  v_rcp_f32 v238, v238
  v_rcp_f32 v239, v239
  v_pk_mul_f32 v[236:237], v[236:237], v[104:105]
  v_pk_mul_f32 v[238:239], v[238:239], v[106:107]
  v_cvt_pk_bf16_f32 v66, v236, v237
  v_cvt_pk_bf16_f32 v67, v238, v239
  buffer_load_dwordx4 v228, s[8:11], s17 offen offset:3072 lds
  s_add_u32 s17, s17, 458752
  s_cmp_eq_u32 s17, s93
  s_cselect_b32 s17, s95, s17
  v_pk_mul_f32 v[232:233], v[128:129], s[42:43]
  v_pk_mul_f32 v[234:235], v[130:131], s[42:43]
  v_exp_f32 v232, v232
  v_exp_f32 v233, v233
  v_exp_f32 v234, v234
  v_exp_f32 v235, v235
  v_pk_add_f32 v[232:233], v[232:233], s[62:63]
  v_pk_add_f32 v[234:235], v[234:235], s[62:63]
  v_rcp_f32 v232, v232
  v_rcp_f32 v233, v233
  v_rcp_f32 v234, v234
  v_rcp_f32 v235, v235
  v_pk_mul_f32 v[232:233], v[232:233], v[156:157]
  v_pk_mul_f32 v[234:235], v[234:235], v[158:159]
  v_cvt_pk_bf16_f32 v120, v232, v233
  v_cvt_pk_bf16_f32 v121, v234, v235
  v_pk_mul_f32 v[236:237], v[132:133], s[42:43]
  v_pk_mul_f32 v[238:239], v[134:135], s[42:43]
  v_exp_f32 v236, v236
  v_exp_f32 v237, v237
  v_exp_f32 v238, v238
  v_exp_f32 v239, v239
  v_pk_add_f32 v[236:237], v[236:237], s[62:63]
  v_pk_add_f32 v[238:239], v[238:239], s[62:63]
  v_rcp_f32 v236, v236
  v_rcp_f32 v237, v237
  v_rcp_f32 v238, v238
  v_rcp_f32 v239, v239
  v_pk_mul_f32 v[236:237], v[236:237], v[160:161]
  v_pk_mul_f32 v[238:239], v[238:239], v[162:163]
  v_cvt_pk_bf16_f32 v122, v236, v237
  v_cvt_pk_bf16_f32 v123, v238, v239
  v_pk_mul_f32 v[232:233], v[184:185], s[42:43]
  v_pk_mul_f32 v[234:235], v[186:187], s[42:43]
  v_exp_f32 v232, v232
  v_exp_f32 v233, v233
  v_exp_f32 v234, v234
  v_exp_f32 v235, v235
  v_pk_add_f32 v[232:233], v[232:233], s[62:63]
  v_pk_add_f32 v[234:235], v[234:235], s[62:63]
  v_rcp_f32 v232, v232
  v_rcp_f32 v233, v233
  v_rcp_f32 v234, v234
  v_rcp_f32 v235, v235
  v_pk_mul_f32 v[232:233], v[232:233], v[212:213]
  v_pk_mul_f32 v[234:235], v[234:235], v[214:215]
  v_cvt_pk_bf16_f32 v176, v232, v233
  v_cvt_pk_bf16_f32 v177, v234, v235
  v_pk_mul_f32 v[236:237], v[188:189], s[42:43]
  v_pk_mul_f32 v[238:239], v[190:191], s[42:43]
  v_exp_f32 v236, v236
  v_exp_f32 v237, v237
  v_exp_f32 v238, v238
  v_exp_f32 v239, v239
  v_pk_add_f32 v[236:237], v[236:237], s[62:63]
  v_pk_add_f32 v[238:239], v[238:239], s[62:63]
  v_rcp_f32 v236, v236
  v_rcp_f32 v237, v237
  v_rcp_f32 v238, v238
  v_rcp_f32 v239, v239
  v_pk_mul_f32 v[236:237], v[236:237], v[216:217]
  v_pk_mul_f32 v[238:239], v[238:239], v[218:219]
  v_cvt_pk_bf16_f32 v178, v236, v237
  v_cvt_pk_bf16_f32 v179, v238, v239
  buffer_load_dword v247, v246, s[56:59], s94 offen sc1
  buffer_store_dwordx4 v[4:7], v224, s[12:15], s99 offen offset:0 sc1
  buffer_store_dwordx4 v[60:63], v224, s[12:15], s99 offen offset:1024 sc1
  buffer_store_dwordx4 v[116:119], v224, s[12:15], s99 offen offset:2048 sc1
  buffer_store_dwordx4 v[172:175], v224, s[12:15], s99 offen offset:3072 sc1
  v_pk_mul_f32 v[232:233], v[24:25], s[42:43]
  v_pk_mul_f32 v[234:235], v[26:27], s[42:43]
  v_exp_f32 v232, v232
  v_exp_f32 v233, v233
  v_exp_f32 v234, v234
  v_exp_f32 v235, v235
  v_pk_add_f32 v[232:233], v[232:233], s[62:63]
  v_pk_add_f32 v[234:235], v[234:235], s[62:63]
  v_rcp_f32 v232, v232
  v_rcp_f32 v233, v233
  v_rcp_f32 v234, v234
  v_rcp_f32 v235, v235
  v_pk_mul_f32 v[232:233], v[232:233], v[52:53]
  v_pk_mul_f32 v[234:235], v[234:235], v[54:55]
  v_cvt_pk_bf16_f32 v12, v232, v233
  v_cvt_pk_bf16_f32 v13, v234, v235
  v_pk_mul_f32 v[236:237], v[80:81], s[42:43]
  v_pk_mul_f32 v[238:239], v[82:83], s[42:43]
  v_exp_f32 v236, v236
  v_exp_f32 v237, v237
  v_exp_f32 v238, v238
  v_exp_f32 v239, v239
  v_pk_add_f32 v[236:237], v[236:237], s[62:63]
  v_pk_add_f32 v[238:239], v[238:239], s[62:63]
  v_rcp_f32 v236, v236
  v_rcp_f32 v237, v237
  v_rcp_f32 v238, v238
  v_rcp_f32 v239, v239
  v_pk_mul_f32 v[236:237], v[236:237], v[108:109]
  v_pk_mul_f32 v[238:239], v[238:239], v[110:111]
  v_cvt_pk_bf16_f32 v14, v236, v237
  v_cvt_pk_bf16_f32 v15, v238, v239
  v_pk_mul_f32 v[232:233], v[136:137], s[42:43]
  v_pk_mul_f32 v[234:235], v[138:139], s[42:43]
  v_exp_f32 v232, v232
  v_exp_f32 v233, v233
  v_exp_f32 v234, v234
  v_exp_f32 v235, v235
  v_pk_add_f32 v[232:233], v[232:233], s[62:63]
  v_pk_add_f32 v[234:235], v[234:235], s[62:63]
  v_rcp_f32 v232, v232
  v_rcp_f32 v233, v233
  v_rcp_f32 v234, v234
  v_rcp_f32 v235, v235
  v_pk_mul_f32 v[232:233], v[232:233], v[164:165]
  v_pk_mul_f32 v[234:235], v[234:235], v[166:167]
  v_cvt_pk_bf16_f32 v124, v232, v233
  v_cvt_pk_bf16_f32 v125, v234, v235
  v_pk_mul_f32 v[236:237], v[192:193], s[42:43]
  v_pk_mul_f32 v[238:239], v[194:195], s[42:43]
  v_exp_f32 v236, v236
  v_exp_f32 v237, v237
  v_exp_f32 v238, v238
  v_exp_f32 v239, v239
  v_pk_add_f32 v[236:237], v[236:237], s[62:63]
  v_pk_add_f32 v[238:239], v[238:239], s[62:63]
  v_rcp_f32 v236, v236
  v_rcp_f32 v237, v237
  v_rcp_f32 v238, v238
  v_rcp_f32 v239, v239
  v_pk_mul_f32 v[236:237], v[236:237], v[220:221]
  v_pk_mul_f32 v[238:239], v[238:239], v[222:223]
  v_cvt_pk_bf16_f32 v126, v236, v237
  v_cvt_pk_bf16_f32 v127, v238, v239
  s_waitcnt vmcnt(4)
  v_cmp_ne_u32 vcc, s19, v247
  s_nop 1
  s_cmp_lg_u64 vcc, 0
  s_cbranch_scc1 L_slow_25
  L_back_26:
  s_add_u32 s94, s94, 65536
  buffer_load_dwordx4 a[0:3], v240, s[4:7], s16 offen offset:0 sc1
  buffer_load_dwordx4 a[4:7], v240, s[4:7], s16 offen offset:1024 sc1
  buffer_load_dwordx4 a[8:11], v241, s[4:7], s16 offen offset:0 sc1
  buffer_load_dwordx4 a[12:15], v241, s[4:7], s16 offen offset:1024 sc1
  s_add_u32 s41, s41, 262144
  s_bitset0_b32 s41, 21
  s_add_u32 s16, s40, s41
  buffer_load_dwordx4 a[16:19], v240, s[4:7], s16 offen offset:0 sc1
  buffer_load_dwordx4 a[20:23], v240, s[4:7], s16 offen offset:1024 sc1
  buffer_load_dwordx4 a[24:27], v241, s[4:7], s16 offen offset:0 sc1
  buffer_load_dwordx4 a[28:31], v241, s[4:7], s16 offen offset:1024 sc1
  s_add_u32 s41, s41, 262144
  s_bitset0_b32 s41, 21
  s_add_u32 s16, s40, s41
  buffer_load_dwordx4 a[32:35], v240, s[4:7], s16 offen offset:0 sc1
  buffer_load_dwordx4 a[36:39], v240, s[4:7], s16 offen offset:1024 sc1
  buffer_load_dwordx4 a[40:43], v241, s[4:7], s16 offen offset:0 sc1
  buffer_load_dwordx4 a[44:47], v241, s[4:7], s16 offen offset:1024 sc1
  s_add_u32 s41, s41, 262144
  s_bitset0_b32 s41, 21
  s_add_u32 s16, s40, s41
  v_add_u32 v104, 65536, v242
  v_add_u32 v105, 65536, v243
  v_add_u32 v106, 65536, v244
  v_add_u32 v107, 65536, v245
  s_waitcnt vmcnt(54)
  s_barrier
  ds_read_b64_tr_b16 a[80:81], v242 offset:2048
  ds_read_b64_tr_b16 a[82:83], v242 offset:6144
  ds_read_b64_tr_b16 a[84:85], v243 offset:2048
  ds_read_b64_tr_b16 a[86:87], v243 offset:6144
  ds_read_b64_tr_b16 a[88:89], v244 offset:2048
  ds_read_b64_tr_b16 a[90:91], v244 offset:6144
  ds_read_b64_tr_b16 a[92:93], v245 offset:2048
  ds_read_b64_tr_b16 a[94:95], v245 offset:6144
  ds_read_b64_tr_b16 a[112:113], v242 offset:10240
  ds_read_b64_tr_b16 a[114:115], v242 offset:14336
  ds_read_b64_tr_b16 a[116:117], v243 offset:10240
  ds_read_b64_tr_b16 a[118:119], v243 offset:14336
  ds_read_b64_tr_b16 a[120:121], v244 offset:10240
  ds_read_b64_tr_b16 a[122:123], v244 offset:14336
  ds_read_b64_tr_b16 a[124:125], v245 offset:10240
  ds_read_b64_tr_b16 a[126:127], v245 offset:14336
  ds_read_b64_tr_b16 a[64:65], v242 offset:0
  ds_read_b64_tr_b16 a[66:67], v242 offset:4096
  ds_read_b64_tr_b16 a[68:69], v243 offset:0
  ds_read_b64_tr_b16 a[70:71], v243 offset:4096
  ds_read_b64_tr_b16 a[72:73], v244 offset:0
  ds_read_b64_tr_b16 a[74:75], v244 offset:4096
  ds_read_b64_tr_b16 a[76:77], v245 offset:0
  ds_read_b64_tr_b16 a[78:79], v245 offset:4096
  ds_read_b64_tr_b16 a[96:97], v242 offset:8192
  ds_read_b64_tr_b16 a[98:99], v242 offset:12288
  ds_read_b64_tr_b16 a[100:101], v243 offset:8192
  ds_read_b64_tr_b16 a[102:103], v243 offset:12288
  ds_read_b64_tr_b16 a[104:105], v244 offset:8192
  ds_read_b64_tr_b16 a[106:107], v244 offset:12288
  ds_read_b64_tr_b16 a[108:109], v245 offset:8192
  ds_read_b64_tr_b16 a[110:111], v245 offset:12288
  s_waitcnt vmcnt(8) lgkmcnt(10)
  s_barrier
  s_mov_b64 exec, 1
  buffer_store_dword v248, v250, s[56:59], s92 offen sc1
  s_mov_b64 exec, -1
  s_add_u32 s92, s92, 65536
  v_mfma_f32_16x16x32_bf16 v[72:75], a[80:83], a[0:3], 0
  buffer_load_dwordx4 a[48:51], v240, s[4:7], s16 offen offset:0 sc1
  v_mfma_f32_16x16x32_bf16 v[88:91], a[80:83], a[4:7], 0
  ds_read_b64_tr_b16 a[80:81], v242 offset:18432
  ds_read_b64_tr_b16 a[82:83], v242 offset:22528
  v_mfma_f32_16x16x32_bf16 v[76:79], a[84:87], a[0:3], 0
  v_mfma_f32_16x16x32_bf16 v[92:95], a[84:87], a[4:7], 0
  ds_read_b64_tr_b16 a[84:85], v243 offset:18432
  ds_read_b64_tr_b16 a[86:87], v243 offset:22528
  v_mfma_f32_16x16x32_bf16 v[80:83], a[88:91], a[0:3], 0
  v_mfma_f32_16x16x32_bf16 v[96:99], a[88:91], a[4:7], 0
  buffer_load_dwordx4 a[52:55], v240, s[4:7], s16 offen offset:1024 sc1
  v_mfma_f32_16x16x32_bf16 v[84:87], a[92:95], a[0:3], 0
  ds_read_b64_tr_b16 a[88:89], v244 offset:18432
  ds_read_b64_tr_b16 a[90:91], v244 offset:22528
  v_mfma_f32_16x16x32_bf16 v[100:103], a[92:95], a[4:7], 0
  ds_read_b64_tr_b16 a[92:93], v245 offset:18432
  ds_read_b64_tr_b16 a[94:95], v245 offset:22528
  v_mfma_f32_16x16x32_bf16 v[72:75], a[112:115], a[8:11], v[72:75]
  v_mfma_f32_16x16x32_bf16 v[88:91], a[112:115], a[12:15], v[88:91]
  ds_read_b64_tr_b16 a[112:113], v242 offset:26624
  ds_read_b64_tr_b16 a[114:115], v242 offset:30720
  v_mfma_f32_16x16x32_bf16 v[76:79], a[116:119], a[8:11], v[76:79]
  buffer_load_dwordx4 a[56:59], v241, s[4:7], s16 offen offset:0 sc1
  v_mfma_f32_16x16x32_bf16 v[92:95], a[116:119], a[12:15], v[92:95]
  ds_read_b64_tr_b16 a[116:117], v243 offset:26624
  ds_read_b64_tr_b16 a[118:119], v243 offset:30720
  v_mfma_f32_16x16x32_bf16 v[80:83], a[120:123], a[8:11], v[80:83]
  v_mfma_f32_16x16x32_bf16 v[96:99], a[120:123], a[12:15], v[96:99]
  ds_read_b64_tr_b16 a[120:121], v244 offset:26624
  ds_read_b64_tr_b16 a[122:123], v244 offset:30720
  v_mfma_f32_16x16x32_bf16 v[84:87], a[124:127], a[8:11], v[84:87]
  v_mfma_f32_16x16x32_bf16 v[100:103], a[124:127], a[12:15], v[100:103]
  buffer_load_dwordx4 a[60:63], v241, s[4:7], s16 offen offset:1024 sc1
  v_mfma_f32_16x16x32_bf16 v[16:19], a[64:67], a[0:3], 0
  ds_read_b64_tr_b16 a[124:125], v245 offset:26624
  s_add_u32 s41, s41, 262144
  v_mfma_f32_16x16x32_bf16 v[32:35], a[64:67], a[4:7], 0
  ds_read_b64_tr_b16 a[126:127], v245 offset:30720
  s_bitset0_b32 s41, 21
  v_mfma_f32_16x16x32_bf16 v[20:23], a[68:71], a[0:3], 0
  ds_read_b64_tr_b16 a[64:65], v242 offset:16384
  s_add_u32 s16, s40, s41
  v_mfma_f32_16x16x32_bf16 v[36:39], a[68:71], a[4:7], 0
  ds_read_b64_tr_b16 a[66:67], v242 offset:20480
  ds_read_b64_tr_b16 a[68:69], v243 offset:16384
  v_mfma_f32_16x16x32_bf16 v[24:27], a[72:75], a[0:3], 0
  buffer_store_dwordx4 v[8:11], v224, s[12:15], s100 offen offset:0 sc1
  v_mfma_f32_16x16x32_bf16 v[40:43], a[72:75], a[4:7], 0
  ds_read_b64_tr_b16 a[70:71], v243 offset:20480
  ds_read_b64_tr_b16 a[72:73], v244 offset:16384
  s_waitcnt lgkmcnt(10)
  v_mfma_f32_16x16x32_bf16 v[28:31], a[76:79], a[0:3], 0
  ds_read_b64_tr_b16 a[74:75], v244 offset:20480
  v_mfma_f32_16x16x32_bf16 v[44:47], a[76:79], a[4:7], 0
  ds_read_b64_tr_b16 a[76:77], v245 offset:16384
  ds_read_b64_tr_b16 a[78:79], v245 offset:20480
  v_mfma_f32_16x16x32_bf16 v[16:19], a[96:99], a[8:11], v[16:19]
  v_mfma_f32_16x16x32_bf16 v[32:35], a[96:99], a[12:15], v[32:35]
  buffer_store_dwordx4 v[64:67], v224, s[12:15], s100 offen offset:1024 sc1
  v_mfma_f32_16x16x32_bf16 v[20:23], a[100:103], a[8:11], v[20:23]
  ds_read_b64_tr_b16 a[96:97], v242 offset:24576
  ds_read_b64_tr_b16 a[98:99], v242 offset:28672
  v_mfma_f32_16x16x32_bf16 v[36:39], a[100:103], a[12:15], v[36:39]
  ds_read_b64_tr_b16 a[100:101], v243 offset:24576
  ds_read_b64_tr_b16 a[102:103], v243 offset:28672
  v_mfma_f32_16x16x32_bf16 v[24:27], a[104:107], a[8:11], v[24:27]
  v_mfma_f32_16x16x32_bf16 v[40:43], a[104:107], a[12:15], v[40:43]
  ds_read_b64_tr_b16 a[104:105], v244 offset:24576
  ds_read_b64_tr_b16 a[106:107], v244 offset:28672
  v_mfma_f32_16x16x32_bf16 v[28:31], a[108:111], a[8:11], v[28:31]
  v_mfma_f32_16x16x32_bf16 v[44:47], a[108:111], a[12:15], v[44:47]
  s_waitcnt vmcnt(11) lgkmcnt(10)
  s_barrier
  v_mfma_f32_16x16x32_bf16 v[72:75], a[80:83], a[16:19], v[72:75]
  buffer_load_dwordx4 a[0:3], v240, s[4:7], s16 offen offset:0 sc1
  v_mfma_f32_16x16x32_bf16 v[88:91], a[80:83], a[20:23], v[88:91]
  ds_read_b64_tr_b16 a[108:109], v245 offset:24576
  ds_read_b64_tr_b16 a[110:111], v245 offset:28672
  v_mfma_f32_16x16x32_bf16 v[76:79], a[84:87], a[16:19], v[76:79]
  ds_read_b64_tr_b16 a[80:81], v242 offset:34816
  ds_read_b64_tr_b16 a[82:83], v242 offset:38912
  v_mfma_f32_16x16x32_bf16 v[92:95], a[84:87], a[20:23], v[92:95]
  ds_read_b64_tr_b16 a[84:85], v243 offset:34816
  ds_read_b64_tr_b16 a[86:87], v243 offset:38912
  v_mfma_f32_16x16x32_bf16 v[80:83], a[88:91], a[16:19], v[80:83]
  v_mfma_f32_16x16x32_bf16 v[96:99], a[88:91], a[20:23], v[96:99]
  buffer_load_dwordx4 a[4:7], v240, s[4:7], s16 offen offset:1024 sc1
  v_mfma_f32_16x16x32_bf16 v[84:87], a[92:95], a[16:19], v[84:87]
  ds_read_b64_tr_b16 a[88:89], v244 offset:34816
  ds_read_b64_tr_b16 a[90:91], v244 offset:38912
  v_mfma_f32_16x16x32_bf16 v[100:103], a[92:95], a[20:23], v[100:103]
  ds_read_b64_tr_b16 a[92:93], v245 offset:34816
  ds_read_b64_tr_b16 a[94:95], v245 offset:38912
  v_mfma_f32_16x16x32_bf16 v[72:75], a[112:115], a[24:27], v[72:75]
  v_mfma_f32_16x16x32_bf16 v[88:91], a[112:115], a[28:31], v[88:91]
  ds_read_b64_tr_b16 a[112:113], v242 offset:43008
  ds_read_b64_tr_b16 a[114:115], v242 offset:47104
  v_mfma_f32_16x16x32_bf16 v[76:79], a[116:119], a[24:27], v[76:79]
  buffer_load_dwordx4 a[8:11], v241, s[4:7], s16 offen offset:0 sc1
  v_mfma_f32_16x16x32_bf16 v[92:95], a[116:119], a[28:31], v[92:95]
  ds_read_b64_tr_b16 a[116:117], v243 offset:43008
  ds_read_b64_tr_b16 a[118:119], v243 offset:47104
  v_mfma_f32_16x16x32_bf16 v[80:83], a[120:123], a[24:27], v[80:83]
  v_mfma_f32_16x16x32_bf16 v[96:99], a[120:123], a[28:31], v[96:99]
  ds_read_b64_tr_b16 a[120:121], v244 offset:43008
  ds_read_b64_tr_b16 a[122:123], v244 offset:47104
  v_mfma_f32_16x16x32_bf16 v[84:87], a[124:127], a[24:27], v[84:87]
  v_mfma_f32_16x16x32_bf16 v[100:103], a[124:127], a[28:31], v[100:103]
  buffer_load_dwordx4 a[12:15], v241, s[4:7], s16 offen offset:1024 sc1
  v_mfma_f32_16x16x32_bf16 v[16:19], a[64:67], a[16:19], v[16:19]
  ds_read_b64_tr_b16 a[124:125], v245 offset:43008
  s_add_u32 s41, s41, 262144
  v_mfma_f32_16x16x32_bf16 v[32:35], a[64:67], a[20:23], v[32:35]
  ds_read_b64_tr_b16 a[126:127], v245 offset:47104
  s_bitset0_b32 s41, 21
  v_mfma_f32_16x16x32_bf16 v[20:23], a[68:71], a[16:19], v[20:23]
  ds_read_b64_tr_b16 a[64:65], v242 offset:32768
  s_add_u32 s16, s40, s41
  v_mfma_f32_16x16x32_bf16 v[36:39], a[68:71], a[20:23], v[36:39]
  ds_read_b64_tr_b16 a[66:67], v242 offset:36864
  ds_read_b64_tr_b16 a[68:69], v243 offset:32768
  s_waitcnt lgkmcnt(10)
  v_mfma_f32_16x16x32_bf16 v[24:27], a[72:75], a[16:19], v[24:27]
  buffer_store_dwordx4 v[120:123], v224, s[12:15], s100 offen offset:2048 sc1
  v_mfma_f32_16x16x32_bf16 v[40:43], a[72:75], a[20:23], v[40:43]
  ds_read_b64_tr_b16 a[70:71], v243 offset:36864
  ds_read_b64_tr_b16 a[72:73], v244 offset:32768
  v_mfma_f32_16x16x32_bf16 v[28:31], a[76:79], a[16:19], v[28:31]
  ds_read_b64_tr_b16 a[74:75], v244 offset:36864
  v_mfma_f32_16x16x32_bf16 v[44:47], a[76:79], a[20:23], v[44:47]
  ds_read_b64_tr_b16 a[76:77], v245 offset:32768
  ds_read_b64_tr_b16 a[78:79], v245 offset:36864
  v_mfma_f32_16x16x32_bf16 v[16:19], a[96:99], a[24:27], v[16:19]
  v_mfma_f32_16x16x32_bf16 v[32:35], a[96:99], a[28:31], v[32:35]
  buffer_store_dwordx4 v[176:179], v224, s[12:15], s100 offen offset:3072 sc1
  v_mfma_f32_16x16x32_bf16 v[20:23], a[100:103], a[24:27], v[20:23]
  ds_read_b64_tr_b16 a[96:97], v242 offset:40960
  ds_read_b64_tr_b16 a[98:99], v242 offset:45056
  v_mfma_f32_16x16x32_bf16 v[36:39], a[100:103], a[28:31], v[36:39]
  ds_read_b64_tr_b16 a[100:101], v243 offset:40960
  ds_read_b64_tr_b16 a[102:103], v243 offset:45056
  v_mfma_f32_16x16x32_bf16 v[24:27], a[104:107], a[24:27], v[24:27]
  v_mfma_f32_16x16x32_bf16 v[40:43], a[104:107], a[28:31], v[40:43]
  ds_read_b64_tr_b16 a[104:105], v244 offset:40960
  ds_read_b64_tr_b16 a[106:107], v244 offset:45056
  v_mfma_f32_16x16x32_bf16 v[28:31], a[108:111], a[24:27], v[28:31]
  v_mfma_f32_16x16x32_bf16 v[44:47], a[108:111], a[28:31], v[44:47]
  s_waitcnt vmcnt(13) lgkmcnt(10)
  s_barrier
  v_mfma_f32_16x16x32_bf16 v[72:75], a[80:83], a[32:35], v[72:75]
  buffer_load_dwordx4 a[16:19], v240, s[4:7], s16 offen offset:0 sc1
  v_mfma_f32_16x16x32_bf16 v[88:91], a[80:83], a[36:39], v[88:91]
  ds_read_b64_tr_b16 a[108:109], v245 offset:40960
  ds_read_b64_tr_b16 a[110:111], v245 offset:45056
  v_mfma_f32_16x16x32_bf16 v[76:79], a[84:87], a[32:35], v[76:79]
  ds_read_b64_tr_b16 a[80:81], v242 offset:51200
  ds_read_b64_tr_b16 a[82:83], v242 offset:55296
  v_mfma_f32_16x16x32_bf16 v[92:95], a[84:87], a[36:39], v[92:95]
  ds_read_b64_tr_b16 a[84:85], v243 offset:51200
  ds_read_b64_tr_b16 a[86:87], v243 offset:55296
  v_mfma_f32_16x16x32_bf16 v[80:83], a[88:91], a[32:35], v[80:83]
  v_mfma_f32_16x16x32_bf16 v[96:99], a[88:91], a[36:39], v[96:99]
  buffer_load_dwordx4 a[20:23], v240, s[4:7], s16 offen offset:1024 sc1
  v_mfma_f32_16x16x32_bf16 v[84:87], a[92:95], a[32:35], v[84:87]
  ds_read_b64_tr_b16 a[88:89], v244 offset:51200
  ds_read_b64_tr_b16 a[90:91], v244 offset:55296
  v_mfma_f32_16x16x32_bf16 v[100:103], a[92:95], a[36:39], v[100:103]
  ds_read_b64_tr_b16 a[92:93], v245 offset:51200
  ds_read_b64_tr_b16 a[94:95], v245 offset:55296
  v_mfma_f32_16x16x32_bf16 v[72:75], a[112:115], a[40:43], v[72:75]
  v_mfma_f32_16x16x32_bf16 v[88:91], a[112:115], a[44:47], v[88:91]
  ds_read_b64_tr_b16 a[112:113], v242 offset:59392
  ds_read_b64_tr_b16 a[114:115], v242 offset:63488
  v_mfma_f32_16x16x32_bf16 v[76:79], a[116:119], a[40:43], v[76:79]
  buffer_load_dwordx4 a[24:27], v241, s[4:7], s16 offen offset:0 sc1
  v_mfma_f32_16x16x32_bf16 v[92:95], a[116:119], a[44:47], v[92:95]
  ds_read_b64_tr_b16 a[116:117], v243 offset:59392
  ds_read_b64_tr_b16 a[118:119], v243 offset:63488
  v_mfma_f32_16x16x32_bf16 v[80:83], a[120:123], a[40:43], v[80:83]
  v_mfma_f32_16x16x32_bf16 v[96:99], a[120:123], a[44:47], v[96:99]
  ds_read_b64_tr_b16 a[120:121], v244 offset:59392
  ds_read_b64_tr_b16 a[122:123], v244 offset:63488
  v_mfma_f32_16x16x32_bf16 v[84:87], a[124:127], a[40:43], v[84:87]
  v_mfma_f32_16x16x32_bf16 v[100:103], a[124:127], a[44:47], v[100:103]
  buffer_load_dwordx4 a[28:31], v241, s[4:7], s16 offen offset:1024 sc1
  v_mfma_f32_16x16x32_bf16 v[16:19], a[64:67], a[32:35], v[16:19]
  ds_read_b64_tr_b16 a[124:125], v245 offset:59392
  s_add_u32 s41, s41, 262144
  v_mfma_f32_16x16x32_bf16 v[32:35], a[64:67], a[36:39], v[32:35]
  ds_read_b64_tr_b16 a[126:127], v245 offset:63488
  s_bitset0_b32 s41, 21
  v_mfma_f32_16x16x32_bf16 v[20:23], a[68:71], a[32:35], v[20:23]
  ds_read_b64_tr_b16 a[64:65], v242 offset:49152
  s_add_u32 s16, s40, s41
  v_mfma_f32_16x16x32_bf16 v[36:39], a[68:71], a[36:39], v[36:39]
  ds_read_b64_tr_b16 a[66:67], v242 offset:53248
  ds_read_b64_tr_b16 a[68:69], v243 offset:49152
  s_waitcnt lgkmcnt(10)
  v_mfma_f32_16x16x32_bf16 v[24:27], a[72:75], a[32:35], v[24:27]
  buffer_store_dwordx4 v[12:15], v224, s[12:15], s101 offen offset:0 sc1
  v_mfma_f32_16x16x32_bf16 v[40:43], a[72:75], a[36:39], v[40:43]
  ds_read_b64_tr_b16 a[70:71], v243 offset:53248
  ds_read_b64_tr_b16 a[72:73], v244 offset:49152
  v_mfma_f32_16x16x32_bf16 v[28:31], a[76:79], a[32:35], v[28:31]
  ds_read_b64_tr_b16 a[74:75], v244 offset:53248
  v_mfma_f32_16x16x32_bf16 v[44:47], a[76:79], a[36:39], v[44:47]
  ds_read_b64_tr_b16 a[76:77], v245 offset:49152
  ds_read_b64_tr_b16 a[78:79], v245 offset:53248
  v_mfma_f32_16x16x32_bf16 v[16:19], a[96:99], a[40:43], v[16:19]
  v_mfma_f32_16x16x32_bf16 v[32:35], a[96:99], a[44:47], v[32:35]
  buffer_store_dwordx4 v[124:127], v224, s[12:15], s101 offen offset:2048 sc1
  v_mfma_f32_16x16x32_bf16 v[20:23], a[100:103], a[40:43], v[20:23]
  ds_read_b64_tr_b16 a[96:97], v242 offset:57344
  ds_read_b64_tr_b16 a[98:99], v242 offset:61440
  v_mfma_f32_16x16x32_bf16 v[36:39], a[100:103], a[44:47], v[36:39]
  ds_read_b64_tr_b16 a[100:101], v243 offset:57344
  ds_read_b64_tr_b16 a[102:103], v243 offset:61440
  v_mfma_f32_16x16x32_bf16 v[24:27], a[104:107], a[40:43], v[24:27]
  v_mfma_f32_16x16x32_bf16 v[40:43], a[104:107], a[44:47], v[40:43]
  ds_read_b64_tr_b16 a[104:105], v244 offset:57344
  ds_read_b64_tr_b16 a[106:107], v244 offset:61440
  v_mfma_f32_16x16x32_bf16 v[28:31], a[108:111], a[40:43], v[28:31]
  v_mfma_f32_16x16x32_bf16 v[44:47], a[108:111], a[44:47], v[44:47]
  s_waitcnt vmcnt(14) lgkmcnt(10)
  s_barrier
  v_mfma_f32_16x16x32_bf16 v[72:75], a[80:83], a[48:51], v[72:75]
  ds_read_b64_tr_b16 a[108:109], v245 offset:57344
  s_add_u32 m0, s38, 0
  v_mfma_f32_16x16x32_bf16 v[88:91], a[80:83], a[52:55], v[88:91]
  buffer_load_dwordx4 v225, s[8:11], s17 offen lds
  v_mfma_f32_16x16x32_bf16 v[76:79], a[84:87], a[48:51], v[76:79]
  ds_read_b64_tr_b16 a[110:111], v245 offset:61440
  ds_read_b64_tr_b16 a[80:81], v104 offset:2048
  v_mfma_f32_16x16x32_bf16 v[92:95], a[84:87], a[52:55], v[92:95]
  ds_read_b64_tr_b16 a[82:83], v104 offset:6144
  ds_read_b64_tr_b16 a[84:85], v105 offset:2048
  v_mfma_f32_16x16x32_bf16 v[80:83], a[88:91], a[48:51], v[80:83]
  buffer_load_dwordx4 a[32:35], v240, s[4:7], s16 offen offset:0 sc1
  v_mfma_f32_16x16x32_bf16 v[96:99], a[88:91], a[52:55], v[96:99]
  ds_read_b64_tr_b16 a[86:87], v105 offset:6144
  ds_read_b64_tr_b16 a[88:89], v106 offset:2048
  v_mfma_f32_16x16x32_bf16 v[84:87], a[92:95], a[48:51], v[84:87]
  ds_read_b64_tr_b16 a[90:91], v106 offset:6144
  v_mfma_f32_16x16x32_bf16 v[100:103], a[92:95], a[52:55], v[100:103]
  ds_read_b64_tr_b16 a[92:93], v107 offset:2048
  ds_read_b64_tr_b16 a[94:95], v107 offset:6144
  v_mfma_f32_16x16x32_bf16 v[72:75], a[112:115], a[56:59], v[72:75]
  buffer_load_dwordx4 v226, s[8:11], s17 offen offset:1024 lds
  v_mfma_f32_16x16x32_bf16 v[88:91], a[112:115], a[60:63], v[88:91]
  ds_read_b64_tr_b16 a[112:113], v104 offset:10240
  ds_read_b64_tr_b16 a[114:115], v104 offset:14336
  v_mfma_f32_16x16x32_bf16 v[76:79], a[116:119], a[56:59], v[76:79]
  v_mfma_f32_16x16x32_bf16 v[92:95], a[116:119], a[60:63], v[92:95]
  ds_read_b64_tr_b16 a[116:117], v105 offset:10240
  ds_read_b64_tr_b16 a[118:119], v105 offset:14336
  v_mfma_f32_16x16x32_bf16 v[80:83], a[120:123], a[56:59], v[80:83]
  buffer_load_dwordx4 a[36:39], v240, s[4:7], s16 offen offset:1024 sc1
  v_mfma_f32_16x16x32_bf16 v[96:99], a[120:123], a[60:63], v[96:99]
  ds_read_b64_tr_b16 a[120:121], v106 offset:10240
  ds_read_b64_tr_b16 a[122:123], v106 offset:14336
  v_mfma_f32_16x16x32_bf16 v[84:87], a[124:127], a[56:59], v[84:87]
  v_mfma_f32_16x16x32_bf16 v[100:103], a[124:127], a[60:63], v[100:103]
  buffer_load_dword v247, v246, s[56:59], s94 offen sc1
  v_mfma_f32_16x16x32_bf16 v[16:19], a[64:67], a[48:51], v[16:19]
  buffer_load_dwordx4 v227, s[8:11], s17 offen offset:2048 lds
  v_mfma_f32_16x16x32_bf16 v[32:35], a[64:67], a[52:55], v[32:35]
  ds_read_b64_tr_b16 a[124:125], v107 offset:10240
  ds_read_b64_tr_b16 a[126:127], v107 offset:14336
  v_mfma_f32_16x16x32_bf16 v[20:23], a[68:71], a[48:51], v[20:23]
  ds_read_b64_tr_b16 a[64:65], v104 offset:0
  ds_read_b64_tr_b16 a[66:67], v104 offset:4096
  v_mfma_f32_16x16x32_bf16 v[36:39], a[68:71], a[52:55], v[36:39]
  ds_read_b64_tr_b16 a[68:69], v105 offset:0
  ds_read_b64_tr_b16 a[70:71], v105 offset:4096
  s_waitcnt lgkmcnt(10)
  v_mfma_f32_16x16x32_bf16 v[24:27], a[72:75], a[48:51], v[24:27]
  buffer_load_dwordx4 a[40:43], v241, s[4:7], s16 offen offset:0 sc1
  v_mfma_f32_16x16x32_bf16 v[40:43], a[72:75], a[52:55], v[40:43]
  ds_read_b64_tr_b16 a[72:73], v106 offset:0
  ds_read_b64_tr_b16 a[74:75], v106 offset:4096
  v_mfma_f32_16x16x32_bf16 v[28:31], a[76:79], a[48:51], v[28:31]
  v_mfma_f32_16x16x32_bf16 v[44:47], a[76:79], a[52:55], v[44:47]
  buffer_load_dwordx4 v228, s[8:11], s17 offen offset:3072 lds
  v_mfma_f32_16x16x32_bf16 v[16:19], a[96:99], a[56:59], v[16:19]
  ds_read_b64_tr_b16 a[76:77], v107 offset:0
  s_add_u32 s17, s17, 458752
  v_mfma_f32_16x16x32_bf16 v[32:35], a[96:99], a[60:63], v[32:35]
  ds_read_b64_tr_b16 a[78:79], v107 offset:4096
  s_cmp_eq_u32 s17, s93
  v_mfma_f32_16x16x32_bf16 v[20:23], a[100:103], a[56:59], v[20:23]
  ds_read_b64_tr_b16 a[96:97], v104 offset:8192
  s_cselect_b32 s17, s95, s17
  v_mfma_f32_16x16x32_bf16 v[36:39], a[100:103], a[60:63], v[36:39]
  buffer_load_dwordx4 a[44:47], v241, s[4:7], s16 offen offset:1024 sc1
  v_mfma_f32_16x16x32_bf16 v[24:27], a[104:107], a[56:59], v[24:27]
  ds_read_b64_tr_b16 a[98:99], v104 offset:12288
  s_add_u32 s41, s41, 262144
  v_mfma_f32_16x16x32_bf16 v[40:43], a[104:107], a[60:63], v[40:43]
  ds_read_b64_tr_b16 a[100:101], v105 offset:8192
  s_bitset0_b32 s41, 21
  v_mfma_f32_16x16x32_bf16 v[28:31], a[108:111], a[56:59], v[28:31]
  ds_read_b64_tr_b16 a[102:103], v105 offset:12288
  s_add_u32 s16, s40, s41
  v_mfma_f32_16x16x32_bf16 v[44:47], a[108:111], a[60:63], v[44:47]
  s_waitcnt vmcnt(17) lgkmcnt(10)
  s_barrier
  v_mfma_f32_16x16x32_bf16 v[72:75], a[80:83], a[0:3], v[72:75]
  ds_read_b64_tr_b16 a[104:105], v106 offset:8192
  ds_read_b64_tr_b16 a[106:107], v106 offset:12288
  s_add_u32 m0, s38, 16384
  v_mfma_f32_16x16x32_bf16 v[88:91], a[80:83], a[4:7], v[88:91]
  buffer_load_dwordx4 v225, s[8:11], s17 offen lds
  v_mfma_f32_16x16x32_bf16 v[76:79], a[84:87], a[0:3], v[76:79]
  ds_read_b64_tr_b16 a[108:109], v107 offset:8192
  ds_read_b64_tr_b16 a[110:111], v107 offset:12288
  v_add_u32 v124, 131072, v242
  v_mfma_f32_16x16x32_bf16 v[92:95], a[84:87], a[4:7], v[92:95]
  ds_read_b64_tr_b16 a[80:81], v104 offset:18432
  ds_read_b64_tr_b16 a[82:83], v104 offset:22528
  v_mfma_f32_16x16x32_bf16 v[80:83], a[88:91], a[0:3], v[80:83]
  buffer_load_dwordx4 a[48:51], v240, s[4:7], s16 offen offset:0 sc1
  v_mfma_f32_16x16x32_bf16 v[96:99], a[88:91], a[4:7], v[96:99]
  ds_read_b64_tr_b16 a[84:85], v105 offset:18432
  ds_read_b64_tr_b16 a[86:87], v105 offset:22528
  v_mfma_f32_16x16x32_bf16 v[84:87], a[92:95], a[0:3], v[84:87]
  ds_read_b64_tr_b16 a[88:89], v106 offset:18432
  v_add_u32 v125, 131072, v243
  v_mfma_f32_16x16x32_bf16 v[100:103], a[92:95], a[4:7], v[100:103]
  ds_read_b64_tr_b16 a[90:91], v106 offset:22528
  ds_read_b64_tr_b16 a[92:93], v107 offset:18432
  v_mfma_f32_16x16x32_bf16 v[72:75], a[112:115], a[8:11], v[72:75]
  buffer_load_dwordx4 v226, s[8:11], s17 offen offset:1024 lds
  v_mfma_f32_16x16x32_bf16 v[88:91], a[112:115], a[12:15], v[88:91]
  ds_read_b64_tr_b16 a[94:95], v107 offset:22528
  ds_read_b64_tr_b16 a[112:113], v104 offset:26624
  v_mfma_f32_16x16x32_bf16 v[76:79], a[116:119], a[8:11], v[76:79]
  ds_read_b64_tr_b16 a[114:115], v104 offset:30720
  v_add_u32 v126, 131072, v244
  v_mfma_f32_16x16x32_bf16 v[92:95], a[116:119], a[12:15], v[92:95]
  ds_read_b64_tr_b16 a[116:117], v105 offset:26624
  ds_read_b64_tr_b16 a[118:119], v105 offset:30720
  v_mfma_f32_16x16x32_bf16 v[80:83], a[120:123], a[8:11], v[80:83]
  buffer_load_dwordx4 a[52:55], v240, s[4:7], s16 offen offset:1024 sc1
  v_mfma_f32_16x16x32_bf16 v[96:99], a[120:123], a[12:15], v[96:99]
  ds_read_b64_tr_b16 a[120:121], v106 offset:26624
  ds_read_b64_tr_b16 a[122:123], v106 offset:30720
  v_mfma_f32_16x16x32_bf16 v[84:87], a[124:127], a[8:11], v[84:87]
  v_add_u32 v127, 131072, v245
  v_mfma_f32_16x16x32_bf16 v[100:103], a[124:127], a[12:15], v[100:103]
  ds_read_b64_tr_b16 a[124:125], v107 offset:26624
  ds_read_b64_tr_b16 a[126:127], v107 offset:30720
  v_mfma_f32_16x16x32_bf16 v[16:19], a[64:67], a[0:3], v[16:19]
  buffer_load_dwordx4 v227, s[8:11], s17 offen offset:2048 lds
  v_mfma_f32_16x16x32_bf16 v[32:35], a[64:67], a[4:7], v[32:35]
  ds_read_b64_tr_b16 a[64:65], v104 offset:16384
  ds_read_b64_tr_b16 a[66:67], v104 offset:20480
  s_waitcnt lgkmcnt(10)
  v_mfma_f32_16x16x32_bf16 v[20:23], a[68:71], a[0:3], v[20:23]
  v_mfma_f32_16x16x32_bf16 v[36:39], a[68:71], a[4:7], v[36:39]
  ds_read_b64_tr_b16 a[68:69], v105 offset:16384
  ds_read_b64_tr_b16 a[70:71], v105 offset:20480
  v_mfma_f32_16x16x32_bf16 v[24:27], a[72:75], a[0:3], v[24:27]
  buffer_load_dwordx4 a[56:59], v241, s[4:7], s16 offen offset:0 sc1
  v_mfma_f32_16x16x32_bf16 v[40:43], a[72:75], a[4:7], v[40:43]
  ds_read_b64_tr_b16 a[72:73], v106 offset:16384
  ds_read_b64_tr_b16 a[74:75], v106 offset:20480
  v_mfma_f32_16x16x32_bf16 v[28:31], a[76:79], a[0:3], v[28:31]
  buffer_load_dwordx4 v228, s[8:11], s17 offen offset:3072 lds
  v_mfma_f32_16x16x32_bf16 v[44:47], a[76:79], a[4:7], v[44:47]
  ds_read_b64_tr_b16 a[76:77], v107 offset:16384
  s_add_u32 s17, s17, 458752
  v_mfma_f32_16x16x32_bf16 v[16:19], a[96:99], a[8:11], v[16:19]
  ds_read_b64_tr_b16 a[78:79], v107 offset:20480
  s_cmp_eq_u32 s17, s93
  v_mfma_f32_16x16x32_bf16 v[32:35], a[96:99], a[12:15], v[32:35]
  ds_read_b64_tr_b16 a[96:97], v104 offset:24576
  s_cselect_b32 s17, s95, s17
  v_mfma_f32_16x16x32_bf16 v[20:23], a[100:103], a[8:11], v[20:23]
  buffer_load_dwordx4 a[60:63], v241, s[4:7], s16 offen offset:1024 sc1
  v_mfma_f32_16x16x32_bf16 v[36:39], a[100:103], a[12:15], v[36:39]
  ds_read_b64_tr_b16 a[98:99], v104 offset:28672
  s_add_u32 s41, s41, 262144
  v_mfma_f32_16x16x32_bf16 v[24:27], a[104:107], a[8:11], v[24:27]
  ds_read_b64_tr_b16 a[100:101], v105 offset:24576
  s_bitset0_b32 s41, 21
  v_mfma_f32_16x16x32_bf16 v[40:43], a[104:107], a[12:15], v[40:43]
  ds_read_b64_tr_b16 a[102:103], v105 offset:28672
  s_add_u32 s40, s40, 2097152
  v_mfma_f32_16x16x32_bf16 v[28:31], a[108:111], a[8:11], v[28:31]
  ds_read_b64_tr_b16 a[104:105], v106 offset:24576
  s_add_u32 s16, s40, s41
  v_mfma_f32_16x16x32_bf16 v[44:47], a[108:111], a[12:15], v[44:47]
  s_waitcnt vmcnt(12) lgkmcnt(10)
  s_barrier
  v_cmp_ne_u32 vcc, s19, v247
  s_nop 1
  s_cmp_lg_u64 vcc, 0
  s_cbranch_scc1 L_slow_27
  L_back_28:
  s_add_u32 s94, s94, 65536
  v_mfma_f32_16x16x32_bf16 v[72:75], a[80:83], a[16:19], v[72:75]
  ds_read_b64_tr_b16 a[106:107], v106 offset:28672
  buffer_load_dwordx4 a[0:3], v240, s[4:7], s16 offen offset:0 sc1
  v_mfma_f32_16x16x32_bf16 v[88:91], a[80:83], a[20:23], v[88:91]
  ds_read_b64_tr_b16 a[108:109], v107 offset:24576
  ds_read_b64_tr_b16 a[110:111], v107 offset:28672
  v_mfma_f32_16x16x32_bf16 v[76:79], a[84:87], a[16:19], v[76:79]
  ds_read_b64_tr_b16 a[80:81], v104 offset:34816
  ds_read_b64_tr_b16 a[82:83], v104 offset:38912
  v_mfma_f32_16x16x32_bf16 v[92:95], a[84:87], a[20:23], v[92:95]
  ds_read_b64_tr_b16 a[84:85], v105 offset:34816
  ds_read_b64_tr_b16 a[86:87], v105 offset:38912
  v_mfma_f32_16x16x32_bf16 v[80:83], a[88:91], a[16:19], v[80:83]
  v_mfma_f32_16x16x32_bf16 v[96:99], a[88:91], a[20:23], v[96:99]
  ds_read_b64_tr_b16 a[88:89], v106 offset:34816
  ds_read_b64_tr_b16 a[90:91], v106 offset:38912
  v_mfma_f32_16x16x32_bf16 v[84:87], a[92:95], a[16:19], v[84:87]
  v_mfma_f32_16x16x32_bf16 v[100:103], a[92:95], a[20:23], v[100:103]
  buffer_load_dwordx4 a[4:7], v240, s[4:7], s16 offen offset:1024 sc1
  v_mfma_f32_16x16x32_bf16 v[72:75], a[112:115], a[24:27], v[72:75]
  ds_read_b64_tr_b16 a[92:93], v107 offset:34816
  ds_read_b64_tr_b16 a[94:95], v107 offset:38912
  v_mfma_f32_16x16x32_bf16 v[88:91], a[112:115], a[28:31], v[88:91]
  ds_read_b64_tr_b16 a[112:113], v104 offset:43008
  ds_read_b64_tr_b16 a[114:115], v104 offset:47104
  v_mfma_f32_16x16x32_bf16 v[76:79], a[116:119], a[24:27], v[76:79]
  v_mfma_f32_16x16x32_bf16 v[92:95], a[116:119], a[28:31], v[92:95]
  ds_read_b64_tr_b16 a[116:117], v105 offset:43008
  ds_read_b64_tr_b16 a[118:119], v105 offset:47104
  v_mfma_f32_16x16x32_bf16 v[80:83], a[120:123], a[24:27], v[80:83]
  v_mfma_f32_16x16x32_bf16 v[96:99], a[120:123], a[28:31], v[96:99]
  ds_read_b64_tr_b16 a[120:121], v106 offset:43008
  ds_read_b64_tr_b16 a[122:123], v106 offset:47104
  v_mfma_f32_16x16x32_bf16 v[84:87], a[124:127], a[24:27], v[84:87]
  v_mfma_f32_16x16x32_bf16 v[100:103], a[124:127], a[28:31], v[100:103]
  buffer_load_dwordx4 a[8:11], v241, s[4:7], s16 offen offset:0 sc1
  v_mfma_f32_16x16x32_bf16 v[16:19], a[64:67], a[16:19], v[16:19]
  ds_read_b64_tr_b16 a[124:125], v107 offset:43008
  ds_read_b64_tr_b16 a[126:127], v107 offset:47104
  v_mfma_f32_16x16x32_bf16 v[32:35], a[64:67], a[20:23], v[32:35]
  ds_read_b64_tr_b16 a[64:65], v104 offset:32768
  ds_read_b64_tr_b16 a[66:67], v104 offset:36864
  s_waitcnt lgkmcnt(10)
  v_mfma_f32_16x16x32_bf16 v[20:23], a[68:71], a[16:19], v[20:23]
  v_mfma_f32_16x16x32_bf16 v[36:39], a[68:71], a[20:23], v[36:39]
  ds_read_b64_tr_b16 a[68:69], v105 offset:32768
  ds_read_b64_tr_b16 a[70:71], v105 offset:36864
  v_mfma_f32_16x16x32_bf16 v[24:27], a[72:75], a[16:19], v[24:27]
  v_mfma_f32_16x16x32_bf16 v[40:43], a[72:75], a[20:23], v[40:43]
  ds_read_b64_tr_b16 a[72:73], v106 offset:32768
  ds_read_b64_tr_b16 a[74:75], v106 offset:36864
  v_mfma_f32_16x16x32_bf16 v[28:31], a[76:79], a[16:19], v[28:31]
  v_mfma_f32_16x16x32_bf16 v[44:47], a[76:79], a[20:23], v[44:47]
  buffer_load_dwordx4 a[12:15], v241, s[4:7], s16 offen offset:1024 sc1
  v_mfma_f32_16x16x32_bf16 v[16:19], a[96:99], a[24:27], v[16:19]
  ds_read_b64_tr_b16 a[76:77], v107 offset:32768
  s_add_u32 s41, s41, 262144
  v_mfma_f32_16x16x32_bf16 v[32:35], a[96:99], a[28:31], v[32:35]
  ds_read_b64_tr_b16 a[78:79], v107 offset:36864
  s_bitset0_b32 s41, 21
  v_mfma_f32_16x16x32_bf16 v[20:23], a[100:103], a[24:27], v[20:23]
  ds_read_b64_tr_b16 a[96:97], v104 offset:40960
  s_add_u32 s16, s40, s41
  v_mfma_f32_16x16x32_bf16 v[36:39], a[100:103], a[28:31], v[36:39]
  ds_read_b64_tr_b16 a[98:99], v104 offset:45056
  ds_read_b64_tr_b16 a[100:101], v105 offset:40960
  v_mfma_f32_16x16x32_bf16 v[24:27], a[104:107], a[24:27], v[24:27]
  ds_read_b64_tr_b16 a[102:103], v105 offset:45056
  v_mfma_f32_16x16x32_bf16 v[40:43], a[104:107], a[28:31], v[40:43]
  ds_read_b64_tr_b16 a[104:105], v106 offset:40960
  ds_read_b64_tr_b16 a[106:107], v106 offset:45056
  v_mfma_f32_16x16x32_bf16 v[28:31], a[108:111], a[24:27], v[28:31]
  v_mfma_f32_16x16x32_bf16 v[44:47], a[108:111], a[28:31], v[44:47]
  s_waitcnt vmcnt(12) lgkmcnt(10)
  s_barrier
  s_mov_b64 exec, 1
  buffer_store_dword v248, v250, s[56:59], s92 offen sc1
  s_mov_b64 exec, -1
  s_add_u32 s92, s92, 65536
  v_mfma_f32_16x16x32_bf16 v[72:75], a[80:83], a[32:35], v[72:75]
  ds_read_b64_tr_b16 a[108:109], v107 offset:40960
  s_add_u32 m0, s38, 32768
  v_mfma_f32_16x16x32_bf16 v[88:91], a[80:83], a[36:39], v[88:91]
  buffer_load_dwordx4 v225, s[8:11], s17 offen lds
  v_mfma_f32_16x16x32_bf16 v[76:79], a[84:87], a[32:35], v[76:79]
  ds_read_b64_tr_b16 a[110:111], v107 offset:45056
  ds_read_b64_tr_b16 a[80:81], v104 offset:51200
  v_mfma_f32_16x16x32_bf16 v[92:95], a[84:87], a[36:39], v[92:95]
  ds_read_b64_tr_b16 a[82:83], v104 offset:55296
  ds_read_b64_tr_b16 a[84:85], v105 offset:51200
  v_mfma_f32_16x16x32_bf16 v[80:83], a[88:91], a[32:35], v[80:83]
  buffer_load_dwordx4 a[16:19], v240, s[4:7], s16 offen offset:0 sc1
  v_mfma_f32_16x16x32_bf16 v[96:99], a[88:91], a[36:39], v[96:99]
  ds_read_b64_tr_b16 a[86:87], v105 offset:55296
  ds_read_b64_tr_b16 a[88:89], v106 offset:51200
  v_mfma_f32_16x16x32_bf16 v[84:87], a[92:95], a[32:35], v[84:87]
  ds_read_b64_tr_b16 a[90:91], v106 offset:55296
  v_mfma_f32_16x16x32_bf16 v[100:103], a[92:95], a[36:39], v[100:103]
  ds_read_b64_tr_b16 a[92:93], v107 offset:51200
  ds_read_b64_tr_b16 a[94:95], v107 offset:55296
  v_mfma_f32_16x16x32_bf16 v[72:75], a[112:115], a[40:43], v[72:75]
  buffer_load_dwordx4 v226, s[8:11], s17 offen offset:1024 lds
  v_mfma_f32_16x16x32_bf16 v[88:91], a[112:115], a[44:47], v[88:91]
  ds_read_b64_tr_b16 a[112:113], v104 offset:59392
  ds_read_b64_tr_b16 a[114:115], v104 offset:63488
  v_mfma_f32_16x16x32_bf16 v[76:79], a[116:119], a[40:43], v[76:79]
  v_mfma_f32_16x16x32_bf16 v[92:95], a[116:119], a[44:47], v[92:95]
  ds_read_b64_tr_b16 a[116:117], v105 offset:59392
  ds_read_b64_tr_b16 a[118:119], v105 offset:63488
  v_mfma_f32_16x16x32_bf16 v[80:83], a[120:123], a[40:43], v[80:83]
  buffer_load_dwordx4 a[20:23], v240, s[4:7], s16 offen offset:1024 sc1
  v_mfma_f32_16x16x32_bf16 v[96:99], a[120:123], a[44:47], v[96:99]
  ds_read_b64_tr_b16 a[120:121], v106 offset:59392
  ds_read_b64_tr_b16 a[122:123], v106 offset:63488
  v_mfma_f32_16x16x32_bf16 v[84:87], a[124:127], a[40:43], v[84:87]
  v_mfma_f32_16x16x32_bf16 v[100:103], a[124:127], a[44:47], v[100:103]
  ds_read_b64_tr_b16 a[124:125], v107 offset:59392
  ds_read_b64_tr_b16 a[126:127], v107 offset:63488
  v_mfma_f32_16x16x32_bf16 v[16:19], a[64:67], a[32:35], v[16:19]
  buffer_load_dwordx4 v227, s[8:11], s17 offen offset:2048 lds
  v_mfma_f32_16x16x32_bf16 v[32:35], a[64:67], a[36:39], v[32:35]
  ds_read_b64_tr_b16 a[64:65], v104 offset:49152
  ds_read_b64_tr_b16 a[66:67], v104 offset:53248
  v_mfma_f32_16x16x32_bf16 v[20:23], a[68:71], a[32:35], v[20:23]
  v_mfma_f32_16x16x32_bf16 v[36:39], a[68:71], a[36:39], v[36:39]
  ds_read_b64_tr_b16 a[68:69], v105 offset:49152
  ds_read_b64_tr_b16 a[70:71], v105 offset:53248
  s_waitcnt lgkmcnt(10)
  v_mfma_f32_16x16x32_bf16 v[24:27], a[72:75], a[32:35], v[24:27]
  buffer_load_dwordx4 a[24:27], v241, s[4:7], s16 offen offset:0 sc1
  v_mfma_f32_16x16x32_bf16 v[40:43], a[72:75], a[36:39], v[40:43]
  ds_read_b64_tr_b16 a[72:73], v106 offset:49152
  ds_read_b64_tr_b16 a[74:75], v106 offset:53248
  v_mfma_f32_16x16x32_bf16 v[28:31], a[76:79], a[32:35], v[28:31]
  v_mfma_f32_16x16x32_bf16 v[44:47], a[76:79], a[36:39], v[44:47]
  buffer_load_dwordx4 v228, s[8:11], s17 offen offset:3072 lds
  v_mfma_f32_16x16x32_bf16 v[16:19], a[96:99], a[40:43], v[16:19]
  ds_read_b64_tr_b16 a[76:77], v107 offset:49152
  s_add_u32 s17, s17, 458752
  v_mfma_f32_16x16x32_bf16 v[32:35], a[96:99], a[44:47], v[32:35]
  ds_read_b64_tr_b16 a[78:79], v107 offset:53248
  s_cmp_eq_u32 s17, s93
  v_mfma_f32_16x16x32_bf16 v[20:23], a[100:103], a[40:43], v[20:23]
  ds_read_b64_tr_b16 a[96:97], v104 offset:57344
  s_cselect_b32 s17, s95, s17
  v_mfma_f32_16x16x32_bf16 v[36:39], a[100:103], a[44:47], v[36:39]
  buffer_load_dwordx4 a[28:31], v241, s[4:7], s16 offen offset:1024 sc1
  v_mfma_f32_16x16x32_bf16 v[24:27], a[104:107], a[40:43], v[24:27]
  ds_read_b64_tr_b16 a[98:99], v104 offset:61440
  s_add_u32 s41, s41, 262144
  v_mfma_f32_16x16x32_bf16 v[40:43], a[104:107], a[44:47], v[40:43]
  ds_read_b64_tr_b16 a[100:101], v105 offset:57344
  s_bitset0_b32 s41, 21
  v_mfma_f32_16x16x32_bf16 v[28:31], a[108:111], a[40:43], v[28:31]
  ds_read_b64_tr_b16 a[102:103], v105 offset:61440
  s_add_u32 s16, s40, s41
  v_mfma_f32_16x16x32_bf16 v[44:47], a[108:111], a[44:47], v[44:47]
  s_waitcnt vmcnt(13) lgkmcnt(10)
  s_barrier
  v_mfma_f32_16x16x32_bf16 v[72:75], a[80:83], a[48:51], v[72:75]
  ds_read_b64_tr_b16 a[104:105], v106 offset:57344
  ds_read_b64_tr_b16 a[106:107], v106 offset:61440
  s_add_u32 m0, s38, 49152
  v_mfma_f32_16x16x32_bf16 v[88:91], a[80:83], a[52:55], v[88:91]
  buffer_load_dwordx4 v225, s[8:11], s17 offen lds
  v_mfma_f32_16x16x32_bf16 v[76:79], a[84:87], a[48:51], v[76:79]
  ds_read_b64_tr_b16 a[108:109], v107 offset:57344
  ds_read_b64_tr_b16 a[110:111], v107 offset:61440
  v_mfma_f32_16x16x32_bf16 v[92:95], a[84:87], a[52:55], v[92:95]
  ds_read_b64_tr_b16 a[80:81], v124 offset:2048
  ds_read_b64_tr_b16 a[82:83], v124 offset:6144
  v_mfma_f32_16x16x32_bf16 v[80:83], a[88:91], a[48:51], v[80:83]
  buffer_load_dwordx4 a[32:35], v240, s[4:7], s16 offen offset:0 sc1
  v_mfma_f32_16x16x32_bf16 v[96:99], a[88:91], a[52:55], v[96:99]
  ds_read_b64_tr_b16 a[84:85], v125 offset:2048
  ds_read_b64_tr_b16 a[86:87], v125 offset:6144
  v_mfma_f32_16x16x32_bf16 v[84:87], a[92:95], a[48:51], v[84:87]
  ds_read_b64_tr_b16 a[88:89], v126 offset:2048
  ds_read_b64_tr_b16 a[90:91], v126 offset:6144
  v_mfma_f32_16x16x32_bf16 v[100:103], a[92:95], a[52:55], v[100:103]
  ds_read_b64_tr_b16 a[92:93], v127 offset:2048
  ds_read_b64_tr_b16 a[94:95], v127 offset:6144
  v_mfma_f32_16x16x32_bf16 v[72:75], a[112:115], a[56:59], v[72:75]
  buffer_load_dwordx4 v226, s[8:11], s17 offen offset:1024 lds
  v_mfma_f32_16x16x32_bf16 v[88:91], a[112:115], a[60:63], v[88:91]
  ds_read_b64_tr_b16 a[112:113], v124 offset:10240
  ds_read_b64_tr_b16 a[114:115], v124 offset:14336
  v_mfma_f32_16x16x32_bf16 v[76:79], a[116:119], a[56:59], v[76:79]
  v_mfma_f32_16x16x32_bf16 v[92:95], a[116:119], a[60:63], v[92:95]
  ds_read_b64_tr_b16 a[116:117], v125 offset:10240
  ds_read_b64_tr_b16 a[118:119], v125 offset:14336
  v_mfma_f32_16x16x32_bf16 v[80:83], a[120:123], a[56:59], v[80:83]
  buffer_load_dwordx4 a[36:39], v240, s[4:7], s16 offen offset:1024 sc1
  v_mfma_f32_16x16x32_bf16 v[96:99], a[120:123], a[60:63], v[96:99]
  ds_read_b64_tr_b16 a[120:121], v126 offset:10240
  ds_read_b64_tr_b16 a[122:123], v126 offset:14336
  v_mfma_f32_16x16x32_bf16 v[84:87], a[124:127], a[56:59], v[84:87]
  v_mfma_f32_16x16x32_bf16 v[100:103], a[124:127], a[60:63], v[100:103]
  ds_read_b64_tr_b16 a[124:125], v127 offset:10240
  ds_read_b64_tr_b16 a[126:127], v127 offset:14336
  v_mfma_f32_16x16x32_bf16 v[16:19], a[64:67], a[48:51], v[16:19]
  buffer_load_dwordx4 v227, s[8:11], s17 offen offset:2048 lds
  v_mfma_f32_16x16x32_bf16 v[32:35], a[64:67], a[52:55], v[32:35]
  ds_read_b64_tr_b16 a[64:65], v124 offset:0
  ds_read_b64_tr_b16 a[66:67], v124 offset:4096
  s_waitcnt lgkmcnt(10)
  v_mfma_f32_16x16x32_bf16 v[20:23], a[68:71], a[48:51], v[20:23]
  v_mfma_f32_16x16x32_bf16 v[36:39], a[68:71], a[52:55], v[36:39]
  ds_read_b64_tr_b16 a[68:69], v125 offset:0
  ds_read_b64_tr_b16 a[70:71], v125 offset:4096
  v_mfma_f32_16x16x32_bf16 v[24:27], a[72:75], a[48:51], v[24:27]
  buffer_load_dwordx4 a[40:43], v241, s[4:7], s16 offen offset:0 sc1
  v_mfma_f32_16x16x32_bf16 v[40:43], a[72:75], a[52:55], v[40:43]
  ds_read_b64_tr_b16 a[72:73], v126 offset:0
  ds_read_b64_tr_b16 a[74:75], v126 offset:4096
  v_mfma_f32_16x16x32_bf16 v[28:31], a[76:79], a[48:51], v[28:31]
  v_mfma_f32_16x16x32_bf16 v[44:47], a[76:79], a[52:55], v[44:47]
  buffer_load_dwordx4 v228, s[8:11], s17 offen offset:3072 lds
  v_mfma_f32_16x16x32_bf16 v[16:19], a[96:99], a[56:59], v[16:19]
  ds_read_b64_tr_b16 a[76:77], v127 offset:0
  s_add_u32 s17, s17, 458752
  v_mfma_f32_16x16x32_bf16 v[32:35], a[96:99], a[60:63], v[32:35]
  ds_read_b64_tr_b16 a[78:79], v127 offset:4096
  s_cmp_eq_u32 s17, s93
  v_mfma_f32_16x16x32_bf16 v[20:23], a[100:103], a[56:59], v[20:23]
  ds_read_b64_tr_b16 a[96:97], v124 offset:8192
  s_cselect_b32 s17, s95, s17
  v_mfma_f32_16x16x32_bf16 v[36:39], a[100:103], a[60:63], v[36:39]
  buffer_load_dwordx4 a[44:47], v241, s[4:7], s16 offen offset:1024 sc1
  v_mfma_f32_16x16x32_bf16 v[24:27], a[104:107], a[56:59], v[24:27]
  ds_read_b64_tr_b16 a[98:99], v124 offset:12288
  s_add_u32 s41, s41, 262144
  v_mfma_f32_16x16x32_bf16 v[40:43], a[104:107], a[60:63], v[40:43]
  ds_read_b64_tr_b16 a[100:101], v125 offset:8192
  s_bitset0_b32 s41, 21
  v_mfma_f32_16x16x32_bf16 v[28:31], a[108:111], a[56:59], v[28:31]
  ds_read_b64_tr_b16 a[102:103], v125 offset:12288
  s_add_u32 s16, s40, s41
  v_mfma_f32_16x16x32_bf16 v[44:47], a[108:111], a[60:63], v[44:47]
  s_waitcnt vmcnt(17) lgkmcnt(10)
  s_barrier
  v_mfma_f32_16x16x32_bf16 v[72:75], a[80:83], a[0:3], v[72:75]
  ds_read_b64_tr_b16 a[104:105], v126 offset:8192
  ds_read_b64_tr_b16 a[106:107], v126 offset:12288
  s_add_u32 m0, s38, 65536
  v_mfma_f32_16x16x32_bf16 v[88:91], a[80:83], a[4:7], v[88:91]
  buffer_load_dwordx4 v225, s[8:11], s17 offen lds
  v_mfma_f32_16x16x32_bf16 v[76:79], a[84:87], a[0:3], v[76:79]
  ds_read_b64_tr_b16 a[108:109], v127 offset:8192
  ds_read_b64_tr_b16 a[110:111], v127 offset:12288
  v_mfma_f32_16x16x32_bf16 v[92:95], a[84:87], a[4:7], v[92:95]
  ds_read_b64_tr_b16 a[80:81], v242 offset:2048
  ds_read_b64_tr_b16 a[82:83], v242 offset:6144
  v_mfma_f32_16x16x32_bf16 v[80:83], a[88:91], a[0:3], v[80:83]
  buffer_load_dwordx4 a[48:51], v240, s[4:7], s16 offen offset:0 sc1
  v_mfma_f32_16x16x32_bf16 v[96:99], a[88:91], a[4:7], v[96:99]
  ds_read_b64_tr_b16 a[84:85], v243 offset:2048
  ds_read_b64_tr_b16 a[86:87], v243 offset:6144
  v_mfma_f32_16x16x32_bf16 v[84:87], a[92:95], a[0:3], v[84:87]
  ds_read_b64_tr_b16 a[88:89], v244 offset:2048
  ds_read_b64_tr_b16 a[90:91], v244 offset:6144
  v_mfma_f32_16x16x32_bf16 v[100:103], a[92:95], a[4:7], v[100:103]
  ds_read_b64_tr_b16 a[92:93], v245 offset:2048
  ds_read_b64_tr_b16 a[94:95], v245 offset:6144
  v_mfma_f32_16x16x32_bf16 v[72:75], a[112:115], a[8:11], v[72:75]
  buffer_load_dwordx4 v226, s[8:11], s17 offen offset:1024 lds
  v_mfma_f32_16x16x32_bf16 v[88:91], a[112:115], a[12:15], v[88:91]
  ds_read_b64_tr_b16 a[112:113], v242 offset:10240
  ds_read_b64_tr_b16 a[114:115], v242 offset:14336
  v_mfma_f32_16x16x32_bf16 v[76:79], a[116:119], a[8:11], v[76:79]
  v_mfma_f32_16x16x32_bf16 v[92:95], a[116:119], a[12:15], v[92:95]
  ds_read_b64_tr_b16 a[116:117], v243 offset:10240
  ds_read_b64_tr_b16 a[118:119], v243 offset:14336
  v_mfma_f32_16x16x32_bf16 v[80:83], a[120:123], a[8:11], v[80:83]
  buffer_load_dwordx4 a[52:55], v240, s[4:7], s16 offen offset:1024 sc1
  v_mfma_f32_16x16x32_bf16 v[96:99], a[120:123], a[12:15], v[96:99]
  ds_read_b64_tr_b16 a[120:121], v244 offset:10240
  ds_read_b64_tr_b16 a[122:123], v244 offset:14336
  v_mfma_f32_16x16x32_bf16 v[84:87], a[124:127], a[8:11], v[84:87]
  v_mfma_f32_16x16x32_bf16 v[100:103], a[124:127], a[12:15], v[100:103]
  ds_read_b64_tr_b16 a[124:125], v245 offset:10240
  ds_read_b64_tr_b16 a[126:127], v245 offset:14336
  v_mfma_f32_16x16x32_bf16 v[16:19], a[64:67], a[0:3], v[16:19]
  buffer_load_dwordx4 v227, s[8:11], s17 offen offset:2048 lds
  v_mfma_f32_16x16x32_bf16 v[32:35], a[64:67], a[4:7], v[32:35]
  ds_read_b64_tr_b16 a[64:65], v242 offset:0
  ds_read_b64_tr_b16 a[66:67], v242 offset:4096
  s_waitcnt lgkmcnt(10)
  v_mfma_f32_16x16x32_bf16 v[20:23], a[68:71], a[0:3], v[20:23]
  v_mfma_f32_16x16x32_bf16 v[36:39], a[68:71], a[4:7], v[36:39]
  ds_read_b64_tr_b16 a[68:69], v243 offset:0
  ds_read_b64_tr_b16 a[70:71], v243 offset:4096
  v_mfma_f32_16x16x32_bf16 v[24:27], a[72:75], a[0:3], v[24:27]
  buffer_load_dwordx4 a[56:59], v241, s[4:7], s16 offen offset:0 sc1
  v_mfma_f32_16x16x32_bf16 v[40:43], a[72:75], a[4:7], v[40:43]
  ds_read_b64_tr_b16 a[72:73], v244 offset:0
  ds_read_b64_tr_b16 a[74:75], v244 offset:4096
  v_mfma_f32_16x16x32_bf16 v[28:31], a[76:79], a[0:3], v[28:31]
  v_mfma_f32_16x16x32_bf16 v[44:47], a[76:79], a[4:7], v[44:47]
  buffer_load_dwordx4 v228, s[8:11], s17 offen offset:3072 lds
  v_mfma_f32_16x16x32_bf16 v[16:19], a[96:99], a[8:11], v[16:19]
  ds_read_b64_tr_b16 a[76:77], v245 offset:0
  s_add_u32 s17, s17, 458752
  v_mfma_f32_16x16x32_bf16 v[32:35], a[96:99], a[12:15], v[32:35]
  ds_read_b64_tr_b16 a[78:79], v245 offset:4096
  s_cmp_eq_u32 s17, s93
  v_mfma_f32_16x16x32_bf16 v[20:23], a[100:103], a[8:11], v[20:23]
  ds_read_b64_tr_b16 a[96:97], v242 offset:8192
  s_cselect_b32 s17, s95, s17
  v_mfma_f32_16x16x32_bf16 v[36:39], a[100:103], a[12:15], v[36:39]
  buffer_load_dwordx4 a[60:63], v241, s[4:7], s16 offen offset:1024 sc1
  v_mfma_f32_16x16x32_bf16 v[24:27], a[104:107], a[8:11], v[24:27]
  ds_read_b64_tr_b16 a[98:99], v242 offset:12288
  s_add_u32 s41, s41, 262144
  v_mfma_f32_16x16x32_bf16 v[40:43], a[104:107], a[12:15], v[40:43]
  ds_read_b64_tr_b16 a[100:101], v243 offset:8192
  s_bitset0_b32 s41, 21
  v_mfma_f32_16x16x32_bf16 v[28:31], a[108:111], a[8:11], v[28:31]
  ds_read_b64_tr_b16 a[102:103], v243 offset:12288
  s_add_u32 s16, s40, s41
  v_mfma_f32_16x16x32_bf16 v[44:47], a[108:111], a[12:15], v[44:47]
  s_waitcnt vmcnt(16) lgkmcnt(10)
  s_barrier
  v_mfma_f32_16x16x32_bf16 v[72:75], a[80:83], a[16:19], v[72:75]
  ds_read_b64_tr_b16 a[104:105], v244 offset:8192
  ds_read_b64_tr_b16 a[106:107], v244 offset:12288
  s_add_u32 m0, s38, 81920
  v_mfma_f32_16x16x32_bf16 v[88:91], a[80:83], a[20:23], v[88:91]
  buffer_load_dwordx4 v225, s[8:11], s17 offen lds
  v_mfma_f32_16x16x32_bf16 v[76:79], a[84:87], a[16:19], v[76:79]
  ds_read_b64_tr_b16 a[108:109], v245 offset:8192
  ds_read_b64_tr_b16 a[110:111], v245 offset:12288
  v_mfma_f32_16x16x32_bf16 v[92:95], a[84:87], a[20:23], v[92:95]
  ds_read_b64_tr_b16 a[80:81], v242 offset:18432
  ds_read_b64_tr_b16 a[82:83], v242 offset:22528
  v_mfma_f32_16x16x32_bf16 v[80:83], a[88:91], a[16:19], v[80:83]
  buffer_load_dwordx4 a[0:3], v240, s[4:7], s16 offen offset:0 sc1
  v_mfma_f32_16x16x32_bf16 v[96:99], a[88:91], a[20:23], v[96:99]
  ds_read_b64_tr_b16 a[84:85], v243 offset:18432
  ds_read_b64_tr_b16 a[86:87], v243 offset:22528
  v_mfma_f32_16x16x32_bf16 v[84:87], a[92:95], a[16:19], v[84:87]
  ds_read_b64_tr_b16 a[88:89], v244 offset:18432
  ds_read_b64_tr_b16 a[90:91], v244 offset:22528
  v_mfma_f32_16x16x32_bf16 v[100:103], a[92:95], a[20:23], v[100:103]
  ds_read_b64_tr_b16 a[92:93], v245 offset:18432
  ds_read_b64_tr_b16 a[94:95], v245 offset:22528
  v_mfma_f32_16x16x32_bf16 v[72:75], a[112:115], a[24:27], v[72:75]
  buffer_load_dwordx4 v226, s[8:11], s17 offen offset:1024 lds
  v_mfma_f32_16x16x32_bf16 v[88:91], a[112:115], a[28:31], v[88:91]
  ds_read_b64_tr_b16 a[112:113], v242 offset:26624
  ds_read_b64_tr_b16 a[114:115], v242 offset:30720
  v_mfma_f32_16x16x32_bf16 v[76:79], a[116:119], a[24:27], v[76:79]
  v_mfma_f32_16x16x32_bf16 v[92:95], a[116:119], a[28:31], v[92:95]
  ds_read_b64_tr_b16 a[116:117], v243 offset:26624
  ds_read_b64_tr_b16 a[118:119], v243 offset:30720
  v_mfma_f32_16x16x32_bf16 v[80:83], a[120:123], a[24:27], v[80:83]
  buffer_load_dwordx4 a[4:7], v240, s[4:7], s16 offen offset:1024 sc1
  v_mfma_f32_16x16x32_bf16 v[96:99], a[120:123], a[28:31], v[96:99]
  ds_read_b64_tr_b16 a[120:121], v244 offset:26624
  ds_read_b64_tr_b16 a[122:123], v244 offset:30720
  v_mfma_f32_16x16x32_bf16 v[84:87], a[124:127], a[24:27], v[84:87]
  v_mfma_f32_16x16x32_bf16 v[100:103], a[124:127], a[28:31], v[100:103]
  ds_read_b64_tr_b16 a[124:125], v245 offset:26624
  ds_read_b64_tr_b16 a[126:127], v245 offset:30720
  v_mfma_f32_16x16x32_bf16 v[16:19], a[64:67], a[16:19], v[16:19]
  buffer_load_dwordx4 v227, s[8:11], s17 offen offset:2048 lds
  v_mfma_f32_16x16x32_bf16 v[32:35], a[64:67], a[20:23], v[32:35]
  ds_read_b64_tr_b16 a[64:65], v242 offset:16384
  ds_read_b64_tr_b16 a[66:67], v242 offset:20480
  s_waitcnt lgkmcnt(10)
  v_mfma_f32_16x16x32_bf16 v[20:23], a[68:71], a[16:19], v[20:23]
  v_mfma_f32_16x16x32_bf16 v[36:39], a[68:71], a[20:23], v[36:39]
  ds_read_b64_tr_b16 a[68:69], v243 offset:16384
  ds_read_b64_tr_b16 a[70:71], v243 offset:20480
  v_mfma_f32_16x16x32_bf16 v[24:27], a[72:75], a[16:19], v[24:27]
  buffer_load_dwordx4 a[8:11], v241, s[4:7], s16 offen offset:0 sc1
  v_mfma_f32_16x16x32_bf16 v[40:43], a[72:75], a[20:23], v[40:43]
  ds_read_b64_tr_b16 a[72:73], v244 offset:16384
  ds_read_b64_tr_b16 a[74:75], v244 offset:20480
  v_mfma_f32_16x16x32_bf16 v[28:31], a[76:79], a[16:19], v[28:31]
  v_mfma_f32_16x16x32_bf16 v[44:47], a[76:79], a[20:23], v[44:47]
  buffer_load_dwordx4 v228, s[8:11], s17 offen offset:3072 lds
  v_mfma_f32_16x16x32_bf16 v[16:19], a[96:99], a[24:27], v[16:19]
  ds_read_b64_tr_b16 a[76:77], v245 offset:16384
  s_add_u32 s17, s17, 458752
  v_mfma_f32_16x16x32_bf16 v[32:35], a[96:99], a[28:31], v[32:35]
  ds_read_b64_tr_b16 a[78:79], v245 offset:20480
  s_cmp_eq_u32 s17, s93
  v_mfma_f32_16x16x32_bf16 v[20:23], a[100:103], a[24:27], v[20:23]
  ds_read_b64_tr_b16 a[96:97], v242 offset:24576
  s_cselect_b32 s17, s95, s17
  v_mfma_f32_16x16x32_bf16 v[36:39], a[100:103], a[28:31], v[36:39]
  buffer_load_dwordx4 a[12:15], v241, s[4:7], s16 offen offset:1024 sc1
  v_mfma_f32_16x16x32_bf16 v[24:27], a[104:107], a[24:27], v[24:27]
  ds_read_b64_tr_b16 a[98:99], v242 offset:28672
  s_add_u32 s41, s41, 262144
  v_mfma_f32_16x16x32_bf16 v[40:43], a[104:107], a[28:31], v[40:43]
  ds_read_b64_tr_b16 a[100:101], v243 offset:24576
  s_bitset0_b32 s41, 21
  v_mfma_f32_16x16x32_bf16 v[28:31], a[108:111], a[24:27], v[28:31]
  ds_read_b64_tr_b16 a[102:103], v243 offset:28672
  s_add_u32 s16, s40, s41
  v_mfma_f32_16x16x32_bf16 v[44:47], a[108:111], a[28:31], v[44:47]
  s_waitcnt vmcnt(16) lgkmcnt(10)
  s_barrier
  v_mfma_f32_16x16x32_bf16 v[72:75], a[80:83], a[32:35], v[72:75]
  ds_read_b64_tr_b16 a[104:105], v244 offset:24576
  ds_read_b64_tr_b16 a[106:107], v244 offset:28672
  s_add_u32 m0, s38, 98304
  v_mfma_f32_16x16x32_bf16 v[88:91], a[80:83], a[36:39], v[88:91]
  v_accvgpr_read_b32 v0, a128
  buffer_load_dwordx4 v225, s[8:11], s17 offen lds
  v_mfma_f32_16x16x32_bf16 v[76:79], a[84:87], a[32:35], v[76:79]
  ds_read_b64_tr_b16 a[108:109], v245 offset:24576
  ds_read_b64_tr_b16 a[110:111], v245 offset:28672
  v_mfma_f32_16x16x32_bf16 v[92:95], a[84:87], a[36:39], v[92:95]
  ds_read_b64_tr_b16 a[80:81], v242 offset:34816
  v_accvgpr_read_b32 v1, a129
  v_mfma_f32_16x16x32_bf16 v[80:83], a[88:91], a[32:35], v[80:83]
  ds_read_b64_tr_b16 a[82:83], v242 offset:38912
  buffer_load_dwordx4 a[16:19], v240, s[4:7], s16 offen offset:0 sc1
  v_mfma_f32_16x16x32_bf16 v[96:99], a[88:91], a[36:39], v[96:99]
  ds_read_b64_tr_b16 a[84:85], v243 offset:34816
  v_accvgpr_read_b32 v2, a130
  v_mfma_f32_16x16x32_bf16 v[84:87], a[92:95], a[32:35], v[84:87]
  ds_read_b64_tr_b16 a[86:87], v243 offset:38912
  ds_read_b64_tr_b16 a[88:89], v244 offset:34816
  v_mfma_f32_16x16x32_bf16 v[100:103], a[92:95], a[36:39], v[100:103]
  ds_read_b64_tr_b16 a[90:91], v244 offset:38912
  ds_read_b64_tr_b16 a[92:93], v245 offset:34816
  v_mfma_f32_16x16x32_bf16 v[72:75], a[112:115], a[40:43], v[72:75]
  v_accvgpr_read_b32 v3, a131
  buffer_load_dwordx4 v226, s[8:11], s17 offen offset:1024 lds
  v_mfma_f32_16x16x32_bf16 v[88:91], a[112:115], a[44:47], v[88:91]
  ds_read_b64_tr_b16 a[94:95], v245 offset:38912
  ds_read_b64_tr_b16 a[112:113], v242 offset:43008
  v_mfma_f32_16x16x32_bf16 v[76:79], a[116:119], a[40:43], v[76:79]
  ds_read_b64_tr_b16 a[114:115], v242 offset:47104
  v_lshlrev_b32 v192, 16, v0
  v_mfma_f32_16x16x32_bf16 v[92:95], a[116:119], a[44:47], v[92:95]
  ds_read_b64_tr_b16 a[116:117], v243 offset:43008
  ds_read_b64_tr_b16 a[118:119], v243 offset:47104
  v_mfma_f32_16x16x32_bf16 v[80:83], a[120:123], a[40:43], v[80:83]
  v_and_b32 v193, 0xffff0000, v0
  buffer_load_dwordx4 a[20:23], v240, s[4:7], s16 offen offset:1024 sc1
  v_mfma_f32_16x16x32_bf16 v[96:99], a[120:123], a[44:47], v[96:99]
  ds_read_b64_tr_b16 a[120:121], v244 offset:43008
  ds_read_b64_tr_b16 a[122:123], v244 offset:47104
  v_mfma_f32_16x16x32_bf16 v[84:87], a[124:127], a[40:43], v[84:87]
  v_mfma_f32_16x16x32_bf16 v[100:103], a[124:127], a[44:47], v[100:103]
  ds_read_b64_tr_b16 a[124:125], v245 offset:43008
  v_lshlrev_b32 v194, 16, v1
  v_mfma_f32_16x16x32_bf16 v[16:19], a[64:67], a[32:35], v[16:19]
  buffer_load_dwordx4 v227, s[8:11], s17 offen offset:2048 lds
  v_mfma_f32_16x16x32_bf16 v[32:35], a[64:67], a[36:39], v[32:35]
  ds_read_b64_tr_b16 a[126:127], v245 offset:47104
  v_and_b32 v195, 0xffff0000, v1
  s_waitcnt lgkmcnt(10)
  v_mfma_f32_16x16x32_bf16 v[20:23], a[68:71], a[32:35], v[20:23]
  ds_read_b64_tr_b16 a[64:65], v242 offset:32768
  ds_read_b64_tr_b16 a[66:67], v242 offset:36864
  v_mfma_f32_16x16x32_bf16 v[36:39], a[68:71], a[36:39], v[36:39]
  v_lshlrev_b32 v196, 16, v2
  buffer_load_dwordx4 a[24:27], v241, s[4:7], s16 offen offset:0 sc1
  v_mfma_f32_16x16x32_bf16 v[24:27], a[72:75], a[32:35], v[24:27]
  buffer_load_dwordx4 v228, s[8:11], s17 offen offset:3072 lds
  v_mfma_f32_16x16x32_bf16 v[40:43], a[72:75], a[36:39], v[40:43]
  ds_read_b64_tr_b16 a[68:69], v243 offset:32768
  s_add_u32 s17, s17, 458752
  v_mfma_f32_16x16x32_bf16 v[28:31], a[76:79], a[32:35], v[28:31]
  ds_read_b64_tr_b16 a[70:71], v243 offset:36864
  v_and_b32 v197, 0xffff0000, v2
  s_cmp_eq_u32 s17, s93
  v_mfma_f32_16x16x32_bf16 v[44:47], a[76:79], a[36:39], v[44:47]
  ds_read_b64_tr_b16 a[72:73], v244 offset:32768
  s_cselect_b32 s17, s95, s17
  v_mfma_f32_16x16x32_bf16 v[16:19], a[96:99], a[40:43], v[16:19]
  ds_read_b64_tr_b16 a[74:75], v244 offset:36864
  v_lshlrev_b32 v198, 16, v3
  s_add_u32 s17, s17, 65536
  v_mfma_f32_16x16x32_bf16 v[32:35], a[96:99], a[44:47], v[32:35]
  ds_read_b64_tr_b16 a[76:77], v245 offset:32768
  s_add_u32 s93, s93, 65536
  v_mfma_f32_16x16x32_bf16 v[20:23], a[100:103], a[40:43], v[20:23]
  ds_read_b64_tr_b16 a[78:79], v245 offset:36864
  v_and_b32 v199, 0xffff0000, v3
  s_add_u32 s95, s95, 65536
  v_mfma_f32_16x16x32_bf16 v[36:39], a[100:103], a[44:47], v[36:39]
  buffer_load_dwordx4 a[28:31], v241, s[4:7], s16 offen offset:1024 sc1
  v_mfma_f32_16x16x32_bf16 v[24:27], a[104:107], a[40:43], v[24:27]
  ds_read_b64_tr_b16 a[96:97], v242 offset:40960
  ds_read_b64_tr_b16 a[98:99], v242 offset:45056
  s_add_u32 s41, s41, 262144
  v_mfma_f32_16x16x32_bf16 v[40:43], a[104:107], a[44:47], v[40:43]
  ds_read_b64_tr_b16 a[100:101], v243 offset:40960
  s_bitset0_b32 s41, 21
  v_mfma_f32_16x16x32_bf16 v[28:31], a[108:111], a[40:43], v[28:31]
  ds_read_b64_tr_b16 a[102:103], v243 offset:45056
  ds_read_b128 v[56:59], v253 offset:768
  s_add_u32 s16, s40, s41
  v_mfma_f32_16x16x32_bf16 v[44:47], a[108:111], a[44:47], v[44:47]
  s_waitcnt vmcnt(16) lgkmcnt(10)
  s_barrier
  v_mfma_f32_16x16x32_bf16 v[72:75], a[80:83], a[48:51], v[72:75]
  ds_read_b64_tr_b16 a[104:105], v244 offset:40960
  ds_read_b64_tr_b16 a[106:107], v244 offset:45056
  s_add_u32 m0, s38, 114688
  v_mfma_f32_16x16x32_bf16 v[88:91], a[80:83], a[52:55], v[88:91]
  v_accvgpr_read_b32 v4, a132
  buffer_load_dwordx4 v225, s[8:11], s17 offen lds
  v_mfma_f32_16x16x32_bf16 v[76:79], a[84:87], a[48:51], v[76:79]
  ds_read_b64_tr_b16 a[108:109], v245 offset:40960
  ds_read_b64_tr_b16 a[110:111], v245 offset:45056
  v_mfma_f32_16x16x32_bf16 v[92:95], a[84:87], a[52:55], v[92:95]
  ds_read_b64_tr_b16 a[80:81], v242 offset:51200
  v_accvgpr_read_b32 v5, a133
  v_mfma_f32_16x16x32_bf16 v[80:83], a[88:91], a[48:51], v[80:83]
  ds_read_b64_tr_b16 a[82:83], v242 offset:55296
  buffer_load_dwordx4 a[32:35], v240, s[4:7], s16 offen offset:0 sc1
  v_mfma_f32_16x16x32_bf16 v[96:99], a[88:91], a[52:55], v[96:99]
  ds_read_b64_tr_b16 a[84:85], v243 offset:51200
  v_accvgpr_read_b32 v6, a134
  v_mfma_f32_16x16x32_bf16 v[84:87], a[92:95], a[48:51], v[84:87]
  ds_read_b64_tr_b16 a[86:87], v243 offset:55296
  ds_read_b64_tr_b16 a[88:89], v244 offset:51200
  v_mfma_f32_16x16x32_bf16 v[100:103], a[92:95], a[52:55], v[100:103]
  ds_read_b64_tr_b16 a[90:91], v244 offset:55296
  ds_read_b64_tr_b16 a[92:93], v245 offset:51200
  v_mfma_f32_16x16x32_bf16 v[72:75], a[112:115], a[56:59], v[72:75]
  v_accvgpr_read_b32 v7, a135
  buffer_load_dwordx4 v226, s[8:11], s17 offen offset:1024 lds
  v_mfma_f32_16x16x32_bf16 v[88:91], a[112:115], a[60:63], v[88:91]
  ds_read_b64_tr_b16 a[94:95], v245 offset:55296
  ds_read_b64_tr_b16 a[112:113], v242 offset:59392
  v_mfma_f32_16x16x32_bf16 v[76:79], a[116:119], a[56:59], v[76:79]
  ds_read_b64_tr_b16 a[114:115], v242 offset:63488
  v_lshlrev_b32 v200, 16, v4
  v_mfma_f32_16x16x32_bf16 v[92:95], a[116:119], a[60:63], v[92:95]
  ds_read_b64_tr_b16 a[116:117], v243 offset:59392
  ds_read_b64_tr_b16 a[118:119], v243 offset:63488
  v_mfma_f32_16x16x32_bf16 v[80:83], a[120:123], a[56:59], v[80:83]
  v_and_b32 v201, 0xffff0000, v4
  buffer_load_dwordx4 a[36:39], v240, s[4:7], s16 offen offset:1024 sc1
  v_mfma_f32_16x16x32_bf16 v[96:99], a[120:123], a[60:63], v[96:99]
  ds_read_b64_tr_b16 a[120:121], v244 offset:59392
  ds_read_b64_tr_b16 a[122:123], v244 offset:63488
  v_mfma_f32_16x16x32_bf16 v[84:87], a[124:127], a[56:59], v[84:87]
  v_mfma_f32_16x16x32_bf16 v[100:103], a[124:127], a[60:63], v[100:103]
  v_lshlrev_b32 v202, 16, v5
  buffer_load_dword v247, v246, s[56:59], s94 offen sc1
  v_mfma_f32_16x16x32_bf16 v[16:19], a[64:67], a[48:51], v[16:19]
  buffer_load_dwordx4 v227, s[8:11], s17 offen offset:2048 lds
  v_mfma_f32_16x16x32_bf16 v[32:35], a[64:67], a[52:55], v[32:35]
  ds_read_b64_tr_b16 a[124:125], v245 offset:59392
  v_and_b32 v203, 0xffff0000, v5
  s_waitcnt lgkmcnt(10)
  v_mfma_f32_16x16x32_bf16 v[20:23], a[68:71], a[48:51], v[20:23]
  ds_read_b64_tr_b16 a[126:127], v245 offset:63488
  ds_read_b64_tr_b16 a[64:65], v242 offset:49152
  v_mfma_f32_16x16x32_bf16 v[36:39], a[68:71], a[52:55], v[36:39]
  ds_read_b64_tr_b16 a[66:67], v242 offset:53248
  v_lshlrev_b32 v204, 16, v6
  v_mfma_f32_16x16x32_bf16 v[24:27], a[72:75], a[48:51], v[24:27]
  buffer_load_dwordx4 a[40:43], v241, s[4:7], s16 offen offset:0 sc1
  v_mfma_f32_16x16x32_bf16 v[40:43], a[72:75], a[52:55], v[40:43]
  ds_read_b64_tr_b16 a[68:69], v243 offset:49152
  ds_read_b64_tr_b16 a[70:71], v243 offset:53248
  v_mfma_f32_16x16x32_bf16 v[28:31], a[76:79], a[48:51], v[28:31]
  ds_read_b64_tr_b16 a[72:73], v244 offset:49152
  v_and_b32 v205, 0xffff0000, v6
  v_mfma_f32_16x16x32_bf16 v[44:47], a[76:79], a[52:55], v[44:47]
  buffer_load_dwordx4 v228, s[8:11], s17 offen offset:3072 lds
  v_mfma_f32_16x16x32_bf16 v[16:19], a[96:99], a[56:59], v[16:19]
  ds_read_b64_tr_b16 a[74:75], v244 offset:53248
  v_lshlrev_b32 v206, 16, v7
  s_add_u32 s17, s17, 458752
  v_mfma_f32_16x16x32_bf16 v[32:35], a[96:99], a[60:63], v[32:35]
  ds_read_b64_tr_b16 a[76:77], v245 offset:49152
  s_cmp_eq_u32 s17, s93
  v_mfma_f32_16x16x32_bf16 v[20:23], a[100:103], a[56:59], v[20:23]
  ds_read_b64_tr_b16 a[78:79], v245 offset:53248
  v_and_b32 v207, 0xffff0000, v7
  s_cselect_b32 s17, s95, s17
  v_mfma_f32_16x16x32_bf16 v[36:39], a[100:103], a[60:63], v[36:39]
  buffer_load_dwordx4 a[44:47], v241, s[4:7], s16 offen offset:1024 sc1
  v_mfma_f32_16x16x32_bf16 v[24:27], a[104:107], a[56:59], v[24:27]
  ds_read_b64_tr_b16 a[96:97], v242 offset:57344
  ds_read_b64_tr_b16 a[98:99], v242 offset:61440
  s_add_u32 s41, s41, 262144
  v_mfma_f32_16x16x32_bf16 v[40:43], a[104:107], a[60:63], v[40:43]
  ds_read_b64_tr_b16 a[100:101], v243 offset:57344
  s_bitset0_b32 s41, 21
  v_mfma_f32_16x16x32_bf16 v[28:31], a[108:111], a[56:59], v[28:31]
  ds_read_b64_tr_b16 a[102:103], v243 offset:61440
  ds_read_b128 v[60:63], v253 offset:832
  s_add_u32 s16, s40, s41
  v_mfma_f32_16x16x32_bf16 v[44:47], a[108:111], a[60:63], v[44:47]
  s_waitcnt vmcnt(17) lgkmcnt(10)
  s_barrier
  v_mfma_f32_16x16x32_bf16 v[72:75], a[80:83], a[0:3], v[72:75]
  ds_read_b64_tr_b16 a[104:105], v244 offset:57344
  ds_read_b64_tr_b16 a[106:107], v244 offset:61440
  s_add_u32 m0, s38, 131072
  v_mfma_f32_16x16x32_bf16 v[88:91], a[80:83], a[4:7], v[88:91]
  v_accvgpr_read_b32 v8, a136
  buffer_load_dwordx4 v225, s[8:11], s17 offen lds
  v_mfma_f32_16x16x32_bf16 v[76:79], a[84:87], a[0:3], v[76:79]
  ds_read_b64_tr_b16 a[108:109], v245 offset:57344
  ds_read_b64_tr_b16 a[110:111], v245 offset:61440
  v_mfma_f32_16x16x32_bf16 v[92:95], a[84:87], a[4:7], v[92:95]
  ds_read_b64_tr_b16 a[80:81], v104 offset:2048
  v_accvgpr_read_b32 v9, a137
  v_mfma_f32_16x16x32_bf16 v[80:83], a[88:91], a[0:3], v[80:83]
  ds_read_b64_tr_b16 a[82:83], v104 offset:6144
  buffer_load_dwordx4 a[48:51], v240, s[4:7], s16 offen offset:0 sc1
  v_mfma_f32_16x16x32_bf16 v[96:99], a[88:91], a[4:7], v[96:99]
  ds_read_b64_tr_b16 a[84:85], v105 offset:2048
  v_accvgpr_read_b32 v10, a138
  v_mfma_f32_16x16x32_bf16 v[84:87], a[92:95], a[0:3], v[84:87]
  ds_read_b64_tr_b16 a[86:87], v105 offset:6144
  ds_read_b64_tr_b16 a[88:89], v106 offset:2048
  v_mfma_f32_16x16x32_bf16 v[100:103], a[92:95], a[4:7], v[100:103]
  ds_read_b64_tr_b16 a[90:91], v106 offset:6144
  ds_read_b64_tr_b16 a[92:93], v107 offset:2048
  v_mfma_f32_16x16x32_bf16 v[72:75], a[112:115], a[8:11], v[72:75]
  v_accvgpr_read_b32 v11, a139
  buffer_load_dwordx4 v226, s[8:11], s17 offen offset:1024 lds
  v_mfma_f32_16x16x32_bf16 v[88:91], a[112:115], a[12:15], v[88:91]
  ds_read_b64_tr_b16 a[94:95], v107 offset:6144
  ds_read_b64_tr_b16 a[112:113], v104 offset:10240
  v_mfma_f32_16x16x32_bf16 v[76:79], a[116:119], a[8:11], v[76:79]
  ds_read_b64_tr_b16 a[114:115], v104 offset:14336
  v_lshlrev_b32 v208, 16, v8
  v_mfma_f32_16x16x32_bf16 v[92:95], a[116:119], a[12:15], v[92:95]
  ds_read_b64_tr_b16 a[116:117], v105 offset:10240
  ds_read_b64_tr_b16 a[118:119], v105 offset:14336
  v_mfma_f32_16x16x32_bf16 v[80:83], a[120:123], a[8:11], v[80:83]
  v_and_b32 v209, 0xffff0000, v8
  buffer_load_dwordx4 a[52:55], v240, s[4:7], s16 offen offset:1024 sc1
  v_mfma_f32_16x16x32_bf16 v[96:99], a[120:123], a[12:15], v[96:99]
  ds_read_b64_tr_b16 a[120:121], v106 offset:10240
  ds_read_b64_tr_b16 a[122:123], v106 offset:14336
  v_mfma_f32_16x16x32_bf16 v[84:87], a[124:127], a[8:11], v[84:87]
  v_mfma_f32_16x16x32_bf16 v[100:103], a[124:127], a[12:15], v[100:103]
  ds_read_b64_tr_b16 a[124:125], v107 offset:10240
  v_lshlrev_b32 v210, 16, v9
  v_mfma_f32_16x16x32_bf16 v[16:19], a[64:67], a[0:3], v[16:19]
  buffer_load_dwordx4 v227, s[8:11], s17 offen offset:2048 lds
  v_mfma_f32_16x16x32_bf16 v[32:35], a[64:67], a[4:7], v[32:35]
  ds_read_b64_tr_b16 a[126:127], v107 offset:14336
  v_and_b32 v211, 0xffff0000, v9
  s_waitcnt lgkmcnt(10)
  v_mfma_f32_16x16x32_bf16 v[20:23], a[68:71], a[0:3], v[20:23]
  ds_read_b64_tr_b16 a[64:65], v104 offset:0
  ds_read_b64_tr_b16 a[66:67], v104 offset:4096
  v_mfma_f32_16x16x32_bf16 v[36:39], a[68:71], a[4:7], v[36:39]
  ds_read_b64_tr_b16 a[68:69], v105 offset:0
  v_lshlrev_b32 v212, 16, v10
  v_mfma_f32_16x16x32_bf16 v[24:27], a[72:75], a[0:3], v[24:27]
  buffer_load_dwordx4 a[56:59], v241, s[4:7], s16 offen offset:0 sc1
  v_mfma_f32_16x16x32_bf16 v[40:43], a[72:75], a[4:7], v[40:43]
  ds_read_b64_tr_b16 a[70:71], v105 offset:4096
  ds_read_b64_tr_b16 a[72:73], v106 offset:0
  v_mfma_f32_16x16x32_bf16 v[28:31], a[76:79], a[0:3], v[28:31]
  v_and_b32 v213, 0xffff0000, v10
  buffer_load_dwordx4 v228, s[8:11], s17 offen offset:3072 lds
  v_mfma_f32_16x16x32_bf16 v[44:47], a[76:79], a[4:7], v[44:47]
  ds_read_b64_tr_b16 a[74:75], v106 offset:4096
  s_add_u32 s17, s17, 458752
  v_mfma_f32_16x16x32_bf16 v[16:19], a[96:99], a[8:11], v[16:19]
  v_lshlrev_b32 v214, 16, v11
  s_cmp_eq_u32 s17, s93
  v_mfma_f32_16x16x32_bf16 v[32:35], a[96:99], a[12:15], v[32:35]
  ds_read_b64_tr_b16 a[76:77], v107 offset:0
  s_cselect_b32 s17, s95, s17
  v_mfma_f32_16x16x32_bf16 v[20:23], a[100:103], a[8:11], v[20:23]
  ds_read_b64_tr_b16 a[78:79], v107 offset:4096
  v_and_b32 v215, 0xffff0000, v11
  buffer_load_dwordx4 a[60:63], v241, s[4:7], s16 offen offset:1024 sc1
  v_mfma_f32_16x16x32_bf16 v[36:39], a[100:103], a[12:15], v[36:39]
  ds_read_b64_tr_b16 a[96:97], v104 offset:8192
  s_add_u32 s41, s41, 262144
  v_mfma_f32_16x16x32_bf16 v[24:27], a[104:107], a[8:11], v[24:27]
  ds_read_b64_tr_b16 a[98:99], v104 offset:12288
  s_bitset0_b32 s41, 21
  v_mfma_f32_16x16x32_bf16 v[40:43], a[104:107], a[12:15], v[40:43]
  ds_read_b64_tr_b16 a[100:101], v105 offset:8192
  s_add_u32 s40, s40, 2097152
  v_mfma_f32_16x16x32_bf16 v[28:31], a[108:111], a[8:11], v[28:31]
  ds_read_b64_tr_b16 a[102:103], v105 offset:12288
  ds_read_b128 v[64:67], v253 offset:896
  s_add_u32 s16, s40, s41
  v_mfma_f32_16x16x32_bf16 v[44:47], a[108:111], a[12:15], v[44:47]
  s_waitcnt vmcnt(12) lgkmcnt(10)
  s_barrier
  v_cmp_ne_u32 vcc, s19, v247
  s_nop 1
  s_cmp_lg_u64 vcc, 0
  s_cbranch_scc1 L_slow_29
  L_back_30:
  s_add_u32 s94, s94, 65536
  v_mfma_f32_16x16x32_bf16 v[72:75], a[80:83], a[16:19], v[72:75]
  ds_read_b64_tr_b16 a[104:105], v106 offset:8192
  ds_read_b64_tr_b16 a[106:107], v106 offset:12288
  buffer_load_dwordx4 a[0:3], v240, s[4:7], s16 offen offset:0 sc1
  v_mfma_f32_16x16x32_bf16 v[88:91], a[80:83], a[20:23], v[88:91]
  ds_read_b64_tr_b16 a[108:109], v107 offset:8192
  v_accvgpr_read_b32 v12, a140
  v_mfma_f32_16x16x32_bf16 v[76:79], a[84:87], a[16:19], v[76:79]
  ds_read_b64_tr_b16 a[110:111], v107 offset:12288
  ds_read_b64_tr_b16 a[80:81], v104 offset:18432
  v_mfma_f32_16x16x32_bf16 v[92:95], a[84:87], a[20:23], v[92:95]
  ds_read_b64_tr_b16 a[82:83], v104 offset:22528
  v_accvgpr_read_b32 v13, a141
  v_mfma_f32_16x16x32_bf16 v[80:83], a[88:91], a[16:19], v[80:83]
  ds_read_b64_tr_b16 a[84:85], v105 offset:18432
  ds_read_b64_tr_b16 a[86:87], v105 offset:22528
  v_mfma_f32_16x16x32_bf16 v[96:99], a[88:91], a[20:23], v[96:99]
  ds_read_b64_tr_b16 a[88:89], v106 offset:18432
  v_accvgpr_read_b32 v14, a142
  v_mfma_f32_16x16x32_bf16 v[84:87], a[92:95], a[16:19], v[84:87]
  ds_read_b64_tr_b16 a[90:91], v106 offset:22528
  v_mfma_f32_16x16x32_bf16 v[100:103], a[92:95], a[20:23], v[100:103]
  buffer_load_dwordx4 a[4:7], v240, s[4:7], s16 offen offset:1024 sc1
  v_mfma_f32_16x16x32_bf16 v[72:75], a[112:115], a[24:27], v[72:75]
  ds_read_b64_tr_b16 a[92:93], v107 offset:18432
  v_accvgpr_read_b32 v15, a143
  v_mfma_f32_16x16x32_bf16 v[88:91], a[112:115], a[28:31], v[88:91]
  ds_read_b64_tr_b16 a[94:95], v107 offset:22528
  ds_read_b64_tr_b16 a[112:113], v104 offset:26624
  v_mfma_f32_16x16x32_bf16 v[76:79], a[116:119], a[24:27], v[76:79]
  ds_read_b64_tr_b16 a[114:115], v104 offset:30720
  v_lshlrev_b32 v216, 16, v12
  v_mfma_f32_16x16x32_bf16 v[92:95], a[116:119], a[28:31], v[92:95]
  ds_read_b64_tr_b16 a[116:117], v105 offset:26624
  ds_read_b64_tr_b16 a[118:119], v105 offset:30720
  v_mfma_f32_16x16x32_bf16 v[80:83], a[120:123], a[24:27], v[80:83]
  v_and_b32 v217, 0xffff0000, v12
  v_mfma_f32_16x16x32_bf16 v[96:99], a[120:123], a[28:31], v[96:99]
  ds_read_b64_tr_b16 a[120:121], v106 offset:26624
  ds_read_b64_tr_b16 a[122:123], v106 offset:30720
  v_mfma_f32_16x16x32_bf16 v[84:87], a[124:127], a[24:27], v[84:87]
  v_mfma_f32_16x16x32_bf16 v[100:103], a[124:127], a[28:31], v[100:103]
  v_lshlrev_b32 v218, 16, v13
  buffer_load_dwordx4 a[8:11], v241, s[4:7], s16 offen offset:0 sc1
  v_mfma_f32_16x16x32_bf16 v[16:19], a[64:67], a[16:19], v[16:19]
  ds_read_b64_tr_b16 a[124:125], v107 offset:26624
  ds_read_b64_tr_b16 a[126:127], v107 offset:30720
  v_mfma_f32_16x16x32_bf16 v[32:35], a[64:67], a[20:23], v[32:35]
  ds_read_b64_tr_b16 a[64:65], v104 offset:16384
  v_and_b32 v219, 0xffff0000, v13
  s_waitcnt lgkmcnt(10)
  v_mfma_f32_16x16x32_bf16 v[20:23], a[68:71], a[16:19], v[20:23]
  ds_read_b64_tr_b16 a[66:67], v104 offset:20480
  v_mfma_f32_16x16x32_bf16 v[36:39], a[68:71], a[20:23], v[36:39]
  ds_read_b64_tr_b16 a[68:69], v105 offset:16384
  v_lshlrev_b32 v220, 16, v14
  v_mfma_f32_16x16x32_bf16 v[24:27], a[72:75], a[16:19], v[24:27]
  ds_read_b64_tr_b16 a[70:71], v105 offset:20480
  v_mfma_f32_16x16x32_bf16 v[40:43], a[72:75], a[20:23], v[40:43]
  ds_read_b64_tr_b16 a[72:73], v106 offset:16384
  ds_read_b64_tr_b16 a[74:75], v106 offset:20480
  v_mfma_f32_16x16x32_bf16 v[28:31], a[76:79], a[16:19], v[28:31]
  v_and_b32 v221, 0xffff0000, v14
  v_mfma_f32_16x16x32_bf16 v[44:47], a[76:79], a[20:23], v[44:47]
  buffer_load_dwordx4 a[12:15], v241, s[4:7], s16 offen offset:1024 sc1
  v_mfma_f32_16x16x32_bf16 v[16:19], a[96:99], a[24:27], v[16:19]
  v_lshlrev_b32 v222, 16, v15
  s_add_u32 s41, s41, 262144
  v_mfma_f32_16x16x32_bf16 v[32:35], a[96:99], a[28:31], v[32:35]
  ds_read_b64_tr_b16 a[76:77], v107 offset:16384
  s_bitset0_b32 s41, 21
  v_mfma_f32_16x16x32_bf16 v[20:23], a[100:103], a[24:27], v[20:23]
  ds_read_b64_tr_b16 a[78:79], v107 offset:20480
  v_and_b32 v223, 0xffff0000, v15
  s_add_u32 s16, s40, s41
  v_mfma_f32_16x16x32_bf16 v[36:39], a[100:103], a[28:31], v[36:39]
  ds_read_b64_tr_b16 a[96:97], v104 offset:24576
  ds_read_b64_tr_b16 a[98:99], v104 offset:28672
  v_mfma_f32_16x16x32_bf16 v[24:27], a[104:107], a[24:27], v[24:27]
  ds_read_b64_tr_b16 a[100:101], v105 offset:24576
  ds_read_b64_tr_b16 a[102:103], v105 offset:28672
  v_mfma_f32_16x16x32_bf16 v[40:43], a[104:107], a[28:31], v[40:43]
  ds_read_b64_tr_b16 a[104:105], v106 offset:24576
  ds_read_b64_tr_b16 a[106:107], v106 offset:28672
  v_mfma_f32_16x16x32_bf16 v[28:31], a[108:111], a[24:27], v[28:31]
  ds_read_b128 v[68:71], v253 offset:960
  v_mfma_f32_16x16x32_bf16 v[44:47], a[108:111], a[28:31], v[44:47]
  s_waitcnt vmcnt(12) lgkmcnt(10)
  s_barrier
  v_mfma_f32_16x16x32_bf16 v[72:75], a[80:83], a[32:35], v[72:75]
  ds_read_b64_tr_b16 a[108:109], v107 offset:24576
  s_add_u32 m0, s38, 0
  v_mfma_f32_16x16x32_bf16 v[88:91], a[80:83], a[36:39], v[88:91]
  buffer_load_dwordx4 v225, s[8:11], s17 offen lds
  v_mfma_f32_16x16x32_bf16 v[76:79], a[84:87], a[32:35], v[76:79]
  ds_read_b64_tr_b16 a[110:111], v107 offset:28672
  ds_read_b64_tr_b16 a[80:81], v104 offset:34816
  v_mfma_f32_16x16x32_bf16 v[92:95], a[84:87], a[36:39], v[92:95]
  ds_read_b64_tr_b16 a[82:83], v104 offset:38912
  ds_read_b64_tr_b16 a[84:85], v105 offset:34816
  v_mfma_f32_16x16x32_bf16 v[80:83], a[88:91], a[32:35], v[80:83]
  buffer_load_dwordx4 a[16:19], v240, s[4:7], s16 offen offset:0 sc1
  v_mfma_f32_16x16x32_bf16 v[96:99], a[88:91], a[36:39], v[96:99]
  ds_read_b64_tr_b16 a[86:87], v105 offset:38912
  ds_read_b64_tr_b16 a[88:89], v106 offset:34816
  v_mfma_f32_16x16x32_bf16 v[84:87], a[92:95], a[32:35], v[84:87]
  ds_read_b64_tr_b16 a[90:91], v106 offset:38912
  v_mfma_f32_16x16x32_bf16 v[100:103], a[92:95], a[36:39], v[100:103]
  ds_read_b64_tr_b16 a[92:93], v107 offset:34816
  ds_read_b64_tr_b16 a[94:95], v107 offset:38912
  v_mfma_f32_16x16x32_bf16 v[72:75], a[112:115], a[40:43], v[72:75]
  buffer_load_dwordx4 v226, s[8:11], s17 offen offset:1024 lds
  v_mfma_f32_16x16x32_bf16 v[88:91], a[112:115], a[44:47], v[88:91]
  ds_read_b64_tr_b16 a[112:113], v104 offset:43008
  ds_read_b64_tr_b16 a[114:115], v104 offset:47104
  v_mfma_f32_16x16x32_bf16 v[76:79], a[116:119], a[40:43], v[76:79]
  v_mfma_f32_16x16x32_bf16 v[92:95], a[116:119], a[44:47], v[92:95]
  ds_read_b64_tr_b16 a[116:117], v105 offset:43008
  ds_read_b64_tr_b16 a[118:119], v105 offset:47104
  v_mfma_f32_16x16x32_bf16 v[80:83], a[120:123], a[40:43], v[80:83]
  buffer_load_dwordx4 a[20:23], v240, s[4:7], s16 offen offset:1024 sc1
  v_mfma_f32_16x16x32_bf16 v[96:99], a[120:123], a[44:47], v[96:99]
  ds_read_b64_tr_b16 a[120:121], v106 offset:43008
  ds_read_b64_tr_b16 a[122:123], v106 offset:47104
  v_mfma_f32_16x16x32_bf16 v[84:87], a[124:127], a[40:43], v[84:87]
  v_mfma_f32_16x16x32_bf16 v[100:103], a[124:127], a[44:47], v[100:103]
  ds_read_b64_tr_b16 a[124:125], v107 offset:43008
  ds_read_b64_tr_b16 a[126:127], v107 offset:47104
  v_mfma_f32_16x16x32_bf16 v[16:19], a[64:67], a[32:35], v[16:19]
  buffer_load_dwordx4 v227, s[8:11], s17 offen offset:2048 lds
  v_mfma_f32_16x16x32_bf16 v[32:35], a[64:67], a[36:39], v[32:35]
  ds_read_b64_tr_b16 a[64:65], v104 offset:32768
  ds_read_b64_tr_b16 a[66:67], v104 offset:36864
  v_mfma_f32_16x16x32_bf16 v[20:23], a[68:71], a[32:35], v[20:23]
  v_mfma_f32_16x16x32_bf16 v[36:39], a[68:71], a[36:39], v[36:39]
  ds_read_b64_tr_b16 a[68:69], v105 offset:32768
  ds_read_b64_tr_b16 a[70:71], v105 offset:36864
  s_waitcnt lgkmcnt(10)
  v_mfma_f32_16x16x32_bf16 v[24:27], a[72:75], a[32:35], v[24:27]
  buffer_load_dwordx4 a[24:27], v241, s[4:7], s16 offen offset:0 sc1
  v_mfma_f32_16x16x32_bf16 v[40:43], a[72:75], a[36:39], v[40:43]
  ds_read_b64_tr_b16 a[72:73], v106 offset:32768
  ds_read_b64_tr_b16 a[74:75], v106 offset:36864
  v_mfma_f32_16x16x32_bf16 v[28:31], a[76:79], a[32:35], v[28:31]
  v_mfma_f32_16x16x32_bf16 v[44:47], a[76:79], a[36:39], v[44:47]
  buffer_load_dwordx4 v228, s[8:11], s17 offen offset:3072 lds
  v_mfma_f32_16x16x32_bf16 v[16:19], a[96:99], a[40:43], v[16:19]
  ds_read_b64_tr_b16 a[76:77], v107 offset:32768
  s_add_u32 s17, s17, 458752
  v_mfma_f32_16x16x32_bf16 v[32:35], a[96:99], a[44:47], v[32:35]
  ds_read_b64_tr_b16 a[78:79], v107 offset:36864
  s_cmp_eq_u32 s17, s93
  v_mfma_f32_16x16x32_bf16 v[20:23], a[100:103], a[40:43], v[20:23]
  ds_read_b64_tr_b16 a[96:97], v104 offset:40960
  s_cselect_b32 s17, s95, s17
  v_mfma_f32_16x16x32_bf16 v[36:39], a[100:103], a[44:47], v[36:39]
  buffer_load_dwordx4 a[28:31], v241, s[4:7], s16 offen offset:1024 sc1
  v_mfma_f32_16x16x32_bf16 v[24:27], a[104:107], a[40:43], v[24:27]
  ds_read_b64_tr_b16 a[98:99], v104 offset:45056
  s_add_u32 s41, s41, 262144
  v_mfma_f32_16x16x32_bf16 v[40:43], a[104:107], a[44:47], v[40:43]
  ds_read_b64_tr_b16 a[100:101], v105 offset:40960
  s_bitset0_b32 s41, 21
  v_mfma_f32_16x16x32_bf16 v[28:31], a[108:111], a[40:43], v[28:31]
  ds_read_b64_tr_b16 a[102:103], v105 offset:45056
  s_add_u32 s16, s40, s41
  v_mfma_f32_16x16x32_bf16 v[44:47], a[108:111], a[44:47], v[44:47]
  s_waitcnt vmcnt(12) lgkmcnt(10)
  s_barrier
  v_mfma_f32_16x16x32_bf16 v[72:75], a[80:83], a[48:51], v[72:75]
  ds_read_b64_tr_b16 a[104:105], v106 offset:40960
  ds_read_b64_tr_b16 a[106:107], v106 offset:45056
  s_add_u32 m0, s38, 16384
  v_mfma_f32_16x16x32_bf16 v[88:91], a[80:83], a[52:55], v[88:91]
  buffer_load_dwordx4 v225, s[8:11], s17 offen lds
  v_mfma_f32_16x16x32_bf16 v[76:79], a[84:87], a[48:51], v[76:79]
  ds_read_b64_tr_b16 a[108:109], v107 offset:40960
  ds_read_b64_tr_b16 a[110:111], v107 offset:45056
  v_mfma_f32_16x16x32_bf16 v[92:95], a[84:87], a[52:55], v[92:95]
  ds_read_b64_tr_b16 a[80:81], v104 offset:51200
  ds_read_b64_tr_b16 a[82:83], v104 offset:55296
  v_mfma_f32_16x16x32_bf16 v[80:83], a[88:91], a[48:51], v[80:83]
  buffer_load_dwordx4 a[32:35], v240, s[4:7], s16 offen offset:0 sc1
  v_mfma_f32_16x16x32_bf16 v[96:99], a[88:91], a[52:55], v[96:99]
  ds_read_b64_tr_b16 a[84:85], v105 offset:51200
  ds_read_b64_tr_b16 a[86:87], v105 offset:55296
  v_mfma_f32_16x16x32_bf16 v[84:87], a[92:95], a[48:51], v[84:87]
  ds_read_b64_tr_b16 a[88:89], v106 offset:51200
  ds_read_b64_tr_b16 a[90:91], v106 offset:55296
  v_mfma_f32_16x16x32_bf16 v[100:103], a[92:95], a[52:55], v[100:103]
  ds_read_b64_tr_b16 a[92:93], v107 offset:51200
  ds_read_b64_tr_b16 a[94:95], v107 offset:55296
  v_mfma_f32_16x16x32_bf16 v[72:75], a[112:115], a[56:59], v[72:75]
  buffer_load_dwordx4 v226, s[8:11], s17 offen offset:1024 lds
  v_mfma_f32_16x16x32_bf16 v[88:91], a[112:115], a[60:63], v[88:91]
  ds_read_b64_tr_b16 a[112:113], v104 offset:59392
  ds_read_b64_tr_b16 a[114:115], v104 offset:63488
  v_mfma_f32_16x16x32_bf16 v[76:79], a[116:119], a[56:59], v[76:79]
  v_mfma_f32_16x16x32_bf16 v[92:95], a[116:119], a[60:63], v[92:95]
  ds_read_b64_tr_b16 a[116:117], v105 offset:59392
  ds_read_b64_tr_b16 a[118:119], v105 offset:63488
  v_mfma_f32_16x16x32_bf16 v[80:83], a[120:123], a[56:59], v[80:83]
  buffer_load_dwordx4 a[36:39], v240, s[4:7], s16 offen offset:1024 sc1
  v_mfma_f32_16x16x32_bf16 v[96:99], a[120:123], a[60:63], v[96:99]
  ds_read_b64_tr_b16 a[120:121], v106 offset:59392
  ds_read_b64_tr_b16 a[122:123], v106 offset:63488
  v_mfma_f32_16x16x32_bf16 v[84:87], a[124:127], a[56:59], v[84:87]
  v_mfma_f32_16x16x32_bf16 v[100:103], a[124:127], a[60:63], v[100:103]
  ds_read_b64_tr_b16 a[124:125], v107 offset:59392
  ds_read_b64_tr_b16 a[126:127], v107 offset:63488
  v_mfma_f32_16x16x32_bf16 v[16:19], a[64:67], a[48:51], v[16:19]
  buffer_load_dwordx4 v227, s[8:11], s17 offen offset:2048 lds
  v_mfma_f32_16x16x32_bf16 v[32:35], a[64:67], a[52:55], v[32:35]
  ds_read_b64_tr_b16 a[64:65], v104 offset:49152
  ds_read_b64_tr_b16 a[66:67], v104 offset:53248
  s_waitcnt lgkmcnt(10)
  v_mfma_f32_16x16x32_bf16 v[20:23], a[68:71], a[48:51], v[20:23]
  v_mfma_f32_16x16x32_bf16 v[36:39], a[68:71], a[52:55], v[36:39]
  ds_read_b64_tr_b16 a[68:69], v105 offset:49152
  ds_read_b64_tr_b16 a[70:71], v105 offset:53248
  v_mfma_f32_16x16x32_bf16 v[24:27], a[72:75], a[48:51], v[24:27]
  buffer_load_dwordx4 a[40:43], v241, s[4:7], s16 offen offset:0 sc1
  v_mfma_f32_16x16x32_bf16 v[40:43], a[72:75], a[52:55], v[40:43]
  ds_read_b64_tr_b16 a[72:73], v106 offset:49152
  ds_read_b64_tr_b16 a[74:75], v106 offset:53248
  v_mfma_f32_16x16x32_bf16 v[28:31], a[76:79], a[48:51], v[28:31]
  v_mfma_f32_16x16x32_bf16 v[44:47], a[76:79], a[52:55], v[44:47]
  buffer_load_dwordx4 v228, s[8:11], s17 offen offset:3072 lds
  v_mfma_f32_16x16x32_bf16 v[16:19], a[96:99], a[56:59], v[16:19]
  ds_read_b64_tr_b16 a[76:77], v107 offset:49152
  s_add_u32 s17, s17, 458752
  v_mfma_f32_16x16x32_bf16 v[32:35], a[96:99], a[60:63], v[32:35]
  ds_read_b64_tr_b16 a[78:79], v107 offset:53248
  s_cmp_eq_u32 s17, s93
  v_mfma_f32_16x16x32_bf16 v[20:23], a[100:103], a[56:59], v[20:23]
  ds_read_b64_tr_b16 a[96:97], v104 offset:57344
  s_cselect_b32 s17, s95, s17
  v_mfma_f32_16x16x32_bf16 v[36:39], a[100:103], a[60:63], v[36:39]
  buffer_load_dwordx4 a[44:47], v241, s[4:7], s16 offen offset:1024 sc1
  v_mfma_f32_16x16x32_bf16 v[24:27], a[104:107], a[56:59], v[24:27]
  ds_read_b64_tr_b16 a[98:99], v104 offset:61440
  s_add_u32 s41, s41, 262144
  v_mfma_f32_16x16x32_bf16 v[40:43], a[104:107], a[60:63], v[40:43]
  ds_read_b64_tr_b16 a[100:101], v105 offset:57344
  s_bitset0_b32 s41, 21
  v_mfma_f32_16x16x32_bf16 v[28:31], a[108:111], a[56:59], v[28:31]
  ds_read_b64_tr_b16 a[102:103], v105 offset:61440
  s_add_u32 s16, s40, s41
  v_mfma_f32_16x16x32_bf16 v[44:47], a[108:111], a[60:63], v[44:47]
  s_waitcnt vmcnt(16) lgkmcnt(10)
  s_barrier
  v_mfma_f32_16x16x32_bf16 v[72:75], a[80:83], a[0:3], v[72:75]
  ds_read_b64_tr_b16 a[104:105], v106 offset:57344
  ds_read_b64_tr_b16 a[106:107], v106 offset:61440
  s_add_u32 m0, s38, 32768
  v_mfma_f32_16x16x32_bf16 v[88:91], a[80:83], a[4:7], v[88:91]
  buffer_load_dwordx4 v225, s[8:11], s17 offen lds
  v_mfma_f32_16x16x32_bf16 v[76:79], a[84:87], a[0:3], v[76:79]
  ds_read_b64_tr_b16 a[108:109], v107 offset:57344
  ds_read_b64_tr_b16 a[110:111], v107 offset:61440
  v_mfma_f32_16x16x32_bf16 v[92:95], a[84:87], a[4:7], v[92:95]
  ds_read_b64_tr_b16 a[80:81], v124 offset:2048
  ds_read_b64_tr_b16 a[82:83], v124 offset:6144
  v_mfma_f32_16x16x32_bf16 v[80:83], a[88:91], a[0:3], v[80:83]
  buffer_load_dwordx4 a[48:51], v240, s[4:7], s16 offen offset:0 sc1
  v_mfma_f32_16x16x32_bf16 v[96:99], a[88:91], a[4:7], v[96:99]
  ds_read_b64_tr_b16 a[84:85], v125 offset:2048
  ds_read_b64_tr_b16 a[86:87], v125 offset:6144
  v_mfma_f32_16x16x32_bf16 v[84:87], a[92:95], a[0:3], v[84:87]
  ds_read_b64_tr_b16 a[88:89], v126 offset:2048
  ds_read_b64_tr_b16 a[90:91], v126 offset:6144
  v_mfma_f32_16x16x32_bf16 v[100:103], a[92:95], a[4:7], v[100:103]
  ds_read_b64_tr_b16 a[92:93], v127 offset:2048
  ds_read_b64_tr_b16 a[94:95], v127 offset:6144
  v_mfma_f32_16x16x32_bf16 v[72:75], a[112:115], a[8:11], v[72:75]
  buffer_load_dwordx4 v226, s[8:11], s17 offen offset:1024 lds
  v_mfma_f32_16x16x32_bf16 v[88:91], a[112:115], a[12:15], v[88:91]
  ds_read_b64_tr_b16 a[112:113], v124 offset:10240
  ds_read_b64_tr_b16 a[114:115], v124 offset:14336
  v_mfma_f32_16x16x32_bf16 v[76:79], a[116:119], a[8:11], v[76:79]
  v_mfma_f32_16x16x32_bf16 v[92:95], a[116:119], a[12:15], v[92:95]
  ds_read_b64_tr_b16 a[116:117], v125 offset:10240
  ds_read_b64_tr_b16 a[118:119], v125 offset:14336
  v_mfma_f32_16x16x32_bf16 v[80:83], a[120:123], a[8:11], v[80:83]
  buffer_load_dwordx4 a[52:55], v240, s[4:7], s16 offen offset:1024 sc1
  v_mfma_f32_16x16x32_bf16 v[96:99], a[120:123], a[12:15], v[96:99]
  ds_read_b64_tr_b16 a[120:121], v126 offset:10240
  ds_read_b64_tr_b16 a[122:123], v126 offset:14336
  v_mfma_f32_16x16x32_bf16 v[84:87], a[124:127], a[8:11], v[84:87]
  v_mfma_f32_16x16x32_bf16 v[100:103], a[124:127], a[12:15], v[100:103]
  ds_read_b64_tr_b16 a[124:125], v127 offset:10240
  ds_read_b64_tr_b16 a[126:127], v127 offset:14336
  v_mfma_f32_16x16x32_bf16 v[16:19], a[64:67], a[0:3], v[16:19]
  buffer_load_dwordx4 v227, s[8:11], s17 offen offset:2048 lds
  v_mfma_f32_16x16x32_bf16 v[32:35], a[64:67], a[4:7], v[32:35]
  ds_read_b64_tr_b16 a[64:65], v124 offset:0
  ds_read_b64_tr_b16 a[66:67], v124 offset:4096
  s_waitcnt lgkmcnt(10)
  v_mfma_f32_16x16x32_bf16 v[20:23], a[68:71], a[0:3], v[20:23]
  v_mfma_f32_16x16x32_bf16 v[36:39], a[68:71], a[4:7], v[36:39]
  ds_read_b64_tr_b16 a[68:69], v125 offset:0
  ds_read_b64_tr_b16 a[70:71], v125 offset:4096
  v_mfma_f32_16x16x32_bf16 v[24:27], a[72:75], a[0:3], v[24:27]
  buffer_load_dwordx4 a[56:59], v241, s[4:7], s16 offen offset:0 sc1
  v_mfma_f32_16x16x32_bf16 v[40:43], a[72:75], a[4:7], v[40:43]
  ds_read_b64_tr_b16 a[72:73], v126 offset:0
  ds_read_b64_tr_b16 a[74:75], v126 offset:4096
  v_mfma_f32_16x16x32_bf16 v[28:31], a[76:79], a[0:3], v[28:31]
  v_mfma_f32_16x16x32_bf16 v[44:47], a[76:79], a[4:7], v[44:47]
  buffer_load_dwordx4 v228, s[8:11], s17 offen offset:3072 lds
  v_mfma_f32_16x16x32_bf16 v[16:19], a[96:99], a[8:11], v[16:19]
  ds_read_b64_tr_b16 a[76:77], v127 offset:0
  s_add_u32 s17, s17, 458752
  v_mfma_f32_16x16x32_bf16 v[32:35], a[96:99], a[12:15], v[32:35]
  ds_read_b64_tr_b16 a[78:79], v127 offset:4096
  s_cmp_eq_u32 s17, s93
  v_mfma_f32_16x16x32_bf16 v[20:23], a[100:103], a[8:11], v[20:23]
  ds_read_b64_tr_b16 a[96:97], v124 offset:8192
  s_cselect_b32 s17, s95, s17
  v_mfma_f32_16x16x32_bf16 v[36:39], a[100:103], a[12:15], v[36:39]
  buffer_load_dwordx4 a[60:63], v241, s[4:7], s16 offen offset:1024 sc1
  v_mfma_f32_16x16x32_bf16 v[24:27], a[104:107], a[8:11], v[24:27]
  ds_read_b64_tr_b16 a[98:99], v124 offset:12288
  s_add_u32 s41, s41, 262144
  v_mfma_f32_16x16x32_bf16 v[40:43], a[104:107], a[12:15], v[40:43]
  ds_read_b64_tr_b16 a[100:101], v125 offset:8192
  s_bitset0_b32 s41, 21
  v_mfma_f32_16x16x32_bf16 v[28:31], a[108:111], a[8:11], v[28:31]
  ds_read_b64_tr_b16 a[102:103], v125 offset:12288
  s_add_u32 s16, s40, s41
  v_mfma_f32_16x16x32_bf16 v[44:47], a[108:111], a[12:15], v[44:47]
  s_waitcnt vmcnt(16) lgkmcnt(10)
  s_barrier
  v_mfma_f32_16x16x32_bf16 v[72:75], a[80:83], a[16:19], v[72:75]
  ds_read_b64_tr_b16 a[104:105], v126 offset:8192
  ds_read_b64_tr_b16 a[106:107], v126 offset:12288
  s_add_u32 m0, s38, 49152
  v_mfma_f32_16x16x32_bf16 v[88:91], a[80:83], a[20:23], v[88:91]
  buffer_load_dwordx4 v225, s[8:11], s17 offen lds
  v_mfma_f32_16x16x32_bf16 v[76:79], a[84:87], a[16:19], v[76:79]
  ds_read_b64_tr_b16 a[108:109], v127 offset:8192
  ds_read_b64_tr_b16 a[110:111], v127 offset:12288
  v_mfma_f32_16x16x32_bf16 v[92:95], a[84:87], a[20:23], v[92:95]
  ds_read_b64_tr_b16 a[80:81], v242 offset:2048
  ds_read_b64_tr_b16 a[82:83], v242 offset:6144
  v_mfma_f32_16x16x32_bf16 v[80:83], a[88:91], a[16:19], v[80:83]
  buffer_load_dwordx4 a[0:3], v240, s[4:7], s16 offen offset:0 sc1
  v_mfma_f32_16x16x32_bf16 v[96:99], a[88:91], a[20:23], v[96:99]
  ds_read_b64_tr_b16 a[84:85], v243 offset:2048
  ds_read_b64_tr_b16 a[86:87], v243 offset:6144
  v_mfma_f32_16x16x32_bf16 v[84:87], a[92:95], a[16:19], v[84:87]
  ds_read_b64_tr_b16 a[88:89], v244 offset:2048
  ds_read_b64_tr_b16 a[90:91], v244 offset:6144
  v_mfma_f32_16x16x32_bf16 v[100:103], a[92:95], a[20:23], v[100:103]
  ds_read_b64_tr_b16 a[92:93], v245 offset:2048
  ds_read_b64_tr_b16 a[94:95], v245 offset:6144
  v_mfma_f32_16x16x32_bf16 v[72:75], a[112:115], a[24:27], v[72:75]
  buffer_load_dwordx4 v226, s[8:11], s17 offen offset:1024 lds
  v_mfma_f32_16x16x32_bf16 v[88:91], a[112:115], a[28:31], v[88:91]
  ds_read_b64_tr_b16 a[112:113], v242 offset:10240
  ds_read_b64_tr_b16 a[114:115], v242 offset:14336
  v_mfma_f32_16x16x32_bf16 v[76:79], a[116:119], a[24:27], v[76:79]
  v_mfma_f32_16x16x32_bf16 v[92:95], a[116:119], a[28:31], v[92:95]
  ds_read_b64_tr_b16 a[116:117], v243 offset:10240
  ds_read_b64_tr_b16 a[118:119], v243 offset:14336
  v_mfma_f32_16x16x32_bf16 v[80:83], a[120:123], a[24:27], v[80:83]
  buffer_load_dwordx4 a[4:7], v240, s[4:7], s16 offen offset:1024 sc1
  v_mfma_f32_16x16x32_bf16 v[96:99], a[120:123], a[28:31], v[96:99]
  ds_read_b64_tr_b16 a[120:121], v244 offset:10240
  ds_read_b64_tr_b16 a[122:123], v244 offset:14336
  v_mfma_f32_16x16x32_bf16 v[84:87], a[124:127], a[24:27], v[84:87]
  v_mfma_f32_16x16x32_bf16 v[100:103], a[124:127], a[28:31], v[100:103]
  ds_read_b64_tr_b16 a[124:125], v245 offset:10240
  ds_read_b64_tr_b16 a[126:127], v245 offset:14336
  v_mfma_f32_16x16x32_bf16 v[16:19], a[64:67], a[16:19], v[16:19]
  buffer_load_dwordx4 v227, s[8:11], s17 offen offset:2048 lds
  v_mfma_f32_16x16x32_bf16 v[32:35], a[64:67], a[20:23], v[32:35]
  ds_read_b64_tr_b16 a[64:65], v242 offset:0
  ds_read_b64_tr_b16 a[66:67], v242 offset:4096
  s_waitcnt lgkmcnt(10)
  v_mfma_f32_16x16x32_bf16 v[20:23], a[68:71], a[16:19], v[20:23]
  v_mfma_f32_16x16x32_bf16 v[36:39], a[68:71], a[20:23], v[36:39]
  ds_read_b64_tr_b16 a[68:69], v243 offset:0
  ds_read_b64_tr_b16 a[70:71], v243 offset:4096
  v_mfma_f32_16x16x32_bf16 v[24:27], a[72:75], a[16:19], v[24:27]
  buffer_load_dwordx4 a[8:11], v241, s[4:7], s16 offen offset:0 sc1
  v_mfma_f32_16x16x32_bf16 v[40:43], a[72:75], a[20:23], v[40:43]
  ds_read_b64_tr_b16 a[72:73], v244 offset:0
  ds_read_b64_tr_b16 a[74:75], v244 offset:4096
  v_mfma_f32_16x16x32_bf16 v[28:31], a[76:79], a[16:19], v[28:31]
  v_mfma_f32_16x16x32_bf16 v[44:47], a[76:79], a[20:23], v[44:47]
  buffer_load_dwordx4 v228, s[8:11], s17 offen offset:3072 lds
  v_mfma_f32_16x16x32_bf16 v[16:19], a[96:99], a[24:27], v[16:19]
  ds_read_b64_tr_b16 a[76:77], v245 offset:0
  s_add_u32 s17, s17, 458752
  v_mfma_f32_16x16x32_bf16 v[32:35], a[96:99], a[28:31], v[32:35]
  ds_read_b64_tr_b16 a[78:79], v245 offset:4096
  s_cmp_eq_u32 s17, s93
  v_mfma_f32_16x16x32_bf16 v[20:23], a[100:103], a[24:27], v[20:23]
  ds_read_b64_tr_b16 a[96:97], v242 offset:8192
  s_cselect_b32 s17, s95, s17
  v_mfma_f32_16x16x32_bf16 v[36:39], a[100:103], a[28:31], v[36:39]
  buffer_load_dwordx4 a[12:15], v241, s[4:7], s16 offen offset:1024 sc1
  v_mfma_f32_16x16x32_bf16 v[24:27], a[104:107], a[24:27], v[24:27]
  ds_read_b64_tr_b16 a[98:99], v242 offset:12288
  s_add_u32 s41, s41, 262144
  v_mfma_f32_16x16x32_bf16 v[40:43], a[104:107], a[28:31], v[40:43]
  ds_read_b64_tr_b16 a[100:101], v243 offset:8192
  s_bitset0_b32 s41, 21
  v_mfma_f32_16x16x32_bf16 v[28:31], a[108:111], a[24:27], v[28:31]
  ds_read_b64_tr_b16 a[102:103], v243 offset:12288
  s_add_u32 s16, s40, s41
  v_mfma_f32_16x16x32_bf16 v[44:47], a[108:111], a[28:31], v[44:47]
  s_waitcnt vmcnt(16) lgkmcnt(10)
  s_barrier
  v_mfma_f32_16x16x32_bf16 v[72:75], a[80:83], a[32:35], v[72:75]
  ds_read_b64_tr_b16 a[104:105], v244 offset:8192
  ds_read_b64_tr_b16 a[106:107], v244 offset:12288
  s_add_u32 m0, s38, 65536
  v_mfma_f32_16x16x32_bf16 v[88:91], a[80:83], a[36:39], v[88:91]
  buffer_load_dwordx4 v225, s[8:11], s17 offen lds
  v_mfma_f32_16x16x32_bf16 v[76:79], a[84:87], a[32:35], v[76:79]
  ds_read_b64_tr_b16 a[108:109], v245 offset:8192
  ds_read_b64_tr_b16 a[110:111], v245 offset:12288
  v_mfma_f32_16x16x32_bf16 v[92:95], a[84:87], a[36:39], v[92:95]
  ds_read_b64_tr_b16 a[80:81], v242 offset:18432
  ds_read_b64_tr_b16 a[82:83], v242 offset:22528
  v_mfma_f32_16x16x32_bf16 v[80:83], a[88:91], a[32:35], v[80:83]
  buffer_load_dwordx4 a[16:19], v240, s[4:7], s16 offen offset:0 sc1
  v_mfma_f32_16x16x32_bf16 v[96:99], a[88:91], a[36:39], v[96:99]
  ds_read_b64_tr_b16 a[84:85], v243 offset:18432
  ds_read_b64_tr_b16 a[86:87], v243 offset:22528
  v_mfma_f32_16x16x32_bf16 v[84:87], a[92:95], a[32:35], v[84:87]
  ds_read_b64_tr_b16 a[88:89], v244 offset:18432
  ds_read_b64_tr_b16 a[90:91], v244 offset:22528
  v_mfma_f32_16x16x32_bf16 v[100:103], a[92:95], a[36:39], v[100:103]
  ds_read_b64_tr_b16 a[92:93], v245 offset:18432
  ds_read_b64_tr_b16 a[94:95], v245 offset:22528
  v_mfma_f32_16x16x32_bf16 v[72:75], a[112:115], a[40:43], v[72:75]
  buffer_load_dwordx4 v226, s[8:11], s17 offen offset:1024 lds
  v_mfma_f32_16x16x32_bf16 v[88:91], a[112:115], a[44:47], v[88:91]
  ds_read_b64_tr_b16 a[112:113], v242 offset:26624
  ds_read_b64_tr_b16 a[114:115], v242 offset:30720
  v_mfma_f32_16x16x32_bf16 v[76:79], a[116:119], a[40:43], v[76:79]
  v_mfma_f32_16x16x32_bf16 v[92:95], a[116:119], a[44:47], v[92:95]
  ds_read_b64_tr_b16 a[116:117], v243 offset:26624
  ds_read_b64_tr_b16 a[118:119], v243 offset:30720
  v_mfma_f32_16x16x32_bf16 v[80:83], a[120:123], a[40:43], v[80:83]
  buffer_load_dwordx4 a[20:23], v240, s[4:7], s16 offen offset:1024 sc1
  v_mfma_f32_16x16x32_bf16 v[96:99], a[120:123], a[44:47], v[96:99]
  ds_read_b64_tr_b16 a[120:121], v244 offset:26624
  ds_read_b64_tr_b16 a[122:123], v244 offset:30720
  v_mfma_f32_16x16x32_bf16 v[84:87], a[124:127], a[40:43], v[84:87]
  v_mfma_f32_16x16x32_bf16 v[100:103], a[124:127], a[44:47], v[100:103]
  ds_read_b64_tr_b16 a[124:125], v245 offset:26624
  ds_read_b64_tr_b16 a[126:127], v245 offset:30720
  v_mfma_f32_16x16x32_bf16 v[16:19], a[64:67], a[32:35], v[16:19]
  buffer_load_dwordx4 v227, s[8:11], s17 offen offset:2048 lds
  v_mfma_f32_16x16x32_bf16 v[32:35], a[64:67], a[36:39], v[32:35]
  ds_read_b64_tr_b16 a[64:65], v242 offset:16384
  ds_read_b64_tr_b16 a[66:67], v242 offset:20480
  s_waitcnt lgkmcnt(10)
  v_mfma_f32_16x16x32_bf16 v[20:23], a[68:71], a[32:35], v[20:23]
  v_mfma_f32_16x16x32_bf16 v[36:39], a[68:71], a[36:39], v[36:39]
  ds_read_b64_tr_b16 a[68:69], v243 offset:16384
  ds_read_b64_tr_b16 a[70:71], v243 offset:20480
  v_mfma_f32_16x16x32_bf16 v[24:27], a[72:75], a[32:35], v[24:27]
  buffer_load_dwordx4 a[24:27], v241, s[4:7], s16 offen offset:0 sc1
  v_mfma_f32_16x16x32_bf16 v[40:43], a[72:75], a[36:39], v[40:43]
  ds_read_b64_tr_b16 a[72:73], v244 offset:16384
  ds_read_b64_tr_b16 a[74:75], v244 offset:20480
  v_mfma_f32_16x16x32_bf16 v[28:31], a[76:79], a[32:35], v[28:31]
  v_mfma_f32_16x16x32_bf16 v[44:47], a[76:79], a[36:39], v[44:47]
  buffer_load_dwordx4 v228, s[8:11], s17 offen offset:3072 lds
  v_mfma_f32_16x16x32_bf16 v[16:19], a[96:99], a[40:43], v[16:19]
  ds_read_b64_tr_b16 a[76:77], v245 offset:16384
  s_add_u32 s17, s17, 458752
  v_mfma_f32_16x16x32_bf16 v[32:35], a[96:99], a[44:47], v[32:35]
  ds_read_b64_tr_b16 a[78:79], v245 offset:20480
  s_cmp_eq_u32 s17, s93
  v_mfma_f32_16x16x32_bf16 v[20:23], a[100:103], a[40:43], v[20:23]
  ds_read_b64_tr_b16 a[96:97], v242 offset:24576
  s_cselect_b32 s17, s95, s17
  v_mfma_f32_16x16x32_bf16 v[36:39], a[100:103], a[44:47], v[36:39]
  buffer_load_dwordx4 a[28:31], v241, s[4:7], s16 offen offset:1024 sc1
  v_mfma_f32_16x16x32_bf16 v[24:27], a[104:107], a[40:43], v[24:27]
  ds_read_b64_tr_b16 a[98:99], v242 offset:28672
  s_add_u32 s41, s41, 262144
  v_mfma_f32_16x16x32_bf16 v[40:43], a[104:107], a[44:47], v[40:43]
  ds_read_b64_tr_b16 a[100:101], v243 offset:24576
  s_bitset0_b32 s41, 21
  v_mfma_f32_16x16x32_bf16 v[28:31], a[108:111], a[40:43], v[28:31]
  ds_read_b64_tr_b16 a[102:103], v243 offset:28672
  s_add_u32 s16, s40, s41
  v_mfma_f32_16x16x32_bf16 v[44:47], a[108:111], a[44:47], v[44:47]
  s_waitcnt vmcnt(16) lgkmcnt(10)
  s_barrier
  v_mfma_f32_16x16x32_bf16 v[72:75], a[80:83], a[48:51], v[72:75]
  ds_read_b64_tr_b16 a[104:105], v244 offset:24576
  ds_read_b64_tr_b16 a[106:107], v244 offset:28672
  s_add_u32 m0, s38, 81920
  v_mfma_f32_16x16x32_bf16 v[88:91], a[80:83], a[52:55], v[88:91]
  buffer_load_dwordx4 v225, s[8:11], s17 offen lds
  v_mfma_f32_16x16x32_bf16 v[76:79], a[84:87], a[48:51], v[76:79]
  ds_read_b64_tr_b16 a[108:109], v245 offset:24576
  ds_read_b64_tr_b16 a[110:111], v245 offset:28672
  v_mfma_f32_16x16x32_bf16 v[92:95], a[84:87], a[52:55], v[92:95]
  ds_read_b64_tr_b16 a[80:81], v242 offset:34816
  ds_read_b64_tr_b16 a[82:83], v242 offset:38912
  v_mfma_f32_16x16x32_bf16 v[80:83], a[88:91], a[48:51], v[80:83]
  buffer_load_dwordx4 a[32:35], v240, s[4:7], s16 offen offset:0 sc1
  v_mfma_f32_16x16x32_bf16 v[96:99], a[88:91], a[52:55], v[96:99]
  ds_read_b64_tr_b16 a[84:85], v243 offset:34816
  ds_read_b64_tr_b16 a[86:87], v243 offset:38912
  v_mfma_f32_16x16x32_bf16 v[84:87], a[92:95], a[48:51], v[84:87]
  ds_read_b64_tr_b16 a[88:89], v244 offset:34816
  ds_read_b64_tr_b16 a[90:91], v244 offset:38912
  v_mfma_f32_16x16x32_bf16 v[100:103], a[92:95], a[52:55], v[100:103]
  ds_read_b64_tr_b16 a[92:93], v245 offset:34816
  ds_read_b64_tr_b16 a[94:95], v245 offset:38912
  v_mfma_f32_16x16x32_bf16 v[72:75], a[112:115], a[56:59], v[72:75]
  buffer_load_dwordx4 v226, s[8:11], s17 offen offset:1024 lds
  v_mfma_f32_16x16x32_bf16 v[88:91], a[112:115], a[60:63], v[88:91]
  ds_read_b64_tr_b16 a[112:113], v242 offset:43008
  ds_read_b64_tr_b16 a[114:115], v242 offset:47104
  v_mfma_f32_16x16x32_bf16 v[76:79], a[116:119], a[56:59], v[76:79]
  v_mfma_f32_16x16x32_bf16 v[92:95], a[116:119], a[60:63], v[92:95]
  ds_read_b64_tr_b16 a[116:117], v243 offset:43008
  ds_read_b64_tr_b16 a[118:119], v243 offset:47104
  v_mfma_f32_16x16x32_bf16 v[80:83], a[120:123], a[56:59], v[80:83]
  buffer_load_dwordx4 a[36:39], v240, s[4:7], s16 offen offset:1024 sc1
  v_mfma_f32_16x16x32_bf16 v[96:99], a[120:123], a[60:63], v[96:99]
  ds_read_b64_tr_b16 a[120:121], v244 offset:43008
  ds_read_b64_tr_b16 a[122:123], v244 offset:47104
  v_mfma_f32_16x16x32_bf16 v[84:87], a[124:127], a[56:59], v[84:87]
  v_mfma_f32_16x16x32_bf16 v[100:103], a[124:127], a[60:63], v[100:103]
  ds_read_b64_tr_b16 a[124:125], v245 offset:43008
  ds_read_b64_tr_b16 a[126:127], v245 offset:47104
  v_mfma_f32_16x16x32_bf16 v[16:19], a[64:67], a[48:51], v[16:19]
  buffer_load_dwordx4 v227, s[8:11], s17 offen offset:2048 lds
  v_mfma_f32_16x16x32_bf16 v[32:35], a[64:67], a[52:55], v[32:35]
  ds_read_b64_tr_b16 a[64:65], v242 offset:32768
  ds_read_b64_tr_b16 a[66:67], v242 offset:36864
  s_waitcnt lgkmcnt(10)
  v_mfma_f32_16x16x32_bf16 v[20:23], a[68:71], a[48:51], v[20:23]
  v_mfma_f32_16x16x32_bf16 v[36:39], a[68:71], a[52:55], v[36:39]
  ds_read_b64_tr_b16 a[68:69], v243 offset:32768
  ds_read_b64_tr_b16 a[70:71], v243 offset:36864
  v_mfma_f32_16x16x32_bf16 v[24:27], a[72:75], a[48:51], v[24:27]
  buffer_load_dwordx4 a[40:43], v241, s[4:7], s16 offen offset:0 sc1
  v_mfma_f32_16x16x32_bf16 v[40:43], a[72:75], a[52:55], v[40:43]
  ds_read_b64_tr_b16 a[72:73], v244 offset:32768
  ds_read_b64_tr_b16 a[74:75], v244 offset:36864
  v_mfma_f32_16x16x32_bf16 v[28:31], a[76:79], a[48:51], v[28:31]
  v_mfma_f32_16x16x32_bf16 v[44:47], a[76:79], a[52:55], v[44:47]
  ds_read_b64_tr_b16 a[76:77], v245 offset:32768
  ds_read_b64_tr_b16 a[78:79], v245 offset:36864
  v_mfma_f32_16x16x32_bf16 v[16:19], a[96:99], a[56:59], v[16:19]
  buffer_load_dwordx4 v228, s[8:11], s17 offen offset:3072 lds
  v_mfma_f32_16x16x32_bf16 v[32:35], a[96:99], a[60:63], v[32:35]
  ds_read_b64_tr_b16 a[96:97], v242 offset:40960
  s_mov_b32 s17, s97
  v_mfma_f32_16x16x32_bf16 v[20:23], a[100:103], a[56:59], v[20:23]
  ds_read_b64_tr_b16 a[98:99], v242 offset:45056
  v_mfma_f32_16x16x32_bf16 v[36:39], a[100:103], a[60:63], v[36:39]
  buffer_load_dwordx4 a[44:47], v241, s[4:7], s16 offen offset:1024 sc1
  v_mfma_f32_16x16x32_bf16 v[24:27], a[104:107], a[56:59], v[24:27]
  ds_read_b64_tr_b16 a[100:101], v243 offset:40960
  s_add_u32 s41, s41, 262144
  v_mfma_f32_16x16x32_bf16 v[40:43], a[104:107], a[60:63], v[40:43]
  ds_read_b64_tr_b16 a[102:103], v243 offset:45056
  s_bitset0_b32 s41, 21
  v_mfma_f32_16x16x32_bf16 v[28:31], a[108:111], a[56:59], v[28:31]
  ds_read_b64_tr_b16 a[104:105], v244 offset:40960
  s_add_u32 s16, s40, s41
  v_mfma_f32_16x16x32_bf16 v[44:47], a[108:111], a[60:63], v[44:47]
  s_waitcnt vmcnt(16) lgkmcnt(10)
  s_barrier
  v_mfma_f32_16x16x32_bf16 v[72:75], a[80:83], a[0:3], v[72:75]
  ds_read_b64_tr_b16 a[106:107], v244 offset:45056
  s_add_u32 m0, s38, 98304
  v_mfma_f32_16x16x32_bf16 v[88:91], a[80:83], a[4:7], v[88:91]
  buffer_load_dwordx4 v227, s[8:11], s17 offen offset:2048 lds
  v_mfma_f32_16x16x32_bf16 v[76:79], a[84:87], a[0:3], v[76:79]
  ds_read_b64_tr_b16 a[108:109], v245 offset:40960
  ds_read_b64_tr_b16 a[110:111], v245 offset:45056
  v_mfma_f32_16x16x32_bf16 v[92:95], a[84:87], a[4:7], v[92:95]
  ds_read_b64_tr_b16 a[80:81], v242 offset:51200
  ds_read_b64_tr_b16 a[82:83], v242 offset:55296
  v_mfma_f32_16x16x32_bf16 v[80:83], a[88:91], a[0:3], v[80:83]
  buffer_load_dwordx4 a[48:51], v240, s[4:7], s16 offen offset:0 sc1
  v_mfma_f32_16x16x32_bf16 v[96:99], a[88:91], a[4:7], v[96:99]
  ds_read_b64_tr_b16 a[84:85], v243 offset:51200
  ds_read_b64_tr_b16 a[86:87], v243 offset:55296
  v_mfma_f32_16x16x32_bf16 v[84:87], a[92:95], a[0:3], v[84:87]
  ds_read_b64_tr_b16 a[88:89], v244 offset:51200
  ds_read_b64_tr_b16 a[90:91], v244 offset:55296
  v_mfma_f32_16x16x32_bf16 v[100:103], a[92:95], a[4:7], v[100:103]
  ds_read_b64_tr_b16 a[92:93], v245 offset:51200
  ds_read_b64_tr_b16 a[94:95], v245 offset:55296
  v_mfma_f32_16x16x32_bf16 v[72:75], a[112:115], a[8:11], v[72:75]
  buffer_load_dwordx4 v228, s[8:11], s17 offen offset:3072 lds
  v_mfma_f32_16x16x32_bf16 v[88:91], a[112:115], a[12:15], v[88:91]
  ds_read_b64_tr_b16 a[112:113], v242 offset:59392
  s_add_u32 s17, s17, 917504
  v_mfma_f32_16x16x32_bf16 v[76:79], a[116:119], a[8:11], v[76:79]
  ds_read_b64_tr_b16 a[114:115], v242 offset:63488
  v_mfma_f32_16x16x32_bf16 v[92:95], a[116:119], a[12:15], v[92:95]
  ds_read_b64_tr_b16 a[116:117], v243 offset:59392
  ds_read_b64_tr_b16 a[118:119], v243 offset:63488
  v_mfma_f32_16x16x32_bf16 v[80:83], a[120:123], a[8:11], v[80:83]
  buffer_load_dwordx4 a[52:55], v240, s[4:7], s16 offen offset:1024 sc1
  v_mfma_f32_16x16x32_bf16 v[96:99], a[120:123], a[12:15], v[96:99]
  ds_read_b64_tr_b16 a[120:121], v244 offset:59392
  s_add_u32 m0, s38, 96256
  v_mfma_f32_16x16x32_bf16 v[84:87], a[124:127], a[8:11], v[84:87]
  ds_read_b64_tr_b16 a[122:123], v244 offset:63488
  v_mfma_f32_16x16x32_bf16 v[100:103], a[124:127], a[12:15], v[100:103]
  ds_read_b64_tr_b16 a[124:125], v245 offset:59392
  ds_read_b64_tr_b16 a[126:127], v245 offset:63488
  v_mfma_f32_16x16x32_bf16 v[16:19], a[64:67], a[0:3], v[16:19]
  buffer_load_dwordx4 v227, s[8:11], s17 offen offset:2048 lds
  v_mfma_f32_16x16x32_bf16 v[32:35], a[64:67], a[4:7], v[32:35]
  ds_read_b64_tr_b16 a[64:65], v242 offset:49152
  ds_read_b64_tr_b16 a[66:67], v242 offset:53248
  s_waitcnt lgkmcnt(10)
  v_mfma_f32_16x16x32_bf16 v[20:23], a[68:71], a[0:3], v[20:23]
  v_mfma_f32_16x16x32_bf16 v[36:39], a[68:71], a[4:7], v[36:39]
  ds_read_b64_tr_b16 a[68:69], v243 offset:49152
  ds_read_b64_tr_b16 a[70:71], v243 offset:53248
  v_mfma_f32_16x16x32_bf16 v[24:27], a[72:75], a[0:3], v[24:27]
  buffer_load_dwordx4 a[56:59], v241, s[4:7], s16 offen offset:0 sc1
  v_mfma_f32_16x16x32_bf16 v[40:43], a[72:75], a[4:7], v[40:43]
  ds_read_b64_tr_b16 a[72:73], v244 offset:49152
  ds_read_b64_tr_b16 a[74:75], v244 offset:53248
  v_mfma_f32_16x16x32_bf16 v[28:31], a[76:79], a[0:3], v[28:31]
  v_mfma_f32_16x16x32_bf16 v[44:47], a[76:79], a[4:7], v[44:47]
  ds_read_b64_tr_b16 a[76:77], v245 offset:49152
  ds_read_b64_tr_b16 a[78:79], v245 offset:53248
  v_mfma_f32_16x16x32_bf16 v[16:19], a[96:99], a[8:11], v[16:19]
  buffer_load_dwordx4 v228, s[8:11], s17 offen offset:3072 lds
  v_mfma_f32_16x16x32_bf16 v[32:35], a[96:99], a[12:15], v[32:35]
  ds_read_b64_tr_b16 a[96:97], v242 offset:57344
  s_add_u32 s17, s17, 917504
  v_mfma_f32_16x16x32_bf16 v[20:23], a[100:103], a[8:11], v[20:23]
  ds_read_b64_tr_b16 a[98:99], v242 offset:61440
  v_mfma_f32_16x16x32_bf16 v[36:39], a[100:103], a[12:15], v[36:39]
  ds_read_b64_tr_b16 a[100:101], v243 offset:57344
  ds_read_b64_tr_b16 a[102:103], v243 offset:61440
  v_mfma_f32_16x16x32_bf16 v[24:27], a[104:107], a[8:11], v[24:27]
  buffer_load_dwordx4 a[60:63], v241, s[4:7], s16 offen offset:1024 sc1
  v_mfma_f32_16x16x32_bf16 v[40:43], a[104:107], a[12:15], v[40:43]
  ds_read_b64_tr_b16 a[104:105], v244 offset:57344
  s_add_u32 s16, s40, 2097152
  v_mfma_f32_16x16x32_bf16 v[28:31], a[108:111], a[8:11], v[28:31]
  ds_read_b64_tr_b16 a[106:107], v244 offset:61440
  v_mfma_f32_16x16x32_bf16 v[44:47], a[108:111], a[12:15], v[44:47]
  s_waitcnt vmcnt(16) lgkmcnt(10)
  s_barrier
  v_mfma_f32_16x16x32_bf16 v[72:75], a[80:83], a[16:19], v[72:75]
  buffer_load_dwordx4 v[128:131], v240, s[4:7], s16 offen offset:0 sc1
  v_mfma_f32_16x16x32_bf16 v[88:91], a[80:83], a[20:23], v[88:91]
  ds_read_b64_tr_b16 a[108:109], v245 offset:57344
  ds_read_b64_tr_b16 a[110:111], v245 offset:61440
  v_mfma_f32_16x16x32_bf16 v[76:79], a[84:87], a[16:19], v[76:79]
  ds_read_b64_tr_b16 a[80:81], v104 offset:2048
  ds_read_b64_tr_b16 a[82:83], v104 offset:6144
  v_mfma_f32_16x16x32_bf16 v[92:95], a[84:87], a[20:23], v[92:95]
  buffer_load_dwordx4 v[132:135], v240, s[4:7], s16 offen offset:1024 sc1
  v_mfma_f32_16x16x32_bf16 v[80:83], a[88:91], a[16:19], v[80:83]
  ds_read_b64_tr_b16 a[84:85], v105 offset:2048
  ds_read_b64_tr_b16 a[86:87], v105 offset:6144
  v_mfma_f32_16x16x32_bf16 v[96:99], a[88:91], a[20:23], v[96:99]
  ds_read_b64_tr_b16 a[88:89], v106 offset:2048
  ds_read_b64_tr_b16 a[90:91], v106 offset:6144
  v_mfma_f32_16x16x32_bf16 v[84:87], a[92:95], a[16:19], v[84:87]
  v_mfma_f32_16x16x32_bf16 v[100:103], a[92:95], a[20:23], v[100:103]
  buffer_load_dwordx4 v[136:139], v241, s[4:7], s16 offen offset:0 sc1
  v_mfma_f32_16x16x32_bf16 v[72:75], a[112:115], a[24:27], v[72:75]
  ds_read_b64_tr_b16 a[92:93], v107 offset:2048
  ds_read_b64_tr_b16 a[94:95], v107 offset:6144
  v_mfma_f32_16x16x32_bf16 v[88:91], a[112:115], a[28:31], v[88:91]
  ds_read_b64_tr_b16 a[112:113], v104 offset:10240
  ds_read_b64_tr_b16 a[114:115], v104 offset:14336
  v_mfma_f32_16x16x32_bf16 v[76:79], a[116:119], a[24:27], v[76:79]
  v_mfma_f32_16x16x32_bf16 v[92:95], a[116:119], a[28:31], v[92:95]
  buffer_load_dwordx4 v[140:143], v241, s[4:7], s16 offen offset:1024 sc1
  v_mfma_f32_16x16x32_bf16 v[80:83], a[120:123], a[24:27], v[80:83]
  ds_read_b64_tr_b16 a[116:117], v105 offset:10240
  s_add_u32 s16, s16, 262144
  v_mfma_f32_16x16x32_bf16 v[96:99], a[120:123], a[28:31], v[96:99]
  ds_read_b64_tr_b16 a[118:119], v105 offset:14336
  ds_read_b64_tr_b16 a[120:121], v106 offset:10240
  v_mfma_f32_16x16x32_bf16 v[84:87], a[124:127], a[24:27], v[84:87]
  ds_read_b64_tr_b16 a[122:123], v106 offset:14336
  v_mfma_f32_16x16x32_bf16 v[100:103], a[124:127], a[28:31], v[100:103]
  buffer_load_dwordx4 v[144:147], v240, s[4:7], s16 offen offset:0 sc1
  v_mfma_f32_16x16x32_bf16 v[16:19], a[64:67], a[16:19], v[16:19]
  ds_read_b64_tr_b16 a[124:125], v107 offset:10240
  ds_read_b64_tr_b16 a[126:127], v107 offset:14336
  v_mfma_f32_16x16x32_bf16 v[32:35], a[64:67], a[20:23], v[32:35]
  ds_read_b64_tr_b16 a[64:65], v104 offset:0
  ds_read_b64_tr_b16 a[66:67], v104 offset:4096
  v_mfma_f32_16x16x32_bf16 v[20:23], a[68:71], a[16:19], v[20:23]
  v_mfma_f32_16x16x32_bf16 v[36:39], a[68:71], a[20:23], v[36:39]
  buffer_load_dwordx4 v[148:151], v240, s[4:7], s16 offen offset:1024 sc1
  s_waitcnt lgkmcnt(10)
  v_mfma_f32_16x16x32_bf16 v[24:27], a[72:75], a[16:19], v[24:27]
  ds_read_b64_tr_b16 a[68:69], v105 offset:0
  ds_read_b64_tr_b16 a[70:71], v105 offset:4096
  v_mfma_f32_16x16x32_bf16 v[40:43], a[72:75], a[20:23], v[40:43]
  ds_read_b64_tr_b16 a[72:73], v106 offset:0
  ds_read_b64_tr_b16 a[74:75], v106 offset:4096
  v_mfma_f32_16x16x32_bf16 v[28:31], a[76:79], a[16:19], v[28:31]
  v_mfma_f32_16x16x32_bf16 v[44:47], a[76:79], a[20:23], v[44:47]
  buffer_load_dwordx4 v[152:155], v241, s[4:7], s16 offen offset:0 sc1
  v_mfma_f32_16x16x32_bf16 v[16:19], a[96:99], a[24:27], v[16:19]
  ds_read_b64_tr_b16 a[76:77], v107 offset:0
  ds_read_b64_tr_b16 a[78:79], v107 offset:4096
  v_mfma_f32_16x16x32_bf16 v[32:35], a[96:99], a[28:31], v[32:35]
  ds_read_b64_tr_b16 a[96:97], v104 offset:8192
  ds_read_b64_tr_b16 a[98:99], v104 offset:12288
  v_mfma_f32_16x16x32_bf16 v[20:23], a[100:103], a[24:27], v[20:23]
  v_mfma_f32_16x16x32_bf16 v[36:39], a[100:103], a[28:31], v[36:39]
  buffer_load_dwordx4 v[156:159], v241, s[4:7], s16 offen offset:1024 sc1
  v_mfma_f32_16x16x32_bf16 v[24:27], a[104:107], a[24:27], v[24:27]
  ds_read_b64_tr_b16 a[100:101], v105 offset:8192
  s_add_u32 s16, s16, 262144
  v_mfma_f32_16x16x32_bf16 v[40:43], a[104:107], a[28:31], v[40:43]
  ds_read_b64_tr_b16 a[102:103], v105 offset:12288
  ds_read_b64_tr_b16 a[104:105], v106 offset:8192
  v_mfma_f32_16x16x32_bf16 v[28:31], a[108:111], a[24:27], v[28:31]
  ds_read_b64_tr_b16 a[106:107], v106 offset:12288
  v_mfma_f32_16x16x32_bf16 v[44:47], a[108:111], a[28:31], v[44:47]
  s_waitcnt vmcnt(16) lgkmcnt(10)
  s_barrier
  v_mfma_f32_16x16x32_bf16 v[72:75], a[80:83], a[32:35], v[72:75]
  ds_read_b64_tr_b16 a[108:109], v107 offset:8192
  s_add_u32 m0, s38, 114688
  v_mfma_f32_16x16x32_bf16 v[88:91], a[80:83], a[36:39], v[88:91]
  buffer_load_dwordx4 v227, s[8:11], s17 offen offset:2048 lds
  v_mfma_f32_16x16x32_bf16 v[76:79], a[84:87], a[32:35], v[76:79]
  ds_read_b64_tr_b16 a[110:111], v107 offset:12288
  ds_read_b64_tr_b16 a[80:81], v104 offset:18432
  v_mfma_f32_16x16x32_bf16 v[92:95], a[84:87], a[36:39], v[92:95]
  buffer_load_dwordx4 v[160:163], v240, s[4:7], s16 offen offset:0 sc1
  v_mfma_f32_16x16x32_bf16 v[80:83], a[88:91], a[32:35], v[80:83]
  ds_read_b64_tr_b16 a[82:83], v104 offset:22528
  ds_read_b64_tr_b16 a[84:85], v105 offset:18432
  v_mfma_f32_16x16x32_bf16 v[96:99], a[88:91], a[36:39], v[96:99]
  ds_read_b64_tr_b16 a[86:87], v105 offset:22528
  ds_read_b64_tr_b16 a[88:89], v106 offset:18432
  v_mfma_f32_16x16x32_bf16 v[84:87], a[92:95], a[32:35], v[84:87]
  buffer_load_dwordx4 v228, s[8:11], s17 offen offset:3072 lds
  v_mfma_f32_16x16x32_bf16 v[100:103], a[92:95], a[36:39], v[100:103]
  ds_read_b64_tr_b16 a[90:91], v106 offset:22528
  s_add_u32 s17, s17, 917504
  v_mfma_f32_16x16x32_bf16 v[72:75], a[112:115], a[40:43], v[72:75]
  buffer_load_dwordx4 v[164:167], v240, s[4:7], s16 offen offset:1024 sc1
  v_mfma_f32_16x16x32_bf16 v[88:91], a[112:115], a[44:47], v[88:91]
  ds_read_b64_tr_b16 a[92:93], v107 offset:18432
  s_add_u32 m0, s38, 112640
  v_mfma_f32_16x16x32_bf16 v[76:79], a[116:119], a[40:43], v[76:79]
  ds_read_b64_tr_b16 a[94:95], v107 offset:22528
  ds_read_b64_tr_b16 a[112:113], v104 offset:26624
  v_mfma_f32_16x16x32_bf16 v[92:95], a[116:119], a[44:47], v[92:95]
  buffer_load_dwordx4 v227, s[8:11], s17 offen offset:2048 lds
  v_mfma_f32_16x16x32_bf16 v[80:83], a[120:123], a[40:43], v[80:83]
  ds_read_b64_tr_b16 a[114:115], v104 offset:30720
  ds_read_b64_tr_b16 a[116:117], v105 offset:26624
  v_mfma_f32_16x16x32_bf16 v[96:99], a[120:123], a[44:47], v[96:99]
  buffer_load_dwordx4 v[168:171], v241, s[4:7], s16 offen offset:0 sc1
  v_mfma_f32_16x16x32_bf16 v[84:87], a[124:127], a[40:43], v[84:87]
  ds_read_b64_tr_b16 a[118:119], v105 offset:30720
  ds_read_b64_tr_b16 a[120:121], v106 offset:26624
  v_mfma_f32_16x16x32_bf16 v[100:103], a[124:127], a[44:47], v[100:103]
  ds_read_b64_tr_b16 a[122:123], v106 offset:30720
  ds_read_b64_tr_b16 a[124:125], v107 offset:26624
  v_mfma_f32_16x16x32_bf16 v[16:19], a[64:67], a[32:35], v[16:19]
  buffer_load_dwordx4 v228, s[8:11], s17 offen offset:3072 lds
  v_mfma_f32_16x16x32_bf16 v[32:35], a[64:67], a[36:39], v[32:35]
  ds_read_b64_tr_b16 a[126:127], v107 offset:30720
  s_mov_b32 s17, s97
  v_mfma_f32_16x16x32_bf16 v[20:23], a[68:71], a[32:35], v[20:23]
  ds_read_b64_tr_b16 a[64:65], v104 offset:16384
  ds_read_b64_tr_b16 a[66:67], v104 offset:20480
  v_mfma_f32_16x16x32_bf16 v[36:39], a[68:71], a[36:39], v[36:39]
  buffer_load_dwordx4 v[172:175], v241, s[4:7], s16 offen offset:1024 sc1
  s_waitcnt lgkmcnt(10)
  v_mfma_f32_16x16x32_bf16 v[24:27], a[72:75], a[32:35], v[24:27]
  ds_read_b64_tr_b16 a[68:69], v105 offset:16384
  s_add_u32 s16, s16, 262144
  v_mfma_f32_16x16x32_bf16 v[40:43], a[72:75], a[36:39], v[40:43]
  buffer_load_dwordx4 v[176:179], v240, s[4:7], s16 offen offset:0 sc1
  v_mfma_f32_16x16x32_bf16 v[28:31], a[76:79], a[32:35], v[28:31]
  ds_read_b64_tr_b16 a[70:71], v105 offset:20480
  ds_read_b64_tr_b16 a[72:73], v106 offset:16384
  v_mfma_f32_16x16x32_bf16 v[44:47], a[76:79], a[36:39], v[44:47]
  ds_read_b64_tr_b16 a[74:75], v106 offset:20480
  ds_read_b64_tr_b16 a[76:77], v107 offset:16384
  v_mfma_f32_16x16x32_bf16 v[16:19], a[96:99], a[40:43], v[16:19]
  buffer_load_dwordx4 v[180:183], v240, s[4:7], s16 offen offset:1024 sc1
  v_mfma_f32_16x16x32_bf16 v[32:35], a[96:99], a[44:47], v[32:35]
  ds_read_b64_tr_b16 a[78:79], v107 offset:20480
  ds_read_b64_tr_b16 a[96:97], v104 offset:24576
  v_mfma_f32_16x16x32_bf16 v[20:23], a[100:103], a[40:43], v[20:23]
  buffer_load_dwordx4 v[184:187], v241, s[4:7], s16 offen offset:0 sc1
  v_mfma_f32_16x16x32_bf16 v[36:39], a[100:103], a[44:47], v[36:39]
  ds_read_b64_tr_b16 a[98:99], v104 offset:28672
  ds_read_b64_tr_b16 a[100:101], v105 offset:24576
  v_mfma_f32_16x16x32_bf16 v[24:27], a[104:107], a[40:43], v[24:27]
  ds_read_b64_tr_b16 a[102:103], v105 offset:28672
  v_mfma_f32_16x16x32_bf16 v[40:43], a[104:107], a[44:47], v[40:43]
  buffer_load_dwordx4 v[188:191], v241, s[4:7], s16 offen offset:1024 sc1
  v_mfma_f32_16x16x32_bf16 v[28:31], a[108:111], a[40:43], v[28:31]
  ds_read_b64_tr_b16 a[104:105], v106 offset:24576
  s_add_u32 s16, s16, 262144
  v_mfma_f32_16x16x32_bf16 v[44:47], a[108:111], a[44:47], v[44:47]
  s_waitcnt vmcnt(20) lgkmcnt(10)
  s_barrier
  v_mfma_f32_16x16x32_bf16 v[72:75], a[80:83], a[48:51], v[72:75]
  ds_read_b64_tr_b16 a[106:107], v106 offset:28672
  s_add_u32 m0, s38, 133120
  v_mfma_f32_16x16x32_bf16 v[88:91], a[80:83], a[52:55], v[88:91]
  buffer_load_dwordx4 v225, s[8:11], s17 offen offset:0 lds
  v_mfma_f32_16x16x32_bf16 v[76:79], a[84:87], a[48:51], v[76:79]
  ds_read_b64_tr_b16 a[108:109], v107 offset:24576
  ds_read_b64_tr_b16 a[110:111], v107 offset:28672
  v_mfma_f32_16x16x32_bf16 v[92:95], a[84:87], a[52:55], v[92:95]
  ds_read_b64_tr_b16 a[80:81], v104 offset:34816
  ds_read_b64_tr_b16 a[82:83], v104 offset:38912
  v_mfma_f32_16x16x32_bf16 v[80:83], a[88:91], a[48:51], v[80:83]
  ds_read_b64_tr_b16 a[84:85], v105 offset:34816
  ds_read_b64_tr_b16 a[86:87], v105 offset:38912
  v_mfma_f32_16x16x32_bf16 v[96:99], a[88:91], a[52:55], v[96:99]
  ds_read_b64_tr_b16 a[88:89], v106 offset:34816
  ds_read_b64_tr_b16 a[90:91], v106 offset:38912
  v_mfma_f32_16x16x32_bf16 v[84:87], a[92:95], a[48:51], v[84:87]
  v_mfma_f32_16x16x32_bf16 v[100:103], a[92:95], a[52:55], v[100:103]
  ds_read_b64_tr_b16 a[92:93], v107 offset:34816
  ds_read_b64_tr_b16 a[94:95], v107 offset:38912
  v_mfma_f32_16x16x32_bf16 v[72:75], a[112:115], a[56:59], v[72:75]
  buffer_load_dwordx4 v226, s[8:11], s17 offen offset:1024 lds
  v_mfma_f32_16x16x32_bf16 v[88:91], a[112:115], a[60:63], v[88:91]
  ds_read_b64_tr_b16 a[112:113], v104 offset:43008
  s_add_u32 s17, s17, 917504
  v_mfma_f32_16x16x32_bf16 v[76:79], a[116:119], a[56:59], v[76:79]
  ds_read_b64_tr_b16 a[114:115], v104 offset:47104
  s_add_u32 m0, s38, 131072
  v_mfma_f32_16x16x32_bf16 v[92:95], a[116:119], a[60:63], v[92:95]
  ds_read_b64_tr_b16 a[116:117], v105 offset:43008
  ds_read_b64_tr_b16 a[118:119], v105 offset:47104
  v_mfma_f32_16x16x32_bf16 v[80:83], a[120:123], a[56:59], v[80:83]
  v_mfma_f32_16x16x32_bf16 v[96:99], a[120:123], a[60:63], v[96:99]
  ds_read_b64_tr_b16 a[120:121], v106 offset:43008
  ds_read_b64_tr_b16 a[122:123], v106 offset:47104
  v_mfma_f32_16x16x32_bf16 v[84:87], a[124:127], a[56:59], v[84:87]
  v_mfma_f32_16x16x32_bf16 v[100:103], a[124:127], a[60:63], v[100:103]
  ds_read_b64_tr_b16 a[124:125], v107 offset:43008
  ds_read_b64_tr_b16 a[126:127], v107 offset:47104
  v_mfma_f32_16x16x32_bf16 v[16:19], a[64:67], a[48:51], v[16:19]
  buffer_load_dwordx4 v225, s[8:11], s17 offen offset:0 lds
  v_mfma_f32_16x16x32_bf16 v[32:35], a[64:67], a[52:55], v[32:35]
  ds_read_b64_tr_b16 a[64:65], v104 offset:32768
  ds_read_b64_tr_b16 a[66:67], v104 offset:36864
  s_waitcnt lgkmcnt(10)
  v_mfma_f32_16x16x32_bf16 v[20:23], a[68:71], a[48:51], v[20:23]
  v_mfma_f32_16x16x32_bf16 v[36:39], a[68:71], a[52:55], v[36:39]
  ds_read_b64_tr_b16 a[68:69], v105 offset:32768
  ds_read_b64_tr_b16 a[70:71], v105 offset:36864
  v_mfma_f32_16x16x32_bf16 v[24:27], a[72:75], a[48:51], v[24:27]
  v_mfma_f32_16x16x32_bf16 v[40:43], a[72:75], a[52:55], v[40:43]
  ds_read_b64_tr_b16 a[72:73], v106 offset:32768
  ds_read_b64_tr_b16 a[74:75], v106 offset:36864
  v_mfma_f32_16x16x32_bf16 v[28:31], a[76:79], a[48:51], v[28:31]
  v_mfma_f32_16x16x32_bf16 v[44:47], a[76:79], a[52:55], v[44:47]
  ds_read_b64_tr_b16 a[76:77], v107 offset:32768
  ds_read_b64_tr_b16 a[78:79], v107 offset:36864
  v_mfma_f32_16x16x32_bf16 v[16:19], a[96:99], a[56:59], v[16:19]
  buffer_load_dwordx4 v226, s[8:11], s17 offen offset:1024 lds
  v_mfma_f32_16x16x32_bf16 v[32:35], a[96:99], a[60:63], v[32:35]
  ds_read_b64_tr_b16 a[96:97], v104 offset:40960
  s_add_u32 s17, s17, 917504
  v_mfma_f32_16x16x32_bf16 v[20:23], a[100:103], a[56:59], v[20:23]
  ds_read_b64_tr_b16 a[98:99], v104 offset:45056
  v_mfma_f32_16x16x32_bf16 v[36:39], a[100:103], a[60:63], v[36:39]
  ds_read_b64_tr_b16 a[100:101], v105 offset:40960
  ds_read_b64_tr_b16 a[102:103], v105 offset:45056
  v_mfma_f32_16x16x32_bf16 v[24:27], a[104:107], a[56:59], v[24:27]
  v_mfma_f32_16x16x32_bf16 v[40:43], a[104:107], a[60:63], v[40:43]
  ds_read_b64_tr_b16 a[104:105], v106 offset:40960
  ds_read_b64_tr_b16 a[106:107], v106 offset:45056
  v_mfma_f32_16x16x32_bf16 v[28:31], a[108:111], a[56:59], v[28:31]
  v_mfma_f32_16x16x32_bf16 v[44:47], a[108:111], a[60:63], v[44:47]
  s_waitcnt vmcnt(9) lgkmcnt(10)
  s_barrier
  v_swap_b32 v130, v132
  v_swap_b32 v131, v133
  v_swap_b32 v138, v140
  v_swap_b32 v139, v141
  v_swap_b32 v146, v148
  v_swap_b32 v147, v149
  v_swap_b32 v154, v156
  v_swap_b32 v155, v157
  s_nop 1
  v_mfma_f32_16x16x32_bf16 v[72:75], a[80:83], v[128:131], v[72:75]
  ds_read_b64_tr_b16 a[108:109], v107 offset:40960
  s_add_u32 m0, s38, 2048
  v_mfma_f32_16x16x32_bf16 v[88:91], a[80:83], v[132:135], v[88:91]
  buffer_load_dwordx4 v225, s[8:11], s17 offen offset:0 lds
  v_mfma_f32_16x16x32_bf16 v[76:79], a[84:87], v[128:131], v[76:79]
  ds_read_b64_tr_b16 a[110:111], v107 offset:45056
  ds_read_b64_tr_b16 a[80:81], v104 offset:51200
  v_mfma_f32_16x16x32_bf16 v[92:95], a[84:87], v[132:135], v[92:95]
  ds_read_b64_tr_b16 a[82:83], v104 offset:55296
  ds_read_b64_tr_b16 a[84:85], v105 offset:51200
  v_mfma_f32_16x16x32_bf16 v[80:83], a[88:91], v[128:131], v[80:83]
  ds_read_b64_tr_b16 a[86:87], v105 offset:55296
  v_mfma_f32_16x16x32_bf16 v[96:99], a[88:91], v[132:135], v[96:99]
  ds_read_b64_tr_b16 a[88:89], v106 offset:51200
  ds_read_b64_tr_b16 a[90:91], v106 offset:55296
  v_mfma_f32_16x16x32_bf16 v[84:87], a[92:95], v[128:131], v[84:87]
  v_mfma_f32_16x16x32_bf16 v[100:103], a[92:95], v[132:135], v[100:103]
  ds_read_b64_tr_b16 a[92:93], v107 offset:51200
  ds_read_b64_tr_b16 a[94:95], v107 offset:55296
  v_mfma_f32_16x16x32_bf16 v[72:75], a[112:115], v[136:139], v[72:75]
  buffer_load_dwordx4 v226, s[8:11], s17 offen offset:1024 lds
  v_mfma_f32_16x16x32_bf16 v[88:91], a[112:115], v[140:143], v[88:91]
  ds_read_b64_tr_b16 a[112:113], v104 offset:59392
  s_add_u32 s17, s17, 917504
  v_mfma_f32_16x16x32_bf16 v[76:79], a[116:119], v[136:139], v[76:79]
  ds_read_b64_tr_b16 a[114:115], v104 offset:63488
  s_add_u32 m0, s38, 0
  v_mfma_f32_16x16x32_bf16 v[92:95], a[116:119], v[140:143], v[92:95]
  ds_read_b64_tr_b16 a[116:117], v105 offset:59392
  ds_read_b64_tr_b16 a[118:119], v105 offset:63488
  v_mfma_f32_16x16x32_bf16 v[80:83], a[120:123], v[136:139], v[80:83]
  v_mfma_f32_16x16x32_bf16 v[96:99], a[120:123], v[140:143], v[96:99]
  ds_read_b64_tr_b16 a[120:121], v106 offset:59392
  ds_read_b64_tr_b16 a[122:123], v106 offset:63488
  v_mfma_f32_16x16x32_bf16 v[84:87], a[124:127], v[136:139], v[84:87]
  v_mfma_f32_16x16x32_bf16 v[100:103], a[124:127], v[140:143], v[100:103]
  ds_read_b64_tr_b16 a[124:125], v107 offset:59392
  ds_read_b64_tr_b16 a[126:127], v107 offset:63488
  v_mfma_f32_16x16x32_bf16 v[72:75], a[64:67], v[144:147], v[72:75]
  buffer_load_dwordx4 v225, s[8:11], s17 offen offset:0 lds
  v_mfma_f32_16x16x32_bf16 v[88:91], a[64:67], v[148:151], v[88:91]
  ds_read_b64_tr_b16 a[64:65], v104 offset:49152
  ds_read_b64_tr_b16 a[66:67], v104 offset:53248
  v_mfma_f32_16x16x32_bf16 v[76:79], a[68:71], v[144:147], v[76:79]
  v_mfma_f32_16x16x32_bf16 v[92:95], a[68:71], v[148:151], v[92:95]
  ds_read_b64_tr_b16 a[68:69], v105 offset:49152
  ds_read_b64_tr_b16 a[70:71], v105 offset:53248
  s_waitcnt lgkmcnt(10)
  v_mfma_f32_16x16x32_bf16 v[80:83], a[72:75], v[144:147], v[80:83]
  v_mfma_f32_16x16x32_bf16 v[96:99], a[72:75], v[148:151], v[96:99]
  ds_read_b64_tr_b16 a[72:73], v106 offset:49152
  ds_read_b64_tr_b16 a[74:75], v106 offset:53248
  v_mfma_f32_16x16x32_bf16 v[84:87], a[76:79], v[144:147], v[84:87]
  v_mfma_f32_16x16x32_bf16 v[100:103], a[76:79], v[148:151], v[100:103]
  ds_read_b64_tr_b16 a[76:77], v107 offset:49152
  ds_read_b64_tr_b16 a[78:79], v107 offset:53248
  v_mfma_f32_16x16x32_bf16 v[72:75], a[96:99], v[152:155], v[72:75]
  buffer_load_dwordx4 v226, s[8:11], s17 offen offset:1024 lds
  v_mfma_f32_16x16x32_bf16 v[88:91], a[96:99], v[156:159], v[88:91]
  ds_read_b64_tr_b16 a[96:97], v104 offset:57344
  s_add_u32 s17, s17, 917504
  v_mfma_f32_16x16x32_bf16 v[76:79], a[100:103], v[152:155], v[76:79]
  s_add_u32 s52, s20, 0xe00000
  s_addc_u32 s53, s21, 0
  s_mov_b32 s54, 0x800000
  s_mov_b32 s55, 0x20000
  v_lshlrev_b32 v50, 4, v231
  s_lshl_b32 s36, s2, 2
  s_add_u32 s36, s36, s3
  s_xor_b32 s37, s36, 4
  s_lshl_b32 s39, s37, 12
  s_lshl_b32 s36, s36, 12
  s_mov_b32 s43, 0x8000
  s_mov_b32 s44, s90
  s_mov_b32 s45, s91
  s_mov_b32 s46, 0x400000
  s_mov_b32 s47, 0x20000
  v_mfma_f32_16x16x32_bf16 v[92:95], a[100:103], v[156:159], v[92:95]
  ds_read_b64_tr_b16 a[98:99], v104 offset:61440
  ds_read_b64_tr_b16 a[100:101], v105 offset:57344
  v_mfma_f32_16x16x32_bf16 v[80:83], a[104:107], v[152:155], v[80:83]
  ds_read_b64_tr_b16 a[102:103], v105 offset:61440
  v_mfma_f32_16x16x32_bf16 v[96:99], a[104:107], v[156:159], v[96:99]
  ds_read_b64_tr_b16 a[104:105], v106 offset:57344
  ds_read_b64_tr_b16 a[106:107], v106 offset:61440
  v_mfma_f32_16x16x32_bf16 v[84:87], a[108:111], v[152:155], v[84:87]
  v_mfma_f32_16x16x32_bf16 v[100:103], a[108:111], v[156:159], v[100:103]
  s_waitcnt vmcnt(4) lgkmcnt(10)
  s_barrier
  v_swap_b32 v162, v164
  v_swap_b32 v163, v165
  v_swap_b32 v170, v172
  v_swap_b32 v171, v173
  v_swap_b32 v178, v180
  v_swap_b32 v179, v181
  v_swap_b32 v186, v188
  v_swap_b32 v187, v189
  s_nop 1
  v_mfma_f32_16x16x32_bf16 v[72:75], a[80:83], v[160:163], v[72:75]
  ds_read_b64_tr_b16 a[108:109], v107 offset:57344
  ds_read_b64_tr_b16 a[110:111], v107 offset:61440
  v_mfma_f32_16x16x32_bf16 v[88:91], a[80:83], v[164:167], v[88:91]
  ds_read_b64_tr_b16 a[80:81], v124 offset:2048
  ds_read_b64_tr_b16 a[82:83], v124 offset:6144
  v_mfma_f32_16x16x32_bf16 v[76:79], a[84:87], v[160:163], v[76:79]
  v_mfma_f32_16x16x32_bf16 v[92:95], a[84:87], v[164:167], v[92:95]
  ds_read_b64_tr_b16 a[84:85], v125 offset:2048
  ds_read_b64_tr_b16 a[86:87], v125 offset:6144
  v_mfma_f32_16x16x32_bf16 v[80:83], a[88:91], v[160:163], v[80:83]
  v_mfma_f32_16x16x32_bf16 v[96:99], a[88:91], v[164:167], v[96:99]
  ds_read_b64_tr_b16 a[88:89], v126 offset:2048
  ds_read_b64_tr_b16 a[90:91], v126 offset:6144
  v_mfma_f32_16x16x32_bf16 v[84:87], a[92:95], v[160:163], v[84:87]
  v_mfma_f32_16x16x32_bf16 v[100:103], a[92:95], v[164:167], v[100:103]
  ds_read_b64_tr_b16 a[92:93], v127 offset:2048
  ds_read_b64_tr_b16 a[94:95], v127 offset:6144
  v_mfma_f32_16x16x32_bf16 v[72:75], a[112:115], v[168:171], v[72:75]
  v_mfma_f32_16x16x32_bf16 v[88:91], a[112:115], v[172:175], v[88:91]
  ds_read_b64_tr_b16 a[112:113], v124 offset:10240
  ds_read_b64_tr_b16 a[114:115], v124 offset:14336
  v_mfma_f32_16x16x32_bf16 v[76:79], a[116:119], v[168:171], v[76:79]
  v_mfma_f32_16x16x32_bf16 v[92:95], a[116:119], v[172:175], v[92:95]
  ds_read_b64_tr_b16 a[116:117], v125 offset:10240
  ds_read_b64_tr_b16 a[118:119], v125 offset:14336
  v_mfma_f32_16x16x32_bf16 v[80:83], a[120:123], v[168:171], v[80:83]
  v_mfma_f32_16x16x32_bf16 v[96:99], a[120:123], v[172:175], v[96:99]
  ds_read_b64_tr_b16 a[120:121], v126 offset:10240
  ds_read_b64_tr_b16 a[122:123], v126 offset:14336
  v_mfma_f32_16x16x32_bf16 v[84:87], a[124:127], v[168:171], v[84:87]
  v_mfma_f32_16x16x32_bf16 v[100:103], a[124:127], v[172:175], v[100:103]
  ds_read_b64_tr_b16 a[124:125], v127 offset:10240
  ds_read_b64_tr_b16 a[126:127], v127 offset:14336
  v_mfma_f32_16x16x32_bf16 v[72:75], a[64:67], v[176:179], v[72:75]
  v_mfma_f32_16x16x32_bf16 v[88:91], a[64:67], v[180:183], v[88:91]
  ds_read_b64_tr_b16 a[64:65], v124 offset:0
  ds_read_b64_tr_b16 a[66:67], v124 offset:4096
  v_mfma_f32_16x16x32_bf16 v[76:79], a[68:71], v[176:179], v[76:79]
  v_mfma_f32_16x16x32_bf16 v[92:95], a[68:71], v[180:183], v[92:95]
  ds_read_b64_tr_b16 a[68:69], v125 offset:0
  ds_read_b64_tr_b16 a[70:71], v125 offset:4096
  s_waitcnt lgkmcnt(10)
  v_mfma_f32_16x16x32_bf16 v[80:83], a[72:75], v[176:179], v[80:83]
  v_mfma_f32_16x16x32_bf16 v[96:99], a[72:75], v[180:183], v[96:99]
  ds_read_b64_tr_b16 a[72:73], v126 offset:0
  ds_read_b64_tr_b16 a[74:75], v126 offset:4096
  v_mfma_f32_16x16x32_bf16 v[84:87], a[76:79], v[176:179], v[84:87]
  v_mfma_f32_16x16x32_bf16 v[100:103], a[76:79], v[180:183], v[100:103]
  ds_read_b64_tr_b16 a[76:77], v127 offset:0
  ds_read_b64_tr_b16 a[78:79], v127 offset:4096
  v_mfma_f32_16x16x32_bf16 v[72:75], a[96:99], v[184:187], v[72:75]
  v_mfma_f32_16x16x32_bf16 v[88:91], a[96:99], v[188:191], v[88:91]
  ds_read_b64_tr_b16 a[96:97], v124 offset:8192
  ds_read_b64_tr_b16 a[98:99], v124 offset:12288
  v_mfma_f32_16x16x32_bf16 v[76:79], a[100:103], v[184:187], v[76:79]
  v_mfma_f32_16x16x32_bf16 v[92:95], a[100:103], v[188:191], v[92:95]
  ds_read_b64_tr_b16 a[100:101], v125 offset:8192
  ds_read_b64_tr_b16 a[102:103], v125 offset:12288
  v_mfma_f32_16x16x32_bf16 v[80:83], a[104:107], v[184:187], v[80:83]
  v_mfma_f32_16x16x32_bf16 v[96:99], a[104:107], v[188:191], v[96:99]
  ds_read_b64_tr_b16 a[104:105], v126 offset:8192
  ds_read_b64_tr_b16 a[106:107], v126 offset:12288
  v_mfma_f32_16x16x32_bf16 v[84:87], a[108:111], v[184:187], v[84:87]
  v_mfma_f32_16x16x32_bf16 v[100:103], a[108:111], v[188:191], v[100:103]
  s_waitcnt vmcnt(0) lgkmcnt(10)
  s_barrier
  v_mfma_f32_16x16x32_bf16 v[16:19], a[80:83], v[128:131], v[16:19]
  ds_read_b64_tr_b16 a[108:109], v127 offset:8192
  ds_read_b64_tr_b16 a[110:111], v127 offset:12288
  v_mfma_f32_16x16x32_bf16 v[32:35], a[80:83], v[132:135], v[32:35]
  ds_read_b64_tr_b16 a[80:81], v242 offset:2048
  ds_read_b64_tr_b16 a[82:83], v242 offset:6144
  v_mfma_f32_16x16x32_bf16 v[20:23], a[84:87], v[128:131], v[20:23]
  v_mfma_f32_16x16x32_bf16 v[36:39], a[84:87], v[132:135], v[36:39]
  v_cvt_pk_bf16_f32 v108, v72, v73
  v_cvt_pk_bf16_f32 v109, v74, v75
  v_cvt_pk_bf16_f32 v110, v76, v77
  v_cvt_pk_bf16_f32 v111, v78, v79
  buffer_store_dwordx4 v[108:111], v50, s[52:55], s39 offen offset:0 sc1
  v_mfma_f32_16x16x32_bf16 v[24:27], a[88:91], v[128:131], v[24:27]
  v_cvt_pk_bf16_f32 v116, v88, v89
  v_cvt_pk_bf16_f32 v117, v90, v91
  v_cvt_pk_bf16_f32 v118, v92, v93
  v_cvt_pk_bf16_f32 v119, v94, v95
  buffer_store_dwordx4 v[116:119], v50, s[52:55], s39 offen offset:2048 sc1
  v_mfma_f32_16x16x32_bf16 v[40:43], a[88:91], v[132:135], v[40:43]
  ds_read_b64_tr_b16 a[84:85], v243 offset:2048
  ds_read_b64_tr_b16 a[86:87], v243 offset:6144
  v_mfma_f32_16x16x32_bf16 v[28:31], a[92:95], v[128:131], v[28:31]
  ds_read_b64_tr_b16 a[88:89], v244 offset:2048
  ds_read_b64_tr_b16 a[90:91], v244 offset:6144
  v_mfma_f32_16x16x32_bf16 v[44:47], a[92:95], v[132:135], v[44:47]
  v_cvt_pk_bf16_f32 v112, v80, v81
  v_cvt_pk_bf16_f32 v113, v82, v83
  v_cvt_pk_bf16_f32 v114, v84, v85
  v_cvt_pk_bf16_f32 v115, v86, v87
  buffer_store_dwordx4 v[112:115], v50, s[52:55], s39 offen offset:1024 sc1
  v_mfma_f32_16x16x32_bf16 v[16:19], a[112:115], v[136:139], v[16:19]
  v_cvt_pk_bf16_f32 v120, v96, v97
  v_cvt_pk_bf16_f32 v121, v98, v99
  v_cvt_pk_bf16_f32 v122, v100, v101
  v_cvt_pk_bf16_f32 v123, v102, v103
  buffer_store_dwordx4 v[120:123], v50, s[52:55], s39 offen offset:3072 sc1
  v_mfma_f32_16x16x32_bf16 v[32:35], a[112:115], v[140:143], v[32:35]
  ds_read_b64_tr_b16 a[92:93], v245 offset:2048
  ds_read_b64_tr_b16 a[94:95], v245 offset:6144
  v_mfma_f32_16x16x32_bf16 v[20:23], a[116:119], v[136:139], v[20:23]
  ds_read_b64_tr_b16 a[112:113], v242 offset:10240
  ds_read_b64_tr_b16 a[114:115], v242 offset:14336
  v_mfma_f32_16x16x32_bf16 v[36:39], a[116:119], v[140:143], v[36:39]
  ds_read_b64_tr_b16 a[116:117], v243 offset:10240
  ds_read_b64_tr_b16 a[118:119], v243 offset:14336
  v_mfma_f32_16x16x32_bf16 v[24:27], a[120:123], v[136:139], v[24:27]
  v_mfma_f32_16x16x32_bf16 v[40:43], a[120:123], v[140:143], v[40:43]
  ds_read_b64_tr_b16 a[120:121], v244 offset:10240
  ds_read_b64_tr_b16 a[122:123], v244 offset:14336
  v_mfma_f32_16x16x32_bf16 v[28:31], a[124:127], v[136:139], v[28:31]
  v_mfma_f32_16x16x32_bf16 v[44:47], a[124:127], v[140:143], v[44:47]
  ds_read_b64_tr_b16 a[124:125], v245 offset:10240
  ds_read_b64_tr_b16 a[126:127], v245 offset:14336
  v_mfma_f32_16x16x32_bf16 v[16:19], a[64:67], v[144:147], v[16:19]
  v_mfma_f32_16x16x32_bf16 v[32:35], a[64:67], v[148:151], v[32:35]
  ds_read_b64_tr_b16 a[64:65], v242 offset:0
  ds_read_b64_tr_b16 a[66:67], v242 offset:4096
  v_mfma_f32_16x16x32_bf16 v[20:23], a[68:71], v[144:147], v[20:23]
  v_mfma_f32_16x16x32_bf16 v[36:39], a[68:71], v[148:151], v[36:39]
  ds_read_b64_tr_b16 a[68:69], v243 offset:0
  ds_read_b64_tr_b16 a[70:71], v243 offset:4096
  s_waitcnt lgkmcnt(10)
  v_mfma_f32_16x16x32_bf16 v[24:27], a[72:75], v[144:147], v[24:27]
  v_mfma_f32_16x16x32_bf16 v[40:43], a[72:75], v[148:151], v[40:43]
  ds_read_b64_tr_b16 a[72:73], v244 offset:0
  ds_read_b64_tr_b16 a[74:75], v244 offset:4096
  v_mfma_f32_16x16x32_bf16 v[28:31], a[76:79], v[144:147], v[28:31]
  v_mfma_f32_16x16x32_bf16 v[44:47], a[76:79], v[148:151], v[44:47]
  ds_read_b64_tr_b16 a[76:77], v245 offset:0
  ds_read_b64_tr_b16 a[78:79], v245 offset:4096
  v_mfma_f32_16x16x32_bf16 v[16:19], a[96:99], v[152:155], v[16:19]
  v_mfma_f32_16x16x32_bf16 v[32:35], a[96:99], v[156:159], v[32:35]
  ds_read_b64_tr_b16 a[96:97], v242 offset:8192
  ds_read_b64_tr_b16 a[98:99], v242 offset:12288
  v_mfma_f32_16x16x32_bf16 v[20:23], a[100:103], v[152:155], v[20:23]
  v_mfma_f32_16x16x32_bf16 v[36:39], a[100:103], v[156:159], v[36:39]
  ds_read_b64_tr_b16 a[100:101], v243 offset:8192
  ds_read_b64_tr_b16 a[102:103], v243 offset:12288
  v_mfma_f32_16x16x32_bf16 v[24:27], a[104:107], v[152:155], v[24:27]
  v_mfma_f32_16x16x32_bf16 v[40:43], a[104:107], v[156:159], v[40:43]
  ds_read_b64_tr_b16 a[104:105], v244 offset:8192
  ds_read_b64_tr_b16 a[106:107], v244 offset:12288
  v_mfma_f32_16x16x32_bf16 v[28:31], a[108:111], v[152:155], v[28:31]
  v_mfma_f32_16x16x32_bf16 v[44:47], a[108:111], v[156:159], v[44:47]
  s_waitcnt vmcnt(63) lgkmcnt(10)
  s_barrier
  v_mfma_f32_16x16x32_bf16 v[16:19], a[80:83], v[160:163], v[16:19]
  ds_read_b64_tr_b16 a[108:109], v245 offset:8192
  ds_read_b64_tr_b16 a[110:111], v245 offset:12288
  v_mfma_f32_16x16x32_bf16 v[32:35], a[80:83], v[164:167], v[32:35]
  v_mfma_f32_16x16x32_bf16 v[20:23], a[84:87], v[160:163], v[20:23]
  v_mfma_f32_16x16x32_bf16 v[36:39], a[84:87], v[164:167], v[36:39]
  v_mfma_f32_16x16x32_bf16 v[24:27], a[88:91], v[160:163], v[24:27]
  v_mfma_f32_16x16x32_bf16 v[40:43], a[88:91], v[164:167], v[40:43]
  v_mfma_f32_16x16x32_bf16 v[28:31], a[92:95], v[160:163], v[28:31]
  v_mfma_f32_16x16x32_bf16 v[44:47], a[92:95], v[164:167], v[44:47]
  v_mfma_f32_16x16x32_bf16 v[16:19], a[112:115], v[168:171], v[16:19]
  v_mfma_f32_16x16x32_bf16 v[32:35], a[112:115], v[172:175], v[32:35]
  v_mfma_f32_16x16x32_bf16 v[20:23], a[116:119], v[168:171], v[20:23]
  v_mfma_f32_16x16x32_bf16 v[36:39], a[116:119], v[172:175], v[36:39]
  v_mfma_f32_16x16x32_bf16 v[24:27], a[120:123], v[168:171], v[24:27]
  v_mfma_f32_16x16x32_bf16 v[40:43], a[120:123], v[172:175], v[40:43]
  v_mfma_f32_16x16x32_bf16 v[28:31], a[124:127], v[168:171], v[28:31]
  v_mfma_f32_16x16x32_bf16 v[44:47], a[124:127], v[172:175], v[44:47]
  v_mfma_f32_16x16x32_bf16 v[16:19], a[64:67], v[176:179], v[16:19]
  v_mfma_f32_16x16x32_bf16 v[32:35], a[64:67], v[180:183], v[32:35]
  v_mfma_f32_16x16x32_bf16 v[20:23], a[68:71], v[176:179], v[20:23]
  v_mfma_f32_16x16x32_bf16 v[36:39], a[68:71], v[180:183], v[36:39]
  buffer_load_dwordx4 v[108:111], v50, s[52:55], s36 offen offset:0 sc1
  s_waitcnt lgkmcnt(10)
  v_mfma_f32_16x16x32_bf16 v[24:27], a[72:75], v[176:179], v[24:27]
  buffer_load_dwordx4 v[112:115], v50, s[52:55], s36 offen offset:1024 sc1
  v_mfma_f32_16x16x32_bf16 v[40:43], a[72:75], v[180:183], v[40:43]
  buffer_load_dwordx4 v[116:119], v50, s[52:55], s36 offen offset:2048 sc1
  s_waitcnt lgkmcnt(8)
  v_mfma_f32_16x16x32_bf16 v[28:31], a[76:79], v[176:179], v[28:31]
  buffer_load_dwordx4 v[120:123], v50, s[52:55], s36 offen offset:3072 sc1
  v_mfma_f32_16x16x32_bf16 v[44:47], a[76:79], v[180:183], v[44:47]
  s_waitcnt lgkmcnt(6)
  v_mfma_f32_16x16x32_bf16 v[16:19], a[96:99], v[184:187], v[16:19]
  v_mfma_f32_16x16x32_bf16 v[32:35], a[96:99], v[188:191], v[32:35]
  s_waitcnt lgkmcnt(4)
  v_mfma_f32_16x16x32_bf16 v[20:23], a[100:103], v[184:187], v[20:23]
  v_mfma_f32_16x16x32_bf16 v[36:39], a[100:103], v[188:191], v[36:39]
  s_waitcnt lgkmcnt(2)
  v_mfma_f32_16x16x32_bf16 v[24:27], a[104:107], v[184:187], v[24:27]
  v_mfma_f32_16x16x32_bf16 v[40:43], a[104:107], v[188:191], v[40:43]
  s_waitcnt lgkmcnt(0)
  v_mfma_f32_16x16x32_bf16 v[28:31], a[108:111], v[184:187], v[28:31]
  v_mfma_f32_16x16x32_bf16 v[44:47], a[108:111], v[188:191], v[44:47]
  s_nop 7
  s_nop 1
  s_waitcnt lgkmcnt(0)
  v_pk_fma_f32 v[192:193], v[16:17], v[56:57], v[192:193]
  v_pk_fma_f32 v[194:195], v[18:19], v[58:59], v[194:195]
  v_pk_fma_f32 v[196:197], v[20:21], v[60:61], v[196:197]
  v_pk_fma_f32 v[198:199], v[22:23], v[62:63], v[198:199]
  v_pk_fma_f32 v[200:201], v[24:25], v[64:65], v[200:201]
  v_pk_fma_f32 v[202:203], v[26:27], v[66:67], v[202:203]
  v_pk_fma_f32 v[204:205], v[28:29], v[68:69], v[204:205]
  v_pk_fma_f32 v[206:207], v[30:31], v[70:71], v[206:207]
  v_pk_fma_f32 v[208:209], v[32:33], v[56:57], v[208:209]
  v_pk_fma_f32 v[210:211], v[34:35], v[58:59], v[210:211]
  v_pk_fma_f32 v[212:213], v[36:37], v[60:61], v[212:213]
  v_pk_fma_f32 v[214:215], v[38:39], v[62:63], v[214:215]
  v_pk_fma_f32 v[216:217], v[40:41], v[64:65], v[216:217]
  v_pk_fma_f32 v[218:219], v[42:43], v[66:67], v[218:219]
  v_pk_fma_f32 v[220:221], v[44:45], v[68:69], v[220:221]
  v_pk_fma_f32 v[222:223], v[46:47], v[70:71], v[222:223]
  s_mov_b32 s60, 262144
  s_branch L_chk_33
L_poll_31:
  buffer_load_dwordx4 v[108:111], v50, s[52:55], s36 offen offset:0 sc1
  buffer_load_dwordx4 v[112:115], v50, s[52:55], s36 offen offset:1024 sc1
  buffer_load_dwordx4 v[116:119], v50, s[52:55], s36 offen offset:2048 sc1
  buffer_load_dwordx4 v[120:123], v50, s[52:55], s36 offen offset:3072 sc1
L_chk_33:
  s_waitcnt vmcnt(3)
  v_max3_u32 v51, v108, v109, v110
  v_max_u32 v51, v51, v111
  s_waitcnt vmcnt(2)
  v_max3_u32 v51, v51, v112, v113
  v_max3_u32 v51, v51, v114, v115
  s_waitcnt vmcnt(1)
  v_max3_u32 v51, v51, v116, v117
  v_max3_u32 v51, v51, v118, v119
  s_waitcnt vmcnt(0)
  v_max3_u32 v51, v51, v120, v121
  v_max3_u32 v51, v51, v122, v123
  v_cmp_eq_u32 vcc, -1, v51
  s_nop 1
  s_cmp_eq_u64 vcc, 0
  s_cbranch_scc1 L_ready_32
  s_sub_u32 s60, s60, 1
  s_cmp_lg_u32 s60, 0
  s_cbranch_scc1 L_poll_31
L_ready_32:
  v_lshlrev_b32 v72, 16, v108
  v_and_b32 v73, 0xffff0000, v108
  v_lshlrev_b32 v74, 16, v109
  v_and_b32 v75, 0xffff0000, v109
  v_pk_fma_f32 v[192:193], v[72:73], v[56:57], v[192:193]
  v_pk_fma_f32 v[194:195], v[74:75], v[58:59], v[194:195]
  v_cvt_pk_bf16_f32 v0, v192, v193
  v_cvt_pk_bf16_f32 v1, v194, v195
  v_lshlrev_b32 v76, 16, v110
  v_and_b32 v77, 0xffff0000, v110
  v_lshlrev_b32 v78, 16, v111
  v_and_b32 v79, 0xffff0000, v111
  v_pk_fma_f32 v[196:197], v[76:77], v[60:61], v[196:197]
  v_pk_fma_f32 v[198:199], v[78:79], v[62:63], v[198:199]
  v_cvt_pk_bf16_f32 v2, v196, v197
  v_cvt_pk_bf16_f32 v3, v198, v199
  s_nop 1
  v_permlane16_swap_b32 v0, v2
  v_permlane16_swap_b32 v1, v3
  s_nop 1
  buffer_store_dwordx4 v[0:3], v252, s[44:47], 0 offen offset:0 sc1
  v_lshlrev_b32 v80, 16, v112
  v_and_b32 v81, 0xffff0000, v112
  v_lshlrev_b32 v82, 16, v113
  v_and_b32 v83, 0xffff0000, v113
  v_pk_fma_f32 v[200:201], v[80:81], v[64:65], v[200:201]
  v_pk_fma_f32 v[202:203], v[82:83], v[66:67], v[202:203]
  v_cvt_pk_bf16_f32 v4, v200, v201
  v_cvt_pk_bf16_f32 v5, v202, v203
  v_lshlrev_b32 v84, 16, v114
  v_and_b32 v85, 0xffff0000, v114
  v_lshlrev_b32 v86, 16, v115
  v_and_b32 v87, 0xffff0000, v115
  v_pk_fma_f32 v[204:205], v[84:85], v[68:69], v[204:205]
  v_pk_fma_f32 v[206:207], v[86:87], v[70:71], v[206:207]
  v_cvt_pk_bf16_f32 v6, v204, v205
  v_cvt_pk_bf16_f32 v7, v206, v207
  s_nop 1
  v_permlane16_swap_b32 v4, v6
  v_permlane16_swap_b32 v5, v7
  s_nop 1
  buffer_store_dwordx4 v[4:7], v252, s[44:47], 0 offen offset:64 sc1
  v_lshlrev_b32 v88, 16, v116
  v_and_b32 v89, 0xffff0000, v116
  v_lshlrev_b32 v90, 16, v117
  v_and_b32 v91, 0xffff0000, v117
  v_pk_fma_f32 v[208:209], v[88:89], v[56:57], v[208:209]
  v_pk_fma_f32 v[210:211], v[90:91], v[58:59], v[210:211]
  v_cvt_pk_bf16_f32 v8, v208, v209
  v_cvt_pk_bf16_f32 v9, v210, v211
  v_lshlrev_b32 v92, 16, v118
  v_and_b32 v93, 0xffff0000, v118
  v_lshlrev_b32 v94, 16, v119
  v_and_b32 v95, 0xffff0000, v119
  v_pk_fma_f32 v[212:213], v[92:93], v[60:61], v[212:213]
  v_pk_fma_f32 v[214:215], v[94:95], v[62:63], v[214:215]
  v_cvt_pk_bf16_f32 v10, v212, v213
  v_cvt_pk_bf16_f32 v11, v214, v215
  s_nop 1
  v_permlane16_swap_b32 v8, v10
  v_permlane16_swap_b32 v9, v11
  s_nop 1
  buffer_store_dwordx4 v[8:11], v252, s[44:47], s43 offen offset:0 sc1
  v_lshlrev_b32 v96, 16, v120
  v_and_b32 v97, 0xffff0000, v120
  v_lshlrev_b32 v98, 16, v121
  v_and_b32 v99, 0xffff0000, v121
  v_pk_fma_f32 v[216:217], v[96:97], v[64:65], v[216:217]
  v_pk_fma_f32 v[218:219], v[98:99], v[66:67], v[218:219]
  v_cvt_pk_bf16_f32 v12, v216, v217
  v_cvt_pk_bf16_f32 v13, v218, v219
  v_lshlrev_b32 v100, 16, v122
  v_and_b32 v101, 0xffff0000, v122
  v_lshlrev_b32 v102, 16, v123
  v_and_b32 v103, 0xffff0000, v123
  v_pk_fma_f32 v[220:221], v[100:101], v[68:69], v[220:221]
  v_pk_fma_f32 v[222:223], v[102:103], v[70:71], v[222:223]
  v_cvt_pk_bf16_f32 v14, v220, v221
  v_cvt_pk_bf16_f32 v15, v222, v223
  s_nop 1
  v_permlane16_swap_b32 v12, v14
  v_permlane16_swap_b32 v13, v15
  s_nop 1
  buffer_store_dwordx4 v[12:15], v252, s[44:47], s43 offen offset:64 sc1
  s_endpgm
L_slow_9:
  s_mov_b32 s33, 262144
L_spin_34:
  buffer_load_dword v127, v126, s[64:67], 0 offen sc1
  s_waitcnt vmcnt(0)
  v_cmp_ne_u32 vcc, s19, v127
  s_nop 1
  s_cmp_eq_u64 vcc, 0
  s_cbranch_scc1 L_back_10
  s_sub_u32 s33, s33, 1
  s_cmp_lg_u32 s33, 0
  s_cbranch_scc1 L_spin_34
  s_branch L_back_10
L_vslow_11:
  s_mov_b32 s33, 262144
L_spin_35:
  buffer_load_dwordx4 v[250:253], v254, s[12:15], s68 offen sc1
  s_waitcnt vmcnt(0)
  v_xor_b32 v168, s44, v250
  v_xor_b32 v169, s45, v251
  v_xor_b32 v170, s46, v252
  v_xor_b32 v171, s47, v253
  v_or3_b32 v172, v168, v169, v170
  v_or_b32 v172, v172, v171
  v_and_b32 v172, 0xff, v172
  v_cmp_ne_u32 vcc, 0, v172
  s_nop 1
  s_cmp_eq_u64 vcc, 0
  s_cbranch_scc1 L_vback_12
  s_sub_u32 s33, s33, 1
  s_cmp_lg_u32 s33, 0
  s_cbranch_scc1 L_spin_35
  s_branch L_vback_12
L_slow_21:
  s_mov_b32 s69, 262144
L_spin_36:
  buffer_load_dword v247, v246, s[64:67], s68 offen sc1
  s_waitcnt vmcnt(0)
  v_cmp_ne_u32 vcc, s19, v247
  s_nop 1
  s_cmp_eq_u64 vcc, 0
  s_cbranch_scc1 L_back_22
  s_sub_u32 s69, s69, 1
  s_cmp_lg_u32 s69, 0
  s_cbranch_scc1 L_spin_36
  s_branch L_back_22
L_slow_25:
  s_mov_b32 s60, 262144
L_spin_37:
  buffer_load_dword v247, v246, s[56:59], s94 offen sc1
  s_waitcnt vmcnt(0)
  v_cmp_ne_u32 vcc, s19, v247
  s_nop 1
  s_cmp_eq_u64 vcc, 0
  s_cbranch_scc1 L_back_26
  s_sub_u32 s60, s60, 1
  s_cmp_lg_u32 s60, 0
  s_cbranch_scc1 L_spin_37
  s_branch L_back_26
L_slow_27:
  s_mov_b32 s60, 262144
L_spin_38:
  buffer_load_dword v247, v246, s[56:59], s94 offen sc1
  s_waitcnt vmcnt(0)
  v_cmp_ne_u32 vcc, s19, v247
  s_nop 1
  s_cmp_eq_u64 vcc, 0
  s_cbranch_scc1 L_back_28
  s_sub_u32 s60, s60, 1
  s_cmp_lg_u32 s60, 0
  s_cbranch_scc1 L_spin_38
  s_branch L_back_28
L_slow_29:
  s_mov_b32 s60, 262144
L_spin_39:
  buffer_load_dword v247, v246, s[56:59], s94 offen sc1
  s_waitcnt vmcnt(0)
  v_cmp_ne_u32 vcc, s19, v247
  s_nop 1
  s_cmp_eq_u64 vcc, 0
  s_cbranch_scc1 L_back_30
  s_sub_u32 s60, s60, 1
  s_cmp_lg_u32 s60, 0
  s_cbranch_scc1 L_spin_39
  s_branch L_back_30
L_end_1:
  s_endpgm
L_code_end:
  s_endpgm
.section .rodata,"a"
.p2align 6
.amdhsa_kernel adaLN_cond__sliding_local_dilated__glu_gated_glu__prompt_kernel
  .amdhsa_next_free_vgpr 512
  .amdhsa_next_free_sgpr 102
  .amdhsa_accum_offset 256
  .amdhsa_group_segment_fixed_size 0
  .amdhsa_kernarg_size 96
  .amdhsa_user_sgpr_count 2
  .amdhsa_user_sgpr_kernarg_segment_ptr 1
  .amdhsa_system_sgpr_workgroup_id_x 1
  .amdhsa_float_denorm_mode_32 3
.end_amdhsa_kernel
```

```asm
; @launch grid=(256,1,1) block=(256,1,1) lds=163840
.amdgcn_target "amdgcn-amd-amdhsa--gfx950"
.text
.globl adaLN_cond__sliding_local_dilated__glu_gated_glu__prompt_kernel
.p2align 8
.type adaLN_cond__sliding_local_dilated__glu_gated_glu__prompt_kernel,@function
adaLN_cond__sliding_local_dilated__glu_gated_glu__prompt_kernel:
  s_cmp_ge_u32 s2, 256
  s_cbranch_scc1 L_end_1
  s_load_dwordx2 s[44:45], s[0:1], 56
  s_load_dwordx2 s[52:53], s[0:1], 64
  s_load_dwordx2 s[12:13], s[0:1], 0
  s_load_dwordx2 s[20:21], s[0:1], 88
  s_load_dwordx2 s[8:9], s[0:1], 8
  s_getpc_b64 s[58:59]
  v_and_b32 v86, 31, v0
  v_lshlrev_b32 v86, 7, v86
  global_load_dword v131, v86, s[58:59] offset:128
  v_lshrrev_b32 v110, 6, v0
  v_and_b32 v104, 63, v0
  s_nop 0
  v_readfirstlane_b32 s3, v110
  s_and_b32 s29, s2, 3
  s_and_b32 s28, s2, 4
  s_lshl_b32 s28, s28, 3
  s_lshr_b32 s31, s2, 3
  s_or_b32 s28, s28, s31
  v_lshrrev_b32 v1, 2, v104
  v_mul_u32_u24 v1, 12288, v1
  v_and_b32 v66, 3, v104
  v_lshl_add_u32 v1, v66, 4, v1
  v_lshlrev_b32 v2, 1, v0
  s_lshl2_add_u32 s30, s29, s3
  s_mul_i32 s50, s30, 786432
  s_lshl_b32 s31, s28, 6
  s_add_u32 s35, s50, s31
  s_lshl_b32 s34, s29, 9
  s_lshl_b32 s31, s3, 12
  s_add_u32 m0, s31, 79872
  v_and_b32 v66, 7, v104
  v_lshlrev_b32 v3, 11, v66
  v_lshrrev_b32 v67, 3, v104
  v_lshl_add_u32 v3, v67, 4, v3
  s_lshl2_add_u32 s37, s28, s29
  s_lshl_b32 s36, s37, 14
  s_lshl_b32 s31, s3, 9
  s_add_u32 s36, s36, s31
  s_movk_i32 s46, 2048
  s_mov_b32 s47, 0x20000
  s_mov_b32 s54, 12582912
  s_mov_b32 s55, 0x20000
  s_mov_b32 s14, 4194304
  s_mov_b32 s15, 0x20000
  s_waitcnt lgkmcnt(0)
  s_load_dword s19, s[20:21], 0x40000
  buffer_load_ushort v4, v2, s[44:47], s34 offen
  buffer_load_dwordx4 v1, s[52:55], s35 offen offset:0 lds
  s_add_u32 s35, s35, 195584
  buffer_load_dwordx4 v1, s[52:55], s35 offen offset:1024 lds
  s_add_u32 s35, s35, 195584
  buffer_load_dwordx4 v1, s[52:55], s35 offen offset:2048 lds
  s_add_u32 s35, s35, 195584
  buffer_load_dwordx4 v1, s[52:55], s35 offen offset:3072 lds
  s_barrier
  buffer_load_dwordx4 v[8:11], v3, s[12:15], s36 offen offset:0
  buffer_load_dwordx4 v[12:15], v3, s[12:15], s36 offen offset:128
  buffer_load_dwordx4 v[16:19], v3, s[12:15], s36 offen offset:256
  buffer_load_dwordx4 v[20:23], v3, s[12:15], s36 offen offset:384
  s_load_dwordx2 s[24:25], s[0:1], 16
  s_load_dwordx4 s[60:63], s[0:1], 32
  s_load_dwordx2 s[22:23], s[0:1], 48
  s_load_dwordx2 s[90:91], s[0:1], 72
  s_mov_b64 s[26:27], s[12:13]
  s_bfe_u32 s30, s2, 0x10002
  s_xor_b32 s30, s30, 1
  s_lshl_b32 s30, s30, 3
  s_bfe_u32 s31, s2, 0x30003
  s_add_u32 s30, s30, s31
  s_bfe_u32 s31, s2, 0x20000
  s_lshl_b32 s31, s31, 2
  s_lshr_b32 s34, s2, 6
  s_add_u32 s31, s31, s34
  v_and_b32 v111, 2, v67
  v_xor_b32 v111, v111, v66
  v_mul_u32_u24 v129, 12288, v67
  v_lshl_add_u32 v129, v111, 4, v129
  s_and_b32 s33, s3, 1
  s_lshl_b32 s33, s33, 2
  v_xor_b32 v111, s33, v111
  v_mul_u32_u24 v110, 6144, v67
  v_lshl_add_u32 v110, v111, 4, v110
  s_mul_i32 s32, s3, 49152
  s_lshl_b32 s33, s31, 7
  s_add_u32 s32, s32, s33
  v_add_u32 v107, s32, v110
  v_add_u32 v108, 1024, v107
  v_add_u32 v109, 2048, v107
  s_mul_i32 s38, s3, 3072
  s_and_b32 s33, s30, 7
  s_mul_i32 s16, s33, 131072
  s_mul_i32 s17, s33, 196608
  s_mov_b32 s10, 1572864
  s_mov_b32 s11, 0x20000
  s_barrier
  s_getpc_b64 s[100:101]
  L_pc_2:
  s_add_u32 s100, s100, L_gemm_a-L_pc_2
  s_addc_u32 s101, s101, 0
  s_lshr_b32 s33, s2, 3
  s_lshl_b32 s33, s33, 2
  s_add_u32 s33, s33, s3
  s_lshl_b32 s33, s33, 13
  v_lshlrev_b32 v200, 7, v104
  v_add_u32 v200, s33, v200
  v_min_u32 v200, L_code_end-L_gemm_a-4, v200
  v_mov_b32 v201, s101
  v_add_co_u32 v200, vcc, s100, v200
  s_nop 1
  v_addc_co_u32 v201, vcc, 0, v201, vcc
  global_load_dword v131, v[200:201], off
  v_lshrrev_b32 v68, 4, v104
  v_bfe_u32 v69, v104, 2, 2
  v_lshl_add_u32 v69, v68, 3, v69
  v_and_b32 v70, 3, v104
  v_lshlrev_b32 v70, 3, v70
  s_lshl_b32 s33, s3, 5
  s_add_u32 s33, s33, 106496
  v_add_u32 v70, s33, v70
  v_lshl_add_u32 v5, v69, 6, v70
  v_subrev_u32 v5, 26624, v5
  v_lshl_add_u32 v196, v69, 7, v70
  v_and_b32 v70, 8, v104
  v_lshlrev_b32 v70, 2, v70
  v_xor_b32 v196, v196, v70
  v_lshlrev_b32 v255, 4, v68
  v_add_u32 v197, 147456, v255
  v_and_b32 v70, 15, v104
  v_lshl_or_b32 v255, v70, 24, v255
  v_mov_b32 v198, 0xffffff00
  v_add_u32 v2, 147456, v2
  s_mov_b32 s12, s20
  s_mov_b32 s13, s21
  s_mov_b32 s14, 0x38000
  s_mov_b32 s15, 0x20000
  s_mul_i32 s96, s29, 24576
  s_lshl_b32 s33, s3, 6
  s_add_u32 s96, s96, s33
  s_lshl_b32 s33, s28, 7
  s_add_u32 s34, s96, s33
  s_add_u32 s96, s34, s33
  s_add_u32 s96, s96, 8192
  s_add_u32 s50, s50, s33
  s_add_u32 s50, s50, 4096
  s_lshl_b32 s51, s3, 13
  s_add_u32 s51, s51, 106496
  s_waitcnt vmcnt(9)
  v_lshlrev_b32 v4, 16, v4
  v_mul_f32 v6, 0xbfb8aa3b, v4
  v_exp_f32 v6, v6
  s_nop 0
  v_add_f32 v6, 1.0, v6
  v_rcp_f32 v6, v6
  s_nop 0
  v_mul_f32 v4, v4, v6
  v_cvt_pk_bf16_f32 v4, v4, v4
  ds_write_b16 v2, v4
  s_waitcnt vmcnt(5) lgkmcnt(0)
  s_barrier
  s_mul_i32 s19, s19, 0x9e3779b1
  s_add_u32 s19, s19, 0x7f4a7c15
  s_bfe_u32 s40, s19, 0x80000
  s_bfe_u32 s41, s19, 0x80008
  s_bfe_u32 s42, s19, 0x80010
  s_bfe_u32 s43, s19, 0x80018
  s_cmp_ge_u32 s3, 2
  s_cbranch_scc1 L_nog_3
  ds_read_b64_tr_b16 a[64:65], v5 offset:0
  ds_read_b64_tr_b16 a[66:67], v5 offset:256
  ds_read_b128 a[68:71], v197 offset:0
  ds_read_b64_tr_b16 a[72:73], v5 offset:2048
  ds_read_b64_tr_b16 a[74:75], v5 offset:2304
  ds_read_b128 a[76:79], v197 offset:64
  ds_read_b64_tr_b16 a[80:81], v5 offset:4096
  ds_read_b64_tr_b16 a[82:83], v5 offset:4352
  ds_read_b128 a[84:87], v197 offset:128
  ds_read_b64_tr_b16 a[88:89], v5 offset:6144
  ds_read_b64_tr_b16 a[90:91], v5 offset:6400
  ds_read_b128 a[92:95], v197 offset:192
  ds_read_b64_tr_b16 a[96:97], v5 offset:8192
  ds_read_b64_tr_b16 a[98:99], v5 offset:8448
  ds_read_b128 a[100:103], v197 offset:256
  s_waitcnt lgkmcnt(12)
  v_mfma_f32_16x16x32_bf16 v[192:195], a[64:67], a[68:71], 0
  ds_read_b64_tr_b16 a[104:105], v5 offset:10240
  ds_read_b64_tr_b16 a[106:107], v5 offset:10496
  ds_read_b128 a[108:111], v197 offset:320
  s_waitcnt lgkmcnt(12)
  v_mfma_f32_16x16x32_bf16 v[192:195], a[72:75], a[76:79], v[192:195]
  ds_read_b64_tr_b16 a[112:113], v5 offset:12288
  ds_read_b64_tr_b16 a[114:115], v5 offset:12544
  ds_read_b128 a[116:119], v197 offset:384
  s_waitcnt lgkmcnt(12)
  v_mfma_f32_16x16x32_bf16 v[192:195], a[80:83], a[84:87], v[192:195]
  ds_read_b64_tr_b16 a[120:121], v5 offset:14336
  ds_read_b64_tr_b16 a[122:123], v5 offset:14592
  ds_read_b128 a[124:127], v197 offset:448
  s_waitcnt lgkmcnt(12)
  v_mfma_f32_16x16x32_bf16 v[192:195], a[88:91], a[92:95], v[192:195]
  s_waitcnt lgkmcnt(9)
  v_mfma_f32_16x16x32_bf16 v[192:195], a[96:99], a[100:103], v[192:195]
  s_waitcnt lgkmcnt(6)
  v_mfma_f32_16x16x32_bf16 v[192:195], a[104:107], a[108:111], v[192:195]
  s_waitcnt lgkmcnt(3)
  v_mfma_f32_16x16x32_bf16 v[192:195], a[112:115], a[116:119], v[192:195]
  s_waitcnt lgkmcnt(0)
  v_mfma_f32_16x16x32_bf16 v[192:195], a[120:123], a[124:127], v[192:195]
  s_nop 7
  v_and_or_b32 v192, v192, v198, s40
  v_and_or_b32 v193, v193, v198, s41
  v_and_or_b32 v194, v194, v198, s42
  v_and_or_b32 v195, v195, v198, s43
  buffer_store_dwordx4 v[192:195], v255, s[12:15], s34 offen sc1
L_nog_3:
  s_waitcnt vmcnt(1)
  v_lshlrev_b32 v24, 16, v8
  v_and_b32 v25, 0xffff0000, v8
  v_lshlrev_b32 v26, 16, v9
  v_and_b32 v27, 0xffff0000, v9
  v_lshlrev_b32 v28, 16, v10
  v_and_b32 v29, 0xffff0000, v10
  v_lshlrev_b32 v30, 16, v11
  v_and_b32 v31, 0xffff0000, v11
  v_lshlrev_b32 v32, 16, v12
  v_and_b32 v33, 0xffff0000, v12
  v_lshlrev_b32 v34, 16, v13
  v_and_b32 v35, 0xffff0000, v13
  v_lshlrev_b32 v36, 16, v14
  v_and_b32 v37, 0xffff0000, v14
  v_lshlrev_b32 v38, 16, v15
  v_and_b32 v39, 0xffff0000, v15
  v_lshlrev_b32 v40, 16, v16
  v_and_b32 v41, 0xffff0000, v16
  v_lshlrev_b32 v42, 16, v17
  v_and_b32 v43, 0xffff0000, v17
  v_lshlrev_b32 v44, 16, v18
  v_and_b32 v45, 0xffff0000, v18
  v_lshlrev_b32 v46, 16, v19
  v_and_b32 v47, 0xffff0000, v19
  v_lshlrev_b32 v48, 16, v20
  v_and_b32 v49, 0xffff0000, v20
  v_lshlrev_b32 v50, 16, v21
  v_and_b32 v51, 0xffff0000, v21
  v_lshlrev_b32 v52, 16, v22
  v_and_b32 v53, 0xffff0000, v22
  v_lshlrev_b32 v54, 16, v23
  v_and_b32 v55, 0xffff0000, v23
  v_pk_add_f32 v[56:57], v[24:25], v[26:27]
  v_pk_mul_f32 v[58:59], v[24:25], v[24:25]
  v_pk_mul_f32 v[60:61], v[26:27], v[26:27]
  v_pk_add_f32 v[56:57], v[56:57], v[28:29]
  v_pk_fma_f32 v[58:59], v[28:29], v[28:29], v[58:59]
  v_pk_add_f32 v[56:57], v[56:57], v[30:31]
  v_pk_fma_f32 v[60:61], v[30:31], v[30:31], v[60:61]
  v_pk_add_f32 v[56:57], v[56:57], v[32:33]
  v_pk_fma_f32 v[58:59], v[32:33], v[32:33], v[58:59]
  v_pk_add_f32 v[56:57], v[56:57], v[34:35]
  v_pk_fma_f32 v[60:61], v[34:35], v[34:35], v[60:61]
  v_pk_add_f32 v[56:57], v[56:57], v[36:37]
  v_pk_fma_f32 v[58:59], v[36:37], v[36:37], v[58:59]
  v_pk_add_f32 v[56:57], v[56:57], v[38:39]
  v_pk_fma_f32 v[60:61], v[38:39], v[38:39], v[60:61]
  v_pk_add_f32 v[56:57], v[56:57], v[40:41]
  v_pk_fma_f32 v[58:59], v[40:41], v[40:41], v[58:59]
  v_pk_add_f32 v[56:57], v[56:57], v[42:43]
  v_pk_fma_f32 v[60:61], v[42:43], v[42:43], v[60:61]
  v_pk_add_f32 v[56:57], v[56:57], v[44:45]
  v_pk_fma_f32 v[58:59], v[44:45], v[44:45], v[58:59]
  v_pk_add_f32 v[56:57], v[56:57], v[46:47]
  v_pk_fma_f32 v[60:61], v[46:47], v[46:47], v[60:61]
  v_pk_add_f32 v[56:57], v[56:57], v[48:49]
  v_pk_fma_f32 v[58:59], v[48:49], v[48:49], v[58:59]
  v_pk_add_f32 v[56:57], v[56:57], v[50:51]
  v_pk_fma_f32 v[60:61], v[50:51], v[50:51], v[60:61]
  v_pk_add_f32 v[56:57], v[56:57], v[52:53]
  v_pk_fma_f32 v[58:59], v[52:53], v[52:53], v[58:59]
  v_pk_add_f32 v[56:57], v[56:57], v[54:55]
  v_pk_fma_f32 v[60:61], v[54:55], v[54:55], v[60:61]
  v_pk_add_f32 v[58:59], v[58:59], v[60:61]
  v_add_f32 v56, v56, v57
  v_add_f32 v57, v58, v59
  s_nop 1
  v_add_f32_dpp v56, v56, v56 row_ror:8 row_mask:0xf bank_mask:0xf
  v_add_f32_dpp v57, v57, v57 row_ror:8 row_mask:0xf bank_mask:0xf
  v_mov_b32 v58, v56
  v_mov_b32 v59, v57
  s_nop 1
  v_permlane16_swap_b32 v58, v56
  v_permlane16_swap_b32 v59, v57
  s_nop 1
  v_add_f32 v56, v56, v58
  v_add_f32 v57, v57, v59
  v_mov_b32 v58, v56
  v_mov_b32 v59, v57
  s_nop 1
  v_permlane32_swap_b32 v58, v56
  v_permlane32_swap_b32 v59, v57
  s_nop 1
  v_add_f32 v56, v56, v58
  v_add_f32 v57, v57, v59
  v_lshlrev_b32 v68, 5, v66
  v_add_u32 v68, 147968, v68
  s_lshl_b32 s33, s3, 3
  v_add_u32 v69, s33, v68
  ds_write_b64 v69, v[56:57]
  v_lshlrev_b32 v119, 4, v104
  s_lshl_b32 s33, s3, 10
  v_add_u32 v1, s33, v119
  v_add_u32 v2, 4096, v1
  s_lshl_b32 s33, s3, 11
  s_add_u32 s33, s33, 139264
  v_add_u32 v3, s33, v119
  v_lshlrev_b32 v4, 5, v67
  v_add_u32 v4, s33, v4
  v_lshrrev_b32 v5, 5, v104
  v_lshlrev_b32 v5, 17, v5
  v_and_b32 v70, 3, v67
  v_lshl_add_u32 v5, v70, 8, v5
  v_lshl_add_u32 v5, v66, 4, v5
  s_waitcnt lgkmcnt(0)
  s_barrier
  ds_read_b128 v[132:135], v68 offset:0
  ds_read_b128 v[136:139], v68 offset:16
  s_add_u32 m0, s38, 0
  s_nop 0
  buffer_load_dwordx4 v107, s[8:11], s17 offen lds
  buffer_load_dwordx4 v108, s[8:11], s17 offen offset:1024 lds
  buffer_load_dwordx4 v109, s[8:11], s17 offen offset:2048 lds
  s_add_u32 s17, s17, 196608
  s_cmp_eq_u32 s17, s10
  s_cselect_b32 s17, 0, s17
  s_mov_b32 s32, 24576
  s_mov_b32 s35, 49152
  s_mov_b32 s36, 73728
  s_add_u32 s4, s20, 0x200000
  s_addc_u32 s5, s21, 0
  s_mov_b32 s6, 0x400000
  s_mov_b32 s7, 0x20000
  s_add_u32 s64, s20, 0xc0000
  s_addc_u32 s65, s21, 0
  s_mov_b32 s66, 0x20000
  s_mov_b32 s67, 0x20000
  s_waitcnt lgkmcnt(0)
  v_pk_add_f32 v[132:133], v[132:133], v[134:135]
  v_pk_add_f32 v[136:137], v[136:137], v[138:139]
  v_pk_add_f32 v[132:133], v[132:133], v[136:137]
  v_mul_f32 v56, 0x3a800000, v132
  v_mul_f32 v60, 0x3a800000, v133
  v_fma_f32 v60, -v56, v56, v60
  v_max_f32 v60, 0, v60
  buffer_load_dwordx4 v[72:75], v1, s[12:15], 0 offen sc1
  buffer_load_dwordx4 v[76:79], v1, s[12:15], s32 offen sc1
  buffer_load_dwordx4 v[80:83], v1, s[12:15], s35 offen sc1
  buffer_load_dwordx4 v[84:87], v1, s[12:15], s36 offen sc1
  buffer_load_dwordx4 v[88:91], v2, s[12:15], 0 offen sc1
  buffer_load_dwordx4 v[92:95], v2, s[12:15], s32 offen sc1
  buffer_load_dwordx4 v[96:99], v2, s[12:15], s35 offen sc1
  buffer_load_dwordx4 v[100:103], v2, s[12:15], s36 offen sc1
  v_cvt_pk_bf16_f32 v64, v56, v60
  v_lshlrev_b32 v56, 16, v64
  v_and_b32 v60, 0xffff0000, v64
  v_add_f32 v60, 0x3727c5ac, v60
  v_cvt_pk_bf16_f32 v64, v60, v61
  v_lshlrev_b32 v60, 16, v64
  v_and_b32 v61, 0xffff0000, v64
  v_sqrt_f32 v60, v60
  s_nop 0
  v_cvt_pk_bf16_f32 v64, v60, v61
  v_lshlrev_b32 v60, 16, v64
  v_and_b32 v61, 0xffff0000, v64
  v_rcp_f32 v60, v60
  v_mov_b32 v57, v56
  s_nop 0
  v_mov_b32 v61, v60
  v_pk_add_f32 v[24:25], v[24:25], v[56:57] neg_lo:[0,1] neg_hi:[0,1]
  v_pk_add_f32 v[26:27], v[26:27], v[56:57] neg_lo:[0,1] neg_hi:[0,1]
  v_pk_add_f32 v[28:29], v[28:29], v[56:57] neg_lo:[0,1] neg_hi:[0,1]
  v_pk_add_f32 v[30:31], v[30:31], v[56:57] neg_lo:[0,1] neg_hi:[0,1]
  v_pk_add_f32 v[32:33], v[32:33], v[56:57] neg_lo:[0,1] neg_hi:[0,1]
  v_pk_add_f32 v[34:35], v[34:35], v[56:57] neg_lo:[0,1] neg_hi:[0,1]
  v_pk_add_f32 v[36:37], v[36:37], v[56:57] neg_lo:[0,1] neg_hi:[0,1]
  v_pk_add_f32 v[38:39], v[38:39], v[56:57] neg_lo:[0,1] neg_hi:[0,1]
  v_pk_add_f32 v[40:41], v[40:41], v[56:57] neg_lo:[0,1] neg_hi:[0,1]
  v_pk_add_f32 v[42:43], v[42:43], v[56:57] neg_lo:[0,1] neg_hi:[0,1]
  v_pk_add_f32 v[44:45], v[44:45], v[56:57] neg_lo:[0,1] neg_hi:[0,1]
  v_pk_add_f32 v[46:47], v[46:47], v[56:57] neg_lo:[0,1] neg_hi:[0,1]
  v_pk_add_f32 v[48:49], v[48:49], v[56:57] neg_lo:[0,1] neg_hi:[0,1]
  v_pk_add_f32 v[50:51], v[50:51], v[56:57] neg_lo:[0,1] neg_hi:[0,1]
  v_pk_add_f32 v[52:53], v[52:53], v[56:57] neg_lo:[0,1] neg_hi:[0,1]
  v_pk_add_f32 v[54:55], v[54:55], v[56:57] neg_lo:[0,1] neg_hi:[0,1]
  v_pk_mul_f32 v[24:25], v[24:25], v[60:61]
  v_pk_mul_f32 v[26:27], v[26:27], v[60:61]
  v_pk_mul_f32 v[28:29], v[28:29], v[60:61]
  v_pk_mul_f32 v[30:31], v[30:31], v[60:61]
  v_pk_mul_f32 v[32:33], v[32:33], v[60:61]
  v_pk_mul_f32 v[34:35], v[34:35], v[60:61]
  v_pk_mul_f32 v[36:37], v[36:37], v[60:61]
  v_pk_mul_f32 v[38:39], v[38:39], v[60:61]
  v_pk_mul_f32 v[40:41], v[40:41], v[60:61]
  v_pk_mul_f32 v[42:43], v[42:43], v[60:61]
  v_pk_mul_f32 v[44:45], v[44:45], v[60:61]
  v_pk_mul_f32 v[46:47], v[46:47], v[60:61]
  v_pk_mul_f32 v[48:49], v[48:49], v[60:61]
  v_pk_mul_f32 v[50:51], v[50:51], v[60:61]
  v_pk_mul_f32 v[52:53], v[52:53], v[60:61]
  v_pk_mul_f32 v[54:55], v[54:55], v[60:61]
  s_lshl_b32 s39, s3, 8
  s_add_u32 s39, s39, 12288
  s_lshl_b32 s33, s30, 6
  s_lshl_b32 s34, s3, 4
  s_add_u32 s34, s34, s33
  s_max_u32 s33, s33, 8
  s_sub_u32 s33, s33, 8
  v_add_u32 v110, s33, v66
  v_add_u32 v126, s34, v104
  v_cmp_lt_u32 vcc, 15, v104
  s_nop 1
  v_cndmask_b32 v126, v126, v110, vcc
  s_mov_b32 s33, 0
  v_and_b32 v128, 0, v126
  v_add_u32 v128, s33, v128
  v_and_b32 v128, 3, v128
  v_and_or_b32 v128, v126, -4, v128
  v_lshlrev_b32 v126, 6, v126
  v_lshlrev_b32 v128, 6, v128
  s_lshl_b32 s34, s30, 13
  s_lshl_b32 s33, s3, 11
  s_add_u32 s34, s34, s33
  v_add_u32 v105, s34, v119
  s_lshl_b32 s34, s30, 3
  s_max_u32 s34, s34, 1
  s_sub_u32 s34, s34, 1
  s_lshl_b32 s34, s34, 10
  s_lshl_b32 s33, s3, 8
  s_add_u32 s34, s34, s33
  v_lshlrev_b32 v106, 2, v104
  v_add_u32 v106, s34, v106
  v_lshrrev_b32 v110, 4, v104
  v_mul_u32_u24 v110, 3072, v110
  v_bfe_u32 v111, v104, 2, 2
  v_lshl_add_u32 v110, v111, 7, v110
  v_bfe_u32 v111, v104, 3, 2
  v_lshl_add_u32 v110, v111, 5, v110
  v_and_b32 v111, 3, v104
  v_lshl_add_u32 v114, v111, 3, v110
  v_xor_b32 v115, 32, v114
  v_xor_b32 v116, 64, v114
  v_xor_b32 v117, 96, v114
  s_lshl_b32 s33, s3, 5
  v_xor_b32 v118, s33, v114
  v_add_u32 v120, 53248, v114
  v_add_u32 v121, 53248, v115
  v_add_u32 v122, 53248, v116
  v_add_u32 v123, 53248, v117
  v_add_u32 v124, 53248, v118
  v_add_u32 v125, 53248, v119
  v_and_b32 v110, 14, v104
  v_lshrrev_b32 v111, 4, v104
  v_lshlrev_b32 v111, 2, v111
  v_cmp_le_u32 s[44:45], v111, v110
  v_add_u32 v111, 2, v111
  v_cmp_le_u32 s[46:47], v111, v110
  v_and_b32 v110, 1, v104
  v_cmp_eq_u32 s[48:49], 1, v110
  s_lshl_b32 s56, s3, 20
  s_lshr_b32 s33, s37, 1
  s_lshl_b32 s33, s33, 10
  s_add_u32 s56, s56, s33
  s_and_b32 s33, s37, 1
  s_lshl_b32 s33, s33, 7
  s_add_u32 s56, s56, s33
  s_add_u32 s57, s56, 262144
  s_add_u32 s58, s56, 524288
  s_add_u32 s59, s56, 786432
  s_lshl2_add_u32 s37, s37, s3
  s_lshl_b32 s37, s37, 6
  s_mov_b32 s33, 262144
L_mod_4:
  s_waitcnt vmcnt(7)
  v_xor_b32 v72, s40, v72
  v_xor_b32 v73, s41, v73
  v_xor_b32 v74, s42, v74
  v_xor_b32 v75, s43, v75
  v_or3_b32 v66, v72, v73, v74
  v_or_b32 v66, v66, v75
  s_waitcnt vmcnt(6)
  v_xor_b32 v76, s40, v76
  v_xor_b32 v77, s41, v77
  v_xor_b32 v78, s42, v78
  v_xor_b32 v79, s43, v79
  v_or3_b32 v66, v66, v76, v77
  v_or3_b32 v66, v66, v78, v79
  s_waitcnt vmcnt(5)
  v_xor_b32 v80, s40, v80
  v_xor_b32 v81, s41, v81
  v_xor_b32 v82, s42, v82
  v_xor_b32 v83, s43, v83
  v_or3_b32 v66, v66, v80, v81
  v_or3_b32 v66, v66, v82, v83
  s_waitcnt vmcnt(4)
  v_xor_b32 v84, s40, v84
  v_xor_b32 v85, s41, v85
  v_xor_b32 v86, s42, v86
  v_xor_b32 v87, s43, v87
  v_or3_b32 v66, v66, v84, v85
  v_or3_b32 v66, v66, v86, v87
  s_waitcnt vmcnt(3)
  v_xor_b32 v88, s40, v88
  v_xor_b32 v89, s41, v89
  v_xor_b32 v90, s42, v90
  v_xor_b32 v91, s43, v91
  v_or3_b32 v66, v66, v88, v89
  v_or3_b32 v66, v66, v90, v91
  s_waitcnt vmcnt(2)
  v_xor_b32 v92, s40, v92
  v_xor_b32 v93, s41, v93
  v_xor_b32 v94, s42, v94
  v_xor_b32 v95, s43, v95
  v_or3_b32 v66, v66, v92, v93
  v_or3_b32 v66, v66, v94, v95
  s_waitcnt vmcnt(1)
  v_xor_b32 v96, s40, v96
  v_xor_b32 v97, s41, v97
  v_xor_b32 v98, s42, v98
  v_xor_b32 v99, s43, v99
  v_or3_b32 v66, v66, v96, v97
  v_or3_b32 v66, v66, v98, v99
  s_waitcnt vmcnt(0)
  v_xor_b32 v100, s40, v100
  v_xor_b32 v101, s41, v101
  v_xor_b32 v102, s42, v102
  v_xor_b32 v103, s43, v103
  v_or3_b32 v66, v66, v100, v101
  v_or3_b32 v66, v66, v102, v103
  v_and_b32 v66, 0xff, v66
  v_cmp_ne_u32 vcc, 0, v66
  s_nop 1
  s_cmp_eq_u64 vcc, 0
  s_cbranch_scc1 L_mok_5
  s_mov_b64 exec, vcc
  buffer_load_dwordx4 v[72:75], v1, s[12:15], 0 offen sc1
  buffer_load_dwordx4 v[76:79], v1, s[12:15], s32 offen sc1
  buffer_load_dwordx4 v[80:83], v1, s[12:15], s35 offen sc1
  buffer_load_dwordx4 v[84:87], v1, s[12:15], s36 offen sc1
  buffer_load_dwordx4 v[88:91], v2, s[12:15], 0 offen sc1
  buffer_load_dwordx4 v[92:95], v2, s[12:15], s32 offen sc1
  buffer_load_dwordx4 v[96:99], v2, s[12:15], s35 offen sc1
  buffer_load_dwordx4 v[100:103], v2, s[12:15], s36 offen sc1
  s_sub_u32 s33, s33, 1
  s_cmp_lg_u32 s33, 0
  s_cbranch_scc1 L_mod_4
  s_waitcnt vmcnt(0)
L_mok_5:
  s_mov_b64 exec, -1
  v_pk_add_f32 v[72:73], v[72:73], v[80:81]
  v_pk_add_f32 v[74:75], v[74:75], v[82:83]
  v_pk_add_f32 v[76:77], v[76:77], v[84:85]
  v_pk_add_f32 v[78:79], v[78:79], v[86:87]
  v_pk_add_f32 v[88:89], v[88:89], v[96:97]
  v_pk_add_f32 v[90:91], v[90:91], v[98:99]
  v_pk_add_f32 v[92:93], v[92:93], v[100:101]
  v_pk_add_f32 v[94:95], v[94:95], v[102:103]
  v_pk_add_f32 v[72:73], v[72:73], v[76:77]
  v_pk_add_f32 v[74:75], v[74:75], v[78:79]
  v_pk_add_f32 v[88:89], v[88:89], v[92:93]
  v_pk_add_f32 v[90:91], v[90:91], v[94:95]
  v_cvt_pk_bf16_f32 v80, v72, v73
  v_lshlrev_b32 v72, 16, v80
  v_and_b32 v73, 0xffff0000, v80
  v_cvt_pk_bf16_f32 v81, v74, v75
  v_lshlrev_b32 v74, 16, v81
  v_and_b32 v75, 0xffff0000, v81
  v_cvt_pk_bf16_f32 v82, v88, v89
  v_lshlrev_b32 v88, 16, v82
  v_and_b32 v89, 0xffff0000, v82
  v_cvt_pk_bf16_f32 v83, v90, v91
  v_lshlrev_b32 v90, 16, v83
  v_and_b32 v91, 0xffff0000, v83
  ds_write_b128 v3, v[72:75]
  v_add_f32 v88, 1.0, v88
  v_add_f32 v89, 1.0, v89
  v_add_f32 v90, 1.0, v90
  v_add_f32 v91, 1.0, v91
  v_cvt_pk_bf16_f32 v80, v88, v89
  v_lshlrev_b32 v88, 16, v80
  v_and_b32 v89, 0xffff0000, v80
  v_cvt_pk_bf16_f32 v81, v90, v91
  v_lshlrev_b32 v90, 16, v81
  v_and_b32 v91, 0xffff0000, v81
  ds_write_b128 v3, v[88:91] offset:1024
  ds_read_b128 v[132:135], v4 offset:0
  ds_read_b128 v[164:167], v4 offset:1024
  ds_read_b128 v[136:139], v4 offset:16
  ds_read_b128 v[168:171], v4 offset:1040
  ds_read_b128 v[140:143], v4 offset:256
  ds_read_b128 v[172:175], v4 offset:1280
  ds_read_b128 v[144:147], v4 offset:272
  ds_read_b128 v[176:179], v4 offset:1296
  ds_read_b128 v[148:151], v4 offset:512
  ds_read_b128 v[180:183], v4 offset:1536
  ds_read_b128 v[152:155], v4 offset:528
  ds_read_b128 v[184:187], v4 offset:1552
  s_waitcnt lgkmcnt(8)
  ds_read_b128 v[156:159], v4 offset:768
  ds_read_b128 v[188:191], v4 offset:1792
  ds_read_b128 v[160:163], v4 offset:784
  ds_read_b128 v[192:195], v4 offset:1808
  s_waitcnt lgkmcnt(12)
  v_pk_fma_f32 v[24:25], v[24:25], v[164:165], v[132:133]
  v_pk_fma_f32 v[26:27], v[26:27], v[166:167], v[134:135]
  v_pk_fma_f32 v[28:29], v[28:29], v[168:169], v[136:137]
  v_pk_fma_f32 v[30:31], v[30:31], v[170:171], v[138:139]
  v_cvt_pk_bf16_f32 v8, v24, v25
  v_cvt_pk_bf16_f32 v9, v26, v27
  v_cvt_pk_bf16_f32 v10, v28, v29
  v_cvt_pk_bf16_f32 v11, v30, v31
  buffer_store_dwordx4 v[8:11], v5, s[4:7], s56 offen sc1
  s_waitcnt lgkmcnt(8)
  v_pk_fma_f32 v[32:33], v[32:33], v[172:173], v[140:141]
  v_pk_fma_f32 v[34:35], v[34:35], v[174:175], v[142:143]
  v_pk_fma_f32 v[36:37], v[36:37], v[176:177], v[144:145]
  v_pk_fma_f32 v[38:39], v[38:39], v[178:179], v[146:147]
  v_cvt_pk_bf16_f32 v12, v32, v33
  v_cvt_pk_bf16_f32 v13, v34, v35
  v_cvt_pk_bf16_f32 v14, v36, v37
  v_cvt_pk_bf16_f32 v15, v38, v39
  buffer_store_dwordx4 v[12:15], v5, s[4:7], s57 offen sc1
  s_waitcnt lgkmcnt(4)
  v_pk_fma_f32 v[40:41], v[40:41], v[180:181], v[148:149]
  v_pk_fma_f32 v[42:43], v[42:43], v[182:183], v[150:151]
  v_pk_fma_f32 v[44:45], v[44:45], v[184:185], v[152:153]
  v_pk_fma_f32 v[46:47], v[46:47], v[186:187], v[154:155]
  v_cvt_pk_bf16_f32 v16, v40, v41
  v_cvt_pk_bf16_f32 v17, v42, v43
  v_cvt_pk_bf16_f32 v18, v44, v45
  v_cvt_pk_bf16_f32 v19, v46, v47
  buffer_store_dwordx4 v[16:19], v5, s[4:7], s58 offen sc1
  s_waitcnt lgkmcnt(0)
  v_pk_fma_f32 v[48:49], v[48:49], v[188:189], v[156:157]
  v_pk_fma_f32 v[50:51], v[50:51], v[190:191], v[158:159]
  v_pk_fma_f32 v[52:53], v[52:53], v[192:193], v[160:161]
  v_pk_fma_f32 v[54:55], v[54:55], v[194:195], v[162:163]
  v_cvt_pk_bf16_f32 v20, v48, v49
  v_cvt_pk_bf16_f32 v21, v50, v51
  v_cvt_pk_bf16_f32 v22, v52, v53
  v_cvt_pk_bf16_f32 v23, v54, v55
  buffer_store_dwordx4 v[20:23], v5, s[4:7], s59 offen sc1
  v_mov_b32 v7, s19
  v_lshlrev_b32 v6, 2, v104
  s_waitcnt vmcnt(0)
  s_mov_b64 exec, 1
  buffer_store_dword v7, v6, s[64:67], s37 offen sc1
  s_mov_b64 exec, -1
  s_barrier
  s_add_u32 m0, s38, 13312
  s_nop 0
  buffer_load_dwordx4 v107, s[8:11], s17 offen lds
  buffer_load_dwordx4 v108, s[8:11], s17 offen offset:1024 lds
  buffer_load_dwordx4 v109, s[8:11], s17 offen offset:2048 lds
  s_add_u32 s17, s17, 196608
  s_cmp_eq_u32 s17, s10
  s_cselect_b32 s17, 0, s17
  s_add_u32 m0, s38, 26624
  s_nop 0
  buffer_load_dwordx4 v107, s[8:11], s17 offen lds
  buffer_load_dwordx4 v108, s[8:11], s17 offen offset:1024 lds
  buffer_load_dwordx4 v109, s[8:11], s17 offen offset:2048 lds
  s_add_u32 s17, s17, 196608
  s_cmp_eq_u32 s17, s10
  s_cselect_b32 s17, 0, s17
  s_add_u32 m0, s38, 39936
  s_nop 0
  buffer_load_dwordx4 v107, s[8:11], s17 offen lds
  buffer_load_dwordx4 v108, s[8:11], s17 offen offset:1024 lds
  buffer_load_dwordx4 v109, s[8:11], s17 offen offset:2048 lds
  s_add_u32 s17, s17, 196608
  s_cmp_eq_u32 s17, s10
  s_cselect_b32 s17, 0, s17
  s_add_u32 m0, s38, 53248
  s_nop 0
  buffer_load_dwordx4 v107, s[8:11], s17 offen lds
  buffer_load_dwordx4 v108, s[8:11], s17 offen offset:1024 lds
  buffer_load_dwordx4 v109, s[8:11], s17 offen offset:2048 lds
  s_add_u32 s17, s17, 196608
  s_cmp_eq_u32 s17, s10
  s_cselect_b32 s17, 0, s17
  s_add_u32 m0, s38, 66560
  s_nop 0
  buffer_load_dwordx4 v107, s[8:11], s17 offen lds
  buffer_load_dwordx4 v108, s[8:11], s17 offen offset:1024 lds
  buffer_load_dwordx4 v109, s[8:11], s17 offen offset:2048 lds
  s_add_u32 s17, s17, 196608
  s_cmp_eq_u32 s17, s10
  s_cselect_b32 s17, 0, s17
  s_add_u32 m0, s38, 79872
  s_nop 0
  buffer_load_dwordx4 v107, s[8:11], s17 offen lds
  buffer_load_dwordx4 v108, s[8:11], s17 offen offset:1024 lds
  buffer_load_dwordx4 v109, s[8:11], s17 offen offset:2048 lds
  s_add_u32 s17, s17, 196608
  s_cmp_eq_u32 s17, s10
  s_cselect_b32 s17, 0, s17
L_slow_6:
  s_mov_b32 s33, 262144
L_spin_8:
  buffer_load_dword v127, v128, s[64:67], 0 offen sc1
  s_waitcnt vmcnt(0)
  v_cmp_ne_u32 vcc, s19, v127
  s_nop 1
  s_cmp_eq_u64 vcc, 0
  s_cbranch_scc1 L_back_7
  s_sub_u32 s33, s33, 1
  s_cmp_lg_u32 s33, 0
  s_cbranch_scc1 L_spin_8
  s_branch L_back_7
L_back_7:
L_gemm_a:
  s_mov_b32 s6, 1048576
  s_add_u32 m0, s39, 0
  s_nop 0
  buffer_load_dword v106, s[4:7], s16 offen sc1 lds
  buffer_load_dwordx4 a[0:3], v105, s[4:7], s16 offen sc1
  buffer_load_dwordx4 a[4:7], v105, s[4:7], s16 offen offset:1024 sc1
  s_add_u32 s16, s16, 131072
  s_bitset0_b32 s16, 20
  s_add_u32 m0, s39, 13312
  s_nop 0
  buffer_load_dword v106, s[4:7], s16 offen sc1 lds
  buffer_load_dwordx4 a[8:11], v105, s[4:7], s16 offen sc1
  buffer_load_dwordx4 a[12:15], v105, s[4:7], s16 offen offset:1024 sc1
  s_add_u32 s16, s16, 131072
  s_bitset0_b32 s16, 20
  s_add_u32 m0, s39, 26624
  s_nop 0
  buffer_load_dword v106, s[4:7], s16 offen sc1 lds
  buffer_load_dwordx4 a[16:19], v105, s[4:7], s16 offen sc1
  buffer_load_dwordx4 a[20:23], v105, s[4:7], s16 offen offset:1024 sc1
  s_add_u32 s16, s16, 131072
  s_bitset0_b32 s16, 20
  s_bitcmp1_b32 s3, 0
  s_cselect_b32 s56, s62, s60
  s_cselect_b32 s57, s63, s61
  s_mov_b32 s58, 7340032
  s_mov_b32 s59, 0x20000
  s_lshl_b32 s97, s2, 1
  s_lshr_b32 s33, s3, 1
  s_add_u32 s97, s97, s33
  s_lshl_b32 s97, s97, 10
  v_lshrrev_b32 v110, 3, v104
  v_min_u32 v130, 1, v110
  v_lshlrev_b32 v130, 19, v130
  v_and_b32 v112, 7, v104
  v_lshl_add_u32 v130, v112, 7, v130
  s_bfe_u32 s36, s2, 0x20001
  s_lshl_b32 s36, s36, 2
  s_bfe_u32 s33, s2, 0x20003
  s_add_u32 s36, s36, s33
  s_lshr_b32 s37, s2, 5
  s_lshl_b32 s37, s37, 1
  s_and_b32 s33, s2, 1
  s_add_u32 s37, s37, s33
  s_and_b32 s33, s36, 3
  s_lshl_b32 s98, s33, 19
  v_and_b32 v111, 6, v110
  v_and_b32 v112, 7, v104
  v_xor_b32 v111, v111, v112
  v_lshlrev_b32 v110, 11, v110
  v_lshl_add_u32 v110, v111, 4, v110
  s_lshl_b32 s32, s3, 15
  s_lshl_b32 s33, s37, 7
  s_add_u32 s32, s32, s33
  v_add_u32 v248, s32, v110
  v_add_u32 v249, 15360, v248
  v_mov_b32 v244, -1
  v_mov_b32 v245, -1
  v_mov_b32 v246, -1
  v_mov_b32 v247, -1
  s_add_u32 s92, s20, 0xe00000
  s_addc_u32 s93, s21, 0
  s_mov_b32 s94, 0x800000
  s_mov_b32 s95, 0x20000
  s_lshl_b32 s35, s2, 2
  s_add_u32 s35, s35, s3
  s_lshl_b32 s35, s35, 12
  v_lshrrev_b32 v254, 4, v104
  s_movk_i32 s33, 24576
  v_mul_u32_u24 v254, s33, v254
  v_and_b32 v110, 15, v104
  v_lshl_add_u32 v254, v110, 4, v254
  v_and_b32 v110, 15, v104
  v_lshlrev_b32 v128, 11, v110
  v_bfe_u32 v112, v104, 4, 1
  v_lshl_add_u32 v128, v112, 5, v128
  v_lshrrev_b32 v112, 5, v104
  v_lshl_add_u32 v128, v112, 4, v128
  s_lshl_b32 s32, s36, 18
  s_lshl_b32 s33, s3, 16
  s_add_u32 s32, s32, s33
  s_lshl_b32 s33, s37, 7
  s_add_u32 s32, s32, s33
  v_add_u32 v128, s32, v128
  s_waitcnt vmcnt(6)
  s_barrier
  ds_read_b64_tr_b16 a[180:181], v118 offset:1024
  ds_read_b64_tr_b16 a[182:183], v118 offset:1536
  ds_read_b128 a[188:191], v119 offset:12288
  ds_read_b64_tr_b16 a[184:185], v118 offset:2048
  ds_read_b64_tr_b16 a[186:187], v118 offset:2560
  ds_read_b64_tr_b16 a[132:133], v114 offset:0
  ds_read_b64_tr_b16 a[134:135], v114 offset:512
  ds_read_b64_tr_b16 a[136:137], v115 offset:0
  ds_read_b64_tr_b16 a[138:139], v115 offset:512
  ds_read_b64_tr_b16 a[140:141], v116 offset:0
  ds_read_b64_tr_b16 a[142:143], v116 offset:512
  ds_read_b64_tr_b16 a[144:145], v117 offset:0
  ds_read_b64_tr_b16 a[146:147], v117 offset:512
  ds_read_b64_tr_b16 a[148:149], v114 offset:1024
  ds_read_b64_tr_b16 a[150:151], v114 offset:1536
  ds_read_b64_tr_b16 a[152:153], v115 offset:1024
  ds_read_b64_tr_b16 a[154:155], v115 offset:1536
  ds_read_b64_tr_b16 a[156:157], v116 offset:1024
  ds_read_b64_tr_b16 a[158:159], v116 offset:1536
  ds_read_b64_tr_b16 a[160:161], v117 offset:1024
  ds_read_b64_tr_b16 a[162:163], v117 offset:1536
  ds_read_b64_tr_b16 a[164:165], v114 offset:2048
  ds_read_b64_tr_b16 a[166:167], v114 offset:2560
  ds_read_b64_tr_b16 a[168:169], v115 offset:2048
  ds_read_b64_tr_b16 a[170:171], v115 offset:2560
  ds_read_b64_tr_b16 a[172:173], v116 offset:2048
  ds_read_b64_tr_b16 a[174:175], v116 offset:2560
  ds_read_b64_tr_b16 a[176:177], v117 offset:2048
  ds_read_b64_tr_b16 a[178:179], v117 offset:2560
  s_waitcnt vmcnt(3) lgkmcnt(10)
  s_barrier
  v_mfma_f32_16x16x32_bf16 v[96:99], a[180:183], a[188:191], 0
  ds_read_b64_tr_b16 a[180:181], v118 offset:14336
  s_add_u32 m0, s39, 39936
  v_mfma_f32_16x16x32_bf16 v[100:103], a[188:191], a[184:187], 0
  buffer_load_dword v106, s[4:7], s16 offen sc1 lds
  v_mfma_f32_16x16x32_bf16 v[0:3], a[132:135], a[0:3], 0
  buffer_load_dwordx4 a[24:27], v105, s[4:7], s16 offen sc1
  v_mfma_f32_16x16x32_bf16 v[48:51], a[132:135], a[4:7], 0
  ds_read_b64_tr_b16 a[182:183], v118 offset:14848
  buffer_load_dwordx4 a[28:31], v105, s[4:7], s16 offen offset:1024 sc1
  v_mfma_f32_16x16x32_bf16 v[4:7], a[136:139], a[0:3], 0
  ds_read_b128 a[188:191], v119 offset:25600
  ds_read_b64_tr_b16 a[184:185], v118 offset:15360
  ds_read_b64_tr_b16 a[186:187], v118 offset:15872
  s_add_u32 s16, s16, 131072
  v_mfma_f32_16x16x32_bf16 v[52:55], a[136:139], a[4:7], 0
  ds_read_b64_tr_b16 a[132:133], v114 offset:13312
  s_bitset0_b32 s16, 20
  v_mfma_f32_16x16x32_bf16 v[8:11], a[140:143], a[0:3], 0
  ds_read_b64_tr_b16 a[134:135], v114 offset:13824
  s_add_u32 m0, s39, 53248
  v_mfma_f32_16x16x32_bf16 v[56:59], a[140:143], a[4:7], 0
  buffer_load_dword v106, s[4:7], s16 offen sc1 lds
  v_mfma_f32_16x16x32_bf16 v[12:15], a[144:147], a[0:3], 0
  ds_read_b64_tr_b16 a[136:137], v115 offset:13312
  ds_read_b64_tr_b16 a[138:139], v115 offset:13824
  buffer_load_dwordx4 a[32:35], v105, s[4:7], s16 offen sc1
  v_mfma_f32_16x16x32_bf16 v[60:63], a[144:147], a[4:7], 0
  buffer_load_dwordx4 a[36:39], v105, s[4:7], s16 offen offset:1024 sc1
  v_mfma_f32_16x16x32_bf16 v[16:19], a[148:151], a[0:3], 0
  ds_read_b64_tr_b16 a[140:141], v116 offset:13312
  ds_read_b64_tr_b16 a[142:143], v116 offset:13824
  s_add_u32 s16, s16, 131072
  v_mfma_f32_16x16x32_bf16 v[64:67], a[148:151], a[4:7], 0
  ds_read_b64_tr_b16 a[144:145], v117 offset:13312
  s_bitset0_b32 s16, 20
  v_mfma_f32_16x16x32_bf16 v[20:23], a[152:155], a[0:3], 0
  ds_read_b64_tr_b16 a[146:147], v117 offset:13824
  s_add_u32 m0, s39, 66560
  v_mfma_f32_16x16x32_bf16 v[68:71], a[152:155], a[4:7], 0
  buffer_load_dword v106, s[4:7], s16 offen sc1 lds
  v_mfma_f32_16x16x32_bf16 v[24:27], a[156:159], a[0:3], 0
  ds_read_b64_tr_b16 a[148:149], v114 offset:14336
  ds_read_b64_tr_b16 a[150:151], v114 offset:14848
  buffer_load_dwordx4 a[40:43], v105, s[4:7], s16 offen sc1
  v_mfma_f32_16x16x32_bf16 v[72:75], a[156:159], a[4:7], 0
  buffer_load_dwordx4 a[44:47], v105, s[4:7], s16 offen offset:1024 sc1
  s_waitcnt lgkmcnt(10)
  v_mfma_f32_16x16x32_bf16 v[28:31], a[160:163], a[0:3], 0
  ds_read_b64_tr_b16 a[152:153], v115 offset:14336
  ds_read_b64_tr_b16 a[154:155], v115 offset:14848
  s_add_u32 s16, s16, 131072
  v_mfma_f32_16x16x32_bf16 v[76:79], a[160:163], a[4:7], 0
  ds_read_b64_tr_b16 a[156:157], v116 offset:14336
  s_bitset0_b32 s16, 20
  v_mfma_f32_16x16x32_bf16 v[32:35], a[0:3], a[164:167], 0
  ds_read_b64_tr_b16 a[158:159], v116 offset:14848
  s_add_u32 m0, s39, 79872
  v_mfma_f32_16x16x32_bf16 v[80:83], a[4:7], a[164:167], 0
  buffer_load_dword v106, s[4:7], s16 offen sc1 lds
  v_mfma_f32_16x16x32_bf16 v[36:39], a[0:3], a[168:171], 0
  ds_read_b64_tr_b16 a[160:161], v117 offset:14336
  ds_read_b64_tr_b16 a[162:163], v117 offset:14848
  buffer_load_dwordx4 a[48:51], v105, s[4:7], s16 offen sc1
  v_mfma_f32_16x16x32_bf16 v[84:87], a[4:7], a[168:171], 0
  buffer_load_dwordx4 a[52:55], v105, s[4:7], s16 offen offset:1024 sc1
  v_mfma_f32_16x16x32_bf16 v[40:43], a[0:3], a[172:175], 0
  ds_read_b64_tr_b16 a[164:165], v114 offset:15360
  ds_read_b64_tr_b16 a[166:167], v114 offset:15872
  s_add_u32 s16, s16, 131072
  v_mfma_f32_16x16x32_bf16 v[88:91], a[4:7], a[172:175], 0
  ds_read_b64_tr_b16 a[168:169], v115 offset:15360
  s_bitset0_b32 s16, 20
  v_mfma_f32_16x16x32_bf16 v[44:47], a[0:3], a[176:179], 0
  ds_read_b64_tr_b16 a[170:171], v115 offset:15872
  ds_read_b64_tr_b16 a[172:173], v116 offset:15360
  v_mfma_f32_16x16x32_bf16 v[92:95], a[4:7], a[176:179], 0
  s_waitcnt vmcnt(12) lgkmcnt(10)
  s_barrier
  v_mfma_f32_16x16x32_bf16 v[96:99], a[180:183], a[188:191], v[96:99]
  ds_read_b64_tr_b16 a[174:175], v116 offset:15872
  s_add_u32 m0, s38, 93184
  v_mfma_f32_16x16x32_bf16 v[100:103], a[188:191], a[184:187], v[100:103]
  buffer_load_dwordx4 v107, s[8:11], s17 offen lds
  v_mfma_f32_16x16x32_bf16 v[0:3], a[132:135], a[8:11], v[0:3]
  ds_read_b64_tr_b16 a[176:177], v117 offset:15360
  ds_read_b64_tr_b16 a[178:179], v117 offset:15872
  v_mfma_f32_16x16x32_bf16 v[48:51], a[132:135], a[12:15], v[48:51]
  ds_read_b64_tr_b16 a[180:181], v118 offset:27648
  ds_read_b64_tr_b16 a[182:183], v118 offset:28160
  buffer_load_dword v127, v126, s[64:67], 0 offen sc1
  v_mfma_f32_16x16x32_bf16 v[4:7], a[136:139], a[8:11], v[4:7]
  ds_read_b128 a[188:191], v119 offset:38912
  ds_read_b64_tr_b16 a[184:185], v118 offset:28672
  ds_read_b64_tr_b16 a[186:187], v118 offset:29184
  buffer_load_dwordx4 v108, s[8:11], s17 offen offset:1024 lds
  v_mfma_f32_16x16x32_bf16 v[52:55], a[136:139], a[12:15], v[52:55]
  buffer_load_dwordx4 v109, s[8:11], s17 offen offset:2048 lds
  v_mfma_f32_16x16x32_bf16 v[8:11], a[140:143], a[8:11], v[8:11]
  ds_read_b64_tr_b16 a[132:133], v114 offset:26624
  ds_read_b64_tr_b16 a[134:135], v114 offset:27136
  v_mfma_f32_16x16x32_bf16 v[56:59], a[140:143], a[12:15], v[56:59]
  ds_read_b64_tr_b16 a[136:137], v115 offset:26624
  s_add_u32 s17, s17, 196608
  v_mfma_f32_16x16x32_bf16 v[12:15], a[144:147], a[8:11], v[12:15]
  ds_read_b64_tr_b16 a[138:139], v115 offset:27136
  s_cmp_eq_u32 s17, s10
  s_cselect_b32 s17, 0, s17
  v_mfma_f32_16x16x32_bf16 v[60:63], a[144:147], a[12:15], v[60:63]
  ds_read_b64_tr_b16 a[140:141], v116 offset:26624
  ds_read_b64_tr_b16 a[142:143], v116 offset:27136
  v_mfma_f32_16x16x32_bf16 v[16:19], a[148:151], a[8:11], v[16:19]
  s_add_u32 s8, s8, s10
  s_addc_u32 s9, s9, 0
  v_mfma_f32_16x16x32_bf16 v[64:67], a[148:151], a[12:15], v[64:67]
  ds_read_b64_tr_b16 a[144:145], v117 offset:26624
  ds_read_b64_tr_b16 a[146:147], v117 offset:27136
  s_waitcnt lgkmcnt(10)
  v_mfma_f32_16x16x32_bf16 v[20:23], a[152:155], a[8:11], v[20:23]
  ds_read_b64_tr_b16 a[148:149], v114 offset:27648
  s_add_u32 m0, s39, 93184
  v_mfma_f32_16x16x32_bf16 v[68:71], a[152:155], a[12:15], v[68:71]
  s_add_u32 s40, s20, 0x40000
  s_addc_u32 s41, s21, 0
  s_mov_b32 s42, 0x0
  s_mov_b32 s43, 0x20000
  s_or_b32 s33, s2, s3
  s_cmp_eq_u32 s33, 0
  s_cselect_b32 s42, 4, 0
  v_mov_b32 v192, s19
  buffer_store_dword v192, v119, s[40:43], 0 offen sc1
  v_mfma_f32_16x16x32_bf16 v[24:27], a[156:159], a[8:11], v[24:27]
  ds_read_b64_tr_b16 a[150:151], v114 offset:28160
  buffer_load_dword v106, s[4:7], s16 offen sc1 lds
  v_mfma_f32_16x16x32_bf16 v[72:75], a[156:159], a[12:15], v[72:75]
  ds_read_b64_tr_b16 a[152:153], v115 offset:27648
  ds_read_b64_tr_b16 a[154:155], v115 offset:28160
  v_mfma_f32_16x16x32_bf16 v[28:31], a[160:163], a[8:11], v[28:31]
  buffer_load_dwordx4 a[56:59], v105, s[4:7], s16 offen sc1
  v_mfma_f32_16x16x32_bf16 v[76:79], a[160:163], a[12:15], v[76:79]
  buffer_load_dwordx4 a[60:63], v105, s[4:7], s16 offen offset:1024 sc1
  v_mfma_f32_16x16x32_bf16 v[32:35], a[8:11], a[164:167], v[32:35]
  ds_read_b64_tr_b16 a[156:157], v116 offset:27648
  ds_read_b64_tr_b16 a[158:159], v116 offset:28160
  v_mfma_f32_16x16x32_bf16 v[80:83], a[12:15], a[164:167], v[80:83]
  ds_read_b64_tr_b16 a[160:161], v117 offset:27648
  s_add_u32 s16, s16, 131072
  v_mfma_f32_16x16x32_bf16 v[36:39], a[8:11], a[168:171], v[36:39]
  ds_read_b64_tr_b16 a[162:163], v117 offset:28160
  ds_read_b64_tr_b16 a[164:165], v114 offset:28672
  v_mfma_f32_16x16x32_bf16 v[84:87], a[12:15], a[168:171], v[84:87]
  ds_read_b64_tr_b16 a[166:167], v114 offset:29184
  s_bitset0_b32 s16, 20
  v_mfma_f32_16x16x32_bf16 v[40:43], a[8:11], a[172:175], v[40:43]
  ds_read_b64_tr_b16 a[168:169], v115 offset:28672
  ds_read_b64_tr_b16 a[170:171], v115 offset:29184
  v_mfma_f32_16x16x32_bf16 v[88:91], a[12:15], a[172:175], v[88:91]
  s_add_u32 s4, s4, s6
  s_addc_u32 s5, s5, 0
  v_mfma_f32_16x16x32_bf16 v[44:47], a[8:11], a[176:179], v[44:47]
  ds_read_b64_tr_b16 a[172:173], v116 offset:28672
  ds_read_b64_tr_b16 a[174:175], v116 offset:29184
  v_mfma_f32_16x16x32_bf16 v[92:95], a[12:15], a[176:179], v[92:95]
  s_waitcnt vmcnt(6) lgkmcnt(10)
  s_barrier
  v_cmp_ne_u32 vcc, s19, v127
  s_nop 1
  s_cmp_lg_u64 vcc, 0
  s_cbranch_scc1 L_slow_9
  L_back_10:
  v_mfma_f32_16x16x32_bf16 v[96:99], a[180:183], a[188:191], v[96:99]
  s_add_u32 m0, s39, 0
  s_nop 0
  buffer_load_dword v106, s[4:7], s16 offen sc1 lds
  v_mfma_f32_16x16x32_bf16 v[100:103], a[188:191], a[184:187], v[100:103]
  buffer_load_dwordx4 a[0:3], v105, s[4:7], s16 offen sc1
  v_mfma_f32_16x16x32_bf16 v[0:3], a[132:135], a[16:19], v[0:3]
  ds_read_b64_tr_b16 a[176:177], v117 offset:28672
  ds_read_b64_tr_b16 a[178:179], v117 offset:29184
  buffer_load_dwordx4 a[4:7], v105, s[4:7], s16 offen offset:1024 sc1
  v_mfma_f32_16x16x32_bf16 v[48:51], a[132:135], a[20:23], v[48:51]
  ds_read_b64_tr_b16 a[180:181], v118 offset:40960
  ds_read_b64_tr_b16 a[182:183], v118 offset:41472
  s_add_u32 s16, s16, 131072
  v_mfma_f32_16x16x32_bf16 v[4:7], a[136:139], a[16:19], v[4:7]
  ds_read_b128 a[188:191], v119 offset:52224
  ds_read_b64_tr_b16 a[184:185], v118 offset:41984
  ds_read_b64_tr_b16 a[186:187], v118 offset:42496
  s_bitset0_b32 s16, 20
  v_mfma_f32_16x16x32_bf16 v[52:55], a[136:139], a[20:23], v[52:55]
  ds_read_b64_tr_b16 a[132:133], v114 offset:39936
  s_add_u32 m0, s38, 0
  v_mfma_f32_16x16x32_bf16 v[8:11], a[140:143], a[16:19], v[8:11]
  ds_read_b64_tr_b16 a[134:135], v114 offset:40448
  buffer_load_dwordx4 v107, s[8:11], s17 offen lds
  buffer_load_dwordx4 v108, s[8:11], s17 offen offset:1024 lds
  v_mfma_f32_16x16x32_bf16 v[56:59], a[140:143], a[20:23], v[56:59]
  buffer_load_dwordx4 v109, s[8:11], s17 offen offset:2048 lds
  v_mfma_f32_16x16x32_bf16 v[12:15], a[144:147], a[16:19], v[12:15]
  ds_read_b64_tr_b16 a[136:137], v115 offset:39936
  ds_read_b64_tr_b16 a[138:139], v115 offset:40448
  s_add_u32 s17, s17, 196608
  v_mfma_f32_16x16x32_bf16 v[60:63], a[144:147], a[20:23], v[60:63]
  ds_read_b64_tr_b16 a[140:141], v116 offset:39936
  s_cmp_eq_u32 s17, s10
  v_mfma_f32_16x16x32_bf16 v[16:19], a[148:151], a[16:19], v[16:19]
  ds_read_b64_tr_b16 a[142:143], v116 offset:40448
  s_cselect_b32 s17, 0, s17
  v_mfma_f32_16x16x32_bf16 v[64:67], a[148:151], a[20:23], v[64:67]
  ds_read_b64_tr_b16 a[144:145], v117 offset:39936
  s_mov_b32 m0, s51
  v_mfma_f32_16x16x32_bf16 v[20:23], a[152:155], a[16:19], v[20:23]
  ds_read_b64_tr_b16 a[146:147], v117 offset:40448
  s_add_u32 s51, s51, 1024
  buffer_load_dwordx4 v129, s[52:55], s50 offen nt lds
  v_mfma_f32_16x16x32_bf16 v[68:71], a[152:155], a[20:23], v[68:71]
  ds_read_b64_tr_b16 a[148:149], v114 offset:40960
  s_add_u32 s50, s50, 98304
  s_waitcnt lgkmcnt(10)
  v_mfma_f32_16x16x32_bf16 v[24:27], a[156:159], a[16:19], v[24:27]
  ds_read_b64_tr_b16 a[150:151], v114 offset:41472
  s_mov_b32 m0, s51
  v_mfma_f32_16x16x32_bf16 v[72:75], a[156:159], a[20:23], v[72:75]
  ds_read_b64_tr_b16 a[152:153], v115 offset:40960
  s_add_u32 s51, s51, 1024
  v_mfma_f32_16x16x32_bf16 v[28:31], a[160:163], a[16:19], v[28:31]
  ds_read_b64_tr_b16 a[154:155], v115 offset:41472
  buffer_load_dwordx4 v129, s[52:55], s50 offen nt lds
  v_mfma_f32_16x16x32_bf16 v[76:79], a[160:163], a[20:23], v[76:79]
  ds_read_b64_tr_b16 a[156:157], v116 offset:40960
  s_add_u32 s50, s50, 98304
  v_mfma_f32_16x16x32_bf16 v[32:35], a[16:19], a[164:167], v[32:35]
  ds_read_b64_tr_b16 a[158:159], v116 offset:41472
  s_mov_b32 m0, s51
  s_add_u32 s51, s51, 1024
  v_mfma_f32_16x16x32_bf16 v[80:83], a[20:23], a[164:167], v[80:83]
  buffer_load_dwordx4 v129, s[52:55], s50 offen nt lds
  v_mfma_f32_16x16x32_bf16 v[36:39], a[16:19], a[168:171], v[36:39]
  ds_read_b64_tr_b16 a[160:161], v117 offset:40960
  ds_read_b64_tr_b16 a[162:163], v117 offset:41472
  s_add_u32 s50, s50, 98304
  v_mfma_f32_16x16x32_bf16 v[84:87], a[20:23], a[168:171], v[84:87]
  ds_read_b64_tr_b16 a[164:165], v114 offset:41984
  s_mov_b32 m0, s51
  v_mfma_f32_16x16x32_bf16 v[40:43], a[16:19], a[172:175], v[40:43]
  ds_read_b64_tr_b16 a[166:167], v114 offset:42496
  s_add_u32 s51, s51, 1024
  v_mfma_f32_16x16x32_bf16 v[88:91], a[20:23], a[172:175], v[88:91]
  buffer_load_dwordx4 v129, s[52:55], s50 offen nt lds
  v_mfma_f32_16x16x32_bf16 v[44:47], a[16:19], a[176:179], v[44:47]
  ds_read_b64_tr_b16 a[168:169], v115 offset:41984
  ds_read_b64_tr_b16 a[170:171], v115 offset:42496
  s_add_u32 s50, s50, 98304
  v_mfma_f32_16x16x32_bf16 v[92:95], a[20:23], a[176:179], v[92:95]
  s_waitcnt vmcnt(24) lgkmcnt(10)
  s_barrier
  v_mfma_f32_16x16x32_bf16 v[96:99], a[180:183], a[188:191], v[96:99]
  ds_read_b64_tr_b16 a[172:173], v116 offset:41984
  ds_read_b64_tr_b16 a[174:175], v116 offset:42496
  v_mfma_f32_16x16x32_bf16 v[100:103], a[188:191], a[184:187], v[100:103]
  ds_read_b64_tr_b16 a[176:177], v117 offset:41984
  ds_read_b64_tr_b16 a[178:179], v117 offset:42496
  v_mfma_f32_16x16x32_bf16 v[0:3], a[132:135], a[24:27], v[0:3]
  ds_read_b64_tr_b16 a[180:181], v124 offset:1024
  ds_read_b64_tr_b16 a[182:183], v124 offset:1536
  v_mfma_f32_16x16x32_bf16 v[48:51], a[132:135], a[28:31], v[48:51]
  ds_read_b128 a[188:191], v125 offset:12288
  ds_read_b64_tr_b16 a[184:185], v124 offset:2048
  v_mfma_f32_16x16x32_bf16 v[4:7], a[136:139], a[24:27], v[4:7]
  ds_read_b64_tr_b16 a[186:187], v124 offset:2560
  ds_read_b64_tr_b16 a[132:133], v120 offset:0
  v_mfma_f32_16x16x32_bf16 v[52:55], a[136:139], a[28:31], v[52:55]
  ds_read_b64_tr_b16 a[134:135], v120 offset:512
  ds_read_b64_tr_b16 a[136:137], v121 offset:0
  v_mfma_f32_16x16x32_bf16 v[8:11], a[140:143], a[24:27], v[8:11]
  ds_read_b64_tr_b16 a[138:139], v121 offset:512
  v_mfma_f32_16x16x32_bf16 v[56:59], a[140:143], a[28:31], v[56:59]
  ds_read_b64_tr_b16 a[140:141], v122 offset:0
  ds_read_b64_tr_b16 a[142:143], v122 offset:512
  v_mfma_f32_16x16x32_bf16 v[12:15], a[144:147], a[24:27], v[12:15]
  v_mfma_f32_16x16x32_bf16 v[60:63], a[144:147], a[28:31], v[60:63]
  ds_read_b64_tr_b16 a[144:145], v123 offset:0
  ds_read_b64_tr_b16 a[146:147], v123 offset:512
  v_mfma_f32_16x16x32_bf16 v[16:19], a[148:151], a[24:27], v[16:19]
  v_mfma_f32_16x16x32_bf16 v[64:67], a[148:151], a[28:31], v[64:67]
  ds_read_b64_tr_b16 a[148:149], v120 offset:1024
  ds_read_b64_tr_b16 a[150:151], v120 offset:1536
  s_waitcnt lgkmcnt(10)
  v_mfma_f32_16x16x32_bf16 v[20:23], a[152:155], a[24:27], v[20:23]
  v_mfma_f32_16x16x32_bf16 v[68:71], a[152:155], a[28:31], v[68:71]
  ds_read_b64_tr_b16 a[152:153], v121 offset:1024
  ds_read_b64_tr_b16 a[154:155], v121 offset:1536
  v_mfma_f32_16x16x32_bf16 v[24:27], a[156:159], a[24:27], v[24:27]
  v_mfma_f32_16x16x32_bf16 v[72:75], a[156:159], a[28:31], v[72:75]
  ds_read_b64_tr_b16 a[156:157], v122 offset:1024
  ds_read_b64_tr_b16 a[158:159], v122 offset:1536
  v_mfma_f32_16x16x32_bf16 v[28:31], a[160:163], a[24:27], v[28:31]
  v_mfma_f32_16x16x32_bf16 v[76:79], a[160:163], a[28:31], v[76:79]
  ds_read_b64_tr_b16 a[160:161], v123 offset:1024
  ds_read_b64_tr_b16 a[162:163], v123 offset:1536
  v_mfma_f32_16x16x32_bf16 v[32:35], a[24:27], a[164:167], v[32:35]
  v_mfma_f32_16x16x32_bf16 v[80:83], a[28:31], a[164:167], v[80:83]
  ds_read_b64_tr_b16 a[164:165], v120 offset:2048
  ds_read_b64_tr_b16 a[166:167], v120 offset:2560
  v_mfma_f32_16x16x32_bf16 v[36:39], a[24:27], a[168:171], v[36:39]
  v_mfma_f32_16x16x32_bf16 v[84:87], a[28:31], a[168:171], v[84:87]
  ds_read_b64_tr_b16 a[168:169], v121 offset:2048
  ds_read_b64_tr_b16 a[170:171], v121 offset:2560
  v_mfma_f32_16x16x32_bf16 v[40:43], a[24:27], a[172:175], v[40:43]
  v_mfma_f32_16x16x32_bf16 v[88:91], a[28:31], a[172:175], v[88:91]
  ds_read_b64_tr_b16 a[172:173], v122 offset:2048
  ds_read_b64_tr_b16 a[174:175], v122 offset:2560
  v_mfma_f32_16x16x32_bf16 v[44:47], a[24:27], a[176:179], v[44:47]
  v_mfma_f32_16x16x32_bf16 v[92:95], a[28:31], a[176:179], v[92:95]
  s_waitcnt vmcnt(21) lgkmcnt(10)
  s_barrier
  v_mfma_f32_16x16x32_bf16 v[96:99], a[180:183], a[188:191], v[96:99]
  buffer_store_dwordx4 v[244:247], v119, s[92:95], s35 offen offset:0 sc1
  v_mfma_f32_16x16x32_bf16 v[100:103], a[188:191], a[184:187], v[100:103]
  ds_read_b64_tr_b16 a[176:177], v123 offset:2048
  ds_read_b64_tr_b16 a[178:179], v123 offset:2560
  v_mfma_f32_16x16x32_bf16 v[0:3], a[132:135], a[32:35], v[0:3]
  ds_read_b64_tr_b16 a[180:181], v124 offset:14336
  ds_read_b64_tr_b16 a[182:183], v124 offset:14848
  v_mfma_f32_16x16x32_bf16 v[48:51], a[132:135], a[36:39], v[48:51]
  ds_read_b128 a[188:191], v125 offset:25600
  ds_read_b64_tr_b16 a[184:185], v124 offset:15360
  v_mfma_f32_16x16x32_bf16 v[4:7], a[136:139], a[32:35], v[4:7]
  ds_read_b64_tr_b16 a[186:187], v124 offset:15872
  ds_read_b64_tr_b16 a[132:133], v120 offset:13312
  v_mfma_f32_16x16x32_bf16 v[52:55], a[136:139], a[36:39], v[52:55]
  ds_read_b64_tr_b16 a[134:135], v120 offset:13824
  ds_read_b64_tr_b16 a[136:137], v121 offset:13312
  v_mfma_f32_16x16x32_bf16 v[8:11], a[140:143], a[32:35], v[8:11]
  ds_read_b64_tr_b16 a[138:139], v121 offset:13824
  v_mfma_f32_16x16x32_bf16 v[56:59], a[140:143], a[36:39], v[56:59]
  ds_read_b64_tr_b16 a[140:141], v122 offset:13312
  ds_read_b64_tr_b16 a[142:143], v122 offset:13824
  v_mfma_f32_16x16x32_bf16 v[12:15], a[144:147], a[32:35], v[12:15]
  v_mfma_f32_16x16x32_bf16 v[60:63], a[144:147], a[36:39], v[60:63]
  ds_read_b64_tr_b16 a[144:145], v123 offset:13312
  ds_read_b64_tr_b16 a[146:147], v123 offset:13824
  v_mfma_f32_16x16x32_bf16 v[16:19], a[148:151], a[32:35], v[16:19]
  v_mfma_f32_16x16x32_bf16 v[64:67], a[148:151], a[36:39], v[64:67]
  ds_read_b64_tr_b16 a[148:149], v120 offset:14336
  ds_read_b64_tr_b16 a[150:151], v120 offset:14848
  v_mfma_f32_16x16x32_bf16 v[20:23], a[152:155], a[32:35], v[20:23]
  v_mfma_f32_16x16x32_bf16 v[68:71], a[152:155], a[36:39], v[68:71]
  ds_read_b64_tr_b16 a[152:153], v121 offset:14336
  ds_read_b64_tr_b16 a[154:155], v121 offset:14848
  s_waitcnt lgkmcnt(10)
  v_mfma_f32_16x16x32_bf16 v[24:27], a[156:159], a[32:35], v[24:27]
  v_mfma_f32_16x16x32_bf16 v[72:75], a[156:159], a[36:39], v[72:75]
  ds_read_b64_tr_b16 a[156:157], v122 offset:14336
  ds_read_b64_tr_b16 a[158:159], v122 offset:14848
  v_mfma_f32_16x16x32_bf16 v[28:31], a[160:163], a[32:35], v[28:31]
  v_mfma_f32_16x16x32_bf16 v[76:79], a[160:163], a[36:39], v[76:79]
  ds_read_b64_tr_b16 a[160:161], v123 offset:14336
  ds_read_b64_tr_b16 a[162:163], v123 offset:14848
  v_mfma_f32_16x16x32_bf16 v[32:35], a[32:35], a[164:167], v[32:35]
  v_mfma_f32_16x16x32_bf16 v[80:83], a[36:39], a[164:167], v[80:83]
  ds_read_b64_tr_b16 a[164:165], v120 offset:15360
  ds_read_b64_tr_b16 a[166:167], v120 offset:15872
  v_mfma_f32_16x16x32_bf16 v[36:39], a[32:35], a[168:171], v[36:39]
  v_mfma_f32_16x16x32_bf16 v[84:87], a[36:39], a[168:171], v[84:87]
  ds_read_b64_tr_b16 a[168:169], v121 offset:15360
  ds_read_b64_tr_b16 a[170:171], v121 offset:15872
  v_mfma_f32_16x16x32_bf16 v[40:43], a[32:35], a[172:175], v[40:43]
  v_mfma_f32_16x16x32_bf16 v[88:91], a[36:39], a[172:175], v[88:91]
  ds_read_b64_tr_b16 a[172:173], v122 offset:15360
  ds_read_b64_tr_b16 a[174:175], v122 offset:15872
  v_mfma_f32_16x16x32_bf16 v[44:47], a[32:35], a[176:179], v[44:47]
  v_mfma_f32_16x16x32_bf16 v[92:95], a[36:39], a[176:179], v[92:95]
  s_waitcnt vmcnt(19) lgkmcnt(10)
  s_barrier
  v_mfma_f32_16x16x32_bf16 v[96:99], a[180:183], a[188:191], v[96:99]
  ds_read_b64_tr_b16 a[176:177], v123 offset:15360
  s_add_u32 m0, s38, 13312
  v_mfma_f32_16x16x32_bf16 v[100:103], a[188:191], a[184:187], v[100:103]
  buffer_load_dwordx4 v107, s[8:11], s17 offen lds
  v_mfma_f32_16x16x32_bf16 v[0:3], a[132:135], a[40:43], v[0:3]
  ds_read_b64_tr_b16 a[178:179], v123 offset:15872
  buffer_load_dwordx4 v108, s[8:11], s17 offen offset:1024 lds
  v_mfma_f32_16x16x32_bf16 v[48:51], a[132:135], a[44:47], v[48:51]
  ds_read_b64_tr_b16 a[180:181], v124 offset:27648
  ds_read_b64_tr_b16 a[182:183], v124 offset:28160
  buffer_load_dwordx4 v109, s[8:11], s17 offen offset:2048 lds
  v_mfma_f32_16x16x32_bf16 v[4:7], a[136:139], a[40:43], v[4:7]
  ds_read_b128 a[188:191], v125 offset:38912
  ds_read_b64_tr_b16 a[184:185], v124 offset:28672
  ds_read_b64_tr_b16 a[186:187], v124 offset:29184
  v_mfma_f32_16x16x32_bf16 v[52:55], a[136:139], a[44:47], v[52:55]
  ds_read_b64_tr_b16 a[132:133], v120 offset:26624
  s_add_u32 s17, s17, 196608
  v_mfma_f32_16x16x32_bf16 v[8:11], a[140:143], a[40:43], v[8:11]
  ds_read_b64_tr_b16 a[134:135], v120 offset:27136
  s_cmp_eq_u32 s17, s10
  v_mfma_f32_16x16x32_bf16 v[56:59], a[140:143], a[44:47], v[56:59]
  ds_read_b64_tr_b16 a[136:137], v121 offset:26624
  s_cselect_b32 s17, 0, s17
  v_mfma_f32_16x16x32_bf16 v[12:15], a[144:147], a[40:43], v[12:15]
  ds_read_b64_tr_b16 a[138:139], v121 offset:27136
  s_add_u32 m0, s39, 13312
  v_mfma_f32_16x16x32_bf16 v[60:63], a[144:147], a[44:47], v[60:63]
  ds_read_b64_tr_b16 a[140:141], v122 offset:26624
  ds_read_b64_tr_b16 a[142:143], v122 offset:27136
  v_mfma_f32_16x16x32_bf16 v[16:19], a[148:151], a[40:43], v[16:19]
  buffer_load_dword v106, s[4:7], s16 offen sc1 lds
  v_mfma_f32_16x16x32_bf16 v[64:67], a[148:151], a[44:47], v[64:67]
  buffer_load_dwordx4 a[8:11], v105, s[4:7], s16 offen sc1
  v_mfma_f32_16x16x32_bf16 v[20:23], a[152:155], a[40:43], v[20:23]
  ds_read_b64_tr_b16 a[144:145], v123 offset:26624
  ds_read_b64_tr_b16 a[146:147], v123 offset:27136
  buffer_load_dwordx4 a[12:15], v105, s[4:7], s16 offen offset:1024 sc1
  v_mfma_f32_16x16x32_bf16 v[68:71], a[152:155], a[44:47], v[68:71]
  ds_read_b64_tr_b16 a[148:149], v120 offset:27648
  s_add_u32 s16, s16, 131072
  s_waitcnt lgkmcnt(10)
  v_mfma_f32_16x16x32_bf16 v[24:27], a[156:159], a[40:43], v[24:27]
  ds_read_b64_tr_b16 a[150:151], v120 offset:28160
  ds_read_b64_tr_b16 a[152:153], v121 offset:27648
  v_mfma_f32_16x16x32_bf16 v[72:75], a[156:159], a[44:47], v[72:75]
  ds_read_b64_tr_b16 a[154:155], v121 offset:28160
  s_bitset0_b32 s16, 20
  v_mfma_f32_16x16x32_bf16 v[28:31], a[160:163], a[40:43], v[28:31]
  ds_read_b64_tr_b16 a[156:157], v122 offset:27648
  s_add_u32 m0, s38, 26624
  v_mfma_f32_16x16x32_bf16 v[76:79], a[160:163], a[44:47], v[76:79]
  buffer_load_dwordx4 v107, s[8:11], s17 offen lds
  v_mfma_f32_16x16x32_bf16 v[32:35], a[40:43], a[164:167], v[32:35]
  ds_read_b64_tr_b16 a[158:159], v122 offset:28160
  buffer_load_dwordx4 v108, s[8:11], s17 offen offset:1024 lds
  v_mfma_f32_16x16x32_bf16 v[80:83], a[44:47], a[164:167], v[80:83]
  ds_read_b64_tr_b16 a[160:161], v123 offset:27648
  ds_read_b64_tr_b16 a[162:163], v123 offset:28160
  v_mfma_f32_16x16x32_bf16 v[36:39], a[40:43], a[168:171], v[36:39]
  buffer_load_dwordx4 v109, s[8:11], s17 offen offset:2048 lds
  v_mfma_f32_16x16x32_bf16 v[84:87], a[44:47], a[168:171], v[84:87]
  ds_read_b64_tr_b16 a[164:165], v120 offset:28672
  s_add_u32 s17, s17, 196608
  v_mfma_f32_16x16x32_bf16 v[40:43], a[40:43], a[172:175], v[40:43]
  ds_read_b64_tr_b16 a[166:167], v120 offset:29184
  s_cmp_eq_u32 s17, s10
  v_mfma_f32_16x16x32_bf16 v[88:91], a[44:47], a[172:175], v[88:91]
  ds_read_b64_tr_b16 a[168:169], v121 offset:28672
  s_cselect_b32 s17, 0, s17
  v_mfma_f32_16x16x32_bf16 v[44:47], a[40:43], a[176:179], v[44:47]
  ds_read_b64_tr_b16 a[170:171], v121 offset:29184
  ds_read_b64_tr_b16 a[172:173], v122 offset:28672
  v_mfma_f32_16x16x32_bf16 v[92:95], a[44:47], a[176:179], v[92:95]
  s_waitcnt vmcnt(20) lgkmcnt(10)
  s_barrier
  v_mfma_f32_16x16x32_bf16 v[96:99], a[180:183], a[188:191], v[96:99]
  ds_read_b64_tr_b16 a[174:175], v122 offset:29184
  s_add_u32 m0, s39, 26624
  v_mfma_f32_16x16x32_bf16 v[100:103], a[188:191], a[184:187], v[100:103]
  buffer_load_dword v106, s[4:7], s16 offen sc1 lds
  v_mfma_f32_16x16x32_bf16 v[0:3], a[132:135], a[48:51], v[0:3]
  ds_read_b64_tr_b16 a[176:177], v123 offset:28672
  ds_read_b64_tr_b16 a[178:179], v123 offset:29184
  buffer_load_dwordx4 a[16:19], v105, s[4:7], s16 offen sc1
  v_mfma_f32_16x16x32_bf16 v[48:51], a[132:135], a[52:55], v[48:51]
  ds_read_b64_tr_b16 a[180:181], v124 offset:40960
  ds_read_b64_tr_b16 a[182:183], v124 offset:41472
  buffer_load_dwordx4 a[20:23], v105, s[4:7], s16 offen offset:1024 sc1
  v_mfma_f32_16x16x32_bf16 v[4:7], a[136:139], a[48:51], v[4:7]
  ds_read_b128 a[188:191], v125 offset:52224
  ds_read_b64_tr_b16 a[184:185], v124 offset:41984
  ds_read_b64_tr_b16 a[186:187], v124 offset:42496
  v_mfma_f32_16x16x32_bf16 v[52:55], a[136:139], a[52:55], v[52:55]
  ds_read_b64_tr_b16 a[132:133], v120 offset:39936
  s_add_u32 s16, s16, 131072
  v_mfma_f32_16x16x32_bf16 v[8:11], a[140:143], a[48:51], v[8:11]
  ds_read_b64_tr_b16 a[134:135], v120 offset:40448
  s_bitset0_b32 s16, 20
  v_mfma_f32_16x16x32_bf16 v[56:59], a[140:143], a[52:55], v[56:59]
  ds_read_b64_tr_b16 a[136:137], v121 offset:39936
  s_add_u32 m0, s38, 39936
  v_mfma_f32_16x16x32_bf16 v[12:15], a[144:147], a[48:51], v[12:15]
  ds_read_b64_tr_b16 a[138:139], v121 offset:40448
  ds_read_b64_tr_b16 a[140:141], v122 offset:39936
  v_mfma_f32_16x16x32_bf16 v[60:63], a[144:147], a[52:55], v[60:63]
  buffer_load_dwordx4 v107, s[8:11], s17 offen lds
  v_mfma_f32_16x16x32_bf16 v[16:19], a[148:151], a[48:51], v[16:19]
  ds_read_b64_tr_b16 a[142:143], v122 offset:40448
  buffer_load_dwordx4 v108, s[8:11], s17 offen offset:1024 lds
  v_mfma_f32_16x16x32_bf16 v[64:67], a[148:151], a[52:55], v[64:67]
  buffer_load_dwordx4 v109, s[8:11], s17 offen offset:2048 lds
  s_waitcnt lgkmcnt(10)
  v_mfma_f32_16x16x32_bf16 v[20:23], a[152:155], a[48:51], v[20:23]
  ds_read_b64_tr_b16 a[144:145], v123 offset:39936
  ds_read_b64_tr_b16 a[146:147], v123 offset:40448
  v_mfma_f32_16x16x32_bf16 v[68:71], a[152:155], a[52:55], v[68:71]
  ds_read_b64_tr_b16 a[148:149], v120 offset:40960
  s_add_u32 s17, s17, 196608
  v_mfma_f32_16x16x32_bf16 v[24:27], a[156:159], a[48:51], v[24:27]
  ds_read_b64_tr_b16 a[150:151], v120 offset:41472
  s_cmp_eq_u32 s17, s10
  v_mfma_f32_16x16x32_bf16 v[72:75], a[156:159], a[52:55], v[72:75]
  ds_read_b64_tr_b16 a[152:153], v121 offset:40960
  s_cselect_b32 s17, 0, s17
  v_mfma_f32_16x16x32_bf16 v[28:31], a[160:163], a[48:51], v[28:31]
  ds_read_b64_tr_b16 a[154:155], v121 offset:41472
  ds_read_b64_tr_b16 a[156:157], v122 offset:40960
  v_mfma_f32_16x16x32_bf16 v[76:79], a[160:163], a[52:55], v[76:79]
  ds_read_b64_tr_b16 a[158:159], v122 offset:41472
  s_add_u32 m0, s39, 39936
  v_mfma_f32_16x16x32_bf16 v[32:35], a[48:51], a[164:167], v[32:35]
  buffer_load_dword v106, s[4:7], s16 offen sc1 lds
  v_mfma_f32_16x16x32_bf16 v[80:83], a[52:55], a[164:167], v[80:83]
  buffer_load_dwordx4 a[24:27], v105, s[4:7], s16 offen sc1
  v_mfma_f32_16x16x32_bf16 v[36:39], a[48:51], a[168:171], v[36:39]
  ds_read_b64_tr_b16 a[160:161], v123 offset:40960
  ds_read_b64_tr_b16 a[162:163], v123 offset:41472
  v_mfma_f32_16x16x32_bf16 v[84:87], a[52:55], a[168:171], v[84:87]
  buffer_load_dwordx4 a[28:31], v105, s[4:7], s16 offen offset:1024 sc1
  v_mfma_f32_16x16x32_bf16 v[40:43], a[48:51], a[172:175], v[40:43]
  ds_read_b64_tr_b16 a[164:165], v120 offset:41984
  ds_read_b64_tr_b16 a[166:167], v120 offset:42496
  s_add_u32 s16, s16, 131072
  v_mfma_f32_16x16x32_bf16 v[88:91], a[52:55], a[172:175], v[88:91]
  ds_read_b64_tr_b16 a[168:169], v121 offset:41984
  s_bitset0_b32 s16, 20
  v_mfma_f32_16x16x32_bf16 v[44:47], a[48:51], a[176:179], v[44:47]
  ds_read_b64_tr_b16 a[170:171], v121 offset:42496
  ds_read_b64_tr_b16 a[172:173], v122 offset:41984
  v_mfma_f32_16x16x32_bf16 v[92:95], a[52:55], a[176:179], v[92:95]
  s_waitcnt vmcnt(23) lgkmcnt(10)
  s_barrier
  v_mfma_f32_16x16x32_bf16 v[96:99], a[180:183], a[188:191], v[96:99]
  ds_read_b64_tr_b16 a[174:175], v122 offset:42496
  s_add_u32 m0, s38, 53248
  v_mfma_f32_16x16x32_bf16 v[100:103], a[188:191], a[184:187], v[100:103]
  buffer_load_dwordx4 v107, s[8:11], s17 offen lds
  v_mfma_f32_16x16x32_bf16 v[0:3], a[132:135], a[56:59], v[0:3]
  ds_read_b64_tr_b16 a[176:177], v123 offset:41984
  ds_read_b64_tr_b16 a[178:179], v123 offset:42496
  buffer_load_dwordx4 v108, s[8:11], s17 offen offset:1024 lds
  v_mfma_f32_16x16x32_bf16 v[48:51], a[132:135], a[60:63], v[48:51]
  ds_read_b64_tr_b16 a[180:181], v118 offset:1024
  ds_read_b64_tr_b16 a[182:183], v118 offset:1536
  buffer_load_dwordx4 v109, s[8:11], s17 offen offset:2048 lds
  v_mfma_f32_16x16x32_bf16 v[4:7], a[136:139], a[56:59], v[4:7]
  ds_read_b128 a[188:191], v119 offset:12288
  ds_read_b64_tr_b16 a[184:185], v118 offset:2048
  ds_read_b64_tr_b16 a[186:187], v118 offset:2560
  v_mfma_f32_16x16x32_bf16 v[52:55], a[136:139], a[60:63], v[52:55]
  ds_read_b64_tr_b16 a[132:133], v114 offset:0
  s_add_u32 s17, s17, 196608
  v_mfma_f32_16x16x32_bf16 v[8:11], a[140:143], a[56:59], v[8:11]
  ds_read_b64_tr_b16 a[134:135], v114 offset:512
  s_cmp_eq_u32 s17, s10
  v_mfma_f32_16x16x32_bf16 v[56:59], a[140:143], a[60:63], v[56:59]
  ds_read_b64_tr_b16 a[136:137], v115 offset:0
  s_cselect_b32 s17, 0, s17
  v_mfma_f32_16x16x32_bf16 v[12:15], a[144:147], a[56:59], v[12:15]
  ds_read_b64_tr_b16 a[138:139], v115 offset:512
  s_add_u32 m0, s39, 53248
  v_mfma_f32_16x16x32_bf16 v[60:63], a[144:147], a[60:63], v[60:63]
  ds_read_b64_tr_b16 a[140:141], v116 offset:0
  ds_read_b64_tr_b16 a[142:143], v116 offset:512
  v_mfma_f32_16x16x32_bf16 v[16:19], a[148:151], a[56:59], v[16:19]
  buffer_load_dword v106, s[4:7], s16 offen sc1 lds
  v_mfma_f32_16x16x32_bf16 v[64:67], a[148:151], a[60:63], v[64:67]
  buffer_load_dwordx4 a[32:35], v105, s[4:7], s16 offen sc1
  s_waitcnt lgkmcnt(10)
  v_mfma_f32_16x16x32_bf16 v[20:23], a[152:155], a[56:59], v[20:23]
  ds_read_b64_tr_b16 a[144:145], v117 offset:0
  ds_read_b64_tr_b16 a[146:147], v117 offset:512
  buffer_load_dwordx4 a[36:39], v105, s[4:7], s16 offen offset:1024 sc1
  v_mfma_f32_16x16x32_bf16 v[68:71], a[152:155], a[60:63], v[68:71]
  ds_read_b64_tr_b16 a[148:149], v114 offset:1024
  s_add_u32 s16, s16, 131072
  v_mfma_f32_16x16x32_bf16 v[24:27], a[156:159], a[56:59], v[24:27]
  ds_read_b64_tr_b16 a[150:151], v114 offset:1536
  ds_read_b64_tr_b16 a[152:153], v115 offset:1024
  v_mfma_f32_16x16x32_bf16 v[72:75], a[156:159], a[60:63], v[72:75]
  ds_read_b64_tr_b16 a[154:155], v115 offset:1536
  s_bitset0_b32 s16, 20
  v_mfma_f32_16x16x32_bf16 v[28:31], a[160:163], a[56:59], v[28:31]
  ds_read_b64_tr_b16 a[156:157], v116 offset:1024
  s_add_u32 m0, s38, 66560
  v_mfma_f32_16x16x32_bf16 v[76:79], a[160:163], a[60:63], v[76:79]
  buffer_load_dwordx4 v107, s[8:11], s17 offen lds
  v_mfma_f32_16x16x32_bf16 v[32:35], a[56:59], a[164:167], v[32:35]
  ds_read_b64_tr_b16 a[158:159], v116 offset:1536
  buffer_load_dwordx4 v108, s[8:11], s17 offen offset:1024 lds
  v_mfma_f32_16x16x32_bf16 v[80:83], a[60:63], a[164:167], v[80:83]
  ds_read_b64_tr_b16 a[160:161], v117 offset:1024
  ds_read_b64_tr_b16 a[162:163], v117 offset:1536
  v_mfma_f32_16x16x32_bf16 v[36:39], a[56:59], a[168:171], v[36:39]
  buffer_load_dwordx4 v109, s[8:11], s17 offen offset:2048 lds
  v_mfma_f32_16x16x32_bf16 v[84:87], a[60:63], a[168:171], v[84:87]
  ds_read_b64_tr_b16 a[164:165], v114 offset:2048
  s_add_u32 s17, s17, 196608
  v_mfma_f32_16x16x32_bf16 v[40:43], a[56:59], a[172:175], v[40:43]
  ds_read_b64_tr_b16 a[166:167], v114 offset:2560
  s_cmp_eq_u32 s17, s10
  v_mfma_f32_16x16x32_bf16 v[88:91], a[60:63], a[172:175], v[88:91]
  ds_read_b64_tr_b16 a[168:169], v115 offset:2048
  s_cselect_b32 s17, 0, s17
  v_mfma_f32_16x16x32_bf16 v[44:47], a[56:59], a[176:179], v[44:47]
  ds_read_b64_tr_b16 a[170:171], v115 offset:2560
  ds_read_b64_tr_b16 a[172:173], v116 offset:2048
  v_mfma_f32_16x16x32_bf16 v[92:95], a[60:63], a[176:179], v[92:95]
  s_waitcnt vmcnt(21) lgkmcnt(10)
  s_barrier
  v_mfma_f32_16x16x32_bf16 v[96:99], a[180:183], a[188:191], v[96:99]
  ds_read_b64_tr_b16 a[174:175], v116 offset:2560
  s_add_u32 m0, s39, 66560
  v_mfma_f32_16x16x32_bf16 v[100:103], a[188:191], a[184:187], v[100:103]
  buffer_load_dword v106, s[4:7], s16 offen sc1 lds
  v_mfma_f32_16x16x32_bf16 v[0:3], a[132:135], a[0:3], v[0:3]
  ds_read_b64_tr_b16 a[176:177], v117 offset:2048
  ds_read_b64_tr_b16 a[178:179], v117 offset:2560
  buffer_load_dwordx4 a[40:43], v105, s[4:7], s16 offen sc1
  v_mfma_f32_16x16x32_bf16 v[48:51], a[132:135], a[4:7], v[48:51]
  ds_read_b64_tr_b16 a[180:181], v118 offset:14336
  ds_read_b64_tr_b16 a[182:183], v118 offset:14848
  buffer_load_dwordx4 a[44:47], v105, s[4:7], s16 offen offset:1024 sc1
  v_mfma_f32_16x16x32_bf16 v[4:7], a[136:139], a[0:3], v[4:7]
  ds_read_b128 a[188:191], v119 offset:25600
  ds_read_b64_tr_b16 a[184:185], v118 offset:15360
  ds_read_b64_tr_b16 a[186:187], v118 offset:15872
  v_mfma_f32_16x16x32_bf16 v[52:55], a[136:139], a[4:7], v[52:55]
  ds_read_b64_tr_b16 a[132:133], v114 offset:13312
  s_add_u32 s16, s16, 131072
  v_mfma_f32_16x16x32_bf16 v[8:11], a[140:143], a[0:3], v[8:11]
  ds_read_b64_tr_b16 a[134:135], v114 offset:13824
  s_bitset0_b32 s16, 20
  v_mfma_f32_16x16x32_bf16 v[56:59], a[140:143], a[4:7], v[56:59]
  ds_read_b64_tr_b16 a[136:137], v115 offset:13312
  s_add_u32 m0, s38, 79872
  v_mfma_f32_16x16x32_bf16 v[12:15], a[144:147], a[0:3], v[12:15]
  ds_read_b64_tr_b16 a[138:139], v115 offset:13824
  buffer_load_dwordx4 v107, s[8:11], s17 offen lds
  v_mfma_f32_16x16x32_bf16 v[60:63], a[144:147], a[4:7], v[60:63]
  ds_read_b64_tr_b16 a[140:141], v116 offset:13312
  ds_read_b64_tr_b16 a[142:143], v116 offset:13824
  v_mfma_f32_16x16x32_bf16 v[16:19], a[148:151], a[0:3], v[16:19]
  buffer_load_dwordx4 v108, s[8:11], s17 offen offset:1024 lds
  v_mfma_f32_16x16x32_bf16 v[64:67], a[148:151], a[4:7], v[64:67]
  buffer_load_dwordx4 v109, s[8:11], s17 offen offset:2048 lds
  s_waitcnt lgkmcnt(10)
  v_mfma_f32_16x16x32_bf16 v[20:23], a[152:155], a[0:3], v[20:23]
  ds_read_b64_tr_b16 a[144:145], v117 offset:13312
  ds_read_b64_tr_b16 a[146:147], v117 offset:13824
  s_add_u32 s17, s17, 196608
  v_mfma_f32_16x16x32_bf16 v[68:71], a[152:155], a[4:7], v[68:71]
  ds_read_b64_tr_b16 a[148:149], v114 offset:14336
  s_cmp_eq_u32 s17, s10
  v_mfma_f32_16x16x32_bf16 v[24:27], a[156:159], a[0:3], v[24:27]
  ds_read_b64_tr_b16 a[150:151], v114 offset:14848
  ds_read_b64_tr_b16 a[152:153], v115 offset:14336
  v_mfma_f32_16x16x32_bf16 v[72:75], a[156:159], a[4:7], v[72:75]
  ds_read_b64_tr_b16 a[154:155], v115 offset:14848
  s_cselect_b32 s17, 0, s17
  v_mfma_f32_16x16x32_bf16 v[28:31], a[160:163], a[0:3], v[28:31]
  ds_read_b64_tr_b16 a[156:157], v116 offset:14336
  s_add_u32 m0, s39, 79872
  v_mfma_f32_16x16x32_bf16 v[76:79], a[160:163], a[4:7], v[76:79]
  buffer_load_dword v106, s[4:7], s16 offen sc1 lds
  v_mfma_f32_16x16x32_bf16 v[32:35], a[0:3], a[164:167], v[32:35]
  ds_read_b64_tr_b16 a[158:159], v116 offset:14848
  buffer_load_dwordx4 a[48:51], v105, s[4:7], s16 offen sc1
  v_mfma_f32_16x16x32_bf16 v[80:83], a[4:7], a[164:167], v[80:83]
  ds_read_b64_tr_b16 a[160:161], v117 offset:14336
  ds_read_b64_tr_b16 a[162:163], v117 offset:14848
  v_mfma_f32_16x16x32_bf16 v[36:39], a[0:3], a[168:171], v[36:39]
  buffer_load_dwordx4 a[52:55], v105, s[4:7], s16 offen offset:1024 sc1
  v_mfma_f32_16x16x32_bf16 v[84:87], a[4:7], a[168:171], v[84:87]
  ds_read_b64_tr_b16 a[164:165], v114 offset:15360
  s_add_u32 s16, s16, 131072
  v_mfma_f32_16x16x32_bf16 v[40:43], a[0:3], a[172:175], v[40:43]
  ds_read_b64_tr_b16 a[166:167], v114 offset:15872
  s_bitset0_b32 s16, 20
  v_mfma_f32_16x16x32_bf16 v[88:91], a[4:7], a[172:175], v[88:91]
  buffer_store_dwordx4 v[244:247], v119, s[92:95], s35 offen offset:1024 sc1
  v_mfma_f32_16x16x32_bf16 v[44:47], a[0:3], a[176:179], v[44:47]
  ds_read_b64_tr_b16 a[168:169], v115 offset:15360
  ds_read_b64_tr_b16 a[170:171], v115 offset:15872
  v_mfma_f32_16x16x32_bf16 v[92:95], a[4:7], a[176:179], v[92:95]
  s_waitcnt vmcnt(25) lgkmcnt(10)
  s_barrier
  v_mfma_f32_16x16x32_bf16 v[96:99], a[180:183], a[188:191], v[96:99]
  ds_read_b64_tr_b16 a[172:173], v116 offset:15360
  ds_read_b64_tr_b16 a[174:175], v116 offset:15872
  s_add_u32 m0, s38, 93184
  v_mfma_f32_16x16x32_bf16 v[100:103], a[188:191], a[184:187], v[100:103]
  buffer_load_dwordx4 v107, s[8:11], s17 offen lds
  v_mfma_f32_16x16x32_bf16 v[0:3], a[132:135], a[8:11], v[0:3]
  ds_read_b64_tr_b16 a[176:177], v117 offset:15360
  ds_read_b64_tr_b16 a[178:179], v117 offset:15872
  buffer_load_dwordx4 v108, s[8:11], s17 offen offset:1024 lds
  v_mfma_f32_16x16x32_bf16 v[48:51], a[132:135], a[12:15], v[48:51]
  ds_read_b64_tr_b16 a[180:181], v118 offset:27648
  ds_read_b64_tr_b16 a[182:183], v118 offset:28160
  buffer_load_dwordx4 v109, s[8:11], s17 offen offset:2048 lds
  v_mfma_f32_16x16x32_bf16 v[4:7], a[136:139], a[8:11], v[4:7]
  ds_read_b128 a[188:191], v119 offset:38912
  ds_read_b64_tr_b16 a[184:185], v118 offset:28672
  ds_read_b64_tr_b16 a[186:187], v118 offset:29184
  s_add_u32 s17, s17, 196608
  v_mfma_f32_16x16x32_bf16 v[52:55], a[136:139], a[12:15], v[52:55]
  ds_read_b64_tr_b16 a[132:133], v114 offset:26624
  s_cmp_eq_u32 s17, s10
  v_mfma_f32_16x16x32_bf16 v[8:11], a[140:143], a[8:11], v[8:11]
  ds_read_b64_tr_b16 a[134:135], v114 offset:27136
  ds_read_b64_tr_b16 a[136:137], v115 offset:26624
  v_mfma_f32_16x16x32_bf16 v[56:59], a[140:143], a[12:15], v[56:59]
  ds_read_b64_tr_b16 a[138:139], v115 offset:27136
  s_cselect_b32 s17, 0, s17
  v_mfma_f32_16x16x32_bf16 v[12:15], a[144:147], a[8:11], v[12:15]
  s_add_u32 s8, s8, s10
  s_addc_u32 s9, s9, 0
  v_mfma_f32_16x16x32_bf16 v[60:63], a[144:147], a[12:15], v[60:63]
  ds_read_b64_tr_b16 a[140:141], v116 offset:26624
  s_add_u32 m0, s39, 93184
  v_mfma_f32_16x16x32_bf16 v[16:19], a[148:151], a[8:11], v[16:19]
  ds_read_b64_tr_b16 a[142:143], v116 offset:27136
  buffer_load_dword v106, s[4:7], s16 offen sc1 lds
  v_mfma_f32_16x16x32_bf16 v[64:67], a[148:151], a[12:15], v[64:67]
  buffer_load_dwordx4 a[56:59], v105, s[4:7], s16 offen sc1
  s_waitcnt lgkmcnt(10)
  v_mfma_f32_16x16x32_bf16 v[20:23], a[152:155], a[8:11], v[20:23]
  ds_read_b64_tr_b16 a[144:145], v117 offset:26624
  ds_read_b64_tr_b16 a[146:147], v117 offset:27136
  v_mfma_f32_16x16x32_bf16 v[68:71], a[152:155], a[12:15], v[68:71]
  buffer_load_dwordx4 a[60:63], v105, s[4:7], s16 offen offset:1024 sc1
  v_mfma_f32_16x16x32_bf16 v[24:27], a[156:159], a[8:11], v[24:27]
  ds_read_b64_tr_b16 a[148:149], v114 offset:27648
  ds_read_b64_tr_b16 a[150:151], v114 offset:28160
  s_add_u32 s16, s16, 131072
  v_mfma_f32_16x16x32_bf16 v[72:75], a[156:159], a[12:15], v[72:75]
  ds_read_b64_tr_b16 a[152:153], v115 offset:27648
  s_bitset0_b32 s16, 20
  v_mfma_f32_16x16x32_bf16 v[28:31], a[160:163], a[8:11], v[28:31]
  ds_read_b64_tr_b16 a[154:155], v115 offset:28160
  s_add_u32 s4, s4, s6
  s_addc_u32 s5, s5, 0
  v_mfma_f32_16x16x32_bf16 v[76:79], a[160:163], a[12:15], v[76:79]
  ds_read_b64_tr_b16 a[156:157], v116 offset:27648
  s_add_u32 m0, s39, 0
  v_mfma_f32_16x16x32_bf16 v[32:35], a[8:11], a[164:167], v[32:35]
  ds_read_b64_tr_b16 a[158:159], v116 offset:28160
  ds_read_b64_tr_b16 a[160:161], v117 offset:27648
  v_mfma_f32_16x16x32_bf16 v[80:83], a[12:15], a[164:167], v[80:83]
  buffer_load_dword v106, s[4:7], s16 offen sc1 lds
  v_mfma_f32_16x16x32_bf16 v[36:39], a[8:11], a[168:171], v[36:39]
  ds_read_b64_tr_b16 a[162:163], v117 offset:28160
  buffer_load_dwordx4 a[0:3], v105, s[4:7], s16 offen sc1
  v_mfma_f32_16x16x32_bf16 v[84:87], a[12:15], a[168:171], v[84:87]
  buffer_load_dwordx4 a[4:7], v105, s[4:7], s16 offen offset:1024 sc1
  v_mfma_f32_16x16x32_bf16 v[40:43], a[8:11], a[172:175], v[40:43]
  ds_read_b64_tr_b16 a[164:165], v114 offset:28672
  ds_read_b64_tr_b16 a[166:167], v114 offset:29184
  s_add_u32 s16, s16, 131072
  v_mfma_f32_16x16x32_bf16 v[88:91], a[12:15], a[172:175], v[88:91]
  ds_read_b64_tr_b16 a[168:169], v115 offset:28672
  s_bitset0_b32 s16, 20
  v_mfma_f32_16x16x32_bf16 v[44:47], a[8:11], a[176:179], v[44:47]
  ds_read_b64_tr_b16 a[170:171], v115 offset:29184
  ds_read_b64_tr_b16 a[172:173], v116 offset:28672
  v_mfma_f32_16x16x32_bf16 v[92:95], a[12:15], a[176:179], v[92:95]
  s_waitcnt vmcnt(28) lgkmcnt(10)
  s_barrier
  v_mfma_f32_16x16x32_bf16 v[96:99], a[180:183], a[188:191], v[96:99]
  ds_read_b64_tr_b16 a[174:175], v116 offset:29184
  s_add_u32 m0, s39, 13312
  s_nop 0
  buffer_load_dword v106, s[4:7], s16 offen sc1 lds
  v_mfma_f32_16x16x32_bf16 v[100:103], a[188:191], a[184:187], v[100:103]
  buffer_load_dwordx4 a[8:11], v105, s[4:7], s16 offen sc1
  v_mfma_f32_16x16x32_bf16 v[0:3], a[132:135], a[16:19], v[0:3]
  ds_read_b64_tr_b16 a[176:177], v117 offset:28672
  ds_read_b64_tr_b16 a[178:179], v117 offset:29184
  buffer_load_dwordx4 a[12:15], v105, s[4:7], s16 offen offset:1024 sc1
  v_mfma_f32_16x16x32_bf16 v[48:51], a[132:135], a[20:23], v[48:51]
  ds_read_b64_tr_b16 a[180:181], v118 offset:40960
  ds_read_b64_tr_b16 a[182:183], v118 offset:41472
  s_add_u32 s16, s16, 131072
  v_mfma_f32_16x16x32_bf16 v[4:7], a[136:139], a[16:19], v[4:7]
  ds_read_b128 a[188:191], v119 offset:52224
  ds_read_b64_tr_b16 a[184:185], v118 offset:41984
  ds_read_b64_tr_b16 a[186:187], v118 offset:42496
  s_bitset0_b32 s16, 20
  v_mfma_f32_16x16x32_bf16 v[52:55], a[136:139], a[20:23], v[52:55]
  s_add_u32 m0, s38, 0
  s_nop 0
  buffer_load_dwordx4 v107, s[8:11], s17 offen lds
  v_mfma_f32_16x16x32_bf16 v[8:11], a[140:143], a[16:19], v[8:11]
  ds_read_b64_tr_b16 a[132:133], v114 offset:39936
  ds_read_b64_tr_b16 a[134:135], v114 offset:40448
  buffer_load_dwordx4 v108, s[8:11], s17 offen offset:1024 lds
  v_mfma_f32_16x16x32_bf16 v[56:59], a[140:143], a[20:23], v[56:59]
  buffer_load_dwordx4 v109, s[8:11], s17 offen offset:2048 lds
  v_mfma_f32_16x16x32_bf16 v[12:15], a[144:147], a[16:19], v[12:15]
  ds_read_b64_tr_b16 a[136:137], v115 offset:39936
  ds_read_b64_tr_b16 a[138:139], v115 offset:40448
  s_add_u32 s17, s17, 196608
  v_mfma_f32_16x16x32_bf16 v[60:63], a[144:147], a[20:23], v[60:63]
  ds_read_b64_tr_b16 a[140:141], v116 offset:39936
  s_cmp_eq_u32 s17, s10
  v_mfma_f32_16x16x32_bf16 v[16:19], a[148:151], a[16:19], v[16:19]
  ds_read_b64_tr_b16 a[142:143], v116 offset:40448
  s_cselect_b32 s17, 0, s17
  s_mov_b32 m0, s51
  v_mfma_f32_16x16x32_bf16 v[64:67], a[148:151], a[20:23], v[64:67]
  ds_read_b64_tr_b16 a[144:145], v117 offset:39936
  s_add_u32 s51, s51, 1024
  s_waitcnt lgkmcnt(10)
  v_mfma_f32_16x16x32_bf16 v[20:23], a[152:155], a[16:19], v[20:23]
  ds_read_b64_tr_b16 a[146:147], v117 offset:40448
  buffer_load_dwordx4 v129, s[52:55], s50 offen nt lds
  v_mfma_f32_16x16x32_bf16 v[68:71], a[152:155], a[20:23], v[68:71]
  ds_read_b64_tr_b16 a[148:149], v114 offset:40960
  s_add_u32 s50, s50, 98304
  v_mfma_f32_16x16x32_bf16 v[24:27], a[156:159], a[16:19], v[24:27]
  ds_read_b64_tr_b16 a[150:151], v114 offset:41472
  s_mov_b32 m0, s51
  v_mfma_f32_16x16x32_bf16 v[72:75], a[156:159], a[20:23], v[72:75]
  s_add_u32 s51, s51, 1024
  buffer_load_dwordx4 v129, s[52:55], s50 offen nt lds
  v_mfma_f32_16x16x32_bf16 v[28:31], a[160:163], a[16:19], v[28:31]
  ds_read_b64_tr_b16 a[152:153], v115 offset:40960
  ds_read_b64_tr_b16 a[154:155], v115 offset:41472
  s_add_u32 s50, s50, 98304
  v_mfma_f32_16x16x32_bf16 v[76:79], a[160:163], a[20:23], v[76:79]
  ds_read_b64_tr_b16 a[156:157], v116 offset:40960
  s_mov_b32 m0, s51
  v_mfma_f32_16x16x32_bf16 v[32:35], a[16:19], a[164:167], v[32:35]
  ds_read_b64_tr_b16 a[158:159], v116 offset:41472
  s_add_u32 s51, s51, 1024
  v_mfma_f32_16x16x32_bf16 v[80:83], a[20:23], a[164:167], v[80:83]
  buffer_load_dwordx4 v129, s[52:55], s50 offen nt lds
  v_mfma_f32_16x16x32_bf16 v[36:39], a[16:19], a[168:171], v[36:39]
  ds_read_b64_tr_b16 a[160:161], v117 offset:40960
  ds_read_b64_tr_b16 a[162:163], v117 offset:41472
  s_add_u32 s50, s50, 98304
  s_mov_b32 m0, s51
  v_mfma_f32_16x16x32_bf16 v[84:87], a[20:23], a[168:171], v[84:87]
  ds_read_b64_tr_b16 a[164:165], v114 offset:41984
  s_add_u32 s51, s51, 1024
  v_mfma_f32_16x16x32_bf16 v[40:43], a[16:19], a[172:175], v[40:43]
  ds_read_b64_tr_b16 a[166:167], v114 offset:42496
  buffer_load_dwordx4 v129, s[52:55], s50 offen nt lds
  v_mfma_f32_16x16x32_bf16 v[88:91], a[20:23], a[172:175], v[88:91]
  ds_read_b64_tr_b16 a[168:169], v115 offset:41984
  s_add_u32 s50, s50, 98304
  v_mfma_f32_16x16x32_bf16 v[44:47], a[16:19], a[176:179], v[44:47]
  ds_read_b64_tr_b16 a[170:171], v115 offset:42496
  s_mov_b32 s40, s20
  s_mov_b32 s41, s21
  s_mov_b32 s42, 0x200000
  s_mov_b32 s43, 0x20000
  v_min_u32 v200, 9, v104
  v_lshlrev_b32 v201, 16, v200
  v_add_u32 v201, 524288, v201
  v_lshlrev_b32 v202, 7, v200
  s_lshl2_add_u32 s33, s2, s3
  s_mul_i32 s32, s33, 448
  s_add_u32 s32, s32, 1572096
  v_add_u32 v202, s32, v202
  v_cmp_le_u32 vcc, 6, v104
  s_lshl_b32 s33, s33, 6
  s_nop 0
  v_cndmask_b32 v201, v201, v202, vcc
  buffer_load_dword v131, v201, s[40:43], s33 offen
  v_mfma_f32_16x16x32_bf16 v[92:95], a[20:23], a[176:179], v[92:95]
  s_waitcnt vmcnt(33) lgkmcnt(10)
  s_barrier
  v_mfma_f32_16x16x32_bf16 v[96:99], a[180:183], a[188:191], v[96:99]
  ds_read_b64_tr_b16 a[172:173], v116 offset:41984
  ds_read_b64_tr_b16 a[174:175], v116 offset:42496
  v_mfma_f32_16x16x32_bf16 v[100:103], a[188:191], a[184:187], v[100:103]
  ds_read_b64_tr_b16 a[176:177], v117 offset:41984
  ds_read_b64_tr_b16 a[178:179], v117 offset:42496
  v_mfma_f32_16x16x32_bf16 v[0:3], a[132:135], a[24:27], v[0:3]
  ds_read_b64_tr_b16 a[180:181], v124 offset:1024
  ds_read_b64_tr_b16 a[182:183], v124 offset:1536
  v_mfma_f32_16x16x32_bf16 v[48:51], a[132:135], a[28:31], v[48:51]
  ds_read_b128 a[188:191], v125 offset:12288
  ds_read_b64_tr_b16 a[184:185], v124 offset:2048
  v_mfma_f32_16x16x32_bf16 v[4:7], a[136:139], a[24:27], v[4:7]
  ds_read_b64_tr_b16 a[186:187], v124 offset:2560
  ds_read_b64_tr_b16 a[132:133], v120 offset:0
  v_mfma_f32_16x16x32_bf16 v[52:55], a[136:139], a[28:31], v[52:55]
  ds_read_b64_tr_b16 a[134:135], v120 offset:512
  ds_read_b64_tr_b16 a[136:137], v121 offset:0
  v_mfma_f32_16x16x32_bf16 v[8:11], a[140:143], a[24:27], v[8:11]
  ds_read_b64_tr_b16 a[138:139], v121 offset:512
  v_mfma_f32_16x16x32_bf16 v[56:59], a[140:143], a[28:31], v[56:59]
  ds_read_b64_tr_b16 a[140:141], v122 offset:0
  ds_read_b64_tr_b16 a[142:143], v122 offset:512
  v_mfma_f32_16x16x32_bf16 v[12:15], a[144:147], a[24:27], v[12:15]
  v_mfma_f32_16x16x32_bf16 v[60:63], a[144:147], a[28:31], v[60:63]
  ds_read_b64_tr_b16 a[144:145], v123 offset:0
  ds_read_b64_tr_b16 a[146:147], v123 offset:512
  v_mfma_f32_16x16x32_bf16 v[16:19], a[148:151], a[24:27], v[16:19]
  v_mfma_f32_16x16x32_bf16 v[64:67], a[148:151], a[28:31], v[64:67]
  ds_read_b64_tr_b16 a[148:149], v120 offset:1024
  ds_read_b64_tr_b16 a[150:151], v120 offset:1536
  s_waitcnt lgkmcnt(10)
  v_mfma_f32_16x16x32_bf16 v[20:23], a[152:155], a[24:27], v[20:23]
  v_mfma_f32_16x16x32_bf16 v[68:71], a[152:155], a[28:31], v[68:71]
  ds_read_b64_tr_b16 a[152:153], v121 offset:1024
  ds_read_b64_tr_b16 a[154:155], v121 offset:1536
  v_mfma_f32_16x16x32_bf16 v[24:27], a[156:159], a[24:27], v[24:27]
  v_mfma_f32_16x16x32_bf16 v[72:75], a[156:159], a[28:31], v[72:75]
  ds_read_b64_tr_b16 a[156:157], v122 offset:1024
  ds_read_b64_tr_b16 a[158:159], v122 offset:1536
  v_mfma_f32_16x16x32_bf16 v[28:31], a[160:163], a[24:27], v[28:31]
  v_mfma_f32_16x16x32_bf16 v[76:79], a[160:163], a[28:31], v[76:79]
  ds_read_b64_tr_b16 a[160:161], v123 offset:1024
  ds_read_b64_tr_b16 a[162:163], v123 offset:1536
  v_mfma_f32_16x16x32_bf16 v[32:35], a[24:27], a[164:167], v[32:35]
  v_mfma_f32_16x16x32_bf16 v[80:83], a[28:31], a[164:167], v[80:83]
  ds_read_b64_tr_b16 a[164:165], v120 offset:2048
  ds_read_b64_tr_b16 a[166:167], v120 offset:2560
  v_mfma_f32_16x16x32_bf16 v[36:39], a[24:27], a[168:171], v[36:39]
  v_mfma_f32_16x16x32_bf16 v[84:87], a[28:31], a[168:171], v[84:87]
  ds_read_b64_tr_b16 a[168:169], v121 offset:2048
  ds_read_b64_tr_b16 a[170:171], v121 offset:2560
  v_mfma_f32_16x16x32_bf16 v[40:43], a[24:27], a[172:175], v[40:43]
  v_mfma_f32_16x16x32_bf16 v[88:91], a[28:31], a[172:175], v[88:91]
  ds_read_b64_tr_b16 a[172:173], v122 offset:2048
  ds_read_b64_tr_b16 a[174:175], v122 offset:2560
  v_mfma_f32_16x16x32_bf16 v[44:47], a[24:27], a[176:179], v[44:47]
  v_mfma_f32_16x16x32_bf16 v[92:95], a[28:31], a[176:179], v[92:95]
  s_waitcnt vmcnt(27) lgkmcnt(10)
  s_barrier
  v_mfma_f32_16x16x32_bf16 v[96:99], a[180:183], a[188:191], v[96:99]
  buffer_store_dwordx4 v[244:247], v119, s[92:95], s35 offen offset:2048 sc1
  v_mfma_f32_16x16x32_bf16 v[100:103], a[188:191], a[184:187], v[100:103]
  ds_read_b64_tr_b16 a[176:177], v123 offset:2048
  ds_read_b64_tr_b16 a[178:179], v123 offset:2560
  v_mfma_f32_16x16x32_bf16 v[0:3], a[132:135], a[32:35], v[0:3]
  ds_read_b64_tr_b16 a[180:181], v124 offset:14336
  ds_read_b64_tr_b16 a[182:183], v124 offset:14848
  v_mfma_f32_16x16x32_bf16 v[48:51], a[132:135], a[36:39], v[48:51]
  ds_read_b128 a[188:191], v125 offset:25600
  ds_read_b64_tr_b16 a[184:185], v124 offset:15360
  v_mfma_f32_16x16x32_bf16 v[4:7], a[136:139], a[32:35], v[4:7]
  ds_read_b64_tr_b16 a[186:187], v124 offset:15872
  ds_read_b64_tr_b16 a[132:133], v120 offset:13312
  v_mfma_f32_16x16x32_bf16 v[52:55], a[136:139], a[36:39], v[52:55]
  ds_read_b64_tr_b16 a[134:135], v120 offset:13824
  ds_read_b64_tr_b16 a[136:137], v121 offset:13312
  v_mfma_f32_16x16x32_bf16 v[8:11], a[140:143], a[32:35], v[8:11]
  ds_read_b64_tr_b16 a[138:139], v121 offset:13824
  v_mfma_f32_16x16x32_bf16 v[56:59], a[140:143], a[36:39], v[56:59]
  ds_read_b64_tr_b16 a[140:141], v122 offset:13312
  ds_read_b64_tr_b16 a[142:143], v122 offset:13824
  v_mfma_f32_16x16x32_bf16 v[12:15], a[144:147], a[32:35], v[12:15]
  v_mfma_f32_16x16x32_bf16 v[60:63], a[144:147], a[36:39], v[60:63]
  ds_read_b64_tr_b16 a[144:145], v123 offset:13312
  ds_read_b64_tr_b16 a[146:147], v123 offset:13824
  v_mfma_f32_16x16x32_bf16 v[16:19], a[148:151], a[32:35], v[16:19]
  v_mfma_f32_16x16x32_bf16 v[64:67], a[148:151], a[36:39], v[64:67]
  ds_read_b64_tr_b16 a[148:149], v120 offset:14336
  ds_read_b64_tr_b16 a[150:151], v120 offset:14848
  v_mfma_f32_16x16x32_bf16 v[20:23], a[152:155], a[32:35], v[20:23]
  v_mfma_f32_16x16x32_bf16 v[68:71], a[152:155], a[36:39], v[68:71]
  ds_read_b64_tr_b16 a[152:153], v121 offset:14336
  ds_read_b64_tr_b16 a[154:155], v121 offset:14848
  s_waitcnt lgkmcnt(10)
  v_mfma_f32_16x16x32_bf16 v[24:27], a[156:159], a[32:35], v[24:27]
  v_mfma_f32_16x16x32_bf16 v[72:75], a[156:159], a[36:39], v[72:75]
  ds_read_b64_tr_b16 a[156:157], v122 offset:14336
  ds_read_b64_tr_b16 a[158:159], v122 offset:14848
  v_mfma_f32_16x16x32_bf16 v[28:31], a[160:163], a[32:35], v[28:31]
  v_mfma_f32_16x16x32_bf16 v[76:79], a[160:163], a[36:39], v[76:79]
  ds_read_b64_tr_b16 a[160:161], v123 offset:14336
  ds_read_b64_tr_b16 a[162:163], v123 offset:14848
  v_mfma_f32_16x16x32_bf16 v[32:35], a[32:35], a[164:167], v[32:35]
  v_mfma_f32_16x16x32_bf16 v[80:83], a[36:39], a[164:167], v[80:83]
  ds_read_b64_tr_b16 a[164:165], v120 offset:15360
  ds_read_b64_tr_b16 a[166:167], v120 offset:15872
  v_mfma_f32_16x16x32_bf16 v[36:39], a[32:35], a[168:171], v[36:39]
  v_mfma_f32_16x16x32_bf16 v[84:87], a[36:39], a[168:171], v[84:87]
  ds_read_b64_tr_b16 a[168:169], v121 offset:15360
  ds_read_b64_tr_b16 a[170:171], v121 offset:15872
  v_mfma_f32_16x16x32_bf16 v[40:43], a[32:35], a[172:175], v[40:43]
  v_mfma_f32_16x16x32_bf16 v[88:91], a[36:39], a[172:175], v[88:91]
  ds_read_b64_tr_b16 a[172:173], v122 offset:15360
  ds_read_b64_tr_b16 a[174:175], v122 offset:15872
  v_mfma_f32_16x16x32_bf16 v[44:47], a[32:35], a[176:179], v[44:47]
  v_mfma_f32_16x16x32_bf16 v[92:95], a[36:39], a[176:179], v[92:95]
  s_waitcnt vmcnt(22) lgkmcnt(10)
  s_barrier
  v_mfma_f32_16x16x32_bf16 v[96:99], a[180:183], a[188:191], v[96:99]
  ds_read_b64_tr_b16 a[176:177], v123 offset:15360
  s_add_u32 m0, s38, 13312
  v_mfma_f32_16x16x32_bf16 v[100:103], a[188:191], a[184:187], v[100:103]
  buffer_load_dwordx4 v107, s[8:11], s17 offen lds
  v_mfma_f32_16x16x32_bf16 v[0:3], a[132:135], a[40:43], v[0:3]
  ds_read_b64_tr_b16 a[178:179], v123 offset:15872
  buffer_load_dwordx4 v108, s[8:11], s17 offen offset:1024 lds
  v_mfma_f32_16x16x32_bf16 v[48:51], a[132:135], a[44:47], v[48:51]
  ds_read_b64_tr_b16 a[180:181], v124 offset:27648
  ds_read_b64_tr_b16 a[182:183], v124 offset:28160
  buffer_load_dwordx4 v109, s[8:11], s17 offen offset:2048 lds
  v_mfma_f32_16x16x32_bf16 v[4:7], a[136:139], a[40:43], v[4:7]
  ds_read_b128 a[188:191], v125 offset:38912
  ds_read_b64_tr_b16 a[184:185], v124 offset:28672
  ds_read_b64_tr_b16 a[186:187], v124 offset:29184
  v_mfma_f32_16x16x32_bf16 v[52:55], a[136:139], a[44:47], v[52:55]
  ds_read_b64_tr_b16 a[132:133], v120 offset:26624
  s_add_u32 s17, s17, 196608
  v_mfma_f32_16x16x32_bf16 v[8:11], a[140:143], a[40:43], v[8:11]
  ds_read_b64_tr_b16 a[134:135], v120 offset:27136
  s_cmp_eq_u32 s17, s10
  v_mfma_f32_16x16x32_bf16 v[56:59], a[140:143], a[44:47], v[56:59]
  ds_read_b64_tr_b16 a[136:137], v121 offset:26624
  s_cselect_b32 s17, 0, s17
  v_mfma_f32_16x16x32_bf16 v[12:15], a[144:147], a[40:43], v[12:15]
  ds_read_b64_tr_b16 a[138:139], v121 offset:27136
  s_add_u32 m0, s38, 26624
  v_mfma_f32_16x16x32_bf16 v[60:63], a[144:147], a[44:47], v[60:63]
  ds_read_b64_tr_b16 a[140:141], v122 offset:26624
  ds_read_b64_tr_b16 a[142:143], v122 offset:27136
  v_mfma_f32_16x16x32_bf16 v[16:19], a[148:151], a[40:43], v[16:19]
  buffer_load_dwordx4 v107, s[8:11], s17 offen lds
  v_mfma_f32_16x16x32_bf16 v[64:67], a[148:151], a[44:47], v[64:67]
  buffer_load_dwordx4 v108, s[8:11], s17 offen offset:1024 lds
  v_mfma_f32_16x16x32_bf16 v[20:23], a[152:155], a[40:43], v[20:23]
  ds_read_b64_tr_b16 a[144:145], v123 offset:26624
  ds_read_b64_tr_b16 a[146:147], v123 offset:27136
  buffer_load_dwordx4 v109, s[8:11], s17 offen offset:2048 lds
  v_mfma_f32_16x16x32_bf16 v[68:71], a[152:155], a[44:47], v[68:71]
  ds_read_b64_tr_b16 a[148:149], v120 offset:27648
  s_add_u32 s17, s17, 196608
  s_waitcnt lgkmcnt(10)
  v_mfma_f32_16x16x32_bf16 v[24:27], a[156:159], a[40:43], v[24:27]
  ds_read_b64_tr_b16 a[150:151], v120 offset:28160
  ds_read_b64_tr_b16 a[152:153], v121 offset:27648
  v_mfma_f32_16x16x32_bf16 v[72:75], a[156:159], a[44:47], v[72:75]
  ds_read_b64_tr_b16 a[154:155], v121 offset:28160
  s_cmp_eq_u32 s17, s10
  v_mfma_f32_16x16x32_bf16 v[28:31], a[160:163], a[40:43], v[28:31]
  ds_read_b64_tr_b16 a[156:157], v122 offset:27648
  s_cselect_b32 s17, 0, s17
  v_mfma_f32_16x16x32_bf16 v[76:79], a[160:163], a[44:47], v[76:79]
  ds_read_b64_tr_b16 a[158:159], v122 offset:28160
  s_add_u32 m0, s39, 26624
  v_mfma_f32_16x16x32_bf16 v[32:35], a[40:43], a[164:167], v[32:35]
  buffer_load_dword v106, s[4:7], s16 offen sc1 lds
  v_mfma_f32_16x16x32_bf16 v[80:83], a[44:47], a[164:167], v[80:83]
  ds_read_b64_tr_b16 a[160:161], v123 offset:27648
  ds_read_b64_tr_b16 a[162:163], v123 offset:28160
  v_mfma_f32_16x16x32_bf16 v[36:39], a[40:43], a[168:171], v[36:39]
  buffer_load_dwordx4 a[16:19], v105, s[4:7], s16 offen sc1
  v_mfma_f32_16x16x32_bf16 v[84:87], a[44:47], a[168:171], v[84:87]
  buffer_load_dwordx4 a[20:23], v105, s[4:7], s16 offen offset:1024 sc1
  v_mfma_f32_16x16x32_bf16 v[40:43], a[40:43], a[172:175], v[40:43]
  ds_read_b64_tr_b16 a[164:165], v120 offset:28672
  ds_read_b64_tr_b16 a[166:167], v120 offset:29184
  s_add_u32 s16, s16, 131072
  v_mfma_f32_16x16x32_bf16 v[88:91], a[44:47], a[172:175], v[88:91]
  ds_read_b64_tr_b16 a[168:169], v121 offset:28672
  s_bitset0_b32 s16, 20
  v_mfma_f32_16x16x32_bf16 v[44:47], a[40:43], a[176:179], v[44:47]
  ds_read_b64_tr_b16 a[170:171], v121 offset:29184
  ds_read_b64_tr_b16 a[172:173], v122 offset:28672
  v_mfma_f32_16x16x32_bf16 v[92:95], a[44:47], a[176:179], v[92:95]
  s_waitcnt vmcnt(10) lgkmcnt(10)
  s_barrier
  v_mfma_f32_16x16x32_bf16 v[96:99], a[180:183], a[188:191], v[96:99]
  ds_read_b64_tr_b16 a[174:175], v122 offset:29184
  s_add_u32 m0, s38, 39936
  v_mfma_f32_16x16x32_bf16 v[100:103], a[188:191], a[184:187], v[100:103]
  ds_read_b64_tr_b16 a[64:65], v196 offset:0
  buffer_load_dwordx4 v107, s[8:11], s17 offen lds
  v_mfma_f32_16x16x32_bf16 v[0:3], a[132:135], a[48:51], v[0:3]
  ds_read_b64_tr_b16 a[176:177], v123 offset:28672
  ds_read_b64_tr_b16 a[178:179], v123 offset:29184
  buffer_load_dwordx4 v108, s[8:11], s17 offen offset:1024 lds
  v_mfma_f32_16x16x32_bf16 v[48:51], a[132:135], a[52:55], v[48:51]
  ds_read_b64_tr_b16 a[180:181], v124 offset:40960
  ds_read_b64_tr_b16 a[182:183], v124 offset:41472
  ds_read_b64_tr_b16 a[66:67], v196 offset:512
  buffer_load_dwordx4 v109, s[8:11], s17 offen offset:2048 lds
  v_mfma_f32_16x16x32_bf16 v[4:7], a[136:139], a[48:51], v[4:7]
  ds_read_b128 a[188:191], v125 offset:52224
  ds_read_b64_tr_b16 a[184:185], v124 offset:41984
  ds_read_b64_tr_b16 a[186:187], v124 offset:42496
  s_add_u32 s17, s17, 196608
  v_mfma_f32_16x16x32_bf16 v[52:55], a[136:139], a[52:55], v[52:55]
  ds_read_b128 a[68:71], v197 offset:0
  s_cmp_eq_u32 s17, s10
  v_mfma_f32_16x16x32_bf16 v[8:11], a[140:143], a[48:51], v[8:11]
  ds_read_b64_tr_b16 a[132:133], v120 offset:39936
  ds_read_b64_tr_b16 a[134:135], v120 offset:40448
  s_cselect_b32 s17, 0, s17
  v_mfma_f32_16x16x32_bf16 v[56:59], a[140:143], a[52:55], v[56:59]
  ds_read_b64_tr_b16 a[72:73], v196 offset:4096
  s_add_u32 m0, s39, 39936
  v_mfma_f32_16x16x32_bf16 v[12:15], a[144:147], a[48:51], v[12:15]
  ds_read_b64_tr_b16 a[136:137], v121 offset:39936
  ds_read_b64_tr_b16 a[138:139], v121 offset:40448
  buffer_load_dword v106, s[4:7], s16 offen sc1 lds
  v_mfma_f32_16x16x32_bf16 v[60:63], a[144:147], a[52:55], v[60:63]
  ds_read_b64_tr_b16 a[74:75], v196 offset:4608
  buffer_load_dwordx4 a[24:27], v105, s[4:7], s16 offen sc1
  v_mfma_f32_16x16x32_bf16 v[16:19], a[148:151], a[48:51], v[16:19]
  ds_read_b64_tr_b16 a[140:141], v122 offset:39936
  ds_read_b64_tr_b16 a[142:143], v122 offset:40448
  buffer_load_dwordx4 a[28:31], v105, s[4:7], s16 offen offset:1024 sc1
  v_mfma_f32_16x16x32_bf16 v[64:67], a[148:151], a[52:55], v[64:67]
  ds_read_b128 a[76:79], v197 offset:64
  s_add_u32 s16, s16, 131072
  s_waitcnt lgkmcnt(10)
  v_mfma_f32_16x16x32_bf16 v[20:23], a[152:155], a[48:51], v[20:23]
  ds_read_b64_tr_b16 a[144:145], v123 offset:39936
  ds_read_b64_tr_b16 a[146:147], v123 offset:40448
  s_bitset0_b32 s16, 20
  v_mfma_f32_16x16x32_bf16 v[68:71], a[152:155], a[52:55], v[68:71]
  ds_read_b64_tr_b16 a[80:81], v196 offset:8192
  s_add_u32 m0, s38, 53248
  v_mfma_f32_16x16x32_bf16 v[24:27], a[156:159], a[48:51], v[24:27]
  ds_read_b64_tr_b16 a[148:149], v120 offset:40960
  ds_read_b64_tr_b16 a[150:151], v120 offset:41472
  buffer_load_dwordx4 v107, s[8:11], s17 offen lds
  v_mfma_f32_16x16x32_bf16 v[72:75], a[156:159], a[52:55], v[72:75]
  ds_read_b64_tr_b16 a[82:83], v196 offset:8704
  buffer_load_dwordx4 v108, s[8:11], s17 offen offset:1024 lds
  v_mfma_f32_16x16x32_bf16 v[28:31], a[160:163], a[48:51], v[28:31]
  ds_read_b64_tr_b16 a[152:153], v121 offset:40960
  ds_read_b64_tr_b16 a[154:155], v121 offset:41472
  buffer_load_dwordx4 v109, s[8:11], s17 offen offset:2048 lds
  v_mfma_f32_16x16x32_bf16 v[76:79], a[160:163], a[52:55], v[76:79]
  ds_read_b128 a[84:87], v197 offset:128
  s_add_u32 s17, s17, 196608
  v_mfma_f32_16x16x32_bf16 v[32:35], a[48:51], a[164:167], v[32:35]
  ds_read_b64_tr_b16 a[156:157], v122 offset:40960
  ds_read_b64_tr_b16 a[158:159], v122 offset:41472
  s_cmp_eq_u32 s17, s10
  v_mfma_f32_16x16x32_bf16 v[80:83], a[52:55], a[164:167], v[80:83]
  ds_read_b64_tr_b16 a[88:89], v196 offset:12288
  s_cselect_b32 s17, 0, s17
  v_mfma_f32_16x16x32_bf16 v[36:39], a[48:51], a[168:171], v[36:39]
  ds_read_b64_tr_b16 a[160:161], v123 offset:40960
  ds_read_b64_tr_b16 a[162:163], v123 offset:41472
  s_mov_b32 s52, s24
  v_mfma_f32_16x16x32_bf16 v[84:87], a[52:55], a[168:171], v[84:87]
  ds_read_b64_tr_b16 a[90:91], v196 offset:12800
  s_mov_b32 s53, s25
  v_mfma_f32_16x16x32_bf16 v[40:43], a[48:51], a[172:175], v[40:43]
  ds_read_b64_tr_b16 a[164:165], v120 offset:41984
  ds_read_b64_tr_b16 a[166:167], v120 offset:42496
  s_mov_b32 s54, 0x200000
  v_mfma_f32_16x16x32_bf16 v[88:91], a[52:55], a[172:175], v[88:91]
  ds_read_b128 a[92:95], v197 offset:192
  s_mov_b32 s55, 0x20000
  v_mfma_f32_16x16x32_bf16 v[44:47], a[48:51], a[176:179], v[44:47]
  ds_read_b64_tr_b16 a[168:169], v121 offset:41984
  ds_read_b64_tr_b16 a[170:171], v121 offset:42496
  s_lshl_b32 s51, s3, 11
  v_mfma_f32_16x16x32_bf16 v[92:95], a[52:55], a[176:179], v[92:95]
  s_waitcnt vmcnt(24) lgkmcnt(10)
  s_barrier
  v_mfma_f32_16x16x32_bf16 v[96:99], a[180:183], a[188:191], v[96:99]
  ds_read_b64_tr_b16 a[172:173], v122 offset:41984
  ds_read_b64_tr_b16 a[174:175], v122 offset:42496
  s_add_u32 m0, s39, 53248
  v_mfma_f32_16x16x32_bf16 v[100:103], a[188:191], a[184:187], v[100:103]
  ds_read_b64_tr_b16 a[96:97], v196 offset:16384
  buffer_load_dword v106, s[4:7], s16 offen sc1 lds
  v_mfma_f32_16x16x32_bf16 v[0:3], a[132:135], a[56:59], v[0:3]
  ds_read_b64_tr_b16 a[176:177], v123 offset:41984
  ds_read_b64_tr_b16 a[178:179], v123 offset:42496
  v_mfma_f32_16x16x32_bf16 v[192:195], a[64:67], a[68:71], 0
  buffer_load_dwordx4 a[32:35], v105, s[4:7], s16 offen sc1
  v_mfma_f32_16x16x32_bf16 v[48:51], a[132:135], a[60:63], v[48:51]
  ds_read_b64_tr_b16 a[180:181], v118 offset:1024
  ds_read_b64_tr_b16 a[182:183], v118 offset:1536
  ds_read_b64_tr_b16 a[98:99], v196 offset:16896
  v_mfma_f32_16x16x32_bf16 v[4:7], a[136:139], a[56:59], v[4:7]
  ds_read_b128 a[188:191], v119 offset:12288
  ds_read_b64_tr_b16 a[184:185], v118 offset:2048
  ds_read_b64_tr_b16 a[186:187], v118 offset:2560
  buffer_load_dwordx4 a[36:39], v105, s[4:7], s16 offen offset:1024 sc1
  v_mfma_f32_16x16x32_bf16 v[52:55], a[136:139], a[60:63], v[52:55]
  ds_read_b128 a[100:103], v197 offset:256
  s_add_u32 s16, s16, 131072
  v_mfma_f32_16x16x32_bf16 v[8:11], a[140:143], a[56:59], v[8:11]
  ds_read_b64_tr_b16 a[132:133], v114 offset:0
  ds_read_b64_tr_b16 a[134:135], v114 offset:512
  s_bitset0_b32 s16, 20
  v_mfma_f32_16x16x32_bf16 v[56:59], a[140:143], a[60:63], v[56:59]
  ds_read_b64_tr_b16 a[104:105], v196 offset:20480
  s_add_u32 m0, s38, 66560
  v_mfma_f32_16x16x32_bf16 v[12:15], a[144:147], a[56:59], v[12:15]
  ds_read_b64_tr_b16 a[136:137], v115 offset:0
  ds_read_b64_tr_b16 a[138:139], v115 offset:512
  v_mfma_f32_16x16x32_bf16 v[192:195], a[72:75], a[76:79], v[192:195]
  v_mfma_f32_16x16x32_bf16 v[60:63], a[144:147], a[60:63], v[60:63]
  ds_read_b64_tr_b16 a[106:107], v196 offset:20992
  buffer_load_dwordx4 v107, s[8:11], s17 offen lds
  v_mfma_f32_16x16x32_bf16 v[16:19], a[148:151], a[56:59], v[16:19]
  ds_read_b64_tr_b16 a[140:141], v116 offset:0
  ds_read_b64_tr_b16 a[142:143], v116 offset:512
  buffer_load_dwordx4 v108, s[8:11], s17 offen offset:1024 lds
  v_mfma_f32_16x16x32_bf16 v[64:67], a[148:151], a[60:63], v[64:67]
  ds_read_b64_tr_b16 a[144:145], v117 offset:0
  ds_read_b128 a[108:111], v197 offset:320
  v_mfma_f32_16x16x32_bf16 v[20:23], a[152:155], a[56:59], v[20:23]
  ds_read_b64_tr_b16 a[146:147], v117 offset:512
  buffer_load_dwordx4 v109, s[8:11], s17 offen offset:2048 lds
  v_mfma_f32_16x16x32_bf16 v[68:71], a[152:155], a[60:63], v[68:71]
  ds_read_b64_tr_b16 a[112:113], v196 offset:24576
  s_add_u32 s17, s17, 196608
  s_waitcnt lgkmcnt(10)
  v_mfma_f32_16x16x32_bf16 v[24:27], a[156:159], a[56:59], v[24:27]
  ds_read_b64_tr_b16 a[148:149], v114 offset:1024
  ds_read_b64_tr_b16 a[150:151], v114 offset:1536
  v_mfma_f32_16x16x32_bf16 v[192:195], a[80:83], a[84:87], v[192:195]
  s_cmp_eq_u32 s17, s10
  v_mfma_f32_16x16x32_bf16 v[72:75], a[156:159], a[60:63], v[72:75]
  ds_read_b64_tr_b16 a[152:153], v115 offset:1024
  ds_read_b64_tr_b16 a[114:115], v196 offset:25088
  v_mfma_f32_16x16x32_bf16 v[28:31], a[160:163], a[56:59], v[28:31]
  ds_read_b64_tr_b16 a[154:155], v115 offset:1536
  s_cselect_b32 s17, 0, s17
  v_mfma_f32_16x16x32_bf16 v[76:79], a[160:163], a[60:63], v[76:79]
  ds_read_b128 a[116:119], v197 offset:384
  s_add_u32 m0, s39, 66560
  v_mfma_f32_16x16x32_bf16 v[32:35], a[56:59], a[164:167], v[32:35]
  ds_read_b64_tr_b16 a[156:157], v116 offset:1024
  ds_read_b64_tr_b16 a[158:159], v116 offset:1536
  buffer_load_dword v106, s[4:7], s16 offen sc1 lds
  v_mfma_f32_16x16x32_bf16 v[80:83], a[60:63], a[164:167], v[80:83]
  ds_read_b64_tr_b16 a[120:121], v196 offset:28672
  buffer_load_dwordx4 a[40:43], v105, s[4:7], s16 offen sc1
  v_mfma_f32_16x16x32_bf16 v[36:39], a[56:59], a[168:171], v[36:39]
  ds_read_b64_tr_b16 a[160:161], v117 offset:1024
  ds_read_b64_tr_b16 a[162:163], v117 offset:1536
  v_mfma_f32_16x16x32_bf16 v[192:195], a[88:91], a[92:95], v[192:195]
  v_mfma_f32_16x16x32_bf16 v[84:87], a[60:63], a[168:171], v[84:87]
  ds_read_b64_tr_b16 a[122:123], v196 offset:29184
  buffer_load_dwordx4 a[44:47], v105, s[4:7], s16 offen offset:1024 sc1
  v_mfma_f32_16x16x32_bf16 v[40:43], a[56:59], a[172:175], v[40:43]
  ds_read_b64_tr_b16 a[164:165], v114 offset:2048
  ds_read_b64_tr_b16 a[166:167], v114 offset:2560
  s_add_u32 s16, s16, 131072
  v_mfma_f32_16x16x32_bf16 v[88:91], a[60:63], a[172:175], v[88:91]
  ds_read_b64_tr_b16 a[168:169], v115 offset:2048
  ds_read_b128 a[124:127], v197 offset:448
  v_mfma_f32_16x16x32_bf16 v[44:47], a[56:59], a[176:179], v[44:47]
  ds_read_b64_tr_b16 a[170:171], v115 offset:2560
  s_bitset0_b32 s16, 20
  v_mfma_f32_16x16x32_bf16 v[92:95], a[60:63], a[176:179], v[92:95]
  s_waitcnt vmcnt(24) lgkmcnt(10)
  s_barrier
  v_mfma_f32_16x16x32_bf16 v[96:99], a[180:183], a[188:191], v[96:99]
  ds_read_b64_tr_b16 a[172:173], v116 offset:2048
  ds_read_b64_tr_b16 a[174:175], v116 offset:2560
  s_add_u32 m0, s38, 79872
  v_mfma_f32_16x16x32_bf16 v[100:103], a[188:191], a[184:187], v[100:103]
  buffer_load_dwordx4 v107, s[8:11], s17 offen lds
  v_mfma_f32_16x16x32_bf16 v[0:3], a[132:135], a[0:3], v[0:3]
  ds_read_b64_tr_b16 a[176:177], v117 offset:2048
  ds_read_b64_tr_b16 a[178:179], v117 offset:2560
  v_mfma_f32_16x16x32_bf16 v[192:195], a[96:99], a[100:103], v[192:195]
  buffer_load_dwordx4 v108, s[8:11], s17 offen offset:1024 lds
  v_mfma_f32_16x16x32_bf16 v[48:51], a[132:135], a[4:7], v[48:51]
  ds_read_b64_tr_b16 a[180:181], v118 offset:14336
  ds_read_b64_tr_b16 a[182:183], v118 offset:14848
  buffer_load_dwordx4 v109, s[8:11], s17 offen offset:2048 lds
  v_mfma_f32_16x16x32_bf16 v[4:7], a[136:139], a[0:3], v[4:7]
  ds_read_b128 a[188:191], v119 offset:25600
  ds_read_b64_tr_b16 a[184:185], v118 offset:15360
  ds_read_b64_tr_b16 a[186:187], v118 offset:15872
  s_add_u32 s17, s17, 196608
  v_mfma_f32_16x16x32_bf16 v[52:55], a[136:139], a[4:7], v[52:55]
  ds_read_b64_tr_b16 a[132:133], v114 offset:13312
  s_cmp_eq_u32 s17, s10
  v_mfma_f32_16x16x32_bf16 v[8:11], a[140:143], a[0:3], v[8:11]
  ds_read_b64_tr_b16 a[134:135], v114 offset:13824
  s_cselect_b32 s17, 0, s17
  v_mfma_f32_16x16x32_bf16 v[56:59], a[140:143], a[4:7], v[56:59]
  ds_read_b64_tr_b16 a[136:137], v115 offset:13312
  s_add_u32 m0, s39, 79872
  v_mfma_f32_16x16x32_bf16 v[12:15], a[144:147], a[0:3], v[12:15]
  ds_read_b64_tr_b16 a[138:139], v115 offset:13824
  v_mfma_f32_16x16x32_bf16 v[192:195], a[104:107], a[108:111], v[192:195]
  v_mfma_f32_16x16x32_bf16 v[60:63], a[144:147], a[4:7], v[60:63]
  buffer_load_dword v106, s[4:7], s16 offen sc1 lds
  v_mfma_f32_16x16x32_bf16 v[16:19], a[148:151], a[0:3], v[16:19]
  ds_read_b64_tr_b16 a[140:141], v116 offset:13312
  ds_read_b64_tr_b16 a[142:143], v116 offset:13824
  buffer_load_dwordx4 a[48:51], v105, s[4:7], s16 offen sc1
  v_mfma_f32_16x16x32_bf16 v[64:67], a[148:151], a[4:7], v[64:67]
  buffer_load_dwordx4 a[52:55], v105, s[4:7], s16 offen offset:1024 sc1
  v_mfma_f32_16x16x32_bf16 v[20:23], a[152:155], a[0:3], v[20:23]
  ds_read_b64_tr_b16 a[144:145], v117 offset:13312
  ds_read_b64_tr_b16 a[146:147], v117 offset:13824
  s_add_u32 s16, s16, 131072
  v_mfma_f32_16x16x32_bf16 v[68:71], a[152:155], a[4:7], v[68:71]
  ds_read_b64_tr_b16 a[148:149], v114 offset:14336
  s_bitset0_b32 s16, 20
  s_waitcnt lgkmcnt(10)
  v_mfma_f32_16x16x32_bf16 v[24:27], a[156:159], a[0:3], v[24:27]
  ds_read_b64_tr_b16 a[150:151], v114 offset:14848
  v_mfma_f32_16x16x32_bf16 v[192:195], a[112:115], a[116:119], v[192:195]
  s_add_u32 m0, s38, 93184
  v_mfma_f32_16x16x32_bf16 v[72:75], a[156:159], a[4:7], v[72:75]
  buffer_load_dwordx4 v107, s[8:11], s17 offen lds
  v_mfma_f32_16x16x32_bf16 v[28:31], a[160:163], a[0:3], v[28:31]
  ds_read_b64_tr_b16 a[152:153], v115 offset:14336
  ds_read_b64_tr_b16 a[154:155], v115 offset:14848
  v_mfma_f32_16x16x32_bf16 v[76:79], a[160:163], a[4:7], v[76:79]
  buffer_load_dwordx4 v108, s[8:11], s17 offen offset:1024 lds
  v_mfma_f32_16x16x32_bf16 v[32:35], a[0:3], a[164:167], v[32:35]
  ds_read_b64_tr_b16 a[156:157], v116 offset:14336
  ds_read_b64_tr_b16 a[158:159], v116 offset:14848
  buffer_load_dwordx4 v109, s[8:11], s17 offen offset:2048 lds
  v_mfma_f32_16x16x32_bf16 v[80:83], a[4:7], a[164:167], v[80:83]
  ds_read_b64_tr_b16 a[160:161], v117 offset:14336
  s_add_u32 s17, s17, 196608
  v_mfma_f32_16x16x32_bf16 v[36:39], a[0:3], a[168:171], v[36:39]
  ds_read_b64_tr_b16 a[162:163], v117 offset:14848
  v_mfma_f32_16x16x32_bf16 v[192:195], a[120:123], a[124:127], v[192:195]
  s_cmp_eq_u32 s17, s10
  v_mfma_f32_16x16x32_bf16 v[84:87], a[4:7], a[168:171], v[84:87]
  ds_read_b64_tr_b16 a[164:165], v114 offset:15360
  s_cselect_b32 s17, 0, s17
  v_mfma_f32_16x16x32_bf16 v[40:43], a[0:3], a[172:175], v[40:43]
  ds_read_b64_tr_b16 a[166:167], v114 offset:15872
  s_add_u32 s8, s8, s10
  s_addc_u32 s9, s9, 0
  v_mfma_f32_16x16x32_bf16 v[88:91], a[4:7], a[172:175], v[88:91]
  buffer_store_dwordx4 v[244:247], v119, s[92:95], s35 offen offset:3072 sc1
  v_mfma_f32_16x16x32_bf16 v[44:47], a[0:3], a[176:179], v[44:47]
  ds_read_b64_tr_b16 a[168:169], v115 offset:15360
  ds_read_b64_tr_b16 a[170:171], v115 offset:15872
  v_mfma_f32_16x16x32_bf16 v[92:95], a[4:7], a[176:179], v[92:95]
  s_waitcnt vmcnt(28) lgkmcnt(10)
  s_barrier
  v_mfma_f32_16x16x32_bf16 v[96:99], a[180:183], a[188:191], v[96:99]
  ds_read_b64_tr_b16 a[172:173], v116 offset:15360
  ds_read_b64_tr_b16 a[174:175], v116 offset:15872
  s_add_u32 m0, s39, 93184
  v_mfma_f32_16x16x32_bf16 v[100:103], a[188:191], a[184:187], v[100:103]
  buffer_load_dword v106, s[4:7], s16 offen sc1 lds
  v_mfma_f32_16x16x32_bf16 v[0:3], a[132:135], a[8:11], v[0:3]
  ds_read_b64_tr_b16 a[176:177], v117 offset:15360
  ds_read_b64_tr_b16 a[178:179], v117 offset:15872
  v_mfma_f32_16x16x32_bf16 v[48:51], a[132:135], a[12:15], v[48:51]
  ds_read_b64_tr_b16 a[180:181], v118 offset:27648
  ds_read_b64_tr_b16 a[182:183], v118 offset:28160
  buffer_load_dwordx4 a[56:59], v105, s[4:7], s16 offen sc1
  v_mfma_f32_16x16x32_bf16 v[4:7], a[136:139], a[8:11], v[4:7]
  ds_read_b128 a[188:191], v119 offset:38912
  ds_read_b64_tr_b16 a[184:185], v118 offset:28672
  ds_read_b64_tr_b16 a[186:187], v118 offset:29184
  v_mfma_f32_16x16x32_bf16 v[52:55], a[136:139], a[12:15], v[52:55]
  s_bfe_u32 s40, s19, 0x80000
  s_bfe_u32 s41, s19, 0x80008
  s_bfe_u32 s42, s19, 0x80010
  s_bfe_u32 s43, s19, 0x80018
  v_and_or_b32 v192, v192, v198, s40
  v_and_or_b32 v193, v193, v198, s41
  v_and_or_b32 v194, v194, v198, s42
  v_and_or_b32 v195, v195, v198, s43
  buffer_store_dwordx4 v[192:195], v255, s[12:15], s96 offen sc1
  v_mfma_f32_16x16x32_bf16 v[8:11], a[140:143], a[8:11], v[8:11]
  ds_read_b64_tr_b16 a[132:133], v114 offset:26624
  ds_read_b64_tr_b16 a[134:135], v114 offset:27136
  buffer_load_dwordx4 a[60:63], v105, s[4:7], s16 offen offset:1024 sc1
  v_mfma_f32_16x16x32_bf16 v[56:59], a[140:143], a[12:15], v[56:59]
  ds_read_b64_tr_b16 a[136:137], v115 offset:26624
  s_add_u32 s16, s16, 131072
  v_mfma_f32_16x16x32_bf16 v[12:15], a[144:147], a[8:11], v[12:15]
  ds_read_b64_tr_b16 a[138:139], v115 offset:27136
  ds_read_b64_tr_b16 a[140:141], v116 offset:26624
  v_mfma_f32_16x16x32_bf16 v[60:63], a[144:147], a[12:15], v[60:63]
  ds_read_b64_tr_b16 a[142:143], v116 offset:27136
  s_bitset0_b32 s16, 20
  v_mfma_f32_16x16x32_bf16 v[16:19], a[148:151], a[8:11], v[16:19]
  ds_read_b64_tr_b16 a[144:145], v117 offset:26624
  ds_read_b64_tr_b16 a[146:147], v117 offset:27136
  v_mfma_f32_16x16x32_bf16 v[64:67], a[148:151], a[12:15], v[64:67]
  s_add_u32 s4, s4, s6
  s_addc_u32 s5, s5, 0
  s_waitcnt lgkmcnt(10)
  v_mfma_f32_16x16x32_bf16 v[20:23], a[152:155], a[8:11], v[20:23]
  ds_read_b64_tr_b16 a[148:149], v114 offset:27648
  ds_read_b64_tr_b16 a[150:151], v114 offset:28160
  v_mfma_f32_16x16x32_bf16 v[68:71], a[152:155], a[12:15], v[68:71]
  ds_read_b64_tr_b16 a[152:153], v115 offset:27648
  s_add_u32 m0, s39, 0
  v_mfma_f32_16x16x32_bf16 v[24:27], a[156:159], a[8:11], v[24:27]
  ds_read_b64_tr_b16 a[154:155], v115 offset:28160
  v_mfma_f32_16x16x32_bf16 v[72:75], a[156:159], a[12:15], v[72:75]
  buffer_load_dword v106, s[4:7], s16 offen sc1 lds
  v_mfma_f32_16x16x32_bf16 v[28:31], a[160:163], a[8:11], v[28:31]
  ds_read_b64_tr_b16 a[156:157], v116 offset:27648
  ds_read_b64_tr_b16 a[158:159], v116 offset:28160
  v_mfma_f32_16x16x32_bf16 v[76:79], a[160:163], a[12:15], v[76:79]
  buffer_load_dwordx4 a[0:3], v105, s[4:7], s16 offen sc1
  v_mfma_f32_16x16x32_bf16 v[32:35], a[8:11], a[164:167], v[32:35]
  ds_read_b64_tr_b16 a[160:161], v117 offset:27648
  ds_read_b64_tr_b16 a[162:163], v117 offset:28160
  v_mfma_f32_16x16x32_bf16 v[80:83], a[12:15], a[164:167], v[80:83]
  buffer_load_dwordx4 a[4:7], v105, s[4:7], s16 offen offset:1024 sc1
  v_mfma_f32_16x16x32_bf16 v[36:39], a[8:11], a[168:171], v[36:39]
  ds_read_b64_tr_b16 a[164:165], v114 offset:28672
  ds_read_b64_tr_b16 a[166:167], v114 offset:29184
  v_mfma_f32_16x16x32_bf16 v[84:87], a[12:15], a[168:171], v[84:87]
  ds_read_b64_tr_b16 a[168:169], v115 offset:28672
  s_add_u32 s16, s16, 131072
  v_mfma_f32_16x16x32_bf16 v[40:43], a[8:11], a[172:175], v[40:43]
  ds_read_b64_tr_b16 a[170:171], v115 offset:29184
  v_mfma_f32_16x16x32_bf16 v[88:91], a[12:15], a[172:175], v[88:91]
  ds_read_b64_tr_b16 a[172:173], v116 offset:28672
  s_bitset0_b32 s16, 20
  v_mfma_f32_16x16x32_bf16 v[44:47], a[8:11], a[176:179], v[44:47]
  ds_read_b64_tr_b16 a[174:175], v116 offset:29184
  v_mfma_f32_16x16x32_bf16 v[92:95], a[12:15], a[176:179], v[92:95]
  s_waitcnt vmcnt(29) lgkmcnt(10)
  s_barrier
  v_mfma_f32_16x16x32_bf16 v[96:99], a[180:183], a[188:191], v[96:99]
  ds_read_b64_tr_b16 a[176:177], v117 offset:28672
  s_add_u32 m0, s39, 13312
  v_mfma_f32_16x16x32_bf16 v[100:103], a[188:191], a[184:187], v[100:103]
  buffer_load_dword v106, s[4:7], s16 offen sc1 lds
  v_mfma_f32_16x16x32_bf16 v[0:3], a[132:135], a[16:19], v[0:3]
  ds_read_b64_tr_b16 a[178:179], v117 offset:29184
  buffer_load_dwordx4 a[8:11], v105, s[4:7], s16 offen sc1
  v_mfma_f32_16x16x32_bf16 v[48:51], a[132:135], a[20:23], v[48:51]
  ds_read_b64_tr_b16 a[180:181], v118 offset:40960
  ds_read_b64_tr_b16 a[182:183], v118 offset:41472
  buffer_load_dwordx4 a[12:15], v105, s[4:7], s16 offen offset:1024 sc1
  v_mfma_f32_16x16x32_bf16 v[4:7], a[136:139], a[16:19], v[4:7]
  ds_read_b128 a[188:191], v119 offset:52224
  ds_read_b64_tr_b16 a[184:185], v118 offset:41984
  ds_read_b64_tr_b16 a[186:187], v118 offset:42496
  v_mfma_f32_16x16x32_bf16 v[52:55], a[136:139], a[20:23], v[52:55]
  ds_read_b64_tr_b16 a[132:133], v114 offset:39936
  s_add_u32 s16, s16, 131072
  v_mfma_f32_16x16x32_bf16 v[8:11], a[140:143], a[16:19], v[8:11]
  ds_read_b64_tr_b16 a[134:135], v114 offset:40448
  s_bitset0_b32 s16, 20
  v_mfma_f32_16x16x32_bf16 v[56:59], a[140:143], a[20:23], v[56:59]
  ds_read_b64_tr_b16 a[136:137], v115 offset:39936
  s_add_u32 m0, s38, 0
  v_mfma_f32_16x16x32_bf16 v[12:15], a[144:147], a[16:19], v[12:15]
  ds_read_b64_tr_b16 a[138:139], v115 offset:40448
  ds_read_b64_tr_b16 a[140:141], v116 offset:39936
  v_mfma_f32_16x16x32_bf16 v[60:63], a[144:147], a[20:23], v[60:63]
  buffer_load_dwordx4 v107, s[8:11], s17 offen lds
  v_mfma_f32_16x16x32_bf16 v[16:19], a[148:151], a[16:19], v[16:19]
  ds_read_b64_tr_b16 a[142:143], v116 offset:40448
  buffer_load_dwordx4 v108, s[8:11], s17 offen offset:1024 lds
  v_mfma_f32_16x16x32_bf16 v[64:67], a[148:151], a[20:23], v[64:67]
  buffer_load_dwordx4 v109, s[8:11], s17 offen offset:2048 lds
  v_mfma_f32_16x16x32_bf16 v[20:23], a[152:155], a[16:19], v[20:23]
  ds_read_b64_tr_b16 a[144:145], v117 offset:39936
  ds_read_b64_tr_b16 a[146:147], v117 offset:40448
  v_mfma_f32_16x16x32_bf16 v[68:71], a[152:155], a[20:23], v[68:71]
  ds_read_b64_tr_b16 a[148:149], v114 offset:40960
  s_add_u32 s17, s17, 196608
  s_waitcnt lgkmcnt(10)
  v_mfma_f32_16x16x32_bf16 v[24:27], a[156:159], a[16:19], v[24:27]
  ds_read_b64_tr_b16 a[150:151], v114 offset:41472
  s_cmp_eq_u32 s17, s10
  v_mfma_f32_16x16x32_bf16 v[72:75], a[156:159], a[20:23], v[72:75]
  ds_read_b64_tr_b16 a[152:153], v115 offset:40960
  s_cselect_b32 s17, 0, s17
  v_mfma_f32_16x16x32_bf16 v[28:31], a[160:163], a[16:19], v[28:31]
  ds_read_b64_tr_b16 a[154:155], v115 offset:41472
  ds_read_b64_tr_b16 a[156:157], v116 offset:40960
  v_mfma_f32_16x16x32_bf16 v[76:79], a[160:163], a[20:23], v[76:79]
  buffer_load_dword v131, v130, s[56:59], s97 offen
  v_mfma_f32_16x16x32_bf16 v[32:35], a[16:19], a[164:167], v[32:35]
  ds_read_b64_tr_b16 a[158:159], v116 offset:41472
  s_add_u32 m0, s51, 106496
  v_mfma_f32_16x16x32_bf16 v[80:83], a[20:23], a[164:167], v[80:83]
  ds_read_b64_tr_b16 a[160:161], v117 offset:40960
  s_add_u32 s50, s98, 1703936
  v_mfma_f32_16x16x32_bf16 v[36:39], a[16:19], a[168:171], v[36:39]
  ds_read_b64_tr_b16 a[162:163], v117 offset:41472
  ds_read_b64_tr_b16 a[164:165], v114 offset:41984
  v_mfma_f32_16x16x32_bf16 v[84:87], a[20:23], a[168:171], v[84:87]
  ds_read_b64_tr_b16 a[166:167], v114 offset:42496
  s_bitset0_b32 s50, 21
  v_mfma_f32_16x16x32_bf16 v[40:43], a[16:19], a[172:175], v[40:43]
  buffer_load_dwordx4 v248, s[52:55], s50 offen lds
  v_mfma_f32_16x16x32_bf16 v[88:91], a[20:23], a[172:175], v[88:91]
  buffer_load_dwordx4 v249, s[52:55], s50 offen offset:1024 lds
  v_mfma_f32_16x16x32_bf16 v[44:47], a[16:19], a[176:179], v[44:47]
  ds_read_b64_tr_b16 a[168:169], v115 offset:41984
  ds_read_b64_tr_b16 a[170:171], v115 offset:42496
  v_mfma_f32_16x16x32_bf16 v[92:95], a[20:23], a[176:179], v[92:95]
  s_waitcnt vmcnt(32) lgkmcnt(10)
  s_barrier
  v_mfma_f32_16x16x32_bf16 v[96:99], a[180:183], a[188:191], v[96:99]
  ds_read_b64_tr_b16 a[172:173], v116 offset:41984
  ds_read_b64_tr_b16 a[174:175], v116 offset:42496
  v_mfma_f32_16x16x32_bf16 v[100:103], a[188:191], a[184:187], v[100:103]
  ds_read_b64_tr_b16 a[176:177], v117 offset:41984
  ds_read_b64_tr_b16 a[178:179], v117 offset:42496
  v_mfma_f32_16x16x32_bf16 v[0:3], a[132:135], a[24:27], v[0:3]
  ds_read_b64_tr_b16 a[180:181], v124 offset:1024
  ds_read_b64_tr_b16 a[182:183], v124 offset:1536
  v_mfma_f32_16x16x32_bf16 v[48:51], a[132:135], a[28:31], v[48:51]
  ds_read_b128 a[188:191], v125 offset:12288
  ds_read_b64_tr_b16 a[184:185], v124 offset:2048
  v_mfma_f32_16x16x32_bf16 v[4:7], a[136:139], a[24:27], v[4:7]
  ds_read_b64_tr_b16 a[186:187], v124 offset:2560
  ds_read_b64_tr_b16 a[132:133], v120 offset:0
  v_mfma_f32_16x16x32_bf16 v[52:55], a[136:139], a[28:31], v[52:55]
  ds_read_b64_tr_b16 a[134:135], v120 offset:512
  ds_read_b64_tr_b16 a[136:137], v121 offset:0
  v_mfma_f32_16x16x32_bf16 v[8:11], a[140:143], a[24:27], v[8:11]
  ds_read_b64_tr_b16 a[138:139], v121 offset:512
  v_mfma_f32_16x16x32_bf16 v[56:59], a[140:143], a[28:31], v[56:59]
  ds_read_b64_tr_b16 a[140:141], v122 offset:0
  ds_read_b64_tr_b16 a[142:143], v122 offset:512
  v_mfma_f32_16x16x32_bf16 v[12:15], a[144:147], a[24:27], v[12:15]
  v_mfma_f32_16x16x32_bf16 v[60:63], a[144:147], a[28:31], v[60:63]
  ds_read_b64_tr_b16 a[144:145], v123 offset:0
  ds_read_b64_tr_b16 a[146:147], v123 offset:512
  v_mfma_f32_16x16x32_bf16 v[16:19], a[148:151], a[24:27], v[16:19]
  v_mfma_f32_16x16x32_bf16 v[64:67], a[148:151], a[28:31], v[64:67]
  ds_read_b64_tr_b16 a[148:149], v120 offset:1024
  ds_read_b64_tr_b16 a[150:151], v120 offset:1536
  s_waitcnt lgkmcnt(10)
  v_mfma_f32_16x16x32_bf16 v[20:23], a[152:155], a[24:27], v[20:23]
  v_mfma_f32_16x16x32_bf16 v[68:71], a[152:155], a[28:31], v[68:71]
  ds_read_b64_tr_b16 a[152:153], v121 offset:1024
  ds_read_b64_tr_b16 a[154:155], v121 offset:1536
  v_mfma_f32_16x16x32_bf16 v[24:27], a[156:159], a[24:27], v[24:27]
  v_mfma_f32_16x16x32_bf16 v[72:75], a[156:159], a[28:31], v[72:75]
  ds_read_b64_tr_b16 a[156:157], v122 offset:1024
  ds_read_b64_tr_b16 a[158:159], v122 offset:1536
  v_mfma_f32_16x16x32_bf16 v[28:31], a[160:163], a[24:27], v[28:31]
  v_mfma_f32_16x16x32_bf16 v[76:79], a[160:163], a[28:31], v[76:79]
  ds_read_b64_tr_b16 a[160:161], v123 offset:1024
  ds_read_b64_tr_b16 a[162:163], v123 offset:1536
  v_mfma_f32_16x16x32_bf16 v[32:35], a[24:27], a[164:167], v[32:35]
  v_mfma_f32_16x16x32_bf16 v[80:83], a[28:31], a[164:167], v[80:83]
  ds_read_b64_tr_b16 a[164:165], v120 offset:2048
  ds_read_b64_tr_b16 a[166:167], v120 offset:2560
  v_mfma_f32_16x16x32_bf16 v[36:39], a[24:27], a[168:171], v[36:39]
  v_mfma_f32_16x16x32_bf16 v[84:87], a[28:31], a[168:171], v[84:87]
  ds_read_b64_tr_b16 a[168:169], v121 offset:2048
  ds_read_b64_tr_b16 a[170:171], v121 offset:2560
  v_mfma_f32_16x16x32_bf16 v[40:43], a[24:27], a[172:175], v[40:43]
  v_mfma_f32_16x16x32_bf16 v[88:91], a[28:31], a[172:175], v[88:91]
  ds_read_b64_tr_b16 a[172:173], v122 offset:2048
  ds_read_b64_tr_b16 a[174:175], v122 offset:2560
  v_mfma_f32_16x16x32_bf16 v[44:47], a[24:27], a[176:179], v[44:47]
  v_mfma_f32_16x16x32_bf16 v[92:95], a[28:31], a[176:179], v[92:95]
  s_waitcnt vmcnt(26) lgkmcnt(10)
  s_barrier
  v_mfma_f32_16x16x32_bf16 v[96:99], a[180:183], a[188:191], v[96:99]
  ds_read_b64_tr_b16 a[176:177], v123 offset:2048
  ds_read_b64_tr_b16 a[178:179], v123 offset:2560
  v_mfma_f32_16x16x32_bf16 v[100:103], a[188:191], a[184:187], v[100:103]
  ds_read_b64_tr_b16 a[180:181], v124 offset:14336
  ds_read_b64_tr_b16 a[182:183], v124 offset:14848
  v_mfma_f32_16x16x32_bf16 v[0:3], a[132:135], a[32:35], v[0:3]
  ds_read_b128 a[188:191], v125 offset:25600
  ds_read_b64_tr_b16 a[184:185], v124 offset:15360
  v_mfma_f32_16x16x32_bf16 v[48:51], a[132:135], a[36:39], v[48:51]
  ds_read_b64_tr_b16 a[186:187], v124 offset:15872
  ds_read_b64_tr_b16 a[132:133], v120 offset:13312
  v_mfma_f32_16x16x32_bf16 v[4:7], a[136:139], a[32:35], v[4:7]
  ds_read_b64_tr_b16 a[134:135], v120 offset:13824
  v_mfma_f32_16x16x32_bf16 v[52:55], a[136:139], a[36:39], v[52:55]
  ds_read_b64_tr_b16 a[136:137], v121 offset:13312
  ds_read_b64_tr_b16 a[138:139], v121 offset:13824
  v_mfma_f32_16x16x32_bf16 v[8:11], a[140:143], a[32:35], v[8:11]
  v_mfma_f32_16x16x32_bf16 v[56:59], a[140:143], a[36:39], v[56:59]
  ds_read_b64_tr_b16 a[140:141], v122 offset:13312
  ds_read_b64_tr_b16 a[142:143], v122 offset:13824
  v_mfma_f32_16x16x32_bf16 v[12:15], a[144:147], a[32:35], v[12:15]
  v_mfma_f32_16x16x32_bf16 v[60:63], a[144:147], a[36:39], v[60:63]
  ds_read_b64_tr_b16 a[144:145], v123 offset:13312
  ds_read_b64_tr_b16 a[146:147], v123 offset:13824
  v_mfma_f32_16x16x32_bf16 v[16:19], a[148:151], a[32:35], v[16:19]
  v_mfma_f32_16x16x32_bf16 v[64:67], a[148:151], a[36:39], v[64:67]
  ds_read_b64_tr_b16 a[148:149], v120 offset:14336
  ds_read_b64_tr_b16 a[150:151], v120 offset:14848
  v_mfma_f32_16x16x32_bf16 v[20:23], a[152:155], a[32:35], v[20:23]
  v_mfma_f32_16x16x32_bf16 v[68:71], a[152:155], a[36:39], v[68:71]
  ds_read_b64_tr_b16 a[152:153], v121 offset:14336
  ds_read_b64_tr_b16 a[154:155], v121 offset:14848
  s_waitcnt lgkmcnt(10)
  v_mfma_f32_16x16x32_bf16 v[24:27], a[156:159], a[32:35], v[24:27]
  v_mfma_f32_16x16x32_bf16 v[72:75], a[156:159], a[36:39], v[72:75]
  ds_read_b64_tr_b16 a[156:157], v122 offset:14336
  ds_read_b64_tr_b16 a[158:159], v122 offset:14848
  v_mfma_f32_16x16x32_bf16 v[28:31], a[160:163], a[32:35], v[28:31]
  v_mfma_f32_16x16x32_bf16 v[76:79], a[160:163], a[36:39], v[76:79]
  ds_read_b64_tr_b16 a[160:161], v123 offset:14336
  ds_read_b64_tr_b16 a[162:163], v123 offset:14848
  v_mfma_f32_16x16x32_bf16 v[32:35], a[32:35], a[164:167], v[32:35]
  v_mfma_f32_16x16x32_bf16 v[80:83], a[36:39], a[164:167], v[80:83]
  ds_read_b64_tr_b16 a[164:165], v120 offset:15360
  ds_read_b64_tr_b16 a[166:167], v120 offset:15872
  v_mfma_f32_16x16x32_bf16 v[36:39], a[32:35], a[168:171], v[36:39]
  v_mfma_f32_16x16x32_bf16 v[84:87], a[36:39], a[168:171], v[84:87]
  ds_read_b64_tr_b16 a[168:169], v121 offset:15360
  ds_read_b64_tr_b16 a[170:171], v121 offset:15872
  v_mfma_f32_16x16x32_bf16 v[40:43], a[32:35], a[172:175], v[40:43]
  v_mfma_f32_16x16x32_bf16 v[88:91], a[36:39], a[172:175], v[88:91]
  ds_read_b64_tr_b16 a[172:173], v122 offset:15360
  ds_read_b64_tr_b16 a[174:175], v122 offset:15872
  v_mfma_f32_16x16x32_bf16 v[44:47], a[32:35], a[176:179], v[44:47]
  v_mfma_f32_16x16x32_bf16 v[92:95], a[36:39], a[176:179], v[92:95]
  s_waitcnt vmcnt(20) lgkmcnt(10)
  s_barrier
  v_mfma_f32_16x16x32_bf16 v[96:99], a[180:183], a[188:191], v[96:99]
  ds_read_b64_tr_b16 a[176:177], v123 offset:15360
  s_add_u32 m0, s38, 13312
  v_mfma_f32_16x16x32_bf16 v[100:103], a[188:191], a[184:187], v[100:103]
  buffer_load_dwordx4 v107, s[8:11], s17 offen lds
  v_mfma_f32_16x16x32_bf16 v[0:3], a[132:135], a[40:43], v[0:3]
  ds_read_b64_tr_b16 a[178:179], v123 offset:15872
  buffer_load_dwordx4 v108, s[8:11], s17 offen offset:1024 lds
  v_mfma_f32_16x16x32_bf16 v[48:51], a[132:135], a[44:47], v[48:51]
  ds_read_b64_tr_b16 a[180:181], v124 offset:27648
  ds_read_b64_tr_b16 a[182:183], v124 offset:28160
  buffer_load_dwordx4 v109, s[8:11], s17 offen offset:2048 lds
  v_mfma_f32_16x16x32_bf16 v[4:7], a[136:139], a[40:43], v[4:7]
  ds_read_b128 a[188:191], v125 offset:38912
  ds_read_b64_tr_b16 a[184:185], v124 offset:28672
  ds_read_b64_tr_b16 a[186:187], v124 offset:29184
  v_mfma_f32_16x16x32_bf16 v[52:55], a[136:139], a[44:47], v[52:55]
  ds_read_b64_tr_b16 a[132:133], v120 offset:26624
  s_add_u32 s17, s17, 196608
  v_mfma_f32_16x16x32_bf16 v[8:11], a[140:143], a[40:43], v[8:11]
  ds_read_b64_tr_b16 a[134:135], v120 offset:27136
  s_cmp_eq_u32 s17, s10
  v_mfma_f32_16x16x32_bf16 v[56:59], a[140:143], a[44:47], v[56:59]
  ds_read_b64_tr_b16 a[136:137], v121 offset:26624
  s_cselect_b32 s17, 0, s17
  v_mfma_f32_16x16x32_bf16 v[12:15], a[144:147], a[40:43], v[12:15]
  ds_read_b64_tr_b16 a[138:139], v121 offset:27136
  s_add_u32 m0, s38, 26624
  v_mfma_f32_16x16x32_bf16 v[60:63], a[144:147], a[44:47], v[60:63]
  ds_read_b64_tr_b16 a[140:141], v122 offset:26624
  ds_read_b64_tr_b16 a[142:143], v122 offset:27136
  v_mfma_f32_16x16x32_bf16 v[16:19], a[148:151], a[40:43], v[16:19]
  buffer_load_dwordx4 v107, s[8:11], s17 offen lds
  v_mfma_f32_16x16x32_bf16 v[64:67], a[148:151], a[44:47], v[64:67]
  buffer_load_dwordx4 v108, s[8:11], s17 offen offset:1024 lds
  v_mfma_f32_16x16x32_bf16 v[20:23], a[152:155], a[40:43], v[20:23]
  ds_read_b64_tr_b16 a[144:145], v123 offset:26624
  ds_read_b64_tr_b16 a[146:147], v123 offset:27136
  buffer_load_dwordx4 v109, s[8:11], s17 offen offset:2048 lds
  v_mfma_f32_16x16x32_bf16 v[68:71], a[152:155], a[44:47], v[68:71]
  ds_read_b64_tr_b16 a[148:149], v120 offset:27648
  s_add_u32 s17, s17, 196608
  s_waitcnt lgkmcnt(10)
  v_mfma_f32_16x16x32_bf16 v[24:27], a[156:159], a[40:43], v[24:27]
  ds_read_b64_tr_b16 a[150:151], v120 offset:28160
  ds_read_b64_tr_b16 a[152:153], v121 offset:27648
  v_mfma_f32_16x16x32_bf16 v[72:75], a[156:159], a[44:47], v[72:75]
  ds_read_b64_tr_b16 a[154:155], v121 offset:28160
  s_cmp_eq_u32 s17, s10
  v_mfma_f32_16x16x32_bf16 v[28:31], a[160:163], a[40:43], v[28:31]
  ds_read_b64_tr_b16 a[156:157], v122 offset:27648
  s_cselect_b32 s17, 0, s17
  v_mfma_f32_16x16x32_bf16 v[76:79], a[160:163], a[44:47], v[76:79]
  ds_read_b64_tr_b16 a[158:159], v122 offset:28160
  s_add_u32 m0, s39, 26624
  v_mfma_f32_16x16x32_bf16 v[32:35], a[40:43], a[164:167], v[32:35]
  buffer_load_dword v106, s[4:7], s16 offen sc1 lds
  v_mfma_f32_16x16x32_bf16 v[80:83], a[44:47], a[164:167], v[80:83]
  ds_read_b64_tr_b16 a[160:161], v123 offset:27648
  ds_read_b64_tr_b16 a[162:163], v123 offset:28160
  v_mfma_f32_16x16x32_bf16 v[36:39], a[40:43], a[168:171], v[36:39]
  buffer_load_dwordx4 a[16:19], v105, s[4:7], s16 offen sc1
  v_mfma_f32_16x16x32_bf16 v[84:87], a[44:47], a[168:171], v[84:87]
  buffer_load_dwordx4 a[20:23], v105, s[4:7], s16 offen offset:1024 sc1
  v_mfma_f32_16x16x32_bf16 v[40:43], a[40:43], a[172:175], v[40:43]
  ds_read_b64_tr_b16 a[164:165], v120 offset:28672
  ds_read_b64_tr_b16 a[166:167], v120 offset:29184
  s_add_u32 s16, s16, 131072
  v_mfma_f32_16x16x32_bf16 v[88:91], a[44:47], a[172:175], v[88:91]
  ds_read_b64_tr_b16 a[168:169], v121 offset:28672
  s_bitset0_b32 s16, 20
  v_mfma_f32_16x16x32_bf16 v[44:47], a[40:43], a[176:179], v[44:47]
  ds_read_b64_tr_b16 a[170:171], v121 offset:29184
  ds_read_b64_tr_b16 a[172:173], v122 offset:28672
  v_mfma_f32_16x16x32_bf16 v[92:95], a[44:47], a[176:179], v[92:95]
  s_waitcnt vmcnt(21) lgkmcnt(10)
  s_barrier
  v_mfma_f32_16x16x32_bf16 v[96:99], a[180:183], a[188:191], v[96:99]
  ds_read_b64_tr_b16 a[174:175], v122 offset:29184
  s_add_u32 m0, s38, 39936
  v_mfma_f32_16x16x32_bf16 v[100:103], a[188:191], a[184:187], v[100:103]
  buffer_load_dwordx4 v107, s[8:11], s17 offen lds
  v_mfma_f32_16x16x32_bf16 v[0:3], a[132:135], a[48:51], v[0:3]
  ds_read_b64_tr_b16 a[176:177], v123 offset:28672
  ds_read_b64_tr_b16 a[178:179], v123 offset:29184
  buffer_load_dwordx4 v108, s[8:11], s17 offen offset:1024 lds
  v_mfma_f32_16x16x32_bf16 v[48:51], a[132:135], a[52:55], v[48:51]
  ds_read_b64_tr_b16 a[180:181], v124 offset:40960
  ds_read_b64_tr_b16 a[182:183], v124 offset:41472
  buffer_load_dwordx4 v109, s[8:11], s17 offen offset:2048 lds
  v_mfma_f32_16x16x32_bf16 v[4:7], a[136:139], a[48:51], v[4:7]
  ds_read_b128 a[188:191], v125 offset:52224
  ds_read_b64_tr_b16 a[184:185], v124 offset:41984
  ds_read_b64_tr_b16 a[186:187], v124 offset:42496
  v_mfma_f32_16x16x32_bf16 v[52:55], a[136:139], a[52:55], v[52:55]
  ds_read_b64_tr_b16 a[132:133], v120 offset:39936
  s_add_u32 s17, s17, 196608
  v_mfma_f32_16x16x32_bf16 v[8:11], a[140:143], a[48:51], v[8:11]
  ds_read_b64_tr_b16 a[134:135], v120 offset:40448
  s_cmp_eq_u32 s17, s10
  v_mfma_f32_16x16x32_bf16 v[56:59], a[140:143], a[52:55], v[56:59]
  ds_read_b64_tr_b16 a[136:137], v121 offset:39936
  s_cselect_b32 s17, 0, s17
  v_mfma_f32_16x16x32_bf16 v[12:15], a[144:147], a[48:51], v[12:15]
  ds_read_b64_tr_b16 a[138:139], v121 offset:40448
  s_add_u32 m0, s39, 39936
  v_mfma_f32_16x16x32_bf16 v[60:63], a[144:147], a[52:55], v[60:63]
  ds_read_b64_tr_b16 a[140:141], v122 offset:39936
  ds_read_b64_tr_b16 a[142:143], v122 offset:40448
  v_mfma_f32_16x16x32_bf16 v[16:19], a[148:151], a[48:51], v[16:19]
  buffer_load_dword v106, s[4:7], s16 offen sc1 lds
  v_mfma_f32_16x16x32_bf16 v[64:67], a[148:151], a[52:55], v[64:67]
  buffer_load_dwordx4 a[24:27], v105, s[4:7], s16 offen sc1
  s_waitcnt lgkmcnt(10)
  v_mfma_f32_16x16x32_bf16 v[20:23], a[152:155], a[48:51], v[20:23]
  ds_read_b64_tr_b16 a[144:145], v123 offset:39936
  ds_read_b64_tr_b16 a[146:147], v123 offset:40448
  buffer_load_dwordx4 a[28:31], v105, s[4:7], s16 offen offset:1024 sc1
  v_mfma_f32_16x16x32_bf16 v[68:71], a[152:155], a[52:55], v[68:71]
  ds_read_b64_tr_b16 a[148:149], v120 offset:40960
  s_add_u32 s16, s16, 131072
  v_mfma_f32_16x16x32_bf16 v[24:27], a[156:159], a[48:51], v[24:27]
  ds_read_b64_tr_b16 a[150:151], v120 offset:41472
  ds_read_b64_tr_b16 a[152:153], v121 offset:40960
  v_mfma_f32_16x16x32_bf16 v[72:75], a[156:159], a[52:55], v[72:75]
  ds_read_b64_tr_b16 a[154:155], v121 offset:41472
  s_bitset0_b32 s16, 20
  v_mfma_f32_16x16x32_bf16 v[28:31], a[160:163], a[48:51], v[28:31]
  ds_read_b64_tr_b16 a[156:157], v122 offset:40960
  s_add_u32 m0, s38, 53248
  v_mfma_f32_16x16x32_bf16 v[76:79], a[160:163], a[52:55], v[76:79]
  buffer_load_dwordx4 v107, s[8:11], s17 offen lds
  v_mfma_f32_16x16x32_bf16 v[32:35], a[48:51], a[164:167], v[32:35]
  ds_read_b64_tr_b16 a[158:159], v122 offset:41472
  buffer_load_dwordx4 v108, s[8:11], s17 offen offset:1024 lds
  v_mfma_f32_16x16x32_bf16 v[80:83], a[52:55], a[164:167], v[80:83]
  ds_read_b64_tr_b16 a[160:161], v123 offset:40960
  ds_read_b64_tr_b16 a[162:163], v123 offset:41472
  v_mfma_f32_16x16x32_bf16 v[36:39], a[48:51], a[168:171], v[36:39]
  buffer_load_dwordx4 v109, s[8:11], s17 offen offset:2048 lds
  v_mfma_f32_16x16x32_bf16 v[84:87], a[52:55], a[168:171], v[84:87]
  ds_read_b64_tr_b16 a[164:165], v120 offset:41984
  s_add_u32 s17, s17, 196608
  v_mfma_f32_16x16x32_bf16 v[40:43], a[48:51], a[172:175], v[40:43]
  ds_read_b64_tr_b16 a[166:167], v120 offset:42496
  s_cmp_eq_u32 s17, s10
  v_mfma_f32_16x16x32_bf16 v[88:91], a[52:55], a[172:175], v[88:91]
  ds_read_b64_tr_b16 a[168:169], v121 offset:41984
  s_cselect_b32 s17, 0, s17
  v_mfma_f32_16x16x32_bf16 v[44:47], a[48:51], a[176:179], v[44:47]
  ds_read_b64_tr_b16 a[170:171], v121 offset:42496
  ds_read_b64_tr_b16 a[172:173], v122 offset:41984
  v_mfma_f32_16x16x32_bf16 v[92:95], a[52:55], a[176:179], v[92:95]
  s_waitcnt vmcnt(21) lgkmcnt(10)
  s_barrier
  v_mfma_f32_16x16x32_bf16 v[96:99], a[180:183], a[188:191], v[96:99]
  ds_read_b64_tr_b16 a[174:175], v122 offset:42496
  s_add_u32 m0, s39, 53248
  v_mfma_f32_16x16x32_bf16 v[100:103], a[188:191], a[184:187], v[100:103]
  buffer_load_dword v106, s[4:7], s16 offen sc1 lds
  v_mfma_f32_16x16x32_bf16 v[0:3], a[132:135], a[56:59], v[0:3]
  ds_read_b64_tr_b16 a[176:177], v123 offset:41984
  ds_read_b64_tr_b16 a[178:179], v123 offset:42496
  buffer_load_dwordx4 a[32:35], v105, s[4:7], s16 offen sc1
  v_mfma_f32_16x16x32_bf16 v[48:51], a[132:135], a[60:63], v[48:51]
  ds_read_b64_tr_b16 a[180:181], v118 offset:1024
  ds_read_b64_tr_b16 a[182:183], v118 offset:1536
  buffer_load_dwordx4 a[36:39], v105, s[4:7], s16 offen offset:1024 sc1
  v_mfma_f32_16x16x32_bf16 v[4:7], a[136:139], a[56:59], v[4:7]
  ds_read_b128 a[188:191], v119 offset:12288
  ds_read_b64_tr_b16 a[184:185], v118 offset:2048
  ds_read_b64_tr_b16 a[186:187], v118 offset:2560
  v_mfma_f32_16x16x32_bf16 v[52:55], a[136:139], a[60:63], v[52:55]
  ds_read_b64_tr_b16 a[132:133], v114 offset:0
  s_add_u32 s16, s16, 131072
  v_mfma_f32_16x16x32_bf16 v[8:11], a[140:143], a[56:59], v[8:11]
  ds_read_b64_tr_b16 a[134:135], v114 offset:512
  s_bitset0_b32 s16, 20
  v_mfma_f32_16x16x32_bf16 v[56:59], a[140:143], a[60:63], v[56:59]
  ds_read_b64_tr_b16 a[136:137], v115 offset:0
  s_add_u32 m0, s38, 66560
  v_mfma_f32_16x16x32_bf16 v[12:15], a[144:147], a[56:59], v[12:15]
  ds_read_b64_tr_b16 a[138:139], v115 offset:512
  ds_read_b64_tr_b16 a[140:141], v116 offset:0
  v_mfma_f32_16x16x32_bf16 v[60:63], a[144:147], a[60:63], v[60:63]
  buffer_load_dwordx4 v107, s[8:11], s17 offen lds
  v_mfma_f32_16x16x32_bf16 v[16:19], a[148:151], a[56:59], v[16:19]
  ds_read_b64_tr_b16 a[142:143], v116 offset:512
  buffer_load_dwordx4 v108, s[8:11], s17 offen offset:1024 lds
  v_mfma_f32_16x16x32_bf16 v[64:67], a[148:151], a[60:63], v[64:67]
  buffer_load_dwordx4 v109, s[8:11], s17 offen offset:2048 lds
  s_waitcnt lgkmcnt(10)
  v_mfma_f32_16x16x32_bf16 v[20:23], a[152:155], a[56:59], v[20:23]
  ds_read_b64_tr_b16 a[144:145], v117 offset:0
  ds_read_b64_tr_b16 a[146:147], v117 offset:512
  v_mfma_f32_16x16x32_bf16 v[68:71], a[152:155], a[60:63], v[68:71]
  ds_read_b64_tr_b16 a[148:149], v114 offset:1024
  s_add_u32 s17, s17, 196608
  v_mfma_f32_16x16x32_bf16 v[24:27], a[156:159], a[56:59], v[24:27]
  ds_read_b64_tr_b16 a[150:151], v114 offset:1536
  s_cmp_eq_u32 s17, s10
  v_mfma_f32_16x16x32_bf16 v[72:75], a[156:159], a[60:63], v[72:75]
  ds_read_b64_tr_b16 a[152:153], v115 offset:1024
  s_cselect_b32 s17, 0, s17
  v_mfma_f32_16x16x32_bf16 v[28:31], a[160:163], a[56:59], v[28:31]
  ds_read_b64_tr_b16 a[154:155], v115 offset:1536
  ds_read_b64_tr_b16 a[156:157], v116 offset:1024
  v_mfma_f32_16x16x32_bf16 v[76:79], a[160:163], a[60:63], v[76:79]
  ds_read_b64_tr_b16 a[158:159], v116 offset:1536
  s_add_u32 m0, s39, 66560
  v_mfma_f32_16x16x32_bf16 v[32:35], a[56:59], a[164:167], v[32:35]
  buffer_load_dword v106, s[4:7], s16 offen sc1 lds
  v_mfma_f32_16x16x32_bf16 v[80:83], a[60:63], a[164:167], v[80:83]
  buffer_load_dwordx4 a[40:43], v105, s[4:7], s16 offen sc1
  v_mfma_f32_16x16x32_bf16 v[36:39], a[56:59], a[168:171], v[36:39]
  ds_read_b64_tr_b16 a[160:161], v117 offset:1024
  ds_read_b64_tr_b16 a[162:163], v117 offset:1536
  v_mfma_f32_16x16x32_bf16 v[84:87], a[60:63], a[168:171], v[84:87]
  buffer_load_dwordx4 a[44:47], v105, s[4:7], s16 offen offset:1024 sc1
  v_mfma_f32_16x16x32_bf16 v[40:43], a[56:59], a[172:175], v[40:43]
  ds_read_b64_tr_b16 a[164:165], v114 offset:2048
  ds_read_b64_tr_b16 a[166:167], v114 offset:2560
  s_add_u32 s16, s16, 131072
  v_mfma_f32_16x16x32_bf16 v[88:91], a[60:63], a[172:175], v[88:91]
  ds_read_b64_tr_b16 a[168:169], v115 offset:2048
  s_bitset0_b32 s16, 20
  v_mfma_f32_16x16x32_bf16 v[44:47], a[56:59], a[176:179], v[44:47]
  ds_read_b64_tr_b16 a[170:171], v115 offset:2560
  ds_read_b64_tr_b16 a[172:173], v116 offset:2048
  v_mfma_f32_16x16x32_bf16 v[92:95], a[60:63], a[176:179], v[92:95]
  s_waitcnt vmcnt(24) lgkmcnt(10)
  s_barrier
  v_mfma_f32_16x16x32_bf16 v[96:99], a[180:183], a[188:191], v[96:99]
  ds_read_b64_tr_b16 a[174:175], v116 offset:2560
  s_add_u32 m0, s38, 79872
  v_mfma_f32_16x16x32_bf16 v[100:103], a[188:191], a[184:187], v[100:103]
  buffer_load_dwordx4 v107, s[8:11], s17 offen lds
  v_mfma_f32_16x16x32_bf16 v[0:3], a[132:135], a[0:3], v[0:3]
  ds_read_b64_tr_b16 a[176:177], v117 offset:2048
  ds_read_b64_tr_b16 a[178:179], v117 offset:2560
  buffer_load_dwordx4 v108, s[8:11], s17 offen offset:1024 lds
  v_mfma_f32_16x16x32_bf16 v[48:51], a[132:135], a[4:7], v[48:51]
  ds_read_b64_tr_b16 a[180:181], v118 offset:14336
  ds_read_b64_tr_b16 a[182:183], v118 offset:14848
  buffer_load_dwordx4 v109, s[8:11], s17 offen offset:2048 lds
  v_mfma_f32_16x16x32_bf16 v[4:7], a[136:139], a[0:3], v[4:7]
  ds_read_b128 a[188:191], v119 offset:25600
  ds_read_b64_tr_b16 a[184:185], v118 offset:15360
  ds_read_b64_tr_b16 a[186:187], v118 offset:15872
  v_mfma_f32_16x16x32_bf16 v[52:55], a[136:139], a[4:7], v[52:55]
  ds_read_b64_tr_b16 a[132:133], v114 offset:13312
  s_add_u32 s17, s17, 196608
  v_mfma_f32_16x16x32_bf16 v[8:11], a[140:143], a[0:3], v[8:11]
  ds_read_b64_tr_b16 a[134:135], v114 offset:13824
  s_cmp_eq_u32 s17, s10
  v_mfma_f32_16x16x32_bf16 v[56:59], a[140:143], a[4:7], v[56:59]
  ds_read_b64_tr_b16 a[136:137], v115 offset:13312
  s_cselect_b32 s17, 0, s17
  v_mfma_f32_16x16x32_bf16 v[12:15], a[144:147], a[0:3], v[12:15]
  ds_read_b64_tr_b16 a[138:139], v115 offset:13824
  s_add_u32 m0, s39, 79872
  v_mfma_f32_16x16x32_bf16 v[60:63], a[144:147], a[4:7], v[60:63]
  ds_read_b64_tr_b16 a[140:141], v116 offset:13312
  ds_read_b64_tr_b16 a[142:143], v116 offset:13824
  v_mfma_f32_16x16x32_bf16 v[16:19], a[148:151], a[0:3], v[16:19]
  buffer_load_dword v106, s[4:7], s16 offen sc1 lds
  v_mfma_f32_16x16x32_bf16 v[64:67], a[148:151], a[4:7], v[64:67]
  buffer_load_dwordx4 a[48:51], v105, s[4:7], s16 offen sc1
  s_waitcnt lgkmcnt(10)
  v_mfma_f32_16x16x32_bf16 v[20:23], a[152:155], a[0:3], v[20:23]
  ds_read_b64_tr_b16 a[144:145], v117 offset:13312
  ds_read_b64_tr_b16 a[146:147], v117 offset:13824
  buffer_load_dwordx4 a[52:55], v105, s[4:7], s16 offen offset:1024 sc1
  v_mfma_f32_16x16x32_bf16 v[68:71], a[152:155], a[4:7], v[68:71]
  ds_read_b64_tr_b16 a[148:149], v114 offset:14336
  s_add_u32 s16, s16, 131072
  v_mfma_f32_16x16x32_bf16 v[24:27], a[156:159], a[0:3], v[24:27]
  ds_read_b64_tr_b16 a[150:151], v114 offset:14848
  ds_read_b64_tr_b16 a[152:153], v115 offset:14336
  v_mfma_f32_16x16x32_bf16 v[72:75], a[156:159], a[4:7], v[72:75]
  ds_read_b64_tr_b16 a[154:155], v115 offset:14848
  s_bitset0_b32 s16, 20
  v_mfma_f32_16x16x32_bf16 v[28:31], a[160:163], a[0:3], v[28:31]
  ds_read_b64_tr_b16 a[156:157], v116 offset:14336
  s_add_u32 m0, s38, 93184
  v_mfma_f32_16x16x32_bf16 v[76:79], a[160:163], a[4:7], v[76:79]
  buffer_load_dwordx4 v107, s[8:11], s17 offen lds
  v_mfma_f32_16x16x32_bf16 v[32:35], a[0:3], a[164:167], v[32:35]
  ds_read_b64_tr_b16 a[158:159], v116 offset:14848
  buffer_load_dwordx4 v108, s[8:11], s17 offen offset:1024 lds
  v_mfma_f32_16x16x32_bf16 v[80:83], a[4:7], a[164:167], v[80:83]
  ds_read_b64_tr_b16 a[160:161], v117 offset:14336
  ds_read_b64_tr_b16 a[162:163], v117 offset:14848
  v_mfma_f32_16x16x32_bf16 v[36:39], a[0:3], a[168:171], v[36:39]
  buffer_load_dwordx4 v109, s[8:11], s17 offen offset:2048 lds
  v_mfma_f32_16x16x32_bf16 v[84:87], a[4:7], a[168:171], v[84:87]
  ds_read_b64_tr_b16 a[164:165], v114 offset:15360
  s_add_u32 s17, s17, 196608
  v_mfma_f32_16x16x32_bf16 v[40:43], a[0:3], a[172:175], v[40:43]
  ds_read_b64_tr_b16 a[166:167], v114 offset:15872
  s_cmp_eq_u32 s17, s10
  v_mfma_f32_16x16x32_bf16 v[88:91], a[4:7], a[172:175], v[88:91]
  ds_read_b64_tr_b16 a[168:169], v115 offset:15360
  s_cselect_b32 s17, 0, s17
  v_mfma_f32_16x16x32_bf16 v[44:47], a[0:3], a[176:179], v[44:47]
  ds_read_b64_tr_b16 a[170:171], v115 offset:15872
  ds_read_b64_tr_b16 a[172:173], v116 offset:15360
  v_mfma_f32_16x16x32_bf16 v[92:95], a[4:7], a[176:179], v[92:95]
  s_waitcnt vmcnt(27) lgkmcnt(10)
  s_barrier
  v_mfma_f32_16x16x32_bf16 v[96:99], a[180:183], a[188:191], v[96:99]
  ds_read_b64_tr_b16 a[174:175], v116 offset:15872
  s_add_u32 m0, s39, 93184
  v_mfma_f32_16x16x32_bf16 v[100:103], a[188:191], a[184:187], v[100:103]
  buffer_load_dword v106, s[4:7], s16 offen sc1 lds
  v_mfma_f32_16x16x32_bf16 v[0:3], a[132:135], a[8:11], v[0:3]
  ds_read_b64_tr_b16 a[176:177], v117 offset:15360
  ds_read_b64_tr_b16 a[178:179], v117 offset:15872
  buffer_load_dwordx4 a[56:59], v105, s[4:7], s16 offen sc1
  v_mfma_f32_16x16x32_bf16 v[48:51], a[132:135], a[12:15], v[48:51]
  ds_read_b64_tr_b16 a[180:181], v118 offset:27648
  ds_read_b64_tr_b16 a[182:183], v118 offset:28160
  buffer_load_dwordx4 a[60:63], v105, s[4:7], s16 offen offset:1024 sc1
  v_mfma_f32_16x16x32_bf16 v[4:7], a[136:139], a[8:11], v[4:7]
  ds_read_b128 a[188:191], v119 offset:38912
  ds_read_b64_tr_b16 a[184:185], v118 offset:28672
  ds_read_b64_tr_b16 a[186:187], v118 offset:29184
  s_add_u32 s16, s16, 131072
  v_mfma_f32_16x16x32_bf16 v[52:55], a[136:139], a[12:15], v[52:55]
  ds_read_b64_tr_b16 a[132:133], v114 offset:26624
  s_bitset0_b32 s16, 20
  v_mfma_f32_16x16x32_bf16 v[8:11], a[140:143], a[8:11], v[8:11]
  ds_read_b64_tr_b16 a[134:135], v114 offset:27136
  ds_read_b64_tr_b16 a[136:137], v115 offset:26624
  v_mfma_f32_16x16x32_bf16 v[56:59], a[140:143], a[12:15], v[56:59]
  ds_read_b64_tr_b16 a[138:139], v115 offset:27136
  s_add_u32 m0, s51, 0
  v_mfma_f32_16x16x32_bf16 v[12:15], a[144:147], a[8:11], v[12:15]
  ds_read_b64_tr_b16 a[140:141], v116 offset:26624
  s_add_u32 s50, s98, 0
  v_mfma_f32_16x16x32_bf16 v[60:63], a[144:147], a[12:15], v[60:63]
  ds_read_b64_tr_b16 a[142:143], v116 offset:27136
  s_bitset0_b32 s50, 21
  v_mfma_f32_16x16x32_bf16 v[16:19], a[148:151], a[8:11], v[16:19]
  buffer_load_dwordx4 v248, s[52:55], s50 offen lds
  v_mfma_f32_16x16x32_bf16 v[64:67], a[148:151], a[12:15], v[64:67]
  buffer_load_dwordx4 v249, s[52:55], s50 offen offset:1024 lds
  s_waitcnt lgkmcnt(10)
  v_mfma_f32_16x16x32_bf16 v[20:23], a[152:155], a[8:11], v[20:23]
  ds_read_b64_tr_b16 a[144:145], v117 offset:26624
  ds_read_b64_tr_b16 a[146:147], v117 offset:27136
  v_mfma_f32_16x16x32_bf16 v[68:71], a[152:155], a[12:15], v[68:71]
  ds_read_b64_tr_b16 a[148:149], v114 offset:27648
  s_add_u32 m0, s51, 114688
  v_mfma_f32_16x16x32_bf16 v[24:27], a[156:159], a[8:11], v[24:27]
  ds_read_b64_tr_b16 a[150:151], v114 offset:28160
  s_add_u32 s50, s98, 1835008
  v_mfma_f32_16x16x32_bf16 v[72:75], a[156:159], a[12:15], v[72:75]
  ds_read_b64_tr_b16 a[152:153], v115 offset:27648
  s_bitset0_b32 s50, 21
  v_mfma_f32_16x16x32_bf16 v[28:31], a[160:163], a[8:11], v[28:31]
  ds_read_b64_tr_b16 a[154:155], v115 offset:28160
  buffer_load_dwordx4 v248, s[52:55], s50 offen lds
  v_mfma_f32_16x16x32_bf16 v[76:79], a[160:163], a[12:15], v[76:79]
  buffer_load_dwordx4 v249, s[52:55], s50 offen offset:1024 lds
  v_mfma_f32_16x16x32_bf16 v[32:35], a[8:11], a[164:167], v[32:35]
  ds_read_b64_tr_b16 a[156:157], v116 offset:27648
  ds_read_b64_tr_b16 a[158:159], v116 offset:28160
  v_mfma_f32_16x16x32_bf16 v[80:83], a[12:15], a[164:167], v[80:83]
  ds_read_b64_tr_b16 a[160:161], v117 offset:27648
  s_add_u32 m0, s51, 122880
  v_mfma_f32_16x16x32_bf16 v[36:39], a[8:11], a[168:171], v[36:39]
  ds_read_b64_tr_b16 a[162:163], v117 offset:28160
  s_add_u32 s50, s98, 1966080
  v_mfma_f32_16x16x32_bf16 v[84:87], a[12:15], a[168:171], v[84:87]
  ds_read_b64_tr_b16 a[164:165], v114 offset:28672
  s_bitset0_b32 s50, 21
  v_mfma_f32_16x16x32_bf16 v[40:43], a[8:11], a[172:175], v[40:43]
  ds_read_b64_tr_b16 a[166:167], v114 offset:29184
  buffer_load_dwordx4 v248, s[52:55], s50 offen lds
  v_mfma_f32_16x16x32_bf16 v[88:91], a[12:15], a[172:175], v[88:91]
  buffer_load_dwordx4 v249, s[52:55], s50 offen offset:1024 lds
  v_mfma_f32_16x16x32_bf16 v[44:47], a[8:11], a[176:179], v[44:47]
  ds_read_b64_tr_b16 a[168:169], v115 offset:28672
  ds_read_b64_tr_b16 a[170:171], v115 offset:29184
  v_mfma_f32_16x16x32_bf16 v[92:95], a[12:15], a[176:179], v[92:95]
  s_waitcnt vmcnt(30) lgkmcnt(10)
  s_barrier
  v_mfma_f32_16x16x32_bf16 v[96:99], a[180:183], a[188:191], v[96:99]
  ds_read_b64_tr_b16 a[172:173], v116 offset:28672
  ds_read_b64_tr_b16 a[174:175], v116 offset:29184
  s_add_u32 m0, s51, 8192
  v_mfma_f32_16x16x32_bf16 v[100:103], a[188:191], a[184:187], v[100:103]
  ds_read_b64_tr_b16 a[176:177], v117 offset:28672
  ds_read_b64_tr_b16 a[178:179], v117 offset:29184
  v_mfma_f32_16x16x32_bf16 v[0:3], a[132:135], a[16:19], v[0:3]
  ds_read_b64_tr_b16 a[180:181], v118 offset:40960
  s_add_u32 s50, s98, 131072
  v_mfma_f32_16x16x32_bf16 v[48:51], a[132:135], a[20:23], v[48:51]
  ds_read_b64_tr_b16 a[182:183], v118 offset:41472
  ds_read_b128 a[188:191], v119 offset:52224
  v_mfma_f32_16x16x32_bf16 v[4:7], a[136:139], a[16:19], v[4:7]
  ds_read_b64_tr_b16 a[184:185], v118 offset:41984
  ds_read_b64_tr_b16 a[186:187], v118 offset:42496
  v_mfma_f32_16x16x32_bf16 v[52:55], a[136:139], a[20:23], v[52:55]
  ds_read_b64_tr_b16 a[132:133], v114 offset:39936
  s_bitset0_b32 s50, 21
  v_mfma_f32_16x16x32_bf16 v[8:11], a[140:143], a[16:19], v[8:11]
  ds_read_b64_tr_b16 a[134:135], v114 offset:40448
  ds_read_b64_tr_b16 a[136:137], v115 offset:39936
  v_mfma_f32_16x16x32_bf16 v[56:59], a[140:143], a[20:23], v[56:59]
  buffer_load_dwordx4 v248, s[52:55], s50 offen lds
  v_mfma_f32_16x16x32_bf16 v[12:15], a[144:147], a[16:19], v[12:15]
  ds_read_b64_tr_b16 a[138:139], v115 offset:40448
  ds_read_b64_tr_b16 a[140:141], v116 offset:39936
  v_mfma_f32_16x16x32_bf16 v[60:63], a[144:147], a[20:23], v[60:63]
  ds_read_b64_tr_b16 a[142:143], v116 offset:40448
  ds_read_b64_tr_b16 a[144:145], v117 offset:39936
  v_mfma_f32_16x16x32_bf16 v[16:19], a[148:151], a[16:19], v[16:19]
  buffer_load_dwordx4 v249, s[52:55], s50 offen offset:1024 lds
  v_mfma_f32_16x16x32_bf16 v[64:67], a[148:151], a[20:23], v[64:67]
  ds_read_b64_tr_b16 a[146:147], v117 offset:40448
  ds_read_b64_tr_b16 a[148:149], v114 offset:40960
  s_waitcnt lgkmcnt(10)
  v_mfma_f32_16x16x32_bf16 v[20:23], a[152:155], a[16:19], v[20:23]
  ds_read_b64_tr_b16 a[150:151], v114 offset:41472
  s_add_u32 m0, s51, 16384
  v_mfma_f32_16x16x32_bf16 v[68:71], a[152:155], a[20:23], v[68:71]
  ds_read_b64_tr_b16 a[152:153], v115 offset:40960
  ds_read_b64_tr_b16 a[154:155], v115 offset:41472
  v_mfma_f32_16x16x32_bf16 v[24:27], a[156:159], a[16:19], v[24:27]
  v_mfma_f32_16x16x32_bf16 v[72:75], a[156:159], a[20:23], v[72:75]
  ds_read_b64_tr_b16 a[156:157], v116 offset:40960
  s_add_u32 s50, s98, 262144
  v_mfma_f32_16x16x32_bf16 v[28:31], a[160:163], a[16:19], v[28:31]
  ds_read_b64_tr_b16 a[158:159], v116 offset:41472
  v_mfma_f32_16x16x32_bf16 v[76:79], a[160:163], a[20:23], v[76:79]
  ds_read_b64_tr_b16 a[160:161], v117 offset:40960
  s_bitset0_b32 s50, 21
  v_mfma_f32_16x16x32_bf16 v[32:35], a[16:19], a[164:167], v[32:35]
  ds_read_b64_tr_b16 a[162:163], v117 offset:41472
  v_mfma_f32_16x16x32_bf16 v[80:83], a[20:23], a[164:167], v[80:83]
  ds_read_b64_tr_b16 a[164:165], v114 offset:41984
  ds_read_b64_tr_b16 a[166:167], v114 offset:42496
  v_mfma_f32_16x16x32_bf16 v[36:39], a[16:19], a[168:171], v[36:39]
  buffer_load_dwordx4 v248, s[52:55], s50 offen lds
  v_mfma_f32_16x16x32_bf16 v[84:87], a[20:23], a[168:171], v[84:87]
  ds_read_b64_tr_b16 a[168:169], v115 offset:41984
  ds_read_b64_tr_b16 a[170:171], v115 offset:42496
  v_mfma_f32_16x16x32_bf16 v[40:43], a[16:19], a[172:175], v[40:43]
  buffer_load_dwordx4 v249, s[52:55], s50 offen offset:1024 lds
  v_mfma_f32_16x16x32_bf16 v[88:91], a[20:23], a[172:175], v[88:91]
  ds_read_b64_tr_b16 a[172:173], v116 offset:41984
  ds_read_b64_tr_b16 a[174:175], v116 offset:42496
  v_mfma_f32_16x16x32_bf16 v[44:47], a[16:19], a[176:179], v[44:47]
  v_mfma_f32_16x16x32_bf16 v[92:95], a[20:23], a[176:179], v[92:95]
  s_waitcnt vmcnt(28) lgkmcnt(10)
  s_barrier
  v_mfma_f32_16x16x32_bf16 v[96:99], a[180:183], a[188:191], v[96:99]
  ds_read_b64_tr_b16 a[176:177], v117 offset:41984
  s_add_u32 m0, s51, 24576
  v_mfma_f32_16x16x32_bf16 v[100:103], a[188:191], a[184:187], v[100:103]
  ds_read_b64_tr_b16 a[178:179], v117 offset:42496
  ds_read_b64_tr_b16 a[180:181], v124 offset:1024
  v_mfma_f32_16x16x32_bf16 v[0:3], a[132:135], a[24:27], v[0:3]
  ds_read_b64_tr_b16 a[182:183], v124 offset:1536
  ds_read_b128 a[188:191], v125 offset:12288
  v_mfma_f32_16x16x32_bf16 v[48:51], a[132:135], a[28:31], v[48:51]
  ds_read_b64_tr_b16 a[184:185], v124 offset:2048
  ds_read_b64_tr_b16 a[186:187], v124 offset:2560
  v_mfma_f32_16x16x32_bf16 v[4:7], a[136:139], a[24:27], v[4:7]
  ds_read_b64_tr_b16 a[132:133], v120 offset:0
  ds_read_b64_tr_b16 a[134:135], v120 offset:512
  v_mfma_f32_16x16x32_bf16 v[52:55], a[136:139], a[28:31], v[52:55]
  ds_read_b64_tr_b16 a[136:137], v121 offset:0
  s_add_u32 s50, s98, 393216
  v_mfma_f32_16x16x32_bf16 v[8:11], a[140:143], a[24:27], v[8:11]
  ds_read_b64_tr_b16 a[138:139], v121 offset:512
  v_mfma_f32_16x16x32_bf16 v[56:59], a[140:143], a[28:31], v[56:59]
  ds_read_b64_tr_b16 a[140:141], v122 offset:0
  ds_read_b64_tr_b16 a[142:143], v122 offset:512
  v_mfma_f32_16x16x32_bf16 v[12:15], a[144:147], a[24:27], v[12:15]
  v_mfma_f32_16x16x32_bf16 v[60:63], a[144:147], a[28:31], v[60:63]
  ds_read_b64_tr_b16 a[144:145], v123 offset:0
  ds_read_b64_tr_b16 a[146:147], v123 offset:512
  v_mfma_f32_16x16x32_bf16 v[16:19], a[148:151], a[24:27], v[16:19]
  s_bitset0_b32 s50, 21
  v_mfma_f32_16x16x32_bf16 v[64:67], a[148:151], a[28:31], v[64:67]
  ds_read_b64_tr_b16 a[148:149], v120 offset:1024
  ds_read_b64_tr_b16 a[150:151], v120 offset:1536
  v_mfma_f32_16x16x32_bf16 v[20:23], a[152:155], a[24:27], v[20:23]
  v_mfma_f32_16x16x32_bf16 v[68:71], a[152:155], a[28:31], v[68:71]
  ds_read_b64_tr_b16 a[152:153], v121 offset:1024
  ds_read_b64_tr_b16 a[154:155], v121 offset:1536
  s_waitcnt lgkmcnt(10)
  v_mfma_f32_16x16x32_bf16 v[24:27], a[156:159], a[24:27], v[24:27]
  v_mfma_f32_16x16x32_bf16 v[72:75], a[156:159], a[28:31], v[72:75]
  buffer_load_dwordx4 v248, s[52:55], s50 offen lds
  v_mfma_f32_16x16x32_bf16 v[28:31], a[160:163], a[24:27], v[28:31]
  ds_read_b64_tr_b16 a[156:157], v122 offset:1024
  ds_read_b64_tr_b16 a[158:159], v122 offset:1536
  v_mfma_f32_16x16x32_bf16 v[76:79], a[160:163], a[28:31], v[76:79]
  ds_read_b64_tr_b16 a[160:161], v123 offset:1024
  ds_read_b64_tr_b16 a[162:163], v123 offset:1536
  v_mfma_f32_16x16x32_bf16 v[32:35], a[24:27], a[164:167], v[32:35]
  v_mfma_f32_16x16x32_bf16 v[80:83], a[28:31], a[164:167], v[80:83]
  ds_read_b64_tr_b16 a[164:165], v120 offset:2048
  ds_read_b64_tr_b16 a[166:167], v120 offset:2560
  v_mfma_f32_16x16x32_bf16 v[36:39], a[24:27], a[168:171], v[36:39]
  buffer_load_dwordx4 v249, s[52:55], s50 offen offset:1024 lds
  v_mfma_f32_16x16x32_bf16 v[84:87], a[28:31], a[168:171], v[84:87]
  ds_read_b64_tr_b16 a[168:169], v121 offset:2048
  ds_read_b64_tr_b16 a[170:171], v121 offset:2560
  v_mfma_f32_16x16x32_bf16 v[40:43], a[24:27], a[172:175], v[40:43]
  v_mfma_f32_16x16x32_bf16 v[88:91], a[28:31], a[172:175], v[88:91]
  ds_read_b64_tr_b16 a[172:173], v122 offset:2048
  ds_read_b64_tr_b16 a[174:175], v122 offset:2560
  v_mfma_f32_16x16x32_bf16 v[44:47], a[24:27], a[176:179], v[44:47]
  v_mfma_f32_16x16x32_bf16 v[92:95], a[28:31], a[176:179], v[92:95]
  s_waitcnt vmcnt(24) lgkmcnt(10)
  s_barrier
  v_mfma_f32_16x16x32_bf16 v[96:99], a[180:183], a[188:191], v[96:99]
  ds_read_b64_tr_b16 a[176:177], v123 offset:2048
  s_add_u32 m0, s51, 32768
  v_mfma_f32_16x16x32_bf16 v[100:103], a[188:191], a[184:187], v[100:103]
  ds_read_b64_tr_b16 a[178:179], v123 offset:2560
  s_add_u32 s50, s98, 524288
  v_mfma_f32_16x16x32_bf16 v[0:3], a[132:135], a[32:35], v[0:3]
  ds_read_b64_tr_b16 a[180:181], v124 offset:14336
  ds_read_b64_tr_b16 a[182:183], v124 offset:14848
  v_mfma_f32_16x16x32_bf16 v[48:51], a[132:135], a[36:39], v[48:51]
  ds_read_b128 a[188:191], v125 offset:25600
  s_bitset0_b32 s50, 21
  v_mfma_f32_16x16x32_bf16 v[4:7], a[136:139], a[32:35], v[4:7]
  ds_read_b64_tr_b16 a[184:185], v124 offset:15360
  ds_read_b64_tr_b16 a[186:187], v124 offset:15872
  v_mfma_f32_16x16x32_bf16 v[52:55], a[136:139], a[36:39], v[52:55]
  buffer_load_dwordx4 v248, s[52:55], s50 offen lds
  v_mfma_f32_16x16x32_bf16 v[8:11], a[140:143], a[32:35], v[8:11]
  ds_read_b64_tr_b16 a[132:133], v120 offset:13312
  ds_read_b64_tr_b16 a[134:135], v120 offset:13824
  buffer_load_dwordx4 v249, s[52:55], s50 offen offset:1024 lds
  v_mfma_f32_16x16x32_bf16 v[56:59], a[140:143], a[36:39], v[56:59]
  ds_read_b64_tr_b16 a[136:137], v121 offset:13312
  ds_read_b64_tr_b16 a[138:139], v121 offset:13824
  v_mfma_f32_16x16x32_bf16 v[12:15], a[144:147], a[32:35], v[12:15]
  ds_read_b64_tr_b16 a[140:141], v122 offset:13312
  s_add_u32 m0, s51, 40960
  v_mfma_f32_16x16x32_bf16 v[60:63], a[144:147], a[36:39], v[60:63]
  ds_read_b64_tr_b16 a[142:143], v122 offset:13824
  ds_read_b64_tr_b16 a[144:145], v123 offset:13312
  v_mfma_f32_16x16x32_bf16 v[16:19], a[148:151], a[32:35], v[16:19]
  ds_read_b64_tr_b16 a[146:147], v123 offset:13824
  s_add_u32 s50, s98, 655360
  v_mfma_f32_16x16x32_bf16 v[64:67], a[148:151], a[36:39], v[64:67]
  ds_read_b64_tr_b16 a[148:149], v120 offset:14336
  s_bitset0_b32 s50, 21
  v_mfma_f32_16x16x32_bf16 v[20:23], a[152:155], a[32:35], v[20:23]
  ds_read_b64_tr_b16 a[150:151], v120 offset:14848
  v_mfma_f32_16x16x32_bf16 v[68:71], a[152:155], a[36:39], v[68:71]
  buffer_load_dwordx4 v248, s[52:55], s50 offen lds
  s_waitcnt lgkmcnt(10)
  v_mfma_f32_16x16x32_bf16 v[24:27], a[156:159], a[32:35], v[24:27]
  ds_read_b64_tr_b16 a[152:153], v121 offset:14336
  ds_read_b64_tr_b16 a[154:155], v121 offset:14848
  v_mfma_f32_16x16x32_bf16 v[72:75], a[156:159], a[36:39], v[72:75]
  buffer_load_dwordx4 v249, s[52:55], s50 offen offset:1024 lds
  v_mfma_f32_16x16x32_bf16 v[28:31], a[160:163], a[32:35], v[28:31]
  ds_read_b64_tr_b16 a[156:157], v122 offset:14336
  s_lshl_b32 s34, s37, 8
  v_mfma_f32_16x16x32_bf16 v[76:79], a[160:163], a[36:39], v[76:79]
  ds_read_b64_tr_b16 a[158:159], v122 offset:14848
  ds_read_b64_tr_b16 a[160:161], v123 offset:14336
  v_mfma_f32_16x16x32_bf16 v[32:35], a[32:35], a[164:167], v[32:35]
  ds_read_b64_tr_b16 a[162:163], v123 offset:14848
  s_lshl_b32 s33, s3, 12
  v_mfma_f32_16x16x32_bf16 v[80:83], a[36:39], a[164:167], v[80:83]
  ds_read_b64_tr_b16 a[164:165], v120 offset:15360
  ds_read_b64_tr_b16 a[166:167], v120 offset:15872
  v_mfma_f32_16x16x32_bf16 v[36:39], a[32:35], a[168:171], v[36:39]
  s_add_u32 s34, s34, s33
  v_mfma_f32_16x16x32_bf16 v[84:87], a[36:39], a[168:171], v[84:87]
  ds_read_b64_tr_b16 a[168:169], v121 offset:15360
  s_add_u32 s68, s34, 8192
  v_mfma_f32_16x16x32_bf16 v[40:43], a[32:35], a[172:175], v[40:43]
  ds_read_b64_tr_b16 a[170:171], v121 offset:15872
  v_mfma_f32_16x16x32_bf16 v[88:91], a[36:39], a[172:175], v[88:91]
  buffer_load_dwordx4 v[250:253], v254, s[12:15], s68 offen sc1
  v_mfma_f32_16x16x32_bf16 v[44:47], a[32:35], a[176:179], v[44:47]
  ds_read_b64_tr_b16 a[172:173], v122 offset:15360
  ds_read_b64_tr_b16 a[174:175], v122 offset:15872
  v_mfma_f32_16x16x32_bf16 v[92:95], a[36:39], a[176:179], v[92:95]
  s_waitcnt vmcnt(23) lgkmcnt(10)
  s_barrier
  v_mfma_f32_16x16x32_bf16 v[96:99], a[180:183], a[188:191], v[96:99]
  ds_read_b64_tr_b16 a[176:177], v123 offset:15360
  s_add_u32 m0, s51, 49152
  v_mfma_f32_16x16x32_bf16 v[100:103], a[188:191], a[184:187], v[100:103]
  ds_read_b64_tr_b16 a[178:179], v123 offset:15872
  s_add_u32 s50, s98, 786432
  v_mfma_f32_16x16x32_bf16 v[0:3], a[132:135], a[40:43], v[0:3]
  ds_read_b64_tr_b16 a[180:181], v124 offset:27648
  s_bitset0_b32 s50, 21
  v_mfma_f32_16x16x32_bf16 v[48:51], a[132:135], a[44:47], v[48:51]
  ds_read_b64_tr_b16 a[182:183], v124 offset:28160
  buffer_load_dwordx4 v248, s[52:55], s50 offen lds
  v_mfma_f32_16x16x32_bf16 v[4:7], a[136:139], a[40:43], v[4:7]
  ds_read_b128 a[188:191], v125 offset:38912
  ds_read_b64_tr_b16 a[184:185], v124 offset:28672
  ds_read_b64_tr_b16 a[186:187], v124 offset:29184
  v_mfma_f32_16x16x32_bf16 v[52:55], a[136:139], a[44:47], v[52:55]
  buffer_load_dwordx4 v249, s[52:55], s50 offen offset:1024 lds
  v_mfma_f32_16x16x32_bf16 v[8:11], a[140:143], a[40:43], v[8:11]
  ds_read_b64_tr_b16 a[132:133], v120 offset:26624
  ds_read_b64_tr_b16 a[134:135], v120 offset:27136
  s_add_u32 m0, s51, 57344
  v_mfma_f32_16x16x32_bf16 v[56:59], a[140:143], a[44:47], v[56:59]
  ds_read_b64_tr_b16 a[136:137], v121 offset:26624
  s_add_u32 s50, s98, 917504
  v_mfma_f32_16x16x32_bf16 v[12:15], a[144:147], a[40:43], v[12:15]
  ds_read_b64_tr_b16 a[138:139], v121 offset:27136
  ds_read_b64_tr_b16 a[140:141], v122 offset:26624
  v_mfma_f32_16x16x32_bf16 v[60:63], a[144:147], a[44:47], v[60:63]
  ds_read_b64_tr_b16 a[142:143], v122 offset:27136
  s_bitset0_b32 s50, 21
  v_mfma_f32_16x16x32_bf16 v[16:19], a[148:151], a[40:43], v[16:19]
  buffer_load_dwordx4 v248, s[52:55], s50 offen lds
  v_mfma_f32_16x16x32_bf16 v[64:67], a[148:151], a[44:47], v[64:67]
  buffer_load_dwordx4 v249, s[52:55], s50 offen offset:1024 lds
  v_mfma_f32_16x16x32_bf16 v[20:23], a[152:155], a[40:43], v[20:23]
  ds_read_b64_tr_b16 a[144:145], v123 offset:26624
  ds_read_b64_tr_b16 a[146:147], v123 offset:27136
  v_mfma_f32_16x16x32_bf16 v[68:71], a[152:155], a[44:47], v[68:71]
  ds_read_b64_tr_b16 a[148:149], v120 offset:27648
  s_mov_b32 s56, s26
  s_waitcnt lgkmcnt(10)
  v_mfma_f32_16x16x32_bf16 v[24:27], a[156:159], a[40:43], v[24:27]
  ds_read_b64_tr_b16 a[150:151], v120 offset:28160
  s_mov_b32 s57, s27
  v_mfma_f32_16x16x32_bf16 v[72:75], a[156:159], a[44:47], v[72:75]
  ds_read_b64_tr_b16 a[152:153], v121 offset:27648
  s_mov_b32 s58, 0x400000
  v_mfma_f32_16x16x32_bf16 v[28:31], a[160:163], a[40:43], v[28:31]
  ds_read_b64_tr_b16 a[154:155], v121 offset:28160
  ds_read_b64_tr_b16 a[156:157], v122 offset:27648
  v_mfma_f32_16x16x32_bf16 v[76:79], a[160:163], a[44:47], v[76:79]
  ds_read_b64_tr_b16 a[158:159], v122 offset:28160
  s_mov_b32 s59, 0x20000
  v_mfma_f32_16x16x32_bf16 v[32:35], a[40:43], a[164:167], v[32:35]
  ds_read_b64_tr_b16 a[160:161], v123 offset:27648
  s_mov_b32 s33, 0x8000
  v_mfma_f32_16x16x32_bf16 v[80:83], a[44:47], a[164:167], v[80:83]
  buffer_load_dwordx4 a[240:243], v128, s[56:59], 0 offen offset:0
  v_mfma_f32_16x16x32_bf16 v[36:39], a[40:43], a[168:171], v[36:39]
  ds_read_b64_tr_b16 a[162:163], v123 offset:28160
  ds_read_b64_tr_b16 a[164:165], v120 offset:28672
  v_mfma_f32_16x16x32_bf16 v[84:87], a[44:47], a[168:171], v[84:87]
  buffer_load_dwordx4 a[244:247], v128, s[56:59], 0 offen offset:64
  v_mfma_f32_16x16x32_bf16 v[40:43], a[40:43], a[172:175], v[40:43]
  ds_read_b64_tr_b16 a[166:167], v120 offset:29184
  buffer_load_dwordx4 a[248:251], v128, s[56:59], s33 offen offset:0
  v_mfma_f32_16x16x32_bf16 v[88:91], a[44:47], a[172:175], v[88:91]
  buffer_load_dwordx4 a[252:255], v128, s[56:59], s33 offen offset:64
  v_mfma_f32_16x16x32_bf16 v[44:47], a[40:43], a[176:179], v[44:47]
  ds_read_b64_tr_b16 a[168:169], v121 offset:28672
  ds_read_b64_tr_b16 a[170:171], v121 offset:29184
  v_mfma_f32_16x16x32_bf16 v[92:95], a[44:47], a[176:179], v[92:95]
  s_waitcnt vmcnt(25) lgkmcnt(10)
  s_barrier
  v_mfma_f32_16x16x32_bf16 v[96:99], a[180:183], a[188:191], v[96:99]
  ds_read_b64_tr_b16 a[172:173], v122 offset:28672
  ds_read_b64_tr_b16 a[174:175], v122 offset:29184
  s_add_u32 m0, s51, 65536
  v_mfma_f32_16x16x32_bf16 v[100:103], a[188:191], a[184:187], v[100:103]
  ds_read_b64_tr_b16 a[176:177], v123 offset:28672
  ds_read_b64_tr_b16 a[178:179], v123 offset:29184
  v_mfma_f32_16x16x32_bf16 v[0:3], a[132:135], a[48:51], v[0:3]
  ds_read_b64_tr_b16 a[180:181], v124 offset:40960
  ds_read_b64_tr_b16 a[182:183], v124 offset:41472
  v_mfma_f32_16x16x32_bf16 v[48:51], a[132:135], a[52:55], v[48:51]
  ds_read_b128 a[188:191], v125 offset:52224
  ds_read_b64_tr_b16 a[184:185], v124 offset:41984
  v_mfma_f32_16x16x32_bf16 v[4:7], a[136:139], a[48:51], v[4:7]
  ds_read_b64_tr_b16 a[186:187], v124 offset:42496
  ds_read_b64_tr_b16 a[132:133], v120 offset:39936
  v_mfma_f32_16x16x32_bf16 v[52:55], a[136:139], a[52:55], v[52:55]
  ds_read_b64_tr_b16 a[134:135], v120 offset:40448
  s_add_u32 s50, s98, 1048576
  v_mfma_f32_16x16x32_bf16 v[8:11], a[140:143], a[48:51], v[8:11]
  ds_read_b64_tr_b16 a[136:137], v121 offset:39936
  ds_read_b64_tr_b16 a[138:139], v121 offset:40448
  v_mfma_f32_16x16x32_bf16 v[56:59], a[140:143], a[52:55], v[56:59]
  ds_read_b64_tr_b16 a[140:141], v122 offset:39936
  ds_read_b64_tr_b16 a[142:143], v122 offset:40448
  v_mfma_f32_16x16x32_bf16 v[12:15], a[144:147], a[48:51], v[12:15]
  v_mfma_f32_16x16x32_bf16 v[60:63], a[144:147], a[52:55], v[60:63]
  ds_read_b64_tr_b16 a[144:145], v123 offset:39936
  ds_read_b64_tr_b16 a[146:147], v123 offset:40448
  v_mfma_f32_16x16x32_bf16 v[16:19], a[148:151], a[48:51], v[16:19]
  s_bitset0_b32 s50, 21
  v_mfma_f32_16x16x32_bf16 v[64:67], a[148:151], a[52:55], v[64:67]
  ds_read_b64_tr_b16 a[148:149], v120 offset:40960
  ds_read_b64_tr_b16 a[150:151], v120 offset:41472
  s_waitcnt lgkmcnt(10)
  v_mfma_f32_16x16x32_bf16 v[20:23], a[152:155], a[48:51], v[20:23]
  v_mfma_f32_16x16x32_bf16 v[68:71], a[152:155], a[52:55], v[68:71]
  ds_read_b64_tr_b16 a[152:153], v121 offset:40960
  ds_read_b64_tr_b16 a[154:155], v121 offset:41472
  v_mfma_f32_16x16x32_bf16 v[24:27], a[156:159], a[48:51], v[24:27]
  v_mfma_f32_16x16x32_bf16 v[72:75], a[156:159], a[52:55], v[72:75]
  buffer_load_dwordx4 v248, s[52:55], s50 offen lds
  v_mfma_f32_16x16x32_bf16 v[28:31], a[160:163], a[48:51], v[28:31]
  ds_read_b64_tr_b16 a[156:157], v122 offset:40960
  ds_read_b64_tr_b16 a[158:159], v122 offset:41472
  v_mfma_f32_16x16x32_bf16 v[76:79], a[160:163], a[52:55], v[76:79]
  ds_read_b64_tr_b16 a[160:161], v123 offset:40960
  ds_read_b64_tr_b16 a[162:163], v123 offset:41472
  v_mfma_f32_16x16x32_bf16 v[32:35], a[48:51], a[164:167], v[32:35]
  v_mfma_f32_16x16x32_bf16 v[80:83], a[52:55], a[164:167], v[80:83]
  s_add_u32 s4, s20, 0x600000
  s_addc_u32 s5, s21, 0
  s_mov_b32 s6, 0x400000
  s_mov_b32 s7, 0x20000
  s_lshl_b32 s33, s3, 12
  s_add_u32 s33, s33, 139264
  v_add_u32 v110, s33, v119
  s_lshr_b32 s33, s3, 1
  s_lshl_b32 s33, s33, 10
  s_and_b32 s34, s3, 1
  s_lshl_b32 s34, s34, 3
  s_add_u32 s33, s33, s34
  s_add_u32 s33, s33, 139264
  v_add_u32 v111, s33, v119
  v_mfma_f32_16x16x32_bf16 v[36:39], a[48:51], a[168:171], v[36:39]
  buffer_load_dwordx4 v249, s[52:55], s50 offen offset:1024 lds
  v_mfma_f32_16x16x32_bf16 v[84:87], a[52:55], a[168:171], v[84:87]
  ds_read_b64_tr_b16 a[164:165], v120 offset:41984
  ds_read_b64_tr_b16 a[166:167], v120 offset:42496
  v_mfma_f32_16x16x32_bf16 v[40:43], a[48:51], a[172:175], v[40:43]
  ds_read_b64_tr_b16 a[168:169], v121 offset:41984
  ds_read_b64_tr_b16 a[170:171], v121 offset:42496
  v_mfma_f32_16x16x32_bf16 v[88:91], a[52:55], a[172:175], v[88:91]
  ds_read_b64_tr_b16 a[172:173], v122 offset:41984
  ds_read_b64_tr_b16 a[174:175], v122 offset:42496
  v_mfma_f32_16x16x32_bf16 v[44:47], a[48:51], a[176:179], v[44:47]
  v_mfma_f32_16x16x32_bf16 v[92:95], a[52:55], a[176:179], v[92:95]
  s_waitcnt vmcnt(27) lgkmcnt(10)
  s_barrier
  v_mfma_f32_16x16x32_bf16 v[96:99], a[180:183], a[188:191], v[96:99]
  ds_read_b64_tr_b16 a[176:177], v123 offset:41984
  ds_read_b64_tr_b16 a[178:179], v123 offset:42496
  v_mfma_f32_16x16x32_bf16 v[100:103], a[188:191], a[184:187], v[100:103]
  v_mfma_f32_16x16x32_bf16 v[64:67], a[148:151], a[60:63], v[64:67]
  v_mfma_f32_16x16x32_bf16 v[68:71], a[152:155], a[60:63], v[68:71]
  s_waitcnt lgkmcnt(10)
  v_mfma_f32_16x16x32_bf16 v[72:75], a[156:159], a[60:63], v[72:75]
  s_waitcnt lgkmcnt(8)
  v_mfma_f32_16x16x32_bf16 v[76:79], a[160:163], a[60:63], v[76:79]
  v_mfma_f32_16x16x32_bf16 v[16:19], a[148:151], a[56:59], v[16:19]
  v_mfma_f32_16x16x32_bf16 v[20:23], a[152:155], a[56:59], v[20:23]
  v_mfma_f32_16x16x32_bf16 v[24:27], a[156:159], a[56:59], v[24:27]
  v_mfma_f32_16x16x32_bf16 v[28:31], a[160:163], a[56:59], v[28:31]
  v_cvt_pk_bf16_f32 v196, v96, v97
  v_cvt_pk_bf16_f32 v197, v98, v99
  s_waitcnt lgkmcnt(6)
  v_mfma_f32_16x16x32_bf16 v[80:83], a[60:63], a[164:167], v[80:83]
  v_cvt_pk_bf16_f32 v198, v100, v101
  v_cvt_pk_bf16_f32 v199, v102, v103
  s_waitcnt lgkmcnt(4)
  v_mfma_f32_16x16x32_bf16 v[84:87], a[60:63], a[168:171], v[84:87]
  ds_write_b64 v111, v[196:197]
  ds_write_b64 v111, v[198:199] offset:2048
  s_waitcnt lgkmcnt(4)
  v_mfma_f32_16x16x32_bf16 v[88:91], a[60:63], a[172:175], v[88:91]
  v_cvt_pk_bf16_f32 v164, v64, v65
  v_cvt_pk_bf16_f32 v165, v66, v67
  s_waitcnt lgkmcnt(2)
  v_mfma_f32_16x16x32_bf16 v[92:95], a[60:63], a[176:179], v[92:95]
  v_cvt_pk_bf16_f32 v166, v68, v69
  v_cvt_pk_bf16_f32 v167, v70, v71
  v_mfma_f32_16x16x32_bf16 v[48:51], a[132:135], a[60:63], v[48:51]
  v_cvt_pk_bf16_f32 v168, v72, v73
  v_cvt_pk_bf16_f32 v169, v74, v75
  v_mfma_f32_16x16x32_bf16 v[52:55], a[136:139], a[60:63], v[52:55]
  v_cvt_pk_bf16_f32 v170, v76, v77
  v_cvt_pk_bf16_f32 v171, v78, v79
  v_mfma_f32_16x16x32_bf16 v[56:59], a[140:143], a[60:63], v[56:59]
  ds_write_b128 v110, v[164:167] offset:4096
  ds_write_b128 v110, v[168:171] offset:5120
  v_mfma_f32_16x16x32_bf16 v[60:63], a[144:147], a[60:63], v[60:63]
  v_cvt_pk_bf16_f32 v176, v80, v81
  v_cvt_pk_bf16_f32 v177, v82, v83
  v_mfma_f32_16x16x32_bf16 v[0:3], a[132:135], a[56:59], v[0:3]
  v_cvt_pk_bf16_f32 v182, v84, v85
  v_cvt_pk_bf16_f32 v183, v86, v87
  v_mfma_f32_16x16x32_bf16 v[4:7], a[136:139], a[56:59], v[4:7]
  v_cvt_pk_bf16_f32 v188, v88, v89
  v_cvt_pk_bf16_f32 v189, v90, v91
  v_mfma_f32_16x16x32_bf16 v[8:11], a[140:143], a[56:59], v[8:11]
  v_cvt_pk_bf16_f32 v194, v92, v93
  v_cvt_pk_bf16_f32 v195, v94, v95
  v_mfma_f32_16x16x32_bf16 v[12:15], a[144:147], a[56:59], v[12:15]
  ds_write_b64 v110, v[176:177] offset:6144
  ds_write_b64 v110, v[182:183] offset:6152
  v_mfma_f32_16x16x32_bf16 v[32:35], a[56:59], a[164:167], v[32:35]
  ds_write_b64 v110, v[188:189] offset:7168
  ds_write_b64 v110, v[194:195] offset:7176
  v_mfma_f32_16x16x32_bf16 v[36:39], a[56:59], a[168:171], v[36:39]
  v_cvt_pk_bf16_f32 v156, v16, v17
  v_cvt_pk_bf16_f32 v157, v18, v19
  v_mfma_f32_16x16x32_bf16 v[40:43], a[56:59], a[172:175], v[40:43]
  v_cvt_pk_bf16_f32 v158, v20, v21
  v_cvt_pk_bf16_f32 v159, v22, v23
  v_mfma_f32_16x16x32_bf16 v[44:47], a[56:59], a[176:179], v[44:47]
L_att:
  v_cvt_pk_bf16_f32 v160, v24, v25
  v_cvt_pk_bf16_f32 v161, v26, v27
  v_cvt_pk_bf16_f32 v162, v28, v29
  v_cvt_pk_bf16_f32 v163, v30, v31
  v_cvt_pk_bf16_f32 v140, v48, v49
  v_cvt_pk_bf16_f32 v141, v50, v51
  v_cvt_pk_bf16_f32 v142, v52, v53
  v_cvt_pk_bf16_f32 v143, v54, v55
  v_cvt_pk_bf16_f32 v144, v56, v57
  v_cvt_pk_bf16_f32 v145, v58, v59
  v_cvt_pk_bf16_f32 v146, v60, v61
  v_cvt_pk_bf16_f32 v147, v62, v63
  s_waitcnt lgkmcnt(0)
  s_barrier
  ds_read_b128 v[148:151], v110 offset:0
  ds_read_b64 v[172:173], v110 offset:2048
  ds_read_b64 v[178:179], v110 offset:2056
  ds_read_b128 v[152:155], v110 offset:1024
  ds_read_b64 v[184:185], v110 offset:3072
  ds_read_b64 v[190:191], v110 offset:3080
  v_mfma_f32_16x16x32_bf16 v[200:203], v[156:159], v[140:143], 0
  v_mfma_f32_16x16x32_bf16 v[204:207], v[164:167], v[140:143], 0
  v_mfma_f32_16x16x32_bf16 v[208:211], v[160:163], v[144:147], 0
  v_mfma_f32_16x16x32_bf16 v[212:215], v[168:171], v[144:147], 0
  v_cvt_pk_bf16_f32 v132, v0, v1
  v_cvt_pk_bf16_f32 v133, v2, v3
  v_cvt_pk_bf16_f32 v134, v4, v5
  v_cvt_pk_bf16_f32 v135, v6, v7
  v_cvt_pk_bf16_f32 v136, v8, v9
  v_cvt_pk_bf16_f32 v137, v10, v11
  v_cvt_pk_bf16_f32 v138, v12, v13
  v_cvt_pk_bf16_f32 v139, v14, v15
  s_or_b32 s33, s30, s3
  s_cmp_eq_u32 s33, 0
  s_cselect_b32 s33, 0xf149f2ca, 0
  v_mov_b32 v232, s33
  v_cndmask_b32_e64 v120, v232, 0, s[44:45]
  v_cndmask_b32_e64 v121, v232, 0, s[46:47]
  v_and_b32 v122, 1, v104
  v_lshlrev_b32 v122, 4, v122
  s_waitcnt lgkmcnt(0)
  v_mfma_f32_16x16x32_bf16 v[216:219], v[148:151], v[132:135], 0
  v_mfma_f32_16x16x32_bf16 v[220:223], v[156:159], v[132:135], 0
  v_mfma_f32_16x16x32_bf16 v[224:227], v[152:155], v[136:139], 0
  v_mfma_f32_16x16x32_bf16 v[228:231], v[160:163], v[136:139], 0
  v_cvt_pk_bf16_f32 v174, v32, v33
  v_cvt_pk_bf16_f32 v175, v34, v35
  v_cvt_pk_bf16_f32 v180, v36, v37
  v_cvt_pk_bf16_f32 v181, v38, v39
  v_cvt_pk_bf16_f32 v186, v40, v41
  v_cvt_pk_bf16_f32 v187, v42, v43
  v_cvt_pk_bf16_f32 v192, v44, v45
  v_cvt_pk_bf16_f32 v193, v46, v47
  s_mov_b32 s40, 0x3e8293ee
  v_cndmask_b32_e64 v200, v200, v201, s[48:49]
  v_cndmask_b32_e64 v202, v202, v203, s[48:49]
  v_cndmask_b32_e64 v204, v204, v205, s[48:49]
  v_cndmask_b32_e64 v206, v206, v207, s[48:49]
  v_cndmask_b32_e64 v208, v208, v209, s[48:49]
  v_cndmask_b32_e64 v210, v210, v211, s[48:49]
  v_cndmask_b32_e64 v212, v212, v213, s[48:49]
  v_cndmask_b32_e64 v214, v214, v215, s[48:49]
  v_cndmask_b32_e64 v216, v216, v217, s[48:49]
  v_cndmask_b32_e64 v218, v218, v219, s[48:49]
  v_cndmask_b32_e64 v220, v220, v221, s[48:49]
  v_cndmask_b32_e64 v222, v222, v223, s[48:49]
  v_cndmask_b32_e64 v224, v224, v225, s[48:49]
  v_cndmask_b32_e64 v226, v226, v227, s[48:49]
  v_cndmask_b32_e64 v228, v228, v229, s[48:49]
  v_cndmask_b32_e64 v230, v230, v231, s[48:49]
  v_cndmask_b32_e64 v200, v200, v204, s[44:45]
  v_cndmask_b32_e64 v201, v202, v206, s[46:47]
  v_cndmask_b32_e64 v208, v208, v212, s[44:45]
  v_cndmask_b32_e64 v209, v210, v214, s[46:47]
  v_cndmask_b32_e64 v216, v216, v220, s[44:45]
  v_cndmask_b32_e64 v217, v218, v222, s[46:47]
  v_cndmask_b32_e64 v224, v224, v228, s[44:45]
  v_cndmask_b32_e64 v225, v226, v230, s[46:47]
  v_mul_f32 v200, s40, v200
  v_mul_f32 v201, s40, v201
  v_mul_f32 v208, s40, v208
  v_mul_f32 v209, s40, v209
  v_fma_f32 v216, v216, s40, v120
  v_fma_f32 v217, v217, s40, v121
  v_fma_f32 v224, v224, s40, v120
  v_fma_f32 v225, v225, s40, v121
  v_max_f32 v232, v200, v201
  v_max_f32 v233, v208, v209
  v_max_f32 v234, v216, v217
  v_max_f32 v235, v224, v225
  v_mov_b32 v236, v232
  v_mov_b32 v237, v233
  v_mov_b32 v238, v234
  v_mov_b32 v239, v235
  s_nop 1
  v_permlane16_swap_b32 v236, v232
  v_permlane16_swap_b32 v237, v233
  v_permlane16_swap_b32 v238, v234
  v_permlane16_swap_b32 v239, v235
  s_nop 1
  v_max_f32 v232, v232, v236
  v_max_f32 v233, v233, v237
  v_max_f32 v234, v234, v238
  v_max_f32 v235, v235, v239
  v_mov_b32 v236, v232
  v_mov_b32 v237, v233
  v_mov_b32 v238, v234
  v_mov_b32 v239, v235
  s_nop 1
  v_permlane32_swap_b32 v236, v232
  v_permlane32_swap_b32 v237, v233
  v_permlane32_swap_b32 v238, v234
  v_permlane32_swap_b32 v239, v235
  s_nop 1
  v_max_f32 v232, v232, v236
  v_max_f32 v233, v233, v237
  v_max_f32 v234, v234, v238
  v_max_f32 v235, v235, v239
  v_sub_f32 v200, v200, v232
  v_sub_f32 v201, v201, v232
  v_sub_f32 v208, v208, v233
  v_sub_f32 v209, v209, v233
  v_sub_f32 v216, v216, v234
  v_sub_f32 v217, v217, v234
  v_sub_f32 v224, v224, v235
  v_sub_f32 v225, v225, v235
  v_exp_f32 v200, v200
  v_exp_f32 v201, v201
  v_exp_f32 v208, v208
  v_exp_f32 v209, v209
  v_exp_f32 v216, v216
  v_exp_f32 v217, v217
  v_exp_f32 v224, v224
  v_exp_f32 v225, v225
  s_nop 0
  v_add_f32 v232, v200, v201
  v_add_f32 v233, v208, v209
  v_add_f32 v234, v216, v217
  v_add_f32 v235, v224, v225
  v_mov_b32 v236, v232
  v_mov_b32 v237, v233
  v_mov_b32 v238, v234
  v_mov_b32 v239, v235
  s_nop 1
  v_permlane16_swap_b32 v236, v232
  v_permlane16_swap_b32 v237, v233
  v_permlane16_swap_b32 v238, v234
  v_permlane16_swap_b32 v239, v235
  s_nop 1
  v_add_f32 v232, v232, v236
  v_add_f32 v233, v233, v237
  v_add_f32 v234, v234, v238
  v_add_f32 v235, v235, v239
  v_mov_b32 v236, v232
  v_mov_b32 v237, v233
  v_mov_b32 v238, v234
  v_mov_b32 v239, v235
  s_nop 1
  v_permlane32_swap_b32 v236, v232
  v_permlane32_swap_b32 v237, v233
  v_permlane32_swap_b32 v238, v234
  v_permlane32_swap_b32 v239, v235
  s_nop 1
  v_add_f32 v232, v232, v236
  v_add_f32 v233, v233, v237
  v_add_f32 v234, v234, v238
  v_add_f32 v235, v235, v239
  v_rcp_f32 v232, v232
  v_rcp_f32 v233, v233
  v_rcp_f32 v234, v234
  v_rcp_f32 v235, v235
  s_nop 0
  v_mul_f32 v200, v200, v232
  v_mul_f32 v201, v201, v232
  v_mul_f32 v208, v208, v233
  v_mul_f32 v209, v209, v233
  v_mul_f32 v216, v216, v234
  v_mul_f32 v217, v217, v234
  v_mul_f32 v224, v224, v235
  v_mul_f32 v225, v225, v235
  v_cvt_pk_bf16_f32 v200, v200, 0
  v_cvt_pk_bf16_f32 v201, v201, 0
  v_cvt_pk_bf16_f32 v208, v208, 0
  v_cvt_pk_bf16_f32 v209, v209, 0
  v_cvt_pk_bf16_f32 v216, v216, 0
  v_cvt_pk_bf16_f32 v217, v217, 0
  v_cvt_pk_bf16_f32 v224, v224, 0
  v_cvt_pk_bf16_f32 v225, v225, 0
  v_lshlrev_b32 v200, v122, v200
  v_lshlrev_b32 v201, v122, v201
  v_lshlrev_b32 v208, v122, v208
  v_lshlrev_b32 v209, v122, v209
  v_lshlrev_b32 v216, v122, v216
  v_lshlrev_b32 v217, v122, v217
  v_lshlrev_b32 v224, v122, v224
  v_lshlrev_b32 v225, v122, v225
  v_cndmask_b32_e64 v132, v200, 0, s[44:45]
  v_cndmask_b32_e64 v134, 0, v200, s[44:45]
  v_cndmask_b32_e64 v133, v201, 0, s[46:47]
  v_cndmask_b32_e64 v135, 0, v201, s[46:47]
  v_cndmask_b32_e64 v136, v208, 0, s[44:45]
  v_cndmask_b32_e64 v138, 0, v208, s[44:45]
  v_cndmask_b32_e64 v137, v209, 0, s[46:47]
  v_cndmask_b32_e64 v139, 0, v209, s[46:47]
  v_cndmask_b32_e64 v140, v216, 0, s[44:45]
  v_cndmask_b32_e64 v142, 0, v216, s[44:45]
  v_cndmask_b32_e64 v141, v217, 0, s[46:47]
  v_cndmask_b32_e64 v143, 0, v217, s[46:47]
  v_cndmask_b32_e64 v144, v224, 0, s[44:45]
  v_cndmask_b32_e64 v146, 0, v224, s[44:45]
  v_cndmask_b32_e64 v145, v225, 0, s[46:47]
  v_cndmask_b32_e64 v147, 0, v225, s[46:47]
  s_nop 1
  v_mfma_f32_16x16x32_bf16 v[200:203], v[174:177], v[132:135], 0
  v_mfma_f32_16x16x32_bf16 v[204:207], v[180:183], v[132:135], 0
  v_mfma_f32_16x16x32_bf16 v[208:211], v[186:189], v[136:139], 0
  v_mfma_f32_16x16x32_bf16 v[212:215], v[192:195], v[136:139], 0
  v_mfma_f32_16x16x32_bf16 v[216:219], v[172:175], v[140:143], 0
  v_mfma_f32_16x16x32_bf16 v[220:223], v[178:181], v[140:143], 0
  v_mfma_f32_16x16x32_bf16 v[224:227], v[184:187], v[144:147], 0
  v_mfma_f32_16x16x32_bf16 v[228:231], v[190:193], v[144:147], 0
  s_lshl_b32 s41, s31, 18
  s_add_u32 s42, s41, 131072
  s_nop 1
  v_cvt_pk_bf16_f32 v148, v200, v201
  v_cvt_pk_bf16_f32 v149, v202, v203
  v_cvt_pk_bf16_f32 v150, v204, v205
  v_cvt_pk_bf16_f32 v151, v206, v207
  buffer_store_dwordx4 v[148:151], v105, s[4:7], s41 offen offset:1024 sc1
  v_cvt_pk_bf16_f32 v152, v208, v209
  v_cvt_pk_bf16_f32 v153, v210, v211
  v_cvt_pk_bf16_f32 v154, v212, v213
  v_cvt_pk_bf16_f32 v155, v214, v215
  buffer_store_dwordx4 v[152:155], v105, s[4:7], s42 offen offset:1024 sc1
  v_cvt_pk_bf16_f32 v156, v216, v217
  v_cvt_pk_bf16_f32 v157, v218, v219
  v_cvt_pk_bf16_f32 v158, v220, v221
  v_cvt_pk_bf16_f32 v159, v222, v223
  buffer_store_dwordx4 v[156:159], v105, s[4:7], s41 offen offset:0 sc1
  s_nop 0
  v_cvt_pk_bf16_f32 v160, v224, v225
  v_cvt_pk_bf16_f32 v161, v226, v227
  v_cvt_pk_bf16_f32 v162, v228, v229
  v_cvt_pk_bf16_f32 v163, v230, v231
  buffer_store_dwordx4 v[160:163], v105, s[4:7], s42 offen offset:0 sc1
  s_lshl_b32 s69, s30, 2
  s_add_u32 s69, s69, s3
  s_lshl_b32 s69, s69, 4
  s_add_u32 s69, s69, s31
  s_add_u32 s69, s69, 1024
  s_lshl_b32 s69, s69, 6
  s_mov_b32 s30, s36
  s_mov_b32 s31, s37
  s_mov_b32 s49, s98
  v_mov_b32 v32, v104
  v_mov_b32 v231, v104
  v_mov_b32 v43, v128
  v_and_b32 v44, 15, v32
  s_lshl_b32 s32, s30, 13
  s_lshl_b32 s33, s3, 11
  s_add_u32 s32, s32, s33
  v_lshlrev_b32 v80, 4, v32
  v_add_u32 v33, s32, v80
  v_add_u32 v34, 131072, v33
  s_lshl_b32 s16, s98, 1
  s_lshl_b32 s32, s30, 2
  s_add_u32 s32, s32, s3
  s_lshl_b32 s32, s32, 4
  s_add_u32 s32, s32, 1024
  v_add_u32 v45, s32, v44
  v_lshlrev_b32 v45, 6, v45
  v_mov_b32 v158, s19
  v_mov_b32 v159, s19
  v_lshlrev_b32 v46, 2, v32
  s_bfe_u32 s44, s19, 0x80000
  s_bfe_u32 s45, s19, 0x80008
  s_bfe_u32 s46, s19, 0x80010
  s_bfe_u32 s47, s19, 0x80018
  s_mov_b32 s92, s30
  s_mov_b32 s93, s31
  s_and_b32 s28, s2, 7
  s_lshr_b32 s29, s2, 3
  s_lshr_b32 s30, s28, 2
  s_xor_b32 s30, s30, 1
  s_lshl_b32 s30, s30, 2
  s_and_b32 s31, s29, 3
  s_add_u32 s30, s30, s31
  s_and_b32 s31, s28, 3
  s_lshl_b32 s31, s31, 3
  s_lshr_b32 s29, s29, 2
  s_add_u32 s31, s31, s29
  s_lshl_b32 s32, s30, 14
  s_lshl_b32 s33, s3, 12
  s_add_u32 s32, s32, s33
  v_lshlrev_b32 v224, 4, v231
  v_add_u32 v224, s32, v224
  s_and_b32 s33, s3, 1
  s_mul_i32 s34, s33, 114688
  s_mul_i32 s35, s31, 224
  s_add_u32 s34, s34, s35
  s_movk_i32 s36, 4682
  s_movk_i32 s37, 7168
  s_and_b32 s39, s31, 1
  s_lshl_b32 s39, s39, 1
  v_add_u32 v234, 0, v231
  v_mul_u32_u24 v235, s36, v234
  v_lshrrev_b32 v235, 16, v235
  v_mul_u32_u24 v236, 14, v235
  v_sub_u32 v236, v234, v236
  v_add_u32 v236, s39, v236
  v_subrev_u32 v237, 14, v236
  v_min_u32 v236, v236, v237
  v_mul_u32_u24 v235, s37, v235
  v_lshl_add_u32 v235, v236, 4, v235
  v_add_u32 v235, s34, v235
  v_subrev_u32 v225, 0, v235
  v_add_u32 v234, 64, v231
  v_mul_u32_u24 v235, s36, v234
  v_lshrrev_b32 v235, 16, v235
  v_mul_u32_u24 v236, 14, v235
  v_sub_u32 v236, v234, v236
  v_add_u32 v236, s39, v236
  v_subrev_u32 v237, 14, v236
  v_min_u32 v236, v236, v237
  v_mul_u32_u24 v235, s37, v235
  v_lshl_add_u32 v235, v236, 4, v235
  v_add_u32 v235, s34, v235
  v_subrev_u32 v226, 1024, v235
  v_add_u32 v234, 128, v231
  v_mul_u32_u24 v235, s36, v234
  v_lshrrev_b32 v235, 16, v235
  v_mul_u32_u24 v236, 14, v235
  v_sub_u32 v236, v234, v236
  v_add_u32 v236, s39, v236
  v_subrev_u32 v237, 14, v236
  v_min_u32 v236, v236, v237
  v_mul_u32_u24 v235, s37, v235
  v_lshl_add_u32 v235, v236, 4, v235
  v_add_u32 v235, s34, v235
  v_subrev_u32 v227, 2048, v235
  v_add_u32 v234, 192, v231
  v_mul_u32_u24 v235, s36, v234
  v_lshrrev_b32 v235, 16, v235
  v_mul_u32_u24 v236, 14, v235
  v_sub_u32 v236, v234, v236
  v_add_u32 v236, s39, v236
  v_subrev_u32 v237, 14, v236
  v_min_u32 v236, v236, v237
  v_mul_u32_u24 v235, s37, v235
  v_lshl_add_u32 v235, v236, 4, v235
  v_add_u32 v235, s34, v235
  v_subrev_u32 v228, 3072, v235
  s_mov_b32 s94, s30
  s_mov_b32 s95, s31
  s_mov_b32 s30, s92
  s_mov_b32 s31, s93
  s_mul_i32 s38, s3, 3584
  s_add_u32 s38, s38, 98304
  s_bfe_u32 s33, s2, 0x20003
  s_mul_i32 s17, s33, 229376
  s_cmp_eq_u32 s33, 3
  s_cselect_b32 s96, -3, 1
  s_mul_i32 s96, s96, 229376
  s_cmp_eq_u32 s33, 2
  s_cselect_b32 s97, -3, 1
  s_mul_i32 s97, s97, 229376
  s_cmp_eq_u32 s33, 1
  s_cselect_b32 s98, -3, 1
  s_mul_i32 s98, s98, 229376
  s_cmp_eq_u32 s33, 0
  s_cselect_b32 s99, 1, 5
  s_mul_i32 s99, s99, 229376
  s_cmp_lt_u32 s3, 2
  s_cselect_b32 s8, s60, s62
  s_cselect_b32 s9, s61, s63
  s_mov_b32 s10, 7340032
  s_mov_b32 s11, 0x20000
  s_waitcnt vmcnt(0)
  s_mov_b64 exec, 1
  buffer_store_dword v158, v46, s[64:67], s69 offen sc1
  s_mov_b64 exec, -1
  s_add_u32 m0, s51, 73728
  s_add_u32 s50, s49, 1179648
  s_bitset0_b32 s50, 21
  buffer_load_dwordx4 v248, s[52:55], s50 offen lds
  buffer_load_dwordx4 v249, s[52:55], s50 offen offset:1024 lds
  s_add_u32 m0, s51, 81920
  s_add_u32 s50, s49, 1310720
  s_bitset0_b32 s50, 21
  buffer_load_dwordx4 v248, s[52:55], s50 offen lds
  buffer_load_dwordx4 v249, s[52:55], s50 offen offset:1024 lds
  s_add_u32 m0, s51, 90112
  s_add_u32 s50, s49, 1441792
  s_bitset0_b32 s50, 21
  buffer_load_dwordx4 v248, s[52:55], s50 offen lds
  buffer_load_dwordx4 v249, s[52:55], s50 offen offset:1024 lds
  s_add_u32 m0, s51, 98304
  s_add_u32 s50, s49, 1572864
  s_bitset0_b32 s50, 21
  buffer_load_dwordx4 v248, s[52:55], s50 offen lds
  buffer_load_dwordx4 v249, s[52:55], s50 offen offset:1024 lds
  v_xor_b32 v168, s44, v250
  v_xor_b32 v169, s45, v251
  v_xor_b32 v170, s46, v252
  v_xor_b32 v171, s47, v253
  v_or3_b32 v172, v168, v169, v170
  v_or_b32 v172, v172, v171
  v_and_b32 v172, 0xff, v172
  v_cmp_ne_u32 vcc, 0, v172
  s_nop 1
  s_cmp_lg_u64 vcc, 0
  s_cbranch_scc1 L_vslow_11
L_vback_12:
  v_mov_b32 v172, v168
  v_mov_b32 v173, v169
  v_mov_b32 v174, v170
  v_mov_b32 v175, v171
  s_nop 1
  v_permlane16_swap_b32 v172, v168
  v_permlane16_swap_b32 v173, v169
  v_permlane16_swap_b32 v174, v170
  v_permlane16_swap_b32 v175, v171
  s_nop 1
  v_add_f32 v168, v168, v172
  v_add_f32 v169, v169, v173
  v_add_f32 v170, v170, v174
  v_add_f32 v171, v171, v175
  v_mov_b32 v172, v168
  v_mov_b32 v173, v169
  v_mov_b32 v174, v170
  v_mov_b32 v175, v171
  s_nop 1
  v_permlane32_swap_b32 v172, v168
  v_permlane32_swap_b32 v173, v169
  v_permlane32_swap_b32 v174, v170
  v_permlane32_swap_b32 v175, v171
  s_nop 1
  v_add_f32 v168, v168, v172
  v_add_f32 v169, v169, v173
  v_add_f32 v170, v170, v174
  v_add_f32 v171, v171, v175
  v_cvt_pk_bf16_f32 v172, v168, v169
  v_lshlrev_b32 v168, 16, v172
  v_and_b32 v169, 0xffff0000, v172
  v_cvt_pk_bf16_f32 v173, v170, v171
  v_lshlrev_b32 v170, 16, v173
  v_and_b32 v171, 0xffff0000, v173
  s_cmp_eq_u32 s3, 2
  s_cselect_b32 s33, 1.0, 0
  v_add_f32 v168, s33, v168
  v_add_f32 v169, s33, v169
  v_add_f32 v170, s33, v170
  v_add_f32 v171, s33, v171
  v_cvt_pk_bf16_f32 v172, v168, v169
  v_lshlrev_b32 v168, 16, v172
  v_and_b32 v169, 0xffff0000, v172
  v_cvt_pk_bf16_f32 v173, v170, v171
  v_lshlrev_b32 v170, 16, v173
  v_and_b32 v171, 0xffff0000, v173
  v_lshlrev_b32 v172, 4, v44
  s_lshl_b32 s33, s3, 8
  s_add_u32 s33, s33, 162816
  v_add_u32 v172, s33, v172
  ds_write_b128 v172, v[168:171]
  v_lshrrev_b32 v82, 2, v32
  v_lshlrev_b32 v82, 7, v82
  v_bfe_u32 v81, v32, 3, 2
  v_lshl_add_u32 v82, v81, 5, v82
  v_and_b32 v81, 3, v32
  v_lshl_add_u32 v35, v81, 3, v82
  v_xor_b32 v36, 32, v35
  v_xor_b32 v37, 64, v35
  v_xor_b32 v38, 96, v35
  v_add_u32 v39, 65536, v35
  v_add_u32 v40, 65536, v36
  v_add_u32 v41, 65536, v37
  v_add_u32 v42, 65536, v38
  v_lshrrev_b32 v47, 4, v32
  v_lshlrev_b32 v46, 4, v47
  v_add_u32 v253, 162816, v46
  s_waitcnt vmcnt(0) lgkmcnt(0)
  s_waitcnt vmcnt(63)
  s_barrier
  ds_read_b64_tr_b16 v[88:89], v35 offset:0
  ds_read_b64_tr_b16 v[90:91], v35 offset:2048
  ds_read_b64_tr_b16 v[92:93], v36 offset:0
  ds_read_b64_tr_b16 v[94:95], v36 offset:2048
  ds_read_b64_tr_b16 v[96:97], v37 offset:0
  ds_read_b64_tr_b16 v[98:99], v37 offset:2048
  ds_read_b64_tr_b16 v[100:101], v38 offset:0
  ds_read_b64_tr_b16 v[102:103], v38 offset:2048
  ds_read_b64_tr_b16 v[104:105], v35 offset:4096
  ds_read_b64_tr_b16 v[106:107], v35 offset:6144
  ds_read_b64_tr_b16 v[108:109], v36 offset:4096
  ds_read_b64_tr_b16 v[110:111], v36 offset:6144
  ds_read_b64_tr_b16 v[112:113], v37 offset:4096
  ds_read_b64_tr_b16 v[114:115], v37 offset:6144
  ds_read_b64_tr_b16 v[116:117], v38 offset:4096
  ds_read_b64_tr_b16 v[118:119], v38 offset:6144
  ds_read_b128 v[64:67], v253 offset:0
  ds_read_b128 v[68:71], v253 offset:64
  ds_read_b128 v[72:75], v253 offset:128
  ds_read_b128 v[76:79], v253 offset:192
  ds_read_b128 v[168:171], v253 offset:256
  ds_read_b128 v[172:175], v253 offset:320
  ds_read_b128 v[176:179], v253 offset:384
  ds_read_b128 v[180:183], v253 offset:448
  ds_read_b128 v[184:187], v253 offset:512
  ds_read_b128 v[188:191], v253 offset:576
  ds_read_b128 v[192:195], v253 offset:640
  ds_read_b128 v[196:199], v253 offset:704
  buffer_load_dword v87, v45, s[64:67], 0 offen sc1
  v_mov_b32 v252, v43
  v_accvgpr_read_b32 v48, a240
  v_accvgpr_read_b32 v49, a241
  v_accvgpr_read_b32 v50, a242
  v_accvgpr_read_b32 v51, a243
  v_accvgpr_read_b32 v52, a244
  v_accvgpr_read_b32 v53, a245
  v_accvgpr_read_b32 v54, a246
  v_accvgpr_read_b32 v55, a247
  v_accvgpr_read_b32 v56, a248
  v_accvgpr_read_b32 v57, a249
  v_accvgpr_read_b32 v58, a250
  v_accvgpr_read_b32 v59, a251
  v_accvgpr_read_b32 v60, a252
  v_accvgpr_read_b32 v61, a253
  v_accvgpr_read_b32 v62, a254
  v_accvgpr_read_b32 v63, a255
  s_lshl_b32 s41, s31, 18
  s_add_u32 s42, s41, 131072
  v_permlane16_swap_b32 v48, v50
  v_permlane16_swap_b32 v49, v51
  v_permlane16_swap_b32 v52, v54
  v_permlane16_swap_b32 v53, v55
  v_permlane16_swap_b32 v56, v58
  v_permlane16_swap_b32 v57, v59
  v_permlane16_swap_b32 v60, v62
  v_permlane16_swap_b32 v61, v63
  v_lshlrev_b32 v120, 16, v48
  v_and_b32 v121, 0xffff0000, v48
  v_lshlrev_b32 v122, 16, v49
  v_and_b32 v123, 0xffff0000, v49
  v_lshlrev_b32 v124, 16, v50
  v_and_b32 v125, 0xffff0000, v50
  v_lshlrev_b32 v126, 16, v51
  v_and_b32 v127, 0xffff0000, v51
  v_lshlrev_b32 v128, 16, v52
  v_and_b32 v129, 0xffff0000, v52
  v_lshlrev_b32 v130, 16, v53
  v_and_b32 v131, 0xffff0000, v53
  v_lshlrev_b32 v132, 16, v54
  v_and_b32 v133, 0xffff0000, v54
  v_lshlrev_b32 v134, 16, v55
  v_and_b32 v135, 0xffff0000, v55
  v_lshlrev_b32 v136, 16, v56
  v_and_b32 v137, 0xffff0000, v56
  v_lshlrev_b32 v138, 16, v57
  v_and_b32 v139, 0xffff0000, v57
  v_lshlrev_b32 v140, 16, v58
  v_and_b32 v141, 0xffff0000, v58
  v_lshlrev_b32 v142, 16, v59
  v_and_b32 v143, 0xffff0000, v59
  v_lshlrev_b32 v144, 16, v60
  v_and_b32 v145, 0xffff0000, v60
  v_lshlrev_b32 v146, 16, v61
  v_and_b32 v147, 0xffff0000, v61
  v_lshlrev_b32 v148, 16, v62
  v_and_b32 v149, 0xffff0000, v62
  v_lshlrev_b32 v150, 16, v63
  v_and_b32 v151, 0xffff0000, v63
  s_add_u32 s52, s20, 0x180000
  s_addc_u32 s53, s21, 0
  s_mov_b32 s54, 0x80000
  s_mov_b32 s55, 0x20000
  s_lshl2_add_u32 s56, s30, s3
  s_lshl_b32 s56, s56, 12
  s_lshl_b32 s57, s31, 8
  s_add_u32 s57, s57, s56
  v_mov_b32 v81, 0xffffff00
  v_mov_b32 v216, 0x3e003e00
  v_mov_b32 v217, 0x3e003e00
  v_mov_b32 v218, 0x3e003e00
  v_mov_b32 v219, 0x3e003e00
  v_lshrrev_b32 v83, 2, v44
  v_xor_b32 v83, v83, v47
  v_lshlrev_b32 v83, 24, v83
  v_lshl_add_u32 v83, v44, 4, v83
  v_and_b32 v84, 1, v32
  v_cmp_ne_u32 s[34:35], 0, v84
  v_and_b32 v84, 2, v32
  v_cmp_ne_u32 s[36:37], 0, v84
  s_mov_b32 s33, 262144
L_spin_15:
  s_waitcnt vmcnt(0)
  v_cmp_ne_u32 vcc, s19, v87
  s_nop 1
  s_and_b32 s32, vcc_lo, 0xffff
  s_cbranch_scc0 L_rdy_16
  buffer_load_dword v87, v45, s[64:67], 0 offen sc1
  s_sub_u32 s33, s33, 1
  s_cmp_lg_u32 s33, 0
  s_cbranch_scc1 L_spin_15
L_rdy_16:
  buffer_load_dwordx4 a[0:3], v33, s[4:7], s16 offen offset:0 sc1
  buffer_load_dwordx4 a[4:7], v33, s[4:7], s16 offen offset:1024 sc1
  buffer_load_dwordx4 a[8:11], v34, s[4:7], s16 offen offset:0 sc1
  buffer_load_dwordx4 a[12:15], v34, s[4:7], s16 offen offset:1024 sc1
  s_add_u32 s16, s16, 262144
  s_bitset0_b32 s16, 22
  buffer_load_dwordx4 a[16:19], v33, s[4:7], s16 offen offset:0 sc1
  buffer_load_dwordx4 a[20:23], v33, s[4:7], s16 offen offset:1024 sc1
  buffer_load_dwordx4 a[24:27], v34, s[4:7], s16 offen offset:0 sc1
  buffer_load_dwordx4 a[28:31], v34, s[4:7], s16 offen offset:1024 sc1
  s_add_u32 s16, s16, 262144
  s_bitset0_b32 s16, 22
  buffer_load_dwordx4 a[32:35], v33, s[4:7], s16 offen offset:0 sc1
  buffer_load_dwordx4 a[36:39], v33, s[4:7], s16 offen offset:1024 sc1
  buffer_load_dwordx4 a[40:43], v34, s[4:7], s16 offen offset:0 sc1
  buffer_load_dwordx4 a[44:47], v34, s[4:7], s16 offen offset:1024 sc1
  s_add_u32 s16, s16, 262144
  s_bitset0_b32 s16, 22
  buffer_load_dwordx4 a[48:51], v33, s[4:7], s16 offen offset:0 sc1
  buffer_load_dwordx4 a[52:55], v33, s[4:7], s16 offen offset:1024 sc1
  buffer_load_dwordx4 a[56:59], v34, s[4:7], s16 offen offset:0 sc1
  buffer_load_dwordx4 a[60:63], v34, s[4:7], s16 offen offset:1024 sc1
  s_add_u32 s16, s16, 262144
  s_bitset0_b32 s16, 22
  s_waitcnt vmcnt(12) lgkmcnt(10)
  v_mfma_f32_16x16x32_bf16 v[0:3], v[88:91], a[0:3], 0
  buffer_load_dwordx4 a[64:67], v33, s[4:7], s16 offen offset:0 sc1
  v_mfma_f32_16x16x32_bf16 v[16:19], v[88:91], a[4:7], 0
  ds_read_b64_tr_b16 v[88:89], v35 offset:8192
  ds_read_b64_tr_b16 v[90:91], v35 offset:10240
  v_mfma_f32_16x16x32_bf16 v[4:7], v[92:95], a[0:3], 0
  buffer_load_dwordx4 a[68:71], v33, s[4:7], s16 offen offset:1024 sc1
  v_mfma_f32_16x16x32_bf16 v[20:23], v[92:95], a[4:7], 0
  ds_read_b64_tr_b16 v[92:93], v36 offset:8192
  ds_read_b64_tr_b16 v[94:95], v36 offset:10240
  v_mfma_f32_16x16x32_bf16 v[8:11], v[96:99], a[0:3], 0
  v_mfma_f32_16x16x32_bf16 v[24:27], v[96:99], a[4:7], 0
  buffer_load_dwordx4 a[72:75], v34, s[4:7], s16 offen offset:0 sc1
  v_mfma_f32_16x16x32_bf16 v[12:15], v[100:103], a[0:3], 0
  ds_read_b64_tr_b16 v[96:97], v37 offset:8192
  ds_read_b64_tr_b16 v[98:99], v37 offset:10240
  v_mfma_f32_16x16x32_bf16 v[28:31], v[100:103], a[4:7], 0
  buffer_load_dwordx4 a[76:79], v34, s[4:7], s16 offen offset:1024 sc1
  v_mfma_f32_16x16x32_bf16 v[0:3], v[104:107], a[8:11], v[0:3]
  ds_read_b64_tr_b16 v[100:101], v38 offset:8192
  ds_read_b64_tr_b16 v[102:103], v38 offset:10240
  v_mfma_f32_16x16x32_bf16 v[16:19], v[104:107], a[12:15], v[16:19]
  ds_read_b64_tr_b16 v[104:105], v35 offset:12288
  ds_read_b64_tr_b16 v[106:107], v35 offset:14336
  v_mfma_f32_16x16x32_bf16 v[4:7], v[108:111], a[8:11], v[4:7]
  s_add_u32 s16, s16, 262144
  v_mfma_f32_16x16x32_bf16 v[20:23], v[108:111], a[12:15], v[20:23]
  ds_read_b64_tr_b16 v[108:109], v36 offset:12288
  ds_read_b64_tr_b16 v[110:111], v36 offset:14336
  v_mfma_f32_16x16x32_bf16 v[8:11], v[112:115], a[8:11], v[8:11]
  s_bitset0_b32 s16, 22
  v_mfma_f32_16x16x32_bf16 v[24:27], v[112:115], a[12:15], v[24:27]
  ds_read_b64_tr_b16 v[112:113], v37 offset:12288
  ds_read_b64_tr_b16 v[114:115], v37 offset:14336
  v_mfma_f32_16x16x32_bf16 v[12:15], v[116:119], a[8:11], v[12:15]
  v_mfma_f32_16x16x32_bf16 v[28:31], v[116:119], a[12:15], v[28:31]
  s_waitcnt vmcnt(12) lgkmcnt(10)
  ds_read_b64_tr_b16 v[116:117], v38 offset:12288
  v_mfma_f32_16x16x32_bf16 v[0:3], v[88:91], a[16:19], v[0:3]
  buffer_load_dwordx4 a[80:83], v33, s[4:7], s16 offen offset:0 sc1
  v_mfma_f32_16x16x32_bf16 v[16:19], v[88:91], a[20:23], v[16:19]
  ds_read_b64_tr_b16 v[118:119], v38 offset:14336
  ds_read_b64_tr_b16 v[88:89], v35 offset:16384
  v_mfma_f32_16x16x32_bf16 v[4:7], v[92:95], a[16:19], v[4:7]
  buffer_load_dwordx4 a[84:87], v33, s[4:7], s16 offen offset:1024 sc1
  v_mfma_f32_16x16x32_bf16 v[20:23], v[92:95], a[20:23], v[20:23]
  ds_read_b64_tr_b16 v[90:91], v35 offset:18432
  ds_read_b64_tr_b16 v[92:93], v36 offset:16384
  s_waitcnt lgkmcnt(10)
  v_mfma_f32_16x16x32_bf16 v[8:11], v[96:99], a[16:19], v[8:11]
  ds_read_b64_tr_b16 v[94:95], v36 offset:18432
  v_mfma_f32_16x16x32_bf16 v[24:27], v[96:99], a[20:23], v[24:27]
  buffer_load_dwordx4 a[88:91], v34, s[4:7], s16 offen offset:0 sc1
  v_mfma_f32_16x16x32_bf16 v[12:15], v[100:103], a[16:19], v[12:15]
  ds_read_b64_tr_b16 v[96:97], v37 offset:16384
  ds_read_b64_tr_b16 v[98:99], v37 offset:18432
  v_mfma_f32_16x16x32_bf16 v[28:31], v[100:103], a[20:23], v[28:31]
  buffer_load_dwordx4 a[92:95], v34, s[4:7], s16 offen offset:1024 sc1
  s_waitcnt lgkmcnt(10)
  v_mfma_f32_16x16x32_bf16 v[0:3], v[104:107], a[24:27], v[0:3]
  ds_read_b64_tr_b16 v[100:101], v38 offset:16384
  ds_read_b64_tr_b16 v[102:103], v38 offset:18432
  v_mfma_f32_16x16x32_bf16 v[16:19], v[104:107], a[28:31], v[16:19]
  ds_read_b64_tr_b16 v[104:105], v35 offset:20480
  ds_read_b64_tr_b16 v[106:107], v35 offset:22528
  v_mfma_f32_16x16x32_bf16 v[4:7], v[108:111], a[24:27], v[4:7]
  s_add_u32 s16, s16, 262144
  v_mfma_f32_16x16x32_bf16 v[20:23], v[108:111], a[28:31], v[20:23]
  ds_read_b64_tr_b16 v[108:109], v36 offset:20480
  ds_read_b64_tr_b16 v[110:111], v36 offset:22528
  s_waitcnt lgkmcnt(10)
  v_mfma_f32_16x16x32_bf16 v[8:11], v[112:115], a[24:27], v[8:11]
  s_bitset0_b32 s16, 22
  v_mfma_f32_16x16x32_bf16 v[24:27], v[112:115], a[28:31], v[24:27]
  ds_read_b64_tr_b16 v[112:113], v37 offset:20480
  ds_read_b64_tr_b16 v[114:115], v37 offset:22528
  v_mfma_f32_16x16x32_bf16 v[12:15], v[116:119], a[24:27], v[12:15]
  v_mfma_f32_16x16x32_bf16 v[28:31], v[116:119], a[28:31], v[28:31]
  s_waitcnt vmcnt(12) lgkmcnt(10)
  ds_read_b64_tr_b16 v[116:117], v38 offset:20480
  v_mfma_f32_16x16x32_bf16 v[0:3], v[88:91], a[32:35], v[0:3]
  buffer_load_dwordx4 a[96:99], v33, s[4:7], s16 offen offset:0 sc1
  v_mfma_f32_16x16x32_bf16 v[16:19], v[88:91], a[36:39], v[16:19]
  ds_read_b64_tr_b16 v[118:119], v38 offset:22528
  ds_read_b64_tr_b16 v[88:89], v35 offset:24576
  v_mfma_f32_16x16x32_bf16 v[4:7], v[92:95], a[32:35], v[4:7]
  buffer_load_dwordx4 a[100:103], v33, s[4:7], s16 offen offset:1024 sc1
  v_mfma_f32_16x16x32_bf16 v[20:23], v[92:95], a[36:39], v[20:23]
  ds_read_b64_tr_b16 v[90:91], v35 offset:26624
  ds_read_b64_tr_b16 v[92:93], v36 offset:24576
  s_waitcnt lgkmcnt(10)
  v_mfma_f32_16x16x32_bf16 v[8:11], v[96:99], a[32:35], v[8:11]
  ds_read_b64_tr_b16 v[94:95], v36 offset:26624
  v_mfma_f32_16x16x32_bf16 v[24:27], v[96:99], a[36:39], v[24:27]
  buffer_load_dwordx4 a[104:107], v34, s[4:7], s16 offen offset:0 sc1
  v_mfma_f32_16x16x32_bf16 v[12:15], v[100:103], a[32:35], v[12:15]
  ds_read_b64_tr_b16 v[96:97], v37 offset:24576
  ds_read_b64_tr_b16 v[98:99], v37 offset:26624
  v_mfma_f32_16x16x32_bf16 v[28:31], v[100:103], a[36:39], v[28:31]
  buffer_load_dwordx4 a[108:111], v34, s[4:7], s16 offen offset:1024 sc1
  s_waitcnt lgkmcnt(10)
  v_mfma_f32_16x16x32_bf16 v[0:3], v[104:107], a[40:43], v[0:3]
  ds_read_b64_tr_b16 v[100:101], v38 offset:24576
  ds_read_b64_tr_b16 v[102:103], v38 offset:26624
  v_mfma_f32_16x16x32_bf16 v[16:19], v[104:107], a[44:47], v[16:19]
  ds_read_b64_tr_b16 v[104:105], v35 offset:28672
  ds_read_b64_tr_b16 v[106:107], v35 offset:30720
  v_mfma_f32_16x16x32_bf16 v[4:7], v[108:111], a[40:43], v[4:7]
  s_add_u32 s16, s16, 262144
  v_mfma_f32_16x16x32_bf16 v[20:23], v[108:111], a[44:47], v[20:23]
  ds_read_b64_tr_b16 v[108:109], v36 offset:28672
  ds_read_b64_tr_b16 v[110:111], v36 offset:30720
  s_waitcnt lgkmcnt(10)
  v_mfma_f32_16x16x32_bf16 v[8:11], v[112:115], a[40:43], v[8:11]
  s_bitset0_b32 s16, 22
  v_mfma_f32_16x16x32_bf16 v[24:27], v[112:115], a[44:47], v[24:27]
  ds_read_b64_tr_b16 v[112:113], v37 offset:28672
  ds_read_b64_tr_b16 v[114:115], v37 offset:30720
  v_mfma_f32_16x16x32_bf16 v[12:15], v[116:119], a[40:43], v[12:15]
  v_mfma_f32_16x16x32_bf16 v[28:31], v[116:119], a[44:47], v[28:31]
  s_waitcnt vmcnt(12) lgkmcnt(10)
  ds_read_b64_tr_b16 v[116:117], v38 offset:28672
  v_mfma_f32_16x16x32_bf16 v[0:3], v[88:91], a[48:51], v[0:3]
  buffer_load_dwordx4 a[112:115], v33, s[4:7], s16 offen offset:0 sc1
  v_mfma_f32_16x16x32_bf16 v[16:19], v[88:91], a[52:55], v[16:19]
  ds_read_b64_tr_b16 v[118:119], v38 offset:30720
  ds_read_b64_tr_b16 v[88:89], v35 offset:32768
  v_mfma_f32_16x16x32_bf16 v[4:7], v[92:95], a[48:51], v[4:7]
  buffer_load_dwordx4 a[116:119], v33, s[4:7], s16 offen offset:1024 sc1
  v_mfma_f32_16x16x32_bf16 v[20:23], v[92:95], a[52:55], v[20:23]
  ds_read_b64_tr_b16 v[90:91], v35 offset:34816
  ds_read_b64_tr_b16 v[92:93], v36 offset:32768
  s_waitcnt lgkmcnt(10)
  v_mfma_f32_16x16x32_bf16 v[8:11], v[96:99], a[48:51], v[8:11]
  ds_read_b64_tr_b16 v[94:95], v36 offset:34816
  v_mfma_f32_16x16x32_bf16 v[24:27], v[96:99], a[52:55], v[24:27]
  buffer_load_dwordx4 a[120:123], v34, s[4:7], s16 offen offset:0 sc1
  v_mfma_f32_16x16x32_bf16 v[12:15], v[100:103], a[48:51], v[12:15]
  ds_read_b64_tr_b16 v[96:97], v37 offset:32768
  ds_read_b64_tr_b16 v[98:99], v37 offset:34816
  v_mfma_f32_16x16x32_bf16 v[28:31], v[100:103], a[52:55], v[28:31]
  buffer_load_dwordx4 a[124:127], v34, s[4:7], s16 offen offset:1024 sc1
  s_waitcnt lgkmcnt(10)
  v_mfma_f32_16x16x32_bf16 v[0:3], v[104:107], a[56:59], v[0:3]
  ds_read_b64_tr_b16 v[100:101], v38 offset:32768
  ds_read_b64_tr_b16 v[102:103], v38 offset:34816
  v_mfma_f32_16x16x32_bf16 v[16:19], v[104:107], a[60:63], v[16:19]
  ds_read_b64_tr_b16 v[104:105], v35 offset:36864
  ds_read_b64_tr_b16 v[106:107], v35 offset:38912
  v_mfma_f32_16x16x32_bf16 v[4:7], v[108:111], a[56:59], v[4:7]
  s_add_u32 s16, s16, 262144
  v_mfma_f32_16x16x32_bf16 v[20:23], v[108:111], a[60:63], v[20:23]
  ds_read_b64_tr_b16 v[108:109], v36 offset:36864
  ds_read_b64_tr_b16 v[110:111], v36 offset:38912
  s_waitcnt lgkmcnt(10)
  v_mfma_f32_16x16x32_bf16 v[8:11], v[112:115], a[56:59], v[8:11]
  s_bitset0_b32 s16, 22
  v_mfma_f32_16x16x32_bf16 v[24:27], v[112:115], a[60:63], v[24:27]
  ds_read_b64_tr_b16 v[112:113], v37 offset:36864
  ds_read_b64_tr_b16 v[114:115], v37 offset:38912
  v_mfma_f32_16x16x32_bf16 v[12:15], v[116:119], a[56:59], v[12:15]
  v_mfma_f32_16x16x32_bf16 v[28:31], v[116:119], a[60:63], v[28:31]
  s_waitcnt vmcnt(12) lgkmcnt(10)
  ds_read_b64_tr_b16 v[116:117], v38 offset:36864
  v_mfma_f32_16x16x32_bf16 v[0:3], v[88:91], a[64:67], v[0:3]
  buffer_load_dwordx4 a[0:3], v33, s[4:7], s16 offen offset:0 sc1
  v_mfma_f32_16x16x32_bf16 v[16:19], v[88:91], a[68:71], v[16:19]
  ds_read_b64_tr_b16 v[118:119], v38 offset:38912
  ds_read_b64_tr_b16 v[88:89], v35 offset:40960
  v_mfma_f32_16x16x32_bf16 v[4:7], v[92:95], a[64:67], v[4:7]
  buffer_load_dwordx4 a[4:7], v33, s[4:7], s16 offen offset:1024 sc1
  v_mfma_f32_16x16x32_bf16 v[20:23], v[92:95], a[68:71], v[20:23]
  ds_read_b64_tr_b16 v[90:91], v35 offset:43008
  ds_read_b64_tr_b16 v[92:93], v36 offset:40960
  s_waitcnt lgkmcnt(10)
  v_mfma_f32_16x16x32_bf16 v[8:11], v[96:99], a[64:67], v[8:11]
  ds_read_b64_tr_b16 v[94:95], v36 offset:43008
  v_mfma_f32_16x16x32_bf16 v[24:27], v[96:99], a[68:71], v[24:27]
  buffer_load_dwordx4 a[8:11], v34, s[4:7], s16 offen offset:0 sc1
  v_mfma_f32_16x16x32_bf16 v[12:15], v[100:103], a[64:67], v[12:15]
  ds_read_b64_tr_b16 v[96:97], v37 offset:40960
  ds_read_b64_tr_b16 v[98:99], v37 offset:43008
  v_mfma_f32_16x16x32_bf16 v[28:31], v[100:103], a[68:71], v[28:31]
  buffer_load_dwordx4 a[12:15], v34, s[4:7], s16 offen offset:1024 sc1
  s_waitcnt lgkmcnt(10)
  v_mfma_f32_16x16x32_bf16 v[0:3], v[104:107], a[72:75], v[0:3]
  ds_read_b64_tr_b16 v[100:101], v38 offset:40960
  ds_read_b64_tr_b16 v[102:103], v38 offset:43008
  v_mfma_f32_16x16x32_bf16 v[16:19], v[104:107], a[76:79], v[16:19]
  ds_read_b64_tr_b16 v[104:105], v35 offset:45056
  ds_read_b64_tr_b16 v[106:107], v35 offset:47104
  v_mfma_f32_16x16x32_bf16 v[4:7], v[108:111], a[72:75], v[4:7]
  s_add_u32 s16, s16, 262144
  v_mfma_f32_16x16x32_bf16 v[20:23], v[108:111], a[76:79], v[20:23]
  ds_read_b64_tr_b16 v[108:109], v36 offset:45056
  ds_read_b64_tr_b16 v[110:111], v36 offset:47104
  s_waitcnt lgkmcnt(10)
  v_mfma_f32_16x16x32_bf16 v[8:11], v[112:115], a[72:75], v[8:11]
  s_bitset0_b32 s16, 22
  v_mfma_f32_16x16x32_bf16 v[24:27], v[112:115], a[76:79], v[24:27]
  ds_read_b64_tr_b16 v[112:113], v37 offset:45056
  ds_read_b64_tr_b16 v[114:115], v37 offset:47104
  v_mfma_f32_16x16x32_bf16 v[12:15], v[116:119], a[72:75], v[12:15]
  v_mfma_f32_16x16x32_bf16 v[28:31], v[116:119], a[76:79], v[28:31]
  s_waitcnt vmcnt(12) lgkmcnt(10)
  ds_read_b64_tr_b16 v[116:117], v38 offset:45056
  v_mfma_f32_16x16x32_bf16 v[0:3], v[88:91], a[80:83], v[0:3]
  buffer_load_dwordx4 a[16:19], v33, s[4:7], s16 offen offset:0 sc1
  v_mfma_f32_16x16x32_bf16 v[16:19], v[88:91], a[84:87], v[16:19]
  ds_read_b64_tr_b16 v[118:119], v38 offset:47104
  ds_read_b64_tr_b16 v[88:89], v35 offset:49152
  v_mfma_f32_16x16x32_bf16 v[4:7], v[92:95], a[80:83], v[4:7]
  buffer_load_dwordx4 a[20:23], v33, s[4:7], s16 offen offset:1024 sc1
  v_mfma_f32_16x16x32_bf16 v[20:23], v[92:95], a[84:87], v[20:23]
  ds_read_b64_tr_b16 v[90:91], v35 offset:51200
  ds_read_b64_tr_b16 v[92:93], v36 offset:49152
  s_waitcnt lgkmcnt(10)
  v_mfma_f32_16x16x32_bf16 v[8:11], v[96:99], a[80:83], v[8:11]
  ds_read_b64_tr_b16 v[94:95], v36 offset:51200
  v_mfma_f32_16x16x32_bf16 v[24:27], v[96:99], a[84:87], v[24:27]
  buffer_load_dwordx4 a[24:27], v34, s[4:7], s16 offen offset:0 sc1
  v_mfma_f32_16x16x32_bf16 v[12:15], v[100:103], a[80:83], v[12:15]
  ds_read_b64_tr_b16 v[96:97], v37 offset:49152
  ds_read_b64_tr_b16 v[98:99], v37 offset:51200
  v_mfma_f32_16x16x32_bf16 v[28:31], v[100:103], a[84:87], v[28:31]
  buffer_load_dwordx4 a[28:31], v34, s[4:7], s16 offen offset:1024 sc1
  s_waitcnt lgkmcnt(10)
  v_mfma_f32_16x16x32_bf16 v[0:3], v[104:107], a[88:91], v[0:3]
  ds_read_b64_tr_b16 v[100:101], v38 offset:49152
  ds_read_b64_tr_b16 v[102:103], v38 offset:51200
  v_mfma_f32_16x16x32_bf16 v[16:19], v[104:107], a[92:95], v[16:19]
  ds_read_b64_tr_b16 v[104:105], v35 offset:53248
  ds_read_b64_tr_b16 v[106:107], v35 offset:55296
  v_mfma_f32_16x16x32_bf16 v[4:7], v[108:111], a[88:91], v[4:7]
  s_add_u32 s16, s16, 262144
  v_mfma_f32_16x16x32_bf16 v[20:23], v[108:111], a[92:95], v[20:23]
  ds_read_b64_tr_b16 v[108:109], v36 offset:53248
  ds_read_b64_tr_b16 v[110:111], v36 offset:55296
  s_waitcnt lgkmcnt(10)
  v_mfma_f32_16x16x32_bf16 v[8:11], v[112:115], a[88:91], v[8:11]
  s_bitset0_b32 s16, 22
  v_mfma_f32_16x16x32_bf16 v[24:27], v[112:115], a[92:95], v[24:27]
  ds_read_b64_tr_b16 v[112:113], v37 offset:53248
  ds_read_b64_tr_b16 v[114:115], v37 offset:55296
  v_mfma_f32_16x16x32_bf16 v[12:15], v[116:119], a[88:91], v[12:15]
  v_mfma_f32_16x16x32_bf16 v[28:31], v[116:119], a[92:95], v[28:31]
  s_waitcnt vmcnt(12) lgkmcnt(10)
  ds_read_b64_tr_b16 v[116:117], v38 offset:53248
  v_mfma_f32_16x16x32_bf16 v[0:3], v[88:91], a[96:99], v[0:3]
  buffer_load_dwordx4 a[32:35], v33, s[4:7], s16 offen offset:0 sc1
  v_mfma_f32_16x16x32_bf16 v[16:19], v[88:91], a[100:103], v[16:19]
  ds_read_b64_tr_b16 v[118:119], v38 offset:55296
  ds_read_b64_tr_b16 v[88:89], v35 offset:57344
  v_mfma_f32_16x16x32_bf16 v[4:7], v[92:95], a[96:99], v[4:7]
  buffer_load_dwordx4 a[36:39], v33, s[4:7], s16 offen offset:1024 sc1
  v_mfma_f32_16x16x32_bf16 v[20:23], v[92:95], a[100:103], v[20:23]
  ds_read_b64_tr_b16 v[90:91], v35 offset:59392
  ds_read_b64_tr_b16 v[92:93], v36 offset:57344
  s_waitcnt lgkmcnt(10)
  v_mfma_f32_16x16x32_bf16 v[8:11], v[96:99], a[96:99], v[8:11]
  ds_read_b64_tr_b16 v[94:95], v36 offset:59392
  v_mfma_f32_16x16x32_bf16 v[24:27], v[96:99], a[100:103], v[24:27]
  buffer_load_dwordx4 a[40:43], v34, s[4:7], s16 offen offset:0 sc1
  v_mfma_f32_16x16x32_bf16 v[12:15], v[100:103], a[96:99], v[12:15]
  ds_read_b64_tr_b16 v[96:97], v37 offset:57344
  ds_read_b64_tr_b16 v[98:99], v37 offset:59392
  v_mfma_f32_16x16x32_bf16 v[28:31], v[100:103], a[100:103], v[28:31]
  buffer_load_dwordx4 a[44:47], v34, s[4:7], s16 offen offset:1024 sc1
  s_waitcnt lgkmcnt(10)
  v_mfma_f32_16x16x32_bf16 v[0:3], v[104:107], a[104:107], v[0:3]
  ds_read_b64_tr_b16 v[100:101], v38 offset:57344
  ds_read_b64_tr_b16 v[102:103], v38 offset:59392
  v_mfma_f32_16x16x32_bf16 v[16:19], v[104:107], a[108:111], v[16:19]
  ds_read_b64_tr_b16 v[104:105], v35 offset:61440
  ds_read_b64_tr_b16 v[106:107], v35 offset:63488
  v_mfma_f32_16x16x32_bf16 v[4:7], v[108:111], a[104:107], v[4:7]
  s_add_u32 s16, s16, 262144
  v_mfma_f32_16x16x32_bf16 v[20:23], v[108:111], a[108:111], v[20:23]
  ds_read_b64_tr_b16 v[108:109], v36 offset:61440
  ds_read_b64_tr_b16 v[110:111], v36 offset:63488
  s_waitcnt lgkmcnt(10)
  v_mfma_f32_16x16x32_bf16 v[8:11], v[112:115], a[104:107], v[8:11]
  s_bitset0_b32 s16, 22
  v_mfma_f32_16x16x32_bf16 v[24:27], v[112:115], a[108:111], v[24:27]
  ds_read_b64_tr_b16 v[112:113], v37 offset:61440
  ds_read_b64_tr_b16 v[114:115], v37 offset:63488
  v_mfma_f32_16x16x32_bf16 v[12:15], v[116:119], a[104:107], v[12:15]
  v_mfma_f32_16x16x32_bf16 v[28:31], v[116:119], a[108:111], v[28:31]
  s_waitcnt vmcnt(12) lgkmcnt(10)
  ds_read_b64_tr_b16 v[116:117], v38 offset:61440
  v_mfma_f32_16x16x32_bf16 v[0:3], v[88:91], a[112:115], v[0:3]
  buffer_load_dwordx4 a[48:51], v33, s[4:7], s16 offen offset:0 sc1
  v_mfma_f32_16x16x32_bf16 v[16:19], v[88:91], a[116:119], v[16:19]
  ds_read_b64_tr_b16 v[118:119], v38 offset:63488
  ds_read_b64_tr_b16 v[88:89], v39 offset:0
  v_mfma_f32_16x16x32_bf16 v[4:7], v[92:95], a[112:115], v[4:7]
  buffer_load_dwordx4 a[52:55], v33, s[4:7], s16 offen offset:1024 sc1
  v_mfma_f32_16x16x32_bf16 v[20:23], v[92:95], a[116:119], v[20:23]
  ds_read_b64_tr_b16 v[90:91], v39 offset:2048
  ds_read_b64_tr_b16 v[92:93], v40 offset:0
  s_waitcnt lgkmcnt(10)
  v_mfma_f32_16x16x32_bf16 v[8:11], v[96:99], a[112:115], v[8:11]
  ds_read_b64_tr_b16 v[94:95], v40 offset:2048
  v_mfma_f32_16x16x32_bf16 v[24:27], v[96:99], a[116:119], v[24:27]
  buffer_load_dwordx4 a[56:59], v34, s[4:7], s16 offen offset:0 sc1
  v_mfma_f32_16x16x32_bf16 v[12:15], v[100:103], a[112:115], v[12:15]
  ds_read_b64_tr_b16 v[96:97], v41 offset:0
  ds_read_b64_tr_b16 v[98:99], v41 offset:2048
  v_mfma_f32_16x16x32_bf16 v[28:31], v[100:103], a[116:119], v[28:31]
  buffer_load_dwordx4 a[60:63], v34, s[4:7], s16 offen offset:1024 sc1
  s_waitcnt lgkmcnt(10)
  v_mfma_f32_16x16x32_bf16 v[0:3], v[104:107], a[120:123], v[0:3]
  ds_read_b64_tr_b16 v[100:101], v42 offset:0
  ds_read_b64_tr_b16 v[102:103], v42 offset:2048
  v_mfma_f32_16x16x32_bf16 v[16:19], v[104:107], a[124:127], v[16:19]
  ds_read_b64_tr_b16 v[104:105], v39 offset:4096
  ds_read_b64_tr_b16 v[106:107], v39 offset:6144
  v_mfma_f32_16x16x32_bf16 v[4:7], v[108:111], a[120:123], v[4:7]
  s_add_u32 s16, s16, 262144
  v_mfma_f32_16x16x32_bf16 v[20:23], v[108:111], a[124:127], v[20:23]
  ds_read_b64_tr_b16 v[108:109], v40 offset:4096
  ds_read_b64_tr_b16 v[110:111], v40 offset:6144
  s_waitcnt lgkmcnt(10)
  v_mfma_f32_16x16x32_bf16 v[8:11], v[112:115], a[120:123], v[8:11]
  s_bitset0_b32 s16, 22
  v_mfma_f32_16x16x32_bf16 v[24:27], v[112:115], a[124:127], v[24:27]
  ds_read_b64_tr_b16 v[112:113], v41 offset:4096
  ds_read_b64_tr_b16 v[114:115], v41 offset:6144
  v_mfma_f32_16x16x32_bf16 v[12:15], v[116:119], a[120:123], v[12:15]
  v_mfma_f32_16x16x32_bf16 v[28:31], v[116:119], a[124:127], v[28:31]
  s_waitcnt vmcnt(12) lgkmcnt(10)
  ds_read_b64_tr_b16 v[116:117], v42 offset:4096
  v_mfma_f32_16x16x32_bf16 v[0:3], v[88:91], a[0:3], v[0:3]
  buffer_load_dwordx4 a[64:67], v33, s[4:7], s16 offen offset:0 sc1
  v_mfma_f32_16x16x32_bf16 v[16:19], v[88:91], a[4:7], v[16:19]
  ds_read_b64_tr_b16 v[118:119], v42 offset:6144
  ds_read_b64_tr_b16 v[88:89], v39 offset:8192
  v_mfma_f32_16x16x32_bf16 v[4:7], v[92:95], a[0:3], v[4:7]
  buffer_load_dwordx4 a[68:71], v33, s[4:7], s16 offen offset:1024 sc1
  v_mfma_f32_16x16x32_bf16 v[20:23], v[92:95], a[4:7], v[20:23]
  ds_read_b64_tr_b16 v[90:91], v39 offset:10240
  ds_read_b64_tr_b16 v[92:93], v40 offset:8192
  s_waitcnt lgkmcnt(10)
  v_mfma_f32_16x16x32_bf16 v[8:11], v[96:99], a[0:3], v[8:11]
  ds_read_b64_tr_b16 v[94:95], v40 offset:10240
  v_mfma_f32_16x16x32_bf16 v[24:27], v[96:99], a[4:7], v[24:27]
  buffer_load_dwordx4 a[72:75], v34, s[4:7], s16 offen offset:0 sc1
  v_mfma_f32_16x16x32_bf16 v[12:15], v[100:103], a[0:3], v[12:15]
  ds_read_b64_tr_b16 v[96:97], v41 offset:8192
  ds_read_b64_tr_b16 v[98:99], v41 offset:10240
  v_mfma_f32_16x16x32_bf16 v[28:31], v[100:103], a[4:7], v[28:31]
  buffer_load_dwordx4 a[76:79], v34, s[4:7], s16 offen offset:1024 sc1
  s_waitcnt lgkmcnt(10)
  v_mfma_f32_16x16x32_bf16 v[0:3], v[104:107], a[8:11], v[0:3]
  ds_read_b64_tr_b16 v[100:101], v42 offset:8192
  ds_read_b64_tr_b16 v[102:103], v42 offset:10240
  v_mfma_f32_16x16x32_bf16 v[16:19], v[104:107], a[12:15], v[16:19]
  ds_read_b64_tr_b16 v[104:105], v39 offset:12288
  ds_read_b64_tr_b16 v[106:107], v39 offset:14336
  v_mfma_f32_16x16x32_bf16 v[4:7], v[108:111], a[8:11], v[4:7]
  s_add_u32 s16, s16, 262144
  v_mfma_f32_16x16x32_bf16 v[20:23], v[108:111], a[12:15], v[20:23]
  ds_read_b64_tr_b16 v[108:109], v40 offset:12288
  ds_read_b64_tr_b16 v[110:111], v40 offset:14336
  s_waitcnt lgkmcnt(10)
  v_mfma_f32_16x16x32_bf16 v[8:11], v[112:115], a[8:11], v[8:11]
  s_bitset0_b32 s16, 22
  v_mfma_f32_16x16x32_bf16 v[24:27], v[112:115], a[12:15], v[24:27]
  ds_read_b64_tr_b16 v[112:113], v41 offset:12288
  ds_read_b64_tr_b16 v[114:115], v41 offset:14336
  v_mfma_f32_16x16x32_bf16 v[12:15], v[116:119], a[8:11], v[12:15]
  v_mfma_f32_16x16x32_bf16 v[28:31], v[116:119], a[12:15], v[28:31]
  s_waitcnt vmcnt(12) lgkmcnt(10)
  ds_read_b64_tr_b16 v[116:117], v42 offset:12288
  v_mfma_f32_16x16x32_bf16 v[0:3], v[88:91], a[16:19], v[0:3]
  buffer_load_dwordx4 a[80:83], v33, s[4:7], s16 offen offset:0 sc1
  v_mfma_f32_16x16x32_bf16 v[16:19], v[88:91], a[20:23], v[16:19]
  ds_read_b64_tr_b16 v[118:119], v42 offset:14336
  ds_read_b64_tr_b16 v[88:89], v39 offset:16384
  v_mfma_f32_16x16x32_bf16 v[4:7], v[92:95], a[16:19], v[4:7]
  buffer_load_dwordx4 a[84:87], v33, s[4:7], s16 offen offset:1024 sc1
  v_mfma_f32_16x16x32_bf16 v[20:23], v[92:95], a[20:23], v[20:23]
  ds_read_b64_tr_b16 v[90:91], v39 offset:18432
  ds_read_b64_tr_b16 v[92:93], v40 offset:16384
  s_waitcnt lgkmcnt(10)
  v_mfma_f32_16x16x32_bf16 v[8:11], v[96:99], a[16:19], v[8:11]
  ds_read_b64_tr_b16 v[94:95], v40 offset:18432
  v_mfma_f32_16x16x32_bf16 v[24:27], v[96:99], a[20:23], v[24:27]
  buffer_load_dwordx4 a[88:91], v34, s[4:7], s16 offen offset:0 sc1
  v_mfma_f32_16x16x32_bf16 v[12:15], v[100:103], a[16:19], v[12:15]
  ds_read_b64_tr_b16 v[96:97], v41 offset:16384
  ds_read_b64_tr_b16 v[98:99], v41 offset:18432
  v_mfma_f32_16x16x32_bf16 v[28:31], v[100:103], a[20:23], v[28:31]
  buffer_load_dwordx4 a[92:95], v34, s[4:7], s16 offen offset:1024 sc1
  s_waitcnt lgkmcnt(10)
  v_mfma_f32_16x16x32_bf16 v[0:3], v[104:107], a[24:27], v[0:3]
  ds_read_b64_tr_b16 v[100:101], v42 offset:16384
  ds_read_b64_tr_b16 v[102:103], v42 offset:18432
  v_mfma_f32_16x16x32_bf16 v[16:19], v[104:107], a[28:31], v[16:19]
  ds_read_b64_tr_b16 v[104:105], v39 offset:20480
  ds_read_b64_tr_b16 v[106:107], v39 offset:22528
  v_mfma_f32_16x16x32_bf16 v[4:7], v[108:111], a[24:27], v[4:7]
  s_add_u32 s16, s16, 262144
  v_mfma_f32_16x16x32_bf16 v[20:23], v[108:111], a[28:31], v[20:23]
  ds_read_b64_tr_b16 v[108:109], v40 offset:20480
  ds_read_b64_tr_b16 v[110:111], v40 offset:22528
  s_waitcnt lgkmcnt(10)
  v_mfma_f32_16x16x32_bf16 v[8:11], v[112:115], a[24:27], v[8:11]
  s_bitset0_b32 s16, 22
  v_mfma_f32_16x16x32_bf16 v[24:27], v[112:115], a[28:31], v[24:27]
  ds_read_b64_tr_b16 v[112:113], v41 offset:20480
  ds_read_b64_tr_b16 v[114:115], v41 offset:22528
  v_mfma_f32_16x16x32_bf16 v[12:15], v[116:119], a[24:27], v[12:15]
  v_mfma_f32_16x16x32_bf16 v[28:31], v[116:119], a[28:31], v[28:31]
  s_waitcnt vmcnt(12) lgkmcnt(10)
  ds_read_b64_tr_b16 v[116:117], v42 offset:20480
  v_mfma_f32_16x16x32_bf16 v[0:3], v[88:91], a[32:35], v[0:3]
  buffer_load_dwordx4 a[96:99], v33, s[4:7], s16 offen offset:0 sc1
  v_mfma_f32_16x16x32_bf16 v[16:19], v[88:91], a[36:39], v[16:19]
  ds_read_b64_tr_b16 v[118:119], v42 offset:22528
  ds_read_b64_tr_b16 v[88:89], v39 offset:24576
  v_mfma_f32_16x16x32_bf16 v[4:7], v[92:95], a[32:35], v[4:7]
  buffer_load_dwordx4 a[100:103], v33, s[4:7], s16 offen offset:1024 sc1
  v_mfma_f32_16x16x32_bf16 v[20:23], v[92:95], a[36:39], v[20:23]
  ds_read_b64_tr_b16 v[90:91], v39 offset:26624
  ds_read_b64_tr_b16 v[92:93], v40 offset:24576
  s_waitcnt lgkmcnt(10)
  v_mfma_f32_16x16x32_bf16 v[8:11], v[96:99], a[32:35], v[8:11]
  ds_read_b64_tr_b16 v[94:95], v40 offset:26624
  v_mfma_f32_16x16x32_bf16 v[24:27], v[96:99], a[36:39], v[24:27]
  buffer_load_dwordx4 a[104:107], v34, s[4:7], s16 offen offset:0 sc1
  v_mfma_f32_16x16x32_bf16 v[12:15], v[100:103], a[32:35], v[12:15]
  ds_read_b64_tr_b16 v[96:97], v41 offset:24576
  ds_read_b64_tr_b16 v[98:99], v41 offset:26624
  v_mfma_f32_16x16x32_bf16 v[28:31], v[100:103], a[36:39], v[28:31]
  buffer_load_dwordx4 a[108:111], v34, s[4:7], s16 offen offset:1024 sc1
  s_waitcnt lgkmcnt(10)
  v_mfma_f32_16x16x32_bf16 v[0:3], v[104:107], a[40:43], v[0:3]
  ds_read_b64_tr_b16 v[100:101], v42 offset:24576
  ds_read_b64_tr_b16 v[102:103], v42 offset:26624
  v_mfma_f32_16x16x32_bf16 v[16:19], v[104:107], a[44:47], v[16:19]
  ds_read_b64_tr_b16 v[104:105], v39 offset:28672
  ds_read_b64_tr_b16 v[106:107], v39 offset:30720
  v_mfma_f32_16x16x32_bf16 v[4:7], v[108:111], a[40:43], v[4:7]
  s_add_u32 s16, s16, 262144
  v_mfma_f32_16x16x32_bf16 v[20:23], v[108:111], a[44:47], v[20:23]
  ds_read_b64_tr_b16 v[108:109], v40 offset:28672
  ds_read_b64_tr_b16 v[110:111], v40 offset:30720
  s_waitcnt lgkmcnt(10)
  v_mfma_f32_16x16x32_bf16 v[8:11], v[112:115], a[40:43], v[8:11]
  s_bitset0_b32 s16, 22
  v_mfma_f32_16x16x32_bf16 v[24:27], v[112:115], a[44:47], v[24:27]
  ds_read_b64_tr_b16 v[112:113], v41 offset:28672
  ds_read_b64_tr_b16 v[114:115], v41 offset:30720
  v_mfma_f32_16x16x32_bf16 v[12:15], v[116:119], a[40:43], v[12:15]
  v_mfma_f32_16x16x32_bf16 v[28:31], v[116:119], a[44:47], v[28:31]
  s_waitcnt vmcnt(12) lgkmcnt(10)
  ds_read_b64_tr_b16 v[116:117], v42 offset:28672
  v_mfma_f32_16x16x32_bf16 v[0:3], v[88:91], a[48:51], v[0:3]
  buffer_load_dwordx4 a[112:115], v33, s[4:7], s16 offen offset:0 sc1
  v_mfma_f32_16x16x32_bf16 v[16:19], v[88:91], a[52:55], v[16:19]
  ds_read_b64_tr_b16 v[118:119], v42 offset:30720
  ds_read_b64_tr_b16 v[88:89], v39 offset:32768
  v_mfma_f32_16x16x32_bf16 v[4:7], v[92:95], a[48:51], v[4:7]
  buffer_load_dwordx4 a[116:119], v33, s[4:7], s16 offen offset:1024 sc1
  v_mfma_f32_16x16x32_bf16 v[20:23], v[92:95], a[52:55], v[20:23]
  ds_read_b64_tr_b16 v[90:91], v39 offset:34816
  ds_read_b64_tr_b16 v[92:93], v40 offset:32768
  s_waitcnt lgkmcnt(10)
  v_mfma_f32_16x16x32_bf16 v[8:11], v[96:99], a[48:51], v[8:11]
  ds_read_b64_tr_b16 v[94:95], v40 offset:34816
  v_mfma_f32_16x16x32_bf16 v[24:27], v[96:99], a[52:55], v[24:27]
  buffer_load_dwordx4 a[120:123], v34, s[4:7], s16 offen offset:0 sc1
  v_mfma_f32_16x16x32_bf16 v[12:15], v[100:103], a[48:51], v[12:15]
  ds_read_b64_tr_b16 v[96:97], v41 offset:32768
  ds_read_b64_tr_b16 v[98:99], v41 offset:34816
  v_mfma_f32_16x16x32_bf16 v[28:31], v[100:103], a[52:55], v[28:31]
  buffer_load_dwordx4 a[124:127], v34, s[4:7], s16 offen offset:1024 sc1
  s_waitcnt lgkmcnt(10)
  v_mfma_f32_16x16x32_bf16 v[0:3], v[104:107], a[56:59], v[0:3]
  ds_read_b64_tr_b16 v[100:101], v42 offset:32768
  ds_read_b64_tr_b16 v[102:103], v42 offset:34816
  v_mfma_f32_16x16x32_bf16 v[16:19], v[104:107], a[60:63], v[16:19]
  ds_read_b64_tr_b16 v[104:105], v39 offset:36864
  ds_read_b64_tr_b16 v[106:107], v39 offset:38912
  v_mfma_f32_16x16x32_bf16 v[4:7], v[108:111], a[56:59], v[4:7]
  s_add_u32 s16, s16, 262144
  v_mfma_f32_16x16x32_bf16 v[20:23], v[108:111], a[60:63], v[20:23]
  ds_read_b64_tr_b16 v[108:109], v40 offset:36864
  ds_read_b64_tr_b16 v[110:111], v40 offset:38912
  s_waitcnt lgkmcnt(10)
  v_mfma_f32_16x16x32_bf16 v[8:11], v[112:115], a[56:59], v[8:11]
  s_bitset0_b32 s16, 22
  v_mfma_f32_16x16x32_bf16 v[24:27], v[112:115], a[60:63], v[24:27]
  ds_read_b64_tr_b16 v[112:113], v41 offset:36864
  ds_read_b64_tr_b16 v[114:115], v41 offset:38912
  v_mfma_f32_16x16x32_bf16 v[12:15], v[116:119], a[56:59], v[12:15]
  v_mfma_f32_16x16x32_bf16 v[28:31], v[116:119], a[60:63], v[28:31]
  s_waitcnt vmcnt(12) lgkmcnt(10)
  ds_read_b64_tr_b16 v[116:117], v42 offset:36864
  v_mfma_f32_16x16x32_bf16 v[0:3], v[88:91], a[64:67], v[0:3]
  ds_read_b64_tr_b16 v[118:119], v42 offset:38912
  s_add_u32 m0, s38, 43008
  v_mfma_f32_16x16x32_bf16 v[16:19], v[88:91], a[68:71], v[16:19]
  ds_read_b64_tr_b16 v[88:89], v39 offset:40960
  ds_read_b64_tr_b16 v[90:91], v39 offset:43008
  v_mfma_f32_16x16x32_bf16 v[4:7], v[92:95], a[64:67], v[4:7]
  v_mfma_f32_16x16x32_bf16 v[20:23], v[92:95], a[68:71], v[20:23]
  ds_read_b64_tr_b16 v[92:93], v40 offset:40960
  ds_read_b64_tr_b16 v[94:95], v40 offset:43008
  s_waitcnt lgkmcnt(10)
  v_mfma_f32_16x16x32_bf16 v[8:11], v[96:99], a[64:67], v[8:11]
  v_mfma_f32_16x16x32_bf16 v[24:27], v[96:99], a[68:71], v[24:27]
  buffer_load_dwordx4 v225, s[8:11], s17 offen lds
  v_mfma_f32_16x16x32_bf16 v[12:15], v[100:103], a[64:67], v[12:15]
  ds_read_b64_tr_b16 v[96:97], v41 offset:40960
  ds_read_b64_tr_b16 v[98:99], v41 offset:43008
  v_mfma_f32_16x16x32_bf16 v[28:31], v[100:103], a[68:71], v[28:31]
  ds_read_b64_tr_b16 v[100:101], v42 offset:40960
  ds_read_b64_tr_b16 v[102:103], v42 offset:43008
  v_mfma_f32_16x16x32_bf16 v[0:3], v[104:107], a[72:75], v[0:3]
  v_mfma_f32_16x16x32_bf16 v[16:19], v[104:107], a[76:79], v[16:19]
  ds_read_b64_tr_b16 v[104:105], v39 offset:45056
  ds_read_b64_tr_b16 v[106:107], v39 offset:47104
  s_waitcnt lgkmcnt(10)
  v_mfma_f32_16x16x32_bf16 v[4:7], v[108:111], a[72:75], v[4:7]
  buffer_load_dwordx4 v226, s[8:11], s17 offen offset:1024 lds
  v_mfma_f32_16x16x32_bf16 v[20:23], v[108:111], a[76:79], v[20:23]
  ds_read_b64_tr_b16 v[108:109], v40 offset:45056
  ds_read_b64_tr_b16 v[110:111], v40 offset:47104
  v_mfma_f32_16x16x32_bf16 v[8:11], v[112:115], a[72:75], v[8:11]
  v_mfma_f32_16x16x32_bf16 v[24:27], v[112:115], a[76:79], v[24:27]
  ds_read_b64_tr_b16 v[112:113], v41 offset:45056
  ds_read_b64_tr_b16 v[114:115], v41 offset:47104
  v_mfma_f32_16x16x32_bf16 v[12:15], v[116:119], a[72:75], v[12:15]
  v_mfma_f32_16x16x32_bf16 v[28:31], v[116:119], a[76:79], v[28:31]
  s_waitcnt vmcnt(10) lgkmcnt(10)
  ds_read_b64_tr_b16 v[116:117], v42 offset:45056
  v_mfma_f32_16x16x32_bf16 v[0:3], v[88:91], a[80:83], v[0:3]
  buffer_load_dwordx4 v227, s[8:11], s17 offen offset:2048 lds
  v_mfma_f32_16x16x32_bf16 v[16:19], v[88:91], a[84:87], v[16:19]
  ds_read_b64_tr_b16 v[118:119], v42 offset:47104
  ds_read_b64_tr_b16 v[88:89], v39 offset:49152
  v_mfma_f32_16x16x32_bf16 v[4:7], v[92:95], a[80:83], v[4:7]
  ds_read_b64_tr_b16 v[90:91], v39 offset:51200
  v_mfma_f32_16x16x32_bf16 v[20:23], v[92:95], a[84:87], v[20:23]
  ds_read_b64_tr_b16 v[92:93], v40 offset:49152
  ds_read_b64_tr_b16 v[94:95], v40 offset:51200
  s_waitcnt lgkmcnt(10)
  v_mfma_f32_16x16x32_bf16 v[8:11], v[96:99], a[80:83], v[8:11]
  v_mfma_f32_16x16x32_bf16 v[24:27], v[96:99], a[84:87], v[24:27]
  s_mov_b32 exec_hi, 0
  buffer_load_dwordx4 v228, s[8:11], s17 offen offset:3072 lds
  s_mov_b32 exec_hi, -1
  v_mfma_f32_16x16x32_bf16 v[12:15], v[100:103], a[80:83], v[12:15]
  ds_read_b64_tr_b16 v[96:97], v41 offset:49152
  ds_read_b64_tr_b16 v[98:99], v41 offset:51200
  v_mfma_f32_16x16x32_bf16 v[28:31], v[100:103], a[84:87], v[28:31]
  ds_read_b64_tr_b16 v[100:101], v42 offset:49152
  ds_read_b64_tr_b16 v[102:103], v42 offset:51200
  v_mfma_f32_16x16x32_bf16 v[0:3], v[104:107], a[88:91], v[0:3]
  v_mfma_f32_16x16x32_bf16 v[16:19], v[104:107], a[92:95], v[16:19]
  ds_read_b64_tr_b16 v[104:105], v39 offset:53248
  ds_read_b64_tr_b16 v[106:107], v39 offset:55296
  s_waitcnt lgkmcnt(10)
  v_mfma_f32_16x16x32_bf16 v[4:7], v[108:111], a[88:91], v[4:7]
  s_add_u32 s17, s17, s96
  v_mfma_f32_16x16x32_bf16 v[20:23], v[108:111], a[92:95], v[20:23]
  ds_read_b64_tr_b16 v[108:109], v40 offset:53248
  ds_read_b64_tr_b16 v[110:111], v40 offset:55296
  v_mfma_f32_16x16x32_bf16 v[8:11], v[112:115], a[88:91], v[8:11]
  v_mfma_f32_16x16x32_bf16 v[24:27], v[112:115], a[92:95], v[24:27]
  ds_read_b64_tr_b16 v[112:113], v41 offset:53248
  ds_read_b64_tr_b16 v[114:115], v41 offset:55296
  v_mfma_f32_16x16x32_bf16 v[12:15], v[116:119], a[88:91], v[12:15]
  v_mfma_f32_16x16x32_bf16 v[28:31], v[116:119], a[92:95], v[28:31]
  s_waitcnt vmcnt(8) lgkmcnt(10)
  ds_read_b64_tr_b16 v[116:117], v42 offset:53248
  v_mfma_f32_16x16x32_bf16 v[0:3], v[88:91], a[96:99], v[0:3]
  ds_read_b64_tr_b16 v[118:119], v42 offset:55296
  v_mfma_f32_16x16x32_bf16 v[16:19], v[88:91], a[100:103], v[16:19]
  ds_read_b64_tr_b16 v[88:89], v39 offset:57344
  ds_read_b64_tr_b16 v[90:91], v39 offset:59392
  v_mfma_f32_16x16x32_bf16 v[4:7], v[92:95], a[96:99], v[4:7]
  v_mfma_f32_16x16x32_bf16 v[20:23], v[92:95], a[100:103], v[20:23]
  ds_read_b64_tr_b16 v[92:93], v40 offset:57344
  ds_read_b64_tr_b16 v[94:95], v40 offset:59392
  s_waitcnt lgkmcnt(10)
  v_mfma_f32_16x16x32_bf16 v[8:11], v[96:99], a[96:99], v[8:11]
  v_mfma_f32_16x16x32_bf16 v[24:27], v[96:99], a[100:103], v[24:27]
  ds_read_b64_tr_b16 v[96:97], v41 offset:57344
  ds_read_b64_tr_b16 v[98:99], v41 offset:59392
  v_mfma_f32_16x16x32_bf16 v[12:15], v[100:103], a[96:99], v[12:15]
  v_mfma_f32_16x16x32_bf16 v[28:31], v[100:103], a[100:103], v[28:31]
  ds_read_b64_tr_b16 v[100:101], v42 offset:57344
  ds_read_b64_tr_b16 v[102:103], v42 offset:59392
  v_mfma_f32_16x16x32_bf16 v[0:3], v[104:107], a[104:107], v[0:3]
  v_mfma_f32_16x16x32_bf16 v[16:19], v[104:107], a[108:111], v[16:19]
  ds_read_b64_tr_b16 v[104:105], v39 offset:61440
  ds_read_b64_tr_b16 v[106:107], v39 offset:63488
  s_waitcnt lgkmcnt(10)
  v_mfma_f32_16x16x32_bf16 v[4:7], v[108:111], a[104:107], v[4:7]
  v_mfma_f32_16x16x32_bf16 v[20:23], v[108:111], a[108:111], v[20:23]
  ds_read_b64_tr_b16 v[108:109], v40 offset:61440
  ds_read_b64_tr_b16 v[110:111], v40 offset:63488
  v_mfma_f32_16x16x32_bf16 v[8:11], v[112:115], a[104:107], v[8:11]
  v_mfma_f32_16x16x32_bf16 v[24:27], v[112:115], a[108:111], v[24:27]
  ds_read_b64_tr_b16 v[112:113], v41 offset:61440
  ds_read_b64_tr_b16 v[114:115], v41 offset:63488
  v_mfma_f32_16x16x32_bf16 v[12:15], v[116:119], a[104:107], v[12:15]
  v_mfma_f32_16x16x32_bf16 v[28:31], v[116:119], a[108:111], v[28:31]
  s_waitcnt vmcnt(4) lgkmcnt(10)
  ds_read_b64_tr_b16 v[116:117], v42 offset:61440
  v_mfma_f32_16x16x32_bf16 v[0:3], v[88:91], a[112:115], v[0:3]
  ds_read_b64_tr_b16 v[118:119], v42 offset:63488
  v_mfma_f32_16x16x32_bf16 v[16:19], v[88:91], a[116:119], v[16:19]
  v_mfma_f32_16x16x32_bf16 v[4:7], v[92:95], a[112:115], v[4:7]
  v_mfma_f32_16x16x32_bf16 v[20:23], v[92:95], a[116:119], v[20:23]
  s_waitcnt lgkmcnt(10)
  v_mfma_f32_16x16x32_bf16 v[8:11], v[96:99], a[112:115], v[8:11]
  v_mfma_f32_16x16x32_bf16 v[24:27], v[96:99], a[116:119], v[24:27]
  s_waitcnt lgkmcnt(8)
  v_mfma_f32_16x16x32_bf16 v[12:15], v[100:103], a[112:115], v[12:15]
  v_mfma_f32_16x16x32_bf16 v[28:31], v[100:103], a[116:119], v[28:31]
  s_waitcnt lgkmcnt(6)
  v_mfma_f32_16x16x32_bf16 v[0:3], v[104:107], a[120:123], v[0:3]
  s_waitcnt lgkmcnt(4)
  v_mfma_f32_16x16x32_bf16 v[4:7], v[108:111], a[120:123], v[4:7]
  s_waitcnt lgkmcnt(2)
  v_mfma_f32_16x16x32_bf16 v[8:11], v[112:115], a[120:123], v[8:11]
  s_waitcnt lgkmcnt(0)
  v_mfma_f32_16x16x32_bf16 v[12:15], v[116:119], a[120:123], v[12:15]
  v_mfma_f32_16x16x32_bf16 v[16:19], v[104:107], a[124:127], v[16:19]
  v_mfma_f32_16x16x32_bf16 v[20:23], v[108:111], a[124:127], v[20:23]
  v_mfma_f32_16x16x32_bf16 v[24:27], v[112:115], a[124:127], v[24:27]
  v_mfma_f32_16x16x32_bf16 v[28:31], v[116:119], a[124:127], v[28:31]
  s_nop 1
  v_pk_fma_f32 v[120:121], v[0:1], v[64:65], v[120:121]
  v_pk_fma_f32 v[122:123], v[2:3], v[66:67], v[122:123]
  v_pk_fma_f32 v[124:125], v[4:5], v[68:69], v[124:125]
  v_pk_fma_f32 v[126:127], v[6:7], v[70:71], v[126:127]
  v_cvt_pk_bf16_f32 v48, v120, v121
  v_cvt_pk_bf16_f32 v49, v122, v123
  v_cvt_pk_bf16_f32 v50, v124, v125
  v_cvt_pk_bf16_f32 v51, v126, v127
  v_pk_fma_f32 v[128:129], v[8:9], v[72:73], v[128:129]
  v_pk_fma_f32 v[130:131], v[10:11], v[74:75], v[130:131]
  v_pk_fma_f32 v[132:133], v[12:13], v[76:77], v[132:133]
  v_pk_fma_f32 v[134:135], v[14:15], v[78:79], v[134:135]
  v_mfma_f32_16x16x32_bf16 v[200:203], v[216:219], v[48:51], 0
  v_mfma_f32_16x16x32_bf16 v[204:207], v[48:51], v[48:51], 0
  v_cvt_pk_bf16_f32 v52, v128, v129
  v_cvt_pk_bf16_f32 v53, v130, v131
  v_cvt_pk_bf16_f32 v54, v132, v133
  v_cvt_pk_bf16_f32 v55, v134, v135
  v_pk_fma_f32 v[136:137], v[16:17], v[64:65], v[136:137]
  v_pk_fma_f32 v[138:139], v[18:19], v[66:67], v[138:139]
  v_pk_fma_f32 v[140:141], v[20:21], v[68:69], v[140:141]
  v_pk_fma_f32 v[142:143], v[22:23], v[70:71], v[142:143]
  v_mfma_f32_16x16x32_bf16 v[200:203], v[216:219], v[52:55], v[200:203]
  v_mfma_f32_16x16x32_bf16 v[204:207], v[52:55], v[52:55], v[204:207]
  v_cvt_pk_bf16_f32 v56, v136, v137
  v_cvt_pk_bf16_f32 v57, v138, v139
  v_cvt_pk_bf16_f32 v58, v140, v141
  v_cvt_pk_bf16_f32 v59, v142, v143
  v_pk_fma_f32 v[144:145], v[24:25], v[72:73], v[144:145]
  v_pk_fma_f32 v[146:147], v[26:27], v[74:75], v[146:147]
  v_pk_fma_f32 v[148:149], v[28:29], v[76:77], v[148:149]
  v_pk_fma_f32 v[150:151], v[30:31], v[78:79], v[150:151]
  v_mfma_f32_16x16x32_bf16 v[208:211], v[216:219], v[56:59], 0
  v_mfma_f32_16x16x32_bf16 v[212:215], v[56:59], v[56:59], 0
  v_cvt_pk_bf16_f32 v60, v144, v145
  v_cvt_pk_bf16_f32 v61, v146, v147
  v_cvt_pk_bf16_f32 v62, v148, v149
  v_cvt_pk_bf16_f32 v63, v150, v151
  s_nop 1
  v_mfma_f32_16x16x32_bf16 v[212:215], v[60:63], v[60:63], v[212:215]
  v_mfma_f32_16x16x32_bf16 v[208:211], v[216:219], v[60:63], v[208:211]
  v_cndmask_b32_e64 v204, v204, v205, s[34:35]
  v_cndmask_b32_e64 v206, v206, v207, s[34:35]
  v_cndmask_b32_e64 v204, v204, v206, s[36:37]
  v_fma_f32 v204, -v200, v200, v204
  v_and_or_b32 v156, v200, v81, s44
  v_and_or_b32 v157, v204, v81, s45
  s_nop 1
  v_cndmask_b32_e64 v212, v212, v213, s[34:35]
  v_cndmask_b32_e64 v214, v214, v215, s[34:35]
  v_cndmask_b32_e64 v212, v212, v214, s[36:37]
  v_fma_f32 v212, -v208, v208, v212
  v_and_or_b32 v158, v208, v81, s46
  v_and_or_b32 v159, v212, v81, s47
  buffer_store_dwordx4 v[156:159], v83, s[52:55], s57 offen sc1
  s_barrier
  s_add_u32 m0, s38, 0
  s_nop 0
  buffer_load_dwordx4 v225, s[8:11], s17 offen lds
  buffer_load_dwordx4 v226, s[8:11], s17 offen offset:1024 lds
  buffer_load_dwordx4 v227, s[8:11], s17 offen offset:2048 lds
  s_mov_b32 exec_hi, 0
  buffer_load_dwordx4 v228, s[8:11], s17 offen offset:3072 lds
  s_mov_b32 exec_hi, -1
  s_add_u32 s17, s17, s97
  s_add_u32 m0, s38, 14336
  s_nop 0
  buffer_load_dwordx4 v225, s[8:11], s17 offen lds
  buffer_load_dwordx4 v226, s[8:11], s17 offen offset:1024 lds
  buffer_load_dwordx4 v227, s[8:11], s17 offen offset:2048 lds
  s_mov_b32 exec_hi, 0
  buffer_load_dwordx4 v228, s[8:11], s17 offen offset:3072 lds
  s_mov_b32 exec_hi, -1
  s_add_u32 s17, s17, s98
  v_accvgpr_write_b32 a128, v48
  v_lshlrev_b32 v0, 16, v48
  v_and_b32 v1, 0xffff0000, v48
  v_accvgpr_write_b32 a129, v49
  v_lshlrev_b32 v2, 16, v49
  v_and_b32 v3, 0xffff0000, v49
  v_accvgpr_write_b32 a130, v50
  v_lshlrev_b32 v4, 16, v50
  v_and_b32 v5, 0xffff0000, v50
  v_accvgpr_write_b32 a131, v51
  v_lshlrev_b32 v6, 16, v51
  v_and_b32 v7, 0xffff0000, v51
  v_accvgpr_write_b32 a132, v52
  v_lshlrev_b32 v8, 16, v52
  v_and_b32 v9, 0xffff0000, v52
  v_accvgpr_write_b32 a133, v53
  v_lshlrev_b32 v10, 16, v53
  v_and_b32 v11, 0xffff0000, v53
  v_accvgpr_write_b32 a134, v54
  v_lshlrev_b32 v12, 16, v54
  v_and_b32 v13, 0xffff0000, v54
  v_accvgpr_write_b32 a135, v55
  v_lshlrev_b32 v14, 16, v55
  v_and_b32 v15, 0xffff0000, v55
  v_accvgpr_write_b32 a136, v56
  v_lshlrev_b32 v16, 16, v56
  v_and_b32 v17, 0xffff0000, v56
  v_accvgpr_write_b32 a137, v57
  v_lshlrev_b32 v18, 16, v57
  v_and_b32 v19, 0xffff0000, v57
  v_accvgpr_write_b32 a138, v58
  v_lshlrev_b32 v20, 16, v58
  v_and_b32 v21, 0xffff0000, v58
  v_accvgpr_write_b32 a139, v59
  v_lshlrev_b32 v22, 16, v59
  v_and_b32 v23, 0xffff0000, v59
  v_accvgpr_write_b32 a140, v60
  v_lshlrev_b32 v24, 16, v60
  v_and_b32 v25, 0xffff0000, v60
  v_accvgpr_write_b32 a141, v61
  v_lshlrev_b32 v26, 16, v61
  v_and_b32 v27, 0xffff0000, v61
  v_accvgpr_write_b32 a142, v62
  v_lshlrev_b32 v28, 16, v62
  v_and_b32 v29, 0xffff0000, v62
  v_accvgpr_write_b32 a143, v63
  v_lshlrev_b32 v30, 16, v63
  v_and_b32 v31, 0xffff0000, v63
  s_add_u32 s48, s20, 0xa00000
  s_addc_u32 s49, s21, 0
  s_mov_b32 s50, 0x400000
  s_mov_b32 s51, 0x20000
  s_mov_b32 s59, 262144
L_poll_17:
  buffer_load_dwordx4 v[88:91], v80, s[52:55], s56 offen offset:0 sc1
  buffer_load_dwordx4 v[92:95], v80, s[52:55], s56 offen offset:1024 sc1
  buffer_load_dwordx4 v[96:99], v80, s[52:55], s56 offen offset:2048 sc1
  buffer_load_dwordx4 v[100:103], v80, s[52:55], s56 offen offset:3072 sc1
  s_waitcnt vmcnt(3)
  v_xor_b32 v88, s44, v88
  v_xor_b32 v89, s45, v89
  v_xor_b32 v90, s46, v90
  v_xor_b32 v91, s47, v91
  v_or3_b32 v160, v88, v89, v90
  v_or_b32 v160, v160, v91
  s_waitcnt vmcnt(2)
  v_xor_b32 v92, s44, v92
  v_xor_b32 v93, s45, v93
  v_xor_b32 v94, s46, v94
  v_xor_b32 v95, s47, v95
  v_or3_b32 v160, v160, v92, v93
  v_or3_b32 v160, v160, v94, v95
  s_waitcnt vmcnt(1)
  v_xor_b32 v96, s44, v96
  v_xor_b32 v97, s45, v97
  v_xor_b32 v98, s46, v98
  v_xor_b32 v99, s47, v99
  v_or3_b32 v160, v160, v96, v97
  v_or3_b32 v160, v160, v98, v99
  s_waitcnt vmcnt(0)
  v_xor_b32 v100, s44, v100
  v_xor_b32 v101, s45, v101
  v_xor_b32 v102, s46, v102
  v_xor_b32 v103, s47, v103
  v_or3_b32 v160, v160, v100, v101
  v_or3_b32 v160, v160, v102, v103
  v_and_b32 v160, 0xff, v160
  v_cmp_ne_u32 vcc, 0, v160
  s_nop 1
  s_cmp_eq_u64 vcc, 0
  s_cbranch_scc1 L_ready_18
  s_sub_u32 s59, s59, 1
  s_cmp_lg_u32 s59, 0
  s_cbranch_scc1 L_poll_17
L_ready_18:
  v_fmac_f32 v89, v88, v88
  v_fmac_f32 v91, v90, v90
  v_fmac_f32 v93, v92, v92
  v_fmac_f32 v95, v94, v94
  v_fmac_f32 v97, v96, v96
  v_fmac_f32 v99, v98, v98
  v_fmac_f32 v101, v100, v100
  v_fmac_f32 v103, v102, v102
  v_pk_add_f32 v[152:153], v[88:89], v[92:93]
  v_pk_add_f32 v[160:161], v[96:97], v[100:101]
  v_pk_add_f32 v[154:155], v[90:91], v[94:95]
  v_pk_add_f32 v[162:163], v[98:99], v[102:103]
  v_pk_add_f32 v[152:153], v[152:153], v[160:161]
  v_pk_add_f32 v[154:155], v[154:155], v[162:163]
  v_mov_b32 v160, v152
  v_mov_b32 v161, v153
  v_mov_b32 v162, v154
  v_mov_b32 v163, v155
  s_nop 1
  v_permlane16_swap_b32 v160, v152
  v_permlane16_swap_b32 v161, v153
  v_permlane16_swap_b32 v162, v154
  v_permlane16_swap_b32 v163, v155
  s_nop 1
  v_add_f32 v152, v152, v160
  v_add_f32 v153, v153, v161
  v_add_f32 v154, v154, v162
  v_add_f32 v155, v155, v163
  v_mov_b32 v160, v152
  v_mov_b32 v161, v153
  v_mov_b32 v162, v154
  v_mov_b32 v163, v155
  s_nop 1
  v_permlane32_swap_b32 v160, v152
  v_permlane32_swap_b32 v161, v153
  v_permlane32_swap_b32 v162, v154
  v_permlane32_swap_b32 v163, v155
  s_nop 1
  v_add_f32 v152, v152, v160
  v_add_f32 v153, v153, v161
  v_add_f32 v154, v154, v162
  v_add_f32 v155, v155, v163
  v_mul_f32 v120, 0x3c000000, v152
  v_mul_f32 v122, 0x3a800000, v153
  v_mul_f32 v121, 0x3c000000, v154
  v_mul_f32 v123, 0x3a800000, v155
  v_fma_f32 v122, -v120, v120, v122
  v_fma_f32 v123, -v121, v121, v123
  v_max_f32 v122, 0, v122
  v_max_f32 v123, 0, v123
  v_cvt_pk_bf16_f32 v124, v122, v123
  v_lshlrev_b32 v122, 16, v124
  v_and_b32 v123, 0xffff0000, v124
  v_add_f32 v122, 0x3727c5ac, v122
  v_add_f32 v123, 0x3727c5ac, v123
  v_cvt_pk_bf16_f32 v124, v122, v123
  v_lshlrev_b32 v122, 16, v124
  v_and_b32 v123, 0xffff0000, v124
  v_sqrt_f32 v122, v122
  v_sqrt_f32 v123, v123
  v_cvt_pk_bf16_f32 v124, v120, v121
  v_lshlrev_b32 v120, 16, v124
  v_and_b32 v121, 0xffff0000, v124
  v_cvt_pk_bf16_f32 v124, v122, v123
  v_lshlrev_b32 v122, 16, v124
  v_and_b32 v123, 0xffff0000, v124
  v_rcp_f32 v126, v122
  v_rcp_f32 v130, v123
  s_nop 0
  v_mov_b32 v127, v126
  v_mul_f32_e64 v128, -v120, v126
  v_mul_f32_e64 v129, -v120, v126
  v_mov_b32 v131, v130
  v_mul_f32_e64 v132, -v121, v130
  v_mul_f32_e64 v133, -v121, v130
  v_pk_fma_f32 v[0:1], v[0:1], v[126:127], v[128:129]
  v_pk_fma_f32 v[2:3], v[2:3], v[126:127], v[128:129]
  v_pk_fma_f32 v[4:5], v[4:5], v[126:127], v[128:129]
  v_pk_fma_f32 v[6:7], v[6:7], v[126:127], v[128:129]
  v_pk_fma_f32 v[0:1], v[0:1], v[184:185], v[168:169]
  v_pk_fma_f32 v[2:3], v[2:3], v[186:187], v[170:171]
  v_pk_fma_f32 v[4:5], v[4:5], v[188:189], v[172:173]
  v_pk_fma_f32 v[6:7], v[6:7], v[190:191], v[174:175]
  v_cvt_pk_bf16_f32 v88, v0, v1
  v_cvt_pk_bf16_f32 v89, v2, v3
  v_cvt_pk_bf16_f32 v90, v4, v5
  v_cvt_pk_bf16_f32 v91, v6, v7
  buffer_store_dwordx4 v[88:91], v33, s[48:51], s41 offen offset:0 sc1
  v_pk_fma_f32 v[8:9], v[8:9], v[126:127], v[128:129]
  v_pk_fma_f32 v[10:11], v[10:11], v[126:127], v[128:129]
  v_pk_fma_f32 v[12:13], v[12:13], v[126:127], v[128:129]
  v_pk_fma_f32 v[14:15], v[14:15], v[126:127], v[128:129]
  v_pk_fma_f32 v[8:9], v[8:9], v[192:193], v[176:177]
  v_pk_fma_f32 v[10:11], v[10:11], v[194:195], v[178:179]
  v_pk_fma_f32 v[12:13], v[12:13], v[196:197], v[180:181]
  v_pk_fma_f32 v[14:15], v[14:15], v[198:199], v[182:183]
  v_cvt_pk_bf16_f32 v92, v8, v9
  v_cvt_pk_bf16_f32 v93, v10, v11
  v_cvt_pk_bf16_f32 v94, v12, v13
  v_cvt_pk_bf16_f32 v95, v14, v15
  buffer_store_dwordx4 v[92:95], v33, s[48:51], s42 offen offset:0 sc1
  v_pk_fma_f32 v[16:17], v[16:17], v[130:131], v[132:133]
  v_pk_fma_f32 v[18:19], v[18:19], v[130:131], v[132:133]
  v_pk_fma_f32 v[20:21], v[20:21], v[130:131], v[132:133]
  v_pk_fma_f32 v[22:23], v[22:23], v[130:131], v[132:133]
  v_pk_fma_f32 v[16:17], v[16:17], v[184:185], v[168:169]
  v_pk_fma_f32 v[18:19], v[18:19], v[186:187], v[170:171]
  v_pk_fma_f32 v[20:21], v[20:21], v[188:189], v[172:173]
  v_pk_fma_f32 v[22:23], v[22:23], v[190:191], v[174:175]
  v_cvt_pk_bf16_f32 v96, v16, v17
  v_cvt_pk_bf16_f32 v97, v18, v19
  v_cvt_pk_bf16_f32 v98, v20, v21
  v_cvt_pk_bf16_f32 v99, v22, v23
  buffer_store_dwordx4 v[96:99], v33, s[48:51], s41 offen offset:1024 sc1
  v_pk_fma_f32 v[24:25], v[24:25], v[130:131], v[132:133]
  v_pk_fma_f32 v[26:27], v[26:27], v[130:131], v[132:133]
  v_pk_fma_f32 v[28:29], v[28:29], v[130:131], v[132:133]
  v_pk_fma_f32 v[30:31], v[30:31], v[130:131], v[132:133]
  v_pk_fma_f32 v[24:25], v[24:25], v[192:193], v[176:177]
  v_pk_fma_f32 v[26:27], v[26:27], v[194:195], v[178:179]
  v_pk_fma_f32 v[28:29], v[28:29], v[196:197], v[180:181]
  v_pk_fma_f32 v[30:31], v[30:31], v[198:199], v[182:183]
  v_cvt_pk_bf16_f32 v100, v24, v25
  v_cvt_pk_bf16_f32 v101, v26, v27
  v_cvt_pk_bf16_f32 v102, v28, v29
  v_cvt_pk_bf16_f32 v103, v30, v31
  buffer_store_dwordx4 v[100:103], v33, s[48:51], s42 offen offset:1024 sc1
  s_add_u32 s64, s20, 0xb0000
  s_addc_u32 s65, s21, 0
  s_mov_b32 s66, 0x10000
  s_mov_b32 s67, 0x20000
  s_lshl_b32 s32, s30, 2
  s_add_u32 s32, s32, s3
  s_lshl_b32 s32, s32, 4
  s_add_u32 s32, s32, s31
  s_lshl_b32 s32, s32, 6
  s_mov_b32 s30, s94
  s_mov_b32 s31, s95
  s_lshl_b32 s33, s30, 2
  s_add_u32 s33, s33, s3
  s_lshl_b32 s68, s33, 11
  v_lshlrev_b32 v250, 2, v231
  v_mov_b32 v248, s19
  v_and_b32 v246, 31, v231
  v_and_b32 v245, 17, v246
  v_lshlrev_b32 v245, 6, v245
  v_lshlrev_b32 v246, 6, v246
  s_mov_b64 s[24:25], s[60:61]
  s_mov_b64 s[26:27], s[62:63]
  s_add_u32 s4, s20, 0xa00000
  s_addc_u32 s5, s21, 0
  s_mov_b32 s6, 0x400000
  s_mov_b32 s7, 0x20000
  s_bfe_u32 s33, s2, 0x20003
  s_mul_i32 s16, s33, 131072
  s_cmp_eq_u32 s33, 3
  s_cselect_b32 s44, -3, 1
  s_mul_i32 s44, s44, 131072
  s_cmp_eq_u32 s33, 2
  s_cselect_b32 s45, -3, 1
  s_mul_i32 s45, s45, 131072
  s_cmp_eq_u32 s33, 1
  s_cselect_b32 s46, -3, 1
  s_mul_i32 s46, s46, 131072
  s_cmp_eq_u32 s33, 0
  s_cselect_b32 s47, 1, 5
  s_mul_i32 s47, s47, 131072
  s_bitcmp1_b32 s3, 0
  s_cselect_b32 s52, s26, s24
  s_cselect_b32 s53, s27, s25
  s_cselect_b32 s60, 3670016, 0
  s_mov_b32 s54, 7340032
  s_mov_b32 s55, 0x20000
  s_lshl_b32 s56, s2, 1
  s_lshr_b32 s59, s3, 1
  s_add_u32 s56, s56, s59
  s_lshl_b32 s56, s56, 10
  s_add_u32 s60, s60, s56
  s_add_u32 s56, s56, 1048576
  s_mov_b32 s59, 0
  v_lshrrev_b32 v249, 3, v231
  v_lshlrev_b32 v249, 7, v249
  v_and_b32 v251, 0, v231
  v_lshl_add_u32 v249, v251, 19, v249
  s_mov_b32 s52, s22
  s_mov_b32 s53, s23
  s_mov_b32 s56, s60
  s_add_u32 s12, s20, 0x1600000
  s_addc_u32 s13, s21, 0
  s_mov_b32 s14, 0xe00000
  s_mov_b32 s15, 0x20000
  v_lshrrev_b32 v234, 2, v231
  v_mul_u32_u24 v234, 224, v234
  v_and_b32 v235, 3, v231
  v_lshl_add_u32 v229, v235, 3, v234
  v_add_u32 v229, 98304, v229
  v_add_u32 v230, 57344, v229
  s_waitcnt vmcnt(0)
  s_mov_b64 exec, 1
  buffer_store_dword v248, v250, s[64:67], s32 offen sc1
  s_mov_b64 exec, -1
  s_waitcnt vmcnt(8)
  s_barrier
  ds_read_b64_tr_b16 a[64:65], v229 offset:43008
  ds_read_b64_tr_b16 a[66:67], v229 offset:46592
  ds_read_b64_tr_b16 a[68:69], v229 offset:43040
  ds_read_b64_tr_b16 a[70:71], v229 offset:46624
  ds_read_b64_tr_b16 a[72:73], v229 offset:43072
  ds_read_b64_tr_b16 a[74:75], v229 offset:46656
  ds_read_b64_tr_b16 a[76:77], v229 offset:43104
  ds_read_b64_tr_b16 a[78:79], v229 offset:46688
  ds_read_b64_tr_b16 a[80:81], v229 offset:43136
  ds_read_b64_tr_b16 a[82:83], v229 offset:46720
  ds_read_b64_tr_b16 a[84:85], v229 offset:43168
  ds_read_b64_tr_b16 a[86:87], v229 offset:46752
  ds_read_b64_tr_b16 a[88:89], v229 offset:43200
  ds_read_b64_tr_b16 a[90:91], v229 offset:46784
  ds_read_b64_tr_b16 a[92:93], v229 offset:50176
  ds_read_b64_tr_b16 a[94:95], v229 offset:53760
  ds_read_b64_tr_b16 a[96:97], v229 offset:50208
  ds_read_b64_tr_b16 a[98:99], v229 offset:53792
  ds_read_b64_tr_b16 a[100:101], v229 offset:50240
  ds_read_b64_tr_b16 a[102:103], v229 offset:53824
  ds_read_b64_tr_b16 a[104:105], v229 offset:50272
  ds_read_b64_tr_b16 a[106:107], v229 offset:53856
  ds_read_b64_tr_b16 a[108:109], v229 offset:50304
  ds_read_b64_tr_b16 a[110:111], v229 offset:53888
  ds_read_b64_tr_b16 a[112:113], v229 offset:50336
  ds_read_b64_tr_b16 a[114:115], v229 offset:53920
  ds_read_b64_tr_b16 a[116:117], v229 offset:50368
  ds_read_b64_tr_b16 a[118:119], v229 offset:53952
  s_mov_b32 s34, 262144
L_spin_21:
  buffer_load_dword v247, v245, s[64:67], s68 offen sc1
  s_waitcnt vmcnt(0)
  v_cmp_ne_u32 vcc, s19, v247
  s_nop 1
  s_cmp_eq_u64 vcc, 0
  s_cbranch_scc1 L_rdy_22
  s_sub_u32 s34, s34, 1
  s_cmp_lg_u32 s34, 0
  s_cbranch_scc1 L_spin_21
L_rdy_22:
  buffer_load_dwordx4 a[0:3], v224, s[4:7], s16 offen offset:0 sc1
  buffer_load_dwordx4 a[4:7], v224, s[4:7], s16 offen offset:1024 sc1
  buffer_load_dwordx4 a[8:11], v224, s[4:7], s16 offen offset:2048 sc1
  buffer_load_dwordx4 a[12:15], v224, s[4:7], s16 offen offset:3072 sc1
  s_add_u32 s16, s16, s44
  buffer_load_dwordx4 a[16:19], v224, s[4:7], s16 offen offset:0 sc1
  buffer_load_dwordx4 a[20:23], v224, s[4:7], s16 offen offset:1024 sc1
  buffer_load_dwordx4 a[24:27], v224, s[4:7], s16 offen offset:2048 sc1
  buffer_load_dwordx4 a[28:31], v224, s[4:7], s16 offen offset:3072 sc1
  s_add_u32 s16, s16, s45
  s_waitcnt vmcnt(4) lgkmcnt(10)
  s_barrier
  buffer_load_dword v247, v246, s[64:67], s68 offen sc1
  v_mfma_f32_16x16x32_bf16 v[0:3], a[64:67], a[0:3], 0
  s_add_u32 m0, s38, 28672
  v_mfma_f32_16x16x32_bf16 v[56:59], a[64:67], a[4:7], 0
  buffer_load_dwordx4 v225, s[8:11], s17 offen lds
  v_mfma_f32_16x16x32_bf16 v[112:115], a[64:67], a[8:11], 0
  v_mfma_f32_16x16x32_bf16 v[168:171], a[64:67], a[12:15], 0
  ds_read_b64_tr_b16 a[64:65], v229 offset:0
  ds_read_b64_tr_b16 a[66:67], v229 offset:3584
  v_mfma_f32_16x16x32_bf16 v[4:7], a[68:71], a[0:3], 0
  v_mfma_f32_16x16x32_bf16 v[60:63], a[68:71], a[4:7], 0
  buffer_load_dwordx4 a[32:35], v224, s[4:7], s16 offen offset:0 sc1
  v_mfma_f32_16x16x32_bf16 v[116:119], a[68:71], a[8:11], 0
  v_mfma_f32_16x16x32_bf16 v[172:175], a[68:71], a[12:15], 0
  ds_read_b64_tr_b16 a[68:69], v229 offset:32
  ds_read_b64_tr_b16 a[70:71], v229 offset:3616
  v_mfma_f32_16x16x32_bf16 v[8:11], a[72:75], a[0:3], 0
  v_mfma_f32_16x16x32_bf16 v[64:67], a[72:75], a[4:7], 0
  v_mfma_f32_16x16x32_bf16 v[120:123], a[72:75], a[8:11], 0
  buffer_load_dwordx4 v226, s[8:11], s17 offen offset:1024 lds
  v_mfma_f32_16x16x32_bf16 v[176:179], a[72:75], a[12:15], 0
  ds_read_b64_tr_b16 a[72:73], v229 offset:64
  ds_read_b64_tr_b16 a[74:75], v229 offset:3648
  v_mfma_f32_16x16x32_bf16 v[12:15], a[76:79], a[0:3], 0
  v_mfma_f32_16x16x32_bf16 v[68:71], a[76:79], a[4:7], 0
  v_mfma_f32_16x16x32_bf16 v[124:127], a[76:79], a[8:11], 0
  buffer_load_dwordx4 a[36:39], v224, s[4:7], s16 offen offset:1024 sc1
  v_mfma_f32_16x16x32_bf16 v[180:183], a[76:79], a[12:15], 0
  ds_read_b64_tr_b16 a[76:77], v229 offset:96
  ds_read_b64_tr_b16 a[78:79], v229 offset:3680
  v_mfma_f32_16x16x32_bf16 v[16:19], a[80:83], a[0:3], 0
  v_mfma_f32_16x16x32_bf16 v[72:75], a[80:83], a[4:7], 0
  v_mfma_f32_16x16x32_bf16 v[128:131], a[80:83], a[8:11], 0
  v_mfma_f32_16x16x32_bf16 v[184:187], a[80:83], a[12:15], 0
  buffer_load_dwordx4 v227, s[8:11], s17 offen offset:2048 lds
  v_mfma_f32_16x16x32_bf16 v[20:23], a[84:87], a[0:3], 0
  ds_read_b64_tr_b16 a[80:81], v229 offset:128
  ds_read_b64_tr_b16 a[82:83], v229 offset:3712
  v_mfma_f32_16x16x32_bf16 v[76:79], a[84:87], a[4:7], 0
  v_mfma_f32_16x16x32_bf16 v[132:135], a[84:87], a[8:11], 0
  v_mfma_f32_16x16x32_bf16 v[188:191], a[84:87], a[12:15], 0
  buffer_load_dwordx4 a[40:43], v224, s[4:7], s16 offen offset:2048 sc1
  v_mfma_f32_16x16x32_bf16 v[24:27], a[88:91], a[0:3], 0
  ds_read_b64_tr_b16 a[84:85], v229 offset:160
  ds_read_b64_tr_b16 a[86:87], v229 offset:3744
  v_mfma_f32_16x16x32_bf16 v[80:83], a[88:91], a[4:7], 0
  v_mfma_f32_16x16x32_bf16 v[136:139], a[88:91], a[8:11], 0
  v_mfma_f32_16x16x32_bf16 v[192:195], a[88:91], a[12:15], 0
  ds_read_b64_tr_b16 a[88:89], v229 offset:192
  ds_read_b64_tr_b16 a[90:91], v229 offset:3776
  v_mfma_f32_16x16x32_bf16 v[28:31], a[92:95], a[0:3], 0
  s_mov_b32 exec_hi, 0
  buffer_load_dwordx4 v228, s[8:11], s17 offen offset:3072 lds
  s_mov_b32 exec_hi, -1
  v_mfma_f32_16x16x32_bf16 v[84:87], a[92:95], a[4:7], 0
  s_add_u32 s17, s17, s99
  v_mfma_f32_16x16x32_bf16 v[140:143], a[92:95], a[8:11], 0
  v_mfma_f32_16x16x32_bf16 v[196:199], a[92:95], a[12:15], 0
  ds_read_b64_tr_b16 a[92:93], v229 offset:7168
  ds_read_b64_tr_b16 a[94:95], v229 offset:10752
  v_mfma_f32_16x16x32_bf16 v[32:35], a[96:99], a[0:3], 0
  v_mfma_f32_16x16x32_bf16 v[88:91], a[96:99], a[4:7], 0
  buffer_load_dwordx4 a[44:47], v224, s[4:7], s16 offen offset:3072 sc1
  v_mfma_f32_16x16x32_bf16 v[144:147], a[96:99], a[8:11], 0
  s_add_u32 s16, s16, s46
  v_mfma_f32_16x16x32_bf16 v[200:203], a[96:99], a[12:15], 0
  ds_read_b64_tr_b16 a[96:97], v229 offset:7200
  ds_read_b64_tr_b16 a[98:99], v229 offset:10784
  s_waitcnt lgkmcnt(10)
  v_mfma_f32_16x16x32_bf16 v[36:39], a[100:103], a[0:3], 0
  v_mfma_f32_16x16x32_bf16 v[92:95], a[100:103], a[4:7], 0
  buffer_load_dwordx4 a[48:51], v224, s[4:7], s16 offen offset:0 sc1
  v_mfma_f32_16x16x32_bf16 v[148:151], a[100:103], a[8:11], 0
  v_mfma_f32_16x16x32_bf16 v[204:207], a[100:103], a[12:15], 0
  ds_read_b64_tr_b16 a[100:101], v229 offset:7232
  ds_read_b64_tr_b16 a[102:103], v229 offset:10816
  v_mfma_f32_16x16x32_bf16 v[40:43], a[104:107], a[0:3], 0
  v_mfma_f32_16x16x32_bf16 v[96:99], a[104:107], a[4:7], 0
  v_mfma_f32_16x16x32_bf16 v[152:155], a[104:107], a[8:11], 0
  buffer_load_dwordx4 a[52:55], v224, s[4:7], s16 offen offset:1024 sc1
  v_mfma_f32_16x16x32_bf16 v[208:211], a[104:107], a[12:15], 0
  ds_read_b64_tr_b16 a[104:105], v229 offset:7264
  ds_read_b64_tr_b16 a[106:107], v229 offset:10848
  v_mfma_f32_16x16x32_bf16 v[44:47], a[108:111], a[0:3], 0
  v_mfma_f32_16x16x32_bf16 v[100:103], a[108:111], a[4:7], 0
  v_mfma_f32_16x16x32_bf16 v[156:159], a[108:111], a[8:11], 0
  buffer_load_dwordx4 a[56:59], v224, s[4:7], s16 offen offset:2048 sc1
  v_mfma_f32_16x16x32_bf16 v[212:215], a[108:111], a[12:15], 0
  ds_read_b64_tr_b16 a[108:109], v229 offset:7296
  ds_read_b64_tr_b16 a[110:111], v229 offset:10880
  v_mfma_f32_16x16x32_bf16 v[48:51], a[112:115], a[0:3], 0
  v_mfma_f32_16x16x32_bf16 v[104:107], a[112:115], a[4:7], 0
  v_mfma_f32_16x16x32_bf16 v[160:163], a[112:115], a[8:11], 0
  v_mfma_f32_16x16x32_bf16 v[216:219], a[112:115], a[12:15], 0
  buffer_load_dwordx4 a[60:63], v224, s[4:7], s16 offen offset:3072 sc1
  v_mfma_f32_16x16x32_bf16 v[52:55], a[116:119], a[0:3], 0
  ds_read_b64_tr_b16 a[112:113], v229 offset:7328
  s_add_u32 s16, s16, s47
  v_mfma_f32_16x16x32_bf16 v[108:111], a[116:119], a[4:7], 0
  ds_read_b64_tr_b16 a[114:115], v229 offset:10912
  v_mfma_f32_16x16x32_bf16 v[164:167], a[116:119], a[8:11], 0
  v_mfma_f32_16x16x32_bf16 v[220:223], a[116:119], a[12:15], 0
  s_waitcnt vmcnt(12) lgkmcnt(10)
  s_barrier
  v_cmp_ne_u32 vcc, s19, v247
  s_nop 1
  s_cmp_lg_u64 vcc, 0
  s_cbranch_scc1 L_slow_19
  L_back_20:
  v_mfma_f32_16x16x32_bf16 v[0:3], a[64:67], a[16:19], v[0:3]
  ds_read_b64_tr_b16 a[116:117], v229 offset:7360
  s_add_u32 m0, s38, 43008
  v_mfma_f32_16x16x32_bf16 v[56:59], a[64:67], a[20:23], v[56:59]
  buffer_load_dwordx4 v225, s[8:11], s17 offen lds
  v_mfma_f32_16x16x32_bf16 v[112:115], a[64:67], a[24:27], v[112:115]
  ds_read_b64_tr_b16 a[118:119], v229 offset:10944
  v_mfma_f32_16x16x32_bf16 v[168:171], a[64:67], a[28:31], v[168:171]
  ds_read_b64_tr_b16 a[64:65], v229 offset:14336
  ds_read_b64_tr_b16 a[66:67], v229 offset:17920
  v_mfma_f32_16x16x32_bf16 v[4:7], a[68:71], a[16:19], v[4:7]
  v_mfma_f32_16x16x32_bf16 v[60:63], a[68:71], a[20:23], v[60:63]
  v_mfma_f32_16x16x32_bf16 v[116:119], a[68:71], a[24:27], v[116:119]
  v_mfma_f32_16x16x32_bf16 v[172:175], a[68:71], a[28:31], v[172:175]
  buffer_load_dwordx4 a[0:3], v224, s[4:7], s16 offen offset:0 sc1
  v_mfma_f32_16x16x32_bf16 v[8:11], a[72:75], a[16:19], v[8:11]
  ds_read_b64_tr_b16 a[68:69], v229 offset:14368
  ds_read_b64_tr_b16 a[70:71], v229 offset:17952
  v_mfma_f32_16x16x32_bf16 v[64:67], a[72:75], a[20:23], v[64:67]
  v_mfma_f32_16x16x32_bf16 v[120:123], a[72:75], a[24:27], v[120:123]
  v_mfma_f32_16x16x32_bf16 v[176:179], a[72:75], a[28:31], v[176:179]
  ds_read_b64_tr_b16 a[72:73], v229 offset:14400
  ds_read_b64_tr_b16 a[74:75], v229 offset:17984
  v_mfma_f32_16x16x32_bf16 v[12:15], a[76:79], a[16:19], v[12:15]
  v_mfma_f32_16x16x32_bf16 v[68:71], a[76:79], a[20:23], v[68:71]
  buffer_load_dwordx4 v226, s[8:11], s17 offen offset:1024 lds
  v_mfma_f32_16x16x32_bf16 v[124:127], a[76:79], a[24:27], v[124:127]
  v_mfma_f32_16x16x32_bf16 v[180:183], a[76:79], a[28:31], v[180:183]
  ds_read_b64_tr_b16 a[76:77], v229 offset:14432
  ds_read_b64_tr_b16 a[78:79], v229 offset:18016
  v_mfma_f32_16x16x32_bf16 v[16:19], a[80:83], a[16:19], v[16:19]
  v_mfma_f32_16x16x32_bf16 v[72:75], a[80:83], a[20:23], v[72:75]
  v_mfma_f32_16x16x32_bf16 v[128:131], a[80:83], a[24:27], v[128:131]
  v_mfma_f32_16x16x32_bf16 v[184:187], a[80:83], a[28:31], v[184:187]
  buffer_load_dwordx4 a[4:7], v224, s[4:7], s16 offen offset:1024 sc1
  v_mfma_f32_16x16x32_bf16 v[20:23], a[84:87], a[16:19], v[20:23]
  ds_read_b64_tr_b16 a[80:81], v229 offset:14464
  ds_read_b64_tr_b16 a[82:83], v229 offset:18048
  v_mfma_f32_16x16x32_bf16 v[76:79], a[84:87], a[20:23], v[76:79]
  v_mfma_f32_16x16x32_bf16 v[132:135], a[84:87], a[24:27], v[132:135]
  v_mfma_f32_16x16x32_bf16 v[188:191], a[84:87], a[28:31], v[188:191]
  ds_read_b64_tr_b16 a[84:85], v229 offset:14496
  ds_read_b64_tr_b16 a[86:87], v229 offset:18080
  v_mfma_f32_16x16x32_bf16 v[24:27], a[88:91], a[16:19], v[24:27]
  v_mfma_f32_16x16x32_bf16 v[80:83], a[88:91], a[20:23], v[80:83]
  buffer_load_dwordx4 v227, s[8:11], s17 offen offset:2048 lds
  v_mfma_f32_16x16x32_bf16 v[136:139], a[88:91], a[24:27], v[136:139]
  v_mfma_f32_16x16x32_bf16 v[192:195], a[88:91], a[28:31], v[192:195]
  ds_read_b64_tr_b16 a[88:89], v229 offset:14528
  ds_read_b64_tr_b16 a[90:91], v229 offset:18112
  v_mfma_f32_16x16x32_bf16 v[28:31], a[92:95], a[16:19], v[28:31]
  v_mfma_f32_16x16x32_bf16 v[84:87], a[92:95], a[20:23], v[84:87]
  v_mfma_f32_16x16x32_bf16 v[140:143], a[92:95], a[24:27], v[140:143]
  v_mfma_f32_16x16x32_bf16 v[196:199], a[92:95], a[28:31], v[196:199]
  buffer_load_dwordx4 a[8:11], v224, s[4:7], s16 offen offset:2048 sc1
  s_waitcnt lgkmcnt(10)
  v_mfma_f32_16x16x32_bf16 v[32:35], a[96:99], a[16:19], v[32:35]
  ds_read_b64_tr_b16 a[92:93], v229 offset:21504
  ds_read_b64_tr_b16 a[94:95], v229 offset:25088
  v_mfma_f32_16x16x32_bf16 v[88:91], a[96:99], a[20:23], v[88:91]
  v_mfma_f32_16x16x32_bf16 v[144:147], a[96:99], a[24:27], v[144:147]
  v_mfma_f32_16x16x32_bf16 v[200:203], a[96:99], a[28:31], v[200:203]
  ds_read_b64_tr_b16 a[96:97], v229 offset:21536
  ds_read_b64_tr_b16 a[98:99], v229 offset:25120
  v_mfma_f32_16x16x32_bf16 v[36:39], a[100:103], a[16:19], v[36:39]
  v_mfma_f32_16x16x32_bf16 v[92:95], a[100:103], a[20:23], v[92:95]
  s_mov_b32 exec_hi, 0
  buffer_load_dwordx4 v228, s[8:11], s17 offen offset:3072 lds
  s_mov_b32 exec_hi, -1
  v_mfma_f32_16x16x32_bf16 v[148:151], a[100:103], a[24:27], v[148:151]
  s_add_u32 s17, s17, s96
  v_mfma_f32_16x16x32_bf16 v[204:207], a[100:103], a[28:31], v[204:207]
  ds_read_b64_tr_b16 a[100:101], v229 offset:21568
  ds_read_b64_tr_b16 a[102:103], v229 offset:25152
  v_mfma_f32_16x16x32_bf16 v[40:43], a[104:107], a[16:19], v[40:43]
  v_mfma_f32_16x16x32_bf16 v[96:99], a[104:107], a[20:23], v[96:99]
  v_mfma_f32_16x16x32_bf16 v[152:155], a[104:107], a[24:27], v[152:155]
  v_mfma_f32_16x16x32_bf16 v[208:211], a[104:107], a[28:31], v[208:211]
  buffer_load_dwordx4 a[12:15], v224, s[4:7], s16 offen offset:3072 sc1
  v_mfma_f32_16x16x32_bf16 v[44:47], a[108:111], a[16:19], v[44:47]
  ds_read_b64_tr_b16 a[104:105], v229 offset:21600
  s_add_u32 s16, s16, s44
  v_mfma_f32_16x16x32_bf16 v[100:103], a[108:111], a[20:23], v[100:103]
  ds_read_b64_tr_b16 a[106:107], v229 offset:25184
  v_mfma_f32_16x16x32_bf16 v[156:159], a[108:111], a[24:27], v[156:159]
  v_mfma_f32_16x16x32_bf16 v[212:215], a[108:111], a[28:31], v[212:215]
  ds_read_b64_tr_b16 a[108:109], v229 offset:21632
  ds_read_b64_tr_b16 a[110:111], v229 offset:25216
  v_mfma_f32_16x16x32_bf16 v[48:51], a[112:115], a[16:19], v[48:51]
  v_mfma_f32_16x16x32_bf16 v[104:107], a[112:115], a[20:23], v[104:107]
  buffer_load_dword v251, v249, s[52:55], s56 offen
  v_mfma_f32_16x16x32_bf16 v[160:163], a[112:115], a[24:27], v[160:163]
  s_add_u32 s56, s56, 524288
  v_mfma_f32_16x16x32_bf16 v[216:219], a[112:115], a[28:31], v[216:219]
  ds_read_b64_tr_b16 a[112:113], v229 offset:21664
  ds_read_b64_tr_b16 a[114:115], v229 offset:25248
  v_mfma_f32_16x16x32_bf16 v[52:55], a[116:119], a[16:19], v[52:55]
  v_mfma_f32_16x16x32_bf16 v[108:111], a[116:119], a[20:23], v[108:111]
  v_mfma_f32_16x16x32_bf16 v[164:167], a[116:119], a[24:27], v[164:167]
  v_mfma_f32_16x16x32_bf16 v[220:223], a[116:119], a[28:31], v[220:223]
  s_waitcnt vmcnt(13) lgkmcnt(10)
  s_barrier
  v_mfma_f32_16x16x32_bf16 v[0:3], a[64:67], a[32:35], v[0:3]
  ds_read_b64_tr_b16 a[116:117], v229 offset:21696
  s_add_u32 m0, s38, 0
  v_mfma_f32_16x16x32_bf16 v[56:59], a[64:67], a[36:39], v[56:59]
  buffer_load_dwordx4 v225, s[8:11], s17 offen lds
  v_mfma_f32_16x16x32_bf16 v[112:115], a[64:67], a[40:43], v[112:115]
  ds_read_b64_tr_b16 a[118:119], v229 offset:25280
  v_mfma_f32_16x16x32_bf16 v[168:171], a[64:67], a[44:47], v[168:171]
  ds_read_b64_tr_b16 a[64:65], v229 offset:28672
  ds_read_b64_tr_b16 a[66:67], v229 offset:32256
  v_mfma_f32_16x16x32_bf16 v[4:7], a[68:71], a[32:35], v[4:7]
  v_mfma_f32_16x16x32_bf16 v[60:63], a[68:71], a[36:39], v[60:63]
  v_mfma_f32_16x16x32_bf16 v[116:119], a[68:71], a[40:43], v[116:119]
  v_mfma_f32_16x16x32_bf16 v[172:175], a[68:71], a[44:47], v[172:175]
  buffer_load_dwordx4 a[16:19], v224, s[4:7], s16 offen offset:0 sc1
  v_mfma_f32_16x16x32_bf16 v[8:11], a[72:75], a[32:35], v[8:11]
  ds_read_b64_tr_b16 a[68:69], v229 offset:28704
  ds_read_b64_tr_b16 a[70:71], v229 offset:32288
  v_mfma_f32_16x16x32_bf16 v[64:67], a[72:75], a[36:39], v[64:67]
  v_mfma_f32_16x16x32_bf16 v[120:123], a[72:75], a[40:43], v[120:123]
  v_mfma_f32_16x16x32_bf16 v[176:179], a[72:75], a[44:47], v[176:179]
  ds_read_b64_tr_b16 a[72:73], v229 offset:28736
  ds_read_b64_tr_b16 a[74:75], v229 offset:32320
  v_mfma_f32_16x16x32_bf16 v[12:15], a[76:79], a[32:35], v[12:15]
  v_mfma_f32_16x16x32_bf16 v[68:71], a[76:79], a[36:39], v[68:71]
  v_mfma_f32_16x16x32_bf16 v[124:127], a[76:79], a[40:43], v[124:127]
  buffer_load_dwordx4 v226, s[8:11], s17 offen offset:1024 lds
  v_mfma_f32_16x16x32_bf16 v[180:183], a[76:79], a[44:47], v[180:183]
  ds_read_b64_tr_b16 a[76:77], v229 offset:28768
  ds_read_b64_tr_b16 a[78:79], v229 offset:32352
  v_mfma_f32_16x16x32_bf16 v[16:19], a[80:83], a[32:35], v[16:19]
  v_mfma_f32_16x16x32_bf16 v[72:75], a[80:83], a[36:39], v[72:75]
  v_mfma_f32_16x16x32_bf16 v[128:131], a[80:83], a[40:43], v[128:131]
  v_mfma_f32_16x16x32_bf16 v[184:187], a[80:83], a[44:47], v[184:187]
  ds_read_b64_tr_b16 a[80:81], v229 offset:28800
  ds_read_b64_tr_b16 a[82:83], v229 offset:32384
  v_mfma_f32_16x16x32_bf16 v[20:23], a[84:87], a[32:35], v[20:23]
  v_mfma_f32_16x16x32_bf16 v[76:79], a[84:87], a[36:39], v[76:79]
  buffer_load_dwordx4 a[20:23], v224, s[4:7], s16 offen offset:1024 sc1
  v_mfma_f32_16x16x32_bf16 v[132:135], a[84:87], a[40:43], v[132:135]
  v_mfma_f32_16x16x32_bf16 v[188:191], a[84:87], a[44:47], v[188:191]
  ds_read_b64_tr_b16 a[84:85], v229 offset:28832
  ds_read_b64_tr_b16 a[86:87], v229 offset:32416
  v_mfma_f32_16x16x32_bf16 v[24:27], a[88:91], a[32:35], v[24:27]
  v_mfma_f32_16x16x32_bf16 v[80:83], a[88:91], a[36:39], v[80:83]
  v_mfma_f32_16x16x32_bf16 v[136:139], a[88:91], a[40:43], v[136:139]
  v_mfma_f32_16x16x32_bf16 v[192:195], a[88:91], a[44:47], v[192:195]
  ds_read_b64_tr_b16 a[88:89], v229 offset:28864
  ds_read_b64_tr_b16 a[90:91], v229 offset:32448
  v_mfma_f32_16x16x32_bf16 v[28:31], a[92:95], a[32:35], v[28:31]
  buffer_load_dwordx4 v227, s[8:11], s17 offen offset:2048 lds
  v_mfma_f32_16x16x32_bf16 v[84:87], a[92:95], a[36:39], v[84:87]
  v_mfma_f32_16x16x32_bf16 v[140:143], a[92:95], a[40:43], v[140:143]
  v_mfma_f32_16x16x32_bf16 v[196:199], a[92:95], a[44:47], v[196:199]
  ds_read_b64_tr_b16 a[92:93], v229 offset:35840
  ds_read_b64_tr_b16 a[94:95], v229 offset:39424
  s_waitcnt lgkmcnt(10)
  v_mfma_f32_16x16x32_bf16 v[32:35], a[96:99], a[32:35], v[32:35]
  v_mfma_f32_16x16x32_bf16 v[88:91], a[96:99], a[36:39], v[88:91]
  v_mfma_f32_16x16x32_bf16 v[144:147], a[96:99], a[40:43], v[144:147]
  v_mfma_f32_16x16x32_bf16 v[200:203], a[96:99], a[44:47], v[200:203]
  buffer_load_dwordx4 a[24:27], v224, s[4:7], s16 offen offset:2048 sc1
  v_mfma_f32_16x16x32_bf16 v[36:39], a[100:103], a[32:35], v[36:39]
  ds_read_b64_tr_b16 a[96:97], v229 offset:35872
  ds_read_b64_tr_b16 a[98:99], v229 offset:39456
  v_mfma_f32_16x16x32_bf16 v[92:95], a[100:103], a[36:39], v[92:95]
  v_mfma_f32_16x16x32_bf16 v[148:151], a[100:103], a[40:43], v[148:151]
  v_mfma_f32_16x16x32_bf16 v[204:207], a[100:103], a[44:47], v[204:207]
  ds_read_b64_tr_b16 a[100:101], v229 offset:35904
  ds_read_b64_tr_b16 a[102:103], v229 offset:39488
  v_mfma_f32_16x16x32_bf16 v[40:43], a[104:107], a[32:35], v[40:43]
  v_mfma_f32_16x16x32_bf16 v[96:99], a[104:107], a[36:39], v[96:99]
  v_mfma_f32_16x16x32_bf16 v[152:155], a[104:107], a[40:43], v[152:155]
  s_mov_b32 exec_hi, 0
  buffer_load_dwordx4 v228, s[8:11], s17 offen offset:3072 lds
  s_mov_b32 exec_hi, -1
  v_mfma_f32_16x16x32_bf16 v[208:211], a[104:107], a[44:47], v[208:211]
  ds_read_b64_tr_b16 a[104:105], v229 offset:35936
  s_add_u32 s17, s17, s97
  v_mfma_f32_16x16x32_bf16 v[44:47], a[108:111], a[32:35], v[44:47]
  ds_read_b64_tr_b16 a[106:107], v229 offset:39520
  v_mfma_f32_16x16x32_bf16 v[100:103], a[108:111], a[36:39], v[100:103]
  v_mfma_f32_16x16x32_bf16 v[156:159], a[108:111], a[40:43], v[156:159]
  v_mfma_f32_16x16x32_bf16 v[212:215], a[108:111], a[44:47], v[212:215]
  ds_read_b64_tr_b16 a[108:109], v229 offset:35968
  ds_read_b64_tr_b16 a[110:111], v229 offset:39552
  v_mfma_f32_16x16x32_bf16 v[48:51], a[112:115], a[32:35], v[48:51]
  v_mfma_f32_16x16x32_bf16 v[104:107], a[112:115], a[36:39], v[104:107]
  buffer_load_dwordx4 a[28:31], v224, s[4:7], s16 offen offset:3072 sc1
  v_mfma_f32_16x16x32_bf16 v[160:163], a[112:115], a[40:43], v[160:163]
  s_add_u32 s16, s16, s45
  v_mfma_f32_16x16x32_bf16 v[216:219], a[112:115], a[44:47], v[216:219]
  ds_read_b64_tr_b16 a[112:113], v229 offset:36000
  ds_read_b64_tr_b16 a[114:115], v229 offset:39584
  v_mfma_f32_16x16x32_bf16 v[52:55], a[116:119], a[32:35], v[52:55]
  v_mfma_f32_16x16x32_bf16 v[108:111], a[116:119], a[36:39], v[108:111]
  v_mfma_f32_16x16x32_bf16 v[164:167], a[116:119], a[40:43], v[164:167]
  v_mfma_f32_16x16x32_bf16 v[220:223], a[116:119], a[44:47], v[220:223]
  s_mov_b32 s18, 6
  .p2align 6
L_loop_24:
  s_waitcnt vmcnt(10) lgkmcnt(10)
  s_barrier
  v_mfma_f32_16x16x32_bf16 v[0:3], a[64:67], a[48:51], v[0:3]
  ds_read_b64_tr_b16 a[116:117], v229 offset:36032
  s_add_u32 m0, s38, 14336
  v_mfma_f32_16x16x32_bf16 v[56:59], a[64:67], a[52:55], v[56:59]
  buffer_load_dwordx4 v225, s[8:11], s17 offen lds
  v_mfma_f32_16x16x32_bf16 v[112:115], a[64:67], a[56:59], v[112:115]
  ds_read_b64_tr_b16 a[118:119], v229 offset:39616
  v_mfma_f32_16x16x32_bf16 v[168:171], a[64:67], a[60:63], v[168:171]
  ds_read_b64_tr_b16 a[64:65], v229 offset:43008
  ds_read_b64_tr_b16 a[66:67], v229 offset:46592
  v_mfma_f32_16x16x32_bf16 v[4:7], a[68:71], a[48:51], v[4:7]
  v_mfma_f32_16x16x32_bf16 v[60:63], a[68:71], a[52:55], v[60:63]
  v_mfma_f32_16x16x32_bf16 v[116:119], a[68:71], a[56:59], v[116:119]
  v_mfma_f32_16x16x32_bf16 v[172:175], a[68:71], a[60:63], v[172:175]
  buffer_load_dwordx4 a[32:35], v224, s[4:7], s16 offen offset:0 sc1
  v_mfma_f32_16x16x32_bf16 v[8:11], a[72:75], a[48:51], v[8:11]
  ds_read_b64_tr_b16 a[68:69], v229 offset:43040
  ds_read_b64_tr_b16 a[70:71], v229 offset:46624
  v_mfma_f32_16x16x32_bf16 v[64:67], a[72:75], a[52:55], v[64:67]
  v_mfma_f32_16x16x32_bf16 v[120:123], a[72:75], a[56:59], v[120:123]
  v_mfma_f32_16x16x32_bf16 v[176:179], a[72:75], a[60:63], v[176:179]
  ds_read_b64_tr_b16 a[72:73], v229 offset:43072
  ds_read_b64_tr_b16 a[74:75], v229 offset:46656
  v_mfma_f32_16x16x32_bf16 v[12:15], a[76:79], a[48:51], v[12:15]
  v_mfma_f32_16x16x32_bf16 v[68:71], a[76:79], a[52:55], v[68:71]
  v_mfma_f32_16x16x32_bf16 v[124:127], a[76:79], a[56:59], v[124:127]
  buffer_load_dwordx4 v226, s[8:11], s17 offen offset:1024 lds
  v_mfma_f32_16x16x32_bf16 v[180:183], a[76:79], a[60:63], v[180:183]
  ds_read_b64_tr_b16 a[76:77], v229 offset:43104
  ds_read_b64_tr_b16 a[78:79], v229 offset:46688
  v_mfma_f32_16x16x32_bf16 v[16:19], a[80:83], a[48:51], v[16:19]
  v_mfma_f32_16x16x32_bf16 v[72:75], a[80:83], a[52:55], v[72:75]
  v_mfma_f32_16x16x32_bf16 v[128:131], a[80:83], a[56:59], v[128:131]
  v_mfma_f32_16x16x32_bf16 v[184:187], a[80:83], a[60:63], v[184:187]
  ds_read_b64_tr_b16 a[80:81], v229 offset:43136
  ds_read_b64_tr_b16 a[82:83], v229 offset:46720
  v_mfma_f32_16x16x32_bf16 v[20:23], a[84:87], a[48:51], v[20:23]
  v_mfma_f32_16x16x32_bf16 v[76:79], a[84:87], a[52:55], v[76:79]
  buffer_load_dwordx4 a[36:39], v224, s[4:7], s16 offen offset:1024 sc1
  v_mfma_f32_16x16x32_bf16 v[132:135], a[84:87], a[56:59], v[132:135]
  v_mfma_f32_16x16x32_bf16 v[188:191], a[84:87], a[60:63], v[188:191]
  ds_read_b64_tr_b16 a[84:85], v229 offset:43168
  ds_read_b64_tr_b16 a[86:87], v229 offset:46752
  v_mfma_f32_16x16x32_bf16 v[24:27], a[88:91], a[48:51], v[24:27]
  v_mfma_f32_16x16x32_bf16 v[80:83], a[88:91], a[52:55], v[80:83]
  v_mfma_f32_16x16x32_bf16 v[136:139], a[88:91], a[56:59], v[136:139]
  v_mfma_f32_16x16x32_bf16 v[192:195], a[88:91], a[60:63], v[192:195]
  ds_read_b64_tr_b16 a[88:89], v229 offset:43200
  ds_read_b64_tr_b16 a[90:91], v229 offset:46784
  v_mfma_f32_16x16x32_bf16 v[28:31], a[92:95], a[48:51], v[28:31]
  buffer_load_dwordx4 v227, s[8:11], s17 offen offset:2048 lds
  v_mfma_f32_16x16x32_bf16 v[84:87], a[92:95], a[52:55], v[84:87]
  v_mfma_f32_16x16x32_bf16 v[140:143], a[92:95], a[56:59], v[140:143]
  v_mfma_f32_16x16x32_bf16 v[196:199], a[92:95], a[60:63], v[196:199]
  ds_read_b64_tr_b16 a[92:93], v229 offset:50176
  ds_read_b64_tr_b16 a[94:95], v229 offset:53760
  s_waitcnt lgkmcnt(10)
  v_mfma_f32_16x16x32_bf16 v[32:35], a[96:99], a[48:51], v[32:35]
  v_mfma_f32_16x16x32_bf16 v[88:91], a[96:99], a[52:55], v[88:91]
  v_mfma_f32_16x16x32_bf16 v[144:147], a[96:99], a[56:59], v[144:147]
  v_mfma_f32_16x16x32_bf16 v[200:203], a[96:99], a[60:63], v[200:203]
  buffer_load_dwordx4 a[40:43], v224, s[4:7], s16 offen offset:2048 sc1
  v_mfma_f32_16x16x32_bf16 v[36:39], a[100:103], a[48:51], v[36:39]
  ds_read_b64_tr_b16 a[96:97], v229 offset:50208
  ds_read_b64_tr_b16 a[98:99], v229 offset:53792
  v_mfma_f32_16x16x32_bf16 v[92:95], a[100:103], a[52:55], v[92:95]
  v_mfma_f32_16x16x32_bf16 v[148:151], a[100:103], a[56:59], v[148:151]
  v_mfma_f32_16x16x32_bf16 v[204:207], a[100:103], a[60:63], v[204:207]
  ds_read_b64_tr_b16 a[100:101], v229 offset:50240
  ds_read_b64_tr_b16 a[102:103], v229 offset:53824
  v_mfma_f32_16x16x32_bf16 v[40:43], a[104:107], a[48:51], v[40:43]
  v_mfma_f32_16x16x32_bf16 v[96:99], a[104:107], a[52:55], v[96:99]
  v_mfma_f32_16x16x32_bf16 v[152:155], a[104:107], a[56:59], v[152:155]
  s_mov_b32 exec_hi, 0
  buffer_load_dwordx4 v228, s[8:11], s17 offen offset:3072 lds
  s_mov_b32 exec_hi, -1
  v_mfma_f32_16x16x32_bf16 v[208:211], a[104:107], a[60:63], v[208:211]
  ds_read_b64_tr_b16 a[104:105], v229 offset:50272
  s_add_u32 s17, s17, s98
  v_mfma_f32_16x16x32_bf16 v[44:47], a[108:111], a[48:51], v[44:47]
  ds_read_b64_tr_b16 a[106:107], v229 offset:53856
  v_mfma_f32_16x16x32_bf16 v[100:103], a[108:111], a[52:55], v[100:103]
  v_mfma_f32_16x16x32_bf16 v[156:159], a[108:111], a[56:59], v[156:159]
  v_mfma_f32_16x16x32_bf16 v[212:215], a[108:111], a[60:63], v[212:215]
  ds_read_b64_tr_b16 a[108:109], v229 offset:50304
  ds_read_b64_tr_b16 a[110:111], v229 offset:53888
  v_mfma_f32_16x16x32_bf16 v[48:51], a[112:115], a[48:51], v[48:51]
  v_mfma_f32_16x16x32_bf16 v[104:107], a[112:115], a[52:55], v[104:107]
  buffer_load_dwordx4 a[44:47], v224, s[4:7], s16 offen offset:3072 sc1
  v_mfma_f32_16x16x32_bf16 v[160:163], a[112:115], a[56:59], v[160:163]
  s_add_u32 s16, s16, s46
  v_mfma_f32_16x16x32_bf16 v[216:219], a[112:115], a[60:63], v[216:219]
  ds_read_b64_tr_b16 a[112:113], v229 offset:50336
  ds_read_b64_tr_b16 a[114:115], v229 offset:53920
  v_mfma_f32_16x16x32_bf16 v[52:55], a[116:119], a[48:51], v[52:55]
  v_mfma_f32_16x16x32_bf16 v[108:111], a[116:119], a[52:55], v[108:111]
  v_mfma_f32_16x16x32_bf16 v[164:167], a[116:119], a[56:59], v[164:167]
  v_mfma_f32_16x16x32_bf16 v[220:223], a[116:119], a[60:63], v[220:223]
  s_waitcnt vmcnt(9) lgkmcnt(10)
  s_barrier
  v_mfma_f32_16x16x32_bf16 v[0:3], a[64:67], a[0:3], v[0:3]
  ds_read_b64_tr_b16 a[116:117], v229 offset:50368
  s_add_u32 m0, s38, 28672
  v_mfma_f32_16x16x32_bf16 v[56:59], a[64:67], a[4:7], v[56:59]
  buffer_load_dwordx4 v225, s[8:11], s17 offen lds
  v_mfma_f32_16x16x32_bf16 v[112:115], a[64:67], a[8:11], v[112:115]
  ds_read_b64_tr_b16 a[118:119], v229 offset:53952
  v_mfma_f32_16x16x32_bf16 v[168:171], a[64:67], a[12:15], v[168:171]
  ds_read_b64_tr_b16 a[64:65], v229 offset:0
  ds_read_b64_tr_b16 a[66:67], v229 offset:3584
  v_mfma_f32_16x16x32_bf16 v[4:7], a[68:71], a[0:3], v[4:7]
  v_mfma_f32_16x16x32_bf16 v[60:63], a[68:71], a[4:7], v[60:63]
  v_mfma_f32_16x16x32_bf16 v[116:119], a[68:71], a[8:11], v[116:119]
  v_mfma_f32_16x16x32_bf16 v[172:175], a[68:71], a[12:15], v[172:175]
  buffer_load_dwordx4 a[48:51], v224, s[4:7], s16 offen offset:0 sc1
  v_mfma_f32_16x16x32_bf16 v[8:11], a[72:75], a[0:3], v[8:11]
  ds_read_b64_tr_b16 a[68:69], v229 offset:32
  ds_read_b64_tr_b16 a[70:71], v229 offset:3616
  v_mfma_f32_16x16x32_bf16 v[64:67], a[72:75], a[4:7], v[64:67]
  v_mfma_f32_16x16x32_bf16 v[120:123], a[72:75], a[8:11], v[120:123]
  v_mfma_f32_16x16x32_bf16 v[176:179], a[72:75], a[12:15], v[176:179]
  ds_read_b64_tr_b16 a[72:73], v229 offset:64
  ds_read_b64_tr_b16 a[74:75], v229 offset:3648
  v_mfma_f32_16x16x32_bf16 v[12:15], a[76:79], a[0:3], v[12:15]
  v_mfma_f32_16x16x32_bf16 v[68:71], a[76:79], a[4:7], v[68:71]
  v_mfma_f32_16x16x32_bf16 v[124:127], a[76:79], a[8:11], v[124:127]
  buffer_load_dwordx4 v226, s[8:11], s17 offen offset:1024 lds
  v_mfma_f32_16x16x32_bf16 v[180:183], a[76:79], a[12:15], v[180:183]
  ds_read_b64_tr_b16 a[76:77], v229 offset:96
  ds_read_b64_tr_b16 a[78:79], v229 offset:3680
  v_mfma_f32_16x16x32_bf16 v[16:19], a[80:83], a[0:3], v[16:19]
  v_mfma_f32_16x16x32_bf16 v[72:75], a[80:83], a[4:7], v[72:75]
  v_mfma_f32_16x16x32_bf16 v[128:131], a[80:83], a[8:11], v[128:131]
  v_mfma_f32_16x16x32_bf16 v[184:187], a[80:83], a[12:15], v[184:187]
  ds_read_b64_tr_b16 a[80:81], v229 offset:128
  ds_read_b64_tr_b16 a[82:83], v229 offset:3712
  v_mfma_f32_16x16x32_bf16 v[20:23], a[84:87], a[0:3], v[20:23]
  v_mfma_f32_16x16x32_bf16 v[76:79], a[84:87], a[4:7], v[76:79]
  buffer_load_dwordx4 a[52:55], v224, s[4:7], s16 offen offset:1024 sc1
  v_mfma_f32_16x16x32_bf16 v[132:135], a[84:87], a[8:11], v[132:135]
  v_mfma_f32_16x16x32_bf16 v[188:191], a[84:87], a[12:15], v[188:191]
  ds_read_b64_tr_b16 a[84:85], v229 offset:160
  ds_read_b64_tr_b16 a[86:87], v229 offset:3744
  v_mfma_f32_16x16x32_bf16 v[24:27], a[88:91], a[0:3], v[24:27]
  v_mfma_f32_16x16x32_bf16 v[80:83], a[88:91], a[4:7], v[80:83]
  v_mfma_f32_16x16x32_bf16 v[136:139], a[88:91], a[8:11], v[136:139]
  v_mfma_f32_16x16x32_bf16 v[192:195], a[88:91], a[12:15], v[192:195]
  ds_read_b64_tr_b16 a[88:89], v229 offset:192
  ds_read_b64_tr_b16 a[90:91], v229 offset:3776
  v_mfma_f32_16x16x32_bf16 v[28:31], a[92:95], a[0:3], v[28:31]
  buffer_load_dwordx4 v227, s[8:11], s17 offen offset:2048 lds
  v_mfma_f32_16x16x32_bf16 v[84:87], a[92:95], a[4:7], v[84:87]
  v_mfma_f32_16x16x32_bf16 v[140:143], a[92:95], a[8:11], v[140:143]
  v_mfma_f32_16x16x32_bf16 v[196:199], a[92:95], a[12:15], v[196:199]
  ds_read_b64_tr_b16 a[92:93], v229 offset:7168
  ds_read_b64_tr_b16 a[94:95], v229 offset:10752
  s_waitcnt lgkmcnt(10)
  v_mfma_f32_16x16x32_bf16 v[32:35], a[96:99], a[0:3], v[32:35]
  v_mfma_f32_16x16x32_bf16 v[88:91], a[96:99], a[4:7], v[88:91]
  v_mfma_f32_16x16x32_bf16 v[144:147], a[96:99], a[8:11], v[144:147]
  v_mfma_f32_16x16x32_bf16 v[200:203], a[96:99], a[12:15], v[200:203]
  buffer_load_dwordx4 a[56:59], v224, s[4:7], s16 offen offset:2048 sc1
  v_mfma_f32_16x16x32_bf16 v[36:39], a[100:103], a[0:3], v[36:39]
  ds_read_b64_tr_b16 a[96:97], v229 offset:7200
  ds_read_b64_tr_b16 a[98:99], v229 offset:10784
  v_mfma_f32_16x16x32_bf16 v[92:95], a[100:103], a[4:7], v[92:95]
  v_mfma_f32_16x16x32_bf16 v[148:151], a[100:103], a[8:11], v[148:151]
  v_mfma_f32_16x16x32_bf16 v[204:207], a[100:103], a[12:15], v[204:207]
  ds_read_b64_tr_b16 a[100:101], v229 offset:7232
  ds_read_b64_tr_b16 a[102:103], v229 offset:10816
  v_mfma_f32_16x16x32_bf16 v[40:43], a[104:107], a[0:3], v[40:43]
  v_mfma_f32_16x16x32_bf16 v[96:99], a[104:107], a[4:7], v[96:99]
  v_mfma_f32_16x16x32_bf16 v[152:155], a[104:107], a[8:11], v[152:155]
  s_mov_b32 exec_hi, 0
  buffer_load_dwordx4 v228, s[8:11], s17 offen offset:3072 lds
  s_mov_b32 exec_hi, -1
  v_mfma_f32_16x16x32_bf16 v[208:211], a[104:107], a[12:15], v[208:211]
  ds_read_b64_tr_b16 a[104:105], v229 offset:7264
  s_add_u32 s17, s17, s99
  v_mfma_f32_16x16x32_bf16 v[44:47], a[108:111], a[0:3], v[44:47]
  ds_read_b64_tr_b16 a[106:107], v229 offset:10848
  v_mfma_f32_16x16x32_bf16 v[100:103], a[108:111], a[4:7], v[100:103]
  v_mfma_f32_16x16x32_bf16 v[156:159], a[108:111], a[8:11], v[156:159]
  v_mfma_f32_16x16x32_bf16 v[212:215], a[108:111], a[12:15], v[212:215]
  ds_read_b64_tr_b16 a[108:109], v229 offset:7296
  ds_read_b64_tr_b16 a[110:111], v229 offset:10880
  v_mfma_f32_16x16x32_bf16 v[48:51], a[112:115], a[0:3], v[48:51]
  v_mfma_f32_16x16x32_bf16 v[104:107], a[112:115], a[4:7], v[104:107]
  buffer_load_dwordx4 a[60:63], v224, s[4:7], s16 offen offset:3072 sc1
  v_mfma_f32_16x16x32_bf16 v[160:163], a[112:115], a[8:11], v[160:163]
  s_add_u32 s16, s16, s47
  v_mfma_f32_16x16x32_bf16 v[216:219], a[112:115], a[12:15], v[216:219]
  ds_read_b64_tr_b16 a[112:113], v229 offset:7328
  ds_read_b64_tr_b16 a[114:115], v229 offset:10912
  v_mfma_f32_16x16x32_bf16 v[52:55], a[116:119], a[0:3], v[52:55]
  v_mfma_f32_16x16x32_bf16 v[108:111], a[116:119], a[4:7], v[108:111]
  v_mfma_f32_16x16x32_bf16 v[164:167], a[116:119], a[8:11], v[164:167]
  v_mfma_f32_16x16x32_bf16 v[220:223], a[116:119], a[12:15], v[220:223]
  s_waitcnt vmcnt(9) lgkmcnt(10)
  s_barrier
  v_mfma_f32_16x16x32_bf16 v[0:3], a[64:67], a[16:19], v[0:3]
  ds_read_b64_tr_b16 a[116:117], v229 offset:7360
  s_add_u32 m0, s38, 43008
  v_mfma_f32_16x16x32_bf16 v[56:59], a[64:67], a[20:23], v[56:59]
  buffer_load_dwordx4 v225, s[8:11], s17 offen lds
  v_mfma_f32_16x16x32_bf16 v[112:115], a[64:67], a[24:27], v[112:115]
  ds_read_b64_tr_b16 a[118:119], v229 offset:10944
  v_mfma_f32_16x16x32_bf16 v[168:171], a[64:67], a[28:31], v[168:171]
  ds_read_b64_tr_b16 a[64:65], v229 offset:14336
  ds_read_b64_tr_b16 a[66:67], v229 offset:17920
  v_mfma_f32_16x16x32_bf16 v[4:7], a[68:71], a[16:19], v[4:7]
  v_mfma_f32_16x16x32_bf16 v[60:63], a[68:71], a[20:23], v[60:63]
  v_mfma_f32_16x16x32_bf16 v[116:119], a[68:71], a[24:27], v[116:119]
  v_mfma_f32_16x16x32_bf16 v[172:175], a[68:71], a[28:31], v[172:175]
  buffer_load_dwordx4 a[0:3], v224, s[4:7], s16 offen offset:0 sc1
  v_mfma_f32_16x16x32_bf16 v[8:11], a[72:75], a[16:19], v[8:11]
  ds_read_b64_tr_b16 a[68:69], v229 offset:14368
  ds_read_b64_tr_b16 a[70:71], v229 offset:17952
  v_mfma_f32_16x16x32_bf16 v[64:67], a[72:75], a[20:23], v[64:67]
  v_mfma_f32_16x16x32_bf16 v[120:123], a[72:75], a[24:27], v[120:123]
  v_mfma_f32_16x16x32_bf16 v[176:179], a[72:75], a[28:31], v[176:179]
  ds_read_b64_tr_b16 a[72:73], v229 offset:14400
  ds_read_b64_tr_b16 a[74:75], v229 offset:17984
  v_mfma_f32_16x16x32_bf16 v[12:15], a[76:79], a[16:19], v[12:15]
  v_mfma_f32_16x16x32_bf16 v[68:71], a[76:79], a[20:23], v[68:71]
  buffer_load_dwordx4 v226, s[8:11], s17 offen offset:1024 lds
  v_mfma_f32_16x16x32_bf16 v[124:127], a[76:79], a[24:27], v[124:127]
  v_mfma_f32_16x16x32_bf16 v[180:183], a[76:79], a[28:31], v[180:183]
  ds_read_b64_tr_b16 a[76:77], v229 offset:14432
  ds_read_b64_tr_b16 a[78:79], v229 offset:18016
  v_mfma_f32_16x16x32_bf16 v[16:19], a[80:83], a[16:19], v[16:19]
  v_mfma_f32_16x16x32_bf16 v[72:75], a[80:83], a[20:23], v[72:75]
  v_mfma_f32_16x16x32_bf16 v[128:131], a[80:83], a[24:27], v[128:131]
  v_mfma_f32_16x16x32_bf16 v[184:187], a[80:83], a[28:31], v[184:187]
  buffer_load_dwordx4 a[4:7], v224, s[4:7], s16 offen offset:1024 sc1
  v_mfma_f32_16x16x32_bf16 v[20:23], a[84:87], a[16:19], v[20:23]
  ds_read_b64_tr_b16 a[80:81], v229 offset:14464
  ds_read_b64_tr_b16 a[82:83], v229 offset:18048
  v_mfma_f32_16x16x32_bf16 v[76:79], a[84:87], a[20:23], v[76:79]
  v_mfma_f32_16x16x32_bf16 v[132:135], a[84:87], a[24:27], v[132:135]
  v_mfma_f32_16x16x32_bf16 v[188:191], a[84:87], a[28:31], v[188:191]
  ds_read_b64_tr_b16 a[84:85], v229 offset:14496
  ds_read_b64_tr_b16 a[86:87], v229 offset:18080
  v_mfma_f32_16x16x32_bf16 v[24:27], a[88:91], a[16:19], v[24:27]
  v_mfma_f32_16x16x32_bf16 v[80:83], a[88:91], a[20:23], v[80:83]
  buffer_load_dwordx4 v227, s[8:11], s17 offen offset:2048 lds
  v_mfma_f32_16x16x32_bf16 v[136:139], a[88:91], a[24:27], v[136:139]
  v_mfma_f32_16x16x32_bf16 v[192:195], a[88:91], a[28:31], v[192:195]
  ds_read_b64_tr_b16 a[88:89], v229 offset:14528
  ds_read_b64_tr_b16 a[90:91], v229 offset:18112
  v_mfma_f32_16x16x32_bf16 v[28:31], a[92:95], a[16:19], v[28:31]
  v_mfma_f32_16x16x32_bf16 v[84:87], a[92:95], a[20:23], v[84:87]
  v_mfma_f32_16x16x32_bf16 v[140:143], a[92:95], a[24:27], v[140:143]
  v_mfma_f32_16x16x32_bf16 v[196:199], a[92:95], a[28:31], v[196:199]
  buffer_load_dwordx4 a[8:11], v224, s[4:7], s16 offen offset:2048 sc1
  s_waitcnt lgkmcnt(10)
  v_mfma_f32_16x16x32_bf16 v[32:35], a[96:99], a[16:19], v[32:35]
  ds_read_b64_tr_b16 a[92:93], v229 offset:21504
  ds_read_b64_tr_b16 a[94:95], v229 offset:25088
  v_mfma_f32_16x16x32_bf16 v[88:91], a[96:99], a[20:23], v[88:91]
  v_mfma_f32_16x16x32_bf16 v[144:147], a[96:99], a[24:27], v[144:147]
  v_mfma_f32_16x16x32_bf16 v[200:203], a[96:99], a[28:31], v[200:203]
  ds_read_b64_tr_b16 a[96:97], v229 offset:21536
  ds_read_b64_tr_b16 a[98:99], v229 offset:25120
  v_mfma_f32_16x16x32_bf16 v[36:39], a[100:103], a[16:19], v[36:39]
  v_mfma_f32_16x16x32_bf16 v[92:95], a[100:103], a[20:23], v[92:95]
  s_mov_b32 exec_hi, 0
  buffer_load_dwordx4 v228, s[8:11], s17 offen offset:3072 lds
  s_mov_b32 exec_hi, -1
  v_mfma_f32_16x16x32_bf16 v[148:151], a[100:103], a[24:27], v[148:151]
  s_add_u32 s17, s17, s96
  v_mfma_f32_16x16x32_bf16 v[204:207], a[100:103], a[28:31], v[204:207]
  ds_read_b64_tr_b16 a[100:101], v229 offset:21568
  ds_read_b64_tr_b16 a[102:103], v229 offset:25152
  v_mfma_f32_16x16x32_bf16 v[40:43], a[104:107], a[16:19], v[40:43]
  v_mfma_f32_16x16x32_bf16 v[96:99], a[104:107], a[20:23], v[96:99]
  v_mfma_f32_16x16x32_bf16 v[152:155], a[104:107], a[24:27], v[152:155]
  v_mfma_f32_16x16x32_bf16 v[208:211], a[104:107], a[28:31], v[208:211]
  buffer_load_dwordx4 a[12:15], v224, s[4:7], s16 offen offset:3072 sc1
  v_mfma_f32_16x16x32_bf16 v[44:47], a[108:111], a[16:19], v[44:47]
  ds_read_b64_tr_b16 a[104:105], v229 offset:21600
  s_add_u32 s16, s16, s44
  v_mfma_f32_16x16x32_bf16 v[100:103], a[108:111], a[20:23], v[100:103]
  ds_read_b64_tr_b16 a[106:107], v229 offset:25184
  v_mfma_f32_16x16x32_bf16 v[156:159], a[108:111], a[24:27], v[156:159]
  v_mfma_f32_16x16x32_bf16 v[212:215], a[108:111], a[28:31], v[212:215]
  ds_read_b64_tr_b16 a[108:109], v229 offset:21632
  ds_read_b64_tr_b16 a[110:111], v229 offset:25216
  v_mfma_f32_16x16x32_bf16 v[48:51], a[112:115], a[16:19], v[48:51]
  v_mfma_f32_16x16x32_bf16 v[104:107], a[112:115], a[20:23], v[104:107]
  buffer_load_dword v251, v249, s[52:55], s56 offen
  v_mfma_f32_16x16x32_bf16 v[160:163], a[112:115], a[24:27], v[160:163]
  s_add_u32 s56, s56, 524288
  v_mfma_f32_16x16x32_bf16 v[216:219], a[112:115], a[28:31], v[216:219]
  ds_read_b64_tr_b16 a[112:113], v229 offset:21664
  ds_read_b64_tr_b16 a[114:115], v229 offset:25248
  v_mfma_f32_16x16x32_bf16 v[52:55], a[116:119], a[16:19], v[52:55]
  v_mfma_f32_16x16x32_bf16 v[108:111], a[116:119], a[20:23], v[108:111]
  v_mfma_f32_16x16x32_bf16 v[164:167], a[116:119], a[24:27], v[164:167]
  v_mfma_f32_16x16x32_bf16 v[220:223], a[116:119], a[28:31], v[220:223]
  s_waitcnt vmcnt(10) lgkmcnt(10)
  s_barrier
  v_mfma_f32_16x16x32_bf16 v[0:3], a[64:67], a[32:35], v[0:3]
  ds_read_b64_tr_b16 a[116:117], v229 offset:21696
  s_add_u32 m0, s38, 0
  v_mfma_f32_16x16x32_bf16 v[56:59], a[64:67], a[36:39], v[56:59]
  buffer_load_dwordx4 v225, s[8:11], s17 offen lds
  v_mfma_f32_16x16x32_bf16 v[112:115], a[64:67], a[40:43], v[112:115]
  ds_read_b64_tr_b16 a[118:119], v229 offset:25280
  v_mfma_f32_16x16x32_bf16 v[168:171], a[64:67], a[44:47], v[168:171]
  ds_read_b64_tr_b16 a[64:65], v229 offset:28672
  ds_read_b64_tr_b16 a[66:67], v229 offset:32256
  v_mfma_f32_16x16x32_bf16 v[4:7], a[68:71], a[32:35], v[4:7]
  v_mfma_f32_16x16x32_bf16 v[60:63], a[68:71], a[36:39], v[60:63]
  v_mfma_f32_16x16x32_bf16 v[116:119], a[68:71], a[40:43], v[116:119]
  v_mfma_f32_16x16x32_bf16 v[172:175], a[68:71], a[44:47], v[172:175]
  buffer_load_dwordx4 a[16:19], v224, s[4:7], s16 offen offset:0 sc1
  v_mfma_f32_16x16x32_bf16 v[8:11], a[72:75], a[32:35], v[8:11]
  ds_read_b64_tr_b16 a[68:69], v229 offset:28704
  ds_read_b64_tr_b16 a[70:71], v229 offset:32288
  v_mfma_f32_16x16x32_bf16 v[64:67], a[72:75], a[36:39], v[64:67]
  v_mfma_f32_16x16x32_bf16 v[120:123], a[72:75], a[40:43], v[120:123]
  v_mfma_f32_16x16x32_bf16 v[176:179], a[72:75], a[44:47], v[176:179]
  ds_read_b64_tr_b16 a[72:73], v229 offset:28736
  ds_read_b64_tr_b16 a[74:75], v229 offset:32320
  v_mfma_f32_16x16x32_bf16 v[12:15], a[76:79], a[32:35], v[12:15]
  v_mfma_f32_16x16x32_bf16 v[68:71], a[76:79], a[36:39], v[68:71]
  v_mfma_f32_16x16x32_bf16 v[124:127], a[76:79], a[40:43], v[124:127]
  buffer_load_dwordx4 v226, s[8:11], s17 offen offset:1024 lds
  v_mfma_f32_16x16x32_bf16 v[180:183], a[76:79], a[44:47], v[180:183]
  ds_read_b64_tr_b16 a[76:77], v229 offset:28768
  ds_read_b64_tr_b16 a[78:79], v229 offset:32352
  v_mfma_f32_16x16x32_bf16 v[16:19], a[80:83], a[32:35], v[16:19]
  v_mfma_f32_16x16x32_bf16 v[72:75], a[80:83], a[36:39], v[72:75]
  v_mfma_f32_16x16x32_bf16 v[128:131], a[80:83], a[40:43], v[128:131]
  v_mfma_f32_16x16x32_bf16 v[184:187], a[80:83], a[44:47], v[184:187]
  ds_read_b64_tr_b16 a[80:81], v229 offset:28800
  ds_read_b64_tr_b16 a[82:83], v229 offset:32384
  v_mfma_f32_16x16x32_bf16 v[20:23], a[84:87], a[32:35], v[20:23]
  v_mfma_f32_16x16x32_bf16 v[76:79], a[84:87], a[36:39], v[76:79]
  buffer_load_dwordx4 a[20:23], v224, s[4:7], s16 offen offset:1024 sc1
  v_mfma_f32_16x16x32_bf16 v[132:135], a[84:87], a[40:43], v[132:135]
  v_mfma_f32_16x16x32_bf16 v[188:191], a[84:87], a[44:47], v[188:191]
  ds_read_b64_tr_b16 a[84:85], v229 offset:28832
  ds_read_b64_tr_b16 a[86:87], v229 offset:32416
  v_mfma_f32_16x16x32_bf16 v[24:27], a[88:91], a[32:35], v[24:27]
  v_mfma_f32_16x16x32_bf16 v[80:83], a[88:91], a[36:39], v[80:83]
  v_mfma_f32_16x16x32_bf16 v[136:139], a[88:91], a[40:43], v[136:139]
  v_mfma_f32_16x16x32_bf16 v[192:195], a[88:91], a[44:47], v[192:195]
  ds_read_b64_tr_b16 a[88:89], v229 offset:28864
  ds_read_b64_tr_b16 a[90:91], v229 offset:32448
  v_mfma_f32_16x16x32_bf16 v[28:31], a[92:95], a[32:35], v[28:31]
  buffer_load_dwordx4 v227, s[8:11], s17 offen offset:2048 lds
  v_mfma_f32_16x16x32_bf16 v[84:87], a[92:95], a[36:39], v[84:87]
  v_mfma_f32_16x16x32_bf16 v[140:143], a[92:95], a[40:43], v[140:143]
  v_mfma_f32_16x16x32_bf16 v[196:199], a[92:95], a[44:47], v[196:199]
  ds_read_b64_tr_b16 a[92:93], v229 offset:35840
  ds_read_b64_tr_b16 a[94:95], v229 offset:39424
  s_waitcnt lgkmcnt(10)
  v_mfma_f32_16x16x32_bf16 v[32:35], a[96:99], a[32:35], v[32:35]
  v_mfma_f32_16x16x32_bf16 v[88:91], a[96:99], a[36:39], v[88:91]
  v_mfma_f32_16x16x32_bf16 v[144:147], a[96:99], a[40:43], v[144:147]
  v_mfma_f32_16x16x32_bf16 v[200:203], a[96:99], a[44:47], v[200:203]
  buffer_load_dwordx4 a[24:27], v224, s[4:7], s16 offen offset:2048 sc1
  v_mfma_f32_16x16x32_bf16 v[36:39], a[100:103], a[32:35], v[36:39]
  ds_read_b64_tr_b16 a[96:97], v229 offset:35872
  ds_read_b64_tr_b16 a[98:99], v229 offset:39456
  v_mfma_f32_16x16x32_bf16 v[92:95], a[100:103], a[36:39], v[92:95]
  v_mfma_f32_16x16x32_bf16 v[148:151], a[100:103], a[40:43], v[148:151]
  v_mfma_f32_16x16x32_bf16 v[204:207], a[100:103], a[44:47], v[204:207]
  ds_read_b64_tr_b16 a[100:101], v229 offset:35904
  ds_read_b64_tr_b16 a[102:103], v229 offset:39488
  v_mfma_f32_16x16x32_bf16 v[40:43], a[104:107], a[32:35], v[40:43]
  v_mfma_f32_16x16x32_bf16 v[96:99], a[104:107], a[36:39], v[96:99]
  v_mfma_f32_16x16x32_bf16 v[152:155], a[104:107], a[40:43], v[152:155]
  s_mov_b32 exec_hi, 0
  buffer_load_dwordx4 v228, s[8:11], s17 offen offset:3072 lds
  s_mov_b32 exec_hi, -1
  v_mfma_f32_16x16x32_bf16 v[208:211], a[104:107], a[44:47], v[208:211]
  ds_read_b64_tr_b16 a[104:105], v229 offset:35936
  s_add_u32 s17, s17, s97
  v_mfma_f32_16x16x32_bf16 v[44:47], a[108:111], a[32:35], v[44:47]
  ds_read_b64_tr_b16 a[106:107], v229 offset:39520
  v_mfma_f32_16x16x32_bf16 v[100:103], a[108:111], a[36:39], v[100:103]
  v_mfma_f32_16x16x32_bf16 v[156:159], a[108:111], a[40:43], v[156:159]
  v_mfma_f32_16x16x32_bf16 v[212:215], a[108:111], a[44:47], v[212:215]
  ds_read_b64_tr_b16 a[108:109], v229 offset:35968
  ds_read_b64_tr_b16 a[110:111], v229 offset:39552
  v_mfma_f32_16x16x32_bf16 v[48:51], a[112:115], a[32:35], v[48:51]
  v_mfma_f32_16x16x32_bf16 v[104:107], a[112:115], a[36:39], v[104:107]
  buffer_load_dwordx4 a[28:31], v224, s[4:7], s16 offen offset:3072 sc1
  v_mfma_f32_16x16x32_bf16 v[160:163], a[112:115], a[40:43], v[160:163]
  s_add_u32 s16, s16, s45
  v_mfma_f32_16x16x32_bf16 v[216:219], a[112:115], a[44:47], v[216:219]
  ds_read_b64_tr_b16 a[112:113], v229 offset:36000
  ds_read_b64_tr_b16 a[114:115], v229 offset:39584
  v_mfma_f32_16x16x32_bf16 v[52:55], a[116:119], a[32:35], v[52:55]
  v_mfma_f32_16x16x32_bf16 v[108:111], a[116:119], a[36:39], v[108:111]
  v_mfma_f32_16x16x32_bf16 v[164:167], a[116:119], a[40:43], v[164:167]
  v_mfma_f32_16x16x32_bf16 v[220:223], a[116:119], a[44:47], v[220:223]
  s_sub_u32 s18, s18, 1
  s_cmp_lg_u32 s18, 0
  s_cbranch_scc1 L_loop_24
  s_waitcnt vmcnt(10) lgkmcnt(10)
  s_barrier
  v_mfma_f32_16x16x32_bf16 v[0:3], a[64:67], a[48:51], v[0:3]
  ds_read_b64_tr_b16 a[116:117], v229 offset:36032
  s_add_u32 m0, s38, 14336
  v_mfma_f32_16x16x32_bf16 v[56:59], a[64:67], a[52:55], v[56:59]
  buffer_load_dwordx4 v225, s[8:11], s17 offen lds
  v_mfma_f32_16x16x32_bf16 v[112:115], a[64:67], a[56:59], v[112:115]
  ds_read_b64_tr_b16 a[118:119], v229 offset:39616
  v_mfma_f32_16x16x32_bf16 v[168:171], a[64:67], a[60:63], v[168:171]
  ds_read_b64_tr_b16 a[64:65], v229 offset:43008
  ds_read_b64_tr_b16 a[66:67], v229 offset:46592
  v_mfma_f32_16x16x32_bf16 v[4:7], a[68:71], a[48:51], v[4:7]
  v_mfma_f32_16x16x32_bf16 v[60:63], a[68:71], a[52:55], v[60:63]
  v_mfma_f32_16x16x32_bf16 v[116:119], a[68:71], a[56:59], v[116:119]
  v_mfma_f32_16x16x32_bf16 v[172:175], a[68:71], a[60:63], v[172:175]
  buffer_load_dwordx4 a[32:35], v224, s[4:7], s16 offen offset:0 sc1
  v_mfma_f32_16x16x32_bf16 v[8:11], a[72:75], a[48:51], v[8:11]
  ds_read_b64_tr_b16 a[68:69], v229 offset:43040
  ds_read_b64_tr_b16 a[70:71], v229 offset:46624
  v_mfma_f32_16x16x32_bf16 v[64:67], a[72:75], a[52:55], v[64:67]
  v_mfma_f32_16x16x32_bf16 v[120:123], a[72:75], a[56:59], v[120:123]
  v_mfma_f32_16x16x32_bf16 v[176:179], a[72:75], a[60:63], v[176:179]
  ds_read_b64_tr_b16 a[72:73], v229 offset:43072
  ds_read_b64_tr_b16 a[74:75], v229 offset:46656
  v_mfma_f32_16x16x32_bf16 v[12:15], a[76:79], a[48:51], v[12:15]
  v_mfma_f32_16x16x32_bf16 v[68:71], a[76:79], a[52:55], v[68:71]
  v_mfma_f32_16x16x32_bf16 v[124:127], a[76:79], a[56:59], v[124:127]
  buffer_load_dwordx4 v226, s[8:11], s17 offen offset:1024 lds
  v_mfma_f32_16x16x32_bf16 v[180:183], a[76:79], a[60:63], v[180:183]
  ds_read_b64_tr_b16 a[76:77], v229 offset:43104
  ds_read_b64_tr_b16 a[78:79], v229 offset:46688
  v_mfma_f32_16x16x32_bf16 v[16:19], a[80:83], a[48:51], v[16:19]
  v_mfma_f32_16x16x32_bf16 v[72:75], a[80:83], a[52:55], v[72:75]
  v_mfma_f32_16x16x32_bf16 v[128:131], a[80:83], a[56:59], v[128:131]
  v_mfma_f32_16x16x32_bf16 v[184:187], a[80:83], a[60:63], v[184:187]
  ds_read_b64_tr_b16 a[80:81], v229 offset:43136
  ds_read_b64_tr_b16 a[82:83], v229 offset:46720
  v_mfma_f32_16x16x32_bf16 v[20:23], a[84:87], a[48:51], v[20:23]
  v_mfma_f32_16x16x32_bf16 v[76:79], a[84:87], a[52:55], v[76:79]
  buffer_load_dwordx4 a[36:39], v224, s[4:7], s16 offen offset:1024 sc1
  v_mfma_f32_16x16x32_bf16 v[132:135], a[84:87], a[56:59], v[132:135]
  v_mfma_f32_16x16x32_bf16 v[188:191], a[84:87], a[60:63], v[188:191]
  ds_read_b64_tr_b16 a[84:85], v229 offset:43168
  ds_read_b64_tr_b16 a[86:87], v229 offset:46752
  v_mfma_f32_16x16x32_bf16 v[24:27], a[88:91], a[48:51], v[24:27]
  v_mfma_f32_16x16x32_bf16 v[80:83], a[88:91], a[52:55], v[80:83]
  v_mfma_f32_16x16x32_bf16 v[136:139], a[88:91], a[56:59], v[136:139]
  v_mfma_f32_16x16x32_bf16 v[192:195], a[88:91], a[60:63], v[192:195]
  ds_read_b64_tr_b16 a[88:89], v229 offset:43200
  ds_read_b64_tr_b16 a[90:91], v229 offset:46784
  v_mfma_f32_16x16x32_bf16 v[28:31], a[92:95], a[48:51], v[28:31]
  buffer_load_dwordx4 v227, s[8:11], s17 offen offset:2048 lds
  v_mfma_f32_16x16x32_bf16 v[84:87], a[92:95], a[52:55], v[84:87]
  v_mfma_f32_16x16x32_bf16 v[140:143], a[92:95], a[56:59], v[140:143]
  v_mfma_f32_16x16x32_bf16 v[196:199], a[92:95], a[60:63], v[196:199]
  ds_read_b64_tr_b16 a[92:93], v229 offset:50176
  ds_read_b64_tr_b16 a[94:95], v229 offset:53760
  s_waitcnt lgkmcnt(10)
  v_mfma_f32_16x16x32_bf16 v[32:35], a[96:99], a[48:51], v[32:35]
  v_mfma_f32_16x16x32_bf16 v[88:91], a[96:99], a[52:55], v[88:91]
  v_mfma_f32_16x16x32_bf16 v[144:147], a[96:99], a[56:59], v[144:147]
  v_mfma_f32_16x16x32_bf16 v[200:203], a[96:99], a[60:63], v[200:203]
  buffer_load_dwordx4 a[40:43], v224, s[4:7], s16 offen offset:2048 sc1
  v_mfma_f32_16x16x32_bf16 v[36:39], a[100:103], a[48:51], v[36:39]
  ds_read_b64_tr_b16 a[96:97], v229 offset:50208
  ds_read_b64_tr_b16 a[98:99], v229 offset:53792
  v_mfma_f32_16x16x32_bf16 v[92:95], a[100:103], a[52:55], v[92:95]
  v_mfma_f32_16x16x32_bf16 v[148:151], a[100:103], a[56:59], v[148:151]
  v_mfma_f32_16x16x32_bf16 v[204:207], a[100:103], a[60:63], v[204:207]
  ds_read_b64_tr_b16 a[100:101], v229 offset:50240
  ds_read_b64_tr_b16 a[102:103], v229 offset:53824
  v_mfma_f32_16x16x32_bf16 v[40:43], a[104:107], a[48:51], v[40:43]
  v_mfma_f32_16x16x32_bf16 v[96:99], a[104:107], a[52:55], v[96:99]
  v_mfma_f32_16x16x32_bf16 v[152:155], a[104:107], a[56:59], v[152:155]
  s_mov_b32 exec_hi, 0
  buffer_load_dwordx4 v228, s[8:11], s17 offen offset:3072 lds
  s_mov_b32 exec_hi, -1
  v_mfma_f32_16x16x32_bf16 v[208:211], a[104:107], a[60:63], v[208:211]
  ds_read_b64_tr_b16 a[104:105], v229 offset:50272
  s_add_u32 s17, s17, s98
  v_mfma_f32_16x16x32_bf16 v[44:47], a[108:111], a[48:51], v[44:47]
  ds_read_b64_tr_b16 a[106:107], v229 offset:53856
  v_mfma_f32_16x16x32_bf16 v[100:103], a[108:111], a[52:55], v[100:103]
  v_mfma_f32_16x16x32_bf16 v[156:159], a[108:111], a[56:59], v[156:159]
  v_mfma_f32_16x16x32_bf16 v[212:215], a[108:111], a[60:63], v[212:215]
  ds_read_b64_tr_b16 a[108:109], v229 offset:50304
  ds_read_b64_tr_b16 a[110:111], v229 offset:53888
  v_mfma_f32_16x16x32_bf16 v[48:51], a[112:115], a[48:51], v[48:51]
  v_mfma_f32_16x16x32_bf16 v[104:107], a[112:115], a[52:55], v[104:107]
  buffer_load_dwordx4 a[44:47], v224, s[4:7], s16 offen offset:3072 sc1
  v_mfma_f32_16x16x32_bf16 v[160:163], a[112:115], a[56:59], v[160:163]
  s_add_u32 s16, s16, s46
  v_mfma_f32_16x16x32_bf16 v[216:219], a[112:115], a[60:63], v[216:219]
  ds_read_b64_tr_b16 a[112:113], v229 offset:50336
  ds_read_b64_tr_b16 a[114:115], v229 offset:53920
  v_mfma_f32_16x16x32_bf16 v[52:55], a[116:119], a[48:51], v[52:55]
  v_mfma_f32_16x16x32_bf16 v[108:111], a[116:119], a[52:55], v[108:111]
  v_mfma_f32_16x16x32_bf16 v[164:167], a[116:119], a[56:59], v[164:167]
  v_mfma_f32_16x16x32_bf16 v[220:223], a[116:119], a[60:63], v[220:223]
  s_waitcnt vmcnt(9) lgkmcnt(10)
  s_barrier
  v_mfma_f32_16x16x32_bf16 v[0:3], a[64:67], a[0:3], v[0:3]
  ds_read_b64_tr_b16 a[116:117], v229 offset:50368
  s_add_u32 m0, s38, 28672
  v_mfma_f32_16x16x32_bf16 v[56:59], a[64:67], a[4:7], v[56:59]
  buffer_load_dwordx4 v225, s[8:11], s17 offen lds
  v_mfma_f32_16x16x32_bf16 v[112:115], a[64:67], a[8:11], v[112:115]
  ds_read_b64_tr_b16 a[118:119], v229 offset:53952
  v_mfma_f32_16x16x32_bf16 v[168:171], a[64:67], a[12:15], v[168:171]
  ds_read_b64_tr_b16 a[64:65], v229 offset:0
  ds_read_b64_tr_b16 a[66:67], v229 offset:3584
  v_mfma_f32_16x16x32_bf16 v[4:7], a[68:71], a[0:3], v[4:7]
  v_mfma_f32_16x16x32_bf16 v[60:63], a[68:71], a[4:7], v[60:63]
  v_mfma_f32_16x16x32_bf16 v[116:119], a[68:71], a[8:11], v[116:119]
  v_mfma_f32_16x16x32_bf16 v[172:175], a[68:71], a[12:15], v[172:175]
  buffer_load_dwordx4 a[48:51], v224, s[4:7], s16 offen offset:0 sc1
  v_mfma_f32_16x16x32_bf16 v[8:11], a[72:75], a[0:3], v[8:11]
  ds_read_b64_tr_b16 a[68:69], v229 offset:32
  ds_read_b64_tr_b16 a[70:71], v229 offset:3616
  v_mfma_f32_16x16x32_bf16 v[64:67], a[72:75], a[4:7], v[64:67]
  v_mfma_f32_16x16x32_bf16 v[120:123], a[72:75], a[8:11], v[120:123]
  v_mfma_f32_16x16x32_bf16 v[176:179], a[72:75], a[12:15], v[176:179]
  ds_read_b64_tr_b16 a[72:73], v229 offset:64
  ds_read_b64_tr_b16 a[74:75], v229 offset:3648
  v_mfma_f32_16x16x32_bf16 v[12:15], a[76:79], a[0:3], v[12:15]
  v_mfma_f32_16x16x32_bf16 v[68:71], a[76:79], a[4:7], v[68:71]
  buffer_load_dwordx4 v226, s[8:11], s17 offen offset:1024 lds
  v_mfma_f32_16x16x32_bf16 v[124:127], a[76:79], a[8:11], v[124:127]
  v_mfma_f32_16x16x32_bf16 v[180:183], a[76:79], a[12:15], v[180:183]
  ds_read_b64_tr_b16 a[76:77], v229 offset:96
  ds_read_b64_tr_b16 a[78:79], v229 offset:3680
  v_mfma_f32_16x16x32_bf16 v[16:19], a[80:83], a[0:3], v[16:19]
  v_mfma_f32_16x16x32_bf16 v[72:75], a[80:83], a[4:7], v[72:75]
  v_mfma_f32_16x16x32_bf16 v[128:131], a[80:83], a[8:11], v[128:131]
  v_mfma_f32_16x16x32_bf16 v[184:187], a[80:83], a[12:15], v[184:187]
  buffer_load_dwordx4 a[52:55], v224, s[4:7], s16 offen offset:1024 sc1
  v_mfma_f32_16x16x32_bf16 v[20:23], a[84:87], a[0:3], v[20:23]
  ds_read_b64_tr_b16 a[80:81], v229 offset:128
  ds_read_b64_tr_b16 a[82:83], v229 offset:3712
  v_mfma_f32_16x16x32_bf16 v[76:79], a[84:87], a[4:7], v[76:79]
  v_mfma_f32_16x16x32_bf16 v[132:135], a[84:87], a[8:11], v[132:135]
  v_mfma_f32_16x16x32_bf16 v[188:191], a[84:87], a[12:15], v[188:191]
  ds_read_b64_tr_b16 a[84:85], v229 offset:160
  ds_read_b64_tr_b16 a[86:87], v229 offset:3744
  v_mfma_f32_16x16x32_bf16 v[24:27], a[88:91], a[0:3], v[24:27]
  v_mfma_f32_16x16x32_bf16 v[80:83], a[88:91], a[4:7], v[80:83]
  buffer_load_dwordx4 v227, s[8:11], s17 offen offset:2048 lds
  v_mfma_f32_16x16x32_bf16 v[136:139], a[88:91], a[8:11], v[136:139]
  v_mfma_f32_16x16x32_bf16 v[192:195], a[88:91], a[12:15], v[192:195]
  ds_read_b64_tr_b16 a[88:89], v229 offset:192
  ds_read_b64_tr_b16 a[90:91], v229 offset:3776
  v_mfma_f32_16x16x32_bf16 v[28:31], a[92:95], a[0:3], v[28:31]
  v_mfma_f32_16x16x32_bf16 v[84:87], a[92:95], a[4:7], v[84:87]
  v_mfma_f32_16x16x32_bf16 v[140:143], a[92:95], a[8:11], v[140:143]
  v_mfma_f32_16x16x32_bf16 v[196:199], a[92:95], a[12:15], v[196:199]
  buffer_load_dwordx4 a[56:59], v224, s[4:7], s16 offen offset:2048 sc1
  s_waitcnt lgkmcnt(10)
  v_mfma_f32_16x16x32_bf16 v[32:35], a[96:99], a[0:3], v[32:35]
  ds_read_b64_tr_b16 a[92:93], v229 offset:7168
  ds_read_b64_tr_b16 a[94:95], v229 offset:10752
  v_mfma_f32_16x16x32_bf16 v[88:91], a[96:99], a[4:7], v[88:91]
  v_mfma_f32_16x16x32_bf16 v[144:147], a[96:99], a[8:11], v[144:147]
  v_mfma_f32_16x16x32_bf16 v[200:203], a[96:99], a[12:15], v[200:203]
  ds_read_b64_tr_b16 a[96:97], v229 offset:7200
  ds_read_b64_tr_b16 a[98:99], v229 offset:10784
  v_mfma_f32_16x16x32_bf16 v[36:39], a[100:103], a[0:3], v[36:39]
  v_mfma_f32_16x16x32_bf16 v[92:95], a[100:103], a[4:7], v[92:95]
  s_mov_b32 exec_hi, 0
  buffer_load_dwordx4 v228, s[8:11], s17 offen offset:3072 lds
  s_mov_b32 exec_hi, -1
  v_mfma_f32_16x16x32_bf16 v[148:151], a[100:103], a[8:11], v[148:151]
  s_add_u32 s17, s17, s99
  v_mfma_f32_16x16x32_bf16 v[204:207], a[100:103], a[12:15], v[204:207]
  ds_read_b64_tr_b16 a[100:101], v229 offset:7232
  ds_read_b64_tr_b16 a[102:103], v229 offset:10816
  v_mfma_f32_16x16x32_bf16 v[40:43], a[104:107], a[0:3], v[40:43]
  v_mfma_f32_16x16x32_bf16 v[96:99], a[104:107], a[4:7], v[96:99]
  v_mfma_f32_16x16x32_bf16 v[152:155], a[104:107], a[8:11], v[152:155]
  v_mfma_f32_16x16x32_bf16 v[208:211], a[104:107], a[12:15], v[208:211]
  buffer_load_dwordx4 a[60:63], v224, s[4:7], s16 offen offset:3072 sc1
  v_mfma_f32_16x16x32_bf16 v[44:47], a[108:111], a[0:3], v[44:47]
  ds_read_b64_tr_b16 a[104:105], v229 offset:7264
  s_add_u32 s16, s16, s47
  v_mfma_f32_16x16x32_bf16 v[100:103], a[108:111], a[4:7], v[100:103]
  ds_read_b64_tr_b16 a[106:107], v229 offset:10848
  v_mfma_f32_16x16x32_bf16 v[156:159], a[108:111], a[8:11], v[156:159]
  v_mfma_f32_16x16x32_bf16 v[212:215], a[108:111], a[12:15], v[212:215]
  ds_read_b64_tr_b16 a[108:109], v229 offset:7296
  ds_read_b64_tr_b16 a[110:111], v229 offset:10880
  v_mfma_f32_16x16x32_bf16 v[48:51], a[112:115], a[0:3], v[48:51]
  v_mfma_f32_16x16x32_bf16 v[104:107], a[112:115], a[4:7], v[104:107]
  s_getpc_b64 s[52:53]
  L_pc_23:
  s_add_u32 s52, s52, L_k56_seam-L_pc_23
  s_addc_u32 s53, s53, 0
  s_lshr_b32 s56, s2, 3
  s_lshl_b32 s56, s56, 2
  s_add_u32 s56, s56, s3
  s_lshl_b32 s56, s56, 13
  v_lshlrev_b32 v254, 7, v231
  v_add_u32 v254, s56, v254
  v_min_u32 v254, L_code_end-L_k56_seam-4, v254
  v_mov_b32 v255, s53
  v_add_co_u32 v254, vcc, s52, v254
  s_nop 1
  v_addc_co_u32 v255, vcc, 0, v255, vcc
  global_load_dword v251, v[254:255], off
  v_mfma_f32_16x16x32_bf16 v[160:163], a[112:115], a[8:11], v[160:163]
  v_mfma_f32_16x16x32_bf16 v[216:219], a[112:115], a[12:15], v[216:219]
  ds_read_b64_tr_b16 a[112:113], v229 offset:7328
  ds_read_b64_tr_b16 a[114:115], v229 offset:10912
  v_mfma_f32_16x16x32_bf16 v[52:55], a[116:119], a[0:3], v[52:55]
  v_mfma_f32_16x16x32_bf16 v[108:111], a[116:119], a[4:7], v[108:111]
  v_mfma_f32_16x16x32_bf16 v[164:167], a[116:119], a[8:11], v[164:167]
  v_mfma_f32_16x16x32_bf16 v[220:223], a[116:119], a[12:15], v[220:223]
  s_waitcnt vmcnt(10) lgkmcnt(10)
  s_barrier
  s_lshr_b32 s32, s31, 4
  s_mul_i32 s32, s32, 56
  v_mfma_f32_16x16x32_bf16 v[0:3], a[64:67], a[16:19], v[0:3]
  s_and_b32 s33, s31, 15
  s_add_u32 s34, s33, s32
  v_mfma_f32_16x16x32_bf16 v[56:59], a[64:67], a[20:23], v[56:59]
  s_lshl_b32 s98, s34, 17
  s_add_u32 s99, s98, 2097152
  v_mfma_f32_16x16x32_bf16 v[112:115], a[64:67], a[24:27], v[112:115]
  ds_read_b64_tr_b16 a[116:117], v229 offset:7360
  ds_read_b64_tr_b16 a[118:119], v229 offset:10944
  s_add_u32 s100, s98, 4194304
  s_lshr_b32 s34, s33, 1
  v_mfma_f32_16x16x32_bf16 v[168:171], a[64:67], a[28:31], v[168:171]
  s_add_u32 s34, s34, s32
  s_add_u32 s34, s34, 48
  v_mfma_f32_16x16x32_bf16 v[4:7], a[68:71], a[16:19], v[4:7]
  s_lshl_b32 s101, s34, 17
  s_and_b32 s35, s31, 1
  v_mfma_f32_16x16x32_bf16 v[60:63], a[68:71], a[20:23], v[60:63]
  s_lshl_b32 s35, s35, 10
  s_add_u32 s101, s101, s35
  v_mfma_f32_16x16x32_bf16 v[116:119], a[68:71], a[24:27], v[116:119]
  ds_read_b64_tr_b16 a[64:65], v229 offset:14336
  ds_read_b64_tr_b16 a[66:67], v229 offset:17920
  s_lshl_b32 s92, s30, 2
  s_add_u32 s92, s92, s3
  v_mfma_f32_16x16x32_bf16 v[172:175], a[68:71], a[28:31], v[172:175]
  s_lshl_b32 s92, s92, 5
  s_add_u32 s92, s92, s31
  v_mfma_f32_16x16x32_bf16 v[8:11], a[72:75], a[16:19], v[8:11]
  s_lshl_b32 s92, s92, 6
  s_add_u32 s56, s20, 0x80000
  v_mfma_f32_16x16x32_bf16 v[64:67], a[72:75], a[20:23], v[64:67]
  s_addc_u32 s57, s21, 0
  s_mov_b32 s58, 0x30000
  v_mfma_f32_16x16x32_bf16 v[120:123], a[72:75], a[24:27], v[120:123]
  ds_read_b64_tr_b16 a[68:69], v229 offset:14368
  ds_read_b64_tr_b16 a[70:71], v229 offset:17952
  s_mov_b32 s59, 0x20000
  s_and_b32 s28, s2, 1
  v_mfma_f32_16x16x32_bf16 v[176:179], a[72:75], a[28:31], v[176:179]
  s_lshr_b32 s29, s2, 3
  s_bfe_u32 s30, s2, 0x20001
  v_mfma_f32_16x16x32_bf16 v[12:15], a[76:79], a[16:19], v[12:15]
  s_lshl_b32 s30, s30, 2
  s_and_b32 s31, s29, 3
  v_mfma_f32_16x16x32_bf16 v[68:71], a[76:79], a[20:23], v[68:71]
  s_add_u32 s30, s30, s31
  s_lshr_b32 s29, s29, 2
  v_mfma_f32_16x16x32_bf16 v[124:127], a[76:79], a[24:27], v[124:127]
  ds_read_b64_tr_b16 a[72:73], v229 offset:14400
  ds_read_b64_tr_b16 a[74:75], v229 offset:17984
  s_lshl_b32 s31, s29, 1
  s_add_u32 s31, s31, s28
  v_mfma_f32_16x16x32_bf16 v[180:183], a[76:79], a[28:31], v[180:183]
  s_lshl_b32 s94, s30, 1
  s_lshr_b32 s33, s3, 1
  v_mfma_f32_16x16x32_bf16 v[16:19], a[80:83], a[16:19], v[16:19]
  s_add_u32 s94, s94, s33
  s_lshl_b32 s94, s94, 11
  v_mfma_f32_16x16x32_bf16 v[72:75], a[80:83], a[20:23], v[72:75]
  s_lshl_b32 s33, s28, 10
  s_add_u32 s94, s94, s33
  v_mfma_f32_16x16x32_bf16 v[128:131], a[80:83], a[24:27], v[128:131]
  ds_read_b64_tr_b16 a[76:77], v229 offset:14432
  ds_read_b64_tr_b16 a[78:79], v229 offset:18016
  v_and_b32 v246, 15, v231
  v_lshlrev_b32 v246, 6, v246
  v_mfma_f32_16x16x32_bf16 v[184:187], a[80:83], a[28:31], v[184:187]
  s_lshl_b32 s32, s30, 13
  s_lshl_b32 s33, s3, 11
  v_mfma_f32_16x16x32_bf16 v[20:23], a[84:87], a[16:19], v[20:23]
  s_add_u32 s32, s32, s33
  v_lshlrev_b32 v240, 4, v231
  v_mfma_f32_16x16x32_bf16 v[76:79], a[84:87], a[20:23], v[76:79]
  v_add_u32 v240, s32, v240
  v_add_u32 v241, 131072, v240
  v_mfma_f32_16x16x32_bf16 v[132:135], a[84:87], a[24:27], v[132:135]
  ds_read_b64_tr_b16 a[80:81], v229 offset:14464
  ds_read_b64_tr_b16 a[82:83], v229 offset:18048
  v_lshrrev_b32 v232, 3, v231
  v_and_b32 v233, 6, v232
  v_mfma_f32_16x16x32_bf16 v[188:191], a[84:87], a[28:31], v[188:191]
  v_and_b32 v234, 7, v231
  v_xor_b32 v233, v233, v234
  v_mfma_f32_16x16x32_bf16 v[24:27], a[88:91], a[16:19], v[24:27]
  v_lshlrev_b32 v232, 11, v232
  v_lshl_add_u32 v232, v233, 4, v232
  v_mfma_f32_16x16x32_bf16 v[80:83], a[88:91], a[20:23], v[80:83]
  s_lshl_b32 s32, s3, 15
  s_add_u32 s32, s32, 4096
  v_mfma_f32_16x16x32_bf16 v[136:139], a[88:91], a[24:27], v[136:139]
  ds_read_b64_tr_b16 a[84:85], v229 offset:14496
  ds_read_b64_tr_b16 a[86:87], v229 offset:18080
  s_lshl_b32 s33, s31, 7
  s_add_u32 s34, s32, s33
  v_mfma_f32_16x16x32_bf16 v[192:195], a[88:91], a[28:31], v[192:195]
  s_xor_b32 s33, s33, 128
  s_add_u32 s35, s32, s33
  v_mfma_f32_16x16x32_bf16 v[28:31], a[92:95], a[16:19], v[28:31]
  v_add_u32 v225, s34, v232
  v_add_u32 v226, 15360, v225
  v_mfma_f32_16x16x32_bf16 v[84:87], a[92:95], a[20:23], v[84:87]
  v_add_u32 v227, s35, v232
  v_add_u32 v228, 13312, v227
  v_mfma_f32_16x16x32_bf16 v[140:143], a[92:95], a[24:27], v[140:143]
  ds_read_b64_tr_b16 a[88:89], v229 offset:14528
  ds_read_b64_tr_b16 a[90:91], v229 offset:18112
  v_subrev_u32 v227, 2048, v227
  s_lshl_b32 s38, s3, 12
  v_mfma_f32_16x16x32_bf16 v[196:199], a[92:95], a[28:31], v[196:199]
  s_add_u32 s38, s38, 0
  s_mul_i32 s16, s28, 7340032
  s_waitcnt lgkmcnt(10)
  v_mfma_f32_16x16x32_bf16 v[32:35], a[96:99], a[16:19], v[32:35]
  s_mul_i32 s17, s28, 3670016
  s_lshr_b32 s33, s3, 1
  v_mfma_f32_16x16x32_bf16 v[88:91], a[96:99], a[20:23], v[88:91]
  s_mul_i32 s33, s33, 196608
  s_add_u32 s17, s17, s33
  v_mfma_f32_16x16x32_bf16 v[144:147], a[96:99], a[24:27], v[144:147]
  ds_read_b64_tr_b16 a[92:93], v229 offset:21504
  ds_read_b64_tr_b16 a[94:95], v229 offset:25088
  s_add_u32 s97, s17, s33
  s_add_u32 s97, s97, 196608
  v_mfma_f32_16x16x32_bf16 v[200:203], a[96:99], a[28:31], v[200:203]
  s_lshr_b32 s33, s2, 5
  s_mul_i32 s33, s33, 2
  v_mfma_f32_16x16x32_bf16 v[36:39], a[100:103], a[16:19], v[36:39]
  s_bfe_u32 s34, s2, 0x20003
  s_mul_i32 s34, s34, 1
  v_mfma_f32_16x16x32_bf16 v[92:95], a[100:103], a[20:23], v[92:95]
  s_add_u32 s33, s33, s34
  s_and_b32 s33, s33, 7
  v_mfma_f32_16x16x32_bf16 v[148:151], a[100:103], a[24:27], v[148:151]
  ds_read_b64_tr_b16 a[96:97], v229 offset:21536
  ds_read_b64_tr_b16 a[98:99], v229 offset:25120
  s_mov_b32 s95, s17
  s_add_u32 s93, s17, 3670016
  v_mfma_f32_16x16x32_bf16 v[204:207], a[100:103], a[28:31], v[204:207]
  s_mul_i32 s34, s33, 458752
  s_add_u32 s17, s17, s34
  v_mfma_f32_16x16x32_bf16 v[40:43], a[104:107], a[16:19], v[40:43]
  s_mov_b32 s40, s16
  s_lshl_b32 s41, s33, 18
  v_mfma_f32_16x16x32_bf16 v[96:99], a[104:107], a[20:23], v[96:99]
  s_add_u32 s16, s40, s41
  s_sub_u32 s8, s22, 4096
  v_mfma_f32_16x16x32_bf16 v[152:155], a[104:107], a[24:27], v[152:155]
  ds_read_b64_tr_b16 a[100:101], v229 offset:21568
  ds_read_b64_tr_b16 a[102:103], v229 offset:25152
  s_subb_u32 s9, s23, 0
  s_mov_b32 s10, 7344128
  v_mfma_f32_16x16x32_bf16 v[208:211], a[104:107], a[28:31], v[208:211]
  s_add_u32 s4, s20, 0x1600000
  s_addc_u32 s5, s21, 0
  v_mfma_f32_16x16x32_bf16 v[44:47], a[108:111], a[16:19], v[44:47]
  s_mov_b32 s6, 0xe00000
  s_mov_b32 s7, 0x20000
  v_mfma_f32_16x16x32_bf16 v[100:103], a[108:111], a[20:23], v[100:103]
  v_lshrrev_b32 v232, 2, v231
  v_lshlrev_b32 v232, 7, v232
  v_mfma_f32_16x16x32_bf16 v[156:159], a[108:111], a[24:27], v[156:159]
  ds_read_b64_tr_b16 a[104:105], v229 offset:21600
  ds_read_b64_tr_b16 a[106:107], v229 offset:25184
  v_bfe_u32 v233, v231, 3, 2
  v_lshl_add_u32 v232, v233, 5, v232
  v_mfma_f32_16x16x32_bf16 v[212:215], a[108:111], a[28:31], v[212:215]
  v_and_b32 v233, 3, v231
  v_lshl_add_u32 v232, v233, 3, v232
  v_mfma_f32_16x16x32_bf16 v[48:51], a[112:115], a[16:19], v[48:51]
  v_xor_b32 v242, 0, v232
  v_add_u32 v242, 0, v242
  v_mfma_f32_16x16x32_bf16 v[104:107], a[112:115], a[20:23], v[104:107]
  v_xor_b32 v243, 32, v232
  v_add_u32 v243, 0, v243
  v_mfma_f32_16x16x32_bf16 v[160:163], a[112:115], a[24:27], v[160:163]
  ds_read_b64_tr_b16 a[108:109], v229 offset:21632
  ds_read_b64_tr_b16 a[110:111], v229 offset:25216
  v_xor_b32 v244, 64, v232
  v_add_u32 v244, 0, v244
  v_mfma_f32_16x16x32_bf16 v[216:219], a[112:115], a[28:31], v[216:219]
  v_xor_b32 v245, 96, v232
  v_add_u32 v245, 0, v245
  v_mfma_f32_16x16x32_bf16 v[52:55], a[116:119], a[16:19], v[52:55]
  s_mov_b32 s42, 0xbfb8aa3b
  s_mov_b32 s43, 0xbfb8aa3b
  v_mfma_f32_16x16x32_bf16 v[108:111], a[116:119], a[20:23], v[108:111]
  s_mov_b32 s62, 1.0
  s_mov_b32 s63, 1.0
  v_mfma_f32_16x16x32_bf16 v[164:167], a[116:119], a[24:27], v[164:167]
  ds_read_b64_tr_b16 a[112:113], v229 offset:21664
  ds_read_b64_tr_b16 a[114:115], v229 offset:25248
  v_mfma_f32_16x16x32_bf16 v[220:223], a[116:119], a[28:31], v[220:223]
  s_waitcnt vmcnt(2) lgkmcnt(10)
  s_barrier
  v_mfma_f32_16x16x32_bf16 v[0:3], a[64:67], a[32:35], v[0:3]
  ds_read_b64_tr_b16 a[116:117], v229 offset:21696
  ds_read_b64_tr_b16 a[118:119], v229 offset:25280
  v_mfma_f32_16x16x32_bf16 v[56:59], a[64:67], a[36:39], v[56:59]
  s_add_u32 m0, s38, 0
  s_nop 0
  buffer_load_dwordx4 v225, s[8:11], s17 offen lds
  v_mfma_f32_16x16x32_bf16 v[112:115], a[64:67], a[40:43], v[112:115]
  v_mfma_f32_16x16x32_bf16 v[168:171], a[64:67], a[44:47], v[168:171]
  ds_read_b64_tr_b16 a[64:65], v229 offset:28672
  ds_read_b64_tr_b16 a[66:67], v229 offset:32256
  v_mfma_f32_16x16x32_bf16 v[4:7], a[68:71], a[32:35], v[4:7]
  v_mfma_f32_16x16x32_bf16 v[60:63], a[68:71], a[36:39], v[60:63]
  buffer_load_dwordx4 v226, s[8:11], s17 offen offset:1024 lds
  v_mfma_f32_16x16x32_bf16 v[116:119], a[68:71], a[40:43], v[116:119]
  v_mfma_f32_16x16x32_bf16 v[172:175], a[68:71], a[44:47], v[172:175]
  ds_read_b64_tr_b16 a[68:69], v229 offset:28704
  ds_read_b64_tr_b16 a[70:71], v229 offset:32288
  v_mfma_f32_16x16x32_bf16 v[8:11], a[72:75], a[32:35], v[8:11]
  v_mfma_f32_16x16x32_bf16 v[64:67], a[72:75], a[36:39], v[64:67]
  buffer_load_dwordx4 v227, s[8:11], s17 offen offset:2048 lds
  v_mfma_f32_16x16x32_bf16 v[120:123], a[72:75], a[40:43], v[120:123]
  v_mfma_f32_16x16x32_bf16 v[176:179], a[72:75], a[44:47], v[176:179]
  ds_read_b64_tr_b16 a[72:73], v229 offset:35840
  ds_read_b64_tr_b16 a[74:75], v229 offset:39424
  v_mfma_f32_16x16x32_bf16 v[12:15], a[76:79], a[32:35], v[12:15]
  v_mfma_f32_16x16x32_bf16 v[68:71], a[76:79], a[36:39], v[68:71]
  buffer_load_dwordx4 v228, s[8:11], s17 offen offset:3072 lds
  s_add_u32 s17, s17, 458752
  s_cmp_eq_u32 s17, s93
  s_cselect_b32 s17, s95, s17
  v_mfma_f32_16x16x32_bf16 v[124:127], a[76:79], a[40:43], v[124:127]
  v_mfma_f32_16x16x32_bf16 v[180:183], a[76:79], a[44:47], v[180:183]
  ds_read_b64_tr_b16 a[76:77], v229 offset:35872
  ds_read_b64_tr_b16 a[78:79], v229 offset:39456
  v_mfma_f32_16x16x32_bf16 v[16:19], a[80:83], a[32:35], v[16:19]
  v_mfma_f32_16x16x32_bf16 v[72:75], a[80:83], a[36:39], v[72:75]
  s_add_u32 m0, s38, 16384
  s_nop 0
  buffer_load_dwordx4 v225, s[8:11], s17 offen lds
  v_mfma_f32_16x16x32_bf16 v[128:131], a[80:83], a[40:43], v[128:131]
  v_mfma_f32_16x16x32_bf16 v[184:187], a[80:83], a[44:47], v[184:187]
  ds_read_b64_tr_b16 a[80:81], v229 offset:28736
  ds_read_b64_tr_b16 a[82:83], v229 offset:32320
  v_mfma_f32_16x16x32_bf16 v[20:23], a[84:87], a[32:35], v[20:23]
  v_mfma_f32_16x16x32_bf16 v[76:79], a[84:87], a[36:39], v[76:79]
  buffer_load_dwordx4 v226, s[8:11], s17 offen offset:1024 lds
  v_mfma_f32_16x16x32_bf16 v[132:135], a[84:87], a[40:43], v[132:135]
  v_mfma_f32_16x16x32_bf16 v[188:191], a[84:87], a[44:47], v[188:191]
  ds_read_b64_tr_b16 a[84:85], v229 offset:28768
  ds_read_b64_tr_b16 a[86:87], v229 offset:32352
  v_mfma_f32_16x16x32_bf16 v[24:27], a[88:91], a[32:35], v[24:27]
  v_mfma_f32_16x16x32_bf16 v[80:83], a[88:91], a[36:39], v[80:83]
  buffer_load_dwordx4 v227, s[8:11], s17 offen offset:2048 lds
  v_mfma_f32_16x16x32_bf16 v[136:139], a[88:91], a[40:43], v[136:139]
  v_mfma_f32_16x16x32_bf16 v[192:195], a[88:91], a[44:47], v[192:195]
  ds_read_b64_tr_b16 a[88:89], v229 offset:35904
  ds_read_b64_tr_b16 a[90:91], v229 offset:39488
  v_mfma_f32_16x16x32_bf16 v[28:31], a[92:95], a[32:35], v[28:31]
  v_mfma_f32_16x16x32_bf16 v[84:87], a[92:95], a[36:39], v[84:87]
  buffer_load_dwordx4 v228, s[8:11], s17 offen offset:3072 lds
  s_add_u32 s17, s17, 458752
  s_cmp_eq_u32 s17, s93
  s_cselect_b32 s17, s95, s17
  v_mfma_f32_16x16x32_bf16 v[140:143], a[92:95], a[40:43], v[140:143]
  v_mfma_f32_16x16x32_bf16 v[196:199], a[92:95], a[44:47], v[196:199]
  ds_read_b64_tr_b16 a[92:93], v229 offset:35936
  ds_read_b64_tr_b16 a[94:95], v229 offset:39520
  s_waitcnt lgkmcnt(10)
  v_mfma_f32_16x16x32_bf16 v[32:35], a[96:99], a[32:35], v[32:35]
  v_mfma_f32_16x16x32_bf16 v[88:91], a[96:99], a[36:39], v[88:91]
  s_add_u32 m0, s38, 32768
  s_nop 0
  buffer_load_dwordx4 v225, s[8:11], s17 offen lds
  v_mfma_f32_16x16x32_bf16 v[144:147], a[96:99], a[40:43], v[144:147]
  v_mfma_f32_16x16x32_bf16 v[200:203], a[96:99], a[44:47], v[200:203]
  ds_read_b64_tr_b16 a[96:97], v229 offset:28800
  ds_read_b64_tr_b16 a[98:99], v229 offset:32384
  v_mfma_f32_16x16x32_bf16 v[36:39], a[100:103], a[32:35], v[36:39]
  v_mfma_f32_16x16x32_bf16 v[92:95], a[100:103], a[36:39], v[92:95]
  buffer_load_dwordx4 v226, s[8:11], s17 offen offset:1024 lds
  v_mfma_f32_16x16x32_bf16 v[148:151], a[100:103], a[40:43], v[148:151]
  v_mfma_f32_16x16x32_bf16 v[204:207], a[100:103], a[44:47], v[204:207]
  ds_read_b64_tr_b16 a[100:101], v229 offset:28832
  ds_read_b64_tr_b16 a[102:103], v229 offset:32416
  v_mfma_f32_16x16x32_bf16 v[40:43], a[104:107], a[32:35], v[40:43]
  v_mfma_f32_16x16x32_bf16 v[96:99], a[104:107], a[36:39], v[96:99]
  buffer_load_dwordx4 v227, s[8:11], s17 offen offset:2048 lds
  v_mfma_f32_16x16x32_bf16 v[152:155], a[104:107], a[40:43], v[152:155]
  v_mfma_f32_16x16x32_bf16 v[208:211], a[104:107], a[44:47], v[208:211]
  ds_read_b64_tr_b16 a[104:105], v229 offset:28864
  ds_read_b64_tr_b16 a[106:107], v229 offset:32448
  v_mfma_f32_16x16x32_bf16 v[44:47], a[108:111], a[32:35], v[44:47]
  v_mfma_f32_16x16x32_bf16 v[100:103], a[108:111], a[36:39], v[100:103]
  buffer_load_dwordx4 v228, s[8:11], s17 offen offset:3072 lds
  s_add_u32 s17, s17, 458752
  s_cmp_eq_u32 s17, s93
  s_cselect_b32 s17, s95, s17
  v_mfma_f32_16x16x32_bf16 v[156:159], a[108:111], a[40:43], v[156:159]
  v_mfma_f32_16x16x32_bf16 v[212:215], a[108:111], a[44:47], v[212:215]
  ds_read_b64_tr_b16 a[108:109], v229 offset:35968
  ds_read_b64_tr_b16 a[110:111], v229 offset:39552
  v_mfma_f32_16x16x32_bf16 v[48:51], a[112:115], a[32:35], v[48:51]
  v_mfma_f32_16x16x32_bf16 v[104:107], a[112:115], a[36:39], v[104:107]
  v_mfma_f32_16x16x32_bf16 v[160:163], a[112:115], a[40:43], v[160:163]
  v_mfma_f32_16x16x32_bf16 v[216:219], a[112:115], a[44:47], v[216:219]
  ds_read_b64_tr_b16 a[112:113], v229 offset:36000
  ds_read_b64_tr_b16 a[114:115], v229 offset:39584
  v_mfma_f32_16x16x32_bf16 v[52:55], a[116:119], a[32:35], v[52:55]
  v_mfma_f32_16x16x32_bf16 v[108:111], a[116:119], a[36:39], v[108:111]
  v_mfma_f32_16x16x32_bf16 v[164:167], a[116:119], a[40:43], v[164:167]
  v_mfma_f32_16x16x32_bf16 v[220:223], a[116:119], a[44:47], v[220:223]
  s_waitcnt vmcnt(13) lgkmcnt(10)
  s_barrier
  v_mfma_f32_16x16x32_bf16 v[0:3], a[64:67], a[48:51], v[0:3]
  ds_read_b64_tr_b16 a[116:117], v229 offset:36032
  ds_read_b64_tr_b16 a[118:119], v229 offset:39616
  v_mfma_f32_16x16x32_bf16 v[56:59], a[64:67], a[52:55], v[56:59]
  s_add_u32 m0, s38, 49152
  s_nop 0
  buffer_load_dwordx4 v225, s[8:11], s17 offen lds
  v_mfma_f32_16x16x32_bf16 v[112:115], a[64:67], a[56:59], v[112:115]
  v_mfma_f32_16x16x32_bf16 v[168:171], a[64:67], a[60:63], v[168:171]
  v_mfma_f32_16x16x32_bf16 v[4:7], a[68:71], a[48:51], v[4:7]
  v_mfma_f32_16x16x32_bf16 v[60:63], a[68:71], a[52:55], v[60:63]
  buffer_load_dwordx4 v226, s[8:11], s17 offen offset:1024 lds
  v_mfma_f32_16x16x32_bf16 v[116:119], a[68:71], a[56:59], v[116:119]
  v_mfma_f32_16x16x32_bf16 v[172:175], a[68:71], a[60:63], v[172:175]
  v_mfma_f32_16x16x32_bf16 v[28:31], a[72:75], a[48:51], v[28:31]
  v_mfma_f32_16x16x32_bf16 v[84:87], a[72:75], a[52:55], v[84:87]
  buffer_load_dwordx4 v227, s[8:11], s17 offen offset:2048 lds
  v_mfma_f32_16x16x32_bf16 v[140:143], a[72:75], a[56:59], v[140:143]
  v_mfma_f32_16x16x32_bf16 v[196:199], a[72:75], a[60:63], v[196:199]
  v_mfma_f32_16x16x32_bf16 v[32:35], a[76:79], a[48:51], v[32:35]
  v_mfma_f32_16x16x32_bf16 v[88:91], a[76:79], a[52:55], v[88:91]
  buffer_load_dwordx4 v228, s[8:11], s17 offen offset:3072 lds
  s_add_u32 s17, s17, 458752
  s_cmp_eq_u32 s17, s93
  s_cselect_b32 s17, s95, s17
  v_mfma_f32_16x16x32_bf16 v[144:147], a[76:79], a[56:59], v[144:147]
  v_mfma_f32_16x16x32_bf16 v[200:203], a[76:79], a[60:63], v[200:203]
  v_mfma_f32_16x16x32_bf16 v[8:11], a[80:83], a[48:51], v[8:11]
  v_mfma_f32_16x16x32_bf16 v[64:67], a[80:83], a[52:55], v[64:67]
  s_add_u32 m0, s38, 65536
  s_nop 0
  buffer_load_dwordx4 v225, s[8:11], s17 offen lds
  v_mfma_f32_16x16x32_bf16 v[120:123], a[80:83], a[56:59], v[120:123]
  v_mfma_f32_16x16x32_bf16 v[176:179], a[80:83], a[60:63], v[176:179]
  v_mfma_f32_16x16x32_bf16 v[12:15], a[84:87], a[48:51], v[12:15]
  v_mfma_f32_16x16x32_bf16 v[68:71], a[84:87], a[52:55], v[68:71]
  buffer_load_dwordx4 v226, s[8:11], s17 offen offset:1024 lds
  v_mfma_f32_16x16x32_bf16 v[124:127], a[84:87], a[56:59], v[124:127]
  v_mfma_f32_16x16x32_bf16 v[180:183], a[84:87], a[60:63], v[180:183]
  v_mfma_f32_16x16x32_bf16 v[36:39], a[88:91], a[48:51], v[36:39]
  v_mfma_f32_16x16x32_bf16 v[92:95], a[88:91], a[52:55], v[92:95]
  buffer_load_dwordx4 v227, s[8:11], s17 offen offset:2048 lds
  v_mfma_f32_16x16x32_bf16 v[148:151], a[88:91], a[56:59], v[148:151]
  v_mfma_f32_16x16x32_bf16 v[204:207], a[88:91], a[60:63], v[204:207]
  v_mfma_f32_16x16x32_bf16 v[40:43], a[92:95], a[48:51], v[40:43]
  v_mfma_f32_16x16x32_bf16 v[96:99], a[92:95], a[52:55], v[96:99]
  buffer_load_dwordx4 v228, s[8:11], s17 offen offset:3072 lds
  s_add_u32 s17, s17, 458752
  s_cmp_eq_u32 s17, s93
  s_cselect_b32 s17, s95, s17
  v_mfma_f32_16x16x32_bf16 v[152:155], a[92:95], a[56:59], v[152:155]
  v_mfma_f32_16x16x32_bf16 v[208:211], a[92:95], a[60:63], v[208:211]
  s_waitcnt lgkmcnt(10)
  v_mfma_f32_16x16x32_bf16 v[16:19], a[96:99], a[48:51], v[16:19]
  v_mfma_f32_16x16x32_bf16 v[72:75], a[96:99], a[52:55], v[72:75]
  s_add_u32 m0, s38, 81920
  s_nop 0
  buffer_load_dwordx4 v225, s[8:11], s17 offen lds
  v_mfma_f32_16x16x32_bf16 v[128:131], a[96:99], a[56:59], v[128:131]
  v_mfma_f32_16x16x32_bf16 v[184:187], a[96:99], a[60:63], v[184:187]
  s_waitcnt lgkmcnt(8)
  v_mfma_f32_16x16x32_bf16 v[20:23], a[100:103], a[48:51], v[20:23]
  v_mfma_f32_16x16x32_bf16 v[76:79], a[100:103], a[52:55], v[76:79]
  buffer_load_dwordx4 v226, s[8:11], s17 offen offset:1024 lds
  v_mfma_f32_16x16x32_bf16 v[132:135], a[100:103], a[56:59], v[132:135]
  v_mfma_f32_16x16x32_bf16 v[188:191], a[100:103], a[60:63], v[188:191]
  s_waitcnt lgkmcnt(6)
  v_mfma_f32_16x16x32_bf16 v[24:27], a[104:107], a[48:51], v[24:27]
  v_mfma_f32_16x16x32_bf16 v[80:83], a[104:107], a[52:55], v[80:83]
  buffer_load_dwordx4 v227, s[8:11], s17 offen offset:2048 lds
  v_mfma_f32_16x16x32_bf16 v[136:139], a[104:107], a[56:59], v[136:139]
  v_mfma_f32_16x16x32_bf16 v[192:195], a[104:107], a[60:63], v[192:195]
  s_waitcnt lgkmcnt(4)
  v_mfma_f32_16x16x32_bf16 v[44:47], a[108:111], a[48:51], v[44:47]
  v_mfma_f32_16x16x32_bf16 v[100:103], a[108:111], a[52:55], v[100:103]
  buffer_load_dwordx4 v228, s[8:11], s17 offen offset:3072 lds
  s_add_u32 s17, s17, 458752
  s_cmp_eq_u32 s17, s93
  s_cselect_b32 s17, s95, s17
  v_mfma_f32_16x16x32_bf16 v[156:159], a[108:111], a[56:59], v[156:159]
  v_mfma_f32_16x16x32_bf16 v[212:215], a[108:111], a[60:63], v[212:215]
  s_waitcnt lgkmcnt(2)
  v_mfma_f32_16x16x32_bf16 v[48:51], a[112:115], a[48:51], v[48:51]
  v_mfma_f32_16x16x32_bf16 v[104:107], a[112:115], a[52:55], v[104:107]
  v_mfma_f32_16x16x32_bf16 v[160:163], a[112:115], a[56:59], v[160:163]
  v_mfma_f32_16x16x32_bf16 v[216:219], a[112:115], a[60:63], v[216:219]
  s_waitcnt lgkmcnt(0)
  v_mfma_f32_16x16x32_bf16 v[52:55], a[116:119], a[48:51], v[52:55]
  v_mfma_f32_16x16x32_bf16 v[108:111], a[116:119], a[52:55], v[108:111]
  v_mfma_f32_16x16x32_bf16 v[164:167], a[116:119], a[56:59], v[164:167]
  v_mfma_f32_16x16x32_bf16 v[220:223], a[116:119], a[60:63], v[220:223]
  s_nop 7
  s_nop 1
L_k56_seam:
  v_pk_mul_f32 v[232:233], v[0:1], s[42:43]
  v_pk_mul_f32 v[234:235], v[2:3], s[42:43]
  v_exp_f32 v232, v232
  v_exp_f32 v233, v233
  v_exp_f32 v234, v234
  v_exp_f32 v235, v235
  v_pk_add_f32 v[232:233], v[232:233], s[62:63]
  v_pk_add_f32 v[234:235], v[234:235], s[62:63]
  v_rcp_f32 v232, v232
  v_rcp_f32 v233, v233
  v_rcp_f32 v234, v234
  v_rcp_f32 v235, v235
  v_pk_mul_f32 v[232:233], v[232:233], v[28:29]
  v_pk_mul_f32 v[234:235], v[234:235], v[30:31]
  v_cvt_pk_bf16_f32 v0, v232, v233
  v_cvt_pk_bf16_f32 v1, v234, v235
  v_pk_mul_f32 v[236:237], v[4:5], s[42:43]
  v_pk_mul_f32 v[238:239], v[6:7], s[42:43]
  v_exp_f32 v236, v236
  v_exp_f32 v237, v237
  v_exp_f32 v238, v238
  v_exp_f32 v239, v239
  v_pk_add_f32 v[236:237], v[236:237], s[62:63]
  v_pk_add_f32 v[238:239], v[238:239], s[62:63]
  v_rcp_f32 v236, v236
  v_rcp_f32 v237, v237
  v_rcp_f32 v238, v238
  v_rcp_f32 v239, v239
  v_pk_mul_f32 v[236:237], v[236:237], v[32:33]
  v_pk_mul_f32 v[238:239], v[238:239], v[34:35]
  v_cvt_pk_bf16_f32 v2, v236, v237
  v_cvt_pk_bf16_f32 v3, v238, v239
  buffer_store_dwordx4 v[0:3], v224, s[12:15], s98 offen offset:0 sc1
  v_pk_mul_f32 v[232:233], v[56:57], s[42:43]
  v_pk_mul_f32 v[234:235], v[58:59], s[42:43]
  v_exp_f32 v232, v232
  v_exp_f32 v233, v233
  v_exp_f32 v234, v234
  v_exp_f32 v235, v235
  v_pk_add_f32 v[232:233], v[232:233], s[62:63]
  v_pk_add_f32 v[234:235], v[234:235], s[62:63]
  v_rcp_f32 v232, v232
  v_rcp_f32 v233, v233
  v_rcp_f32 v234, v234
  v_rcp_f32 v235, v235
  v_pk_mul_f32 v[232:233], v[232:233], v[84:85]
  v_pk_mul_f32 v[234:235], v[234:235], v[86:87]
  v_cvt_pk_bf16_f32 v56, v232, v233
  v_cvt_pk_bf16_f32 v57, v234, v235
  v_pk_mul_f32 v[236:237], v[60:61], s[42:43]
  v_pk_mul_f32 v[238:239], v[62:63], s[42:43]
  v_exp_f32 v236, v236
  v_exp_f32 v237, v237
  v_exp_f32 v238, v238
  v_exp_f32 v239, v239
  v_pk_add_f32 v[236:237], v[236:237], s[62:63]
  v_pk_add_f32 v[238:239], v[238:239], s[62:63]
  v_rcp_f32 v236, v236
  v_rcp_f32 v237, v237
  v_rcp_f32 v238, v238
  v_rcp_f32 v239, v239
  v_pk_mul_f32 v[236:237], v[236:237], v[88:89]
  v_pk_mul_f32 v[238:239], v[238:239], v[90:91]
  v_cvt_pk_bf16_f32 v58, v236, v237
  v_cvt_pk_bf16_f32 v59, v238, v239
  buffer_store_dwordx4 v[56:59], v224, s[12:15], s98 offen offset:1024 sc1
  v_pk_mul_f32 v[232:233], v[112:113], s[42:43]
  v_pk_mul_f32 v[234:235], v[114:115], s[42:43]
  v_exp_f32 v232, v232
  v_exp_f32 v233, v233
  v_exp_f32 v234, v234
  v_exp_f32 v235, v235
  v_pk_add_f32 v[232:233], v[232:233], s[62:63]
  v_pk_add_f32 v[234:235], v[234:235], s[62:63]
  v_rcp_f32 v232, v232
  v_rcp_f32 v233, v233
  v_rcp_f32 v234, v234
  v_rcp_f32 v235, v235
  v_pk_mul_f32 v[232:233], v[232:233], v[140:141]
  v_pk_mul_f32 v[234:235], v[234:235], v[142:143]
  v_cvt_pk_bf16_f32 v112, v232, v233
  v_cvt_pk_bf16_f32 v113, v234, v235
  v_pk_mul_f32 v[236:237], v[116:117], s[42:43]
  v_pk_mul_f32 v[238:239], v[118:119], s[42:43]
  v_exp_f32 v236, v236
  v_exp_f32 v237, v237
  v_exp_f32 v238, v238
  v_exp_f32 v239, v239
  v_pk_add_f32 v[236:237], v[236:237], s[62:63]
  v_pk_add_f32 v[238:239], v[238:239], s[62:63]
  v_rcp_f32 v236, v236
  v_rcp_f32 v237, v237
  v_rcp_f32 v238, v238
  v_rcp_f32 v239, v239
  v_pk_mul_f32 v[236:237], v[236:237], v[144:145]
  v_pk_mul_f32 v[238:239], v[238:239], v[146:147]
  v_cvt_pk_bf16_f32 v114, v236, v237
  v_cvt_pk_bf16_f32 v115, v238, v239
  buffer_store_dwordx4 v[112:115], v224, s[12:15], s98 offen offset:2048 sc1
  v_pk_mul_f32 v[232:233], v[168:169], s[42:43]
  v_pk_mul_f32 v[234:235], v[170:171], s[42:43]
  v_exp_f32 v232, v232
  v_exp_f32 v233, v233
  v_exp_f32 v234, v234
  v_exp_f32 v235, v235
  v_pk_add_f32 v[232:233], v[232:233], s[62:63]
  v_pk_add_f32 v[234:235], v[234:235], s[62:63]
  v_rcp_f32 v232, v232
  v_rcp_f32 v233, v233
  v_rcp_f32 v234, v234
  v_rcp_f32 v235, v235
  v_pk_mul_f32 v[232:233], v[232:233], v[196:197]
  v_pk_mul_f32 v[234:235], v[234:235], v[198:199]
  v_cvt_pk_bf16_f32 v168, v232, v233
  v_cvt_pk_bf16_f32 v169, v234, v235
  v_pk_mul_f32 v[236:237], v[172:173], s[42:43]
  v_pk_mul_f32 v[238:239], v[174:175], s[42:43]
  v_exp_f32 v236, v236
  v_exp_f32 v237, v237
  v_exp_f32 v238, v238
  v_exp_f32 v239, v239
  v_pk_add_f32 v[236:237], v[236:237], s[62:63]
  v_pk_add_f32 v[238:239], v[238:239], s[62:63]
  v_rcp_f32 v236, v236
  v_rcp_f32 v237, v237
  v_rcp_f32 v238, v238
  v_rcp_f32 v239, v239
  v_pk_mul_f32 v[236:237], v[236:237], v[200:201]
  v_pk_mul_f32 v[238:239], v[238:239], v[202:203]
  v_cvt_pk_bf16_f32 v170, v236, v237
  v_cvt_pk_bf16_f32 v171, v238, v239
  buffer_store_dwordx4 v[168:171], v224, s[12:15], s98 offen offset:3072 sc1
  v_pk_mul_f32 v[232:233], v[8:9], s[42:43]
  v_pk_mul_f32 v[234:235], v[10:11], s[42:43]
  v_exp_f32 v232, v232
  v_exp_f32 v233, v233
  v_exp_f32 v234, v234
  v_exp_f32 v235, v235
  v_pk_add_f32 v[232:233], v[232:233], s[62:63]
  v_pk_add_f32 v[234:235], v[234:235], s[62:63]
  v_rcp_f32 v232, v232
  v_rcp_f32 v233, v233
  v_rcp_f32 v234, v234
  v_rcp_f32 v235, v235
  v_pk_mul_f32 v[232:233], v[232:233], v[36:37]
  v_pk_mul_f32 v[234:235], v[234:235], v[38:39]
  v_cvt_pk_bf16_f32 v4, v232, v233
  v_cvt_pk_bf16_f32 v5, v234, v235
  v_pk_mul_f32 v[236:237], v[12:13], s[42:43]
  v_pk_mul_f32 v[238:239], v[14:15], s[42:43]
  v_exp_f32 v236, v236
  v_exp_f32 v237, v237
  v_exp_f32 v238, v238
  v_exp_f32 v239, v239
  v_pk_add_f32 v[236:237], v[236:237], s[62:63]
  v_pk_add_f32 v[238:239], v[238:239], s[62:63]
  v_rcp_f32 v236, v236
  v_rcp_f32 v237, v237
  v_rcp_f32 v238, v238
  v_rcp_f32 v239, v239
  v_pk_mul_f32 v[236:237], v[236:237], v[40:41]
  v_pk_mul_f32 v[238:239], v[238:239], v[42:43]
  v_cvt_pk_bf16_f32 v6, v236, v237
  v_cvt_pk_bf16_f32 v7, v238, v239
  v_pk_mul_f32 v[232:233], v[64:65], s[42:43]
  v_pk_mul_f32 v[234:235], v[66:67], s[42:43]
  v_exp_f32 v232, v232
  v_exp_f32 v233, v233
  v_exp_f32 v234, v234
  v_exp_f32 v235, v235
  v_pk_add_f32 v[232:233], v[232:233], s[62:63]
  v_pk_add_f32 v[234:235], v[234:235], s[62:63]
  v_rcp_f32 v232, v232
  v_rcp_f32 v233, v233
  v_rcp_f32 v234, v234
  v_rcp_f32 v235, v235
  v_pk_mul_f32 v[232:233], v[232:233], v[92:93]
  v_pk_mul_f32 v[234:235], v[234:235], v[94:95]
  v_cvt_pk_bf16_f32 v60, v232, v233
  v_cvt_pk_bf16_f32 v61, v234, v235
  v_pk_mul_f32 v[236:237], v[68:69], s[42:43]
  v_pk_mul_f32 v[238:239], v[70:71], s[42:43]
  v_exp_f32 v236, v236
  v_exp_f32 v237, v237
  v_exp_f32 v238, v238
  v_exp_f32 v239, v239
  v_pk_add_f32 v[236:237], v[236:237], s[62:63]
  v_pk_add_f32 v[238:239], v[238:239], s[62:63]
  v_rcp_f32 v236, v236
  v_rcp_f32 v237, v237
  v_rcp_f32 v238, v238
  v_rcp_f32 v239, v239
  v_pk_mul_f32 v[236:237], v[236:237], v[96:97]
  v_pk_mul_f32 v[238:239], v[238:239], v[98:99]
  v_cvt_pk_bf16_f32 v62, v236, v237
  v_cvt_pk_bf16_f32 v63, v238, v239
  v_pk_mul_f32 v[232:233], v[120:121], s[42:43]
  v_pk_mul_f32 v[234:235], v[122:123], s[42:43]
  v_exp_f32 v232, v232
  v_exp_f32 v233, v233
  v_exp_f32 v234, v234
  v_exp_f32 v235, v235
  v_pk_add_f32 v[232:233], v[232:233], s[62:63]
  v_pk_add_f32 v[234:235], v[234:235], s[62:63]
  v_rcp_f32 v232, v232
  v_rcp_f32 v233, v233
  v_rcp_f32 v234, v234
  v_rcp_f32 v235, v235
  v_pk_mul_f32 v[232:233], v[232:233], v[148:149]
  v_pk_mul_f32 v[234:235], v[234:235], v[150:151]
  v_cvt_pk_bf16_f32 v116, v232, v233
  v_cvt_pk_bf16_f32 v117, v234, v235
  v_pk_mul_f32 v[236:237], v[124:125], s[42:43]
  v_pk_mul_f32 v[238:239], v[126:127], s[42:43]
  v_exp_f32 v236, v236
  v_exp_f32 v237, v237
  v_exp_f32 v238, v238
  v_exp_f32 v239, v239
  v_pk_add_f32 v[236:237], v[236:237], s[62:63]
  v_pk_add_f32 v[238:239], v[238:239], s[62:63]
  v_rcp_f32 v236, v236
  v_rcp_f32 v237, v237
  v_rcp_f32 v238, v238
  v_rcp_f32 v239, v239
  v_pk_mul_f32 v[236:237], v[236:237], v[152:153]
  v_pk_mul_f32 v[238:239], v[238:239], v[154:155]
  v_cvt_pk_bf16_f32 v118, v236, v237
  v_cvt_pk_bf16_f32 v119, v238, v239
  s_waitcnt vmcnt(0)
  s_mov_b64 exec, 1
  buffer_store_dword v248, v250, s[56:59], s92 offen sc1
  s_mov_b64 exec, -1
  s_add_u32 s92, s92, 65536
  s_barrier
  v_pk_mul_f32 v[232:233], v[176:177], s[42:43]
  v_pk_mul_f32 v[234:235], v[178:179], s[42:43]
  v_exp_f32 v232, v232
  v_exp_f32 v233, v233
  v_exp_f32 v234, v234
  v_exp_f32 v235, v235
  v_pk_add_f32 v[232:233], v[232:233], s[62:63]
  v_pk_add_f32 v[234:235], v[234:235], s[62:63]
  s_add_u32 m0, s38, 98304
  s_nop 0
  buffer_load_dwordx4 v225, s[8:11], s17 offen lds
  v_rcp_f32 v232, v232
  v_rcp_f32 v233, v233
  v_rcp_f32 v234, v234
  v_rcp_f32 v235, v235
  v_pk_mul_f32 v[232:233], v[232:233], v[204:205]
  v_pk_mul_f32 v[234:235], v[234:235], v[206:207]
  v_cvt_pk_bf16_f32 v172, v232, v233
  v_cvt_pk_bf16_f32 v173, v234, v235
  buffer_load_dwordx4 v226, s[8:11], s17 offen offset:1024 lds
  v_pk_mul_f32 v[236:237], v[180:181], s[42:43]
  v_pk_mul_f32 v[238:239], v[182:183], s[42:43]
  v_exp_f32 v236, v236
  v_exp_f32 v237, v237
  v_exp_f32 v238, v238
  v_exp_f32 v239, v239
  v_pk_add_f32 v[236:237], v[236:237], s[62:63]
  v_pk_add_f32 v[238:239], v[238:239], s[62:63]
  buffer_load_dwordx4 v227, s[8:11], s17 offen offset:2048 lds
  v_rcp_f32 v236, v236
  v_rcp_f32 v237, v237
  v_rcp_f32 v238, v238
  v_rcp_f32 v239, v239
  v_pk_mul_f32 v[236:237], v[236:237], v[208:209]
  v_pk_mul_f32 v[238:239], v[238:239], v[210:211]
  v_cvt_pk_bf16_f32 v174, v236, v237
  v_cvt_pk_bf16_f32 v175, v238, v239
  buffer_load_dwordx4 v228, s[8:11], s17 offen offset:3072 lds
  s_add_u32 s17, s17, 458752
  s_cmp_eq_u32 s17, s93
  s_cselect_b32 s17, s95, s17
  v_pk_mul_f32 v[232:233], v[16:17], s[42:43]
  v_pk_mul_f32 v[234:235], v[18:19], s[42:43]
  v_exp_f32 v232, v232
  v_exp_f32 v233, v233
  v_exp_f32 v234, v234
  v_exp_f32 v235, v235
  v_pk_add_f32 v[232:233], v[232:233], s[62:63]
  v_pk_add_f32 v[234:235], v[234:235], s[62:63]
  s_add_u32 m0, s38, 114688
  s_nop 0
  buffer_load_dwordx4 v225, s[8:11], s17 offen lds
  v_rcp_f32 v232, v232
  v_rcp_f32 v233, v233
  v_rcp_f32 v234, v234
  v_rcp_f32 v235, v235
  v_pk_mul_f32 v[232:233], v[232:233], v[44:45]
  v_pk_mul_f32 v[234:235], v[234:235], v[46:47]
  v_cvt_pk_bf16_f32 v8, v232, v233
  v_cvt_pk_bf16_f32 v9, v234, v235
  buffer_load_dwordx4 v226, s[8:11], s17 offen offset:1024 lds
  v_pk_mul_f32 v[236:237], v[20:21], s[42:43]
  v_pk_mul_f32 v[238:239], v[22:23], s[42:43]
  v_exp_f32 v236, v236
  v_exp_f32 v237, v237
  v_exp_f32 v238, v238
  v_exp_f32 v239, v239
  v_pk_add_f32 v[236:237], v[236:237], s[62:63]
  v_pk_add_f32 v[238:239], v[238:239], s[62:63]
  buffer_load_dwordx4 v227, s[8:11], s17 offen offset:2048 lds
  v_rcp_f32 v236, v236
  v_rcp_f32 v237, v237
  v_rcp_f32 v238, v238
  v_rcp_f32 v239, v239
  v_pk_mul_f32 v[236:237], v[236:237], v[48:49]
  v_pk_mul_f32 v[238:239], v[238:239], v[50:51]
  v_cvt_pk_bf16_f32 v10, v236, v237
  v_cvt_pk_bf16_f32 v11, v238, v239
  buffer_load_dwordx4 v228, s[8:11], s17 offen offset:3072 lds
  s_add_u32 s17, s17, 458752
  s_cmp_eq_u32 s17, s93
  s_cselect_b32 s17, s95, s17
  s_add_u32 s17, s17, 65536
  s_add_u32 s93, s93, 65536
  s_add_u32 s95, s95, 65536
  v_pk_mul_f32 v[232:233], v[72:73], s[42:43]
  v_pk_mul_f32 v[234:235], v[74:75], s[42:43]
  v_exp_f32 v232, v232
  v_exp_f32 v233, v233
  v_exp_f32 v234, v234
  v_exp_f32 v235, v235
  v_pk_add_f32 v[232:233], v[232:233], s[62:63]
  v_pk_add_f32 v[234:235], v[234:235], s[62:63]
  s_add_u32 m0, s38, 131072
  s_nop 0
  buffer_load_dwordx4 v225, s[8:11], s17 offen lds
  v_rcp_f32 v232, v232
  v_rcp_f32 v233, v233
  v_rcp_f32 v234, v234
  v_rcp_f32 v235, v235
  v_pk_mul_f32 v[232:233], v[232:233], v[100:101]
  v_pk_mul_f32 v[234:235], v[234:235], v[102:103]
  v_cvt_pk_bf16_f32 v64, v232, v233
  v_cvt_pk_bf16_f32 v65, v234, v235
  buffer_load_dwordx4 v226, s[8:11], s17 offen offset:1024 lds
  v_pk_mul_f32 v[236:237], v[76:77], s[42:43]
  v_pk_mul_f32 v[238:239], v[78:79], s[42:43]
  v_exp_f32 v236, v236
  v_exp_f32 v237, v237
  v_exp_f32 v238, v238
  v_exp_f32 v239, v239
  v_pk_add_f32 v[236:237], v[236:237], s[62:63]
  v_pk_add_f32 v[238:239], v[238:239], s[62:63]
  buffer_load_dwordx4 v227, s[8:11], s17 offen offset:2048 lds
  v_rcp_f32 v236, v236
  v_rcp_f32 v237, v237
  v_rcp_f32 v238, v238
  v_rcp_f32 v239, v239
  v_pk_mul_f32 v[236:237], v[236:237], v[104:105]
  v_pk_mul_f32 v[238:239], v[238:239], v[106:107]
  v_cvt_pk_bf16_f32 v66, v236, v237
  v_cvt_pk_bf16_f32 v67, v238, v239
  buffer_load_dwordx4 v228, s[8:11], s17 offen offset:3072 lds
  s_add_u32 s17, s17, 458752
  s_cmp_eq_u32 s17, s93
  s_cselect_b32 s17, s95, s17
  v_pk_mul_f32 v[232:233], v[128:129], s[42:43]
  v_pk_mul_f32 v[234:235], v[130:131], s[42:43]
  v_exp_f32 v232, v232
  v_exp_f32 v233, v233
  v_exp_f32 v234, v234
  v_exp_f32 v235, v235
  v_pk_add_f32 v[232:233], v[232:233], s[62:63]
  v_pk_add_f32 v[234:235], v[234:235], s[62:63]
  v_rcp_f32 v232, v232
  v_rcp_f32 v233, v233
  v_rcp_f32 v234, v234
  v_rcp_f32 v235, v235
  v_pk_mul_f32 v[232:233], v[232:233], v[156:157]
  v_pk_mul_f32 v[234:235], v[234:235], v[158:159]
  v_cvt_pk_bf16_f32 v120, v232, v233
  v_cvt_pk_bf16_f32 v121, v234, v235
  v_pk_mul_f32 v[236:237], v[132:133], s[42:43]
  v_pk_mul_f32 v[238:239], v[134:135], s[42:43]
  v_exp_f32 v236, v236
  v_exp_f32 v237, v237
  v_exp_f32 v238, v238
  v_exp_f32 v239, v239
  v_pk_add_f32 v[236:237], v[236:237], s[62:63]
  v_pk_add_f32 v[238:239], v[238:239], s[62:63]
  v_rcp_f32 v236, v236
  v_rcp_f32 v237, v237
  v_rcp_f32 v238, v238
  v_rcp_f32 v239, v239
  v_pk_mul_f32 v[236:237], v[236:237], v[160:161]
  v_pk_mul_f32 v[238:239], v[238:239], v[162:163]
  v_cvt_pk_bf16_f32 v122, v236, v237
  v_cvt_pk_bf16_f32 v123, v238, v239
  v_pk_mul_f32 v[232:233], v[184:185], s[42:43]
  v_pk_mul_f32 v[234:235], v[186:187], s[42:43]
  v_exp_f32 v232, v232
  v_exp_f32 v233, v233
  v_exp_f32 v234, v234
  v_exp_f32 v235, v235
  v_pk_add_f32 v[232:233], v[232:233], s[62:63]
  v_pk_add_f32 v[234:235], v[234:235], s[62:63]
  v_rcp_f32 v232, v232
  v_rcp_f32 v233, v233
  v_rcp_f32 v234, v234
  v_rcp_f32 v235, v235
  v_pk_mul_f32 v[232:233], v[232:233], v[212:213]
  v_pk_mul_f32 v[234:235], v[234:235], v[214:215]
  v_cvt_pk_bf16_f32 v176, v232, v233
  v_cvt_pk_bf16_f32 v177, v234, v235
  v_pk_mul_f32 v[236:237], v[188:189], s[42:43]
  v_pk_mul_f32 v[238:239], v[190:191], s[42:43]
  v_exp_f32 v236, v236
  v_exp_f32 v237, v237
  v_exp_f32 v238, v238
  v_exp_f32 v239, v239
  v_pk_add_f32 v[236:237], v[236:237], s[62:63]
  v_pk_add_f32 v[238:239], v[238:239], s[62:63]
  v_rcp_f32 v236, v236
  v_rcp_f32 v237, v237
  v_rcp_f32 v238, v238
  v_rcp_f32 v239, v239
  v_pk_mul_f32 v[236:237], v[236:237], v[216:217]
  v_pk_mul_f32 v[238:239], v[238:239], v[218:219]
  v_cvt_pk_bf16_f32 v178, v236, v237
  v_cvt_pk_bf16_f32 v179, v238, v239
  buffer_load_dword v247, v246, s[56:59], s94 offen sc1
  buffer_store_dwordx4 v[4:7], v224, s[12:15], s99 offen offset:0 sc1
  buffer_store_dwordx4 v[60:63], v224, s[12:15], s99 offen offset:1024 sc1
  buffer_store_dwordx4 v[116:119], v224, s[12:15], s99 offen offset:2048 sc1
  buffer_store_dwordx4 v[172:175], v224, s[12:15], s99 offen offset:3072 sc1
  v_pk_mul_f32 v[232:233], v[24:25], s[42:43]
  v_pk_mul_f32 v[234:235], v[26:27], s[42:43]
  v_exp_f32 v232, v232
  v_exp_f32 v233, v233
  v_exp_f32 v234, v234
  v_exp_f32 v235, v235
  v_pk_add_f32 v[232:233], v[232:233], s[62:63]
  v_pk_add_f32 v[234:235], v[234:235], s[62:63]
  v_rcp_f32 v232, v232
  v_rcp_f32 v233, v233
  v_rcp_f32 v234, v234
  v_rcp_f32 v235, v235
  v_pk_mul_f32 v[232:233], v[232:233], v[52:53]
  v_pk_mul_f32 v[234:235], v[234:235], v[54:55]
  v_cvt_pk_bf16_f32 v12, v232, v233
  v_cvt_pk_bf16_f32 v13, v234, v235
  v_pk_mul_f32 v[236:237], v[80:81], s[42:43]
  v_pk_mul_f32 v[238:239], v[82:83], s[42:43]
  v_exp_f32 v236, v236
  v_exp_f32 v237, v237
  v_exp_f32 v238, v238
  v_exp_f32 v239, v239
  v_pk_add_f32 v[236:237], v[236:237], s[62:63]
  v_pk_add_f32 v[238:239], v[238:239], s[62:63]
  v_rcp_f32 v236, v236
  v_rcp_f32 v237, v237
  v_rcp_f32 v238, v238
  v_rcp_f32 v239, v239
  v_pk_mul_f32 v[236:237], v[236:237], v[108:109]
  v_pk_mul_f32 v[238:239], v[238:239], v[110:111]
  v_cvt_pk_bf16_f32 v14, v236, v237
  v_cvt_pk_bf16_f32 v15, v238, v239
  v_pk_mul_f32 v[232:233], v[136:137], s[42:43]
  v_pk_mul_f32 v[234:235], v[138:139], s[42:43]
  v_exp_f32 v232, v232
  v_exp_f32 v233, v233
  v_exp_f32 v234, v234
  v_exp_f32 v235, v235
  v_pk_add_f32 v[232:233], v[232:233], s[62:63]
  v_pk_add_f32 v[234:235], v[234:235], s[62:63]
  v_rcp_f32 v232, v232
  v_rcp_f32 v233, v233
  v_rcp_f32 v234, v234
  v_rcp_f32 v235, v235
  v_pk_mul_f32 v[232:233], v[232:233], v[164:165]
  v_pk_mul_f32 v[234:235], v[234:235], v[166:167]
  v_cvt_pk_bf16_f32 v124, v232, v233
  v_cvt_pk_bf16_f32 v125, v234, v235
  v_pk_mul_f32 v[236:237], v[192:193], s[42:43]
  v_pk_mul_f32 v[238:239], v[194:195], s[42:43]
  v_exp_f32 v236, v236
  v_exp_f32 v237, v237
  v_exp_f32 v238, v238
  v_exp_f32 v239, v239
  v_pk_add_f32 v[236:237], v[236:237], s[62:63]
  v_pk_add_f32 v[238:239], v[238:239], s[62:63]
  v_rcp_f32 v236, v236
  v_rcp_f32 v237, v237
  v_rcp_f32 v238, v238
  v_rcp_f32 v239, v239
  v_pk_mul_f32 v[236:237], v[236:237], v[220:221]
  v_pk_mul_f32 v[238:239], v[238:239], v[222:223]
  v_cvt_pk_bf16_f32 v126, v236, v237
  v_cvt_pk_bf16_f32 v127, v238, v239
  s_waitcnt vmcnt(4)
  v_cmp_ne_u32 vcc, s19, v247
  s_nop 1
  s_cmp_lg_u64 vcc, 0
  s_cbranch_scc1 L_slow_25
  L_back_26:
  s_add_u32 s94, s94, 65536
  buffer_load_dwordx4 a[0:3], v240, s[4:7], s16 offen offset:0 sc1
  buffer_load_dwordx4 a[4:7], v240, s[4:7], s16 offen offset:1024 sc1
  buffer_load_dwordx4 a[8:11], v241, s[4:7], s16 offen offset:0 sc1
  buffer_load_dwordx4 a[12:15], v241, s[4:7], s16 offen offset:1024 sc1
  s_add_u32 s41, s41, 262144
  s_bitset0_b32 s41, 21
  s_add_u32 s16, s40, s41
  buffer_load_dwordx4 a[16:19], v240, s[4:7], s16 offen offset:0 sc1
  buffer_load_dwordx4 a[20:23], v240, s[4:7], s16 offen offset:1024 sc1
  buffer_load_dwordx4 a[24:27], v241, s[4:7], s16 offen offset:0 sc1
  buffer_load_dwordx4 a[28:31], v241, s[4:7], s16 offen offset:1024 sc1
  s_add_u32 s41, s41, 262144
  s_bitset0_b32 s41, 21
  s_add_u32 s16, s40, s41
  buffer_load_dwordx4 a[32:35], v240, s[4:7], s16 offen offset:0 sc1
  buffer_load_dwordx4 a[36:39], v240, s[4:7], s16 offen offset:1024 sc1
  buffer_load_dwordx4 a[40:43], v241, s[4:7], s16 offen offset:0 sc1
  buffer_load_dwordx4 a[44:47], v241, s[4:7], s16 offen offset:1024 sc1
  s_add_u32 s41, s41, 262144
  s_bitset0_b32 s41, 21
  s_add_u32 s16, s40, s41
  v_add_u32 v104, 65536, v242
  v_add_u32 v105, 65536, v243
  v_add_u32 v106, 65536, v244
  v_add_u32 v107, 65536, v245
  s_waitcnt vmcnt(54)
  s_barrier
  ds_read_b64_tr_b16 a[80:81], v242 offset:2048
  ds_read_b64_tr_b16 a[82:83], v242 offset:6144
  ds_read_b64_tr_b16 a[84:85], v243 offset:2048
  ds_read_b64_tr_b16 a[86:87], v243 offset:6144
  ds_read_b64_tr_b16 a[88:89], v244 offset:2048
  ds_read_b64_tr_b16 a[90:91], v244 offset:6144
  ds_read_b64_tr_b16 a[92:93], v245 offset:2048
  ds_read_b64_tr_b16 a[94:95], v245 offset:6144
  ds_read_b64_tr_b16 a[112:113], v242 offset:10240
  ds_read_b64_tr_b16 a[114:115], v242 offset:14336
  ds_read_b64_tr_b16 a[116:117], v243 offset:10240
  ds_read_b64_tr_b16 a[118:119], v243 offset:14336
  ds_read_b64_tr_b16 a[120:121], v244 offset:10240
  ds_read_b64_tr_b16 a[122:123], v244 offset:14336
  ds_read_b64_tr_b16 a[124:125], v245 offset:10240
  ds_read_b64_tr_b16 a[126:127], v245 offset:14336
  ds_read_b64_tr_b16 a[64:65], v242 offset:0
  ds_read_b64_tr_b16 a[66:67], v242 offset:4096
  ds_read_b64_tr_b16 a[68:69], v243 offset:0
  ds_read_b64_tr_b16 a[70:71], v243 offset:4096
  ds_read_b64_tr_b16 a[72:73], v244 offset:0
  ds_read_b64_tr_b16 a[74:75], v244 offset:4096
  ds_read_b64_tr_b16 a[76:77], v245 offset:0
  ds_read_b64_tr_b16 a[78:79], v245 offset:4096
  ds_read_b64_tr_b16 a[96:97], v242 offset:8192
  ds_read_b64_tr_b16 a[98:99], v242 offset:12288
  ds_read_b64_tr_b16 a[100:101], v243 offset:8192
  ds_read_b64_tr_b16 a[102:103], v243 offset:12288
  ds_read_b64_tr_b16 a[104:105], v244 offset:8192
  ds_read_b64_tr_b16 a[106:107], v244 offset:12288
  ds_read_b64_tr_b16 a[108:109], v245 offset:8192
  ds_read_b64_tr_b16 a[110:111], v245 offset:12288
  s_waitcnt vmcnt(8) lgkmcnt(10)
  s_barrier
  s_mov_b64 exec, 1
  buffer_store_dword v248, v250, s[56:59], s92 offen sc1
  s_mov_b64 exec, -1
  s_add_u32 s92, s92, 65536
  v_mfma_f32_16x16x32_bf16 v[72:75], a[80:83], a[0:3], 0
  buffer_load_dwordx4 a[48:51], v240, s[4:7], s16 offen offset:0 sc1
  v_mfma_f32_16x16x32_bf16 v[88:91], a[80:83], a[4:7], 0
  ds_read_b64_tr_b16 a[80:81], v242 offset:18432
  ds_read_b64_tr_b16 a[82:83], v242 offset:22528
  v_mfma_f32_16x16x32_bf16 v[76:79], a[84:87], a[0:3], 0
  v_mfma_f32_16x16x32_bf16 v[92:95], a[84:87], a[4:7], 0
  ds_read_b64_tr_b16 a[84:85], v243 offset:18432
  ds_read_b64_tr_b16 a[86:87], v243 offset:22528
  v_mfma_f32_16x16x32_bf16 v[80:83], a[88:91], a[0:3], 0
  v_mfma_f32_16x16x32_bf16 v[96:99], a[88:91], a[4:7], 0
  buffer_load_dwordx4 a[52:55], v240, s[4:7], s16 offen offset:1024 sc1
  v_mfma_f32_16x16x32_bf16 v[84:87], a[92:95], a[0:3], 0
  ds_read_b64_tr_b16 a[88:89], v244 offset:18432
  ds_read_b64_tr_b16 a[90:91], v244 offset:22528
  v_mfma_f32_16x16x32_bf16 v[100:103], a[92:95], a[4:7], 0
  ds_read_b64_tr_b16 a[92:93], v245 offset:18432
  ds_read_b64_tr_b16 a[94:95], v245 offset:22528
  v_mfma_f32_16x16x32_bf16 v[72:75], a[112:115], a[8:11], v[72:75]
  v_mfma_f32_16x16x32_bf16 v[88:91], a[112:115], a[12:15], v[88:91]
  ds_read_b64_tr_b16 a[112:113], v242 offset:26624
  ds_read_b64_tr_b16 a[114:115], v242 offset:30720
  v_mfma_f32_16x16x32_bf16 v[76:79], a[116:119], a[8:11], v[76:79]
  buffer_load_dwordx4 a[56:59], v241, s[4:7], s16 offen offset:0 sc1
  v_mfma_f32_16x16x32_bf16 v[92:95], a[116:119], a[12:15], v[92:95]
  ds_read_b64_tr_b16 a[116:117], v243 offset:26624
  ds_read_b64_tr_b16 a[118:119], v243 offset:30720
  v_mfma_f32_16x16x32_bf16 v[80:83], a[120:123], a[8:11], v[80:83]
  v_mfma_f32_16x16x32_bf16 v[96:99], a[120:123], a[12:15], v[96:99]
  ds_read_b64_tr_b16 a[120:121], v244 offset:26624
  ds_read_b64_tr_b16 a[122:123], v244 offset:30720
  v_mfma_f32_16x16x32_bf16 v[84:87], a[124:127], a[8:11], v[84:87]
  v_mfma_f32_16x16x32_bf16 v[100:103], a[124:127], a[12:15], v[100:103]
  buffer_load_dwordx4 a[60:63], v241, s[4:7], s16 offen offset:1024 sc1
  v_mfma_f32_16x16x32_bf16 v[16:19], a[64:67], a[0:3], 0
  ds_read_b64_tr_b16 a[124:125], v245 offset:26624
  s_add_u32 s41, s41, 262144
  v_mfma_f32_16x16x32_bf16 v[32:35], a[64:67], a[4:7], 0
  ds_read_b64_tr_b16 a[126:127], v245 offset:30720
  s_bitset0_b32 s41, 21
  v_mfma_f32_16x16x32_bf16 v[20:23], a[68:71], a[0:3], 0
  ds_read_b64_tr_b16 a[64:65], v242 offset:16384
  s_add_u32 s16, s40, s41
  v_mfma_f32_16x16x32_bf16 v[36:39], a[68:71], a[4:7], 0
  ds_read_b64_tr_b16 a[66:67], v242 offset:20480
  ds_read_b64_tr_b16 a[68:69], v243 offset:16384
  v_mfma_f32_16x16x32_bf16 v[24:27], a[72:75], a[0:3], 0
  buffer_store_dwordx4 v[8:11], v224, s[12:15], s100 offen offset:0 sc1
  v_mfma_f32_16x16x32_bf16 v[40:43], a[72:75], a[4:7], 0
  ds_read_b64_tr_b16 a[70:71], v243 offset:20480
  ds_read_b64_tr_b16 a[72:73], v244 offset:16384
  s_waitcnt lgkmcnt(10)
  v_mfma_f32_16x16x32_bf16 v[28:31], a[76:79], a[0:3], 0
  ds_read_b64_tr_b16 a[74:75], v244 offset:20480
  v_mfma_f32_16x16x32_bf16 v[44:47], a[76:79], a[4:7], 0
  ds_read_b64_tr_b16 a[76:77], v245 offset:16384
  ds_read_b64_tr_b16 a[78:79], v245 offset:20480
  v_mfma_f32_16x16x32_bf16 v[16:19], a[96:99], a[8:11], v[16:19]
  v_mfma_f32_16x16x32_bf16 v[32:35], a[96:99], a[12:15], v[32:35]
  buffer_store_dwordx4 v[64:67], v224, s[12:15], s100 offen offset:1024 sc1
  v_mfma_f32_16x16x32_bf16 v[20:23], a[100:103], a[8:11], v[20:23]
  ds_read_b64_tr_b16 a[96:97], v242 offset:24576
  ds_read_b64_tr_b16 a[98:99], v242 offset:28672
  v_mfma_f32_16x16x32_bf16 v[36:39], a[100:103], a[12:15], v[36:39]
  ds_read_b64_tr_b16 a[100:101], v243 offset:24576
  ds_read_b64_tr_b16 a[102:103], v243 offset:28672
  v_mfma_f32_16x16x32_bf16 v[24:27], a[104:107], a[8:11], v[24:27]
  v_mfma_f32_16x16x32_bf16 v[40:43], a[104:107], a[12:15], v[40:43]
  ds_read_b64_tr_b16 a[104:105], v244 offset:24576
  ds_read_b64_tr_b16 a[106:107], v244 offset:28672
  v_mfma_f32_16x16x32_bf16 v[28:31], a[108:111], a[8:11], v[28:31]
  v_mfma_f32_16x16x32_bf16 v[44:47], a[108:111], a[12:15], v[44:47]
  s_waitcnt vmcnt(11) lgkmcnt(10)
  s_barrier
  v_mfma_f32_16x16x32_bf16 v[72:75], a[80:83], a[16:19], v[72:75]
  buffer_load_dwordx4 a[0:3], v240, s[4:7], s16 offen offset:0 sc1
  v_mfma_f32_16x16x32_bf16 v[88:91], a[80:83], a[20:23], v[88:91]
  ds_read_b64_tr_b16 a[108:109], v245 offset:24576
  ds_read_b64_tr_b16 a[110:111], v245 offset:28672
  v_mfma_f32_16x16x32_bf16 v[76:79], a[84:87], a[16:19], v[76:79]
  ds_read_b64_tr_b16 a[80:81], v242 offset:34816
  ds_read_b64_tr_b16 a[82:83], v242 offset:38912
  v_mfma_f32_16x16x32_bf16 v[92:95], a[84:87], a[20:23], v[92:95]
  ds_read_b64_tr_b16 a[84:85], v243 offset:34816
  ds_read_b64_tr_b16 a[86:87], v243 offset:38912
  v_mfma_f32_16x16x32_bf16 v[80:83], a[88:91], a[16:19], v[80:83]
  v_mfma_f32_16x16x32_bf16 v[96:99], a[88:91], a[20:23], v[96:99]
  buffer_load_dwordx4 a[4:7], v240, s[4:7], s16 offen offset:1024 sc1
  v_mfma_f32_16x16x32_bf16 v[84:87], a[92:95], a[16:19], v[84:87]
  ds_read_b64_tr_b16 a[88:89], v244 offset:34816
  ds_read_b64_tr_b16 a[90:91], v244 offset:38912
  v_mfma_f32_16x16x32_bf16 v[100:103], a[92:95], a[20:23], v[100:103]
  ds_read_b64_tr_b16 a[92:93], v245 offset:34816
  ds_read_b64_tr_b16 a[94:95], v245 offset:38912
  v_mfma_f32_16x16x32_bf16 v[72:75], a[112:115], a[24:27], v[72:75]
  v_mfma_f32_16x16x32_bf16 v[88:91], a[112:115], a[28:31], v[88:91]
  ds_read_b64_tr_b16 a[112:113], v242 offset:43008
  ds_read_b64_tr_b16 a[114:115], v242 offset:47104
  v_mfma_f32_16x16x32_bf16 v[76:79], a[116:119], a[24:27], v[76:79]
  buffer_load_dwordx4 a[8:11], v241, s[4:7], s16 offen offset:0 sc1
  v_mfma_f32_16x16x32_bf16 v[92:95], a[116:119], a[28:31], v[92:95]
  ds_read_b64_tr_b16 a[116:117], v243 offset:43008
  ds_read_b64_tr_b16 a[118:119], v243 offset:47104
  v_mfma_f32_16x16x32_bf16 v[80:83], a[120:123], a[24:27], v[80:83]
  v_mfma_f32_16x16x32_bf16 v[96:99], a[120:123], a[28:31], v[96:99]
  ds_read_b64_tr_b16 a[120:121], v244 offset:43008
  ds_read_b64_tr_b16 a[122:123], v244 offset:47104
  v_mfma_f32_16x16x32_bf16 v[84:87], a[124:127], a[24:27], v[84:87]
  v_mfma_f32_16x16x32_bf16 v[100:103], a[124:127], a[28:31], v[100:103]
  buffer_load_dwordx4 a[12:15], v241, s[4:7], s16 offen offset:1024 sc1
  v_mfma_f32_16x16x32_bf16 v[16:19], a[64:67], a[16:19], v[16:19]
  ds_read_b64_tr_b16 a[124:125], v245 offset:43008
  s_add_u32 s41, s41, 262144
  v_mfma_f32_16x16x32_bf16 v[32:35], a[64:67], a[20:23], v[32:35]
  ds_read_b64_tr_b16 a[126:127], v245 offset:47104
  s_bitset0_b32 s41, 21
  v_mfma_f32_16x16x32_bf16 v[20:23], a[68:71], a[16:19], v[20:23]
  ds_read_b64_tr_b16 a[64:65], v242 offset:32768
  s_add_u32 s16, s40, s41
  v_mfma_f32_16x16x32_bf16 v[36:39], a[68:71], a[20:23], v[36:39]
  ds_read_b64_tr_b16 a[66:67], v242 offset:36864
  ds_read_b64_tr_b16 a[68:69], v243 offset:32768
  s_waitcnt lgkmcnt(10)
  v_mfma_f32_16x16x32_bf16 v[24:27], a[72:75], a[16:19], v[24:27]
  buffer_store_dwordx4 v[120:123], v224, s[12:15], s100 offen offset:2048 sc1
  v_mfma_f32_16x16x32_bf16 v[40:43], a[72:75], a[20:23], v[40:43]
  ds_read_b64_tr_b16 a[70:71], v243 offset:36864
  ds_read_b64_tr_b16 a[72:73], v244 offset:32768
  v_mfma_f32_16x16x32_bf16 v[28:31], a[76:79], a[16:19], v[28:31]
  ds_read_b64_tr_b16 a[74:75], v244 offset:36864
  v_mfma_f32_16x16x32_bf16 v[44:47], a[76:79], a[20:23], v[44:47]
  ds_read_b64_tr_b16 a[76:77], v245 offset:32768
  ds_read_b64_tr_b16 a[78:79], v245 offset:36864
  v_mfma_f32_16x16x32_bf16 v[16:19], a[96:99], a[24:27], v[16:19]
  v_mfma_f32_16x16x32_bf16 v[32:35], a[96:99], a[28:31], v[32:35]
  buffer_store_dwordx4 v[176:179], v224, s[12:15], s100 offen offset:3072 sc1
  v_mfma_f32_16x16x32_bf16 v[20:23], a[100:103], a[24:27], v[20:23]
  ds_read_b64_tr_b16 a[96:97], v242 offset:40960
  ds_read_b64_tr_b16 a[98:99], v242 offset:45056
  v_mfma_f32_16x16x32_bf16 v[36:39], a[100:103], a[28:31], v[36:39]
  ds_read_b64_tr_b16 a[100:101], v243 offset:40960
  ds_read_b64_tr_b16 a[102:103], v243 offset:45056
  v_mfma_f32_16x16x32_bf16 v[24:27], a[104:107], a[24:27], v[24:27]
  v_mfma_f32_16x16x32_bf16 v[40:43], a[104:107], a[28:31], v[40:43]
  ds_read_b64_tr_b16 a[104:105], v244 offset:40960
  ds_read_b64_tr_b16 a[106:107], v244 offset:45056
  v_mfma_f32_16x16x32_bf16 v[28:31], a[108:111], a[24:27], v[28:31]
  v_mfma_f32_16x16x32_bf16 v[44:47], a[108:111], a[28:31], v[44:47]
  s_waitcnt vmcnt(13) lgkmcnt(10)
  s_barrier
  v_mfma_f32_16x16x32_bf16 v[72:75], a[80:83], a[32:35], v[72:75]
  buffer_load_dwordx4 a[16:19], v240, s[4:7], s16 offen offset:0 sc1
  v_mfma_f32_16x16x32_bf16 v[88:91], a[80:83], a[36:39], v[88:91]
  ds_read_b64_tr_b16 a[108:109], v245 offset:40960
  ds_read_b64_tr_b16 a[110:111], v245 offset:45056
  v_mfma_f32_16x16x32_bf16 v[76:79], a[84:87], a[32:35], v[76:79]
  ds_read_b64_tr_b16 a[80:81], v242 offset:51200
  ds_read_b64_tr_b16 a[82:83], v242 offset:55296
  v_mfma_f32_16x16x32_bf16 v[92:95], a[84:87], a[36:39], v[92:95]
  ds_read_b64_tr_b16 a[84:85], v243 offset:51200
  ds_read_b64_tr_b16 a[86:87], v243 offset:55296
  v_mfma_f32_16x16x32_bf16 v[80:83], a[88:91], a[32:35], v[80:83]
  v_mfma_f32_16x16x32_bf16 v[96:99], a[88:91], a[36:39], v[96:99]
  buffer_load_dwordx4 a[20:23], v240, s[4:7], s16 offen offset:1024 sc1
  v_mfma_f32_16x16x32_bf16 v[84:87], a[92:95], a[32:35], v[84:87]
  ds_read_b64_tr_b16 a[88:89], v244 offset:51200
  ds_read_b64_tr_b16 a[90:91], v244 offset:55296
  v_mfma_f32_16x16x32_bf16 v[100:103], a[92:95], a[36:39], v[100:103]
  ds_read_b64_tr_b16 a[92:93], v245 offset:51200
  ds_read_b64_tr_b16 a[94:95], v245 offset:55296
  v_mfma_f32_16x16x32_bf16 v[72:75], a[112:115], a[40:43], v[72:75]
  v_mfma_f32_16x16x32_bf16 v[88:91], a[112:115], a[44:47], v[88:91]
  ds_read_b64_tr_b16 a[112:113], v242 offset:59392
  ds_read_b64_tr_b16 a[114:115], v242 offset:63488
  v_mfma_f32_16x16x32_bf16 v[76:79], a[116:119], a[40:43], v[76:79]
  buffer_load_dwordx4 a[24:27], v241, s[4:7], s16 offen offset:0 sc1
  v_mfma_f32_16x16x32_bf16 v[92:95], a[116:119], a[44:47], v[92:95]
  ds_read_b64_tr_b16 a[116:117], v243 offset:59392
  ds_read_b64_tr_b16 a[118:119], v243 offset:63488
  v_mfma_f32_16x16x32_bf16 v[80:83], a[120:123], a[40:43], v[80:83]
  v_mfma_f32_16x16x32_bf16 v[96:99], a[120:123], a[44:47], v[96:99]
  ds_read_b64_tr_b16 a[120:121], v244 offset:59392
  ds_read_b64_tr_b16 a[122:123], v244 offset:63488
  v_mfma_f32_16x16x32_bf16 v[84:87], a[124:127], a[40:43], v[84:87]
  v_mfma_f32_16x16x32_bf16 v[100:103], a[124:127], a[44:47], v[100:103]
  buffer_load_dwordx4 a[28:31], v241, s[4:7], s16 offen offset:1024 sc1
  v_mfma_f32_16x16x32_bf16 v[16:19], a[64:67], a[32:35], v[16:19]
  ds_read_b64_tr_b16 a[124:125], v245 offset:59392
  s_add_u32 s41, s41, 262144
  v_mfma_f32_16x16x32_bf16 v[32:35], a[64:67], a[36:39], v[32:35]
  ds_read_b64_tr_b16 a[126:127], v245 offset:63488
  s_bitset0_b32 s41, 21
  v_mfma_f32_16x16x32_bf16 v[20:23], a[68:71], a[32:35], v[20:23]
  ds_read_b64_tr_b16 a[64:65], v242 offset:49152
  s_add_u32 s16, s40, s41
  v_mfma_f32_16x16x32_bf16 v[36:39], a[68:71], a[36:39], v[36:39]
  ds_read_b64_tr_b16 a[66:67], v242 offset:53248
  ds_read_b64_tr_b16 a[68:69], v243 offset:49152
  s_waitcnt lgkmcnt(10)
  v_mfma_f32_16x16x32_bf16 v[24:27], a[72:75], a[32:35], v[24:27]
  buffer_store_dwordx4 v[12:15], v224, s[12:15], s101 offen offset:0 sc1
  v_mfma_f32_16x16x32_bf16 v[40:43], a[72:75], a[36:39], v[40:43]
  ds_read_b64_tr_b16 a[70:71], v243 offset:53248
  ds_read_b64_tr_b16 a[72:73], v244 offset:49152
  v_mfma_f32_16x16x32_bf16 v[28:31], a[76:79], a[32:35], v[28:31]
  ds_read_b64_tr_b16 a[74:75], v244 offset:53248
  v_mfma_f32_16x16x32_bf16 v[44:47], a[76:79], a[36:39], v[44:47]
  ds_read_b64_tr_b16 a[76:77], v245 offset:49152
  ds_read_b64_tr_b16 a[78:79], v245 offset:53248
  v_mfma_f32_16x16x32_bf16 v[16:19], a[96:99], a[40:43], v[16:19]
  v_mfma_f32_16x16x32_bf16 v[32:35], a[96:99], a[44:47], v[32:35]
  buffer_store_dwordx4 v[124:127], v224, s[12:15], s101 offen offset:2048 sc1
  v_mfma_f32_16x16x32_bf16 v[20:23], a[100:103], a[40:43], v[20:23]
  ds_read_b64_tr_b16 a[96:97], v242 offset:57344
  ds_read_b64_tr_b16 a[98:99], v242 offset:61440
  v_mfma_f32_16x16x32_bf16 v[36:39], a[100:103], a[44:47], v[36:39]
  ds_read_b64_tr_b16 a[100:101], v243 offset:57344
  ds_read_b64_tr_b16 a[102:103], v243 offset:61440
  v_mfma_f32_16x16x32_bf16 v[24:27], a[104:107], a[40:43], v[24:27]
  v_mfma_f32_16x16x32_bf16 v[40:43], a[104:107], a[44:47], v[40:43]
  ds_read_b64_tr_b16 a[104:105], v244 offset:57344
  ds_read_b64_tr_b16 a[106:107], v244 offset:61440
  v_mfma_f32_16x16x32_bf16 v[28:31], a[108:111], a[40:43], v[28:31]
  v_mfma_f32_16x16x32_bf16 v[44:47], a[108:111], a[44:47], v[44:47]
  s_waitcnt vmcnt(14) lgkmcnt(10)
  s_barrier
  v_mfma_f32_16x16x32_bf16 v[72:75], a[80:83], a[48:51], v[72:75]
  ds_read_b64_tr_b16 a[108:109], v245 offset:57344
  s_add_u32 m0, s38, 0
  v_mfma_f32_16x16x32_bf16 v[88:91], a[80:83], a[52:55], v[88:91]
  buffer_load_dwordx4 v225, s[8:11], s17 offen lds
  v_mfma_f32_16x16x32_bf16 v[76:79], a[84:87], a[48:51], v[76:79]
  ds_read_b64_tr_b16 a[110:111], v245 offset:61440
  ds_read_b64_tr_b16 a[80:81], v104 offset:2048
  v_mfma_f32_16x16x32_bf16 v[92:95], a[84:87], a[52:55], v[92:95]
  ds_read_b64_tr_b16 a[82:83], v104 offset:6144
  ds_read_b64_tr_b16 a[84:85], v105 offset:2048
  v_mfma_f32_16x16x32_bf16 v[80:83], a[88:91], a[48:51], v[80:83]
  buffer_load_dwordx4 a[32:35], v240, s[4:7], s16 offen offset:0 sc1
  v_mfma_f32_16x16x32_bf16 v[96:99], a[88:91], a[52:55], v[96:99]
  ds_read_b64_tr_b16 a[86:87], v105 offset:6144
  ds_read_b64_tr_b16 a[88:89], v106 offset:2048
  v_mfma_f32_16x16x32_bf16 v[84:87], a[92:95], a[48:51], v[84:87]
  ds_read_b64_tr_b16 a[90:91], v106 offset:6144
  v_mfma_f32_16x16x32_bf16 v[100:103], a[92:95], a[52:55], v[100:103]
  ds_read_b64_tr_b16 a[92:93], v107 offset:2048
  ds_read_b64_tr_b16 a[94:95], v107 offset:6144
  v_mfma_f32_16x16x32_bf16 v[72:75], a[112:115], a[56:59], v[72:75]
  buffer_load_dwordx4 v226, s[8:11], s17 offen offset:1024 lds
  v_mfma_f32_16x16x32_bf16 v[88:91], a[112:115], a[60:63], v[88:91]
  ds_read_b64_tr_b16 a[112:113], v104 offset:10240
  ds_read_b64_tr_b16 a[114:115], v104 offset:14336
  v_mfma_f32_16x16x32_bf16 v[76:79], a[116:119], a[56:59], v[76:79]
  v_mfma_f32_16x16x32_bf16 v[92:95], a[116:119], a[60:63], v[92:95]
  ds_read_b64_tr_b16 a[116:117], v105 offset:10240
  ds_read_b64_tr_b16 a[118:119], v105 offset:14336
  v_mfma_f32_16x16x32_bf16 v[80:83], a[120:123], a[56:59], v[80:83]
  buffer_load_dwordx4 a[36:39], v240, s[4:7], s16 offen offset:1024 sc1
  v_mfma_f32_16x16x32_bf16 v[96:99], a[120:123], a[60:63], v[96:99]
  ds_read_b64_tr_b16 a[120:121], v106 offset:10240
  ds_read_b64_tr_b16 a[122:123], v106 offset:14336
  v_mfma_f32_16x16x32_bf16 v[84:87], a[124:127], a[56:59], v[84:87]
  v_mfma_f32_16x16x32_bf16 v[100:103], a[124:127], a[60:63], v[100:103]
  buffer_load_dword v247, v246, s[56:59], s94 offen sc1
  v_mfma_f32_16x16x32_bf16 v[16:19], a[64:67], a[48:51], v[16:19]
  buffer_load_dwordx4 v227, s[8:11], s17 offen offset:2048 lds
  v_mfma_f32_16x16x32_bf16 v[32:35], a[64:67], a[52:55], v[32:35]
  ds_read_b64_tr_b16 a[124:125], v107 offset:10240
  ds_read_b64_tr_b16 a[126:127], v107 offset:14336
  v_mfma_f32_16x16x32_bf16 v[20:23], a[68:71], a[48:51], v[20:23]
  ds_read_b64_tr_b16 a[64:65], v104 offset:0
  ds_read_b64_tr_b16 a[66:67], v104 offset:4096
  v_mfma_f32_16x16x32_bf16 v[36:39], a[68:71], a[52:55], v[36:39]
  ds_read_b64_tr_b16 a[68:69], v105 offset:0
  ds_read_b64_tr_b16 a[70:71], v105 offset:4096
  s_waitcnt lgkmcnt(10)
  v_mfma_f32_16x16x32_bf16 v[24:27], a[72:75], a[48:51], v[24:27]
  buffer_load_dwordx4 a[40:43], v241, s[4:7], s16 offen offset:0 sc1
  v_mfma_f32_16x16x32_bf16 v[40:43], a[72:75], a[52:55], v[40:43]
  ds_read_b64_tr_b16 a[72:73], v106 offset:0
  ds_read_b64_tr_b16 a[74:75], v106 offset:4096
  v_mfma_f32_16x16x32_bf16 v[28:31], a[76:79], a[48:51], v[28:31]
  v_mfma_f32_16x16x32_bf16 v[44:47], a[76:79], a[52:55], v[44:47]
  buffer_load_dwordx4 v228, s[8:11], s17 offen offset:3072 lds
  v_mfma_f32_16x16x32_bf16 v[16:19], a[96:99], a[56:59], v[16:19]
  ds_read_b64_tr_b16 a[76:77], v107 offset:0
  s_add_u32 s17, s17, 458752
  v_mfma_f32_16x16x32_bf16 v[32:35], a[96:99], a[60:63], v[32:35]
  ds_read_b64_tr_b16 a[78:79], v107 offset:4096
  s_cmp_eq_u32 s17, s93
  v_mfma_f32_16x16x32_bf16 v[20:23], a[100:103], a[56:59], v[20:23]
  ds_read_b64_tr_b16 a[96:97], v104 offset:8192
  s_cselect_b32 s17, s95, s17
  v_mfma_f32_16x16x32_bf16 v[36:39], a[100:103], a[60:63], v[36:39]
  buffer_load_dwordx4 a[44:47], v241, s[4:7], s16 offen offset:1024 sc1
  v_mfma_f32_16x16x32_bf16 v[24:27], a[104:107], a[56:59], v[24:27]
  ds_read_b64_tr_b16 a[98:99], v104 offset:12288
  s_add_u32 s41, s41, 262144
  v_mfma_f32_16x16x32_bf16 v[40:43], a[104:107], a[60:63], v[40:43]
  ds_read_b64_tr_b16 a[100:101], v105 offset:8192
  s_bitset0_b32 s41, 21
  v_mfma_f32_16x16x32_bf16 v[28:31], a[108:111], a[56:59], v[28:31]
  ds_read_b64_tr_b16 a[102:103], v105 offset:12288
  s_add_u32 s16, s40, s41
  v_mfma_f32_16x16x32_bf16 v[44:47], a[108:111], a[60:63], v[44:47]
  s_waitcnt vmcnt(17) lgkmcnt(10)
  s_barrier
  v_mfma_f32_16x16x32_bf16 v[72:75], a[80:83], a[0:3], v[72:75]
  ds_read_b64_tr_b16 a[104:105], v106 offset:8192
  ds_read_b64_tr_b16 a[106:107], v106 offset:12288
  s_add_u32 m0, s38, 16384
  v_mfma_f32_16x16x32_bf16 v[88:91], a[80:83], a[4:7], v[88:91]
  buffer_load_dwordx4 v225, s[8:11], s17 offen lds
  v_mfma_f32_16x16x32_bf16 v[76:79], a[84:87], a[0:3], v[76:79]
  ds_read_b64_tr_b16 a[108:109], v107 offset:8192
  ds_read_b64_tr_b16 a[110:111], v107 offset:12288
  v_add_u32 v124, 131072, v242
  v_mfma_f32_16x16x32_bf16 v[92:95], a[84:87], a[4:7], v[92:95]
  ds_read_b64_tr_b16 a[80:81], v104 offset:18432
  ds_read_b64_tr_b16 a[82:83], v104 offset:22528
  v_mfma_f32_16x16x32_bf16 v[80:83], a[88:91], a[0:3], v[80:83]
  buffer_load_dwordx4 a[48:51], v240, s[4:7], s16 offen offset:0 sc1
  v_mfma_f32_16x16x32_bf16 v[96:99], a[88:91], a[4:7], v[96:99]
  ds_read_b64_tr_b16 a[84:85], v105 offset:18432
  ds_read_b64_tr_b16 a[86:87], v105 offset:22528
  v_mfma_f32_16x16x32_bf16 v[84:87], a[92:95], a[0:3], v[84:87]
  ds_read_b64_tr_b16 a[88:89], v106 offset:18432
  v_add_u32 v125, 131072, v243
  v_mfma_f32_16x16x32_bf16 v[100:103], a[92:95], a[4:7], v[100:103]
  ds_read_b64_tr_b16 a[90:91], v106 offset:22528
  ds_read_b64_tr_b16 a[92:93], v107 offset:18432
  v_mfma_f32_16x16x32_bf16 v[72:75], a[112:115], a[8:11], v[72:75]
  buffer_load_dwordx4 v226, s[8:11], s17 offen offset:1024 lds
  v_mfma_f32_16x16x32_bf16 v[88:91], a[112:115], a[12:15], v[88:91]
  ds_read_b64_tr_b16 a[94:95], v107 offset:22528
  ds_read_b64_tr_b16 a[112:113], v104 offset:26624
  v_mfma_f32_16x16x32_bf16 v[76:79], a[116:119], a[8:11], v[76:79]
  ds_read_b64_tr_b16 a[114:115], v104 offset:30720
  v_add_u32 v126, 131072, v244
  v_mfma_f32_16x16x32_bf16 v[92:95], a[116:119], a[12:15], v[92:95]
  ds_read_b64_tr_b16 a[116:117], v105 offset:26624
  ds_read_b64_tr_b16 a[118:119], v105 offset:30720
  v_mfma_f32_16x16x32_bf16 v[80:83], a[120:123], a[8:11], v[80:83]
  buffer_load_dwordx4 a[52:55], v240, s[4:7], s16 offen offset:1024 sc1
  v_mfma_f32_16x16x32_bf16 v[96:99], a[120:123], a[12:15], v[96:99]
  ds_read_b64_tr_b16 a[120:121], v106 offset:26624
  ds_read_b64_tr_b16 a[122:123], v106 offset:30720
  v_mfma_f32_16x16x32_bf16 v[84:87], a[124:127], a[8:11], v[84:87]
  v_add_u32 v127, 131072, v245
  v_mfma_f32_16x16x32_bf16 v[100:103], a[124:127], a[12:15], v[100:103]
  ds_read_b64_tr_b16 a[124:125], v107 offset:26624
  ds_read_b64_tr_b16 a[126:127], v107 offset:30720
  v_mfma_f32_16x16x32_bf16 v[16:19], a[64:67], a[0:3], v[16:19]
  buffer_load_dwordx4 v227, s[8:11], s17 offen offset:2048 lds
  v_mfma_f32_16x16x32_bf16 v[32:35], a[64:67], a[4:7], v[32:35]
  ds_read_b64_tr_b16 a[64:65], v104 offset:16384
  ds_read_b64_tr_b16 a[66:67], v104 offset:20480
  s_waitcnt lgkmcnt(10)
  v_mfma_f32_16x16x32_bf16 v[20:23], a[68:71], a[0:3], v[20:23]
  v_mfma_f32_16x16x32_bf16 v[36:39], a[68:71], a[4:7], v[36:39]
  ds_read_b64_tr_b16 a[68:69], v105 offset:16384
  ds_read_b64_tr_b16 a[70:71], v105 offset:20480
  v_mfma_f32_16x16x32_bf16 v[24:27], a[72:75], a[0:3], v[24:27]
  buffer_load_dwordx4 a[56:59], v241, s[4:7], s16 offen offset:0 sc1
  v_mfma_f32_16x16x32_bf16 v[40:43], a[72:75], a[4:7], v[40:43]
  ds_read_b64_tr_b16 a[72:73], v106 offset:16384
  ds_read_b64_tr_b16 a[74:75], v106 offset:20480
  v_mfma_f32_16x16x32_bf16 v[28:31], a[76:79], a[0:3], v[28:31]
  buffer_load_dwordx4 v228, s[8:11], s17 offen offset:3072 lds
  v_mfma_f32_16x16x32_bf16 v[44:47], a[76:79], a[4:7], v[44:47]
  ds_read_b64_tr_b16 a[76:77], v107 offset:16384
  s_add_u32 s17, s17, 458752
  v_mfma_f32_16x16x32_bf16 v[16:19], a[96:99], a[8:11], v[16:19]
  ds_read_b64_tr_b16 a[78:79], v107 offset:20480
  s_cmp_eq_u32 s17, s93
  v_mfma_f32_16x16x32_bf16 v[32:35], a[96:99], a[12:15], v[32:35]
  ds_read_b64_tr_b16 a[96:97], v104 offset:24576
  s_cselect_b32 s17, s95, s17
  v_mfma_f32_16x16x32_bf16 v[20:23], a[100:103], a[8:11], v[20:23]
  buffer_load_dwordx4 a[60:63], v241, s[4:7], s16 offen offset:1024 sc1
  v_mfma_f32_16x16x32_bf16 v[36:39], a[100:103], a[12:15], v[36:39]
  ds_read_b64_tr_b16 a[98:99], v104 offset:28672
  s_add_u32 s41, s41, 262144
  v_mfma_f32_16x16x32_bf16 v[24:27], a[104:107], a[8:11], v[24:27]
  ds_read_b64_tr_b16 a[100:101], v105 offset:24576
  s_bitset0_b32 s41, 21
  v_mfma_f32_16x16x32_bf16 v[40:43], a[104:107], a[12:15], v[40:43]
  ds_read_b64_tr_b16 a[102:103], v105 offset:28672
  s_add_u32 s40, s40, 2097152
  v_mfma_f32_16x16x32_bf16 v[28:31], a[108:111], a[8:11], v[28:31]
  ds_read_b64_tr_b16 a[104:105], v106 offset:24576
  s_add_u32 s16, s40, s41
  v_mfma_f32_16x16x32_bf16 v[44:47], a[108:111], a[12:15], v[44:47]
  s_waitcnt vmcnt(12) lgkmcnt(10)
  s_barrier
  v_cmp_ne_u32 vcc, s19, v247
  s_nop 1
  s_cmp_lg_u64 vcc, 0
  s_cbranch_scc1 L_slow_27
  L_back_28:
  s_add_u32 s94, s94, 65536
  v_mfma_f32_16x16x32_bf16 v[72:75], a[80:83], a[16:19], v[72:75]
  ds_read_b64_tr_b16 a[106:107], v106 offset:28672
  buffer_load_dwordx4 a[0:3], v240, s[4:7], s16 offen offset:0 sc1
  v_mfma_f32_16x16x32_bf16 v[88:91], a[80:83], a[20:23], v[88:91]
  ds_read_b64_tr_b16 a[108:109], v107 offset:24576
  ds_read_b64_tr_b16 a[110:111], v107 offset:28672
  v_mfma_f32_16x16x32_bf16 v[76:79], a[84:87], a[16:19], v[76:79]
  ds_read_b64_tr_b16 a[80:81], v104 offset:34816
  ds_read_b64_tr_b16 a[82:83], v104 offset:38912
  v_mfma_f32_16x16x32_bf16 v[92:95], a[84:87], a[20:23], v[92:95]
  ds_read_b64_tr_b16 a[84:85], v105 offset:34816
  ds_read_b64_tr_b16 a[86:87], v105 offset:38912
  v_mfma_f32_16x16x32_bf16 v[80:83], a[88:91], a[16:19], v[80:83]
  v_mfma_f32_16x16x32_bf16 v[96:99], a[88:91], a[20:23], v[96:99]
  ds_read_b64_tr_b16 a[88:89], v106 offset:34816
  ds_read_b64_tr_b16 a[90:91], v106 offset:38912
  v_mfma_f32_16x16x32_bf16 v[84:87], a[92:95], a[16:19], v[84:87]
  v_mfma_f32_16x16x32_bf16 v[100:103], a[92:95], a[20:23], v[100:103]
  buffer_load_dwordx4 a[4:7], v240, s[4:7], s16 offen offset:1024 sc1
  v_mfma_f32_16x16x32_bf16 v[72:75], a[112:115], a[24:27], v[72:75]
  ds_read_b64_tr_b16 a[92:93], v107 offset:34816
  ds_read_b64_tr_b16 a[94:95], v107 offset:38912
  v_mfma_f32_16x16x32_bf16 v[88:91], a[112:115], a[28:31], v[88:91]
  ds_read_b64_tr_b16 a[112:113], v104 offset:43008
  ds_read_b64_tr_b16 a[114:115], v104 offset:47104
  v_mfma_f32_16x16x32_bf16 v[76:79], a[116:119], a[24:27], v[76:79]
  v_mfma_f32_16x16x32_bf16 v[92:95], a[116:119], a[28:31], v[92:95]
  ds_read_b64_tr_b16 a[116:117], v105 offset:43008
  ds_read_b64_tr_b16 a[118:119], v105 offset:47104
  v_mfma_f32_16x16x32_bf16 v[80:83], a[120:123], a[24:27], v[80:83]
  v_mfma_f32_16x16x32_bf16 v[96:99], a[120:123], a[28:31], v[96:99]
  ds_read_b64_tr_b16 a[120:121], v106 offset:43008
  ds_read_b64_tr_b16 a[122:123], v106 offset:47104
  v_mfma_f32_16x16x32_bf16 v[84:87], a[124:127], a[24:27], v[84:87]
  v_mfma_f32_16x16x32_bf16 v[100:103], a[124:127], a[28:31], v[100:103]
  buffer_load_dwordx4 a[8:11], v241, s[4:7], s16 offen offset:0 sc1
  v_mfma_f32_16x16x32_bf16 v[16:19], a[64:67], a[16:19], v[16:19]
  ds_read_b64_tr_b16 a[124:125], v107 offset:43008
  ds_read_b64_tr_b16 a[126:127], v107 offset:47104
  v_mfma_f32_16x16x32_bf16 v[32:35], a[64:67], a[20:23], v[32:35]
  ds_read_b64_tr_b16 a[64:65], v104 offset:32768
  ds_read_b64_tr_b16 a[66:67], v104 offset:36864
  s_waitcnt lgkmcnt(10)
  v_mfma_f32_16x16x32_bf16 v[20:23], a[68:71], a[16:19], v[20:23]
  v_mfma_f32_16x16x32_bf16 v[36:39], a[68:71], a[20:23], v[36:39]
  ds_read_b64_tr_b16 a[68:69], v105 offset:32768
  ds_read_b64_tr_b16 a[70:71], v105 offset:36864
  v_mfma_f32_16x16x32_bf16 v[24:27], a[72:75], a[16:19], v[24:27]
  v_mfma_f32_16x16x32_bf16 v[40:43], a[72:75], a[20:23], v[40:43]
  ds_read_b64_tr_b16 a[72:73], v106 offset:32768
  ds_read_b64_tr_b16 a[74:75], v106 offset:36864
  v_mfma_f32_16x16x32_bf16 v[28:31], a[76:79], a[16:19], v[28:31]
  v_mfma_f32_16x16x32_bf16 v[44:47], a[76:79], a[20:23], v[44:47]
  buffer_load_dwordx4 a[12:15], v241, s[4:7], s16 offen offset:1024 sc1
  v_mfma_f32_16x16x32_bf16 v[16:19], a[96:99], a[24:27], v[16:19]
  ds_read_b64_tr_b16 a[76:77], v107 offset:32768
  s_add_u32 s41, s41, 262144
  v_mfma_f32_16x16x32_bf16 v[32:35], a[96:99], a[28:31], v[32:35]
  ds_read_b64_tr_b16 a[78:79], v107 offset:36864
  s_bitset0_b32 s41, 21
  v_mfma_f32_16x16x32_bf16 v[20:23], a[100:103], a[24:27], v[20:23]
  ds_read_b64_tr_b16 a[96:97], v104 offset:40960
  s_add_u32 s16, s40, s41
  v_mfma_f32_16x16x32_bf16 v[36:39], a[100:103], a[28:31], v[36:39]
  ds_read_b64_tr_b16 a[98:99], v104 offset:45056
  ds_read_b64_tr_b16 a[100:101], v105 offset:40960
  v_mfma_f32_16x16x32_bf16 v[24:27], a[104:107], a[24:27], v[24:27]
  ds_read_b64_tr_b16 a[102:103], v105 offset:45056
  v_mfma_f32_16x16x32_bf16 v[40:43], a[104:107], a[28:31], v[40:43]
  ds_read_b64_tr_b16 a[104:105], v106 offset:40960
  ds_read_b64_tr_b16 a[106:107], v106 offset:45056
  v_mfma_f32_16x16x32_bf16 v[28:31], a[108:111], a[24:27], v[28:31]
  v_mfma_f32_16x16x32_bf16 v[44:47], a[108:111], a[28:31], v[44:47]
  s_waitcnt vmcnt(12) lgkmcnt(10)
  s_barrier
  s_mov_b64 exec, 1
  buffer_store_dword v248, v250, s[56:59], s92 offen sc1
  s_mov_b64 exec, -1
  s_add_u32 s92, s92, 65536
  v_mfma_f32_16x16x32_bf16 v[72:75], a[80:83], a[32:35], v[72:75]
  ds_read_b64_tr_b16 a[108:109], v107 offset:40960
  s_add_u32 m0, s38, 32768
  v_mfma_f32_16x16x32_bf16 v[88:91], a[80:83], a[36:39], v[88:91]
  buffer_load_dwordx4 v225, s[8:11], s17 offen lds
  v_mfma_f32_16x16x32_bf16 v[76:79], a[84:87], a[32:35], v[76:79]
  ds_read_b64_tr_b16 a[110:111], v107 offset:45056
  ds_read_b64_tr_b16 a[80:81], v104 offset:51200
  v_mfma_f32_16x16x32_bf16 v[92:95], a[84:87], a[36:39], v[92:95]
  ds_read_b64_tr_b16 a[82:83], v104 offset:55296
  ds_read_b64_tr_b16 a[84:85], v105 offset:51200
  v_mfma_f32_16x16x32_bf16 v[80:83], a[88:91], a[32:35], v[80:83]
  buffer_load_dwordx4 a[16:19], v240, s[4:7], s16 offen offset:0 sc1
  v_mfma_f32_16x16x32_bf16 v[96:99], a[88:91], a[36:39], v[96:99]
  ds_read_b64_tr_b16 a[86:87], v105 offset:55296
  ds_read_b64_tr_b16 a[88:89], v106 offset:51200
  v_mfma_f32_16x16x32_bf16 v[84:87], a[92:95], a[32:35], v[84:87]
  ds_read_b64_tr_b16 a[90:91], v106 offset:55296
  v_mfma_f32_16x16x32_bf16 v[100:103], a[92:95], a[36:39], v[100:103]
  ds_read_b64_tr_b16 a[92:93], v107 offset:51200
  ds_read_b64_tr_b16 a[94:95], v107 offset:55296
  v_mfma_f32_16x16x32_bf16 v[72:75], a[112:115], a[40:43], v[72:75]
  buffer_load_dwordx4 v226, s[8:11], s17 offen offset:1024 lds
  v_mfma_f32_16x16x32_bf16 v[88:91], a[112:115], a[44:47], v[88:91]
  ds_read_b64_tr_b16 a[112:113], v104 offset:59392
  ds_read_b64_tr_b16 a[114:115], v104 offset:63488
  v_mfma_f32_16x16x32_bf16 v[76:79], a[116:119], a[40:43], v[76:79]
  v_mfma_f32_16x16x32_bf16 v[92:95], a[116:119], a[44:47], v[92:95]
  ds_read_b64_tr_b16 a[116:117], v105 offset:59392
  ds_read_b64_tr_b16 a[118:119], v105 offset:63488
  v_mfma_f32_16x16x32_bf16 v[80:83], a[120:123], a[40:43], v[80:83]
  buffer_load_dwordx4 a[20:23], v240, s[4:7], s16 offen offset:1024 sc1
  v_mfma_f32_16x16x32_bf16 v[96:99], a[120:123], a[44:47], v[96:99]
  ds_read_b64_tr_b16 a[120:121], v106 offset:59392
  ds_read_b64_tr_b16 a[122:123], v106 offset:63488
  v_mfma_f32_16x16x32_bf16 v[84:87], a[124:127], a[40:43], v[84:87]
  v_mfma_f32_16x16x32_bf16 v[100:103], a[124:127], a[44:47], v[100:103]
  ds_read_b64_tr_b16 a[124:125], v107 offset:59392
  ds_read_b64_tr_b16 a[126:127], v107 offset:63488
  v_mfma_f32_16x16x32_bf16 v[16:19], a[64:67], a[32:35], v[16:19]
  buffer_load_dwordx4 v227, s[8:11], s17 offen offset:2048 lds
  v_mfma_f32_16x16x32_bf16 v[32:35], a[64:67], a[36:39], v[32:35]
  ds_read_b64_tr_b16 a[64:65], v104 offset:49152
  ds_read_b64_tr_b16 a[66:67], v104 offset:53248
  v_mfma_f32_16x16x32_bf16 v[20:23], a[68:71], a[32:35], v[20:23]
  v_mfma_f32_16x16x32_bf16 v[36:39], a[68:71], a[36:39], v[36:39]
  ds_read_b64_tr_b16 a[68:69], v105 offset:49152
  ds_read_b64_tr_b16 a[70:71], v105 offset:53248
  s_waitcnt lgkmcnt(10)
  v_mfma_f32_16x16x32_bf16 v[24:27], a[72:75], a[32:35], v[24:27]
  buffer_load_dwordx4 a[24:27], v241, s[4:7], s16 offen offset:0 sc1
  v_mfma_f32_16x16x32_bf16 v[40:43], a[72:75], a[36:39], v[40:43]
  ds_read_b64_tr_b16 a[72:73], v106 offset:49152
  ds_read_b64_tr_b16 a[74:75], v106 offset:53248
  v_mfma_f32_16x16x32_bf16 v[28:31], a[76:79], a[32:35], v[28:31]
  v_mfma_f32_16x16x32_bf16 v[44:47], a[76:79], a[36:39], v[44:47]
  buffer_load_dwordx4 v228, s[8:11], s17 offen offset:3072 lds
  v_mfma_f32_16x16x32_bf16 v[16:19], a[96:99], a[40:43], v[16:19]
  ds_read_b64_tr_b16 a[76:77], v107 offset:49152
  s_add_u32 s17, s17, 458752
  v_mfma_f32_16x16x32_bf16 v[32:35], a[96:99], a[44:47], v[32:35]
  ds_read_b64_tr_b16 a[78:79], v107 offset:53248
  s_cmp_eq_u32 s17, s93
  v_mfma_f32_16x16x32_bf16 v[20:23], a[100:103], a[40:43], v[20:23]
  ds_read_b64_tr_b16 a[96:97], v104 offset:57344
  s_cselect_b32 s17, s95, s17
  v_mfma_f32_16x16x32_bf16 v[36:39], a[100:103], a[44:47], v[36:39]
  buffer_load_dwordx4 a[28:31], v241, s[4:7], s16 offen offset:1024 sc1
  v_mfma_f32_16x16x32_bf16 v[24:27], a[104:107], a[40:43], v[24:27]
  ds_read_b64_tr_b16 a[98:99], v104 offset:61440
  s_add_u32 s41, s41, 262144
  v_mfma_f32_16x16x32_bf16 v[40:43], a[104:107], a[44:47], v[40:43]
  ds_read_b64_tr_b16 a[100:101], v105 offset:57344
  s_bitset0_b32 s41, 21
  v_mfma_f32_16x16x32_bf16 v[28:31], a[108:111], a[40:43], v[28:31]
  ds_read_b64_tr_b16 a[102:103], v105 offset:61440
  s_add_u32 s16, s40, s41
  v_mfma_f32_16x16x32_bf16 v[44:47], a[108:111], a[44:47], v[44:47]
  s_waitcnt vmcnt(13) lgkmcnt(10)
  s_barrier
  v_mfma_f32_16x16x32_bf16 v[72:75], a[80:83], a[48:51], v[72:75]
  ds_read_b64_tr_b16 a[104:105], v106 offset:57344
  ds_read_b64_tr_b16 a[106:107], v106 offset:61440
  s_add_u32 m0, s38, 49152
  v_mfma_f32_16x16x32_bf16 v[88:91], a[80:83], a[52:55], v[88:91]
  buffer_load_dwordx4 v225, s[8:11], s17 offen lds
  v_mfma_f32_16x16x32_bf16 v[76:79], a[84:87], a[48:51], v[76:79]
  ds_read_b64_tr_b16 a[108:109], v107 offset:57344
  ds_read_b64_tr_b16 a[110:111], v107 offset:61440
  v_mfma_f32_16x16x32_bf16 v[92:95], a[84:87], a[52:55], v[92:95]
  ds_read_b64_tr_b16 a[80:81], v124 offset:2048
  ds_read_b64_tr_b16 a[82:83], v124 offset:6144
  v_mfma_f32_16x16x32_bf16 v[80:83], a[88:91], a[48:51], v[80:83]
  buffer_load_dwordx4 a[32:35], v240, s[4:7], s16 offen offset:0 sc1
  v_mfma_f32_16x16x32_bf16 v[96:99], a[88:91], a[52:55], v[96:99]
  ds_read_b64_tr_b16 a[84:85], v125 offset:2048
  ds_read_b64_tr_b16 a[86:87], v125 offset:6144
  v_mfma_f32_16x16x32_bf16 v[84:87], a[92:95], a[48:51], v[84:87]
  ds_read_b64_tr_b16 a[88:89], v126 offset:2048
  ds_read_b64_tr_b16 a[90:91], v126 offset:6144
  v_mfma_f32_16x16x32_bf16 v[100:103], a[92:95], a[52:55], v[100:103]
  ds_read_b64_tr_b16 a[92:93], v127 offset:2048
  ds_read_b64_tr_b16 a[94:95], v127 offset:6144
  v_mfma_f32_16x16x32_bf16 v[72:75], a[112:115], a[56:59], v[72:75]
  buffer_load_dwordx4 v226, s[8:11], s17 offen offset:1024 lds
  v_mfma_f32_16x16x32_bf16 v[88:91], a[112:115], a[60:63], v[88:91]
  ds_read_b64_tr_b16 a[112:113], v124 offset:10240
  ds_read_b64_tr_b16 a[114:115], v124 offset:14336
  v_mfma_f32_16x16x32_bf16 v[76:79], a[116:119], a[56:59], v[76:79]
  v_mfma_f32_16x16x32_bf16 v[92:95], a[116:119], a[60:63], v[92:95]
  ds_read_b64_tr_b16 a[116:117], v125 offset:10240
  ds_read_b64_tr_b16 a[118:119], v125 offset:14336
  v_mfma_f32_16x16x32_bf16 v[80:83], a[120:123], a[56:59], v[80:83]
  buffer_load_dwordx4 a[36:39], v240, s[4:7], s16 offen offset:1024 sc1
  v_mfma_f32_16x16x32_bf16 v[96:99], a[120:123], a[60:63], v[96:99]
  ds_read_b64_tr_b16 a[120:121], v126 offset:10240
  ds_read_b64_tr_b16 a[122:123], v126 offset:14336
  v_mfma_f32_16x16x32_bf16 v[84:87], a[124:127], a[56:59], v[84:87]
  v_mfma_f32_16x16x32_bf16 v[100:103], a[124:127], a[60:63], v[100:103]
  ds_read_b64_tr_b16 a[124:125], v127 offset:10240
  ds_read_b64_tr_b16 a[126:127], v127 offset:14336
  v_mfma_f32_16x16x32_bf16 v[16:19], a[64:67], a[48:51], v[16:19]
  buffer_load_dwordx4 v227, s[8:11], s17 offen offset:2048 lds
  v_mfma_f32_16x16x32_bf16 v[32:35], a[64:67], a[52:55], v[32:35]
  ds_read_b64_tr_b16 a[64:65], v124 offset:0
  ds_read_b64_tr_b16 a[66:67], v124 offset:4096
  s_waitcnt lgkmcnt(10)
  v_mfma_f32_16x16x32_bf16 v[20:23], a[68:71], a[48:51], v[20:23]
  v_mfma_f32_16x16x32_bf16 v[36:39], a[68:71], a[52:55], v[36:39]
  ds_read_b64_tr_b16 a[68:69], v125 offset:0
  ds_read_b64_tr_b16 a[70:71], v125 offset:4096
  v_mfma_f32_16x16x32_bf16 v[24:27], a[72:75], a[48:51], v[24:27]
  buffer_load_dwordx4 a[40:43], v241, s[4:7], s16 offen offset:0 sc1
  v_mfma_f32_16x16x32_bf16 v[40:43], a[72:75], a[52:55], v[40:43]
  ds_read_b64_tr_b16 a[72:73], v126 offset:0
  ds_read_b64_tr_b16 a[74:75], v126 offset:4096
  v_mfma_f32_16x16x32_bf16 v[28:31], a[76:79], a[48:51], v[28:31]
  v_mfma_f32_16x16x32_bf16 v[44:47], a[76:79], a[52:55], v[44:47]
  buffer_load_dwordx4 v228, s[8:11], s17 offen offset:3072 lds
  v_mfma_f32_16x16x32_bf16 v[16:19], a[96:99], a[56:59], v[16:19]
  ds_read_b64_tr_b16 a[76:77], v127 offset:0
  s_add_u32 s17, s17, 458752
  v_mfma_f32_16x16x32_bf16 v[32:35], a[96:99], a[60:63], v[32:35]
  ds_read_b64_tr_b16 a[78:79], v127 offset:4096
  s_cmp_eq_u32 s17, s93
  v_mfma_f32_16x16x32_bf16 v[20:23], a[100:103], a[56:59], v[20:23]
  ds_read_b64_tr_b16 a[96:97], v124 offset:8192
  s_cselect_b32 s17, s95, s17
  v_mfma_f32_16x16x32_bf16 v[36:39], a[100:103], a[60:63], v[36:39]
  buffer_load_dwordx4 a[44:47], v241, s[4:7], s16 offen offset:1024 sc1
  v_mfma_f32_16x16x32_bf16 v[24:27], a[104:107], a[56:59], v[24:27]
  ds_read_b64_tr_b16 a[98:99], v124 offset:12288
  s_add_u32 s41, s41, 262144
  v_mfma_f32_16x16x32_bf16 v[40:43], a[104:107], a[60:63], v[40:43]
  ds_read_b64_tr_b16 a[100:101], v125 offset:8192
  s_bitset0_b32 s41, 21
  v_mfma_f32_16x16x32_bf16 v[28:31], a[108:111], a[56:59], v[28:31]
  ds_read_b64_tr_b16 a[102:103], v125 offset:12288
  s_add_u32 s16, s40, s41
  v_mfma_f32_16x16x32_bf16 v[44:47], a[108:111], a[60:63], v[44:47]
  s_waitcnt vmcnt(17) lgkmcnt(10)
  s_barrier
  v_mfma_f32_16x16x32_bf16 v[72:75], a[80:83], a[0:3], v[72:75]
  ds_read_b64_tr_b16 a[104:105], v126 offset:8192
  ds_read_b64_tr_b16 a[106:107], v126 offset:12288
  s_add_u32 m0, s38, 65536
  v_mfma_f32_16x16x32_bf16 v[88:91], a[80:83], a[4:7], v[88:91]
  buffer_load_dwordx4 v225, s[8:11], s17 offen lds
  v_mfma_f32_16x16x32_bf16 v[76:79], a[84:87], a[0:3], v[76:79]
  ds_read_b64_tr_b16 a[108:109], v127 offset:8192
  ds_read_b64_tr_b16 a[110:111], v127 offset:12288
  v_mfma_f32_16x16x32_bf16 v[92:95], a[84:87], a[4:7], v[92:95]
  ds_read_b64_tr_b16 a[80:81], v242 offset:2048
  ds_read_b64_tr_b16 a[82:83], v242 offset:6144
  v_mfma_f32_16x16x32_bf16 v[80:83], a[88:91], a[0:3], v[80:83]
  buffer_load_dwordx4 a[48:51], v240, s[4:7], s16 offen offset:0 sc1
  v_mfma_f32_16x16x32_bf16 v[96:99], a[88:91], a[4:7], v[96:99]
  ds_read_b64_tr_b16 a[84:85], v243 offset:2048
  ds_read_b64_tr_b16 a[86:87], v243 offset:6144
  v_mfma_f32_16x16x32_bf16 v[84:87], a[92:95], a[0:3], v[84:87]
  ds_read_b64_tr_b16 a[88:89], v244 offset:2048
  ds_read_b64_tr_b16 a[90:91], v244 offset:6144
  v_mfma_f32_16x16x32_bf16 v[100:103], a[92:95], a[4:7], v[100:103]
  ds_read_b64_tr_b16 a[92:93], v245 offset:2048
  ds_read_b64_tr_b16 a[94:95], v245 offset:6144
  v_mfma_f32_16x16x32_bf16 v[72:75], a[112:115], a[8:11], v[72:75]
  buffer_load_dwordx4 v226, s[8:11], s17 offen offset:1024 lds
  v_mfma_f32_16x16x32_bf16 v[88:91], a[112:115], a[12:15], v[88:91]
  ds_read_b64_tr_b16 a[112:113], v242 offset:10240
  ds_read_b64_tr_b16 a[114:115], v242 offset:14336
  v_mfma_f32_16x16x32_bf16 v[76:79], a[116:119], a[8:11], v[76:79]
  v_mfma_f32_16x16x32_bf16 v[92:95], a[116:119], a[12:15], v[92:95]
  ds_read_b64_tr_b16 a[116:117], v243 offset:10240
  ds_read_b64_tr_b16 a[118:119], v243 offset:14336
  v_mfma_f32_16x16x32_bf16 v[80:83], a[120:123], a[8:11], v[80:83]
  buffer_load_dwordx4 a[52:55], v240, s[4:7], s16 offen offset:1024 sc1
  v_mfma_f32_16x16x32_bf16 v[96:99], a[120:123], a[12:15], v[96:99]
  ds_read_b64_tr_b16 a[120:121], v244 offset:10240
  ds_read_b64_tr_b16 a[122:123], v244 offset:14336
  v_mfma_f32_16x16x32_bf16 v[84:87], a[124:127], a[8:11], v[84:87]
  v_mfma_f32_16x16x32_bf16 v[100:103], a[124:127], a[12:15], v[100:103]
  ds_read_b64_tr_b16 a[124:125], v245 offset:10240
  ds_read_b64_tr_b16 a[126:127], v245 offset:14336
  v_mfma_f32_16x16x32_bf16 v[16:19], a[64:67], a[0:3], v[16:19]
  buffer_load_dwordx4 v227, s[8:11], s17 offen offset:2048 lds
  v_mfma_f32_16x16x32_bf16 v[32:35], a[64:67], a[4:7], v[32:35]
  ds_read_b64_tr_b16 a[64:65], v242 offset:0
  ds_read_b64_tr_b16 a[66:67], v242 offset:4096
  s_waitcnt lgkmcnt(10)
  v_mfma_f32_16x16x32_bf16 v[20:23], a[68:71], a[0:3], v[20:23]
  v_mfma_f32_16x16x32_bf16 v[36:39], a[68:71], a[4:7], v[36:39]
  ds_read_b64_tr_b16 a[68:69], v243 offset:0
  ds_read_b64_tr_b16 a[70:71], v243 offset:4096
  v_mfma_f32_16x16x32_bf16 v[24:27], a[72:75], a[0:3], v[24:27]
  buffer_load_dwordx4 a[56:59], v241, s[4:7], s16 offen offset:0 sc1
  v_mfma_f32_16x16x32_bf16 v[40:43], a[72:75], a[4:7], v[40:43]
  ds_read_b64_tr_b16 a[72:73], v244 offset:0
  ds_read_b64_tr_b16 a[74:75], v244 offset:4096
  v_mfma_f32_16x16x32_bf16 v[28:31], a[76:79], a[0:3], v[28:31]
  v_mfma_f32_16x16x32_bf16 v[44:47], a[76:79], a[4:7], v[44:47]
  buffer_load_dwordx4 v228, s[8:11], s17 offen offset:3072 lds
  v_mfma_f32_16x16x32_bf16 v[16:19], a[96:99], a[8:11], v[16:19]
  ds_read_b64_tr_b16 a[76:77], v245 offset:0
  s_add_u32 s17, s17, 458752
  v_mfma_f32_16x16x32_bf16 v[32:35], a[96:99], a[12:15], v[32:35]
  ds_read_b64_tr_b16 a[78:79], v245 offset:4096
  s_cmp_eq_u32 s17, s93
  v_mfma_f32_16x16x32_bf16 v[20:23], a[100:103], a[8:11], v[20:23]
  ds_read_b64_tr_b16 a[96:97], v242 offset:8192
  s_cselect_b32 s17, s95, s17
  v_mfma_f32_16x16x32_bf16 v[36:39], a[100:103], a[12:15], v[36:39]
  buffer_load_dwordx4 a[60:63], v241, s[4:7], s16 offen offset:1024 sc1
  v_mfma_f32_16x16x32_bf16 v[24:27], a[104:107], a[8:11], v[24:27]
  ds_read_b64_tr_b16 a[98:99], v242 offset:12288
  s_add_u32 s41, s41, 262144
  v_mfma_f32_16x16x32_bf16 v[40:43], a[104:107], a[12:15], v[40:43]
  ds_read_b64_tr_b16 a[100:101], v243 offset:8192
  s_bitset0_b32 s41, 21
  v_mfma_f32_16x16x32_bf16 v[28:31], a[108:111], a[8:11], v[28:31]
  ds_read_b64_tr_b16 a[102:103], v243 offset:12288
  s_add_u32 s16, s40, s41
  v_mfma_f32_16x16x32_bf16 v[44:47], a[108:111], a[12:15], v[44:47]
  s_waitcnt vmcnt(16) lgkmcnt(10)
  s_barrier
  v_mfma_f32_16x16x32_bf16 v[72:75], a[80:83], a[16:19], v[72:75]
  ds_read_b64_tr_b16 a[104:105], v244 offset:8192
  ds_read_b64_tr_b16 a[106:107], v244 offset:12288
  s_add_u32 m0, s38, 81920
  v_mfma_f32_16x16x32_bf16 v[88:91], a[80:83], a[20:23], v[88:91]
  buffer_load_dwordx4 v225, s[8:11], s17 offen lds
  v_mfma_f32_16x16x32_bf16 v[76:79], a[84:87], a[16:19], v[76:79]
  ds_read_b64_tr_b16 a[108:109], v245 offset:8192
  ds_read_b64_tr_b16 a[110:111], v245 offset:12288
  v_mfma_f32_16x16x32_bf16 v[92:95], a[84:87], a[20:23], v[92:95]
  ds_read_b64_tr_b16 a[80:81], v242 offset:18432
  ds_read_b64_tr_b16 a[82:83], v242 offset:22528
  v_mfma_f32_16x16x32_bf16 v[80:83], a[88:91], a[16:19], v[80:83]
  buffer_load_dwordx4 a[0:3], v240, s[4:7], s16 offen offset:0 sc1
  v_mfma_f32_16x16x32_bf16 v[96:99], a[88:91], a[20:23], v[96:99]
  ds_read_b64_tr_b16 a[84:85], v243 offset:18432
  ds_read_b64_tr_b16 a[86:87], v243 offset:22528
  v_mfma_f32_16x16x32_bf16 v[84:87], a[92:95], a[16:19], v[84:87]
  ds_read_b64_tr_b16 a[88:89], v244 offset:18432
  ds_read_b64_tr_b16 a[90:91], v244 offset:22528
  v_mfma_f32_16x16x32_bf16 v[100:103], a[92:95], a[20:23], v[100:103]
  ds_read_b64_tr_b16 a[92:93], v245 offset:18432
  ds_read_b64_tr_b16 a[94:95], v245 offset:22528
  v_mfma_f32_16x16x32_bf16 v[72:75], a[112:115], a[24:27], v[72:75]
  buffer_load_dwordx4 v226, s[8:11], s17 offen offset:1024 lds
  v_mfma_f32_16x16x32_bf16 v[88:91], a[112:115], a[28:31], v[88:91]
  ds_read_b64_tr_b16 a[112:113], v242 offset:26624
  ds_read_b64_tr_b16 a[114:115], v242 offset:30720
  v_mfma_f32_16x16x32_bf16 v[76:79], a[116:119], a[24:27], v[76:79]
  v_mfma_f32_16x16x32_bf16 v[92:95], a[116:119], a[28:31], v[92:95]
  ds_read_b64_tr_b16 a[116:117], v243 offset:26624
  ds_read_b64_tr_b16 a[118:119], v243 offset:30720
  v_mfma_f32_16x16x32_bf16 v[80:83], a[120:123], a[24:27], v[80:83]
  buffer_load_dwordx4 a[4:7], v240, s[4:7], s16 offen offset:1024 sc1
  v_mfma_f32_16x16x32_bf16 v[96:99], a[120:123], a[28:31], v[96:99]
  ds_read_b64_tr_b16 a[120:121], v244 offset:26624
  ds_read_b64_tr_b16 a[122:123], v244 offset:30720
  v_mfma_f32_16x16x32_bf16 v[84:87], a[124:127], a[24:27], v[84:87]
  v_mfma_f32_16x16x32_bf16 v[100:103], a[124:127], a[28:31], v[100:103]
  ds_read_b64_tr_b16 a[124:125], v245 offset:26624
  ds_read_b64_tr_b16 a[126:127], v245 offset:30720
  v_mfma_f32_16x16x32_bf16 v[16:19], a[64:67], a[16:19], v[16:19]
  buffer_load_dwordx4 v227, s[8:11], s17 offen offset:2048 lds
  v_mfma_f32_16x16x32_bf16 v[32:35], a[64:67], a[20:23], v[32:35]
  ds_read_b64_tr_b16 a[64:65], v242 offset:16384
  ds_read_b64_tr_b16 a[66:67], v242 offset:20480
  s_waitcnt lgkmcnt(10)
  v_mfma_f32_16x16x32_bf16 v[20:23], a[68:71], a[16:19], v[20:23]
  v_mfma_f32_16x16x32_bf16 v[36:39], a[68:71], a[20:23], v[36:39]
  ds_read_b64_tr_b16 a[68:69], v243 offset:16384
  ds_read_b64_tr_b16 a[70:71], v243 offset:20480
  v_mfma_f32_16x16x32_bf16 v[24:27], a[72:75], a[16:19], v[24:27]
  buffer_load_dwordx4 a[8:11], v241, s[4:7], s16 offen offset:0 sc1
  v_mfma_f32_16x16x32_bf16 v[40:43], a[72:75], a[20:23], v[40:43]
  ds_read_b64_tr_b16 a[72:73], v244 offset:16384
  ds_read_b64_tr_b16 a[74:75], v244 offset:20480
  v_mfma_f32_16x16x32_bf16 v[28:31], a[76:79], a[16:19], v[28:31]
  v_mfma_f32_16x16x32_bf16 v[44:47], a[76:79], a[20:23], v[44:47]
  buffer_load_dwordx4 v228, s[8:11], s17 offen offset:3072 lds
  v_mfma_f32_16x16x32_bf16 v[16:19], a[96:99], a[24:27], v[16:19]
  ds_read_b64_tr_b16 a[76:77], v245 offset:16384
  s_add_u32 s17, s17, 458752
  v_mfma_f32_16x16x32_bf16 v[32:35], a[96:99], a[28:31], v[32:35]
  ds_read_b64_tr_b16 a[78:79], v245 offset:20480
  s_cmp_eq_u32 s17, s93
  v_mfma_f32_16x16x32_bf16 v[20:23], a[100:103], a[24:27], v[20:23]
  ds_read_b64_tr_b16 a[96:97], v242 offset:24576
  s_cselect_b32 s17, s95, s17
  v_mfma_f32_16x16x32_bf16 v[36:39], a[100:103], a[28:31], v[36:39]
  buffer_load_dwordx4 a[12:15], v241, s[4:7], s16 offen offset:1024 sc1
  v_mfma_f32_16x16x32_bf16 v[24:27], a[104:107], a[24:27], v[24:27]
  ds_read_b64_tr_b16 a[98:99], v242 offset:28672
  s_add_u32 s41, s41, 262144
  v_mfma_f32_16x16x32_bf16 v[40:43], a[104:107], a[28:31], v[40:43]
  ds_read_b64_tr_b16 a[100:101], v243 offset:24576
  s_bitset0_b32 s41, 21
  v_mfma_f32_16x16x32_bf16 v[28:31], a[108:111], a[24:27], v[28:31]
  ds_read_b64_tr_b16 a[102:103], v243 offset:28672
  s_add_u32 s16, s40, s41
  v_mfma_f32_16x16x32_bf16 v[44:47], a[108:111], a[28:31], v[44:47]
  s_waitcnt vmcnt(16) lgkmcnt(10)
  s_barrier
  v_mfma_f32_16x16x32_bf16 v[72:75], a[80:83], a[32:35], v[72:75]
  ds_read_b64_tr_b16 a[104:105], v244 offset:24576
  ds_read_b64_tr_b16 a[106:107], v244 offset:28672
  s_add_u32 m0, s38, 98304
  v_mfma_f32_16x16x32_bf16 v[88:91], a[80:83], a[36:39], v[88:91]
  v_accvgpr_read_b32 v0, a128
  buffer_load_dwordx4 v225, s[8:11], s17 offen lds
  v_mfma_f32_16x16x32_bf16 v[76:79], a[84:87], a[32:35], v[76:79]
  ds_read_b64_tr_b16 a[108:109], v245 offset:24576
  ds_read_b64_tr_b16 a[110:111], v245 offset:28672
  v_mfma_f32_16x16x32_bf16 v[92:95], a[84:87], a[36:39], v[92:95]
  ds_read_b64_tr_b16 a[80:81], v242 offset:34816
  v_accvgpr_read_b32 v1, a129
  v_mfma_f32_16x16x32_bf16 v[80:83], a[88:91], a[32:35], v[80:83]
  ds_read_b64_tr_b16 a[82:83], v242 offset:38912
  buffer_load_dwordx4 a[16:19], v240, s[4:7], s16 offen offset:0 sc1
  v_mfma_f32_16x16x32_bf16 v[96:99], a[88:91], a[36:39], v[96:99]
  ds_read_b64_tr_b16 a[84:85], v243 offset:34816
  v_accvgpr_read_b32 v2, a130
  v_mfma_f32_16x16x32_bf16 v[84:87], a[92:95], a[32:35], v[84:87]
  ds_read_b64_tr_b16 a[86:87], v243 offset:38912
  ds_read_b64_tr_b16 a[88:89], v244 offset:34816
  v_mfma_f32_16x16x32_bf16 v[100:103], a[92:95], a[36:39], v[100:103]
  ds_read_b64_tr_b16 a[90:91], v244 offset:38912
  ds_read_b64_tr_b16 a[92:93], v245 offset:34816
  v_mfma_f32_16x16x32_bf16 v[72:75], a[112:115], a[40:43], v[72:75]
  v_accvgpr_read_b32 v3, a131
  buffer_load_dwordx4 v226, s[8:11], s17 offen offset:1024 lds
  v_mfma_f32_16x16x32_bf16 v[88:91], a[112:115], a[44:47], v[88:91]
  ds_read_b64_tr_b16 a[94:95], v245 offset:38912
  ds_read_b64_tr_b16 a[112:113], v242 offset:43008
  v_mfma_f32_16x16x32_bf16 v[76:79], a[116:119], a[40:43], v[76:79]
  ds_read_b64_tr_b16 a[114:115], v242 offset:47104
  v_lshlrev_b32 v192, 16, v0
  v_mfma_f32_16x16x32_bf16 v[92:95], a[116:119], a[44:47], v[92:95]
  ds_read_b64_tr_b16 a[116:117], v243 offset:43008
  ds_read_b64_tr_b16 a[118:119], v243 offset:47104
  v_mfma_f32_16x16x32_bf16 v[80:83], a[120:123], a[40:43], v[80:83]
  v_and_b32 v193, 0xffff0000, v0
  buffer_load_dwordx4 a[20:23], v240, s[4:7], s16 offen offset:1024 sc1
  v_mfma_f32_16x16x32_bf16 v[96:99], a[120:123], a[44:47], v[96:99]
  ds_read_b64_tr_b16 a[120:121], v244 offset:43008
  ds_read_b64_tr_b16 a[122:123], v244 offset:47104
  v_mfma_f32_16x16x32_bf16 v[84:87], a[124:127], a[40:43], v[84:87]
  v_mfma_f32_16x16x32_bf16 v[100:103], a[124:127], a[44:47], v[100:103]
  ds_read_b64_tr_b16 a[124:125], v245 offset:43008
  v_lshlrev_b32 v194, 16, v1
  v_mfma_f32_16x16x32_bf16 v[16:19], a[64:67], a[32:35], v[16:19]
  buffer_load_dwordx4 v227, s[8:11], s17 offen offset:2048 lds
  v_mfma_f32_16x16x32_bf16 v[32:35], a[64:67], a[36:39], v[32:35]
  ds_read_b64_tr_b16 a[126:127], v245 offset:47104
  v_and_b32 v195, 0xffff0000, v1
  s_waitcnt lgkmcnt(10)
  v_mfma_f32_16x16x32_bf16 v[20:23], a[68:71], a[32:35], v[20:23]
  ds_read_b64_tr_b16 a[64:65], v242 offset:32768
  ds_read_b64_tr_b16 a[66:67], v242 offset:36864
  v_mfma_f32_16x16x32_bf16 v[36:39], a[68:71], a[36:39], v[36:39]
  v_lshlrev_b32 v196, 16, v2
  buffer_load_dwordx4 a[24:27], v241, s[4:7], s16 offen offset:0 sc1
  v_mfma_f32_16x16x32_bf16 v[24:27], a[72:75], a[32:35], v[24:27]
  buffer_load_dwordx4 v228, s[8:11], s17 offen offset:3072 lds
  v_mfma_f32_16x16x32_bf16 v[40:43], a[72:75], a[36:39], v[40:43]
  ds_read_b64_tr_b16 a[68:69], v243 offset:32768
  s_add_u32 s17, s17, 458752
  v_mfma_f32_16x16x32_bf16 v[28:31], a[76:79], a[32:35], v[28:31]
  ds_read_b64_tr_b16 a[70:71], v243 offset:36864
  v_and_b32 v197, 0xffff0000, v2
  s_cmp_eq_u32 s17, s93
  v_mfma_f32_16x16x32_bf16 v[44:47], a[76:79], a[36:39], v[44:47]
  ds_read_b64_tr_b16 a[72:73], v244 offset:32768
  s_cselect_b32 s17, s95, s17
  v_mfma_f32_16x16x32_bf16 v[16:19], a[96:99], a[40:43], v[16:19]
  ds_read_b64_tr_b16 a[74:75], v244 offset:36864
  v_lshlrev_b32 v198, 16, v3
  s_add_u32 s17, s17, 65536
  v_mfma_f32_16x16x32_bf16 v[32:35], a[96:99], a[44:47], v[32:35]
  ds_read_b64_tr_b16 a[76:77], v245 offset:32768
  s_add_u32 s93, s93, 65536
  v_mfma_f32_16x16x32_bf16 v[20:23], a[100:103], a[40:43], v[20:23]
  ds_read_b64_tr_b16 a[78:79], v245 offset:36864
  v_and_b32 v199, 0xffff0000, v3
  s_add_u32 s95, s95, 65536
  v_mfma_f32_16x16x32_bf16 v[36:39], a[100:103], a[44:47], v[36:39]
  buffer_load_dwordx4 a[28:31], v241, s[4:7], s16 offen offset:1024 sc1
  v_mfma_f32_16x16x32_bf16 v[24:27], a[104:107], a[40:43], v[24:27]
  ds_read_b64_tr_b16 a[96:97], v242 offset:40960
  ds_read_b64_tr_b16 a[98:99], v242 offset:45056
  s_add_u32 s41, s41, 262144
  v_mfma_f32_16x16x32_bf16 v[40:43], a[104:107], a[44:47], v[40:43]
  ds_read_b64_tr_b16 a[100:101], v243 offset:40960
  s_bitset0_b32 s41, 21
  v_mfma_f32_16x16x32_bf16 v[28:31], a[108:111], a[40:43], v[28:31]
  ds_read_b64_tr_b16 a[102:103], v243 offset:45056
  ds_read_b128 v[56:59], v253 offset:768
  s_add_u32 s16, s40, s41
  v_mfma_f32_16x16x32_bf16 v[44:47], a[108:111], a[44:47], v[44:47]
  s_waitcnt vmcnt(16) lgkmcnt(10)
  s_barrier
  v_mfma_f32_16x16x32_bf16 v[72:75], a[80:83], a[48:51], v[72:75]
  ds_read_b64_tr_b16 a[104:105], v244 offset:40960
  ds_read_b64_tr_b16 a[106:107], v244 offset:45056
  s_add_u32 m0, s38, 114688
  v_mfma_f32_16x16x32_bf16 v[88:91], a[80:83], a[52:55], v[88:91]
  v_accvgpr_read_b32 v4, a132
  buffer_load_dwordx4 v225, s[8:11], s17 offen lds
  v_mfma_f32_16x16x32_bf16 v[76:79], a[84:87], a[48:51], v[76:79]
  ds_read_b64_tr_b16 a[108:109], v245 offset:40960
  ds_read_b64_tr_b16 a[110:111], v245 offset:45056
  v_mfma_f32_16x16x32_bf16 v[92:95], a[84:87], a[52:55], v[92:95]
  ds_read_b64_tr_b16 a[80:81], v242 offset:51200
  v_accvgpr_read_b32 v5, a133
  v_mfma_f32_16x16x32_bf16 v[80:83], a[88:91], a[48:51], v[80:83]
  ds_read_b64_tr_b16 a[82:83], v242 offset:55296
  buffer_load_dwordx4 a[32:35], v240, s[4:7], s16 offen offset:0 sc1
  v_mfma_f32_16x16x32_bf16 v[96:99], a[88:91], a[52:55], v[96:99]
  ds_read_b64_tr_b16 a[84:85], v243 offset:51200
  v_accvgpr_read_b32 v6, a134
  v_mfma_f32_16x16x32_bf16 v[84:87], a[92:95], a[48:51], v[84:87]
  ds_read_b64_tr_b16 a[86:87], v243 offset:55296
  ds_read_b64_tr_b16 a[88:89], v244 offset:51200
  v_mfma_f32_16x16x32_bf16 v[100:103], a[92:95], a[52:55], v[100:103]
  ds_read_b64_tr_b16 a[90:91], v244 offset:55296
  ds_read_b64_tr_b16 a[92:93], v245 offset:51200
  v_mfma_f32_16x16x32_bf16 v[72:75], a[112:115], a[56:59], v[72:75]
  v_accvgpr_read_b32 v7, a135
  buffer_load_dwordx4 v226, s[8:11], s17 offen offset:1024 lds
  v_mfma_f32_16x16x32_bf16 v[88:91], a[112:115], a[60:63], v[88:91]
  ds_read_b64_tr_b16 a[94:95], v245 offset:55296
  ds_read_b64_tr_b16 a[112:113], v242 offset:59392
  v_mfma_f32_16x16x32_bf16 v[76:79], a[116:119], a[56:59], v[76:79]
  ds_read_b64_tr_b16 a[114:115], v242 offset:63488
  v_lshlrev_b32 v200, 16, v4
  v_mfma_f32_16x16x32_bf16 v[92:95], a[116:119], a[60:63], v[92:95]
  ds_read_b64_tr_b16 a[116:117], v243 offset:59392
  ds_read_b64_tr_b16 a[118:119], v243 offset:63488
  v_mfma_f32_16x16x32_bf16 v[80:83], a[120:123], a[56:59], v[80:83]
  v_and_b32 v201, 0xffff0000, v4
  buffer_load_dwordx4 a[36:39], v240, s[4:7], s16 offen offset:1024 sc1
  v_mfma_f32_16x16x32_bf16 v[96:99], a[120:123], a[60:63], v[96:99]
  ds_read_b64_tr_b16 a[120:121], v244 offset:59392
  ds_read_b64_tr_b16 a[122:123], v244 offset:63488
  v_mfma_f32_16x16x32_bf16 v[84:87], a[124:127], a[56:59], v[84:87]
  v_mfma_f32_16x16x32_bf16 v[100:103], a[124:127], a[60:63], v[100:103]
  v_lshlrev_b32 v202, 16, v5
  buffer_load_dword v247, v246, s[56:59], s94 offen sc1
  v_mfma_f32_16x16x32_bf16 v[16:19], a[64:67], a[48:51], v[16:19]
  buffer_load_dwordx4 v227, s[8:11], s17 offen offset:2048 lds
  v_mfma_f32_16x16x32_bf16 v[32:35], a[64:67], a[52:55], v[32:35]
  ds_read_b64_tr_b16 a[124:125], v245 offset:59392
  v_and_b32 v203, 0xffff0000, v5
  s_waitcnt lgkmcnt(10)
  v_mfma_f32_16x16x32_bf16 v[20:23], a[68:71], a[48:51], v[20:23]
  ds_read_b64_tr_b16 a[126:127], v245 offset:63488
  ds_read_b64_tr_b16 a[64:65], v242 offset:49152
  v_mfma_f32_16x16x32_bf16 v[36:39], a[68:71], a[52:55], v[36:39]
  ds_read_b64_tr_b16 a[66:67], v242 offset:53248
  v_lshlrev_b32 v204, 16, v6
  v_mfma_f32_16x16x32_bf16 v[24:27], a[72:75], a[48:51], v[24:27]
  buffer_load_dwordx4 a[40:43], v241, s[4:7], s16 offen offset:0 sc1
  v_mfma_f32_16x16x32_bf16 v[40:43], a[72:75], a[52:55], v[40:43]
  ds_read_b64_tr_b16 a[68:69], v243 offset:49152
  ds_read_b64_tr_b16 a[70:71], v243 offset:53248
  v_mfma_f32_16x16x32_bf16 v[28:31], a[76:79], a[48:51], v[28:31]
  ds_read_b64_tr_b16 a[72:73], v244 offset:49152
  v_and_b32 v205, 0xffff0000, v6
  v_mfma_f32_16x16x32_bf16 v[44:47], a[76:79], a[52:55], v[44:47]
  buffer_load_dwordx4 v228, s[8:11], s17 offen offset:3072 lds
  v_mfma_f32_16x16x32_bf16 v[16:19], a[96:99], a[56:59], v[16:19]
  ds_read_b64_tr_b16 a[74:75], v244 offset:53248
  v_lshlrev_b32 v206, 16, v7
  s_add_u32 s17, s17, 458752
  v_mfma_f32_16x16x32_bf16 v[32:35], a[96:99], a[60:63], v[32:35]
  ds_read_b64_tr_b16 a[76:77], v245 offset:49152
  s_cmp_eq_u32 s17, s93
  v_mfma_f32_16x16x32_bf16 v[20:23], a[100:103], a[56:59], v[20:23]
  ds_read_b64_tr_b16 a[78:79], v245 offset:53248
  v_and_b32 v207, 0xffff0000, v7
  s_cselect_b32 s17, s95, s17
  v_mfma_f32_16x16x32_bf16 v[36:39], a[100:103], a[60:63], v[36:39]
  buffer_load_dwordx4 a[44:47], v241, s[4:7], s16 offen offset:1024 sc1
  v_mfma_f32_16x16x32_bf16 v[24:27], a[104:107], a[56:59], v[24:27]
  ds_read_b64_tr_b16 a[96:97], v242 offset:57344
  ds_read_b64_tr_b16 a[98:99], v242 offset:61440
  s_add_u32 s41, s41, 262144
  v_mfma_f32_16x16x32_bf16 v[40:43], a[104:107], a[60:63], v[40:43]
  ds_read_b64_tr_b16 a[100:101], v243 offset:57344
  s_bitset0_b32 s41, 21
  v_mfma_f32_16x16x32_bf16 v[28:31], a[108:111], a[56:59], v[28:31]
  ds_read_b64_tr_b16 a[102:103], v243 offset:61440
  ds_read_b128 v[60:63], v253 offset:832
  s_add_u32 s16, s40, s41
  v_mfma_f32_16x16x32_bf16 v[44:47], a[108:111], a[60:63], v[44:47]
  s_waitcnt vmcnt(17) lgkmcnt(10)
  s_barrier
  v_mfma_f32_16x16x32_bf16 v[72:75], a[80:83], a[0:3], v[72:75]
  ds_read_b64_tr_b16 a[104:105], v244 offset:57344
  ds_read_b64_tr_b16 a[106:107], v244 offset:61440
  s_add_u32 m0, s38, 131072
  v_mfma_f32_16x16x32_bf16 v[88:91], a[80:83], a[4:7], v[88:91]
  v_accvgpr_read_b32 v8, a136
  buffer_load_dwordx4 v225, s[8:11], s17 offen lds
  v_mfma_f32_16x16x32_bf16 v[76:79], a[84:87], a[0:3], v[76:79]
  ds_read_b64_tr_b16 a[108:109], v245 offset:57344
  ds_read_b64_tr_b16 a[110:111], v245 offset:61440
  v_mfma_f32_16x16x32_bf16 v[92:95], a[84:87], a[4:7], v[92:95]
  ds_read_b64_tr_b16 a[80:81], v104 offset:2048
  v_accvgpr_read_b32 v9, a137
  v_mfma_f32_16x16x32_bf16 v[80:83], a[88:91], a[0:3], v[80:83]
  ds_read_b64_tr_b16 a[82:83], v104 offset:6144
  buffer_load_dwordx4 a[48:51], v240, s[4:7], s16 offen offset:0 sc1
  v_mfma_f32_16x16x32_bf16 v[96:99], a[88:91], a[4:7], v[96:99]
  ds_read_b64_tr_b16 a[84:85], v105 offset:2048
  v_accvgpr_read_b32 v10, a138
  v_mfma_f32_16x16x32_bf16 v[84:87], a[92:95], a[0:3], v[84:87]
  ds_read_b64_tr_b16 a[86:87], v105 offset:6144
  ds_read_b64_tr_b16 a[88:89], v106 offset:2048
  v_mfma_f32_16x16x32_bf16 v[100:103], a[92:95], a[4:7], v[100:103]
  ds_read_b64_tr_b16 a[90:91], v106 offset:6144
  ds_read_b64_tr_b16 a[92:93], v107 offset:2048
  v_mfma_f32_16x16x32_bf16 v[72:75], a[112:115], a[8:11], v[72:75]
  v_accvgpr_read_b32 v11, a139
  buffer_load_dwordx4 v226, s[8:11], s17 offen offset:1024 lds
  v_mfma_f32_16x16x32_bf16 v[88:91], a[112:115], a[12:15], v[88:91]
  ds_read_b64_tr_b16 a[94:95], v107 offset:6144
  ds_read_b64_tr_b16 a[112:113], v104 offset:10240
  v_mfma_f32_16x16x32_bf16 v[76:79], a[116:119], a[8:11], v[76:79]
  ds_read_b64_tr_b16 a[114:115], v104 offset:14336
  v_lshlrev_b32 v208, 16, v8
  v_mfma_f32_16x16x32_bf16 v[92:95], a[116:119], a[12:15], v[92:95]
  ds_read_b64_tr_b16 a[116:117], v105 offset:10240
  ds_read_b64_tr_b16 a[118:119], v105 offset:14336
  v_mfma_f32_16x16x32_bf16 v[80:83], a[120:123], a[8:11], v[80:83]
  v_and_b32 v209, 0xffff0000, v8
  buffer_load_dwordx4 a[52:55], v240, s[4:7], s16 offen offset:1024 sc1
  v_mfma_f32_16x16x32_bf16 v[96:99], a[120:123], a[12:15], v[96:99]
  ds_read_b64_tr_b16 a[120:121], v106 offset:10240
  ds_read_b64_tr_b16 a[122:123], v106 offset:14336
  v_mfma_f32_16x16x32_bf16 v[84:87], a[124:127], a[8:11], v[84:87]
  v_mfma_f32_16x16x32_bf16 v[100:103], a[124:127], a[12:15], v[100:103]
  ds_read_b64_tr_b16 a[124:125], v107 offset:10240
  v_lshlrev_b32 v210, 16, v9
  v_mfma_f32_16x16x32_bf16 v[16:19], a[64:67], a[0:3], v[16:19]
  buffer_load_dwordx4 v227, s[8:11], s17 offen offset:2048 lds
  v_mfma_f32_16x16x32_bf16 v[32:35], a[64:67], a[4:7], v[32:35]
  ds_read_b64_tr_b16 a[126:127], v107 offset:14336
  v_and_b32 v211, 0xffff0000, v9
  s_waitcnt lgkmcnt(10)
  v_mfma_f32_16x16x32_bf16 v[20:23], a[68:71], a[0:3], v[20:23]
  ds_read_b64_tr_b16 a[64:65], v104 offset:0
  ds_read_b64_tr_b16 a[66:67], v104 offset:4096
  v_mfma_f32_16x16x32_bf16 v[36:39], a[68:71], a[4:7], v[36:39]
  ds_read_b64_tr_b16 a[68:69], v105 offset:0
  v_lshlrev_b32 v212, 16, v10
  v_mfma_f32_16x16x32_bf16 v[24:27], a[72:75], a[0:3], v[24:27]
  buffer_load_dwordx4 a[56:59], v241, s[4:7], s16 offen offset:0 sc1
  v_mfma_f32_16x16x32_bf16 v[40:43], a[72:75], a[4:7], v[40:43]
  ds_read_b64_tr_b16 a[70:71], v105 offset:4096
  ds_read_b64_tr_b16 a[72:73], v106 offset:0
  v_mfma_f32_16x16x32_bf16 v[28:31], a[76:79], a[0:3], v[28:31]
  v_and_b32 v213, 0xffff0000, v10
  buffer_load_dwordx4 v228, s[8:11], s17 offen offset:3072 lds
  v_mfma_f32_16x16x32_bf16 v[44:47], a[76:79], a[4:7], v[44:47]
  ds_read_b64_tr_b16 a[74:75], v106 offset:4096
  s_add_u32 s17, s17, 458752
  v_mfma_f32_16x16x32_bf16 v[16:19], a[96:99], a[8:11], v[16:19]
  v_lshlrev_b32 v214, 16, v11
  s_cmp_eq_u32 s17, s93
  v_mfma_f32_16x16x32_bf16 v[32:35], a[96:99], a[12:15], v[32:35]
  ds_read_b64_tr_b16 a[76:77], v107 offset:0
  s_cselect_b32 s17, s95, s17
  v_mfma_f32_16x16x32_bf16 v[20:23], a[100:103], a[8:11], v[20:23]
  ds_read_b64_tr_b16 a[78:79], v107 offset:4096
  v_and_b32 v215, 0xffff0000, v11
  buffer_load_dwordx4 a[60:63], v241, s[4:7], s16 offen offset:1024 sc1
  v_mfma_f32_16x16x32_bf16 v[36:39], a[100:103], a[12:15], v[36:39]
  ds_read_b64_tr_b16 a[96:97], v104 offset:8192
  s_add_u32 s41, s41, 262144
  v_mfma_f32_16x16x32_bf16 v[24:27], a[104:107], a[8:11], v[24:27]
  ds_read_b64_tr_b16 a[98:99], v104 offset:12288
  s_bitset0_b32 s41, 21
  v_mfma_f32_16x16x32_bf16 v[40:43], a[104:107], a[12:15], v[40:43]
  ds_read_b64_tr_b16 a[100:101], v105 offset:8192
  s_add_u32 s40, s40, 2097152
  v_mfma_f32_16x16x32_bf16 v[28:31], a[108:111], a[8:11], v[28:31]
  ds_read_b64_tr_b16 a[102:103], v105 offset:12288
  ds_read_b128 v[64:67], v253 offset:896
  s_add_u32 s16, s40, s41
  v_mfma_f32_16x16x32_bf16 v[44:47], a[108:111], a[12:15], v[44:47]
  s_waitcnt vmcnt(12) lgkmcnt(10)
  s_barrier
  v_cmp_ne_u32 vcc, s19, v247
  s_nop 1
  s_cmp_lg_u64 vcc, 0
  s_cbranch_scc1 L_slow_29
  L_back_30:
  s_add_u32 s94, s94, 65536
  v_mfma_f32_16x16x32_bf16 v[72:75], a[80:83], a[16:19], v[72:75]
  ds_read_b64_tr_b16 a[104:105], v106 offset:8192
  ds_read_b64_tr_b16 a[106:107], v106 offset:12288
  buffer_load_dwordx4 a[0:3], v240, s[4:7], s16 offen offset:0 sc1
  v_mfma_f32_16x16x32_bf16 v[88:91], a[80:83], a[20:23], v[88:91]
  ds_read_b64_tr_b16 a[108:109], v107 offset:8192
  v_accvgpr_read_b32 v12, a140
  v_mfma_f32_16x16x32_bf16 v[76:79], a[84:87], a[16:19], v[76:79]
  ds_read_b64_tr_b16 a[110:111], v107 offset:12288
  ds_read_b64_tr_b16 a[80:81], v104 offset:18432
  v_mfma_f32_16x16x32_bf16 v[92:95], a[84:87], a[20:23], v[92:95]
  ds_read_b64_tr_b16 a[82:83], v104 offset:22528
  v_accvgpr_read_b32 v13, a141
  v_mfma_f32_16x16x32_bf16 v[80:83], a[88:91], a[16:19], v[80:83]
  ds_read_b64_tr_b16 a[84:85], v105 offset:18432
  ds_read_b64_tr_b16 a[86:87], v105 offset:22528
  v_mfma_f32_16x16x32_bf16 v[96:99], a[88:91], a[20:23], v[96:99]
  ds_read_b64_tr_b16 a[88:89], v106 offset:18432
  v_accvgpr_read_b32 v14, a142
  v_mfma_f32_16x16x32_bf16 v[84:87], a[92:95], a[16:19], v[84:87]
  ds_read_b64_tr_b16 a[90:91], v106 offset:22528
  v_mfma_f32_16x16x32_bf16 v[100:103], a[92:95], a[20:23], v[100:103]
  buffer_load_dwordx4 a[4:7], v240, s[4:7], s16 offen offset:1024 sc1
  v_mfma_f32_16x16x32_bf16 v[72:75], a[112:115], a[24:27], v[72:75]
  ds_read_b64_tr_b16 a[92:93], v107 offset:18432
  v_accvgpr_read_b32 v15, a143
  v_mfma_f32_16x16x32_bf16 v[88:91], a[112:115], a[28:31], v[88:91]
  ds_read_b64_tr_b16 a[94:95], v107 offset:22528
  ds_read_b64_tr_b16 a[112:113], v104 offset:26624
  v_mfma_f32_16x16x32_bf16 v[76:79], a[116:119], a[24:27], v[76:79]
  ds_read_b64_tr_b16 a[114:115], v104 offset:30720
  v_lshlrev_b32 v216, 16, v12
  v_mfma_f32_16x16x32_bf16 v[92:95], a[116:119], a[28:31], v[92:95]
  ds_read_b64_tr_b16 a[116:117], v105 offset:26624
  ds_read_b64_tr_b16 a[118:119], v105 offset:30720
  v_mfma_f32_16x16x32_bf16 v[80:83], a[120:123], a[24:27], v[80:83]
  v_and_b32 v217, 0xffff0000, v12
  v_mfma_f32_16x16x32_bf16 v[96:99], a[120:123], a[28:31], v[96:99]
  ds_read_b64_tr_b16 a[120:121], v106 offset:26624
  ds_read_b64_tr_b16 a[122:123], v106 offset:30720
  v_mfma_f32_16x16x32_bf16 v[84:87], a[124:127], a[24:27], v[84:87]
  v_mfma_f32_16x16x32_bf16 v[100:103], a[124:127], a[28:31], v[100:103]
  v_lshlrev_b32 v218, 16, v13
  buffer_load_dwordx4 a[8:11], v241, s[4:7], s16 offen offset:0 sc1
  v_mfma_f32_16x16x32_bf16 v[16:19], a[64:67], a[16:19], v[16:19]
  ds_read_b64_tr_b16 a[124:125], v107 offset:26624
  ds_read_b64_tr_b16 a[126:127], v107 offset:30720
  v_mfma_f32_16x16x32_bf16 v[32:35], a[64:67], a[20:23], v[32:35]
  ds_read_b64_tr_b16 a[64:65], v104 offset:16384
  v_and_b32 v219, 0xffff0000, v13
  s_waitcnt lgkmcnt(10)
  v_mfma_f32_16x16x32_bf16 v[20:23], a[68:71], a[16:19], v[20:23]
  ds_read_b64_tr_b16 a[66:67], v104 offset:20480
  v_mfma_f32_16x16x32_bf16 v[36:39], a[68:71], a[20:23], v[36:39]
  ds_read_b64_tr_b16 a[68:69], v105 offset:16384
  v_lshlrev_b32 v220, 16, v14
  v_mfma_f32_16x16x32_bf16 v[24:27], a[72:75], a[16:19], v[24:27]
  ds_read_b64_tr_b16 a[70:71], v105 offset:20480
  v_mfma_f32_16x16x32_bf16 v[40:43], a[72:75], a[20:23], v[40:43]
  ds_read_b64_tr_b16 a[72:73], v106 offset:16384
  ds_read_b64_tr_b16 a[74:75], v106 offset:20480
  v_mfma_f32_16x16x32_bf16 v[28:31], a[76:79], a[16:19], v[28:31]
  v_and_b32 v221, 0xffff0000, v14
  v_mfma_f32_16x16x32_bf16 v[44:47], a[76:79], a[20:23], v[44:47]
  buffer_load_dwordx4 a[12:15], v241, s[4:7], s16 offen offset:1024 sc1
  v_mfma_f32_16x16x32_bf16 v[16:19], a[96:99], a[24:27], v[16:19]
  v_lshlrev_b32 v222, 16, v15
  s_add_u32 s41, s41, 262144
  v_mfma_f32_16x16x32_bf16 v[32:35], a[96:99], a[28:31], v[32:35]
  ds_read_b64_tr_b16 a[76:77], v107 offset:16384
  s_bitset0_b32 s41, 21
  v_mfma_f32_16x16x32_bf16 v[20:23], a[100:103], a[24:27], v[20:23]
  ds_read_b64_tr_b16 a[78:79], v107 offset:20480
  v_and_b32 v223, 0xffff0000, v15
  s_add_u32 s16, s40, s41
  v_mfma_f32_16x16x32_bf16 v[36:39], a[100:103], a[28:31], v[36:39]
  ds_read_b64_tr_b16 a[96:97], v104 offset:24576
  ds_read_b64_tr_b16 a[98:99], v104 offset:28672
  v_mfma_f32_16x16x32_bf16 v[24:27], a[104:107], a[24:27], v[24:27]
  ds_read_b64_tr_b16 a[100:101], v105 offset:24576
  ds_read_b64_tr_b16 a[102:103], v105 offset:28672
  v_mfma_f32_16x16x32_bf16 v[40:43], a[104:107], a[28:31], v[40:43]
  ds_read_b64_tr_b16 a[104:105], v106 offset:24576
  ds_read_b64_tr_b16 a[106:107], v106 offset:28672
  v_mfma_f32_16x16x32_bf16 v[28:31], a[108:111], a[24:27], v[28:31]
  ds_read_b128 v[68:71], v253 offset:960
  v_mfma_f32_16x16x32_bf16 v[44:47], a[108:111], a[28:31], v[44:47]
  s_waitcnt vmcnt(12) lgkmcnt(10)
  s_barrier
  v_mfma_f32_16x16x32_bf16 v[72:75], a[80:83], a[32:35], v[72:75]
  ds_read_b64_tr_b16 a[108:109], v107 offset:24576
  s_add_u32 m0, s38, 0
  v_mfma_f32_16x16x32_bf16 v[88:91], a[80:83], a[36:39], v[88:91]
  buffer_load_dwordx4 v225, s[8:11], s17 offen lds
  v_mfma_f32_16x16x32_bf16 v[76:79], a[84:87], a[32:35], v[76:79]
  ds_read_b64_tr_b16 a[110:111], v107 offset:28672
  ds_read_b64_tr_b16 a[80:81], v104 offset:34816
  v_mfma_f32_16x16x32_bf16 v[92:95], a[84:87], a[36:39], v[92:95]
  ds_read_b64_tr_b16 a[82:83], v104 offset:38912
  ds_read_b64_tr_b16 a[84:85], v105 offset:34816
  v_mfma_f32_16x16x32_bf16 v[80:83], a[88:91], a[32:35], v[80:83]
  buffer_load_dwordx4 a[16:19], v240, s[4:7], s16 offen offset:0 sc1
  v_mfma_f32_16x16x32_bf16 v[96:99], a[88:91], a[36:39], v[96:99]
  ds_read_b64_tr_b16 a[86:87], v105 offset:38912
  ds_read_b64_tr_b16 a[88:89], v106 offset:34816
  v_mfma_f32_16x16x32_bf16 v[84:87], a[92:95], a[32:35], v[84:87]
  ds_read_b64_tr_b16 a[90:91], v106 offset:38912
  v_mfma_f32_16x16x32_bf16 v[100:103], a[92:95], a[36:39], v[100:103]
  ds_read_b64_tr_b16 a[92:93], v107 offset:34816
  ds_read_b64_tr_b16 a[94:95], v107 offset:38912
  v_mfma_f32_16x16x32_bf16 v[72:75], a[112:115], a[40:43], v[72:75]
  buffer_load_dwordx4 v226, s[8:11], s17 offen offset:1024 lds
  v_mfma_f32_16x16x32_bf16 v[88:91], a[112:115], a[44:47], v[88:91]
  ds_read_b64_tr_b16 a[112:113], v104 offset:43008
  ds_read_b64_tr_b16 a[114:115], v104 offset:47104
  v_mfma_f32_16x16x32_bf16 v[76:79], a[116:119], a[40:43], v[76:79]
  v_mfma_f32_16x16x32_bf16 v[92:95], a[116:119], a[44:47], v[92:95]
  ds_read_b64_tr_b16 a[116:117], v105 offset:43008
  ds_read_b64_tr_b16 a[118:119], v105 offset:47104
  v_mfma_f32_16x16x32_bf16 v[80:83], a[120:123], a[40:43], v[80:83]
  buffer_load_dwordx4 a[20:23], v240, s[4:7], s16 offen offset:1024 sc1
  v_mfma_f32_16x16x32_bf16 v[96:99], a[120:123], a[44:47], v[96:99]
  ds_read_b64_tr_b16 a[120:121], v106 offset:43008
  ds_read_b64_tr_b16 a[122:123], v106 offset:47104
  v_mfma_f32_16x16x32_bf16 v[84:87], a[124:127], a[40:43], v[84:87]
  v_mfma_f32_16x16x32_bf16 v[100:103], a[124:127], a[44:47], v[100:103]
  ds_read_b64_tr_b16 a[124:125], v107 offset:43008
  ds_read_b64_tr_b16 a[126:127], v107 offset:47104
  v_mfma_f32_16x16x32_bf16 v[16:19], a[64:67], a[32:35], v[16:19]
  buffer_load_dwordx4 v227, s[8:11], s17 offen offset:2048 lds
  v_mfma_f32_16x16x32_bf16 v[32:35], a[64:67], a[36:39], v[32:35]
  ds_read_b64_tr_b16 a[64:65], v104 offset:32768
  ds_read_b64_tr_b16 a[66:67], v104 offset:36864
  v_mfma_f32_16x16x32_bf16 v[20:23], a[68:71], a[32:35], v[20:23]
  v_mfma_f32_16x16x32_bf16 v[36:39], a[68:71], a[36:39], v[36:39]
  ds_read_b64_tr_b16 a[68:69], v105 offset:32768
  ds_read_b64_tr_b16 a[70:71], v105 offset:36864
  s_waitcnt lgkmcnt(10)
  v_mfma_f32_16x16x32_bf16 v[24:27], a[72:75], a[32:35], v[24:27]
  buffer_load_dwordx4 a[24:27], v241, s[4:7], s16 offen offset:0 sc1
  v_mfma_f32_16x16x32_bf16 v[40:43], a[72:75], a[36:39], v[40:43]
  ds_read_b64_tr_b16 a[72:73], v106 offset:32768
  ds_read_b64_tr_b16 a[74:75], v106 offset:36864
  v_mfma_f32_16x16x32_bf16 v[28:31], a[76:79], a[32:35], v[28:31]
  v_mfma_f32_16x16x32_bf16 v[44:47], a[76:79], a[36:39], v[44:47]
  buffer_load_dwordx4 v228, s[8:11], s17 offen offset:3072 lds
  v_mfma_f32_16x16x32_bf16 v[16:19], a[96:99], a[40:43], v[16:19]
  ds_read_b64_tr_b16 a[76:77], v107 offset:32768
  s_add_u32 s17, s17, 458752
  v_mfma_f32_16x16x32_bf16 v[32:35], a[96:99], a[44:47], v[32:35]
  ds_read_b64_tr_b16 a[78:79], v107 offset:36864
  s_cmp_eq_u32 s17, s93
  v_mfma_f32_16x16x32_bf16 v[20:23], a[100:103], a[40:43], v[20:23]
  ds_read_b64_tr_b16 a[96:97], v104 offset:40960
  s_cselect_b32 s17, s95, s17
  v_mfma_f32_16x16x32_bf16 v[36:39], a[100:103], a[44:47], v[36:39]
  buffer_load_dwordx4 a[28:31], v241, s[4:7], s16 offen offset:1024 sc1
  v_mfma_f32_16x16x32_bf16 v[24:27], a[104:107], a[40:43], v[24:27]
  ds_read_b64_tr_b16 a[98:99], v104 offset:45056
  s_add_u32 s41, s41, 262144
  v_mfma_f32_16x16x32_bf16 v[40:43], a[104:107], a[44:47], v[40:43]
  ds_read_b64_tr_b16 a[100:101], v105 offset:40960
  s_bitset0_b32 s41, 21
  v_mfma_f32_16x16x32_bf16 v[28:31], a[108:111], a[40:43], v[28:31]
  ds_read_b64_tr_b16 a[102:103], v105 offset:45056
  s_add_u32 s16, s40, s41
  v_mfma_f32_16x16x32_bf16 v[44:47], a[108:111], a[44:47], v[44:47]
  s_waitcnt vmcnt(12) lgkmcnt(10)
  s_barrier
  v_mfma_f32_16x16x32_bf16 v[72:75], a[80:83], a[48:51], v[72:75]
  ds_read_b64_tr_b16 a[104:105], v106 offset:40960
  ds_read_b64_tr_b16 a[106:107], v106 offset:45056
  s_add_u32 m0, s38, 16384
  v_mfma_f32_16x16x32_bf16 v[88:91], a[80:83], a[52:55], v[88:91]
  buffer_load_dwordx4 v225, s[8:11], s17 offen lds
  v_mfma_f32_16x16x32_bf16 v[76:79], a[84:87], a[48:51], v[76:79]
  ds_read_b64_tr_b16 a[108:109], v107 offset:40960
  ds_read_b64_tr_b16 a[110:111], v107 offset:45056
  v_mfma_f32_16x16x32_bf16 v[92:95], a[84:87], a[52:55], v[92:95]
  ds_read_b64_tr_b16 a[80:81], v104 offset:51200
  ds_read_b64_tr_b16 a[82:83], v104 offset:55296
  v_mfma_f32_16x16x32_bf16 v[80:83], a[88:91], a[48:51], v[80:83]
  buffer_load_dwordx4 a[32:35], v240, s[4:7], s16 offen offset:0 sc1
  v_mfma_f32_16x16x32_bf16 v[96:99], a[88:91], a[52:55], v[96:99]
  ds_read_b64_tr_b16 a[84:85], v105 offset:51200
  ds_read_b64_tr_b16 a[86:87], v105 offset:55296
  v_mfma_f32_16x16x32_bf16 v[84:87], a[92:95], a[48:51], v[84:87]
  ds_read_b64_tr_b16 a[88:89], v106 offset:51200
  ds_read_b64_tr_b16 a[90:91], v106 offset:55296
  v_mfma_f32_16x16x32_bf16 v[100:103], a[92:95], a[52:55], v[100:103]
  ds_read_b64_tr_b16 a[92:93], v107 offset:51200
  ds_read_b64_tr_b16 a[94:95], v107 offset:55296
  v_mfma_f32_16x16x32_bf16 v[72:75], a[112:115], a[56:59], v[72:75]
  buffer_load_dwordx4 v226, s[8:11], s17 offen offset:1024 lds
  v_mfma_f32_16x16x32_bf16 v[88:91], a[112:115], a[60:63], v[88:91]
  ds_read_b64_tr_b16 a[112:113], v104 offset:59392
  ds_read_b64_tr_b16 a[114:115], v104 offset:63488
  v_mfma_f32_16x16x32_bf16 v[76:79], a[116:119], a[56:59], v[76:79]
  v_mfma_f32_16x16x32_bf16 v[92:95], a[116:119], a[60:63], v[92:95]
  ds_read_b64_tr_b16 a[116:117], v105 offset:59392
  ds_read_b64_tr_b16 a[118:119], v105 offset:63488
  v_mfma_f32_16x16x32_bf16 v[80:83], a[120:123], a[56:59], v[80:83]
  buffer_load_dwordx4 a[36:39], v240, s[4:7], s16 offen offset:1024 sc1
  v_mfma_f32_16x16x32_bf16 v[96:99], a[120:123], a[60:63], v[96:99]
  ds_read_b64_tr_b16 a[120:121], v106 offset:59392
  ds_read_b64_tr_b16 a[122:123], v106 offset:63488
  v_mfma_f32_16x16x32_bf16 v[84:87], a[124:127], a[56:59], v[84:87]
  v_mfma_f32_16x16x32_bf16 v[100:103], a[124:127], a[60:63], v[100:103]
  ds_read_b64_tr_b16 a[124:125], v107 offset:59392
  ds_read_b64_tr_b16 a[126:127], v107 offset:63488
  v_mfma_f32_16x16x32_bf16 v[16:19], a[64:67], a[48:51], v[16:19]
  buffer_load_dwordx4 v227, s[8:11], s17 offen offset:2048 lds
  v_mfma_f32_16x16x32_bf16 v[32:35], a[64:67], a[52:55], v[32:35]
  ds_read_b64_tr_b16 a[64:65], v104 offset:49152
  ds_read_b64_tr_b16 a[66:67], v104 offset:53248
  s_waitcnt lgkmcnt(10)
  v_mfma_f32_16x16x32_bf16 v[20:23], a[68:71], a[48:51], v[20:23]
  v_mfma_f32_16x16x32_bf16 v[36:39], a[68:71], a[52:55], v[36:39]
  ds_read_b64_tr_b16 a[68:69], v105 offset:49152
  ds_read_b64_tr_b16 a[70:71], v105 offset:53248
  v_mfma_f32_16x16x32_bf16 v[24:27], a[72:75], a[48:51], v[24:27]
  buffer_load_dwordx4 a[40:43], v241, s[4:7], s16 offen offset:0 sc1
  v_mfma_f32_16x16x32_bf16 v[40:43], a[72:75], a[52:55], v[40:43]
  ds_read_b64_tr_b16 a[72:73], v106 offset:49152
  ds_read_b64_tr_b16 a[74:75], v106 offset:53248
  v_mfma_f32_16x16x32_bf16 v[28:31], a[76:79], a[48:51], v[28:31]
  v_mfma_f32_16x16x32_bf16 v[44:47], a[76:79], a[52:55], v[44:47]
  buffer_load_dwordx4 v228, s[8:11], s17 offen offset:3072 lds
  v_mfma_f32_16x16x32_bf16 v[16:19], a[96:99], a[56:59], v[16:19]
  ds_read_b64_tr_b16 a[76:77], v107 offset:49152
  s_add_u32 s17, s17, 458752
  v_mfma_f32_16x16x32_bf16 v[32:35], a[96:99], a[60:63], v[32:35]
  ds_read_b64_tr_b16 a[78:79], v107 offset:53248
  s_cmp_eq_u32 s17, s93
  v_mfma_f32_16x16x32_bf16 v[20:23], a[100:103], a[56:59], v[20:23]
  ds_read_b64_tr_b16 a[96:97], v104 offset:57344
  s_cselect_b32 s17, s95, s17
  v_mfma_f32_16x16x32_bf16 v[36:39], a[100:103], a[60:63], v[36:39]
  buffer_load_dwordx4 a[44:47], v241, s[4:7], s16 offen offset:1024 sc1
  v_mfma_f32_16x16x32_bf16 v[24:27], a[104:107], a[56:59], v[24:27]
  ds_read_b64_tr_b16 a[98:99], v104 offset:61440
  s_add_u32 s41, s41, 262144
  v_mfma_f32_16x16x32_bf16 v[40:43], a[104:107], a[60:63], v[40:43]
  ds_read_b64_tr_b16 a[100:101], v105 offset:57344
  s_bitset0_b32 s41, 21
  v_mfma_f32_16x16x32_bf16 v[28:31], a[108:111], a[56:59], v[28:31]
  ds_read_b64_tr_b16 a[102:103], v105 offset:61440
  s_add_u32 s16, s40, s41
  v_mfma_f32_16x16x32_bf16 v[44:47], a[108:111], a[60:63], v[44:47]
  s_waitcnt vmcnt(16) lgkmcnt(10)
  s_barrier
  v_mfma_f32_16x16x32_bf16 v[72:75], a[80:83], a[0:3], v[72:75]
  ds_read_b64_tr_b16 a[104:105], v106 offset:57344
  ds_read_b64_tr_b16 a[106:107], v106 offset:61440
  s_add_u32 m0, s38, 32768
  v_mfma_f32_16x16x32_bf16 v[88:91], a[80:83], a[4:7], v[88:91]
  buffer_load_dwordx4 v225, s[8:11], s17 offen lds
  v_mfma_f32_16x16x32_bf16 v[76:79], a[84:87], a[0:3], v[76:79]
  ds_read_b64_tr_b16 a[108:109], v107 offset:57344
  ds_read_b64_tr_b16 a[110:111], v107 offset:61440
  v_mfma_f32_16x16x32_bf16 v[92:95], a[84:87], a[4:7], v[92:95]
  ds_read_b64_tr_b16 a[80:81], v124 offset:2048
  ds_read_b64_tr_b16 a[82:83], v124 offset:6144
  v_mfma_f32_16x16x32_bf16 v[80:83], a[88:91], a[0:3], v[80:83]
  buffer_load_dwordx4 a[48:51], v240, s[4:7], s16 offen offset:0 sc1
  v_mfma_f32_16x16x32_bf16 v[96:99], a[88:91], a[4:7], v[96:99]
  ds_read_b64_tr_b16 a[84:85], v125 offset:2048
  ds_read_b64_tr_b16 a[86:87], v125 offset:6144
  v_mfma_f32_16x16x32_bf16 v[84:87], a[92:95], a[0:3], v[84:87]
  ds_read_b64_tr_b16 a[88:89], v126 offset:2048
  ds_read_b64_tr_b16 a[90:91], v126 offset:6144
  v_mfma_f32_16x16x32_bf16 v[100:103], a[92:95], a[4:7], v[100:103]
  ds_read_b64_tr_b16 a[92:93], v127 offset:2048
  ds_read_b64_tr_b16 a[94:95], v127 offset:6144
  v_mfma_f32_16x16x32_bf16 v[72:75], a[112:115], a[8:11], v[72:75]
  buffer_load_dwordx4 v226, s[8:11], s17 offen offset:1024 lds
  v_mfma_f32_16x16x32_bf16 v[88:91], a[112:115], a[12:15], v[88:91]
  ds_read_b64_tr_b16 a[112:113], v124 offset:10240
  ds_read_b64_tr_b16 a[114:115], v124 offset:14336
  v_mfma_f32_16x16x32_bf16 v[76:79], a[116:119], a[8:11], v[76:79]
  v_mfma_f32_16x16x32_bf16 v[92:95], a[116:119], a[12:15], v[92:95]
  ds_read_b64_tr_b16 a[116:117], v125 offset:10240
  ds_read_b64_tr_b16 a[118:119], v125 offset:14336
  v_mfma_f32_16x16x32_bf16 v[80:83], a[120:123], a[8:11], v[80:83]
  buffer_load_dwordx4 a[52:55], v240, s[4:7], s16 offen offset:1024 sc1
  v_mfma_f32_16x16x32_bf16 v[96:99], a[120:123], a[12:15], v[96:99]
  ds_read_b64_tr_b16 a[120:121], v126 offset:10240
  ds_read_b64_tr_b16 a[122:123], v126 offset:14336
  v_mfma_f32_16x16x32_bf16 v[84:87], a[124:127], a[8:11], v[84:87]
  v_mfma_f32_16x16x32_bf16 v[100:103], a[124:127], a[12:15], v[100:103]
  ds_read_b64_tr_b16 a[124:125], v127 offset:10240
  ds_read_b64_tr_b16 a[126:127], v127 offset:14336
  v_mfma_f32_16x16x32_bf16 v[16:19], a[64:67], a[0:3], v[16:19]
  buffer_load_dwordx4 v227, s[8:11], s17 offen offset:2048 lds
  v_mfma_f32_16x16x32_bf16 v[32:35], a[64:67], a[4:7], v[32:35]
  ds_read_b64_tr_b16 a[64:65], v124 offset:0
  ds_read_b64_tr_b16 a[66:67], v124 offset:4096
  s_waitcnt lgkmcnt(10)
  v_mfma_f32_16x16x32_bf16 v[20:23], a[68:71], a[0:3], v[20:23]
  v_mfma_f32_16x16x32_bf16 v[36:39], a[68:71], a[4:7], v[36:39]
  ds_read_b64_tr_b16 a[68:69], v125 offset:0
  ds_read_b64_tr_b16 a[70:71], v125 offset:4096
  v_mfma_f32_16x16x32_bf16 v[24:27], a[72:75], a[0:3], v[24:27]
  buffer_load_dwordx4 a[56:59], v241, s[4:7], s16 offen offset:0 sc1
  v_mfma_f32_16x16x32_bf16 v[40:43], a[72:75], a[4:7], v[40:43]
  ds_read_b64_tr_b16 a[72:73], v126 offset:0
  ds_read_b64_tr_b16 a[74:75], v126 offset:4096
  v_mfma_f32_16x16x32_bf16 v[28:31], a[76:79], a[0:3], v[28:31]
  v_mfma_f32_16x16x32_bf16 v[44:47], a[76:79], a[4:7], v[44:47]
  buffer_load_dwordx4 v228, s[8:11], s17 offen offset:3072 lds
  v_mfma_f32_16x16x32_bf16 v[16:19], a[96:99], a[8:11], v[16:19]
  ds_read_b64_tr_b16 a[76:77], v127 offset:0
  s_add_u32 s17, s17, 458752
  v_mfma_f32_16x16x32_bf16 v[32:35], a[96:99], a[12:15], v[32:35]
  ds_read_b64_tr_b16 a[78:79], v127 offset:4096
  s_cmp_eq_u32 s17, s93
  v_mfma_f32_16x16x32_bf16 v[20:23], a[100:103], a[8:11], v[20:23]
  ds_read_b64_tr_b16 a[96:97], v124 offset:8192
  s_cselect_b32 s17, s95, s17
  v_mfma_f32_16x16x32_bf16 v[36:39], a[100:103], a[12:15], v[36:39]
  buffer_load_dwordx4 a[60:63], v241, s[4:7], s16 offen offset:1024 sc1
  v_mfma_f32_16x16x32_bf16 v[24:27], a[104:107], a[8:11], v[24:27]
  ds_read_b64_tr_b16 a[98:99], v124 offset:12288
  s_add_u32 s41, s41, 262144
  v_mfma_f32_16x16x32_bf16 v[40:43], a[104:107], a[12:15], v[40:43]
  ds_read_b64_tr_b16 a[100:101], v125 offset:8192
  s_bitset0_b32 s41, 21
  v_mfma_f32_16x16x32_bf16 v[28:31], a[108:111], a[8:11], v[28:31]
  ds_read_b64_tr_b16 a[102:103], v125 offset:12288
  s_add_u32 s16, s40, s41
  v_mfma_f32_16x16x32_bf16 v[44:47], a[108:111], a[12:15], v[44:47]
  s_waitcnt vmcnt(16) lgkmcnt(10)
  s_barrier
  v_mfma_f32_16x16x32_bf16 v[72:75], a[80:83], a[16:19], v[72:75]
  ds_read_b64_tr_b16 a[104:105], v126 offset:8192
  ds_read_b64_tr_b16 a[106:107], v126 offset:12288
  s_add_u32 m0, s38, 49152
  v_mfma_f32_16x16x32_bf16 v[88:91], a[80:83], a[20:23], v[88:91]
  buffer_load_dwordx4 v225, s[8:11], s17 offen lds
  v_mfma_f32_16x16x32_bf16 v[76:79], a[84:87], a[16:19], v[76:79]
  ds_read_b64_tr_b16 a[108:109], v127 offset:8192
  ds_read_b64_tr_b16 a[110:111], v127 offset:12288
  v_mfma_f32_16x16x32_bf16 v[92:95], a[84:87], a[20:23], v[92:95]
  ds_read_b64_tr_b16 a[80:81], v242 offset:2048
  ds_read_b64_tr_b16 a[82:83], v242 offset:6144
  v_mfma_f32_16x16x32_bf16 v[80:83], a[88:91], a[16:19], v[80:83]
  buffer_load_dwordx4 a[0:3], v240, s[4:7], s16 offen offset:0 sc1
  v_mfma_f32_16x16x32_bf16 v[96:99], a[88:91], a[20:23], v[96:99]
  ds_read_b64_tr_b16 a[84:85], v243 offset:2048
  ds_read_b64_tr_b16 a[86:87], v243 offset:6144
  v_mfma_f32_16x16x32_bf16 v[84:87], a[92:95], a[16:19], v[84:87]
  ds_read_b64_tr_b16 a[88:89], v244 offset:2048
  ds_read_b64_tr_b16 a[90:91], v244 offset:6144
  v_mfma_f32_16x16x32_bf16 v[100:103], a[92:95], a[20:23], v[100:103]
  ds_read_b64_tr_b16 a[92:93], v245 offset:2048
  ds_read_b64_tr_b16 a[94:95], v245 offset:6144
  v_mfma_f32_16x16x32_bf16 v[72:75], a[112:115], a[24:27], v[72:75]
  buffer_load_dwordx4 v226, s[8:11], s17 offen offset:1024 lds
  v_mfma_f32_16x16x32_bf16 v[88:91], a[112:115], a[28:31], v[88:91]
  ds_read_b64_tr_b16 a[112:113], v242 offset:10240
  ds_read_b64_tr_b16 a[114:115], v242 offset:14336
  v_mfma_f32_16x16x32_bf16 v[76:79], a[116:119], a[24:27], v[76:79]
  v_mfma_f32_16x16x32_bf16 v[92:95], a[116:119], a[28:31], v[92:95]
  ds_read_b64_tr_b16 a[116:117], v243 offset:10240
  ds_read_b64_tr_b16 a[118:119], v243 offset:14336
  v_mfma_f32_16x16x32_bf16 v[80:83], a[120:123], a[24:27], v[80:83]
  buffer_load_dwordx4 a[4:7], v240, s[4:7], s16 offen offset:1024 sc1
  v_mfma_f32_16x16x32_bf16 v[96:99], a[120:123], a[28:31], v[96:99]
  ds_read_b64_tr_b16 a[120:121], v244 offset:10240
  ds_read_b64_tr_b16 a[122:123], v244 offset:14336
  v_mfma_f32_16x16x32_bf16 v[84:87], a[124:127], a[24:27], v[84:87]
  v_mfma_f32_16x16x32_bf16 v[100:103], a[124:127], a[28:31], v[100:103]
  ds_read_b64_tr_b16 a[124:125], v245 offset:10240
  ds_read_b64_tr_b16 a[126:127], v245 offset:14336
  v_mfma_f32_16x16x32_bf16 v[16:19], a[64:67], a[16:19], v[16:19]
  buffer_load_dwordx4 v227, s[8:11], s17 offen offset:2048 lds
  v_mfma_f32_16x16x32_bf16 v[32:35], a[64:67], a[20:23], v[32:35]
  ds_read_b64_tr_b16 a[64:65], v242 offset:0
  ds_read_b64_tr_b16 a[66:67], v242 offset:4096
  s_waitcnt lgkmcnt(10)
  v_mfma_f32_16x16x32_bf16 v[20:23], a[68:71], a[16:19], v[20:23]
  v_mfma_f32_16x16x32_bf16 v[36:39], a[68:71], a[20:23], v[36:39]
  ds_read_b64_tr_b16 a[68:69], v243 offset:0
  ds_read_b64_tr_b16 a[70:71], v243 offset:4096
  v_mfma_f32_16x16x32_bf16 v[24:27], a[72:75], a[16:19], v[24:27]
  buffer_load_dwordx4 a[8:11], v241, s[4:7], s16 offen offset:0 sc1
  v_mfma_f32_16x16x32_bf16 v[40:43], a[72:75], a[20:23], v[40:43]
  ds_read_b64_tr_b16 a[72:73], v244 offset:0
  ds_read_b64_tr_b16 a[74:75], v244 offset:4096
  v_mfma_f32_16x16x32_bf16 v[28:31], a[76:79], a[16:19], v[28:31]
  v_mfma_f32_16x16x32_bf16 v[44:47], a[76:79], a[20:23], v[44:47]
  buffer_load_dwordx4 v228, s[8:11], s17 offen offset:3072 lds
  v_mfma_f32_16x16x32_bf16 v[16:19], a[96:99], a[24:27], v[16:19]
  ds_read_b64_tr_b16 a[76:77], v245 offset:0
  s_add_u32 s17, s17, 458752
  v_mfma_f32_16x16x32_bf16 v[32:35], a[96:99], a[28:31], v[32:35]
  ds_read_b64_tr_b16 a[78:79], v245 offset:4096
  s_cmp_eq_u32 s17, s93
  v_mfma_f32_16x16x32_bf16 v[20:23], a[100:103], a[24:27], v[20:23]
  ds_read_b64_tr_b16 a[96:97], v242 offset:8192
  s_cselect_b32 s17, s95, s17
  v_mfma_f32_16x16x32_bf16 v[36:39], a[100:103], a[28:31], v[36:39]
  buffer_load_dwordx4 a[12:15], v241, s[4:7], s16 offen offset:1024 sc1
  v_mfma_f32_16x16x32_bf16 v[24:27], a[104:107], a[24:27], v[24:27]
  ds_read_b64_tr_b16 a[98:99], v242 offset:12288
  s_add_u32 s41, s41, 262144
  v_mfma_f32_16x16x32_bf16 v[40:43], a[104:107], a[28:31], v[40:43]
  ds_read_b64_tr_b16 a[100:101], v243 offset:8192
  s_bitset0_b32 s41, 21
  v_mfma_f32_16x16x32_bf16 v[28:31], a[108:111], a[24:27], v[28:31]
  ds_read_b64_tr_b16 a[102:103], v243 offset:12288
  s_add_u32 s16, s40, s41
  v_mfma_f32_16x16x32_bf16 v[44:47], a[108:111], a[28:31], v[44:47]
  s_waitcnt vmcnt(16) lgkmcnt(10)
  s_barrier
  v_mfma_f32_16x16x32_bf16 v[72:75], a[80:83], a[32:35], v[72:75]
  ds_read_b64_tr_b16 a[104:105], v244 offset:8192
  ds_read_b64_tr_b16 a[106:107], v244 offset:12288
  s_add_u32 m0, s38, 65536
  v_mfma_f32_16x16x32_bf16 v[88:91], a[80:83], a[36:39], v[88:91]
  buffer_load_dwordx4 v225, s[8:11], s17 offen lds
  v_mfma_f32_16x16x32_bf16 v[76:79], a[84:87], a[32:35], v[76:79]
  ds_read_b64_tr_b16 a[108:109], v245 offset:8192
  ds_read_b64_tr_b16 a[110:111], v245 offset:12288
  v_mfma_f32_16x16x32_bf16 v[92:95], a[84:87], a[36:39], v[92:95]
  ds_read_b64_tr_b16 a[80:81], v242 offset:18432
  ds_read_b64_tr_b16 a[82:83], v242 offset:22528
  v_mfma_f32_16x16x32_bf16 v[80:83], a[88:91], a[32:35], v[80:83]
  buffer_load_dwordx4 a[16:19], v240, s[4:7], s16 offen offset:0 sc1
  v_mfma_f32_16x16x32_bf16 v[96:99], a[88:91], a[36:39], v[96:99]
  ds_read_b64_tr_b16 a[84:85], v243 offset:18432
  ds_read_b64_tr_b16 a[86:87], v243 offset:22528
  v_mfma_f32_16x16x32_bf16 v[84:87], a[92:95], a[32:35], v[84:87]
  ds_read_b64_tr_b16 a[88:89], v244 offset:18432
  ds_read_b64_tr_b16 a[90:91], v244 offset:22528
  v_mfma_f32_16x16x32_bf16 v[100:103], a[92:95], a[36:39], v[100:103]
  ds_read_b64_tr_b16 a[92:93], v245 offset:18432
  ds_read_b64_tr_b16 a[94:95], v245 offset:22528
  v_mfma_f32_16x16x32_bf16 v[72:75], a[112:115], a[40:43], v[72:75]
  buffer_load_dwordx4 v226, s[8:11], s17 offen offset:1024 lds
  v_mfma_f32_16x16x32_bf16 v[88:91], a[112:115], a[44:47], v[88:91]
  ds_read_b64_tr_b16 a[112:113], v242 offset:26624
  ds_read_b64_tr_b16 a[114:115], v242 offset:30720
  v_mfma_f32_16x16x32_bf16 v[76:79], a[116:119], a[40:43], v[76:79]
  v_mfma_f32_16x16x32_bf16 v[92:95], a[116:119], a[44:47], v[92:95]
  ds_read_b64_tr_b16 a[116:117], v243 offset:26624
  ds_read_b64_tr_b16 a[118:119], v243 offset:30720
  v_mfma_f32_16x16x32_bf16 v[80:83], a[120:123], a[40:43], v[80:83]
  buffer_load_dwordx4 a[20:23], v240, s[4:7], s16 offen offset:1024 sc1
  v_mfma_f32_16x16x32_bf16 v[96:99], a[120:123], a[44:47], v[96:99]
  ds_read_b64_tr_b16 a[120:121], v244 offset:26624
  ds_read_b64_tr_b16 a[122:123], v244 offset:30720
  v_mfma_f32_16x16x32_bf16 v[84:87], a[124:127], a[40:43], v[84:87]
  v_mfma_f32_16x16x32_bf16 v[100:103], a[124:127], a[44:47], v[100:103]
  ds_read_b64_tr_b16 a[124:125], v245 offset:26624
  ds_read_b64_tr_b16 a[126:127], v245 offset:30720
  v_mfma_f32_16x16x32_bf16 v[16:19], a[64:67], a[32:35], v[16:19]
  buffer_load_dwordx4 v227, s[8:11], s17 offen offset:2048 lds
  v_mfma_f32_16x16x32_bf16 v[32:35], a[64:67], a[36:39], v[32:35]
  ds_read_b64_tr_b16 a[64:65], v242 offset:16384
  ds_read_b64_tr_b16 a[66:67], v242 offset:20480
  s_waitcnt lgkmcnt(10)
  v_mfma_f32_16x16x32_bf16 v[20:23], a[68:71], a[32:35], v[20:23]
  v_mfma_f32_16x16x32_bf16 v[36:39], a[68:71], a[36:39], v[36:39]
  ds_read_b64_tr_b16 a[68:69], v243 offset:16384
  ds_read_b64_tr_b16 a[70:71], v243 offset:20480
  v_mfma_f32_16x16x32_bf16 v[24:27], a[72:75], a[32:35], v[24:27]
  buffer_load_dwordx4 a[24:27], v241, s[4:7], s16 offen offset:0 sc1
  v_mfma_f32_16x16x32_bf16 v[40:43], a[72:75], a[36:39], v[40:43]
  ds_read_b64_tr_b16 a[72:73], v244 offset:16384
  ds_read_b64_tr_b16 a[74:75], v244 offset:20480
  v_mfma_f32_16x16x32_bf16 v[28:31], a[76:79], a[32:35], v[28:31]
  v_mfma_f32_16x16x32_bf16 v[44:47], a[76:79], a[36:39], v[44:47]
  buffer_load_dwordx4 v228, s[8:11], s17 offen offset:3072 lds
  v_mfma_f32_16x16x32_bf16 v[16:19], a[96:99], a[40:43], v[16:19]
  ds_read_b64_tr_b16 a[76:77], v245 offset:16384
  s_add_u32 s17, s17, 458752
  v_mfma_f32_16x16x32_bf16 v[32:35], a[96:99], a[44:47], v[32:35]
  ds_read_b64_tr_b16 a[78:79], v245 offset:20480
  s_cmp_eq_u32 s17, s93
  v_mfma_f32_16x16x32_bf16 v[20:23], a[100:103], a[40:43], v[20:23]
  ds_read_b64_tr_b16 a[96:97], v242 offset:24576
  s_cselect_b32 s17, s95, s17
  v_mfma_f32_16x16x32_bf16 v[36:39], a[100:103], a[44:47], v[36:39]
  buffer_load_dwordx4 a[28:31], v241, s[4:7], s16 offen offset:1024 sc1
  v_mfma_f32_16x16x32_bf16 v[24:27], a[104:107], a[40:43], v[24:27]
  ds_read_b64_tr_b16 a[98:99], v242 offset:28672
  s_add_u32 s41, s41, 262144
  v_mfma_f32_16x16x32_bf16 v[40:43], a[104:107], a[44:47], v[40:43]
  ds_read_b64_tr_b16 a[100:101], v243 offset:24576
  s_bitset0_b32 s41, 21
  v_mfma_f32_16x16x32_bf16 v[28:31], a[108:111], a[40:43], v[28:31]
  ds_read_b64_tr_b16 a[102:103], v243 offset:28672
  s_add_u32 s16, s40, s41
  v_mfma_f32_16x16x32_bf16 v[44:47], a[108:111], a[44:47], v[44:47]
  s_waitcnt vmcnt(16) lgkmcnt(10)
  s_barrier
  v_mfma_f32_16x16x32_bf16 v[72:75], a[80:83], a[48:51], v[72:75]
  ds_read_b64_tr_b16 a[104:105], v244 offset:24576
  ds_read_b64_tr_b16 a[106:107], v244 offset:28672
  s_add_u32 m0, s38, 81920
  v_mfma_f32_16x16x32_bf16 v[88:91], a[80:83], a[52:55], v[88:91]
  buffer_load_dwordx4 v225, s[8:11], s17 offen lds
  v_mfma_f32_16x16x32_bf16 v[76:79], a[84:87], a[48:51], v[76:79]
  ds_read_b64_tr_b16 a[108:109], v245 offset:24576
  ds_read_b64_tr_b16 a[110:111], v245 offset:28672
  v_mfma_f32_16x16x32_bf16 v[92:95], a[84:87], a[52:55], v[92:95]
  ds_read_b64_tr_b16 a[80:81], v242 offset:34816
  ds_read_b64_tr_b16 a[82:83], v242 offset:38912
  v_mfma_f32_16x16x32_bf16 v[80:83], a[88:91], a[48:51], v[80:83]
  buffer_load_dwordx4 a[32:35], v240, s[4:7], s16 offen offset:0 sc1
  v_mfma_f32_16x16x32_bf16 v[96:99], a[88:91], a[52:55], v[96:99]
  ds_read_b64_tr_b16 a[84:85], v243 offset:34816
  ds_read_b64_tr_b16 a[86:87], v243 offset:38912
  v_mfma_f32_16x16x32_bf16 v[84:87], a[92:95], a[48:51], v[84:87]
  ds_read_b64_tr_b16 a[88:89], v244 offset:34816
  ds_read_b64_tr_b16 a[90:91], v244 offset:38912
  v_mfma_f32_16x16x32_bf16 v[100:103], a[92:95], a[52:55], v[100:103]
  ds_read_b64_tr_b16 a[92:93], v245 offset:34816
  ds_read_b64_tr_b16 a[94:95], v245 offset:38912
  v_mfma_f32_16x16x32_bf16 v[72:75], a[112:115], a[56:59], v[72:75]
  buffer_load_dwordx4 v226, s[8:11], s17 offen offset:1024 lds
  v_mfma_f32_16x16x32_bf16 v[88:91], a[112:115], a[60:63], v[88:91]
  ds_read_b64_tr_b16 a[112:113], v242 offset:43008
  ds_read_b64_tr_b16 a[114:115], v242 offset:47104
  v_mfma_f32_16x16x32_bf16 v[76:79], a[116:119], a[56:59], v[76:79]
  v_mfma_f32_16x16x32_bf16 v[92:95], a[116:119], a[60:63], v[92:95]
  ds_read_b64_tr_b16 a[116:117], v243 offset:43008
  ds_read_b64_tr_b16 a[118:119], v243 offset:47104
  v_mfma_f32_16x16x32_bf16 v[80:83], a[120:123], a[56:59], v[80:83]
  buffer_load_dwordx4 a[36:39], v240, s[4:7], s16 offen offset:1024 sc1
  v_mfma_f32_16x16x32_bf16 v[96:99], a[120:123], a[60:63], v[96:99]
  ds_read_b64_tr_b16 a[120:121], v244 offset:43008
  ds_read_b64_tr_b16 a[122:123], v244 offset:47104
  v_mfma_f32_16x16x32_bf16 v[84:87], a[124:127], a[56:59], v[84:87]
  v_mfma_f32_16x16x32_bf16 v[100:103], a[124:127], a[60:63], v[100:103]
  ds_read_b64_tr_b16 a[124:125], v245 offset:43008
  ds_read_b64_tr_b16 a[126:127], v245 offset:47104
  v_mfma_f32_16x16x32_bf16 v[16:19], a[64:67], a[48:51], v[16:19]
  buffer_load_dwordx4 v227, s[8:11], s17 offen offset:2048 lds
  v_mfma_f32_16x16x32_bf16 v[32:35], a[64:67], a[52:55], v[32:35]
  ds_read_b64_tr_b16 a[64:65], v242 offset:32768
  ds_read_b64_tr_b16 a[66:67], v242 offset:36864
  s_waitcnt lgkmcnt(10)
  v_mfma_f32_16x16x32_bf16 v[20:23], a[68:71], a[48:51], v[20:23]
  v_mfma_f32_16x16x32_bf16 v[36:39], a[68:71], a[52:55], v[36:39]
  ds_read_b64_tr_b16 a[68:69], v243 offset:32768
  ds_read_b64_tr_b16 a[70:71], v243 offset:36864
  v_mfma_f32_16x16x32_bf16 v[24:27], a[72:75], a[48:51], v[24:27]
  buffer_load_dwordx4 a[40:43], v241, s[4:7], s16 offen offset:0 sc1
  v_mfma_f32_16x16x32_bf16 v[40:43], a[72:75], a[52:55], v[40:43]
  ds_read_b64_tr_b16 a[72:73], v244 offset:32768
  ds_read_b64_tr_b16 a[74:75], v244 offset:36864
  v_mfma_f32_16x16x32_bf16 v[28:31], a[76:79], a[48:51], v[28:31]
  v_mfma_f32_16x16x32_bf16 v[44:47], a[76:79], a[52:55], v[44:47]
  ds_read_b64_tr_b16 a[76:77], v245 offset:32768
  ds_read_b64_tr_b16 a[78:79], v245 offset:36864
  v_mfma_f32_16x16x32_bf16 v[16:19], a[96:99], a[56:59], v[16:19]
  buffer_load_dwordx4 v228, s[8:11], s17 offen offset:3072 lds
  v_mfma_f32_16x16x32_bf16 v[32:35], a[96:99], a[60:63], v[32:35]
  ds_read_b64_tr_b16 a[96:97], v242 offset:40960
  s_mov_b32 s17, s97
  v_mfma_f32_16x16x32_bf16 v[20:23], a[100:103], a[56:59], v[20:23]
  ds_read_b64_tr_b16 a[98:99], v242 offset:45056
  v_mfma_f32_16x16x32_bf16 v[36:39], a[100:103], a[60:63], v[36:39]
  buffer_load_dwordx4 a[44:47], v241, s[4:7], s16 offen offset:1024 sc1
  v_mfma_f32_16x16x32_bf16 v[24:27], a[104:107], a[56:59], v[24:27]
  ds_read_b64_tr_b16 a[100:101], v243 offset:40960
  s_add_u32 s41, s41, 262144
  v_mfma_f32_16x16x32_bf16 v[40:43], a[104:107], a[60:63], v[40:43]
  ds_read_b64_tr_b16 a[102:103], v243 offset:45056
  s_bitset0_b32 s41, 21
  v_mfma_f32_16x16x32_bf16 v[28:31], a[108:111], a[56:59], v[28:31]
  ds_read_b64_tr_b16 a[104:105], v244 offset:40960
  s_add_u32 s16, s40, s41
  v_mfma_f32_16x16x32_bf16 v[44:47], a[108:111], a[60:63], v[44:47]
  s_waitcnt vmcnt(16) lgkmcnt(10)
  s_barrier
  v_mfma_f32_16x16x32_bf16 v[72:75], a[80:83], a[0:3], v[72:75]
  ds_read_b64_tr_b16 a[106:107], v244 offset:45056
  s_add_u32 m0, s38, 98304
  v_mfma_f32_16x16x32_bf16 v[88:91], a[80:83], a[4:7], v[88:91]
  buffer_load_dwordx4 v227, s[8:11], s17 offen offset:2048 lds
  v_mfma_f32_16x16x32_bf16 v[76:79], a[84:87], a[0:3], v[76:79]
  ds_read_b64_tr_b16 a[108:109], v245 offset:40960
  ds_read_b64_tr_b16 a[110:111], v245 offset:45056
  v_mfma_f32_16x16x32_bf16 v[92:95], a[84:87], a[4:7], v[92:95]
  ds_read_b64_tr_b16 a[80:81], v242 offset:51200
  ds_read_b64_tr_b16 a[82:83], v242 offset:55296
  v_mfma_f32_16x16x32_bf16 v[80:83], a[88:91], a[0:3], v[80:83]
  buffer_load_dwordx4 a[48:51], v240, s[4:7], s16 offen offset:0 sc1
  v_mfma_f32_16x16x32_bf16 v[96:99], a[88:91], a[4:7], v[96:99]
  ds_read_b64_tr_b16 a[84:85], v243 offset:51200
  ds_read_b64_tr_b16 a[86:87], v243 offset:55296
  v_mfma_f32_16x16x32_bf16 v[84:87], a[92:95], a[0:3], v[84:87]
  ds_read_b64_tr_b16 a[88:89], v244 offset:51200
  ds_read_b64_tr_b16 a[90:91], v244 offset:55296
  v_mfma_f32_16x16x32_bf16 v[100:103], a[92:95], a[4:7], v[100:103]
  ds_read_b64_tr_b16 a[92:93], v245 offset:51200
  ds_read_b64_tr_b16 a[94:95], v245 offset:55296
  v_mfma_f32_16x16x32_bf16 v[72:75], a[112:115], a[8:11], v[72:75]
  buffer_load_dwordx4 v228, s[8:11], s17 offen offset:3072 lds
  v_mfma_f32_16x16x32_bf16 v[88:91], a[112:115], a[12:15], v[88:91]
  ds_read_b64_tr_b16 a[112:113], v242 offset:59392
  s_add_u32 s17, s17, 917504
  v_mfma_f32_16x16x32_bf16 v[76:79], a[116:119], a[8:11], v[76:79]
  ds_read_b64_tr_b16 a[114:115], v242 offset:63488
  v_mfma_f32_16x16x32_bf16 v[92:95], a[116:119], a[12:15], v[92:95]
  ds_read_b64_tr_b16 a[116:117], v243 offset:59392
  ds_read_b64_tr_b16 a[118:119], v243 offset:63488
  v_mfma_f32_16x16x32_bf16 v[80:83], a[120:123], a[8:11], v[80:83]
  buffer_load_dwordx4 a[52:55], v240, s[4:7], s16 offen offset:1024 sc1
  v_mfma_f32_16x16x32_bf16 v[96:99], a[120:123], a[12:15], v[96:99]
  ds_read_b64_tr_b16 a[120:121], v244 offset:59392
  s_add_u32 m0, s38, 96256
  v_mfma_f32_16x16x32_bf16 v[84:87], a[124:127], a[8:11], v[84:87]
  ds_read_b64_tr_b16 a[122:123], v244 offset:63488
  v_mfma_f32_16x16x32_bf16 v[100:103], a[124:127], a[12:15], v[100:103]
  ds_read_b64_tr_b16 a[124:125], v245 offset:59392
  ds_read_b64_tr_b16 a[126:127], v245 offset:63488
  v_mfma_f32_16x16x32_bf16 v[16:19], a[64:67], a[0:3], v[16:19]
  buffer_load_dwordx4 v227, s[8:11], s17 offen offset:2048 lds
  v_mfma_f32_16x16x32_bf16 v[32:35], a[64:67], a[4:7], v[32:35]
  ds_read_b64_tr_b16 a[64:65], v242 offset:49152
  ds_read_b64_tr_b16 a[66:67], v242 offset:53248
  s_waitcnt lgkmcnt(10)
  v_mfma_f32_16x16x32_bf16 v[20:23], a[68:71], a[0:3], v[20:23]
  v_mfma_f32_16x16x32_bf16 v[36:39], a[68:71], a[4:7], v[36:39]
  ds_read_b64_tr_b16 a[68:69], v243 offset:49152
  ds_read_b64_tr_b16 a[70:71], v243 offset:53248
  v_mfma_f32_16x16x32_bf16 v[24:27], a[72:75], a[0:3], v[24:27]
  buffer_load_dwordx4 a[56:59], v241, s[4:7], s16 offen offset:0 sc1
  v_mfma_f32_16x16x32_bf16 v[40:43], a[72:75], a[4:7], v[40:43]
  ds_read_b64_tr_b16 a[72:73], v244 offset:49152
  ds_read_b64_tr_b16 a[74:75], v244 offset:53248
  v_mfma_f32_16x16x32_bf16 v[28:31], a[76:79], a[0:3], v[28:31]
  v_mfma_f32_16x16x32_bf16 v[44:47], a[76:79], a[4:7], v[44:47]
  ds_read_b64_tr_b16 a[76:77], v245 offset:49152
  ds_read_b64_tr_b16 a[78:79], v245 offset:53248
  v_mfma_f32_16x16x32_bf16 v[16:19], a[96:99], a[8:11], v[16:19]
  buffer_load_dwordx4 v228, s[8:11], s17 offen offset:3072 lds
  v_mfma_f32_16x16x32_bf16 v[32:35], a[96:99], a[12:15], v[32:35]
  ds_read_b64_tr_b16 a[96:97], v242 offset:57344
  s_add_u32 s17, s17, 917504
  v_mfma_f32_16x16x32_bf16 v[20:23], a[100:103], a[8:11], v[20:23]
  ds_read_b64_tr_b16 a[98:99], v242 offset:61440
  v_mfma_f32_16x16x32_bf16 v[36:39], a[100:103], a[12:15], v[36:39]
  ds_read_b64_tr_b16 a[100:101], v243 offset:57344
  ds_read_b64_tr_b16 a[102:103], v243 offset:61440
  v_mfma_f32_16x16x32_bf16 v[24:27], a[104:107], a[8:11], v[24:27]
  buffer_load_dwordx4 a[60:63], v241, s[4:7], s16 offen offset:1024 sc1
  v_mfma_f32_16x16x32_bf16 v[40:43], a[104:107], a[12:15], v[40:43]
  ds_read_b64_tr_b16 a[104:105], v244 offset:57344
  s_add_u32 s16, s40, 2097152
  v_mfma_f32_16x16x32_bf16 v[28:31], a[108:111], a[8:11], v[28:31]
  ds_read_b64_tr_b16 a[106:107], v244 offset:61440
  v_mfma_f32_16x16x32_bf16 v[44:47], a[108:111], a[12:15], v[44:47]
  s_waitcnt vmcnt(16) lgkmcnt(10)
  s_barrier
  v_mfma_f32_16x16x32_bf16 v[72:75], a[80:83], a[16:19], v[72:75]
  buffer_load_dwordx4 v[128:131], v240, s[4:7], s16 offen offset:0 sc1
  v_mfma_f32_16x16x32_bf16 v[88:91], a[80:83], a[20:23], v[88:91]
  ds_read_b64_tr_b16 a[108:109], v245 offset:57344
  ds_read_b64_tr_b16 a[110:111], v245 offset:61440
  v_mfma_f32_16x16x32_bf16 v[76:79], a[84:87], a[16:19], v[76:79]
  ds_read_b64_tr_b16 a[80:81], v104 offset:2048
  ds_read_b64_tr_b16 a[82:83], v104 offset:6144
  v_mfma_f32_16x16x32_bf16 v[92:95], a[84:87], a[20:23], v[92:95]
  buffer_load_dwordx4 v[132:135], v240, s[4:7], s16 offen offset:1024 sc1
  v_mfma_f32_16x16x32_bf16 v[80:83], a[88:91], a[16:19], v[80:83]
  ds_read_b64_tr_b16 a[84:85], v105 offset:2048
  ds_read_b64_tr_b16 a[86:87], v105 offset:6144
  v_mfma_f32_16x16x32_bf16 v[96:99], a[88:91], a[20:23], v[96:99]
  ds_read_b64_tr_b16 a[88:89], v106 offset:2048
  ds_read_b64_tr_b16 a[90:91], v106 offset:6144
  v_mfma_f32_16x16x32_bf16 v[84:87], a[92:95], a[16:19], v[84:87]
  v_mfma_f32_16x16x32_bf16 v[100:103], a[92:95], a[20:23], v[100:103]
  buffer_load_dwordx4 v[136:139], v241, s[4:7], s16 offen offset:0 sc1
  v_mfma_f32_16x16x32_bf16 v[72:75], a[112:115], a[24:27], v[72:75]
  ds_read_b64_tr_b16 a[92:93], v107 offset:2048
  ds_read_b64_tr_b16 a[94:95], v107 offset:6144
  v_mfma_f32_16x16x32_bf16 v[88:91], a[112:115], a[28:31], v[88:91]
  ds_read_b64_tr_b16 a[112:113], v104 offset:10240
  ds_read_b64_tr_b16 a[114:115], v104 offset:14336
  v_mfma_f32_16x16x32_bf16 v[76:79], a[116:119], a[24:27], v[76:79]
  v_mfma_f32_16x16x32_bf16 v[92:95], a[116:119], a[28:31], v[92:95]
  buffer_load_dwordx4 v[140:143], v241, s[4:7], s16 offen offset:1024 sc1
  v_mfma_f32_16x16x32_bf16 v[80:83], a[120:123], a[24:27], v[80:83]
  ds_read_b64_tr_b16 a[116:117], v105 offset:10240
  s_add_u32 s16, s16, 262144
  v_mfma_f32_16x16x32_bf16 v[96:99], a[120:123], a[28:31], v[96:99]
  ds_read_b64_tr_b16 a[118:119], v105 offset:14336
  ds_read_b64_tr_b16 a[120:121], v106 offset:10240
  v_mfma_f32_16x16x32_bf16 v[84:87], a[124:127], a[24:27], v[84:87]
  ds_read_b64_tr_b16 a[122:123], v106 offset:14336
  v_mfma_f32_16x16x32_bf16 v[100:103], a[124:127], a[28:31], v[100:103]
  buffer_load_dwordx4 v[144:147], v240, s[4:7], s16 offen offset:0 sc1
  v_mfma_f32_16x16x32_bf16 v[16:19], a[64:67], a[16:19], v[16:19]
  ds_read_b64_tr_b16 a[124:125], v107 offset:10240
  ds_read_b64_tr_b16 a[126:127], v107 offset:14336
  v_mfma_f32_16x16x32_bf16 v[32:35], a[64:67], a[20:23], v[32:35]
  ds_read_b64_tr_b16 a[64:65], v104 offset:0
  ds_read_b64_tr_b16 a[66:67], v104 offset:4096
  v_mfma_f32_16x16x32_bf16 v[20:23], a[68:71], a[16:19], v[20:23]
  v_mfma_f32_16x16x32_bf16 v[36:39], a[68:71], a[20:23], v[36:39]
  buffer_load_dwordx4 v[148:151], v240, s[4:7], s16 offen offset:1024 sc1
  s_waitcnt lgkmcnt(10)
  v_mfma_f32_16x16x32_bf16 v[24:27], a[72:75], a[16:19], v[24:27]
  ds_read_b64_tr_b16 a[68:69], v105 offset:0
  ds_read_b64_tr_b16 a[70:71], v105 offset:4096
  v_mfma_f32_16x16x32_bf16 v[40:43], a[72:75], a[20:23], v[40:43]
  ds_read_b64_tr_b16 a[72:73], v106 offset:0
  ds_read_b64_tr_b16 a[74:75], v106 offset:4096
  v_mfma_f32_16x16x32_bf16 v[28:31], a[76:79], a[16:19], v[28:31]
  v_mfma_f32_16x16x32_bf16 v[44:47], a[76:79], a[20:23], v[44:47]
  buffer_load_dwordx4 v[152:155], v241, s[4:7], s16 offen offset:0 sc1
  v_mfma_f32_16x16x32_bf16 v[16:19], a[96:99], a[24:27], v[16:19]
  ds_read_b64_tr_b16 a[76:77], v107 offset:0
  ds_read_b64_tr_b16 a[78:79], v107 offset:4096
  v_mfma_f32_16x16x32_bf16 v[32:35], a[96:99], a[28:31], v[32:35]
  ds_read_b64_tr_b16 a[96:97], v104 offset:8192
  ds_read_b64_tr_b16 a[98:99], v104 offset:12288
  v_mfma_f32_16x16x32_bf16 v[20:23], a[100:103], a[24:27], v[20:23]
  v_mfma_f32_16x16x32_bf16 v[36:39], a[100:103], a[28:31], v[36:39]
  buffer_load_dwordx4 v[156:159], v241, s[4:7], s16 offen offset:1024 sc1
  v_mfma_f32_16x16x32_bf16 v[24:27], a[104:107], a[24:27], v[24:27]
  ds_read_b64_tr_b16 a[100:101], v105 offset:8192
  s_add_u32 s16, s16, 262144
  v_mfma_f32_16x16x32_bf16 v[40:43], a[104:107], a[28:31], v[40:43]
  ds_read_b64_tr_b16 a[102:103], v105 offset:12288
  ds_read_b64_tr_b16 a[104:105], v106 offset:8192
  v_mfma_f32_16x16x32_bf16 v[28:31], a[108:111], a[24:27], v[28:31]
  ds_read_b64_tr_b16 a[106:107], v106 offset:12288
  v_mfma_f32_16x16x32_bf16 v[44:47], a[108:111], a[28:31], v[44:47]
  s_waitcnt vmcnt(16) lgkmcnt(10)
  s_barrier
  v_mfma_f32_16x16x32_bf16 v[72:75], a[80:83], a[32:35], v[72:75]
  ds_read_b64_tr_b16 a[108:109], v107 offset:8192
  s_add_u32 m0, s38, 114688
  v_mfma_f32_16x16x32_bf16 v[88:91], a[80:83], a[36:39], v[88:91]
  buffer_load_dwordx4 v227, s[8:11], s17 offen offset:2048 lds
  v_mfma_f32_16x16x32_bf16 v[76:79], a[84:87], a[32:35], v[76:79]
  ds_read_b64_tr_b16 a[110:111], v107 offset:12288
  ds_read_b64_tr_b16 a[80:81], v104 offset:18432
  v_mfma_f32_16x16x32_bf16 v[92:95], a[84:87], a[36:39], v[92:95]
  buffer_load_dwordx4 v[160:163], v240, s[4:7], s16 offen offset:0 sc1
  v_mfma_f32_16x16x32_bf16 v[80:83], a[88:91], a[32:35], v[80:83]
  ds_read_b64_tr_b16 a[82:83], v104 offset:22528
  ds_read_b64_tr_b16 a[84:85], v105 offset:18432
  v_mfma_f32_16x16x32_bf16 v[96:99], a[88:91], a[36:39], v[96:99]
  ds_read_b64_tr_b16 a[86:87], v105 offset:22528
  ds_read_b64_tr_b16 a[88:89], v106 offset:18432
  v_mfma_f32_16x16x32_bf16 v[84:87], a[92:95], a[32:35], v[84:87]
  buffer_load_dwordx4 v228, s[8:11], s17 offen offset:3072 lds
  v_mfma_f32_16x16x32_bf16 v[100:103], a[92:95], a[36:39], v[100:103]
  ds_read_b64_tr_b16 a[90:91], v106 offset:22528
  s_add_u32 s17, s17, 917504
  v_mfma_f32_16x16x32_bf16 v[72:75], a[112:115], a[40:43], v[72:75]
  buffer_load_dwordx4 v[164:167], v240, s[4:7], s16 offen offset:1024 sc1
  v_mfma_f32_16x16x32_bf16 v[88:91], a[112:115], a[44:47], v[88:91]
  ds_read_b64_tr_b16 a[92:93], v107 offset:18432
  s_add_u32 m0, s38, 112640
  v_mfma_f32_16x16x32_bf16 v[76:79], a[116:119], a[40:43], v[76:79]
  ds_read_b64_tr_b16 a[94:95], v107 offset:22528
  ds_read_b64_tr_b16 a[112:113], v104 offset:26624
  v_mfma_f32_16x16x32_bf16 v[92:95], a[116:119], a[44:47], v[92:95]
  buffer_load_dwordx4 v227, s[8:11], s17 offen offset:2048 lds
  v_mfma_f32_16x16x32_bf16 v[80:83], a[120:123], a[40:43], v[80:83]
  ds_read_b64_tr_b16 a[114:115], v104 offset:30720
  ds_read_b64_tr_b16 a[116:117], v105 offset:26624
  v_mfma_f32_16x16x32_bf16 v[96:99], a[120:123], a[44:47], v[96:99]
  buffer_load_dwordx4 v[168:171], v241, s[4:7], s16 offen offset:0 sc1
  v_mfma_f32_16x16x32_bf16 v[84:87], a[124:127], a[40:43], v[84:87]
  ds_read_b64_tr_b16 a[118:119], v105 offset:30720
  ds_read_b64_tr_b16 a[120:121], v106 offset:26624
  v_mfma_f32_16x16x32_bf16 v[100:103], a[124:127], a[44:47], v[100:103]
  ds_read_b64_tr_b16 a[122:123], v106 offset:30720
  ds_read_b64_tr_b16 a[124:125], v107 offset:26624
  v_mfma_f32_16x16x32_bf16 v[16:19], a[64:67], a[32:35], v[16:19]
  buffer_load_dwordx4 v228, s[8:11], s17 offen offset:3072 lds
  v_mfma_f32_16x16x32_bf16 v[32:35], a[64:67], a[36:39], v[32:35]
  ds_read_b64_tr_b16 a[126:127], v107 offset:30720
  s_mov_b32 s17, s97
  v_mfma_f32_16x16x32_bf16 v[20:23], a[68:71], a[32:35], v[20:23]
  ds_read_b64_tr_b16 a[64:65], v104 offset:16384
  ds_read_b64_tr_b16 a[66:67], v104 offset:20480
  v_mfma_f32_16x16x32_bf16 v[36:39], a[68:71], a[36:39], v[36:39]
  buffer_load_dwordx4 v[172:175], v241, s[4:7], s16 offen offset:1024 sc1
  s_waitcnt lgkmcnt(10)
  v_mfma_f32_16x16x32_bf16 v[24:27], a[72:75], a[32:35], v[24:27]
  ds_read_b64_tr_b16 a[68:69], v105 offset:16384
  s_add_u32 s16, s16, 262144
  v_mfma_f32_16x16x32_bf16 v[40:43], a[72:75], a[36:39], v[40:43]
  buffer_load_dwordx4 v[176:179], v240, s[4:7], s16 offen offset:0 sc1
  v_mfma_f32_16x16x32_bf16 v[28:31], a[76:79], a[32:35], v[28:31]
  ds_read_b64_tr_b16 a[70:71], v105 offset:20480
  ds_read_b64_tr_b16 a[72:73], v106 offset:16384
  v_mfma_f32_16x16x32_bf16 v[44:47], a[76:79], a[36:39], v[44:47]
  ds_read_b64_tr_b16 a[74:75], v106 offset:20480
  ds_read_b64_tr_b16 a[76:77], v107 offset:16384
  v_mfma_f32_16x16x32_bf16 v[16:19], a[96:99], a[40:43], v[16:19]
  buffer_load_dwordx4 v[180:183], v240, s[4:7], s16 offen offset:1024 sc1
  v_mfma_f32_16x16x32_bf16 v[32:35], a[96:99], a[44:47], v[32:35]
  ds_read_b64_tr_b16 a[78:79], v107 offset:20480
  ds_read_b64_tr_b16 a[96:97], v104 offset:24576
  v_mfma_f32_16x16x32_bf16 v[20:23], a[100:103], a[40:43], v[20:23]
  buffer_load_dwordx4 v[184:187], v241, s[4:7], s16 offen offset:0 sc1
  v_mfma_f32_16x16x32_bf16 v[36:39], a[100:103], a[44:47], v[36:39]
  ds_read_b64_tr_b16 a[98:99], v104 offset:28672
  ds_read_b64_tr_b16 a[100:101], v105 offset:24576
  v_mfma_f32_16x16x32_bf16 v[24:27], a[104:107], a[40:43], v[24:27]
  ds_read_b64_tr_b16 a[102:103], v105 offset:28672
  v_mfma_f32_16x16x32_bf16 v[40:43], a[104:107], a[44:47], v[40:43]
  buffer_load_dwordx4 v[188:191], v241, s[4:7], s16 offen offset:1024 sc1
  v_mfma_f32_16x16x32_bf16 v[28:31], a[108:111], a[40:43], v[28:31]
  ds_read_b64_tr_b16 a[104:105], v106 offset:24576
  s_add_u32 s16, s16, 262144
  v_mfma_f32_16x16x32_bf16 v[44:47], a[108:111], a[44:47], v[44:47]
  s_waitcnt vmcnt(20) lgkmcnt(10)
  s_barrier
  v_mfma_f32_16x16x32_bf16 v[72:75], a[80:83], a[48:51], v[72:75]
  ds_read_b64_tr_b16 a[106:107], v106 offset:28672
  s_add_u32 m0, s38, 133120
  v_mfma_f32_16x16x32_bf16 v[88:91], a[80:83], a[52:55], v[88:91]
  buffer_load_dwordx4 v225, s[8:11], s17 offen offset:0 lds
  v_mfma_f32_16x16x32_bf16 v[76:79], a[84:87], a[48:51], v[76:79]
  ds_read_b64_tr_b16 a[108:109], v107 offset:24576
  ds_read_b64_tr_b16 a[110:111], v107 offset:28672
  v_mfma_f32_16x16x32_bf16 v[92:95], a[84:87], a[52:55], v[92:95]
  ds_read_b64_tr_b16 a[80:81], v104 offset:34816
  ds_read_b64_tr_b16 a[82:83], v104 offset:38912
  v_mfma_f32_16x16x32_bf16 v[80:83], a[88:91], a[48:51], v[80:83]
  ds_read_b64_tr_b16 a[84:85], v105 offset:34816
  ds_read_b64_tr_b16 a[86:87], v105 offset:38912
  v_mfma_f32_16x16x32_bf16 v[96:99], a[88:91], a[52:55], v[96:99]
  ds_read_b64_tr_b16 a[88:89], v106 offset:34816
  ds_read_b64_tr_b16 a[90:91], v106 offset:38912
  v_mfma_f32_16x16x32_bf16 v[84:87], a[92:95], a[48:51], v[84:87]
  v_mfma_f32_16x16x32_bf16 v[100:103], a[92:95], a[52:55], v[100:103]
  ds_read_b64_tr_b16 a[92:93], v107 offset:34816
  ds_read_b64_tr_b16 a[94:95], v107 offset:38912
  v_mfma_f32_16x16x32_bf16 v[72:75], a[112:115], a[56:59], v[72:75]
  buffer_load_dwordx4 v226, s[8:11], s17 offen offset:1024 lds
  v_mfma_f32_16x16x32_bf16 v[88:91], a[112:115], a[60:63], v[88:91]
  ds_read_b64_tr_b16 a[112:113], v104 offset:43008
  s_add_u32 s17, s17, 917504
  v_mfma_f32_16x16x32_bf16 v[76:79], a[116:119], a[56:59], v[76:79]
  ds_read_b64_tr_b16 a[114:115], v104 offset:47104
  s_add_u32 m0, s38, 131072
  v_mfma_f32_16x16x32_bf16 v[92:95], a[116:119], a[60:63], v[92:95]
  ds_read_b64_tr_b16 a[116:117], v105 offset:43008
  ds_read_b64_tr_b16 a[118:119], v105 offset:47104
  v_mfma_f32_16x16x32_bf16 v[80:83], a[120:123], a[56:59], v[80:83]
  v_mfma_f32_16x16x32_bf16 v[96:99], a[120:123], a[60:63], v[96:99]
  ds_read_b64_tr_b16 a[120:121], v106 offset:43008
  ds_read_b64_tr_b16 a[122:123], v106 offset:47104
  v_mfma_f32_16x16x32_bf16 v[84:87], a[124:127], a[56:59], v[84:87]
  v_mfma_f32_16x16x32_bf16 v[100:103], a[124:127], a[60:63], v[100:103]
  ds_read_b64_tr_b16 a[124:125], v107 offset:43008
  ds_read_b64_tr_b16 a[126:127], v107 offset:47104
  v_mfma_f32_16x16x32_bf16 v[16:19], a[64:67], a[48:51], v[16:19]
  buffer_load_dwordx4 v225, s[8:11], s17 offen offset:0 lds
  v_mfma_f32_16x16x32_bf16 v[32:35], a[64:67], a[52:55], v[32:35]
  ds_read_b64_tr_b16 a[64:65], v104 offset:32768
  ds_read_b64_tr_b16 a[66:67], v104 offset:36864
  s_waitcnt lgkmcnt(10)
  v_mfma_f32_16x16x32_bf16 v[20:23], a[68:71], a[48:51], v[20:23]
  v_mfma_f32_16x16x32_bf16 v[36:39], a[68:71], a[52:55], v[36:39]
  ds_read_b64_tr_b16 a[68:69], v105 offset:32768
  ds_read_b64_tr_b16 a[70:71], v105 offset:36864
  v_mfma_f32_16x16x32_bf16 v[24:27], a[72:75], a[48:51], v[24:27]
  v_mfma_f32_16x16x32_bf16 v[40:43], a[72:75], a[52:55], v[40:43]
  ds_read_b64_tr_b16 a[72:73], v106 offset:32768
  ds_read_b64_tr_b16 a[74:75], v106 offset:36864
  v_mfma_f32_16x16x32_bf16 v[28:31], a[76:79], a[48:51], v[28:31]
  v_mfma_f32_16x16x32_bf16 v[44:47], a[76:79], a[52:55], v[44:47]
  ds_read_b64_tr_b16 a[76:77], v107 offset:32768
  ds_read_b64_tr_b16 a[78:79], v107 offset:36864
  v_mfma_f32_16x16x32_bf16 v[16:19], a[96:99], a[56:59], v[16:19]
  buffer_load_dwordx4 v226, s[8:11], s17 offen offset:1024 lds
  v_mfma_f32_16x16x32_bf16 v[32:35], a[96:99], a[60:63], v[32:35]
  ds_read_b64_tr_b16 a[96:97], v104 offset:40960
  s_add_u32 s17, s17, 917504
  v_mfma_f32_16x16x32_bf16 v[20:23], a[100:103], a[56:59], v[20:23]
  ds_read_b64_tr_b16 a[98:99], v104 offset:45056
  v_mfma_f32_16x16x32_bf16 v[36:39], a[100:103], a[60:63], v[36:39]
  ds_read_b64_tr_b16 a[100:101], v105 offset:40960
  ds_read_b64_tr_b16 a[102:103], v105 offset:45056
  v_mfma_f32_16x16x32_bf16 v[24:27], a[104:107], a[56:59], v[24:27]
  v_mfma_f32_16x16x32_bf16 v[40:43], a[104:107], a[60:63], v[40:43]
  ds_read_b64_tr_b16 a[104:105], v106 offset:40960
  ds_read_b64_tr_b16 a[106:107], v106 offset:45056
  v_mfma_f32_16x16x32_bf16 v[28:31], a[108:111], a[56:59], v[28:31]
  v_mfma_f32_16x16x32_bf16 v[44:47], a[108:111], a[60:63], v[44:47]
  s_waitcnt vmcnt(9) lgkmcnt(10)
  s_barrier
  v_swap_b32 v130, v132
  v_swap_b32 v131, v133
  v_swap_b32 v138, v140
  v_swap_b32 v139, v141
  v_swap_b32 v146, v148
  v_swap_b32 v147, v149
  v_swap_b32 v154, v156
  v_swap_b32 v155, v157
  s_nop 1
  v_mfma_f32_16x16x32_bf16 v[72:75], a[80:83], v[128:131], v[72:75]
  ds_read_b64_tr_b16 a[108:109], v107 offset:40960
  s_add_u32 m0, s38, 2048
  v_mfma_f32_16x16x32_bf16 v[88:91], a[80:83], v[132:135], v[88:91]
  buffer_load_dwordx4 v225, s[8:11], s17 offen offset:0 lds
  v_mfma_f32_16x16x32_bf16 v[76:79], a[84:87], v[128:131], v[76:79]
  ds_read_b64_tr_b16 a[110:111], v107 offset:45056
  ds_read_b64_tr_b16 a[80:81], v104 offset:51200
  v_mfma_f32_16x16x32_bf16 v[92:95], a[84:87], v[132:135], v[92:95]
  ds_read_b64_tr_b16 a[82:83], v104 offset:55296
  ds_read_b64_tr_b16 a[84:85], v105 offset:51200
  v_mfma_f32_16x16x32_bf16 v[80:83], a[88:91], v[128:131], v[80:83]
  ds_read_b64_tr_b16 a[86:87], v105 offset:55296
  v_mfma_f32_16x16x32_bf16 v[96:99], a[88:91], v[132:135], v[96:99]
  ds_read_b64_tr_b16 a[88:89], v106 offset:51200
  ds_read_b64_tr_b16 a[90:91], v106 offset:55296
  v_mfma_f32_16x16x32_bf16 v[84:87], a[92:95], v[128:131], v[84:87]
  v_mfma_f32_16x16x32_bf16 v[100:103], a[92:95], v[132:135], v[100:103]
  ds_read_b64_tr_b16 a[92:93], v107 offset:51200
  ds_read_b64_tr_b16 a[94:95], v107 offset:55296
  v_mfma_f32_16x16x32_bf16 v[72:75], a[112:115], v[136:139], v[72:75]
  buffer_load_dwordx4 v226, s[8:11], s17 offen offset:1024 lds
  v_mfma_f32_16x16x32_bf16 v[88:91], a[112:115], v[140:143], v[88:91]
  ds_read_b64_tr_b16 a[112:113], v104 offset:59392
  s_add_u32 s17, s17, 917504
  v_mfma_f32_16x16x32_bf16 v[76:79], a[116:119], v[136:139], v[76:79]
  ds_read_b64_tr_b16 a[114:115], v104 offset:63488
  s_add_u32 m0, s38, 0
  v_mfma_f32_16x16x32_bf16 v[92:95], a[116:119], v[140:143], v[92:95]
  ds_read_b64_tr_b16 a[116:117], v105 offset:59392
  ds_read_b64_tr_b16 a[118:119], v105 offset:63488
  v_mfma_f32_16x16x32_bf16 v[80:83], a[120:123], v[136:139], v[80:83]
  v_mfma_f32_16x16x32_bf16 v[96:99], a[120:123], v[140:143], v[96:99]
  ds_read_b64_tr_b16 a[120:121], v106 offset:59392
  ds_read_b64_tr_b16 a[122:123], v106 offset:63488
  v_mfma_f32_16x16x32_bf16 v[84:87], a[124:127], v[136:139], v[84:87]
  v_mfma_f32_16x16x32_bf16 v[100:103], a[124:127], v[140:143], v[100:103]
  ds_read_b64_tr_b16 a[124:125], v107 offset:59392
  ds_read_b64_tr_b16 a[126:127], v107 offset:63488
  v_mfma_f32_16x16x32_bf16 v[72:75], a[64:67], v[144:147], v[72:75]
  buffer_load_dwordx4 v225, s[8:11], s17 offen offset:0 lds
  v_mfma_f32_16x16x32_bf16 v[88:91], a[64:67], v[148:151], v[88:91]
  ds_read_b64_tr_b16 a[64:65], v104 offset:49152
  ds_read_b64_tr_b16 a[66:67], v104 offset:53248
  v_mfma_f32_16x16x32_bf16 v[76:79], a[68:71], v[144:147], v[76:79]
  v_mfma_f32_16x16x32_bf16 v[92:95], a[68:71], v[148:151], v[92:95]
  ds_read_b64_tr_b16 a[68:69], v105 offset:49152
  ds_read_b64_tr_b16 a[70:71], v105 offset:53248
  s_waitcnt lgkmcnt(10)
  v_mfma_f32_16x16x32_bf16 v[80:83], a[72:75], v[144:147], v[80:83]
  v_mfma_f32_16x16x32_bf16 v[96:99], a[72:75], v[148:151], v[96:99]
  ds_read_b64_tr_b16 a[72:73], v106 offset:49152
  ds_read_b64_tr_b16 a[74:75], v106 offset:53248
  v_mfma_f32_16x16x32_bf16 v[84:87], a[76:79], v[144:147], v[84:87]
  v_mfma_f32_16x16x32_bf16 v[100:103], a[76:79], v[148:151], v[100:103]
  ds_read_b64_tr_b16 a[76:77], v107 offset:49152
  ds_read_b64_tr_b16 a[78:79], v107 offset:53248
  v_mfma_f32_16x16x32_bf16 v[72:75], a[96:99], v[152:155], v[72:75]
  buffer_load_dwordx4 v226, s[8:11], s17 offen offset:1024 lds
  v_mfma_f32_16x16x32_bf16 v[88:91], a[96:99], v[156:159], v[88:91]
  ds_read_b64_tr_b16 a[96:97], v104 offset:57344
  s_add_u32 s17, s17, 917504
  v_mfma_f32_16x16x32_bf16 v[76:79], a[100:103], v[152:155], v[76:79]
  s_add_u32 s52, s20, 0xe00000
  s_addc_u32 s53, s21, 0
  s_mov_b32 s54, 0x800000
  s_mov_b32 s55, 0x20000
  v_lshlrev_b32 v50, 4, v231
  s_lshl_b32 s36, s2, 2
  s_add_u32 s36, s36, s3
  s_xor_b32 s37, s36, 4
  s_lshl_b32 s39, s37, 12
  s_lshl_b32 s36, s36, 12
  s_mov_b32 s43, 0x8000
  s_mov_b32 s44, s90
  s_mov_b32 s45, s91
  s_mov_b32 s46, 0x400000
  s_mov_b32 s47, 0x20000
  v_mfma_f32_16x16x32_bf16 v[92:95], a[100:103], v[156:159], v[92:95]
  ds_read_b64_tr_b16 a[98:99], v104 offset:61440
  ds_read_b64_tr_b16 a[100:101], v105 offset:57344
  v_mfma_f32_16x16x32_bf16 v[80:83], a[104:107], v[152:155], v[80:83]
  ds_read_b64_tr_b16 a[102:103], v105 offset:61440
  v_mfma_f32_16x16x32_bf16 v[96:99], a[104:107], v[156:159], v[96:99]
  ds_read_b64_tr_b16 a[104:105], v106 offset:57344
  ds_read_b64_tr_b16 a[106:107], v106 offset:61440
  v_mfma_f32_16x16x32_bf16 v[84:87], a[108:111], v[152:155], v[84:87]
  v_mfma_f32_16x16x32_bf16 v[100:103], a[108:111], v[156:159], v[100:103]
  s_waitcnt vmcnt(4) lgkmcnt(10)
  s_barrier
  v_swap_b32 v162, v164
  v_swap_b32 v163, v165
  v_swap_b32 v170, v172
  v_swap_b32 v171, v173
  v_swap_b32 v178, v180
  v_swap_b32 v179, v181
  v_swap_b32 v186, v188
  v_swap_b32 v187, v189
  s_nop 1
  v_mfma_f32_16x16x32_bf16 v[72:75], a[80:83], v[160:163], v[72:75]
  ds_read_b64_tr_b16 a[108:109], v107 offset:57344
  ds_read_b64_tr_b16 a[110:111], v107 offset:61440
  v_mfma_f32_16x16x32_bf16 v[88:91], a[80:83], v[164:167], v[88:91]
  ds_read_b64_tr_b16 a[80:81], v124 offset:2048
  ds_read_b64_tr_b16 a[82:83], v124 offset:6144
  v_mfma_f32_16x16x32_bf16 v[76:79], a[84:87], v[160:163], v[76:79]
  v_mfma_f32_16x16x32_bf16 v[92:95], a[84:87], v[164:167], v[92:95]
  ds_read_b64_tr_b16 a[84:85], v125 offset:2048
  ds_read_b64_tr_b16 a[86:87], v125 offset:6144
  v_mfma_f32_16x16x32_bf16 v[80:83], a[88:91], v[160:163], v[80:83]
  v_mfma_f32_16x16x32_bf16 v[96:99], a[88:91], v[164:167], v[96:99]
  ds_read_b64_tr_b16 a[88:89], v126 offset:2048
  ds_read_b64_tr_b16 a[90:91], v126 offset:6144
  v_mfma_f32_16x16x32_bf16 v[84:87], a[92:95], v[160:163], v[84:87]
  v_mfma_f32_16x16x32_bf16 v[100:103], a[92:95], v[164:167], v[100:103]
  ds_read_b64_tr_b16 a[92:93], v127 offset:2048
  ds_read_b64_tr_b16 a[94:95], v127 offset:6144
  v_mfma_f32_16x16x32_bf16 v[72:75], a[112:115], v[168:171], v[72:75]
  v_mfma_f32_16x16x32_bf16 v[88:91], a[112:115], v[172:175], v[88:91]
  ds_read_b64_tr_b16 a[112:113], v124 offset:10240
  ds_read_b64_tr_b16 a[114:115], v124 offset:14336
  v_mfma_f32_16x16x32_bf16 v[76:79], a[116:119], v[168:171], v[76:79]
  v_mfma_f32_16x16x32_bf16 v[92:95], a[116:119], v[172:175], v[92:95]
  ds_read_b64_tr_b16 a[116:117], v125 offset:10240
  ds_read_b64_tr_b16 a[118:119], v125 offset:14336
  v_mfma_f32_16x16x32_bf16 v[80:83], a[120:123], v[168:171], v[80:83]
  v_mfma_f32_16x16x32_bf16 v[96:99], a[120:123], v[172:175], v[96:99]
  ds_read_b64_tr_b16 a[120:121], v126 offset:10240
  ds_read_b64_tr_b16 a[122:123], v126 offset:14336
  v_mfma_f32_16x16x32_bf16 v[84:87], a[124:127], v[168:171], v[84:87]
  v_mfma_f32_16x16x32_bf16 v[100:103], a[124:127], v[172:175], v[100:103]
  ds_read_b64_tr_b16 a[124:125], v127 offset:10240
  ds_read_b64_tr_b16 a[126:127], v127 offset:14336
  v_mfma_f32_16x16x32_bf16 v[72:75], a[64:67], v[176:179], v[72:75]
  v_mfma_f32_16x16x32_bf16 v[88:91], a[64:67], v[180:183], v[88:91]
  ds_read_b64_tr_b16 a[64:65], v124 offset:0
  ds_read_b64_tr_b16 a[66:67], v124 offset:4096
  v_mfma_f32_16x16x32_bf16 v[76:79], a[68:71], v[176:179], v[76:79]
  v_mfma_f32_16x16x32_bf16 v[92:95], a[68:71], v[180:183], v[92:95]
  ds_read_b64_tr_b16 a[68:69], v125 offset:0
  ds_read_b64_tr_b16 a[70:71], v125 offset:4096
  s_waitcnt lgkmcnt(10)
  v_mfma_f32_16x16x32_bf16 v[80:83], a[72:75], v[176:179], v[80:83]
  v_mfma_f32_16x16x32_bf16 v[96:99], a[72:75], v[180:183], v[96:99]
  ds_read_b64_tr_b16 a[72:73], v126 offset:0
  ds_read_b64_tr_b16 a[74:75], v126 offset:4096
  v_mfma_f32_16x16x32_bf16 v[84:87], a[76:79], v[176:179], v[84:87]
  v_mfma_f32_16x16x32_bf16 v[100:103], a[76:79], v[180:183], v[100:103]
  ds_read_b64_tr_b16 a[76:77], v127 offset:0
  ds_read_b64_tr_b16 a[78:79], v127 offset:4096
  v_mfma_f32_16x16x32_bf16 v[72:75], a[96:99], v[184:187], v[72:75]
  v_mfma_f32_16x16x32_bf16 v[88:91], a[96:99], v[188:191], v[88:91]
  ds_read_b64_tr_b16 a[96:97], v124 offset:8192
  ds_read_b64_tr_b16 a[98:99], v124 offset:12288
  v_mfma_f32_16x16x32_bf16 v[76:79], a[100:103], v[184:187], v[76:79]
  v_mfma_f32_16x16x32_bf16 v[92:95], a[100:103], v[188:191], v[92:95]
  ds_read_b64_tr_b16 a[100:101], v125 offset:8192
  ds_read_b64_tr_b16 a[102:103], v125 offset:12288
  v_mfma_f32_16x16x32_bf16 v[80:83], a[104:107], v[184:187], v[80:83]
  v_mfma_f32_16x16x32_bf16 v[96:99], a[104:107], v[188:191], v[96:99]
  ds_read_b64_tr_b16 a[104:105], v126 offset:8192
  ds_read_b64_tr_b16 a[106:107], v126 offset:12288
  v_mfma_f32_16x16x32_bf16 v[84:87], a[108:111], v[184:187], v[84:87]
  v_mfma_f32_16x16x32_bf16 v[100:103], a[108:111], v[188:191], v[100:103]
  s_waitcnt vmcnt(0) lgkmcnt(10)
  s_barrier
  v_mfma_f32_16x16x32_bf16 v[16:19], a[80:83], v[128:131], v[16:19]
  ds_read_b64_tr_b16 a[108:109], v127 offset:8192
  ds_read_b64_tr_b16 a[110:111], v127 offset:12288
  v_mfma_f32_16x16x32_bf16 v[32:35], a[80:83], v[132:135], v[32:35]
  ds_read_b64_tr_b16 a[80:81], v242 offset:2048
  ds_read_b64_tr_b16 a[82:83], v242 offset:6144
  v_mfma_f32_16x16x32_bf16 v[20:23], a[84:87], v[128:131], v[20:23]
  v_mfma_f32_16x16x32_bf16 v[36:39], a[84:87], v[132:135], v[36:39]
  v_cvt_pk_bf16_f32 v108, v72, v73
  v_cvt_pk_bf16_f32 v109, v74, v75
  v_cvt_pk_bf16_f32 v110, v76, v77
  v_cvt_pk_bf16_f32 v111, v78, v79
  buffer_store_dwordx4 v[108:111], v50, s[52:55], s39 offen offset:0 sc1
  v_mfma_f32_16x16x32_bf16 v[24:27], a[88:91], v[128:131], v[24:27]
  v_cvt_pk_bf16_f32 v116, v88, v89
  v_cvt_pk_bf16_f32 v117, v90, v91
  v_cvt_pk_bf16_f32 v118, v92, v93
  v_cvt_pk_bf16_f32 v119, v94, v95
  buffer_store_dwordx4 v[116:119], v50, s[52:55], s39 offen offset:2048 sc1
  v_mfma_f32_16x16x32_bf16 v[40:43], a[88:91], v[132:135], v[40:43]
  ds_read_b64_tr_b16 a[84:85], v243 offset:2048
  ds_read_b64_tr_b16 a[86:87], v243 offset:6144
  v_mfma_f32_16x16x32_bf16 v[28:31], a[92:95], v[128:131], v[28:31]
  ds_read_b64_tr_b16 a[88:89], v244 offset:2048
  ds_read_b64_tr_b16 a[90:91], v244 offset:6144
  v_mfma_f32_16x16x32_bf16 v[44:47], a[92:95], v[132:135], v[44:47]
  v_cvt_pk_bf16_f32 v112, v80, v81
  v_cvt_pk_bf16_f32 v113, v82, v83
  v_cvt_pk_bf16_f32 v114, v84, v85
  v_cvt_pk_bf16_f32 v115, v86, v87
  buffer_store_dwordx4 v[112:115], v50, s[52:55], s39 offen offset:1024 sc1
  v_mfma_f32_16x16x32_bf16 v[16:19], a[112:115], v[136:139], v[16:19]
  v_cvt_pk_bf16_f32 v120, v96, v97
  v_cvt_pk_bf16_f32 v121, v98, v99
  v_cvt_pk_bf16_f32 v122, v100, v101
  v_cvt_pk_bf16_f32 v123, v102, v103
  buffer_store_dwordx4 v[120:123], v50, s[52:55], s39 offen offset:3072 sc1
  v_mfma_f32_16x16x32_bf16 v[32:35], a[112:115], v[140:143], v[32:35]
  ds_read_b64_tr_b16 a[92:93], v245 offset:2048
  ds_read_b64_tr_b16 a[94:95], v245 offset:6144
  v_mfma_f32_16x16x32_bf16 v[20:23], a[116:119], v[136:139], v[20:23]
  ds_read_b64_tr_b16 a[112:113], v242 offset:10240
  ds_read_b64_tr_b16 a[114:115], v242 offset:14336
  v_mfma_f32_16x16x32_bf16 v[36:39], a[116:119], v[140:143], v[36:39]
  ds_read_b64_tr_b16 a[116:117], v243 offset:10240
  ds_read_b64_tr_b16 a[118:119], v243 offset:14336
  v_mfma_f32_16x16x32_bf16 v[24:27], a[120:123], v[136:139], v[24:27]
  v_mfma_f32_16x16x32_bf16 v[40:43], a[120:123], v[140:143], v[40:43]
  ds_read_b64_tr_b16 a[120:121], v244 offset:10240
  ds_read_b64_tr_b16 a[122:123], v244 offset:14336
  v_mfma_f32_16x16x32_bf16 v[28:31], a[124:127], v[136:139], v[28:31]
  v_mfma_f32_16x16x32_bf16 v[44:47], a[124:127], v[140:143], v[44:47]
  ds_read_b64_tr_b16 a[124:125], v245 offset:10240
  ds_read_b64_tr_b16 a[126:127], v245 offset:14336
  v_mfma_f32_16x16x32_bf16 v[16:19], a[64:67], v[144:147], v[16:19]
  v_mfma_f32_16x16x32_bf16 v[32:35], a[64:67], v[148:151], v[32:35]
  ds_read_b64_tr_b16 a[64:65], v242 offset:0
  ds_read_b64_tr_b16 a[66:67], v242 offset:4096
  v_mfma_f32_16x16x32_bf16 v[20:23], a[68:71], v[144:147], v[20:23]
  v_mfma_f32_16x16x32_bf16 v[36:39], a[68:71], v[148:151], v[36:39]
  ds_read_b64_tr_b16 a[68:69], v243 offset:0
  ds_read_b64_tr_b16 a[70:71], v243 offset:4096
  s_waitcnt lgkmcnt(10)
  v_mfma_f32_16x16x32_bf16 v[24:27], a[72:75], v[144:147], v[24:27]
  v_mfma_f32_16x16x32_bf16 v[40:43], a[72:75], v[148:151], v[40:43]
  ds_read_b64_tr_b16 a[72:73], v244 offset:0
  ds_read_b64_tr_b16 a[74:75], v244 offset:4096
  v_mfma_f32_16x16x32_bf16 v[28:31], a[76:79], v[144:147], v[28:31]
  v_mfma_f32_16x16x32_bf16 v[44:47], a[76:79], v[148:151], v[44:47]
  ds_read_b64_tr_b16 a[76:77], v245 offset:0
  ds_read_b64_tr_b16 a[78:79], v245 offset:4096
  v_mfma_f32_16x16x32_bf16 v[16:19], a[96:99], v[152:155], v[16:19]
  v_mfma_f32_16x16x32_bf16 v[32:35], a[96:99], v[156:159], v[32:35]
  ds_read_b64_tr_b16 a[96:97], v242 offset:8192
  ds_read_b64_tr_b16 a[98:99], v242 offset:12288
  v_mfma_f32_16x16x32_bf16 v[20:23], a[100:103], v[152:155], v[20:23]
  v_mfma_f32_16x16x32_bf16 v[36:39], a[100:103], v[156:159], v[36:39]
  ds_read_b64_tr_b16 a[100:101], v243 offset:8192
  ds_read_b64_tr_b16 a[102:103], v243 offset:12288
  v_mfma_f32_16x16x32_bf16 v[24:27], a[104:107], v[152:155], v[24:27]
  v_mfma_f32_16x16x32_bf16 v[40:43], a[104:107], v[156:159], v[40:43]
  ds_read_b64_tr_b16 a[104:105], v244 offset:8192
  ds_read_b64_tr_b16 a[106:107], v244 offset:12288
  v_mfma_f32_16x16x32_bf16 v[28:31], a[108:111], v[152:155], v[28:31]
  v_mfma_f32_16x16x32_bf16 v[44:47], a[108:111], v[156:159], v[44:47]
  s_waitcnt vmcnt(63) lgkmcnt(10)
  s_barrier
  v_mfma_f32_16x16x32_bf16 v[16:19], a[80:83], v[160:163], v[16:19]
  ds_read_b64_tr_b16 a[108:109], v245 offset:8192
  ds_read_b64_tr_b16 a[110:111], v245 offset:12288
  v_mfma_f32_16x16x32_bf16 v[32:35], a[80:83], v[164:167], v[32:35]
  v_mfma_f32_16x16x32_bf16 v[20:23], a[84:87], v[160:163], v[20:23]
  v_mfma_f32_16x16x32_bf16 v[36:39], a[84:87], v[164:167], v[36:39]
  v_mfma_f32_16x16x32_bf16 v[24:27], a[88:91], v[160:163], v[24:27]
  v_mfma_f32_16x16x32_bf16 v[40:43], a[88:91], v[164:167], v[40:43]
  v_mfma_f32_16x16x32_bf16 v[28:31], a[92:95], v[160:163], v[28:31]
  v_mfma_f32_16x16x32_bf16 v[44:47], a[92:95], v[164:167], v[44:47]
  v_mfma_f32_16x16x32_bf16 v[16:19], a[112:115], v[168:171], v[16:19]
  v_mfma_f32_16x16x32_bf16 v[32:35], a[112:115], v[172:175], v[32:35]
  v_mfma_f32_16x16x32_bf16 v[20:23], a[116:119], v[168:171], v[20:23]
  v_mfma_f32_16x16x32_bf16 v[36:39], a[116:119], v[172:175], v[36:39]
  v_mfma_f32_16x16x32_bf16 v[24:27], a[120:123], v[168:171], v[24:27]
  v_mfma_f32_16x16x32_bf16 v[40:43], a[120:123], v[172:175], v[40:43]
  v_mfma_f32_16x16x32_bf16 v[28:31], a[124:127], v[168:171], v[28:31]
  v_mfma_f32_16x16x32_bf16 v[44:47], a[124:127], v[172:175], v[44:47]
  v_mfma_f32_16x16x32_bf16 v[16:19], a[64:67], v[176:179], v[16:19]
  v_mfma_f32_16x16x32_bf16 v[32:35], a[64:67], v[180:183], v[32:35]
  v_mfma_f32_16x16x32_bf16 v[20:23], a[68:71], v[176:179], v[20:23]
  v_mfma_f32_16x16x32_bf16 v[36:39], a[68:71], v[180:183], v[36:39]
  buffer_load_dwordx4 v[108:111], v50, s[52:55], s36 offen offset:0 sc1
  s_waitcnt lgkmcnt(10)
  v_mfma_f32_16x16x32_bf16 v[24:27], a[72:75], v[176:179], v[24:27]
  buffer_load_dwordx4 v[112:115], v50, s[52:55], s36 offen offset:1024 sc1
  v_mfma_f32_16x16x32_bf16 v[40:43], a[72:75], v[180:183], v[40:43]
  buffer_load_dwordx4 v[116:119], v50, s[52:55], s36 offen offset:2048 sc1
  s_waitcnt lgkmcnt(8)
  v_mfma_f32_16x16x32_bf16 v[28:31], a[76:79], v[176:179], v[28:31]
  buffer_load_dwordx4 v[120:123], v50, s[52:55], s36 offen offset:3072 sc1
  v_mfma_f32_16x16x32_bf16 v[44:47], a[76:79], v[180:183], v[44:47]
  s_waitcnt lgkmcnt(6)
  v_mfma_f32_16x16x32_bf16 v[16:19], a[96:99], v[184:187], v[16:19]
  v_mfma_f32_16x16x32_bf16 v[32:35], a[96:99], v[188:191], v[32:35]
  s_waitcnt lgkmcnt(4)
  v_mfma_f32_16x16x32_bf16 v[20:23], a[100:103], v[184:187], v[20:23]
  v_mfma_f32_16x16x32_bf16 v[36:39], a[100:103], v[188:191], v[36:39]
  s_waitcnt lgkmcnt(2)
  v_mfma_f32_16x16x32_bf16 v[24:27], a[104:107], v[184:187], v[24:27]
  v_mfma_f32_16x16x32_bf16 v[40:43], a[104:107], v[188:191], v[40:43]
  s_waitcnt lgkmcnt(0)
  v_mfma_f32_16x16x32_bf16 v[28:31], a[108:111], v[184:187], v[28:31]
  v_mfma_f32_16x16x32_bf16 v[44:47], a[108:111], v[188:191], v[44:47]
  s_nop 7
  s_nop 1
  s_waitcnt lgkmcnt(0)
  v_pk_fma_f32 v[192:193], v[16:17], v[56:57], v[192:193]
  v_pk_fma_f32 v[194:195], v[18:19], v[58:59], v[194:195]
  v_pk_fma_f32 v[196:197], v[20:21], v[60:61], v[196:197]
  v_pk_fma_f32 v[198:199], v[22:23], v[62:63], v[198:199]
  v_pk_fma_f32 v[200:201], v[24:25], v[64:65], v[200:201]
  v_pk_fma_f32 v[202:203], v[26:27], v[66:67], v[202:203]
  v_pk_fma_f32 v[204:205], v[28:29], v[68:69], v[204:205]
  v_pk_fma_f32 v[206:207], v[30:31], v[70:71], v[206:207]
  v_pk_fma_f32 v[208:209], v[32:33], v[56:57], v[208:209]
  v_pk_fma_f32 v[210:211], v[34:35], v[58:59], v[210:211]
  v_pk_fma_f32 v[212:213], v[36:37], v[60:61], v[212:213]
  v_pk_fma_f32 v[214:215], v[38:39], v[62:63], v[214:215]
  v_pk_fma_f32 v[216:217], v[40:41], v[64:65], v[216:217]
  v_pk_fma_f32 v[218:219], v[42:43], v[66:67], v[218:219]
  v_pk_fma_f32 v[220:221], v[44:45], v[68:69], v[220:221]
  v_pk_fma_f32 v[222:223], v[46:47], v[70:71], v[222:223]
  s_mov_b32 s60, 262144
  s_branch L_chk_33
L_poll_31:
  buffer_load_dwordx4 v[108:111], v50, s[52:55], s36 offen offset:0 sc1
  buffer_load_dwordx4 v[112:115], v50, s[52:55], s36 offen offset:1024 sc1
  buffer_load_dwordx4 v[116:119], v50, s[52:55], s36 offen offset:2048 sc1
  buffer_load_dwordx4 v[120:123], v50, s[52:55], s36 offen offset:3072 sc1
L_chk_33:
  s_waitcnt vmcnt(3)
  v_max3_u32 v51, v108, v109, v110
  v_max_u32 v51, v51, v111
  s_waitcnt vmcnt(2)
  v_max3_u32 v51, v51, v112, v113
  v_max3_u32 v51, v51, v114, v115
  s_waitcnt vmcnt(1)
  v_max3_u32 v51, v51, v116, v117
  v_max3_u32 v51, v51, v118, v119
  s_waitcnt vmcnt(0)
  v_max3_u32 v51, v51, v120, v121
  v_max3_u32 v51, v51, v122, v123
  v_cmp_eq_u32 vcc, -1, v51
  s_nop 1
  s_cmp_eq_u64 vcc, 0
  s_cbranch_scc1 L_ready_32
  s_sub_u32 s60, s60, 1
  s_cmp_lg_u32 s60, 0
  s_cbranch_scc1 L_poll_31
L_ready_32:
  v_lshlrev_b32 v72, 16, v108
  v_and_b32 v73, 0xffff0000, v108
  v_lshlrev_b32 v74, 16, v109
  v_and_b32 v75, 0xffff0000, v109
  v_pk_fma_f32 v[192:193], v[72:73], v[56:57], v[192:193]
  v_pk_fma_f32 v[194:195], v[74:75], v[58:59], v[194:195]
  v_cvt_pk_bf16_f32 v0, v192, v193
  v_cvt_pk_bf16_f32 v1, v194, v195
  v_lshlrev_b32 v76, 16, v110
  v_and_b32 v77, 0xffff0000, v110
  v_lshlrev_b32 v78, 16, v111
  v_and_b32 v79, 0xffff0000, v111
  v_pk_fma_f32 v[196:197], v[76:77], v[60:61], v[196:197]
  v_pk_fma_f32 v[198:199], v[78:79], v[62:63], v[198:199]
  v_cvt_pk_bf16_f32 v2, v196, v197
  v_cvt_pk_bf16_f32 v3, v198, v199
  s_nop 1
  v_permlane16_swap_b32 v0, v2
  v_permlane16_swap_b32 v1, v3
  s_nop 1
  buffer_store_dwordx4 v[0:3], v252, s[44:47], 0 offen offset:0 sc1
  v_lshlrev_b32 v80, 16, v112
  v_and_b32 v81, 0xffff0000, v112
  v_lshlrev_b32 v82, 16, v113
  v_and_b32 v83, 0xffff0000, v113
  v_pk_fma_f32 v[200:201], v[80:81], v[64:65], v[200:201]
  v_pk_fma_f32 v[202:203], v[82:83], v[66:67], v[202:203]
  v_cvt_pk_bf16_f32 v4, v200, v201
  v_cvt_pk_bf16_f32 v5, v202, v203
  v_lshlrev_b32 v84, 16, v114
  v_and_b32 v85, 0xffff0000, v114
  v_lshlrev_b32 v86, 16, v115
  v_and_b32 v87, 0xffff0000, v115
  v_pk_fma_f32 v[204:205], v[84:85], v[68:69], v[204:205]
  v_pk_fma_f32 v[206:207], v[86:87], v[70:71], v[206:207]
  v_cvt_pk_bf16_f32 v6, v204, v205
  v_cvt_pk_bf16_f32 v7, v206, v207
  s_nop 1
  v_permlane16_swap_b32 v4, v6
  v_permlane16_swap_b32 v5, v7
  s_nop 1
  buffer_store_dwordx4 v[4:7], v252, s[44:47], 0 offen offset:64 sc1
  v_lshlrev_b32 v88, 16, v116
  v_and_b32 v89, 0xffff0000, v116
  v_lshlrev_b32 v90, 16, v117
  v_and_b32 v91, 0xffff0000, v117
  v_pk_fma_f32 v[208:209], v[88:89], v[56:57], v[208:209]
  v_pk_fma_f32 v[210:211], v[90:91], v[58:59], v[210:211]
  v_cvt_pk_bf16_f32 v8, v208, v209
  v_cvt_pk_bf16_f32 v9, v210, v211
  v_lshlrev_b32 v92, 16, v118
  v_and_b32 v93, 0xffff0000, v118
  v_lshlrev_b32 v94, 16, v119
  v_and_b32 v95, 0xffff0000, v119
  v_pk_fma_f32 v[212:213], v[92:93], v[60:61], v[212:213]
  v_pk_fma_f32 v[214:215], v[94:95], v[62:63], v[214:215]
  v_cvt_pk_bf16_f32 v10, v212, v213
  v_cvt_pk_bf16_f32 v11, v214, v215
  s_nop 1
  v_permlane16_swap_b32 v8, v10
  v_permlane16_swap_b32 v9, v11
  s_nop 1
  buffer_store_dwordx4 v[8:11], v252, s[44:47], s43 offen offset:0 sc1
  v_lshlrev_b32 v96, 16, v120
  v_and_b32 v97, 0xffff0000, v120
  v_lshlrev_b32 v98, 16, v121
  v_and_b32 v99, 0xffff0000, v121
  v_pk_fma_f32 v[216:217], v[96:97], v[64:65], v[216:217]
  v_pk_fma_f32 v[218:219], v[98:99], v[66:67], v[218:219]
  v_cvt_pk_bf16_f32 v12, v216, v217
  v_cvt_pk_bf16_f32 v13, v218, v219
  v_lshlrev_b32 v100, 16, v122
  v_and_b32 v101, 0xffff0000, v122
  v_lshlrev_b32 v102, 16, v123
  v_and_b32 v103, 0xffff0000, v123
  v_pk_fma_f32 v[220:221], v[100:101], v[68:69], v[220:221]
  v_pk_fma_f32 v[222:223], v[102:103], v[70:71], v[222:223]
  v_cvt_pk_bf16_f32 v14, v220, v221
  v_cvt_pk_bf16_f32 v15, v222, v223
  s_nop 1
  v_permlane16_swap_b32 v12, v14
  v_permlane16_swap_b32 v13, v15
  s_nop 1
  buffer_store_dwordx4 v[12:15], v252, s[44:47], s43 offen offset:64 sc1
  s_endpgm
L_slow_9:
  s_mov_b32 s33, 262144
L_spin_34:
  buffer_load_dword v127, v126, s[64:67], 0 offen sc1
  s_waitcnt vmcnt(0)
  v_cmp_ne_u32 vcc, s19, v127
  s_nop 1
  s_cmp_eq_u64 vcc, 0
  s_cbranch_scc1 L_back_10
  s_sub_u32 s33, s33, 1
  s_cmp_lg_u32 s33, 0
  s_cbranch_scc1 L_spin_34
  s_branch L_back_10
L_vslow_11:
  s_mov_b32 s33, 262144
L_spin_35:
  buffer_load_dwordx4 v[250:253], v254, s[12:15], s68 offen sc1
  s_waitcnt vmcnt(0)
  v_xor_b32 v168, s44, v250
  v_xor_b32 v169, s45, v251
  v_xor_b32 v170, s46, v252
  v_xor_b32 v171, s47, v253
  v_or3_b32 v172, v168, v169, v170
  v_or_b32 v172, v172, v171
  v_and_b32 v172, 0xff, v172
  v_cmp_ne_u32 vcc, 0, v172
  s_nop 1
  s_cmp_eq_u64 vcc, 0
  s_cbranch_scc1 L_vback_12
  s_sub_u32 s33, s33, 1
  s_cmp_lg_u32 s33, 0
  s_cbranch_scc1 L_spin_35
  s_branch L_vback_12
L_slow_19:
  s_mov_b32 s69, 262144
L_spin_36:
  buffer_load_dword v247, v246, s[64:67], s68 offen sc1
  s_waitcnt vmcnt(0)
  v_cmp_ne_u32 vcc, s19, v247
  s_nop 1
  s_cmp_eq_u64 vcc, 0
  s_cbranch_scc1 L_back_20
  s_sub_u32 s69, s69, 1
  s_cmp_lg_u32 s69, 0
  s_cbranch_scc1 L_spin_36
  s_branch L_back_20
L_slow_25:
  s_mov_b32 s60, 262144
L_spin_37:
  buffer_load_dword v247, v246, s[56:59], s94 offen sc1
  s_waitcnt vmcnt(0)
  v_cmp_ne_u32 vcc, s19, v247
  s_nop 1
  s_cmp_eq_u64 vcc, 0
  s_cbranch_scc1 L_back_26
  s_sub_u32 s60, s60, 1
  s_cmp_lg_u32 s60, 0
  s_cbranch_scc1 L_spin_37
  s_branch L_back_26
L_slow_27:
  s_mov_b32 s60, 262144
L_spin_38:
  buffer_load_dword v247, v246, s[56:59], s94 offen sc1
  s_waitcnt vmcnt(0)
  v_cmp_ne_u32 vcc, s19, v247
  s_nop 1
  s_cmp_eq_u64 vcc, 0
  s_cbranch_scc1 L_back_28
  s_sub_u32 s60, s60, 1
  s_cmp_lg_u32 s60, 0
  s_cbranch_scc1 L_spin_38
  s_branch L_back_28
L_slow_29:
  s_mov_b32 s60, 262144
L_spin_39:
  buffer_load_dword v247, v246, s[56:59], s94 offen sc1
  s_waitcnt vmcnt(0)
  v_cmp_ne_u32 vcc, s19, v247
  s_nop 1
  s_cmp_eq_u64 vcc, 0
  s_cbranch_scc1 L_back_30
  s_sub_u32 s60, s60, 1
  s_cmp_lg_u32 s60, 0
  s_cbranch_scc1 L_spin_39
  s_branch L_back_30
L_end_1:
  s_endpgm
L_code_end:
  s_endpgm
.section .rodata,"a"
.p2align 6
.amdhsa_kernel adaLN_cond__sliding_local_dilated__glu_gated_glu__prompt_kernel
  .amdhsa_next_free_vgpr 512
  .amdhsa_next_free_sgpr 102
  .amdhsa_accum_offset 256
  .amdhsa_group_segment_fixed_size 0
  .amdhsa_kernarg_size 96
  .amdhsa_user_sgpr_count 2
  .amdhsa_user_sgpr_kernarg_segment_ptr 1
  .amdhsa_system_sgpr_workgroup_id_x 1
  .amdhsa_float_denorm_mode_32 3
.end_amdhsa_kernel
```

```asm
; @launch grid=(256,1,1) block=(256,1,1) lds=163840
.amdgcn_target "amdgcn-amd-amdhsa--gfx950"
.text
.globl adaLN_cond__sliding_local_dilated__glu_gated_glu__prompt_kernel
.p2align 8
.type adaLN_cond__sliding_local_dilated__glu_gated_glu__prompt_kernel,@function
adaLN_cond__sliding_local_dilated__glu_gated_glu__prompt_kernel:
  s_cmp_ge_u32 s2, 256
  s_cbranch_scc1 L_end_1
  s_load_dwordx2 s[44:45], s[0:1], 56
  s_load_dwordx2 s[52:53], s[0:1], 64
  s_load_dwordx2 s[12:13], s[0:1], 0
  s_load_dwordx2 s[20:21], s[0:1], 88
  s_load_dwordx2 s[8:9], s[0:1], 8
  s_getpc_b64 s[58:59]
  v_and_b32 v86, 31, v0
  v_lshlrev_b32 v86, 7, v86
  global_load_dword v131, v86, s[58:59] offset:128
  v_lshrrev_b32 v110, 6, v0
  v_and_b32 v104, 63, v0
  s_nop 0
  v_readfirstlane_b32 s3, v110
  s_and_b32 s29, s2, 3
  s_and_b32 s28, s2, 4
  s_lshl_b32 s28, s28, 3
  s_lshr_b32 s31, s2, 3
  s_or_b32 s28, s28, s31
  v_lshrrev_b32 v1, 2, v104
  v_mul_u32_u24 v1, 12288, v1
  v_and_b32 v66, 3, v104
  v_lshl_add_u32 v1, v66, 4, v1
  v_lshlrev_b32 v2, 1, v0
  s_lshl2_add_u32 s30, s29, s3
  s_mul_i32 s50, s30, 786432
  s_lshl_b32 s31, s28, 6
  s_add_u32 s35, s50, s31
  s_lshl_b32 s34, s29, 9
  s_lshl_b32 s31, s3, 12
  s_add_u32 m0, s31, 79872
  v_and_b32 v66, 7, v104
  v_lshlrev_b32 v3, 11, v66
  v_lshrrev_b32 v67, 3, v104
  v_lshl_add_u32 v3, v67, 4, v3
  s_lshl2_add_u32 s37, s28, s29
  s_lshl_b32 s36, s37, 14
  s_lshl_b32 s31, s3, 9
  s_add_u32 s36, s36, s31
  s_movk_i32 s46, 2048
  s_mov_b32 s47, 0x20000
  s_mov_b32 s54, 12582912
  s_mov_b32 s55, 0x20000
  s_mov_b32 s14, 4194304
  s_mov_b32 s15, 0x20000
  s_waitcnt lgkmcnt(0)
  s_load_dword s19, s[20:21], 0x40000
  buffer_load_ushort v4, v2, s[44:47], s34 offen
  buffer_load_dwordx4 v1, s[52:55], s35 offen offset:0 lds
  s_add_u32 s35, s35, 195584
  buffer_load_dwordx4 v1, s[52:55], s35 offen offset:1024 lds
  s_add_u32 s35, s35, 195584
  buffer_load_dwordx4 v1, s[52:55], s35 offen offset:2048 lds
  s_add_u32 s35, s35, 195584
  buffer_load_dwordx4 v1, s[52:55], s35 offen offset:3072 lds
  s_barrier
  buffer_load_dwordx4 v[8:11], v3, s[12:15], s36 offen offset:0
  buffer_load_dwordx4 v[12:15], v3, s[12:15], s36 offen offset:128
  buffer_load_dwordx4 v[16:19], v3, s[12:15], s36 offen offset:256
  buffer_load_dwordx4 v[20:23], v3, s[12:15], s36 offen offset:384
  s_load_dwordx2 s[24:25], s[0:1], 16
  s_load_dwordx4 s[60:63], s[0:1], 32
  s_load_dwordx2 s[22:23], s[0:1], 48
  s_load_dwordx2 s[90:91], s[0:1], 72
  s_mov_b64 s[26:27], s[12:13]
  s_bfe_u32 s30, s2, 0x10002
  s_xor_b32 s30, s30, 1
  s_lshl_b32 s30, s30, 3
  s_bfe_u32 s31, s2, 0x30003
  s_add_u32 s30, s30, s31
  s_bfe_u32 s31, s2, 0x20000
  s_lshl_b32 s31, s31, 2
  s_lshr_b32 s34, s2, 6
  s_add_u32 s31, s31, s34
  v_and_b32 v111, 2, v67
  v_xor_b32 v111, v111, v66
  v_mul_u32_u24 v129, 12288, v67
  v_lshl_add_u32 v129, v111, 4, v129
  s_and_b32 s33, s3, 1
  s_lshl_b32 s33, s33, 2
  v_xor_b32 v111, s33, v111
  v_mul_u32_u24 v110, 6144, v67
  v_lshl_add_u32 v110, v111, 4, v110
  s_mul_i32 s32, s3, 49152
  s_lshl_b32 s33, s31, 7
  s_add_u32 s32, s32, s33
  v_add_u32 v107, s32, v110
  v_add_u32 v108, 1024, v107
  v_add_u32 v109, 2048, v107
  s_mul_i32 s38, s3, 3072
  s_and_b32 s33, s30, 7
  s_mul_i32 s16, s33, 131072
  s_mul_i32 s17, s33, 196608
  s_mov_b32 s10, 1572864
  s_mov_b32 s11, 0x20000
  s_barrier
  s_getpc_b64 s[100:101]
  L_pc_2:
  s_add_u32 s100, s100, L_gemm_a-L_pc_2
  s_addc_u32 s101, s101, 0
  s_lshr_b32 s33, s2, 3
  s_lshl_b32 s33, s33, 2
  s_add_u32 s33, s33, s3
  s_lshl_b32 s33, s33, 13
  v_lshlrev_b32 v200, 7, v104
  v_add_u32 v200, s33, v200
  v_min_u32 v200, L_code_end-L_gemm_a-4, v200
  v_mov_b32 v201, s101
  v_add_co_u32 v200, vcc, s100, v200
  s_nop 1
  v_addc_co_u32 v201, vcc, 0, v201, vcc
  global_load_dword v131, v[200:201], off
  v_lshrrev_b32 v68, 4, v104
  v_bfe_u32 v69, v104, 2, 2
  v_lshl_add_u32 v69, v68, 3, v69
  v_and_b32 v70, 3, v104
  v_lshlrev_b32 v70, 3, v70
  s_lshl_b32 s33, s3, 5
  s_add_u32 s33, s33, 106496
  v_add_u32 v70, s33, v70
  v_lshl_add_u32 v5, v69, 6, v70
  v_subrev_u32 v5, 26624, v5
  v_lshl_add_u32 v196, v69, 7, v70
  v_and_b32 v70, 8, v104
  v_lshlrev_b32 v70, 2, v70
  v_xor_b32 v196, v196, v70
  v_lshlrev_b32 v255, 4, v68
  v_add_u32 v197, 147456, v255
  v_and_b32 v70, 15, v104
  v_lshl_or_b32 v255, v70, 24, v255
  v_mov_b32 v198, 0xffffff00
  v_add_u32 v2, 147456, v2
  s_mov_b32 s12, s20
  s_mov_b32 s13, s21
  s_mov_b32 s14, 0x38000
  s_mov_b32 s15, 0x20000
  s_mul_i32 s96, s29, 24576
  s_lshl_b32 s33, s3, 6
  s_add_u32 s96, s96, s33
  s_lshl_b32 s33, s28, 7
  s_add_u32 s34, s96, s33
  s_add_u32 s96, s34, s33
  s_add_u32 s96, s96, 8192
  s_add_u32 s50, s50, s33
  s_add_u32 s50, s50, 4096
  s_lshl_b32 s51, s3, 13
  s_add_u32 s51, s51, 106496
  s_waitcnt vmcnt(9)
  v_lshlrev_b32 v4, 16, v4
  v_mul_f32 v6, 0xbfb8aa3b, v4
  v_exp_f32 v6, v6
  s_nop 0
  v_add_f32 v6, 1.0, v6
  v_rcp_f32 v6, v6
  s_nop 0
  v_mul_f32 v4, v4, v6
  v_cvt_pk_bf16_f32 v4, v4, v4
  ds_write_b16 v2, v4
  s_waitcnt vmcnt(5) lgkmcnt(0)
  s_barrier
  s_mul_i32 s19, s19, 0x9e3779b1
  s_add_u32 s19, s19, 0x7f4a7c15
  s_bfe_u32 s40, s19, 0x80000
  s_bfe_u32 s41, s19, 0x80008
  s_bfe_u32 s42, s19, 0x80010
  s_bfe_u32 s43, s19, 0x80018
  s_cmp_ge_u32 s3, 2
  s_cbranch_scc1 L_nog_3
  ds_read_b64_tr_b16 a[64:65], v5 offset:0
  ds_read_b64_tr_b16 a[66:67], v5 offset:256
  ds_read_b128 a[68:71], v197 offset:0
  ds_read_b64_tr_b16 a[72:73], v5 offset:2048
  ds_read_b64_tr_b16 a[74:75], v5 offset:2304
  ds_read_b128 a[76:79], v197 offset:64
  ds_read_b64_tr_b16 a[80:81], v5 offset:4096
  ds_read_b64_tr_b16 a[82:83], v5 offset:4352
  ds_read_b128 a[84:87], v197 offset:128
  ds_read_b64_tr_b16 a[88:89], v5 offset:6144
  ds_read_b64_tr_b16 a[90:91], v5 offset:6400
  ds_read_b128 a[92:95], v197 offset:192
  ds_read_b64_tr_b16 a[96:97], v5 offset:8192
  ds_read_b64_tr_b16 a[98:99], v5 offset:8448
  ds_read_b128 a[100:103], v197 offset:256
  s_waitcnt lgkmcnt(12)
  v_mfma_f32_16x16x32_bf16 v[192:195], a[64:67], a[68:71], 0
  ds_read_b64_tr_b16 a[104:105], v5 offset:10240
  ds_read_b64_tr_b16 a[106:107], v5 offset:10496
  ds_read_b128 a[108:111], v197 offset:320
  s_waitcnt lgkmcnt(12)
  v_mfma_f32_16x16x32_bf16 v[192:195], a[72:75], a[76:79], v[192:195]
  ds_read_b64_tr_b16 a[112:113], v5 offset:12288
  ds_read_b64_tr_b16 a[114:115], v5 offset:12544
  ds_read_b128 a[116:119], v197 offset:384
  s_waitcnt lgkmcnt(12)
  v_mfma_f32_16x16x32_bf16 v[192:195], a[80:83], a[84:87], v[192:195]
  ds_read_b64_tr_b16 a[120:121], v5 offset:14336
  ds_read_b64_tr_b16 a[122:123], v5 offset:14592
  ds_read_b128 a[124:127], v197 offset:448
  s_waitcnt lgkmcnt(12)
  v_mfma_f32_16x16x32_bf16 v[192:195], a[88:91], a[92:95], v[192:195]
  s_waitcnt lgkmcnt(9)
  v_mfma_f32_16x16x32_bf16 v[192:195], a[96:99], a[100:103], v[192:195]
  s_waitcnt lgkmcnt(6)
  v_mfma_f32_16x16x32_bf16 v[192:195], a[104:107], a[108:111], v[192:195]
  s_waitcnt lgkmcnt(3)
  v_mfma_f32_16x16x32_bf16 v[192:195], a[112:115], a[116:119], v[192:195]
  s_waitcnt lgkmcnt(0)
  v_mfma_f32_16x16x32_bf16 v[192:195], a[120:123], a[124:127], v[192:195]
  s_nop 7
  v_and_or_b32 v192, v192, v198, s40
  v_and_or_b32 v193, v193, v198, s41
  v_and_or_b32 v194, v194, v198, s42
  v_and_or_b32 v195, v195, v198, s43
  buffer_store_dwordx4 v[192:195], v255, s[12:15], s34 offen sc1
L_nog_3:
  s_waitcnt vmcnt(1)
  v_lshlrev_b32 v24, 16, v8
  v_and_b32 v25, 0xffff0000, v8
  v_lshlrev_b32 v26, 16, v9
  v_and_b32 v27, 0xffff0000, v9
  v_lshlrev_b32 v28, 16, v10
  v_and_b32 v29, 0xffff0000, v10
  v_lshlrev_b32 v30, 16, v11
  v_and_b32 v31, 0xffff0000, v11
  v_lshlrev_b32 v32, 16, v12
  v_and_b32 v33, 0xffff0000, v12
  v_lshlrev_b32 v34, 16, v13
  v_and_b32 v35, 0xffff0000, v13
  v_lshlrev_b32 v36, 16, v14
  v_and_b32 v37, 0xffff0000, v14
  v_lshlrev_b32 v38, 16, v15
  v_and_b32 v39, 0xffff0000, v15
  v_lshlrev_b32 v40, 16, v16
  v_and_b32 v41, 0xffff0000, v16
  v_lshlrev_b32 v42, 16, v17
  v_and_b32 v43, 0xffff0000, v17
  v_lshlrev_b32 v44, 16, v18
  v_and_b32 v45, 0xffff0000, v18
  v_lshlrev_b32 v46, 16, v19
  v_and_b32 v47, 0xffff0000, v19
  v_lshlrev_b32 v48, 16, v20
  v_and_b32 v49, 0xffff0000, v20
  v_lshlrev_b32 v50, 16, v21
  v_and_b32 v51, 0xffff0000, v21
  v_lshlrev_b32 v52, 16, v22
  v_and_b32 v53, 0xffff0000, v22
  v_lshlrev_b32 v54, 16, v23
  v_and_b32 v55, 0xffff0000, v23
  v_pk_add_f32 v[56:57], v[24:25], v[26:27]
  v_pk_mul_f32 v[58:59], v[24:25], v[24:25]
  v_pk_mul_f32 v[60:61], v[26:27], v[26:27]
  v_pk_add_f32 v[56:57], v[56:57], v[28:29]
  v_pk_fma_f32 v[58:59], v[28:29], v[28:29], v[58:59]
  v_pk_add_f32 v[56:57], v[56:57], v[30:31]
  v_pk_fma_f32 v[60:61], v[30:31], v[30:31], v[60:61]
  v_pk_add_f32 v[56:57], v[56:57], v[32:33]
  v_pk_fma_f32 v[58:59], v[32:33], v[32:33], v[58:59]
  v_pk_add_f32 v[56:57], v[56:57], v[34:35]
  v_pk_fma_f32 v[60:61], v[34:35], v[34:35], v[60:61]
  v_pk_add_f32 v[56:57], v[56:57], v[36:37]
  v_pk_fma_f32 v[58:59], v[36:37], v[36:37], v[58:59]
  v_pk_add_f32 v[56:57], v[56:57], v[38:39]
  v_pk_fma_f32 v[60:61], v[38:39], v[38:39], v[60:61]
  v_pk_add_f32 v[56:57], v[56:57], v[40:41]
  v_pk_fma_f32 v[58:59], v[40:41], v[40:41], v[58:59]
  v_pk_add_f32 v[56:57], v[56:57], v[42:43]
  v_pk_fma_f32 v[60:61], v[42:43], v[42:43], v[60:61]
  v_pk_add_f32 v[56:57], v[56:57], v[44:45]
  v_pk_fma_f32 v[58:59], v[44:45], v[44:45], v[58:59]
  v_pk_add_f32 v[56:57], v[56:57], v[46:47]
  v_pk_fma_f32 v[60:61], v[46:47], v[46:47], v[60:61]
  v_pk_add_f32 v[56:57], v[56:57], v[48:49]
  v_pk_fma_f32 v[58:59], v[48:49], v[48:49], v[58:59]
  v_pk_add_f32 v[56:57], v[56:57], v[50:51]
  v_pk_fma_f32 v[60:61], v[50:51], v[50:51], v[60:61]
  v_pk_add_f32 v[56:57], v[56:57], v[52:53]
  v_pk_fma_f32 v[58:59], v[52:53], v[52:53], v[58:59]
  v_pk_add_f32 v[56:57], v[56:57], v[54:55]
  v_pk_fma_f32 v[60:61], v[54:55], v[54:55], v[60:61]
  v_pk_add_f32 v[58:59], v[58:59], v[60:61]
  v_add_f32 v56, v56, v57
  v_add_f32 v57, v58, v59
  s_nop 1
  v_add_f32_dpp v56, v56, v56 row_ror:8 row_mask:0xf bank_mask:0xf
  v_add_f32_dpp v57, v57, v57 row_ror:8 row_mask:0xf bank_mask:0xf
  v_mov_b32 v58, v56
  v_mov_b32 v59, v57
  s_nop 1
  v_permlane16_swap_b32 v58, v56
  v_permlane16_swap_b32 v59, v57
  s_nop 1
  v_add_f32 v56, v56, v58
  v_add_f32 v57, v57, v59
  v_mov_b32 v58, v56
  v_mov_b32 v59, v57
  s_nop 1
  v_permlane32_swap_b32 v58, v56
  v_permlane32_swap_b32 v59, v57
  s_nop 1
  v_add_f32 v56, v56, v58
  v_add_f32 v57, v57, v59
  v_lshlrev_b32 v68, 5, v66
  v_add_u32 v68, 147968, v68
  s_lshl_b32 s33, s3, 3
  v_add_u32 v69, s33, v68
  ds_write_b64 v69, v[56:57]
  v_lshlrev_b32 v119, 4, v104
  s_lshl_b32 s33, s3, 10
  v_add_u32 v1, s33, v119
  v_add_u32 v2, 4096, v1
  s_lshl_b32 s33, s3, 11
  s_add_u32 s33, s33, 139264
  v_add_u32 v3, s33, v119
  v_lshlrev_b32 v4, 5, v67
  v_add_u32 v4, s33, v4
  v_lshrrev_b32 v5, 5, v104
  v_lshlrev_b32 v5, 17, v5
  v_and_b32 v70, 3, v67
  v_lshl_add_u32 v5, v70, 8, v5
  v_lshl_add_u32 v5, v66, 4, v5
  s_waitcnt lgkmcnt(0)
  s_barrier
  ds_read_b128 v[132:135], v68 offset:0
  ds_read_b128 v[136:139], v68 offset:16
  s_add_u32 m0, s38, 0
  s_nop 0
  buffer_load_dwordx4 v107, s[8:11], s17 offen lds
  buffer_load_dwordx4 v108, s[8:11], s17 offen offset:1024 lds
  buffer_load_dwordx4 v109, s[8:11], s17 offen offset:2048 lds
  s_add_u32 s17, s17, 196608
  s_cmp_eq_u32 s17, s10
  s_cselect_b32 s17, 0, s17
  s_mov_b32 s32, 24576
  s_mov_b32 s35, 49152
  s_mov_b32 s36, 73728
  s_add_u32 s4, s20, 0x200000
  s_addc_u32 s5, s21, 0
  s_mov_b32 s6, 0x400000
  s_mov_b32 s7, 0x20000
  s_add_u32 s64, s20, 0xc0000
  s_addc_u32 s65, s21, 0
  s_mov_b32 s66, 0x20000
  s_mov_b32 s67, 0x20000
  s_waitcnt lgkmcnt(0)
  v_pk_add_f32 v[132:133], v[132:133], v[134:135]
  v_pk_add_f32 v[136:137], v[136:137], v[138:139]
  v_pk_add_f32 v[132:133], v[132:133], v[136:137]
  v_mul_f32 v56, 0x3a800000, v132
  v_mul_f32 v60, 0x3a800000, v133
  v_fma_f32 v60, -v56, v56, v60
  v_max_f32 v60, 0, v60
  buffer_load_dwordx4 v[72:75], v1, s[12:15], 0 offen sc1
  buffer_load_dwordx4 v[76:79], v1, s[12:15], s32 offen sc1
  buffer_load_dwordx4 v[80:83], v1, s[12:15], s35 offen sc1
  buffer_load_dwordx4 v[84:87], v1, s[12:15], s36 offen sc1
  buffer_load_dwordx4 v[88:91], v2, s[12:15], 0 offen sc1
  buffer_load_dwordx4 v[92:95], v2, s[12:15], s32 offen sc1
  buffer_load_dwordx4 v[96:99], v2, s[12:15], s35 offen sc1
  buffer_load_dwordx4 v[100:103], v2, s[12:15], s36 offen sc1
  v_cvt_pk_bf16_f32 v64, v56, v60
  v_lshlrev_b32 v56, 16, v64
  v_and_b32 v60, 0xffff0000, v64
  v_add_f32 v60, 0x3727c5ac, v60
  v_cvt_pk_bf16_f32 v64, v60, v61
  v_lshlrev_b32 v60, 16, v64
  v_and_b32 v61, 0xffff0000, v64
  v_sqrt_f32 v60, v60
  s_nop 0
  v_cvt_pk_bf16_f32 v64, v60, v61
  v_lshlrev_b32 v60, 16, v64
  v_and_b32 v61, 0xffff0000, v64
  v_rcp_f32 v60, v60
  v_mov_b32 v57, v56
  s_nop 0
  v_mov_b32 v61, v60
  v_pk_add_f32 v[24:25], v[24:25], v[56:57] neg_lo:[0,1] neg_hi:[0,1]
  v_pk_add_f32 v[26:27], v[26:27], v[56:57] neg_lo:[0,1] neg_hi:[0,1]
  v_pk_add_f32 v[28:29], v[28:29], v[56:57] neg_lo:[0,1] neg_hi:[0,1]
  v_pk_add_f32 v[30:31], v[30:31], v[56:57] neg_lo:[0,1] neg_hi:[0,1]
  v_pk_add_f32 v[32:33], v[32:33], v[56:57] neg_lo:[0,1] neg_hi:[0,1]
  v_pk_add_f32 v[34:35], v[34:35], v[56:57] neg_lo:[0,1] neg_hi:[0,1]
  v_pk_add_f32 v[36:37], v[36:37], v[56:57] neg_lo:[0,1] neg_hi:[0,1]
  v_pk_add_f32 v[38:39], v[38:39], v[56:57] neg_lo:[0,1] neg_hi:[0,1]
  v_pk_add_f32 v[40:41], v[40:41], v[56:57] neg_lo:[0,1] neg_hi:[0,1]
  v_pk_add_f32 v[42:43], v[42:43], v[56:57] neg_lo:[0,1] neg_hi:[0,1]
  v_pk_add_f32 v[44:45], v[44:45], v[56:57] neg_lo:[0,1] neg_hi:[0,1]
  v_pk_add_f32 v[46:47], v[46:47], v[56:57] neg_lo:[0,1] neg_hi:[0,1]
  v_pk_add_f32 v[48:49], v[48:49], v[56:57] neg_lo:[0,1] neg_hi:[0,1]
  v_pk_add_f32 v[50:51], v[50:51], v[56:57] neg_lo:[0,1] neg_hi:[0,1]
  v_pk_add_f32 v[52:53], v[52:53], v[56:57] neg_lo:[0,1] neg_hi:[0,1]
  v_pk_add_f32 v[54:55], v[54:55], v[56:57] neg_lo:[0,1] neg_hi:[0,1]
  v_pk_mul_f32 v[24:25], v[24:25], v[60:61]
  v_pk_mul_f32 v[26:27], v[26:27], v[60:61]
  v_pk_mul_f32 v[28:29], v[28:29], v[60:61]
  v_pk_mul_f32 v[30:31], v[30:31], v[60:61]
  v_pk_mul_f32 v[32:33], v[32:33], v[60:61]
  v_pk_mul_f32 v[34:35], v[34:35], v[60:61]
  v_pk_mul_f32 v[36:37], v[36:37], v[60:61]
  v_pk_mul_f32 v[38:39], v[38:39], v[60:61]
  v_pk_mul_f32 v[40:41], v[40:41], v[60:61]
  v_pk_mul_f32 v[42:43], v[42:43], v[60:61]
  v_pk_mul_f32 v[44:45], v[44:45], v[60:61]
  v_pk_mul_f32 v[46:47], v[46:47], v[60:61]
  v_pk_mul_f32 v[48:49], v[48:49], v[60:61]
  v_pk_mul_f32 v[50:51], v[50:51], v[60:61]
  v_pk_mul_f32 v[52:53], v[52:53], v[60:61]
  v_pk_mul_f32 v[54:55], v[54:55], v[60:61]
  s_lshl_b32 s39, s3, 8
  s_add_u32 s39, s39, 12288
  s_lshl_b32 s33, s30, 6
  s_lshl_b32 s34, s3, 4
  s_add_u32 s34, s34, s33
  s_max_u32 s33, s33, 8
  s_sub_u32 s33, s33, 8
  v_add_u32 v110, s33, v66
  v_add_u32 v126, s34, v104
  v_cmp_lt_u32 vcc, 15, v104
  s_nop 1
  v_cndmask_b32 v126, v126, v110, vcc
  s_mov_b32 s33, 0
  v_and_b32 v128, 0, v126
  v_add_u32 v128, s33, v128
  v_and_b32 v128, 3, v128
  v_and_or_b32 v128, v126, -4, v128
  v_lshlrev_b32 v126, 6, v126
  v_lshlrev_b32 v128, 6, v128
  s_lshl_b32 s34, s30, 13
  s_lshl_b32 s33, s3, 11
  s_add_u32 s34, s34, s33
  v_add_u32 v105, s34, v119
  s_lshl_b32 s34, s30, 3
  s_max_u32 s34, s34, 1
  s_sub_u32 s34, s34, 1
  s_lshl_b32 s34, s34, 10
  s_lshl_b32 s33, s3, 8
  s_add_u32 s34, s34, s33
  v_lshlrev_b32 v106, 2, v104
  v_add_u32 v106, s34, v106
  v_lshrrev_b32 v110, 4, v104
  v_mul_u32_u24 v110, 3072, v110
  v_bfe_u32 v111, v104, 2, 2
  v_lshl_add_u32 v110, v111, 7, v110
  v_bfe_u32 v111, v104, 3, 2
  v_lshl_add_u32 v110, v111, 5, v110
  v_and_b32 v111, 3, v104
  v_lshl_add_u32 v114, v111, 3, v110
  v_xor_b32 v115, 32, v114
  v_xor_b32 v116, 64, v114
  v_xor_b32 v117, 96, v114
  s_lshl_b32 s33, s3, 5
  v_xor_b32 v118, s33, v114
  v_add_u32 v120, 53248, v114
  v_add_u32 v121, 53248, v115
  v_add_u32 v122, 53248, v116
  v_add_u32 v123, 53248, v117
  v_add_u32 v124, 53248, v118
  v_add_u32 v125, 53248, v119
  v_and_b32 v110, 14, v104
  v_lshrrev_b32 v111, 4, v104
  v_lshlrev_b32 v111, 2, v111
  v_cmp_le_u32 s[44:45], v111, v110
  v_add_u32 v111, 2, v111
  v_cmp_le_u32 s[46:47], v111, v110
  v_and_b32 v110, 1, v104
  v_cmp_eq_u32 s[48:49], 1, v110
  s_lshl_b32 s56, s3, 20
  s_lshr_b32 s33, s37, 1
  s_lshl_b32 s33, s33, 10
  s_add_u32 s56, s56, s33
  s_and_b32 s33, s37, 1
  s_lshl_b32 s33, s33, 7
  s_add_u32 s56, s56, s33
  s_add_u32 s57, s56, 262144
  s_add_u32 s58, s56, 524288
  s_add_u32 s59, s56, 786432
  s_lshl2_add_u32 s37, s37, s3
  s_lshl_b32 s37, s37, 6
  s_mov_b32 s33, 262144
L_mod_4:
  s_waitcnt vmcnt(7)
  v_xor_b32 v72, s40, v72
  v_xor_b32 v73, s41, v73
  v_xor_b32 v74, s42, v74
  v_xor_b32 v75, s43, v75
  v_or3_b32 v66, v72, v73, v74
  v_or_b32 v66, v66, v75
  s_waitcnt vmcnt(6)
  v_xor_b32 v76, s40, v76
  v_xor_b32 v77, s41, v77
  v_xor_b32 v78, s42, v78
  v_xor_b32 v79, s43, v79
  v_or3_b32 v66, v66, v76, v77
  v_or3_b32 v66, v66, v78, v79
  s_waitcnt vmcnt(5)
  v_xor_b32 v80, s40, v80
  v_xor_b32 v81, s41, v81
  v_xor_b32 v82, s42, v82
  v_xor_b32 v83, s43, v83
  v_or3_b32 v66, v66, v80, v81
  v_or3_b32 v66, v66, v82, v83
  s_waitcnt vmcnt(4)
  v_xor_b32 v84, s40, v84
  v_xor_b32 v85, s41, v85
  v_xor_b32 v86, s42, v86
  v_xor_b32 v87, s43, v87
  v_or3_b32 v66, v66, v84, v85
  v_or3_b32 v66, v66, v86, v87
  s_waitcnt vmcnt(3)
  v_xor_b32 v88, s40, v88
  v_xor_b32 v89, s41, v89
  v_xor_b32 v90, s42, v90
  v_xor_b32 v91, s43, v91
  v_or3_b32 v66, v66, v88, v89
  v_or3_b32 v66, v66, v90, v91
  s_waitcnt vmcnt(2)
  v_xor_b32 v92, s40, v92
  v_xor_b32 v93, s41, v93
  v_xor_b32 v94, s42, v94
  v_xor_b32 v95, s43, v95
  v_or3_b32 v66, v66, v92, v93
  v_or3_b32 v66, v66, v94, v95
  s_waitcnt vmcnt(1)
  v_xor_b32 v96, s40, v96
  v_xor_b32 v97, s41, v97
  v_xor_b32 v98, s42, v98
  v_xor_b32 v99, s43, v99
  v_or3_b32 v66, v66, v96, v97
  v_or3_b32 v66, v66, v98, v99
  s_waitcnt vmcnt(0)
  v_xor_b32 v100, s40, v100
  v_xor_b32 v101, s41, v101
  v_xor_b32 v102, s42, v102
  v_xor_b32 v103, s43, v103
  v_or3_b32 v66, v66, v100, v101
  v_or3_b32 v66, v66, v102, v103
  v_and_b32 v66, 0xff, v66
  v_cmp_ne_u32 vcc, 0, v66
  s_nop 1
  s_cmp_eq_u64 vcc, 0
  s_cbranch_scc1 L_mok_5
  s_mov_b64 exec, vcc
  buffer_load_dwordx4 v[72:75], v1, s[12:15], 0 offen sc1
  buffer_load_dwordx4 v[76:79], v1, s[12:15], s32 offen sc1
  buffer_load_dwordx4 v[80:83], v1, s[12:15], s35 offen sc1
  buffer_load_dwordx4 v[84:87], v1, s[12:15], s36 offen sc1
  buffer_load_dwordx4 v[88:91], v2, s[12:15], 0 offen sc1
  buffer_load_dwordx4 v[92:95], v2, s[12:15], s32 offen sc1
  buffer_load_dwordx4 v[96:99], v2, s[12:15], s35 offen sc1
  buffer_load_dwordx4 v[100:103], v2, s[12:15], s36 offen sc1
  s_sub_u32 s33, s33, 1
  s_cmp_lg_u32 s33, 0
  s_cbranch_scc1 L_mod_4
  s_waitcnt vmcnt(0)
L_mok_5:
  s_mov_b64 exec, -1
  v_pk_add_f32 v[72:73], v[72:73], v[80:81]
  v_pk_add_f32 v[74:75], v[74:75], v[82:83]
  v_pk_add_f32 v[76:77], v[76:77], v[84:85]
  v_pk_add_f32 v[78:79], v[78:79], v[86:87]
  v_pk_add_f32 v[88:89], v[88:89], v[96:97]
  v_pk_add_f32 v[90:91], v[90:91], v[98:99]
  v_pk_add_f32 v[92:93], v[92:93], v[100:101]
  v_pk_add_f32 v[94:95], v[94:95], v[102:103]
  v_pk_add_f32 v[72:73], v[72:73], v[76:77]
  v_pk_add_f32 v[74:75], v[74:75], v[78:79]
  v_pk_add_f32 v[88:89], v[88:89], v[92:93]
  v_pk_add_f32 v[90:91], v[90:91], v[94:95]
  v_cvt_pk_bf16_f32 v80, v72, v73
  v_lshlrev_b32 v72, 16, v80
  v_and_b32 v73, 0xffff0000, v80
  v_cvt_pk_bf16_f32 v81, v74, v75
  v_lshlrev_b32 v74, 16, v81
  v_and_b32 v75, 0xffff0000, v81
  v_cvt_pk_bf16_f32 v82, v88, v89
  v_lshlrev_b32 v88, 16, v82
  v_and_b32 v89, 0xffff0000, v82
  v_cvt_pk_bf16_f32 v83, v90, v91
  v_lshlrev_b32 v90, 16, v83
  v_and_b32 v91, 0xffff0000, v83
  ds_write_b128 v3, v[72:75]
  v_add_f32 v88, 1.0, v88
  v_add_f32 v89, 1.0, v89
  v_add_f32 v90, 1.0, v90
  v_add_f32 v91, 1.0, v91
  v_cvt_pk_bf16_f32 v80, v88, v89
  v_lshlrev_b32 v88, 16, v80
  v_and_b32 v89, 0xffff0000, v80
  v_cvt_pk_bf16_f32 v81, v90, v91
  v_lshlrev_b32 v90, 16, v81
  v_and_b32 v91, 0xffff0000, v81
  ds_write_b128 v3, v[88:91] offset:1024
  ds_read_b128 v[132:135], v4 offset:0
  ds_read_b128 v[164:167], v4 offset:1024
  ds_read_b128 v[136:139], v4 offset:16
  ds_read_b128 v[168:171], v4 offset:1040
  ds_read_b128 v[140:143], v4 offset:256
  ds_read_b128 v[172:175], v4 offset:1280
  ds_read_b128 v[144:147], v4 offset:272
  ds_read_b128 v[176:179], v4 offset:1296
  ds_read_b128 v[148:151], v4 offset:512
  ds_read_b128 v[180:183], v4 offset:1536
  ds_read_b128 v[152:155], v4 offset:528
  ds_read_b128 v[184:187], v4 offset:1552
  s_waitcnt lgkmcnt(8)
  ds_read_b128 v[156:159], v4 offset:768
  ds_read_b128 v[188:191], v4 offset:1792
  ds_read_b128 v[160:163], v4 offset:784
  ds_read_b128 v[192:195], v4 offset:1808
  s_waitcnt lgkmcnt(12)
  v_pk_fma_f32 v[24:25], v[24:25], v[164:165], v[132:133]
  v_pk_fma_f32 v[26:27], v[26:27], v[166:167], v[134:135]
  v_pk_fma_f32 v[28:29], v[28:29], v[168:169], v[136:137]
  v_pk_fma_f32 v[30:31], v[30:31], v[170:171], v[138:139]
  v_cvt_pk_bf16_f32 v8, v24, v25
  v_cvt_pk_bf16_f32 v9, v26, v27
  v_cvt_pk_bf16_f32 v10, v28, v29
  v_cvt_pk_bf16_f32 v11, v30, v31
  buffer_store_dwordx4 v[8:11], v5, s[4:7], s56 offen sc1
  s_waitcnt lgkmcnt(8)
  v_pk_fma_f32 v[32:33], v[32:33], v[172:173], v[140:141]
  v_pk_fma_f32 v[34:35], v[34:35], v[174:175], v[142:143]
  v_pk_fma_f32 v[36:37], v[36:37], v[176:177], v[144:145]
  v_pk_fma_f32 v[38:39], v[38:39], v[178:179], v[146:147]
  v_cvt_pk_bf16_f32 v12, v32, v33
  v_cvt_pk_bf16_f32 v13, v34, v35
  v_cvt_pk_bf16_f32 v14, v36, v37
  v_cvt_pk_bf16_f32 v15, v38, v39
  buffer_store_dwordx4 v[12:15], v5, s[4:7], s57 offen sc1
  s_waitcnt lgkmcnt(4)
  v_pk_fma_f32 v[40:41], v[40:41], v[180:181], v[148:149]
  v_pk_fma_f32 v[42:43], v[42:43], v[182:183], v[150:151]
  v_pk_fma_f32 v[44:45], v[44:45], v[184:185], v[152:153]
  v_pk_fma_f32 v[46:47], v[46:47], v[186:187], v[154:155]
  v_cvt_pk_bf16_f32 v16, v40, v41
  v_cvt_pk_bf16_f32 v17, v42, v43
  v_cvt_pk_bf16_f32 v18, v44, v45
  v_cvt_pk_bf16_f32 v19, v46, v47
  buffer_store_dwordx4 v[16:19], v5, s[4:7], s58 offen sc1
  s_waitcnt lgkmcnt(0)
  v_pk_fma_f32 v[48:49], v[48:49], v[188:189], v[156:157]
  v_pk_fma_f32 v[50:51], v[50:51], v[190:191], v[158:159]
  v_pk_fma_f32 v[52:53], v[52:53], v[192:193], v[160:161]
  v_pk_fma_f32 v[54:55], v[54:55], v[194:195], v[162:163]
  v_cvt_pk_bf16_f32 v20, v48, v49
  v_cvt_pk_bf16_f32 v21, v50, v51
  v_cvt_pk_bf16_f32 v22, v52, v53
  v_cvt_pk_bf16_f32 v23, v54, v55
  buffer_store_dwordx4 v[20:23], v5, s[4:7], s59 offen sc1
  v_mov_b32 v7, s19
  v_lshlrev_b32 v6, 2, v104
  s_waitcnt vmcnt(0)
  s_mov_b64 exec, 1
  buffer_store_dword v7, v6, s[64:67], s37 offen sc1
  s_mov_b64 exec, -1
  s_barrier
  s_add_u32 m0, s38, 13312
  s_nop 0
  buffer_load_dwordx4 v107, s[8:11], s17 offen lds
  buffer_load_dwordx4 v108, s[8:11], s17 offen offset:1024 lds
  buffer_load_dwordx4 v109, s[8:11], s17 offen offset:2048 lds
  s_add_u32 s17, s17, 196608
  s_cmp_eq_u32 s17, s10
  s_cselect_b32 s17, 0, s17
  s_add_u32 m0, s38, 26624
  s_nop 0
  buffer_load_dwordx4 v107, s[8:11], s17 offen lds
  buffer_load_dwordx4 v108, s[8:11], s17 offen offset:1024 lds
  buffer_load_dwordx4 v109, s[8:11], s17 offen offset:2048 lds
  s_add_u32 s17, s17, 196608
  s_cmp_eq_u32 s17, s10
  s_cselect_b32 s17, 0, s17
  s_add_u32 m0, s38, 39936
  s_nop 0
  buffer_load_dwordx4 v107, s[8:11], s17 offen lds
  buffer_load_dwordx4 v108, s[8:11], s17 offen offset:1024 lds
  buffer_load_dwordx4 v109, s[8:11], s17 offen offset:2048 lds
  s_add_u32 s17, s17, 196608
  s_cmp_eq_u32 s17, s10
  s_cselect_b32 s17, 0, s17
  s_add_u32 m0, s38, 53248
  s_nop 0
  buffer_load_dwordx4 v107, s[8:11], s17 offen lds
  buffer_load_dwordx4 v108, s[8:11], s17 offen offset:1024 lds
  buffer_load_dwordx4 v109, s[8:11], s17 offen offset:2048 lds
  s_add_u32 s17, s17, 196608
  s_cmp_eq_u32 s17, s10
  s_cselect_b32 s17, 0, s17
  s_add_u32 m0, s38, 66560
  s_nop 0
  buffer_load_dwordx4 v107, s[8:11], s17 offen lds
  buffer_load_dwordx4 v108, s[8:11], s17 offen offset:1024 lds
  buffer_load_dwordx4 v109, s[8:11], s17 offen offset:2048 lds
  s_add_u32 s17, s17, 196608
  s_cmp_eq_u32 s17, s10
  s_cselect_b32 s17, 0, s17
  s_add_u32 m0, s38, 79872
  s_nop 0
  buffer_load_dwordx4 v107, s[8:11], s17 offen lds
  buffer_load_dwordx4 v108, s[8:11], s17 offen offset:1024 lds
  buffer_load_dwordx4 v109, s[8:11], s17 offen offset:2048 lds
  s_add_u32 s17, s17, 196608
  s_cmp_eq_u32 s17, s10
  s_cselect_b32 s17, 0, s17
L_slow_6:
  s_mov_b32 s33, 262144
L_spin_8:
  buffer_load_dword v127, v128, s[64:67], 0 offen sc1
  s_waitcnt vmcnt(0)
  v_cmp_ne_u32 vcc, s19, v127
  s_nop 1
  s_cmp_eq_u64 vcc, 0
  s_cbranch_scc1 L_back_7
  s_sub_u32 s33, s33, 1
  s_cmp_lg_u32 s33, 0
  s_cbranch_scc1 L_spin_8
  s_branch L_back_7
L_back_7:
L_gemm_a:
  s_mov_b32 s6, 1048576
  s_add_u32 m0, s39, 0
  s_nop 0
  buffer_load_dword v106, s[4:7], s16 offen sc1 lds
  buffer_load_dwordx4 a[0:3], v105, s[4:7], s16 offen sc1
  buffer_load_dwordx4 a[4:7], v105, s[4:7], s16 offen offset:1024 sc1
  s_add_u32 s16, s16, 131072
  s_bitset0_b32 s16, 20
  s_add_u32 m0, s39, 13312
  s_nop 0
  buffer_load_dword v106, s[4:7], s16 offen sc1 lds
  buffer_load_dwordx4 a[8:11], v105, s[4:7], s16 offen sc1
  buffer_load_dwordx4 a[12:15], v105, s[4:7], s16 offen offset:1024 sc1
  s_add_u32 s16, s16, 131072
  s_bitset0_b32 s16, 20
  s_add_u32 m0, s39, 26624
  s_nop 0
  buffer_load_dword v106, s[4:7], s16 offen sc1 lds
  buffer_load_dwordx4 a[16:19], v105, s[4:7], s16 offen sc1
  buffer_load_dwordx4 a[20:23], v105, s[4:7], s16 offen offset:1024 sc1
  s_add_u32 s16, s16, 131072
  s_bitset0_b32 s16, 20
  s_bitcmp1_b32 s3, 0
  s_cselect_b32 s56, s62, s60
  s_cselect_b32 s57, s63, s61
  s_mov_b32 s58, 7340032
  s_mov_b32 s59, 0x20000
  s_lshl_b32 s97, s2, 1
  s_lshr_b32 s33, s3, 1
  s_add_u32 s97, s97, s33
  s_lshl_b32 s97, s97, 10
  v_lshrrev_b32 v110, 3, v104
  v_min_u32 v130, 1, v110
  v_lshlrev_b32 v130, 19, v130
  v_and_b32 v112, 7, v104
  v_lshl_add_u32 v130, v112, 7, v130
  s_bfe_u32 s36, s2, 0x20001
  s_lshl_b32 s36, s36, 2
  s_bfe_u32 s33, s2, 0x20003
  s_add_u32 s36, s36, s33
  s_lshr_b32 s37, s2, 5
  s_lshl_b32 s37, s37, 1
  s_and_b32 s33, s2, 1
  s_add_u32 s37, s37, s33
  s_and_b32 s33, s36, 3
  s_lshl_b32 s98, s33, 19
  v_and_b32 v111, 6, v110
  v_and_b32 v112, 7, v104
  v_xor_b32 v111, v111, v112
  v_lshlrev_b32 v110, 11, v110
  v_lshl_add_u32 v110, v111, 4, v110
  s_lshl_b32 s32, s3, 15
  s_lshl_b32 s33, s37, 7
  s_add_u32 s32, s32, s33
  v_add_u32 v248, s32, v110
  v_add_u32 v249, 15360, v248
  v_mov_b32 v244, -1
  v_mov_b32 v245, -1
  v_mov_b32 v246, -1
  v_mov_b32 v247, -1
  s_add_u32 s92, s20, 0xe00000
  s_addc_u32 s93, s21, 0
  s_mov_b32 s94, 0x800000
  s_mov_b32 s95, 0x20000
  s_lshl_b32 s35, s2, 2
  s_add_u32 s35, s35, s3
  s_lshl_b32 s35, s35, 12
  v_lshrrev_b32 v254, 4, v104
  s_movk_i32 s33, 24576
  v_mul_u32_u24 v254, s33, v254
  v_and_b32 v110, 15, v104
  v_lshl_add_u32 v254, v110, 4, v254
  v_and_b32 v110, 15, v104
  v_lshlrev_b32 v128, 11, v110
  v_bfe_u32 v112, v104, 4, 1
  v_lshl_add_u32 v128, v112, 5, v128
  v_lshrrev_b32 v112, 5, v104
  v_lshl_add_u32 v128, v112, 4, v128
  s_lshl_b32 s32, s36, 18
  s_lshl_b32 s33, s3, 16
  s_add_u32 s32, s32, s33
  s_lshl_b32 s33, s37, 7
  s_add_u32 s32, s32, s33
  v_add_u32 v128, s32, v128
  s_waitcnt vmcnt(6)
  s_barrier
  ds_read_b64_tr_b16 a[180:181], v118 offset:1024
  ds_read_b64_tr_b16 a[182:183], v118 offset:1536
  ds_read_b128 a[188:191], v119 offset:12288
  ds_read_b64_tr_b16 a[184:185], v118 offset:2048
  ds_read_b64_tr_b16 a[186:187], v118 offset:2560
  ds_read_b64_tr_b16 a[132:133], v114 offset:0
  ds_read_b64_tr_b16 a[134:135], v114 offset:512
  ds_read_b64_tr_b16 a[136:137], v115 offset:0
  ds_read_b64_tr_b16 a[138:139], v115 offset:512
  ds_read_b64_tr_b16 a[140:141], v116 offset:0
  ds_read_b64_tr_b16 a[142:143], v116 offset:512
  ds_read_b64_tr_b16 a[144:145], v117 offset:0
  ds_read_b64_tr_b16 a[146:147], v117 offset:512
  ds_read_b64_tr_b16 a[148:149], v114 offset:1024
  ds_read_b64_tr_b16 a[150:151], v114 offset:1536
  ds_read_b64_tr_b16 a[152:153], v115 offset:1024
  ds_read_b64_tr_b16 a[154:155], v115 offset:1536
  ds_read_b64_tr_b16 a[156:157], v116 offset:1024
  ds_read_b64_tr_b16 a[158:159], v116 offset:1536
  ds_read_b64_tr_b16 a[160:161], v117 offset:1024
  ds_read_b64_tr_b16 a[162:163], v117 offset:1536
  ds_read_b64_tr_b16 a[164:165], v114 offset:2048
  ds_read_b64_tr_b16 a[166:167], v114 offset:2560
  ds_read_b64_tr_b16 a[168:169], v115 offset:2048
  ds_read_b64_tr_b16 a[170:171], v115 offset:2560
  ds_read_b64_tr_b16 a[172:173], v116 offset:2048
  ds_read_b64_tr_b16 a[174:175], v116 offset:2560
  ds_read_b64_tr_b16 a[176:177], v117 offset:2048
  ds_read_b64_tr_b16 a[178:179], v117 offset:2560
  s_waitcnt vmcnt(3) lgkmcnt(10)
  s_barrier
  v_mfma_f32_16x16x32_bf16 v[96:99], a[180:183], a[188:191], 0
  ds_read_b64_tr_b16 a[180:181], v118 offset:14336
  s_add_u32 m0, s39, 39936
  v_mfma_f32_16x16x32_bf16 v[100:103], a[188:191], a[184:187], 0
  buffer_load_dword v106, s[4:7], s16 offen sc1 lds
  v_mfma_f32_16x16x32_bf16 v[0:3], a[132:135], a[0:3], 0
  buffer_load_dwordx4 a[24:27], v105, s[4:7], s16 offen sc1
  v_mfma_f32_16x16x32_bf16 v[48:51], a[132:135], a[4:7], 0
  ds_read_b64_tr_b16 a[182:183], v118 offset:14848
  buffer_load_dwordx4 a[28:31], v105, s[4:7], s16 offen offset:1024 sc1
  v_mfma_f32_16x16x32_bf16 v[52:55], a[136:139], a[4:7], 0
  ds_read_b128 a[188:191], v119 offset:25600
  ds_read_b64_tr_b16 a[184:185], v118 offset:15360
  ds_read_b64_tr_b16 a[186:187], v118 offset:15872
  s_add_u32 s16, s16, 131072
  v_mfma_f32_16x16x32_bf16 v[4:7], a[136:139], a[0:3], 0
  ds_read_b64_tr_b16 a[132:133], v114 offset:13312
  s_bitset0_b32 s16, 20
  v_mfma_f32_16x16x32_bf16 v[8:11], a[140:143], a[0:3], 0
  ds_read_b64_tr_b16 a[134:135], v114 offset:13824
  s_add_u32 m0, s39, 53248
  v_mfma_f32_16x16x32_bf16 v[56:59], a[140:143], a[4:7], 0
  buffer_load_dword v106, s[4:7], s16 offen sc1 lds
  v_mfma_f32_16x16x32_bf16 v[60:63], a[144:147], a[4:7], 0
  ds_read_b64_tr_b16 a[136:137], v115 offset:13312
  ds_read_b64_tr_b16 a[138:139], v115 offset:13824
  buffer_load_dwordx4 a[32:35], v105, s[4:7], s16 offen sc1
  v_mfma_f32_16x16x32_bf16 v[12:15], a[144:147], a[0:3], 0
  buffer_load_dwordx4 a[36:39], v105, s[4:7], s16 offen offset:1024 sc1
  v_mfma_f32_16x16x32_bf16 v[16:19], a[148:151], a[0:3], 0
  ds_read_b64_tr_b16 a[140:141], v116 offset:13312
  ds_read_b64_tr_b16 a[142:143], v116 offset:13824
  s_add_u32 s16, s16, 131072
  v_mfma_f32_16x16x32_bf16 v[64:67], a[148:151], a[4:7], 0
  ds_read_b64_tr_b16 a[144:145], v117 offset:13312
  s_bitset0_b32 s16, 20
  v_mfma_f32_16x16x32_bf16 v[68:71], a[152:155], a[4:7], 0
  ds_read_b64_tr_b16 a[146:147], v117 offset:13824
  s_add_u32 m0, s39, 66560
  v_mfma_f32_16x16x32_bf16 v[20:23], a[152:155], a[0:3], 0
  buffer_load_dword v106, s[4:7], s16 offen sc1 lds
  v_mfma_f32_16x16x32_bf16 v[24:27], a[156:159], a[0:3], 0
  ds_read_b64_tr_b16 a[148:149], v114 offset:14336
  ds_read_b64_tr_b16 a[150:151], v114 offset:14848
  buffer_load_dwordx4 a[40:43], v105, s[4:7], s16 offen sc1
  v_mfma_f32_16x16x32_bf16 v[72:75], a[156:159], a[4:7], 0
  buffer_load_dwordx4 a[44:47], v105, s[4:7], s16 offen offset:1024 sc1
  s_waitcnt lgkmcnt(10)
  v_mfma_f32_16x16x32_bf16 v[76:79], a[160:163], a[4:7], 0
  ds_read_b64_tr_b16 a[152:153], v115 offset:14336
  ds_read_b64_tr_b16 a[154:155], v115 offset:14848
  s_add_u32 s16, s16, 131072
  v_mfma_f32_16x16x32_bf16 v[28:31], a[160:163], a[0:3], 0
  ds_read_b64_tr_b16 a[156:157], v116 offset:14336
  s_bitset0_b32 s16, 20
  v_mfma_f32_16x16x32_bf16 v[32:35], a[0:3], a[164:167], 0
  ds_read_b64_tr_b16 a[158:159], v116 offset:14848
  s_add_u32 m0, s39, 79872
  v_mfma_f32_16x16x32_bf16 v[80:83], a[4:7], a[164:167], 0
  buffer_load_dword v106, s[4:7], s16 offen sc1 lds
  v_mfma_f32_16x16x32_bf16 v[84:87], a[4:7], a[168:171], 0
  ds_read_b64_tr_b16 a[160:161], v117 offset:14336
  ds_read_b64_tr_b16 a[162:163], v117 offset:14848
  buffer_load_dwordx4 a[48:51], v105, s[4:7], s16 offen sc1
  v_mfma_f32_16x16x32_bf16 v[36:39], a[0:3], a[168:171], 0
  buffer_load_dwordx4 a[52:55], v105, s[4:7], s16 offen offset:1024 sc1
  v_mfma_f32_16x16x32_bf16 v[40:43], a[0:3], a[172:175], 0
  ds_read_b64_tr_b16 a[164:165], v114 offset:15360
  ds_read_b64_tr_b16 a[166:167], v114 offset:15872
  s_add_u32 s16, s16, 131072
  v_mfma_f32_16x16x32_bf16 v[88:91], a[4:7], a[172:175], 0
  ds_read_b64_tr_b16 a[168:169], v115 offset:15360
  s_bitset0_b32 s16, 20
  v_mfma_f32_16x16x32_bf16 v[92:95], a[4:7], a[176:179], 0
  ds_read_b64_tr_b16 a[170:171], v115 offset:15872
  ds_read_b64_tr_b16 a[172:173], v116 offset:15360
  v_mfma_f32_16x16x32_bf16 v[44:47], a[0:3], a[176:179], 0
  s_waitcnt vmcnt(12) lgkmcnt(10)
  s_barrier
  v_mfma_f32_16x16x32_bf16 v[96:99], a[180:183], a[188:191], v[96:99]
  ds_read_b64_tr_b16 a[174:175], v116 offset:15872
  s_add_u32 m0, s38, 93184
  v_mfma_f32_16x16x32_bf16 v[100:103], a[188:191], a[184:187], v[100:103]
  buffer_load_dwordx4 v107, s[8:11], s17 offen lds
  v_mfma_f32_16x16x32_bf16 v[0:3], a[132:135], a[8:11], v[0:3]
  ds_read_b64_tr_b16 a[176:177], v117 offset:15360
  ds_read_b64_tr_b16 a[178:179], v117 offset:15872
  v_mfma_f32_16x16x32_bf16 v[48:51], a[132:135], a[12:15], v[48:51]
  ds_read_b64_tr_b16 a[180:181], v118 offset:27648
  ds_read_b64_tr_b16 a[182:183], v118 offset:28160
  buffer_load_dword v127, v126, s[64:67], 0 offen sc1
  v_mfma_f32_16x16x32_bf16 v[52:55], a[136:139], a[12:15], v[52:55]
  ds_read_b128 a[188:191], v119 offset:38912
  ds_read_b64_tr_b16 a[184:185], v118 offset:28672
  ds_read_b64_tr_b16 a[186:187], v118 offset:29184
  buffer_load_dwordx4 v108, s[8:11], s17 offen offset:1024 lds
  v_mfma_f32_16x16x32_bf16 v[4:7], a[136:139], a[8:11], v[4:7]
  buffer_load_dwordx4 v109, s[8:11], s17 offen offset:2048 lds
  v_mfma_f32_16x16x32_bf16 v[8:11], a[140:143], a[8:11], v[8:11]
  ds_read_b64_tr_b16 a[132:133], v114 offset:26624
  ds_read_b64_tr_b16 a[134:135], v114 offset:27136
  v_mfma_f32_16x16x32_bf16 v[56:59], a[140:143], a[12:15], v[56:59]
  ds_read_b64_tr_b16 a[136:137], v115 offset:26624
  s_add_u32 s17, s17, 196608
  v_mfma_f32_16x16x32_bf16 v[60:63], a[144:147], a[12:15], v[60:63]
  ds_read_b64_tr_b16 a[138:139], v115 offset:27136
  s_cmp_eq_u32 s17, s10
  s_cselect_b32 s17, 0, s17
  v_mfma_f32_16x16x32_bf16 v[12:15], a[144:147], a[8:11], v[12:15]
  ds_read_b64_tr_b16 a[140:141], v116 offset:26624
  ds_read_b64_tr_b16 a[142:143], v116 offset:27136
  v_mfma_f32_16x16x32_bf16 v[16:19], a[148:151], a[8:11], v[16:19]
  s_add_u32 s8, s8, s10
  s_addc_u32 s9, s9, 0
  v_mfma_f32_16x16x32_bf16 v[64:67], a[148:151], a[12:15], v[64:67]
  ds_read_b64_tr_b16 a[144:145], v117 offset:26624
  ds_read_b64_tr_b16 a[146:147], v117 offset:27136
  s_waitcnt lgkmcnt(10)
  v_mfma_f32_16x16x32_bf16 v[68:71], a[152:155], a[12:15], v[68:71]
  ds_read_b64_tr_b16 a[148:149], v114 offset:27648
  s_add_u32 m0, s39, 93184
  v_mfma_f32_16x16x32_bf16 v[20:23], a[152:155], a[8:11], v[20:23]
  s_add_u32 s40, s20, 0x40000
  s_addc_u32 s41, s21, 0
  s_mov_b32 s42, 0x0
  s_mov_b32 s43, 0x20000
  s_or_b32 s33, s2, s3
  s_cmp_eq_u32 s33, 0
  s_cselect_b32 s42, 4, 0
  v_mov_b32 v192, s19
  buffer_store_dword v192, v119, s[40:43], 0 offen sc1
  v_mfma_f32_16x16x32_bf16 v[24:27], a[156:159], a[8:11], v[24:27]
  ds_read_b64_tr_b16 a[150:151], v114 offset:28160
  buffer_load_dword v106, s[4:7], s16 offen sc1 lds
  v_mfma_f32_16x16x32_bf16 v[72:75], a[156:159], a[12:15], v[72:75]
  ds_read_b64_tr_b16 a[152:153], v115 offset:27648
  ds_read_b64_tr_b16 a[154:155], v115 offset:28160
  v_mfma_f32_16x16x32_bf16 v[76:79], a[160:163], a[12:15], v[76:79]
  buffer_load_dwordx4 a[56:59], v105, s[4:7], s16 offen sc1
  v_mfma_f32_16x16x32_bf16 v[28:31], a[160:163], a[8:11], v[28:31]
  buffer_load_dwordx4 a[60:63], v105, s[4:7], s16 offen offset:1024 sc1
  v_mfma_f32_16x16x32_bf16 v[32:35], a[8:11], a[164:167], v[32:35]
  ds_read_b64_tr_b16 a[156:157], v116 offset:27648
  ds_read_b64_tr_b16 a[158:159], v116 offset:28160
  v_mfma_f32_16x16x32_bf16 v[80:83], a[12:15], a[164:167], v[80:83]
  ds_read_b64_tr_b16 a[160:161], v117 offset:27648
  s_add_u32 s16, s16, 131072
  v_mfma_f32_16x16x32_bf16 v[84:87], a[12:15], a[168:171], v[84:87]
  ds_read_b64_tr_b16 a[162:163], v117 offset:28160
  ds_read_b64_tr_b16 a[164:165], v114 offset:28672
  v_mfma_f32_16x16x32_bf16 v[36:39], a[8:11], a[168:171], v[36:39]
  ds_read_b64_tr_b16 a[166:167], v114 offset:29184
  s_bitset0_b32 s16, 20
  v_mfma_f32_16x16x32_bf16 v[40:43], a[8:11], a[172:175], v[40:43]
  ds_read_b64_tr_b16 a[168:169], v115 offset:28672
  ds_read_b64_tr_b16 a[170:171], v115 offset:29184
  v_mfma_f32_16x16x32_bf16 v[88:91], a[12:15], a[172:175], v[88:91]
  s_add_u32 s4, s4, s6
  s_addc_u32 s5, s5, 0
  v_mfma_f32_16x16x32_bf16 v[92:95], a[12:15], a[176:179], v[92:95]
  ds_read_b64_tr_b16 a[172:173], v116 offset:28672
  ds_read_b64_tr_b16 a[174:175], v116 offset:29184
  v_mfma_f32_16x16x32_bf16 v[44:47], a[8:11], a[176:179], v[44:47]
  s_waitcnt vmcnt(6) lgkmcnt(10)
  s_barrier
  v_cmp_ne_u32 vcc, s19, v127
  s_nop 1
  s_cmp_lg_u64 vcc, 0
  s_cbranch_scc1 L_slow_9
  L_back_10:
  v_mfma_f32_16x16x32_bf16 v[96:99], a[180:183], a[188:191], v[96:99]
  s_add_u32 m0, s39, 0
  s_nop 0
  buffer_load_dword v106, s[4:7], s16 offen sc1 lds
  v_mfma_f32_16x16x32_bf16 v[100:103], a[188:191], a[184:187], v[100:103]
  buffer_load_dwordx4 a[0:3], v105, s[4:7], s16 offen sc1
  v_mfma_f32_16x16x32_bf16 v[0:3], a[132:135], a[16:19], v[0:3]
  ds_read_b64_tr_b16 a[176:177], v117 offset:28672
  ds_read_b64_tr_b16 a[178:179], v117 offset:29184
  buffer_load_dwordx4 a[4:7], v105, s[4:7], s16 offen offset:1024 sc1
  v_mfma_f32_16x16x32_bf16 v[48:51], a[132:135], a[20:23], v[48:51]
  ds_read_b64_tr_b16 a[180:181], v118 offset:40960
  ds_read_b64_tr_b16 a[182:183], v118 offset:41472
  s_add_u32 s16, s16, 131072
  v_mfma_f32_16x16x32_bf16 v[52:55], a[136:139], a[20:23], v[52:55]
  ds_read_b128 a[188:191], v119 offset:52224
  ds_read_b64_tr_b16 a[184:185], v118 offset:41984
  ds_read_b64_tr_b16 a[186:187], v118 offset:42496
  s_bitset0_b32 s16, 20
  v_mfma_f32_16x16x32_bf16 v[4:7], a[136:139], a[16:19], v[4:7]
  ds_read_b64_tr_b16 a[132:133], v114 offset:39936
  s_add_u32 m0, s38, 0
  v_mfma_f32_16x16x32_bf16 v[8:11], a[140:143], a[16:19], v[8:11]
  ds_read_b64_tr_b16 a[134:135], v114 offset:40448
  buffer_load_dwordx4 v107, s[8:11], s17 offen lds
  buffer_load_dwordx4 v108, s[8:11], s17 offen offset:1024 lds
  v_mfma_f32_16x16x32_bf16 v[56:59], a[140:143], a[20:23], v[56:59]
  buffer_load_dwordx4 v109, s[8:11], s17 offen offset:2048 lds
  v_mfma_f32_16x16x32_bf16 v[60:63], a[144:147], a[20:23], v[60:63]
  ds_read_b64_tr_b16 a[136:137], v115 offset:39936
  ds_read_b64_tr_b16 a[138:139], v115 offset:40448
  s_add_u32 s17, s17, 196608
  v_mfma_f32_16x16x32_bf16 v[12:15], a[144:147], a[16:19], v[12:15]
  ds_read_b64_tr_b16 a[140:141], v116 offset:39936
  s_cmp_eq_u32 s17, s10
  v_mfma_f32_16x16x32_bf16 v[16:19], a[148:151], a[16:19], v[16:19]
  ds_read_b64_tr_b16 a[142:143], v116 offset:40448
  s_cselect_b32 s17, 0, s17
  v_mfma_f32_16x16x32_bf16 v[64:67], a[148:151], a[20:23], v[64:67]
  ds_read_b64_tr_b16 a[144:145], v117 offset:39936
  s_mov_b32 m0, s51
  v_mfma_f32_16x16x32_bf16 v[68:71], a[152:155], a[20:23], v[68:71]
  ds_read_b64_tr_b16 a[146:147], v117 offset:40448
  s_add_u32 s51, s51, 1024
  buffer_load_dwordx4 v129, s[52:55], s50 offen nt lds
  v_mfma_f32_16x16x32_bf16 v[20:23], a[152:155], a[16:19], v[20:23]
  ds_read_b64_tr_b16 a[148:149], v114 offset:40960
  s_add_u32 s50, s50, 98304
  s_waitcnt lgkmcnt(10)
  v_mfma_f32_16x16x32_bf16 v[24:27], a[156:159], a[16:19], v[24:27]
  ds_read_b64_tr_b16 a[150:151], v114 offset:41472
  s_mov_b32 m0, s51
  v_mfma_f32_16x16x32_bf16 v[72:75], a[156:159], a[20:23], v[72:75]
  ds_read_b64_tr_b16 a[152:153], v115 offset:40960
  s_add_u32 s51, s51, 1024
  v_mfma_f32_16x16x32_bf16 v[76:79], a[160:163], a[20:23], v[76:79]
  ds_read_b64_tr_b16 a[154:155], v115 offset:41472
  buffer_load_dwordx4 v129, s[52:55], s50 offen nt lds
  v_mfma_f32_16x16x32_bf16 v[28:31], a[160:163], a[16:19], v[28:31]
  ds_read_b64_tr_b16 a[156:157], v116 offset:40960
  s_add_u32 s50, s50, 98304
  v_mfma_f32_16x16x32_bf16 v[32:35], a[16:19], a[164:167], v[32:35]
  ds_read_b64_tr_b16 a[158:159], v116 offset:41472
  s_mov_b32 m0, s51
  s_add_u32 s51, s51, 1024
  v_mfma_f32_16x16x32_bf16 v[80:83], a[20:23], a[164:167], v[80:83]
  buffer_load_dwordx4 v129, s[52:55], s50 offen nt lds
  v_mfma_f32_16x16x32_bf16 v[84:87], a[20:23], a[168:171], v[84:87]
  ds_read_b64_tr_b16 a[160:161], v117 offset:40960
  ds_read_b64_tr_b16 a[162:163], v117 offset:41472
  s_add_u32 s50, s50, 98304
  v_mfma_f32_16x16x32_bf16 v[36:39], a[16:19], a[168:171], v[36:39]
  ds_read_b64_tr_b16 a[164:165], v114 offset:41984
  s_mov_b32 m0, s51
  v_mfma_f32_16x16x32_bf16 v[40:43], a[16:19], a[172:175], v[40:43]
  ds_read_b64_tr_b16 a[166:167], v114 offset:42496
  s_add_u32 s51, s51, 1024
  v_mfma_f32_16x16x32_bf16 v[88:91], a[20:23], a[172:175], v[88:91]
  buffer_load_dwordx4 v129, s[52:55], s50 offen nt lds
  v_mfma_f32_16x16x32_bf16 v[92:95], a[20:23], a[176:179], v[92:95]
  ds_read_b64_tr_b16 a[168:169], v115 offset:41984
  ds_read_b64_tr_b16 a[170:171], v115 offset:42496
  s_add_u32 s50, s50, 98304
  v_mfma_f32_16x16x32_bf16 v[44:47], a[16:19], a[176:179], v[44:47]
  s_waitcnt vmcnt(24) lgkmcnt(10)
  s_barrier
  v_mfma_f32_16x16x32_bf16 v[96:99], a[180:183], a[188:191], v[96:99]
  ds_read_b64_tr_b16 a[172:173], v116 offset:41984
  ds_read_b64_tr_b16 a[174:175], v116 offset:42496
  v_mfma_f32_16x16x32_bf16 v[100:103], a[188:191], a[184:187], v[100:103]
  ds_read_b64_tr_b16 a[176:177], v117 offset:41984
  ds_read_b64_tr_b16 a[178:179], v117 offset:42496
  v_mfma_f32_16x16x32_bf16 v[0:3], a[132:135], a[24:27], v[0:3]
  ds_read_b64_tr_b16 a[180:181], v124 offset:1024
  ds_read_b64_tr_b16 a[182:183], v124 offset:1536
  v_mfma_f32_16x16x32_bf16 v[48:51], a[132:135], a[28:31], v[48:51]
  ds_read_b128 a[188:191], v125 offset:12288
  ds_read_b64_tr_b16 a[184:185], v124 offset:2048
  v_mfma_f32_16x16x32_bf16 v[52:55], a[136:139], a[28:31], v[52:55]
  ds_read_b64_tr_b16 a[186:187], v124 offset:2560
  ds_read_b64_tr_b16 a[132:133], v120 offset:0
  v_mfma_f32_16x16x32_bf16 v[4:7], a[136:139], a[24:27], v[4:7]
  ds_read_b64_tr_b16 a[134:135], v120 offset:512
  ds_read_b64_tr_b16 a[136:137], v121 offset:0
  v_mfma_f32_16x16x32_bf16 v[8:11], a[140:143], a[24:27], v[8:11]
  ds_read_b64_tr_b16 a[138:139], v121 offset:512
  v_mfma_f32_16x16x32_bf16 v[56:59], a[140:143], a[28:31], v[56:59]
  ds_read_b64_tr_b16 a[140:141], v122 offset:0
  ds_read_b64_tr_b16 a[142:143], v122 offset:512
  v_mfma_f32_16x16x32_bf16 v[60:63], a[144:147], a[28:31], v[60:63]
  v_mfma_f32_16x16x32_bf16 v[12:15], a[144:147], a[24:27], v[12:15]
  ds_read_b64_tr_b16 a[144:145], v123 offset:0
  ds_read_b64_tr_b16 a[146:147], v123 offset:512
  v_mfma_f32_16x16x32_bf16 v[16:19], a[148:151], a[24:27], v[16:19]
  v_mfma_f32_16x16x32_bf16 v[64:67], a[148:151], a[28:31], v[64:67]
  ds_read_b64_tr_b16 a[148:149], v120 offset:1024
  ds_read_b64_tr_b16 a[150:151], v120 offset:1536
  s_waitcnt lgkmcnt(10)
  v_mfma_f32_16x16x32_bf16 v[68:71], a[152:155], a[28:31], v[68:71]
  v_mfma_f32_16x16x32_bf16 v[20:23], a[152:155], a[24:27], v[20:23]
  ds_read_b64_tr_b16 a[152:153], v121 offset:1024
  ds_read_b64_tr_b16 a[154:155], v121 offset:1536
  v_mfma_f32_16x16x32_bf16 v[24:27], a[156:159], a[24:27], v[24:27]
  v_mfma_f32_16x16x32_bf16 v[72:75], a[156:159], a[28:31], v[72:75]
  ds_read_b64_tr_b16 a[156:157], v122 offset:1024
  ds_read_b64_tr_b16 a[158:159], v122 offset:1536
  v_mfma_f32_16x16x32_bf16 v[76:79], a[160:163], a[28:31], v[76:79]
  v_mfma_f32_16x16x32_bf16 v[28:31], a[160:163], a[24:27], v[28:31]
  ds_read_b64_tr_b16 a[160:161], v123 offset:1024
  ds_read_b64_tr_b16 a[162:163], v123 offset:1536
  v_mfma_f32_16x16x32_bf16 v[32:35], a[24:27], a[164:167], v[32:35]
  v_mfma_f32_16x16x32_bf16 v[80:83], a[28:31], a[164:167], v[80:83]
  ds_read_b64_tr_b16 a[164:165], v120 offset:2048
  ds_read_b64_tr_b16 a[166:167], v120 offset:2560
  v_mfma_f32_16x16x32_bf16 v[84:87], a[28:31], a[168:171], v[84:87]
  v_mfma_f32_16x16x32_bf16 v[36:39], a[24:27], a[168:171], v[36:39]
  ds_read_b64_tr_b16 a[168:169], v121 offset:2048
  ds_read_b64_tr_b16 a[170:171], v121 offset:2560
  v_mfma_f32_16x16x32_bf16 v[40:43], a[24:27], a[172:175], v[40:43]
  v_mfma_f32_16x16x32_bf16 v[88:91], a[28:31], a[172:175], v[88:91]
  ds_read_b64_tr_b16 a[172:173], v122 offset:2048
  ds_read_b64_tr_b16 a[174:175], v122 offset:2560
  v_mfma_f32_16x16x32_bf16 v[92:95], a[28:31], a[176:179], v[92:95]
  v_mfma_f32_16x16x32_bf16 v[44:47], a[24:27], a[176:179], v[44:47]
  s_waitcnt vmcnt(21) lgkmcnt(10)
  s_barrier
  v_mfma_f32_16x16x32_bf16 v[96:99], a[180:183], a[188:191], v[96:99]
  buffer_store_dwordx4 v[244:247], v119, s[92:95], s35 offen offset:0 sc1
  v_mfma_f32_16x16x32_bf16 v[100:103], a[188:191], a[184:187], v[100:103]
  ds_read_b64_tr_b16 a[176:177], v123 offset:2048
  ds_read_b64_tr_b16 a[178:179], v123 offset:2560
  v_mfma_f32_16x16x32_bf16 v[0:3], a[132:135], a[32:35], v[0:3]
  ds_read_b64_tr_b16 a[180:181], v124 offset:14336
  ds_read_b64_tr_b16 a[182:183], v124 offset:14848
  v_mfma_f32_16x16x32_bf16 v[48:51], a[132:135], a[36:39], v[48:51]
  ds_read_b128 a[188:191], v125 offset:25600
  ds_read_b64_tr_b16 a[184:185], v124 offset:15360
  v_mfma_f32_16x16x32_bf16 v[52:55], a[136:139], a[36:39], v[52:55]
  ds_read_b64_tr_b16 a[186:187], v124 offset:15872
  ds_read_b64_tr_b16 a[132:133], v120 offset:13312
  v_mfma_f32_16x16x32_bf16 v[4:7], a[136:139], a[32:35], v[4:7]
  ds_read_b64_tr_b16 a[134:135], v120 offset:13824
  ds_read_b64_tr_b16 a[136:137], v121 offset:13312
  v_mfma_f32_16x16x32_bf16 v[8:11], a[140:143], a[32:35], v[8:11]
  ds_read_b64_tr_b16 a[138:139], v121 offset:13824
  v_mfma_f32_16x16x32_bf16 v[56:59], a[140:143], a[36:39], v[56:59]
  ds_read_b64_tr_b16 a[140:141], v122 offset:13312
  ds_read_b64_tr_b16 a[142:143], v122 offset:13824
  v_mfma_f32_16x16x32_bf16 v[60:63], a[144:147], a[36:39], v[60:63]
  v_mfma_f32_16x16x32_bf16 v[12:15], a[144:147], a[32:35], v[12:15]
  ds_read_b64_tr_b16 a[144:145], v123 offset:13312
  ds_read_b64_tr_b16 a[146:147], v123 offset:13824
  v_mfma_f32_16x16x32_bf16 v[16:19], a[148:151], a[32:35], v[16:19]
  v_mfma_f32_16x16x32_bf16 v[64:67], a[148:151], a[36:39], v[64:67]
  ds_read_b64_tr_b16 a[148:149], v120 offset:14336
  ds_read_b64_tr_b16 a[150:151], v120 offset:14848
  v_mfma_f32_16x16x32_bf16 v[68:71], a[152:155], a[36:39], v[68:71]
  v_mfma_f32_16x16x32_bf16 v[20:23], a[152:155], a[32:35], v[20:23]
  ds_read_b64_tr_b16 a[152:153], v121 offset:14336
  ds_read_b64_tr_b16 a[154:155], v121 offset:14848
  s_waitcnt lgkmcnt(10)
  v_mfma_f32_16x16x32_bf16 v[24:27], a[156:159], a[32:35], v[24:27]
  v_mfma_f32_16x16x32_bf16 v[72:75], a[156:159], a[36:39], v[72:75]
  ds_read_b64_tr_b16 a[156:157], v122 offset:14336
  ds_read_b64_tr_b16 a[158:159], v122 offset:14848
  v_mfma_f32_16x16x32_bf16 v[76:79], a[160:163], a[36:39], v[76:79]
  v_mfma_f32_16x16x32_bf16 v[28:31], a[160:163], a[32:35], v[28:31]
  ds_read_b64_tr_b16 a[160:161], v123 offset:14336
  ds_read_b64_tr_b16 a[162:163], v123 offset:14848
  v_mfma_f32_16x16x32_bf16 v[32:35], a[32:35], a[164:167], v[32:35]
  v_mfma_f32_16x16x32_bf16 v[80:83], a[36:39], a[164:167], v[80:83]
  ds_read_b64_tr_b16 a[164:165], v120 offset:15360
  ds_read_b64_tr_b16 a[166:167], v120 offset:15872
  v_mfma_f32_16x16x32_bf16 v[84:87], a[36:39], a[168:171], v[84:87]
  v_mfma_f32_16x16x32_bf16 v[36:39], a[32:35], a[168:171], v[36:39]
  ds_read_b64_tr_b16 a[168:169], v121 offset:15360
  ds_read_b64_tr_b16 a[170:171], v121 offset:15872
  v_mfma_f32_16x16x32_bf16 v[40:43], a[32:35], a[172:175], v[40:43]
  v_mfma_f32_16x16x32_bf16 v[88:91], a[36:39], a[172:175], v[88:91]
  ds_read_b64_tr_b16 a[172:173], v122 offset:15360
  ds_read_b64_tr_b16 a[174:175], v122 offset:15872
  v_mfma_f32_16x16x32_bf16 v[92:95], a[36:39], a[176:179], v[92:95]
  v_mfma_f32_16x16x32_bf16 v[44:47], a[32:35], a[176:179], v[44:47]
  s_waitcnt vmcnt(19) lgkmcnt(10)
  s_barrier
  v_mfma_f32_16x16x32_bf16 v[96:99], a[180:183], a[188:191], v[96:99]
  ds_read_b64_tr_b16 a[176:177], v123 offset:15360
  s_add_u32 m0, s38, 13312
  v_mfma_f32_16x16x32_bf16 v[100:103], a[188:191], a[184:187], v[100:103]
  buffer_load_dwordx4 v107, s[8:11], s17 offen lds
  v_mfma_f32_16x16x32_bf16 v[0:3], a[132:135], a[40:43], v[0:3]
  ds_read_b64_tr_b16 a[178:179], v123 offset:15872
  buffer_load_dwordx4 v108, s[8:11], s17 offen offset:1024 lds
  v_mfma_f32_16x16x32_bf16 v[48:51], a[132:135], a[44:47], v[48:51]
  ds_read_b64_tr_b16 a[180:181], v124 offset:27648
  ds_read_b64_tr_b16 a[182:183], v124 offset:28160
  buffer_load_dwordx4 v109, s[8:11], s17 offen offset:2048 lds
  v_mfma_f32_16x16x32_bf16 v[52:55], a[136:139], a[44:47], v[52:55]
  ds_read_b128 a[188:191], v125 offset:38912
  ds_read_b64_tr_b16 a[184:185], v124 offset:28672
  ds_read_b64_tr_b16 a[186:187], v124 offset:29184
  v_mfma_f32_16x16x32_bf16 v[4:7], a[136:139], a[40:43], v[4:7]
  ds_read_b64_tr_b16 a[132:133], v120 offset:26624
  s_add_u32 s17, s17, 196608
  v_mfma_f32_16x16x32_bf16 v[8:11], a[140:143], a[40:43], v[8:11]
  ds_read_b64_tr_b16 a[134:135], v120 offset:27136
  s_cmp_eq_u32 s17, s10
  v_mfma_f32_16x16x32_bf16 v[56:59], a[140:143], a[44:47], v[56:59]
  ds_read_b64_tr_b16 a[136:137], v121 offset:26624
  s_cselect_b32 s17, 0, s17
  v_mfma_f32_16x16x32_bf16 v[60:63], a[144:147], a[44:47], v[60:63]
  ds_read_b64_tr_b16 a[138:139], v121 offset:27136
  s_add_u32 m0, s39, 13312
  v_mfma_f32_16x16x32_bf16 v[12:15], a[144:147], a[40:43], v[12:15]
  ds_read_b64_tr_b16 a[140:141], v122 offset:26624
  ds_read_b64_tr_b16 a[142:143], v122 offset:27136
  v_mfma_f32_16x16x32_bf16 v[16:19], a[148:151], a[40:43], v[16:19]
  buffer_load_dword v106, s[4:7], s16 offen sc1 lds
  v_mfma_f32_16x16x32_bf16 v[64:67], a[148:151], a[44:47], v[64:67]
  buffer_load_dwordx4 a[8:11], v105, s[4:7], s16 offen sc1
  v_mfma_f32_16x16x32_bf16 v[68:71], a[152:155], a[44:47], v[68:71]
  ds_read_b64_tr_b16 a[144:145], v123 offset:26624
  ds_read_b64_tr_b16 a[146:147], v123 offset:27136
  buffer_load_dwordx4 a[12:15], v105, s[4:7], s16 offen offset:1024 sc1
  v_mfma_f32_16x16x32_bf16 v[20:23], a[152:155], a[40:43], v[20:23]
  ds_read_b64_tr_b16 a[148:149], v120 offset:27648
  s_add_u32 s16, s16, 131072
  s_waitcnt lgkmcnt(10)
  v_mfma_f32_16x16x32_bf16 v[24:27], a[156:159], a[40:43], v[24:27]
  ds_read_b64_tr_b16 a[150:151], v120 offset:28160
  ds_read_b64_tr_b16 a[152:153], v121 offset:27648
  v_mfma_f32_16x16x32_bf16 v[72:75], a[156:159], a[44:47], v[72:75]
  ds_read_b64_tr_b16 a[154:155], v121 offset:28160
  s_bitset0_b32 s16, 20
  v_mfma_f32_16x16x32_bf16 v[76:79], a[160:163], a[44:47], v[76:79]
  ds_read_b64_tr_b16 a[156:157], v122 offset:27648
  s_add_u32 m0, s38, 26624
  v_mfma_f32_16x16x32_bf16 v[28:31], a[160:163], a[40:43], v[28:31]
  buffer_load_dwordx4 v107, s[8:11], s17 offen lds
  v_mfma_f32_16x16x32_bf16 v[32:35], a[40:43], a[164:167], v[32:35]
  ds_read_b64_tr_b16 a[158:159], v122 offset:28160
  buffer_load_dwordx4 v108, s[8:11], s17 offen offset:1024 lds
  v_mfma_f32_16x16x32_bf16 v[80:83], a[44:47], a[164:167], v[80:83]
  ds_read_b64_tr_b16 a[160:161], v123 offset:27648
  ds_read_b64_tr_b16 a[162:163], v123 offset:28160
  v_mfma_f32_16x16x32_bf16 v[84:87], a[44:47], a[168:171], v[84:87]
  buffer_load_dwordx4 v109, s[8:11], s17 offen offset:2048 lds
  v_mfma_f32_16x16x32_bf16 v[36:39], a[40:43], a[168:171], v[36:39]
  ds_read_b64_tr_b16 a[164:165], v120 offset:28672
  s_add_u32 s17, s17, 196608
  v_mfma_f32_16x16x32_bf16 v[40:43], a[40:43], a[172:175], v[40:43]
  ds_read_b64_tr_b16 a[166:167], v120 offset:29184
  s_cmp_eq_u32 s17, s10
  v_mfma_f32_16x16x32_bf16 v[88:91], a[44:47], a[172:175], v[88:91]
  ds_read_b64_tr_b16 a[168:169], v121 offset:28672
  s_cselect_b32 s17, 0, s17
  v_mfma_f32_16x16x32_bf16 v[92:95], a[44:47], a[176:179], v[92:95]
  ds_read_b64_tr_b16 a[170:171], v121 offset:29184
  ds_read_b64_tr_b16 a[172:173], v122 offset:28672
  v_mfma_f32_16x16x32_bf16 v[44:47], a[40:43], a[176:179], v[44:47]
  s_waitcnt vmcnt(20) lgkmcnt(10)
  s_barrier
  v_mfma_f32_16x16x32_bf16 v[96:99], a[180:183], a[188:191], v[96:99]
  ds_read_b64_tr_b16 a[174:175], v122 offset:29184
  s_add_u32 m0, s39, 26624
  v_mfma_f32_16x16x32_bf16 v[100:103], a[188:191], a[184:187], v[100:103]
  buffer_load_dword v106, s[4:7], s16 offen sc1 lds
  v_mfma_f32_16x16x32_bf16 v[0:3], a[132:135], a[48:51], v[0:3]
  ds_read_b64_tr_b16 a[176:177], v123 offset:28672
  ds_read_b64_tr_b16 a[178:179], v123 offset:29184
  buffer_load_dwordx4 a[16:19], v105, s[4:7], s16 offen sc1
  v_mfma_f32_16x16x32_bf16 v[48:51], a[132:135], a[52:55], v[48:51]
  ds_read_b64_tr_b16 a[180:181], v124 offset:40960
  ds_read_b64_tr_b16 a[182:183], v124 offset:41472
  buffer_load_dwordx4 a[20:23], v105, s[4:7], s16 offen offset:1024 sc1
  v_mfma_f32_16x16x32_bf16 v[52:55], a[136:139], a[52:55], v[52:55]
  ds_read_b128 a[188:191], v125 offset:52224
  ds_read_b64_tr_b16 a[184:185], v124 offset:41984
  ds_read_b64_tr_b16 a[186:187], v124 offset:42496
  v_mfma_f32_16x16x32_bf16 v[4:7], a[136:139], a[48:51], v[4:7]
  ds_read_b64_tr_b16 a[132:133], v120 offset:39936
  s_add_u32 s16, s16, 131072
  v_mfma_f32_16x16x32_bf16 v[8:11], a[140:143], a[48:51], v[8:11]
  ds_read_b64_tr_b16 a[134:135], v120 offset:40448
  s_bitset0_b32 s16, 20
  v_mfma_f32_16x16x32_bf16 v[56:59], a[140:143], a[52:55], v[56:59]
  ds_read_b64_tr_b16 a[136:137], v121 offset:39936
  s_add_u32 m0, s38, 39936
  v_mfma_f32_16x16x32_bf16 v[60:63], a[144:147], a[52:55], v[60:63]
  ds_read_b64_tr_b16 a[138:139], v121 offset:40448
  ds_read_b64_tr_b16 a[140:141], v122 offset:39936
  v_mfma_f32_16x16x32_bf16 v[12:15], a[144:147], a[48:51], v[12:15]
  buffer_load_dwordx4 v107, s[8:11], s17 offen lds
  v_mfma_f32_16x16x32_bf16 v[16:19], a[148:151], a[48:51], v[16:19]
  ds_read_b64_tr_b16 a[142:143], v122 offset:40448
  buffer_load_dwordx4 v108, s[8:11], s17 offen offset:1024 lds
  v_mfma_f32_16x16x32_bf16 v[64:67], a[148:151], a[52:55], v[64:67]
  buffer_load_dwordx4 v109, s[8:11], s17 offen offset:2048 lds
  s_waitcnt lgkmcnt(10)
  v_mfma_f32_16x16x32_bf16 v[68:71], a[152:155], a[52:55], v[68:71]
  ds_read_b64_tr_b16 a[144:145], v123 offset:39936
  ds_read_b64_tr_b16 a[146:147], v123 offset:40448
  v_mfma_f32_16x16x32_bf16 v[20:23], a[152:155], a[48:51], v[20:23]
  ds_read_b64_tr_b16 a[148:149], v120 offset:40960
  s_add_u32 s17, s17, 196608
  v_mfma_f32_16x16x32_bf16 v[24:27], a[156:159], a[48:51], v[24:27]
  ds_read_b64_tr_b16 a[150:151], v120 offset:41472
  s_cmp_eq_u32 s17, s10
  v_mfma_f32_16x16x32_bf16 v[72:75], a[156:159], a[52:55], v[72:75]
  ds_read_b64_tr_b16 a[152:153], v121 offset:40960
  s_cselect_b32 s17, 0, s17
  v_mfma_f32_16x16x32_bf16 v[76:79], a[160:163], a[52:55], v[76:79]
  ds_read_b64_tr_b16 a[154:155], v121 offset:41472
  ds_read_b64_tr_b16 a[156:157], v122 offset:40960
  v_mfma_f32_16x16x32_bf16 v[28:31], a[160:163], a[48:51], v[28:31]
  ds_read_b64_tr_b16 a[158:159], v122 offset:41472
  s_add_u32 m0, s39, 39936
  v_mfma_f32_16x16x32_bf16 v[32:35], a[48:51], a[164:167], v[32:35]
  buffer_load_dword v106, s[4:7], s16 offen sc1 lds
  v_mfma_f32_16x16x32_bf16 v[80:83], a[52:55], a[164:167], v[80:83]
  buffer_load_dwordx4 a[24:27], v105, s[4:7], s16 offen sc1
  v_mfma_f32_16x16x32_bf16 v[84:87], a[52:55], a[168:171], v[84:87]
  ds_read_b64_tr_b16 a[160:161], v123 offset:40960
  ds_read_b64_tr_b16 a[162:163], v123 offset:41472
  v_mfma_f32_16x16x32_bf16 v[36:39], a[48:51], a[168:171], v[36:39]
  buffer_load_dwordx4 a[28:31], v105, s[4:7], s16 offen offset:1024 sc1
  v_mfma_f32_16x16x32_bf16 v[40:43], a[48:51], a[172:175], v[40:43]
  ds_read_b64_tr_b16 a[164:165], v120 offset:41984
  ds_read_b64_tr_b16 a[166:167], v120 offset:42496
  s_add_u32 s16, s16, 131072
  v_mfma_f32_16x16x32_bf16 v[88:91], a[52:55], a[172:175], v[88:91]
  ds_read_b64_tr_b16 a[168:169], v121 offset:41984
  s_bitset0_b32 s16, 20
  v_mfma_f32_16x16x32_bf16 v[92:95], a[52:55], a[176:179], v[92:95]
  ds_read_b64_tr_b16 a[170:171], v121 offset:42496
  ds_read_b64_tr_b16 a[172:173], v122 offset:41984
  v_mfma_f32_16x16x32_bf16 v[44:47], a[48:51], a[176:179], v[44:47]
  s_waitcnt vmcnt(23) lgkmcnt(10)
  s_barrier
  v_mfma_f32_16x16x32_bf16 v[96:99], a[180:183], a[188:191], v[96:99]
  ds_read_b64_tr_b16 a[174:175], v122 offset:42496
  s_add_u32 m0, s38, 53248
  v_mfma_f32_16x16x32_bf16 v[100:103], a[188:191], a[184:187], v[100:103]
  buffer_load_dwordx4 v107, s[8:11], s17 offen lds
  v_mfma_f32_16x16x32_bf16 v[0:3], a[132:135], a[56:59], v[0:3]
  ds_read_b64_tr_b16 a[176:177], v123 offset:41984
  ds_read_b64_tr_b16 a[178:179], v123 offset:42496
  buffer_load_dwordx4 v108, s[8:11], s17 offen offset:1024 lds
  v_mfma_f32_16x16x32_bf16 v[48:51], a[132:135], a[60:63], v[48:51]
  ds_read_b64_tr_b16 a[180:181], v118 offset:1024
  ds_read_b64_tr_b16 a[182:183], v118 offset:1536
  buffer_load_dwordx4 v109, s[8:11], s17 offen offset:2048 lds
  v_mfma_f32_16x16x32_bf16 v[52:55], a[136:139], a[60:63], v[52:55]
  ds_read_b128 a[188:191], v119 offset:12288
  ds_read_b64_tr_b16 a[184:185], v118 offset:2048
  ds_read_b64_tr_b16 a[186:187], v118 offset:2560
  v_mfma_f32_16x16x32_bf16 v[4:7], a[136:139], a[56:59], v[4:7]
  ds_read_b64_tr_b16 a[132:133], v114 offset:0
  s_add_u32 s17, s17, 196608
  v_mfma_f32_16x16x32_bf16 v[8:11], a[140:143], a[56:59], v[8:11]
  ds_read_b64_tr_b16 a[134:135], v114 offset:512
  s_cmp_eq_u32 s17, s10
  v_mfma_f32_16x16x32_bf16 v[56:59], a[140:143], a[60:63], v[56:59]
  ds_read_b64_tr_b16 a[136:137], v115 offset:0
  s_cselect_b32 s17, 0, s17
  v_mfma_f32_16x16x32_bf16 v[60:63], a[144:147], a[60:63], v[60:63]
  ds_read_b64_tr_b16 a[138:139], v115 offset:512
  s_add_u32 m0, s39, 53248
  v_mfma_f32_16x16x32_bf16 v[12:15], a[144:147], a[56:59], v[12:15]
  ds_read_b64_tr_b16 a[140:141], v116 offset:0
  ds_read_b64_tr_b16 a[142:143], v116 offset:512
  v_mfma_f32_16x16x32_bf16 v[16:19], a[148:151], a[56:59], v[16:19]
  buffer_load_dword v106, s[4:7], s16 offen sc1 lds
  v_mfma_f32_16x16x32_bf16 v[64:67], a[148:151], a[60:63], v[64:67]
  buffer_load_dwordx4 a[32:35], v105, s[4:7], s16 offen sc1
  s_waitcnt lgkmcnt(10)
  v_mfma_f32_16x16x32_bf16 v[68:71], a[152:155], a[60:63], v[68:71]
  ds_read_b64_tr_b16 a[144:145], v117 offset:0
  ds_read_b64_tr_b16 a[146:147], v117 offset:512
  buffer_load_dwordx4 a[36:39], v105, s[4:7], s16 offen offset:1024 sc1
  v_mfma_f32_16x16x32_bf16 v[20:23], a[152:155], a[56:59], v[20:23]
  ds_read_b64_tr_b16 a[148:149], v114 offset:1024
  s_add_u32 s16, s16, 131072
  v_mfma_f32_16x16x32_bf16 v[24:27], a[156:159], a[56:59], v[24:27]
  ds_read_b64_tr_b16 a[150:151], v114 offset:1536
  ds_read_b64_tr_b16 a[152:153], v115 offset:1024
  v_mfma_f32_16x16x32_bf16 v[72:75], a[156:159], a[60:63], v[72:75]
  ds_read_b64_tr_b16 a[154:155], v115 offset:1536
  s_bitset0_b32 s16, 20
  v_mfma_f32_16x16x32_bf16 v[76:79], a[160:163], a[60:63], v[76:79]
  ds_read_b64_tr_b16 a[156:157], v116 offset:1024
  s_add_u32 m0, s38, 66560
  v_mfma_f32_16x16x32_bf16 v[28:31], a[160:163], a[56:59], v[28:31]
  buffer_load_dwordx4 v107, s[8:11], s17 offen lds
  v_mfma_f32_16x16x32_bf16 v[32:35], a[56:59], a[164:167], v[32:35]
  ds_read_b64_tr_b16 a[158:159], v116 offset:1536
  buffer_load_dwordx4 v108, s[8:11], s17 offen offset:1024 lds
  v_mfma_f32_16x16x32_bf16 v[80:83], a[60:63], a[164:167], v[80:83]
  ds_read_b64_tr_b16 a[160:161], v117 offset:1024
  ds_read_b64_tr_b16 a[162:163], v117 offset:1536
  v_mfma_f32_16x16x32_bf16 v[84:87], a[60:63], a[168:171], v[84:87]
  buffer_load_dwordx4 v109, s[8:11], s17 offen offset:2048 lds
  v_mfma_f32_16x16x32_bf16 v[36:39], a[56:59], a[168:171], v[36:39]
  ds_read_b64_tr_b16 a[164:165], v114 offset:2048
  s_add_u32 s17, s17, 196608
  v_mfma_f32_16x16x32_bf16 v[40:43], a[56:59], a[172:175], v[40:43]
  ds_read_b64_tr_b16 a[166:167], v114 offset:2560
  s_cmp_eq_u32 s17, s10
  v_mfma_f32_16x16x32_bf16 v[88:91], a[60:63], a[172:175], v[88:91]
  ds_read_b64_tr_b16 a[168:169], v115 offset:2048
  s_cselect_b32 s17, 0, s17
  v_mfma_f32_16x16x32_bf16 v[92:95], a[60:63], a[176:179], v[92:95]
  ds_read_b64_tr_b16 a[170:171], v115 offset:2560
  ds_read_b64_tr_b16 a[172:173], v116 offset:2048
  v_mfma_f32_16x16x32_bf16 v[44:47], a[56:59], a[176:179], v[44:47]
  s_waitcnt vmcnt(21) lgkmcnt(10)
  s_barrier
  v_mfma_f32_16x16x32_bf16 v[96:99], a[180:183], a[188:191], v[96:99]
  ds_read_b64_tr_b16 a[174:175], v116 offset:2560
  s_add_u32 m0, s39, 66560
  v_mfma_f32_16x16x32_bf16 v[100:103], a[188:191], a[184:187], v[100:103]
  buffer_load_dword v106, s[4:7], s16 offen sc1 lds
  v_mfma_f32_16x16x32_bf16 v[0:3], a[132:135], a[0:3], v[0:3]
  ds_read_b64_tr_b16 a[176:177], v117 offset:2048
  ds_read_b64_tr_b16 a[178:179], v117 offset:2560
  buffer_load_dwordx4 a[40:43], v105, s[4:7], s16 offen sc1
  v_mfma_f32_16x16x32_bf16 v[48:51], a[132:135], a[4:7], v[48:51]
  ds_read_b64_tr_b16 a[180:181], v118 offset:14336
  ds_read_b64_tr_b16 a[182:183], v118 offset:14848
  buffer_load_dwordx4 a[44:47], v105, s[4:7], s16 offen offset:1024 sc1
  v_mfma_f32_16x16x32_bf16 v[52:55], a[136:139], a[4:7], v[52:55]
  ds_read_b128 a[188:191], v119 offset:25600
  ds_read_b64_tr_b16 a[184:185], v118 offset:15360
  ds_read_b64_tr_b16 a[186:187], v118 offset:15872
  v_mfma_f32_16x16x32_bf16 v[4:7], a[136:139], a[0:3], v[4:7]
  ds_read_b64_tr_b16 a[132:133], v114 offset:13312
  s_add_u32 s16, s16, 131072
  v_mfma_f32_16x16x32_bf16 v[8:11], a[140:143], a[0:3], v[8:11]
  ds_read_b64_tr_b16 a[134:135], v114 offset:13824
  s_bitset0_b32 s16, 20
  v_mfma_f32_16x16x32_bf16 v[56:59], a[140:143], a[4:7], v[56:59]
  ds_read_b64_tr_b16 a[136:137], v115 offset:13312
  s_add_u32 m0, s38, 79872
  v_mfma_f32_16x16x32_bf16 v[60:63], a[144:147], a[4:7], v[60:63]
  ds_read_b64_tr_b16 a[138:139], v115 offset:13824
  buffer_load_dwordx4 v107, s[8:11], s17 offen lds
  v_mfma_f32_16x16x32_bf16 v[12:15], a[144:147], a[0:3], v[12:15]
  ds_read_b64_tr_b16 a[140:141], v116 offset:13312
  ds_read_b64_tr_b16 a[142:143], v116 offset:13824
  v_mfma_f32_16x16x32_bf16 v[16:19], a[148:151], a[0:3], v[16:19]
  buffer_load_dwordx4 v108, s[8:11], s17 offen offset:1024 lds
  v_mfma_f32_16x16x32_bf16 v[64:67], a[148:151], a[4:7], v[64:67]
  buffer_load_dwordx4 v109, s[8:11], s17 offen offset:2048 lds
  s_waitcnt lgkmcnt(10)
  v_mfma_f32_16x16x32_bf16 v[68:71], a[152:155], a[4:7], v[68:71]
  ds_read_b64_tr_b16 a[144:145], v117 offset:13312
  ds_read_b64_tr_b16 a[146:147], v117 offset:13824
  s_add_u32 s17, s17, 196608
  v_mfma_f32_16x16x32_bf16 v[20:23], a[152:155], a[0:3], v[20:23]
  ds_read_b64_tr_b16 a[148:149], v114 offset:14336
  s_cmp_eq_u32 s17, s10
  v_mfma_f32_16x16x32_bf16 v[24:27], a[156:159], a[0:3], v[24:27]
  ds_read_b64_tr_b16 a[150:151], v114 offset:14848
  ds_read_b64_tr_b16 a[152:153], v115 offset:14336
  v_mfma_f32_16x16x32_bf16 v[72:75], a[156:159], a[4:7], v[72:75]
  ds_read_b64_tr_b16 a[154:155], v115 offset:14848
  s_cselect_b32 s17, 0, s17
  v_mfma_f32_16x16x32_bf16 v[76:79], a[160:163], a[4:7], v[76:79]
  ds_read_b64_tr_b16 a[156:157], v116 offset:14336
  s_add_u32 m0, s39, 79872
  v_mfma_f32_16x16x32_bf16 v[28:31], a[160:163], a[0:3], v[28:31]
  buffer_load_dword v106, s[4:7], s16 offen sc1 lds
  v_mfma_f32_16x16x32_bf16 v[32:35], a[0:3], a[164:167], v[32:35]
  ds_read_b64_tr_b16 a[158:159], v116 offset:14848
  buffer_load_dwordx4 a[48:51], v105, s[4:7], s16 offen sc1
  v_mfma_f32_16x16x32_bf16 v[80:83], a[4:7], a[164:167], v[80:83]
  ds_read_b64_tr_b16 a[160:161], v117 offset:14336
  ds_read_b64_tr_b16 a[162:163], v117 offset:14848
  v_mfma_f32_16x16x32_bf16 v[84:87], a[4:7], a[168:171], v[84:87]
  buffer_load_dwordx4 a[52:55], v105, s[4:7], s16 offen offset:1024 sc1
  v_mfma_f32_16x16x32_bf16 v[36:39], a[0:3], a[168:171], v[36:39]
  ds_read_b64_tr_b16 a[164:165], v114 offset:15360
  s_add_u32 s16, s16, 131072
  v_mfma_f32_16x16x32_bf16 v[40:43], a[0:3], a[172:175], v[40:43]
  ds_read_b64_tr_b16 a[166:167], v114 offset:15872
  s_bitset0_b32 s16, 20
  v_mfma_f32_16x16x32_bf16 v[88:91], a[4:7], a[172:175], v[88:91]
  buffer_store_dwordx4 v[244:247], v119, s[92:95], s35 offen offset:1024 sc1
  v_mfma_f32_16x16x32_bf16 v[92:95], a[4:7], a[176:179], v[92:95]
  ds_read_b64_tr_b16 a[168:169], v115 offset:15360
  ds_read_b64_tr_b16 a[170:171], v115 offset:15872
  v_mfma_f32_16x16x32_bf16 v[44:47], a[0:3], a[176:179], v[44:47]
  s_waitcnt vmcnt(25) lgkmcnt(10)
  s_barrier
  v_mfma_f32_16x16x32_bf16 v[96:99], a[180:183], a[188:191], v[96:99]
  ds_read_b64_tr_b16 a[172:173], v116 offset:15360
  ds_read_b64_tr_b16 a[174:175], v116 offset:15872
  s_add_u32 m0, s38, 93184
  v_mfma_f32_16x16x32_bf16 v[100:103], a[188:191], a[184:187], v[100:103]
  buffer_load_dwordx4 v107, s[8:11], s17 offen lds
  v_mfma_f32_16x16x32_bf16 v[0:3], a[132:135], a[8:11], v[0:3]
  ds_read_b64_tr_b16 a[176:177], v117 offset:15360
  ds_read_b64_tr_b16 a[178:179], v117 offset:15872
  buffer_load_dwordx4 v108, s[8:11], s17 offen offset:1024 lds
  v_mfma_f32_16x16x32_bf16 v[48:51], a[132:135], a[12:15], v[48:51]
  ds_read_b64_tr_b16 a[180:181], v118 offset:27648
  ds_read_b64_tr_b16 a[182:183], v118 offset:28160
  buffer_load_dwordx4 v109, s[8:11], s17 offen offset:2048 lds
  v_mfma_f32_16x16x32_bf16 v[52:55], a[136:139], a[12:15], v[52:55]
  ds_read_b128 a[188:191], v119 offset:38912
  ds_read_b64_tr_b16 a[184:185], v118 offset:28672
  ds_read_b64_tr_b16 a[186:187], v118 offset:29184
  s_add_u32 s17, s17, 196608
  v_mfma_f32_16x16x32_bf16 v[4:7], a[136:139], a[8:11], v[4:7]
  ds_read_b64_tr_b16 a[132:133], v114 offset:26624
  s_cmp_eq_u32 s17, s10
  v_mfma_f32_16x16x32_bf16 v[8:11], a[140:143], a[8:11], v[8:11]
  ds_read_b64_tr_b16 a[134:135], v114 offset:27136
  ds_read_b64_tr_b16 a[136:137], v115 offset:26624
  v_mfma_f32_16x16x32_bf16 v[56:59], a[140:143], a[12:15], v[56:59]
  ds_read_b64_tr_b16 a[138:139], v115 offset:27136
  s_cselect_b32 s17, 0, s17
  v_mfma_f32_16x16x32_bf16 v[60:63], a[144:147], a[12:15], v[60:63]
  s_add_u32 s8, s8, s10
  s_addc_u32 s9, s9, 0
  v_mfma_f32_16x16x32_bf16 v[12:15], a[144:147], a[8:11], v[12:15]
  ds_read_b64_tr_b16 a[140:141], v116 offset:26624
  s_add_u32 m0, s39, 93184
  v_mfma_f32_16x16x32_bf16 v[16:19], a[148:151], a[8:11], v[16:19]
  ds_read_b64_tr_b16 a[142:143], v116 offset:27136
  buffer_load_dword v106, s[4:7], s16 offen sc1 lds
  v_mfma_f32_16x16x32_bf16 v[64:67], a[148:151], a[12:15], v[64:67]
  buffer_load_dwordx4 a[56:59], v105, s[4:7], s16 offen sc1
  s_waitcnt lgkmcnt(10)
  v_mfma_f32_16x16x32_bf16 v[68:71], a[152:155], a[12:15], v[68:71]
  ds_read_b64_tr_b16 a[144:145], v117 offset:26624
  ds_read_b64_tr_b16 a[146:147], v117 offset:27136
  v_mfma_f32_16x16x32_bf16 v[20:23], a[152:155], a[8:11], v[20:23]
  buffer_load_dwordx4 a[60:63], v105, s[4:7], s16 offen offset:1024 sc1
  v_mfma_f32_16x16x32_bf16 v[24:27], a[156:159], a[8:11], v[24:27]
  ds_read_b64_tr_b16 a[148:149], v114 offset:27648
  ds_read_b64_tr_b16 a[150:151], v114 offset:28160
  s_add_u32 s16, s16, 131072
  v_mfma_f32_16x16x32_bf16 v[72:75], a[156:159], a[12:15], v[72:75]
  ds_read_b64_tr_b16 a[152:153], v115 offset:27648
  s_bitset0_b32 s16, 20
  v_mfma_f32_16x16x32_bf16 v[76:79], a[160:163], a[12:15], v[76:79]
  ds_read_b64_tr_b16 a[154:155], v115 offset:28160
  s_add_u32 s4, s4, s6
  s_addc_u32 s5, s5, 0
  v_mfma_f32_16x16x32_bf16 v[28:31], a[160:163], a[8:11], v[28:31]
  ds_read_b64_tr_b16 a[156:157], v116 offset:27648
  s_add_u32 m0, s39, 0
  v_mfma_f32_16x16x32_bf16 v[32:35], a[8:11], a[164:167], v[32:35]
  ds_read_b64_tr_b16 a[158:159], v116 offset:28160
  ds_read_b64_tr_b16 a[160:161], v117 offset:27648
  v_mfma_f32_16x16x32_bf16 v[80:83], a[12:15], a[164:167], v[80:83]
  buffer_load_dword v106, s[4:7], s16 offen sc1 lds
  v_mfma_f32_16x16x32_bf16 v[84:87], a[12:15], a[168:171], v[84:87]
  ds_read_b64_tr_b16 a[162:163], v117 offset:28160
  buffer_load_dwordx4 a[0:3], v105, s[4:7], s16 offen sc1
  v_mfma_f32_16x16x32_bf16 v[36:39], a[8:11], a[168:171], v[36:39]
  buffer_load_dwordx4 a[4:7], v105, s[4:7], s16 offen offset:1024 sc1
  v_mfma_f32_16x16x32_bf16 v[40:43], a[8:11], a[172:175], v[40:43]
  ds_read_b64_tr_b16 a[164:165], v114 offset:28672
  ds_read_b64_tr_b16 a[166:167], v114 offset:29184
  s_add_u32 s16, s16, 131072
  v_mfma_f32_16x16x32_bf16 v[88:91], a[12:15], a[172:175], v[88:91]
  ds_read_b64_tr_b16 a[168:169], v115 offset:28672
  s_bitset0_b32 s16, 20
  v_mfma_f32_16x16x32_bf16 v[92:95], a[12:15], a[176:179], v[92:95]
  ds_read_b64_tr_b16 a[170:171], v115 offset:29184
  ds_read_b64_tr_b16 a[172:173], v116 offset:28672
  v_mfma_f32_16x16x32_bf16 v[44:47], a[8:11], a[176:179], v[44:47]
  s_waitcnt vmcnt(28) lgkmcnt(10)
  s_barrier
  v_mfma_f32_16x16x32_bf16 v[96:99], a[180:183], a[188:191], v[96:99]
  ds_read_b64_tr_b16 a[174:175], v116 offset:29184
  s_add_u32 m0, s39, 13312
  s_nop 0
  buffer_load_dword v106, s[4:7], s16 offen sc1 lds
  v_mfma_f32_16x16x32_bf16 v[100:103], a[188:191], a[184:187], v[100:103]
  buffer_load_dwordx4 a[8:11], v105, s[4:7], s16 offen sc1
  v_mfma_f32_16x16x32_bf16 v[0:3], a[132:135], a[16:19], v[0:3]
  ds_read_b64_tr_b16 a[176:177], v117 offset:28672
  ds_read_b64_tr_b16 a[178:179], v117 offset:29184
  buffer_load_dwordx4 a[12:15], v105, s[4:7], s16 offen offset:1024 sc1
  v_mfma_f32_16x16x32_bf16 v[48:51], a[132:135], a[20:23], v[48:51]
  ds_read_b64_tr_b16 a[180:181], v118 offset:40960
  ds_read_b64_tr_b16 a[182:183], v118 offset:41472
  s_add_u32 s16, s16, 131072
  v_mfma_f32_16x16x32_bf16 v[52:55], a[136:139], a[20:23], v[52:55]
  ds_read_b128 a[188:191], v119 offset:52224
  ds_read_b64_tr_b16 a[184:185], v118 offset:41984
  ds_read_b64_tr_b16 a[186:187], v118 offset:42496
  s_bitset0_b32 s16, 20
  v_mfma_f32_16x16x32_bf16 v[4:7], a[136:139], a[16:19], v[4:7]
  s_add_u32 m0, s38, 0
  s_nop 0
  buffer_load_dwordx4 v107, s[8:11], s17 offen lds
  v_mfma_f32_16x16x32_bf16 v[8:11], a[140:143], a[16:19], v[8:11]
  ds_read_b64_tr_b16 a[132:133], v114 offset:39936
  ds_read_b64_tr_b16 a[134:135], v114 offset:40448
  buffer_load_dwordx4 v108, s[8:11], s17 offen offset:1024 lds
  v_mfma_f32_16x16x32_bf16 v[56:59], a[140:143], a[20:23], v[56:59]
  buffer_load_dwordx4 v109, s[8:11], s17 offen offset:2048 lds
  v_mfma_f32_16x16x32_bf16 v[60:63], a[144:147], a[20:23], v[60:63]
  ds_read_b64_tr_b16 a[136:137], v115 offset:39936
  ds_read_b64_tr_b16 a[138:139], v115 offset:40448
  s_add_u32 s17, s17, 196608
  v_mfma_f32_16x16x32_bf16 v[12:15], a[144:147], a[16:19], v[12:15]
  ds_read_b64_tr_b16 a[140:141], v116 offset:39936
  s_cmp_eq_u32 s17, s10
  v_mfma_f32_16x16x32_bf16 v[16:19], a[148:151], a[16:19], v[16:19]
  ds_read_b64_tr_b16 a[142:143], v116 offset:40448
  s_cselect_b32 s17, 0, s17
  s_mov_b32 m0, s51
  v_mfma_f32_16x16x32_bf16 v[64:67], a[148:151], a[20:23], v[64:67]
  ds_read_b64_tr_b16 a[144:145], v117 offset:39936
  s_add_u32 s51, s51, 1024
  s_waitcnt lgkmcnt(10)
  v_mfma_f32_16x16x32_bf16 v[68:71], a[152:155], a[20:23], v[68:71]
  ds_read_b64_tr_b16 a[146:147], v117 offset:40448
  buffer_load_dwordx4 v129, s[52:55], s50 offen nt lds
  v_mfma_f32_16x16x32_bf16 v[20:23], a[152:155], a[16:19], v[20:23]
  ds_read_b64_tr_b16 a[148:149], v114 offset:40960
  s_add_u32 s50, s50, 98304
  v_mfma_f32_16x16x32_bf16 v[24:27], a[156:159], a[16:19], v[24:27]
  ds_read_b64_tr_b16 a[150:151], v114 offset:41472
  s_mov_b32 m0, s51
  v_mfma_f32_16x16x32_bf16 v[72:75], a[156:159], a[20:23], v[72:75]
  s_add_u32 s51, s51, 1024
  buffer_load_dwordx4 v129, s[52:55], s50 offen nt lds
  v_mfma_f32_16x16x32_bf16 v[76:79], a[160:163], a[20:23], v[76:79]
  ds_read_b64_tr_b16 a[152:153], v115 offset:40960
  ds_read_b64_tr_b16 a[154:155], v115 offset:41472
  s_add_u32 s50, s50, 98304
  v_mfma_f32_16x16x32_bf16 v[28:31], a[160:163], a[16:19], v[28:31]
  ds_read_b64_tr_b16 a[156:157], v116 offset:40960
  s_mov_b32 m0, s51
  v_mfma_f32_16x16x32_bf16 v[32:35], a[16:19], a[164:167], v[32:35]
  ds_read_b64_tr_b16 a[158:159], v116 offset:41472
  s_add_u32 s51, s51, 1024
  v_mfma_f32_16x16x32_bf16 v[80:83], a[20:23], a[164:167], v[80:83]
  buffer_load_dwordx4 v129, s[52:55], s50 offen nt lds
  v_mfma_f32_16x16x32_bf16 v[84:87], a[20:23], a[168:171], v[84:87]
  ds_read_b64_tr_b16 a[160:161], v117 offset:40960
  ds_read_b64_tr_b16 a[162:163], v117 offset:41472
  s_add_u32 s50, s50, 98304
  s_mov_b32 m0, s51
  v_mfma_f32_16x16x32_bf16 v[36:39], a[16:19], a[168:171], v[36:39]
  ds_read_b64_tr_b16 a[164:165], v114 offset:41984
  s_add_u32 s51, s51, 1024
  v_mfma_f32_16x16x32_bf16 v[40:43], a[16:19], a[172:175], v[40:43]
  ds_read_b64_tr_b16 a[166:167], v114 offset:42496
  buffer_load_dwordx4 v129, s[52:55], s50 offen nt lds
  v_mfma_f32_16x16x32_bf16 v[88:91], a[20:23], a[172:175], v[88:91]
  ds_read_b64_tr_b16 a[168:169], v115 offset:41984
  s_add_u32 s50, s50, 98304
  v_mfma_f32_16x16x32_bf16 v[92:95], a[20:23], a[176:179], v[92:95]
  ds_read_b64_tr_b16 a[170:171], v115 offset:42496
  s_mov_b32 s40, s20
  s_mov_b32 s41, s21
  s_mov_b32 s42, 0x200000
  s_mov_b32 s43, 0x20000
  v_min_u32 v200, 9, v104
  v_lshlrev_b32 v201, 16, v200
  v_add_u32 v201, 524288, v201
  v_lshlrev_b32 v202, 7, v200
  s_lshl2_add_u32 s33, s2, s3
  s_mul_i32 s32, s33, 448
  s_add_u32 s32, s32, 1572096
  v_add_u32 v202, s32, v202
  v_cmp_le_u32 vcc, 6, v104
  s_lshl_b32 s33, s33, 6
  s_nop 0
  v_cndmask_b32 v201, v201, v202, vcc
  buffer_load_dword v131, v201, s[40:43], s33 offen
  v_mfma_f32_16x16x32_bf16 v[44:47], a[16:19], a[176:179], v[44:47]
  s_waitcnt vmcnt(33) lgkmcnt(10)
  s_barrier
  v_mfma_f32_16x16x32_bf16 v[96:99], a[180:183], a[188:191], v[96:99]
  ds_read_b64_tr_b16 a[172:173], v116 offset:41984
  ds_read_b64_tr_b16 a[174:175], v116 offset:42496
  v_mfma_f32_16x16x32_bf16 v[100:103], a[188:191], a[184:187], v[100:103]
  ds_read_b64_tr_b16 a[176:177], v117 offset:41984
  ds_read_b64_tr_b16 a[178:179], v117 offset:42496
  v_mfma_f32_16x16x32_bf16 v[0:3], a[132:135], a[24:27], v[0:3]
  ds_read_b64_tr_b16 a[180:181], v124 offset:1024
  ds_read_b64_tr_b16 a[182:183], v124 offset:1536
  v_mfma_f32_16x16x32_bf16 v[48:51], a[132:135], a[28:31], v[48:51]
  ds_read_b128 a[188:191], v125 offset:12288
  ds_read_b64_tr_b16 a[184:185], v124 offset:2048
  v_mfma_f32_16x16x32_bf16 v[52:55], a[136:139], a[28:31], v[52:55]
  ds_read_b64_tr_b16 a[186:187], v124 offset:2560
  ds_read_b64_tr_b16 a[132:133], v120 offset:0
  v_mfma_f32_16x16x32_bf16 v[4:7], a[136:139], a[24:27], v[4:7]
  ds_read_b64_tr_b16 a[134:135], v120 offset:512
  ds_read_b64_tr_b16 a[136:137], v121 offset:0
  v_mfma_f32_16x16x32_bf16 v[8:11], a[140:143], a[24:27], v[8:11]
  ds_read_b64_tr_b16 a[138:139], v121 offset:512
  v_mfma_f32_16x16x32_bf16 v[56:59], a[140:143], a[28:31], v[56:59]
  ds_read_b64_tr_b16 a[140:141], v122 offset:0
  ds_read_b64_tr_b16 a[142:143], v122 offset:512
  v_mfma_f32_16x16x32_bf16 v[60:63], a[144:147], a[28:31], v[60:63]
  v_mfma_f32_16x16x32_bf16 v[12:15], a[144:147], a[24:27], v[12:15]
  ds_read_b64_tr_b16 a[144:145], v123 offset:0
  ds_read_b64_tr_b16 a[146:147], v123 offset:512
  v_mfma_f32_16x16x32_bf16 v[16:19], a[148:151], a[24:27], v[16:19]
  v_mfma_f32_16x16x32_bf16 v[64:67], a[148:151], a[28:31], v[64:67]
  ds_read_b64_tr_b16 a[148:149], v120 offset:1024
  ds_read_b64_tr_b16 a[150:151], v120 offset:1536
  s_waitcnt lgkmcnt(10)
  v_mfma_f32_16x16x32_bf16 v[68:71], a[152:155], a[28:31], v[68:71]
  v_mfma_f32_16x16x32_bf16 v[20:23], a[152:155], a[24:27], v[20:23]
  ds_read_b64_tr_b16 a[152:153], v121 offset:1024
  ds_read_b64_tr_b16 a[154:155], v121 offset:1536
  v_mfma_f32_16x16x32_bf16 v[24:27], a[156:159], a[24:27], v[24:27]
  v_mfma_f32_16x16x32_bf16 v[72:75], a[156:159], a[28:31], v[72:75]
  ds_read_b64_tr_b16 a[156:157], v122 offset:1024
  ds_read_b64_tr_b16 a[158:159], v122 offset:1536
  v_mfma_f32_16x16x32_bf16 v[76:79], a[160:163], a[28:31], v[76:79]
  v_mfma_f32_16x16x32_bf16 v[28:31], a[160:163], a[24:27], v[28:31]
  ds_read_b64_tr_b16 a[160:161], v123 offset:1024
  ds_read_b64_tr_b16 a[162:163], v123 offset:1536
  v_mfma_f32_16x16x32_bf16 v[32:35], a[24:27], a[164:167], v[32:35]
  v_mfma_f32_16x16x32_bf16 v[80:83], a[28:31], a[164:167], v[80:83]
  ds_read_b64_tr_b16 a[164:165], v120 offset:2048
  ds_read_b64_tr_b16 a[166:167], v120 offset:2560
  v_mfma_f32_16x16x32_bf16 v[84:87], a[28:31], a[168:171], v[84:87]
  v_mfma_f32_16x16x32_bf16 v[36:39], a[24:27], a[168:171], v[36:39]
  ds_read_b64_tr_b16 a[168:169], v121 offset:2048
  ds_read_b64_tr_b16 a[170:171], v121 offset:2560
  v_mfma_f32_16x16x32_bf16 v[40:43], a[24:27], a[172:175], v[40:43]
  v_mfma_f32_16x16x32_bf16 v[88:91], a[28:31], a[172:175], v[88:91]
  ds_read_b64_tr_b16 a[172:173], v122 offset:2048
  ds_read_b64_tr_b16 a[174:175], v122 offset:2560
  v_mfma_f32_16x16x32_bf16 v[92:95], a[28:31], a[176:179], v[92:95]
  v_mfma_f32_16x16x32_bf16 v[44:47], a[24:27], a[176:179], v[44:47]
  s_waitcnt vmcnt(27) lgkmcnt(10)
  s_barrier
  v_mfma_f32_16x16x32_bf16 v[96:99], a[180:183], a[188:191], v[96:99]
  buffer_store_dwordx4 v[244:247], v119, s[92:95], s35 offen offset:2048 sc1
  v_mfma_f32_16x16x32_bf16 v[100:103], a[188:191], a[184:187], v[100:103]
  ds_read_b64_tr_b16 a[176:177], v123 offset:2048
  ds_read_b64_tr_b16 a[178:179], v123 offset:2560
  v_mfma_f32_16x16x32_bf16 v[0:3], a[132:135], a[32:35], v[0:3]
  ds_read_b64_tr_b16 a[180:181], v124 offset:14336
  ds_read_b64_tr_b16 a[182:183], v124 offset:14848
  v_mfma_f32_16x16x32_bf16 v[48:51], a[132:135], a[36:39], v[48:51]
  ds_read_b128 a[188:191], v125 offset:25600
  ds_read_b64_tr_b16 a[184:185], v124 offset:15360
  v_mfma_f32_16x16x32_bf16 v[52:55], a[136:139], a[36:39], v[52:55]
  ds_read_b64_tr_b16 a[186:187], v124 offset:15872
  ds_read_b64_tr_b16 a[132:133], v120 offset:13312
  v_mfma_f32_16x16x32_bf16 v[4:7], a[136:139], a[32:35], v[4:7]
  ds_read_b64_tr_b16 a[134:135], v120 offset:13824
  ds_read_b64_tr_b16 a[136:137], v121 offset:13312
  v_mfma_f32_16x16x32_bf16 v[8:11], a[140:143], a[32:35], v[8:11]
  ds_read_b64_tr_b16 a[138:139], v121 offset:13824
  v_mfma_f32_16x16x32_bf16 v[56:59], a[140:143], a[36:39], v[56:59]
  ds_read_b64_tr_b16 a[140:141], v122 offset:13312
  ds_read_b64_tr_b16 a[142:143], v122 offset:13824
  v_mfma_f32_16x16x32_bf16 v[60:63], a[144:147], a[36:39], v[60:63]
  v_mfma_f32_16x16x32_bf16 v[12:15], a[144:147], a[32:35], v[12:15]
  ds_read_b64_tr_b16 a[144:145], v123 offset:13312
  ds_read_b64_tr_b16 a[146:147], v123 offset:13824
  v_mfma_f32_16x16x32_bf16 v[16:19], a[148:151], a[32:35], v[16:19]
  v_mfma_f32_16x16x32_bf16 v[64:67], a[148:151], a[36:39], v[64:67]
  ds_read_b64_tr_b16 a[148:149], v120 offset:14336
  ds_read_b64_tr_b16 a[150:151], v120 offset:14848
  v_mfma_f32_16x16x32_bf16 v[68:71], a[152:155], a[36:39], v[68:71]
  v_mfma_f32_16x16x32_bf16 v[20:23], a[152:155], a[32:35], v[20:23]
  ds_read_b64_tr_b16 a[152:153], v121 offset:14336
  ds_read_b64_tr_b16 a[154:155], v121 offset:14848
  s_waitcnt lgkmcnt(10)
  v_mfma_f32_16x16x32_bf16 v[24:27], a[156:159], a[32:35], v[24:27]
  v_mfma_f32_16x16x32_bf16 v[72:75], a[156:159], a[36:39], v[72:75]
  ds_read_b64_tr_b16 a[156:157], v122 offset:14336
  ds_read_b64_tr_b16 a[158:159], v122 offset:14848
  v_mfma_f32_16x16x32_bf16 v[76:79], a[160:163], a[36:39], v[76:79]
  v_mfma_f32_16x16x32_bf16 v[28:31], a[160:163], a[32:35], v[28:31]
  ds_read_b64_tr_b16 a[160:161], v123 offset:14336
  ds_read_b64_tr_b16 a[162:163], v123 offset:14848
  v_mfma_f32_16x16x32_bf16 v[32:35], a[32:35], a[164:167], v[32:35]
  v_mfma_f32_16x16x32_bf16 v[80:83], a[36:39], a[164:167], v[80:83]
  ds_read_b64_tr_b16 a[164:165], v120 offset:15360
  ds_read_b64_tr_b16 a[166:167], v120 offset:15872
  v_mfma_f32_16x16x32_bf16 v[84:87], a[36:39], a[168:171], v[84:87]
  v_mfma_f32_16x16x32_bf16 v[36:39], a[32:35], a[168:171], v[36:39]
  ds_read_b64_tr_b16 a[168:169], v121 offset:15360
  ds_read_b64_tr_b16 a[170:171], v121 offset:15872
  v_mfma_f32_16x16x32_bf16 v[40:43], a[32:35], a[172:175], v[40:43]
  v_mfma_f32_16x16x32_bf16 v[88:91], a[36:39], a[172:175], v[88:91]
  ds_read_b64_tr_b16 a[172:173], v122 offset:15360
  ds_read_b64_tr_b16 a[174:175], v122 offset:15872
  v_mfma_f32_16x16x32_bf16 v[92:95], a[36:39], a[176:179], v[92:95]
  v_mfma_f32_16x16x32_bf16 v[44:47], a[32:35], a[176:179], v[44:47]
  s_waitcnt vmcnt(22) lgkmcnt(10)
  s_barrier
  v_mfma_f32_16x16x32_bf16 v[96:99], a[180:183], a[188:191], v[96:99]
  ds_read_b64_tr_b16 a[176:177], v123 offset:15360
  s_add_u32 m0, s38, 13312
  v_mfma_f32_16x16x32_bf16 v[100:103], a[188:191], a[184:187], v[100:103]
  buffer_load_dwordx4 v107, s[8:11], s17 offen lds
  v_mfma_f32_16x16x32_bf16 v[0:3], a[132:135], a[40:43], v[0:3]
  ds_read_b64_tr_b16 a[178:179], v123 offset:15872
  buffer_load_dwordx4 v108, s[8:11], s17 offen offset:1024 lds
  v_mfma_f32_16x16x32_bf16 v[48:51], a[132:135], a[44:47], v[48:51]
  ds_read_b64_tr_b16 a[180:181], v124 offset:27648
  ds_read_b64_tr_b16 a[182:183], v124 offset:28160
  buffer_load_dwordx4 v109, s[8:11], s17 offen offset:2048 lds
  v_mfma_f32_16x16x32_bf16 v[52:55], a[136:139], a[44:47], v[52:55]
  ds_read_b128 a[188:191], v125 offset:38912
  ds_read_b64_tr_b16 a[184:185], v124 offset:28672
  ds_read_b64_tr_b16 a[186:187], v124 offset:29184
  v_mfma_f32_16x16x32_bf16 v[4:7], a[136:139], a[40:43], v[4:7]
  ds_read_b64_tr_b16 a[132:133], v120 offset:26624
  s_add_u32 s17, s17, 196608
  v_mfma_f32_16x16x32_bf16 v[8:11], a[140:143], a[40:43], v[8:11]
  ds_read_b64_tr_b16 a[134:135], v120 offset:27136
  s_cmp_eq_u32 s17, s10
  v_mfma_f32_16x16x32_bf16 v[56:59], a[140:143], a[44:47], v[56:59]
  ds_read_b64_tr_b16 a[136:137], v121 offset:26624
  s_cselect_b32 s17, 0, s17
  v_mfma_f32_16x16x32_bf16 v[60:63], a[144:147], a[44:47], v[60:63]
  ds_read_b64_tr_b16 a[138:139], v121 offset:27136
  s_add_u32 m0, s38, 26624
  v_mfma_f32_16x16x32_bf16 v[12:15], a[144:147], a[40:43], v[12:15]
  ds_read_b64_tr_b16 a[140:141], v122 offset:26624
  ds_read_b64_tr_b16 a[142:143], v122 offset:27136
  v_mfma_f32_16x16x32_bf16 v[16:19], a[148:151], a[40:43], v[16:19]
  buffer_load_dwordx4 v107, s[8:11], s17 offen lds
  v_mfma_f32_16x16x32_bf16 v[64:67], a[148:151], a[44:47], v[64:67]
  buffer_load_dwordx4 v108, s[8:11], s17 offen offset:1024 lds
  v_mfma_f32_16x16x32_bf16 v[68:71], a[152:155], a[44:47], v[68:71]
  ds_read_b64_tr_b16 a[144:145], v123 offset:26624
  ds_read_b64_tr_b16 a[146:147], v123 offset:27136
  buffer_load_dwordx4 v109, s[8:11], s17 offen offset:2048 lds
  v_mfma_f32_16x16x32_bf16 v[20:23], a[152:155], a[40:43], v[20:23]
  ds_read_b64_tr_b16 a[148:149], v120 offset:27648
  s_add_u32 s17, s17, 196608
  s_waitcnt lgkmcnt(10)
  v_mfma_f32_16x16x32_bf16 v[24:27], a[156:159], a[40:43], v[24:27]
  ds_read_b64_tr_b16 a[150:151], v120 offset:28160
  ds_read_b64_tr_b16 a[152:153], v121 offset:27648
  v_mfma_f32_16x16x32_bf16 v[72:75], a[156:159], a[44:47], v[72:75]
  ds_read_b64_tr_b16 a[154:155], v121 offset:28160
  s_cmp_eq_u32 s17, s10
  v_mfma_f32_16x16x32_bf16 v[76:79], a[160:163], a[44:47], v[76:79]
  ds_read_b64_tr_b16 a[156:157], v122 offset:27648
  s_cselect_b32 s17, 0, s17
  v_mfma_f32_16x16x32_bf16 v[28:31], a[160:163], a[40:43], v[28:31]
  ds_read_b64_tr_b16 a[158:159], v122 offset:28160
  s_add_u32 m0, s39, 26624
  v_mfma_f32_16x16x32_bf16 v[32:35], a[40:43], a[164:167], v[32:35]
  buffer_load_dword v106, s[4:7], s16 offen sc1 lds
  v_mfma_f32_16x16x32_bf16 v[80:83], a[44:47], a[164:167], v[80:83]
  ds_read_b64_tr_b16 a[160:161], v123 offset:27648
  ds_read_b64_tr_b16 a[162:163], v123 offset:28160
  v_mfma_f32_16x16x32_bf16 v[84:87], a[44:47], a[168:171], v[84:87]
  buffer_load_dwordx4 a[16:19], v105, s[4:7], s16 offen sc1
  v_mfma_f32_16x16x32_bf16 v[36:39], a[40:43], a[168:171], v[36:39]
  buffer_load_dwordx4 a[20:23], v105, s[4:7], s16 offen offset:1024 sc1
  v_mfma_f32_16x16x32_bf16 v[40:43], a[40:43], a[172:175], v[40:43]
  ds_read_b64_tr_b16 a[164:165], v120 offset:28672
  ds_read_b64_tr_b16 a[166:167], v120 offset:29184
  s_add_u32 s16, s16, 131072
  v_mfma_f32_16x16x32_bf16 v[88:91], a[44:47], a[172:175], v[88:91]
  ds_read_b64_tr_b16 a[168:169], v121 offset:28672
  s_bitset0_b32 s16, 20
  v_mfma_f32_16x16x32_bf16 v[92:95], a[44:47], a[176:179], v[92:95]
  ds_read_b64_tr_b16 a[170:171], v121 offset:29184
  ds_read_b64_tr_b16 a[172:173], v122 offset:28672
  v_mfma_f32_16x16x32_bf16 v[44:47], a[40:43], a[176:179], v[44:47]
  s_waitcnt vmcnt(10) lgkmcnt(10)
  s_barrier
  v_mfma_f32_16x16x32_bf16 v[96:99], a[180:183], a[188:191], v[96:99]
  ds_read_b64_tr_b16 a[174:175], v122 offset:29184
  s_add_u32 m0, s38, 39936
  v_mfma_f32_16x16x32_bf16 v[100:103], a[188:191], a[184:187], v[100:103]
  ds_read_b64_tr_b16 a[64:65], v196 offset:0
  buffer_load_dwordx4 v107, s[8:11], s17 offen lds
  v_mfma_f32_16x16x32_bf16 v[0:3], a[132:135], a[48:51], v[0:3]
  ds_read_b64_tr_b16 a[176:177], v123 offset:28672
  ds_read_b64_tr_b16 a[178:179], v123 offset:29184
  buffer_load_dwordx4 v108, s[8:11], s17 offen offset:1024 lds
  v_mfma_f32_16x16x32_bf16 v[48:51], a[132:135], a[52:55], v[48:51]
  ds_read_b64_tr_b16 a[180:181], v124 offset:40960
  ds_read_b64_tr_b16 a[182:183], v124 offset:41472
  ds_read_b64_tr_b16 a[66:67], v196 offset:512
  buffer_load_dwordx4 v109, s[8:11], s17 offen offset:2048 lds
  v_mfma_f32_16x16x32_bf16 v[52:55], a[136:139], a[52:55], v[52:55]
  ds_read_b128 a[188:191], v125 offset:52224
  ds_read_b64_tr_b16 a[184:185], v124 offset:41984
  ds_read_b64_tr_b16 a[186:187], v124 offset:42496
  s_add_u32 s17, s17, 196608
  v_mfma_f32_16x16x32_bf16 v[4:7], a[136:139], a[48:51], v[4:7]
  ds_read_b128 a[68:71], v197 offset:0
  s_cmp_eq_u32 s17, s10
  v_mfma_f32_16x16x32_bf16 v[8:11], a[140:143], a[48:51], v[8:11]
  ds_read_b64_tr_b16 a[132:133], v120 offset:39936
  ds_read_b64_tr_b16 a[134:135], v120 offset:40448
  s_cselect_b32 s17, 0, s17
  v_mfma_f32_16x16x32_bf16 v[56:59], a[140:143], a[52:55], v[56:59]
  ds_read_b64_tr_b16 a[72:73], v196 offset:4096
  s_add_u32 m0, s39, 39936
  v_mfma_f32_16x16x32_bf16 v[60:63], a[144:147], a[52:55], v[60:63]
  ds_read_b64_tr_b16 a[136:137], v121 offset:39936
  ds_read_b64_tr_b16 a[138:139], v121 offset:40448
  buffer_load_dword v106, s[4:7], s16 offen sc1 lds
  v_mfma_f32_16x16x32_bf16 v[12:15], a[144:147], a[48:51], v[12:15]
  ds_read_b64_tr_b16 a[74:75], v196 offset:4608
  buffer_load_dwordx4 a[24:27], v105, s[4:7], s16 offen sc1
  v_mfma_f32_16x16x32_bf16 v[16:19], a[148:151], a[48:51], v[16:19]
  ds_read_b64_tr_b16 a[140:141], v122 offset:39936
  ds_read_b64_tr_b16 a[142:143], v122 offset:40448
  buffer_load_dwordx4 a[28:31], v105, s[4:7], s16 offen offset:1024 sc1
  v_mfma_f32_16x16x32_bf16 v[64:67], a[148:151], a[52:55], v[64:67]
  ds_read_b128 a[76:79], v197 offset:64
  s_add_u32 s16, s16, 131072
  s_waitcnt lgkmcnt(10)
  v_mfma_f32_16x16x32_bf16 v[68:71], a[152:155], a[52:55], v[68:71]
  ds_read_b64_tr_b16 a[144:145], v123 offset:39936
  ds_read_b64_tr_b16 a[146:147], v123 offset:40448
  s_bitset0_b32 s16, 20
  v_mfma_f32_16x16x32_bf16 v[20:23], a[152:155], a[48:51], v[20:23]
  ds_read_b64_tr_b16 a[80:81], v196 offset:8192
  s_add_u32 m0, s38, 53248
  v_mfma_f32_16x16x32_bf16 v[24:27], a[156:159], a[48:51], v[24:27]
  ds_read_b64_tr_b16 a[148:149], v120 offset:40960
  ds_read_b64_tr_b16 a[150:151], v120 offset:41472
  buffer_load_dwordx4 v107, s[8:11], s17 offen lds
  v_mfma_f32_16x16x32_bf16 v[72:75], a[156:159], a[52:55], v[72:75]
  ds_read_b64_tr_b16 a[82:83], v196 offset:8704
  buffer_load_dwordx4 v108, s[8:11], s17 offen offset:1024 lds
  v_mfma_f32_16x16x32_bf16 v[76:79], a[160:163], a[52:55], v[76:79]
  ds_read_b64_tr_b16 a[152:153], v121 offset:40960
  ds_read_b64_tr_b16 a[154:155], v121 offset:41472
  buffer_load_dwordx4 v109, s[8:11], s17 offen offset:2048 lds
  v_mfma_f32_16x16x32_bf16 v[28:31], a[160:163], a[48:51], v[28:31]
  ds_read_b128 a[84:87], v197 offset:128
  s_add_u32 s17, s17, 196608
  v_mfma_f32_16x16x32_bf16 v[32:35], a[48:51], a[164:167], v[32:35]
  ds_read_b64_tr_b16 a[156:157], v122 offset:40960
  ds_read_b64_tr_b16 a[158:159], v122 offset:41472
  s_cmp_eq_u32 s17, s10
  v_mfma_f32_16x16x32_bf16 v[80:83], a[52:55], a[164:167], v[80:83]
  ds_read_b64_tr_b16 a[88:89], v196 offset:12288
  s_cselect_b32 s17, 0, s17
  v_mfma_f32_16x16x32_bf16 v[84:87], a[52:55], a[168:171], v[84:87]
  ds_read_b64_tr_b16 a[160:161], v123 offset:40960
  ds_read_b64_tr_b16 a[162:163], v123 offset:41472
  s_mov_b32 s52, s24
  v_mfma_f32_16x16x32_bf16 v[36:39], a[48:51], a[168:171], v[36:39]
  ds_read_b64_tr_b16 a[90:91], v196 offset:12800
  s_mov_b32 s53, s25
  v_mfma_f32_16x16x32_bf16 v[40:43], a[48:51], a[172:175], v[40:43]
  ds_read_b64_tr_b16 a[164:165], v120 offset:41984
  ds_read_b64_tr_b16 a[166:167], v120 offset:42496
  s_mov_b32 s54, 0x200000
  v_mfma_f32_16x16x32_bf16 v[88:91], a[52:55], a[172:175], v[88:91]
  ds_read_b128 a[92:95], v197 offset:192
  s_mov_b32 s55, 0x20000
  v_mfma_f32_16x16x32_bf16 v[92:95], a[52:55], a[176:179], v[92:95]
  ds_read_b64_tr_b16 a[168:169], v121 offset:41984
  ds_read_b64_tr_b16 a[170:171], v121 offset:42496
  s_lshl_b32 s51, s3, 11
  v_mfma_f32_16x16x32_bf16 v[44:47], a[48:51], a[176:179], v[44:47]
  s_waitcnt vmcnt(24) lgkmcnt(10)
  s_barrier
  v_mfma_f32_16x16x32_bf16 v[96:99], a[180:183], a[188:191], v[96:99]
  ds_read_b64_tr_b16 a[172:173], v122 offset:41984
  ds_read_b64_tr_b16 a[174:175], v122 offset:42496
  s_add_u32 m0, s39, 53248
  v_mfma_f32_16x16x32_bf16 v[100:103], a[188:191], a[184:187], v[100:103]
  ds_read_b64_tr_b16 a[96:97], v196 offset:16384
  buffer_load_dword v106, s[4:7], s16 offen sc1 lds
  v_mfma_f32_16x16x32_bf16 v[0:3], a[132:135], a[56:59], v[0:3]
  ds_read_b64_tr_b16 a[176:177], v123 offset:41984
  ds_read_b64_tr_b16 a[178:179], v123 offset:42496
  v_mfma_f32_16x16x32_bf16 v[192:195], a[64:67], a[68:71], 0
  buffer_load_dwordx4 a[32:35], v105, s[4:7], s16 offen sc1
  v_mfma_f32_16x16x32_bf16 v[48:51], a[132:135], a[60:63], v[48:51]
  ds_read_b64_tr_b16 a[180:181], v118 offset:1024
  ds_read_b64_tr_b16 a[182:183], v118 offset:1536
  ds_read_b64_tr_b16 a[98:99], v196 offset:16896
  v_mfma_f32_16x16x32_bf16 v[52:55], a[136:139], a[60:63], v[52:55]
  ds_read_b128 a[188:191], v119 offset:12288
  ds_read_b64_tr_b16 a[184:185], v118 offset:2048
  ds_read_b64_tr_b16 a[186:187], v118 offset:2560
  buffer_load_dwordx4 a[36:39], v105, s[4:7], s16 offen offset:1024 sc1
  v_mfma_f32_16x16x32_bf16 v[4:7], a[136:139], a[56:59], v[4:7]
  ds_read_b128 a[100:103], v197 offset:256
  s_add_u32 s16, s16, 131072
  v_mfma_f32_16x16x32_bf16 v[8:11], a[140:143], a[56:59], v[8:11]
  ds_read_b64_tr_b16 a[132:133], v114 offset:0
  ds_read_b64_tr_b16 a[134:135], v114 offset:512
  s_bitset0_b32 s16, 20
  v_mfma_f32_16x16x32_bf16 v[56:59], a[140:143], a[60:63], v[56:59]
  ds_read_b64_tr_b16 a[104:105], v196 offset:20480
  s_add_u32 m0, s38, 66560
  v_mfma_f32_16x16x32_bf16 v[60:63], a[144:147], a[60:63], v[60:63]
  ds_read_b64_tr_b16 a[136:137], v115 offset:0
  ds_read_b64_tr_b16 a[138:139], v115 offset:512
  v_mfma_f32_16x16x32_bf16 v[192:195], a[72:75], a[76:79], v[192:195]
  v_mfma_f32_16x16x32_bf16 v[12:15], a[144:147], a[56:59], v[12:15]
  ds_read_b64_tr_b16 a[106:107], v196 offset:20992
  buffer_load_dwordx4 v107, s[8:11], s17 offen lds
  v_mfma_f32_16x16x32_bf16 v[16:19], a[148:151], a[56:59], v[16:19]
  ds_read_b64_tr_b16 a[140:141], v116 offset:0
  ds_read_b64_tr_b16 a[142:143], v116 offset:512
  buffer_load_dwordx4 v108, s[8:11], s17 offen offset:1024 lds
  v_mfma_f32_16x16x32_bf16 v[64:67], a[148:151], a[60:63], v[64:67]
  ds_read_b64_tr_b16 a[144:145], v117 offset:0
  ds_read_b128 a[108:111], v197 offset:320
  v_mfma_f32_16x16x32_bf16 v[68:71], a[152:155], a[60:63], v[68:71]
  ds_read_b64_tr_b16 a[146:147], v117 offset:512
  buffer_load_dwordx4 v109, s[8:11], s17 offen offset:2048 lds
  v_mfma_f32_16x16x32_bf16 v[20:23], a[152:155], a[56:59], v[20:23]
  ds_read_b64_tr_b16 a[112:113], v196 offset:24576
  s_add_u32 s17, s17, 196608
  s_waitcnt lgkmcnt(10)
  v_mfma_f32_16x16x32_bf16 v[24:27], a[156:159], a[56:59], v[24:27]
  ds_read_b64_tr_b16 a[148:149], v114 offset:1024
  ds_read_b64_tr_b16 a[150:151], v114 offset:1536
  v_mfma_f32_16x16x32_bf16 v[192:195], a[80:83], a[84:87], v[192:195]
  s_cmp_eq_u32 s17, s10
  v_mfma_f32_16x16x32_bf16 v[72:75], a[156:159], a[60:63], v[72:75]
  ds_read_b64_tr_b16 a[152:153], v115 offset:1024
  ds_read_b64_tr_b16 a[114:115], v196 offset:25088
  v_mfma_f32_16x16x32_bf16 v[76:79], a[160:163], a[60:63], v[76:79]
  ds_read_b64_tr_b16 a[154:155], v115 offset:1536
  s_cselect_b32 s17, 0, s17
  v_mfma_f32_16x16x32_bf16 v[28:31], a[160:163], a[56:59], v[28:31]
  ds_read_b128 a[116:119], v197 offset:384
  s_add_u32 m0, s39, 66560
  v_mfma_f32_16x16x32_bf16 v[32:35], a[56:59], a[164:167], v[32:35]
  ds_read_b64_tr_b16 a[156:157], v116 offset:1024
  ds_read_b64_tr_b16 a[158:159], v116 offset:1536
  buffer_load_dword v106, s[4:7], s16 offen sc1 lds
  v_mfma_f32_16x16x32_bf16 v[80:83], a[60:63], a[164:167], v[80:83]
  ds_read_b64_tr_b16 a[120:121], v196 offset:28672
  buffer_load_dwordx4 a[40:43], v105, s[4:7], s16 offen sc1
  v_mfma_f32_16x16x32_bf16 v[84:87], a[60:63], a[168:171], v[84:87]
  ds_read_b64_tr_b16 a[160:161], v117 offset:1024
  ds_read_b64_tr_b16 a[162:163], v117 offset:1536
  v_mfma_f32_16x16x32_bf16 v[192:195], a[88:91], a[92:95], v[192:195]
  v_mfma_f32_16x16x32_bf16 v[36:39], a[56:59], a[168:171], v[36:39]
  ds_read_b64_tr_b16 a[122:123], v196 offset:29184
  buffer_load_dwordx4 a[44:47], v105, s[4:7], s16 offen offset:1024 sc1
  v_mfma_f32_16x16x32_bf16 v[40:43], a[56:59], a[172:175], v[40:43]
  ds_read_b64_tr_b16 a[164:165], v114 offset:2048
  ds_read_b64_tr_b16 a[166:167], v114 offset:2560
  s_add_u32 s16, s16, 131072
  v_mfma_f32_16x16x32_bf16 v[88:91], a[60:63], a[172:175], v[88:91]
  ds_read_b64_tr_b16 a[168:169], v115 offset:2048
  ds_read_b128 a[124:127], v197 offset:448
  v_mfma_f32_16x16x32_bf16 v[92:95], a[60:63], a[176:179], v[92:95]
  ds_read_b64_tr_b16 a[170:171], v115 offset:2560
  s_bitset0_b32 s16, 20
  v_mfma_f32_16x16x32_bf16 v[44:47], a[56:59], a[176:179], v[44:47]
  s_waitcnt vmcnt(24) lgkmcnt(10)
  s_barrier
  v_mfma_f32_16x16x32_bf16 v[96:99], a[180:183], a[188:191], v[96:99]
  ds_read_b64_tr_b16 a[172:173], v116 offset:2048
  ds_read_b64_tr_b16 a[174:175], v116 offset:2560
  s_add_u32 m0, s38, 79872
  v_mfma_f32_16x16x32_bf16 v[100:103], a[188:191], a[184:187], v[100:103]
  buffer_load_dwordx4 v107, s[8:11], s17 offen lds
  v_mfma_f32_16x16x32_bf16 v[0:3], a[132:135], a[0:3], v[0:3]
  ds_read_b64_tr_b16 a[176:177], v117 offset:2048
  ds_read_b64_tr_b16 a[178:179], v117 offset:2560
  v_mfma_f32_16x16x32_bf16 v[192:195], a[96:99], a[100:103], v[192:195]
  buffer_load_dwordx4 v108, s[8:11], s17 offen offset:1024 lds
  v_mfma_f32_16x16x32_bf16 v[48:51], a[132:135], a[4:7], v[48:51]
  ds_read_b64_tr_b16 a[180:181], v118 offset:14336
  ds_read_b64_tr_b16 a[182:183], v118 offset:14848
  buffer_load_dwordx4 v109, s[8:11], s17 offen offset:2048 lds
  v_mfma_f32_16x16x32_bf16 v[52:55], a[136:139], a[4:7], v[52:55]
  ds_read_b128 a[188:191], v119 offset:25600
  ds_read_b64_tr_b16 a[184:185], v118 offset:15360
  ds_read_b64_tr_b16 a[186:187], v118 offset:15872
  s_add_u32 s17, s17, 196608
  v_mfma_f32_16x16x32_bf16 v[4:7], a[136:139], a[0:3], v[4:7]
  ds_read_b64_tr_b16 a[132:133], v114 offset:13312
  s_cmp_eq_u32 s17, s10
  v_mfma_f32_16x16x32_bf16 v[8:11], a[140:143], a[0:3], v[8:11]
  ds_read_b64_tr_b16 a[134:135], v114 offset:13824
  s_cselect_b32 s17, 0, s17
  v_mfma_f32_16x16x32_bf16 v[56:59], a[140:143], a[4:7], v[56:59]
  ds_read_b64_tr_b16 a[136:137], v115 offset:13312
  s_add_u32 m0, s39, 79872
  v_mfma_f32_16x16x32_bf16 v[60:63], a[144:147], a[4:7], v[60:63]
  ds_read_b64_tr_b16 a[138:139], v115 offset:13824
  v_mfma_f32_16x16x32_bf16 v[192:195], a[104:107], a[108:111], v[192:195]
  v_mfma_f32_16x16x32_bf16 v[12:15], a[144:147], a[0:3], v[12:15]
  buffer_load_dword v106, s[4:7], s16 offen sc1 lds
  v_mfma_f32_16x16x32_bf16 v[16:19], a[148:151], a[0:3], v[16:19]
  ds_read_b64_tr_b16 a[140:141], v116 offset:13312
  ds_read_b64_tr_b16 a[142:143], v116 offset:13824
  buffer_load_dwordx4 a[48:51], v105, s[4:7], s16 offen sc1
  v_mfma_f32_16x16x32_bf16 v[64:67], a[148:151], a[4:7], v[64:67]
  buffer_load_dwordx4 a[52:55], v105, s[4:7], s16 offen offset:1024 sc1
  v_mfma_f32_16x16x32_bf16 v[68:71], a[152:155], a[4:7], v[68:71]
  ds_read_b64_tr_b16 a[144:145], v117 offset:13312
  ds_read_b64_tr_b16 a[146:147], v117 offset:13824
  s_add_u32 s16, s16, 131072
  v_mfma_f32_16x16x32_bf16 v[20:23], a[152:155], a[0:3], v[20:23]
  ds_read_b64_tr_b16 a[148:149], v114 offset:14336
  s_bitset0_b32 s16, 20
  s_waitcnt lgkmcnt(10)
  v_mfma_f32_16x16x32_bf16 v[24:27], a[156:159], a[0:3], v[24:27]
  ds_read_b64_tr_b16 a[150:151], v114 offset:14848
  v_mfma_f32_16x16x32_bf16 v[192:195], a[112:115], a[116:119], v[192:195]
  s_add_u32 m0, s38, 93184
  v_mfma_f32_16x16x32_bf16 v[72:75], a[156:159], a[4:7], v[72:75]
  buffer_load_dwordx4 v107, s[8:11], s17 offen lds
  v_mfma_f32_16x16x32_bf16 v[76:79], a[160:163], a[4:7], v[76:79]
  ds_read_b64_tr_b16 a[152:153], v115 offset:14336
  ds_read_b64_tr_b16 a[154:155], v115 offset:14848
  v_mfma_f32_16x16x32_bf16 v[28:31], a[160:163], a[0:3], v[28:31]
  buffer_load_dwordx4 v108, s[8:11], s17 offen offset:1024 lds
  v_mfma_f32_16x16x32_bf16 v[32:35], a[0:3], a[164:167], v[32:35]
  ds_read_b64_tr_b16 a[156:157], v116 offset:14336
  ds_read_b64_tr_b16 a[158:159], v116 offset:14848
  buffer_load_dwordx4 v109, s[8:11], s17 offen offset:2048 lds
  v_mfma_f32_16x16x32_bf16 v[80:83], a[4:7], a[164:167], v[80:83]
  ds_read_b64_tr_b16 a[160:161], v117 offset:14336
  s_add_u32 s17, s17, 196608
  v_mfma_f32_16x16x32_bf16 v[84:87], a[4:7], a[168:171], v[84:87]
  ds_read_b64_tr_b16 a[162:163], v117 offset:14848
  v_mfma_f32_16x16x32_bf16 v[192:195], a[120:123], a[124:127], v[192:195]
  s_cmp_eq_u32 s17, s10
  v_mfma_f32_16x16x32_bf16 v[36:39], a[0:3], a[168:171], v[36:39]
  ds_read_b64_tr_b16 a[164:165], v114 offset:15360
  s_cselect_b32 s17, 0, s17
  v_mfma_f32_16x16x32_bf16 v[40:43], a[0:3], a[172:175], v[40:43]
  ds_read_b64_tr_b16 a[166:167], v114 offset:15872
  s_add_u32 s8, s8, s10
  s_addc_u32 s9, s9, 0
  v_mfma_f32_16x16x32_bf16 v[88:91], a[4:7], a[172:175], v[88:91]
  buffer_store_dwordx4 v[244:247], v119, s[92:95], s35 offen offset:3072 sc1
  v_mfma_f32_16x16x32_bf16 v[92:95], a[4:7], a[176:179], v[92:95]
  ds_read_b64_tr_b16 a[168:169], v115 offset:15360
  ds_read_b64_tr_b16 a[170:171], v115 offset:15872
  v_mfma_f32_16x16x32_bf16 v[44:47], a[0:3], a[176:179], v[44:47]
  s_waitcnt vmcnt(28) lgkmcnt(10)
  s_barrier
  v_mfma_f32_16x16x32_bf16 v[96:99], a[180:183], a[188:191], v[96:99]
  ds_read_b64_tr_b16 a[172:173], v116 offset:15360
  ds_read_b64_tr_b16 a[174:175], v116 offset:15872
  s_add_u32 m0, s39, 93184
  v_mfma_f32_16x16x32_bf16 v[100:103], a[188:191], a[184:187], v[100:103]
  buffer_load_dword v106, s[4:7], s16 offen sc1 lds
  v_mfma_f32_16x16x32_bf16 v[0:3], a[132:135], a[8:11], v[0:3]
  ds_read_b64_tr_b16 a[176:177], v117 offset:15360
  ds_read_b64_tr_b16 a[178:179], v117 offset:15872
  v_mfma_f32_16x16x32_bf16 v[48:51], a[132:135], a[12:15], v[48:51]
  ds_read_b64_tr_b16 a[180:181], v118 offset:27648
  ds_read_b64_tr_b16 a[182:183], v118 offset:28160
  buffer_load_dwordx4 a[56:59], v105, s[4:7], s16 offen sc1
  v_mfma_f32_16x16x32_bf16 v[52:55], a[136:139], a[12:15], v[52:55]
  ds_read_b128 a[188:191], v119 offset:38912
  ds_read_b64_tr_b16 a[184:185], v118 offset:28672
  ds_read_b64_tr_b16 a[186:187], v118 offset:29184
  v_mfma_f32_16x16x32_bf16 v[4:7], a[136:139], a[8:11], v[4:7]
  s_bfe_u32 s40, s19, 0x80000
  s_bfe_u32 s41, s19, 0x80008
  s_bfe_u32 s42, s19, 0x80010
  s_bfe_u32 s43, s19, 0x80018
  v_and_or_b32 v192, v192, v198, s40
  v_and_or_b32 v193, v193, v198, s41
  v_and_or_b32 v194, v194, v198, s42
  v_and_or_b32 v195, v195, v198, s43
  buffer_store_dwordx4 v[192:195], v255, s[12:15], s96 offen sc1
  v_mfma_f32_16x16x32_bf16 v[8:11], a[140:143], a[8:11], v[8:11]
  ds_read_b64_tr_b16 a[132:133], v114 offset:26624
  ds_read_b64_tr_b16 a[134:135], v114 offset:27136
  buffer_load_dwordx4 a[60:63], v105, s[4:7], s16 offen offset:1024 sc1
  v_mfma_f32_16x16x32_bf16 v[56:59], a[140:143], a[12:15], v[56:59]
  ds_read_b64_tr_b16 a[136:137], v115 offset:26624
  s_add_u32 s16, s16, 131072
  v_mfma_f32_16x16x32_bf16 v[60:63], a[144:147], a[12:15], v[60:63]
  ds_read_b64_tr_b16 a[138:139], v115 offset:27136
  ds_read_b64_tr_b16 a[140:141], v116 offset:26624
  v_mfma_f32_16x16x32_bf16 v[12:15], a[144:147], a[8:11], v[12:15]
  ds_read_b64_tr_b16 a[142:143], v116 offset:27136
  s_bitset0_b32 s16, 20
  v_mfma_f32_16x16x32_bf16 v[16:19], a[148:151], a[8:11], v[16:19]
  ds_read_b64_tr_b16 a[144:145], v117 offset:26624
  ds_read_b64_tr_b16 a[146:147], v117 offset:27136
  v_mfma_f32_16x16x32_bf16 v[64:67], a[148:151], a[12:15], v[64:67]
  s_add_u32 s4, s4, s6
  s_addc_u32 s5, s5, 0
  s_waitcnt lgkmcnt(10)
  v_mfma_f32_16x16x32_bf16 v[68:71], a[152:155], a[12:15], v[68:71]
  ds_read_b64_tr_b16 a[148:149], v114 offset:27648
  ds_read_b64_tr_b16 a[150:151], v114 offset:28160
  v_mfma_f32_16x16x32_bf16 v[20:23], a[152:155], a[8:11], v[20:23]
  ds_read_b64_tr_b16 a[152:153], v115 offset:27648
  s_add_u32 m0, s39, 0
  v_mfma_f32_16x16x32_bf16 v[24:27], a[156:159], a[8:11], v[24:27]
  ds_read_b64_tr_b16 a[154:155], v115 offset:28160
  v_mfma_f32_16x16x32_bf16 v[72:75], a[156:159], a[12:15], v[72:75]
  buffer_load_dword v106, s[4:7], s16 offen sc1 lds
  v_mfma_f32_16x16x32_bf16 v[76:79], a[160:163], a[12:15], v[76:79]
  ds_read_b64_tr_b16 a[156:157], v116 offset:27648
  ds_read_b64_tr_b16 a[158:159], v116 offset:28160
  v_mfma_f32_16x16x32_bf16 v[28:31], a[160:163], a[8:11], v[28:31]
  buffer_load_dwordx4 a[0:3], v105, s[4:7], s16 offen sc1
  v_mfma_f32_16x16x32_bf16 v[32:35], a[8:11], a[164:167], v[32:35]
  ds_read_b64_tr_b16 a[160:161], v117 offset:27648
  ds_read_b64_tr_b16 a[162:163], v117 offset:28160
  v_mfma_f32_16x16x32_bf16 v[80:83], a[12:15], a[164:167], v[80:83]
  buffer_load_dwordx4 a[4:7], v105, s[4:7], s16 offen offset:1024 sc1
  v_mfma_f32_16x16x32_bf16 v[84:87], a[12:15], a[168:171], v[84:87]
  ds_read_b64_tr_b16 a[164:165], v114 offset:28672
  ds_read_b64_tr_b16 a[166:167], v114 offset:29184
  v_mfma_f32_16x16x32_bf16 v[36:39], a[8:11], a[168:171], v[36:39]
  ds_read_b64_tr_b16 a[168:169], v115 offset:28672
  s_add_u32 s16, s16, 131072
  v_mfma_f32_16x16x32_bf16 v[40:43], a[8:11], a[172:175], v[40:43]
  ds_read_b64_tr_b16 a[170:171], v115 offset:29184
  v_mfma_f32_16x16x32_bf16 v[88:91], a[12:15], a[172:175], v[88:91]
  ds_read_b64_tr_b16 a[172:173], v116 offset:28672
  s_bitset0_b32 s16, 20
  v_mfma_f32_16x16x32_bf16 v[92:95], a[12:15], a[176:179], v[92:95]
  ds_read_b64_tr_b16 a[174:175], v116 offset:29184
  v_mfma_f32_16x16x32_bf16 v[44:47], a[8:11], a[176:179], v[44:47]
  s_waitcnt vmcnt(29) lgkmcnt(10)
  s_barrier
  v_mfma_f32_16x16x32_bf16 v[96:99], a[180:183], a[188:191], v[96:99]
  ds_read_b64_tr_b16 a[176:177], v117 offset:28672
  s_add_u32 m0, s39, 13312
  v_mfma_f32_16x16x32_bf16 v[100:103], a[188:191], a[184:187], v[100:103]
  buffer_load_dword v106, s[4:7], s16 offen sc1 lds
  v_mfma_f32_16x16x32_bf16 v[0:3], a[132:135], a[16:19], v[0:3]
  ds_read_b64_tr_b16 a[178:179], v117 offset:29184
  buffer_load_dwordx4 a[8:11], v105, s[4:7], s16 offen sc1
  v_mfma_f32_16x16x32_bf16 v[48:51], a[132:135], a[20:23], v[48:51]
  ds_read_b64_tr_b16 a[180:181], v118 offset:40960
  ds_read_b64_tr_b16 a[182:183], v118 offset:41472
  buffer_load_dwordx4 a[12:15], v105, s[4:7], s16 offen offset:1024 sc1
  v_mfma_f32_16x16x32_bf16 v[52:55], a[136:139], a[20:23], v[52:55]
  ds_read_b128 a[188:191], v119 offset:52224
  ds_read_b64_tr_b16 a[184:185], v118 offset:41984
  ds_read_b64_tr_b16 a[186:187], v118 offset:42496
  v_mfma_f32_16x16x32_bf16 v[4:7], a[136:139], a[16:19], v[4:7]
  ds_read_b64_tr_b16 a[132:133], v114 offset:39936
  s_add_u32 s16, s16, 131072
  v_mfma_f32_16x16x32_bf16 v[8:11], a[140:143], a[16:19], v[8:11]
  ds_read_b64_tr_b16 a[134:135], v114 offset:40448
  s_bitset0_b32 s16, 20
  v_mfma_f32_16x16x32_bf16 v[56:59], a[140:143], a[20:23], v[56:59]
  ds_read_b64_tr_b16 a[136:137], v115 offset:39936
  s_add_u32 m0, s38, 0
  v_mfma_f32_16x16x32_bf16 v[60:63], a[144:147], a[20:23], v[60:63]
  ds_read_b64_tr_b16 a[138:139], v115 offset:40448
  ds_read_b64_tr_b16 a[140:141], v116 offset:39936
  v_mfma_f32_16x16x32_bf16 v[12:15], a[144:147], a[16:19], v[12:15]
  buffer_load_dwordx4 v107, s[8:11], s17 offen lds
  v_mfma_f32_16x16x32_bf16 v[16:19], a[148:151], a[16:19], v[16:19]
  ds_read_b64_tr_b16 a[142:143], v116 offset:40448
  buffer_load_dwordx4 v108, s[8:11], s17 offen offset:1024 lds
  v_mfma_f32_16x16x32_bf16 v[64:67], a[148:151], a[20:23], v[64:67]
  buffer_load_dwordx4 v109, s[8:11], s17 offen offset:2048 lds
  v_mfma_f32_16x16x32_bf16 v[68:71], a[152:155], a[20:23], v[68:71]
  ds_read_b64_tr_b16 a[144:145], v117 offset:39936
  ds_read_b64_tr_b16 a[146:147], v117 offset:40448
  v_mfma_f32_16x16x32_bf16 v[20:23], a[152:155], a[16:19], v[20:23]
  ds_read_b64_tr_b16 a[148:149], v114 offset:40960
  s_add_u32 s17, s17, 196608
  s_waitcnt lgkmcnt(10)
  v_mfma_f32_16x16x32_bf16 v[24:27], a[156:159], a[16:19], v[24:27]
  ds_read_b64_tr_b16 a[150:151], v114 offset:41472
  s_cmp_eq_u32 s17, s10
  v_mfma_f32_16x16x32_bf16 v[72:75], a[156:159], a[20:23], v[72:75]
  ds_read_b64_tr_b16 a[152:153], v115 offset:40960
  s_cselect_b32 s17, 0, s17
  v_mfma_f32_16x16x32_bf16 v[76:79], a[160:163], a[20:23], v[76:79]
  ds_read_b64_tr_b16 a[154:155], v115 offset:41472
  ds_read_b64_tr_b16 a[156:157], v116 offset:40960
  v_mfma_f32_16x16x32_bf16 v[28:31], a[160:163], a[16:19], v[28:31]
  buffer_load_dword v131, v130, s[56:59], s97 offen
  v_mfma_f32_16x16x32_bf16 v[32:35], a[16:19], a[164:167], v[32:35]
  ds_read_b64_tr_b16 a[158:159], v116 offset:41472
  s_add_u32 m0, s51, 106496
  v_mfma_f32_16x16x32_bf16 v[80:83], a[20:23], a[164:167], v[80:83]
  ds_read_b64_tr_b16 a[160:161], v117 offset:40960
  s_add_u32 s50, s98, 1703936
  v_mfma_f32_16x16x32_bf16 v[84:87], a[20:23], a[168:171], v[84:87]
  ds_read_b64_tr_b16 a[162:163], v117 offset:41472
  ds_read_b64_tr_b16 a[164:165], v114 offset:41984
  v_mfma_f32_16x16x32_bf16 v[36:39], a[16:19], a[168:171], v[36:39]
  ds_read_b64_tr_b16 a[166:167], v114 offset:42496
  s_bitset0_b32 s50, 21
  v_mfma_f32_16x16x32_bf16 v[40:43], a[16:19], a[172:175], v[40:43]
  buffer_load_dwordx4 v248, s[52:55], s50 offen lds
  v_mfma_f32_16x16x32_bf16 v[88:91], a[20:23], a[172:175], v[88:91]
  buffer_load_dwordx4 v249, s[52:55], s50 offen offset:1024 lds
  v_mfma_f32_16x16x32_bf16 v[92:95], a[20:23], a[176:179], v[92:95]
  ds_read_b64_tr_b16 a[168:169], v115 offset:41984
  ds_read_b64_tr_b16 a[170:171], v115 offset:42496
  v_mfma_f32_16x16x32_bf16 v[44:47], a[16:19], a[176:179], v[44:47]
  s_waitcnt vmcnt(32) lgkmcnt(10)
  s_barrier
  v_mfma_f32_16x16x32_bf16 v[96:99], a[180:183], a[188:191], v[96:99]
  ds_read_b64_tr_b16 a[172:173], v116 offset:41984
  ds_read_b64_tr_b16 a[174:175], v116 offset:42496
  v_mfma_f32_16x16x32_bf16 v[100:103], a[188:191], a[184:187], v[100:103]
  ds_read_b64_tr_b16 a[176:177], v117 offset:41984
  ds_read_b64_tr_b16 a[178:179], v117 offset:42496
  v_mfma_f32_16x16x32_bf16 v[0:3], a[132:135], a[24:27], v[0:3]
  ds_read_b64_tr_b16 a[180:181], v124 offset:1024
  ds_read_b64_tr_b16 a[182:183], v124 offset:1536
  v_mfma_f32_16x16x32_bf16 v[48:51], a[132:135], a[28:31], v[48:51]
  ds_read_b128 a[188:191], v125 offset:12288
  ds_read_b64_tr_b16 a[184:185], v124 offset:2048
  v_mfma_f32_16x16x32_bf16 v[52:55], a[136:139], a[28:31], v[52:55]
  ds_read_b64_tr_b16 a[186:187], v124 offset:2560
  ds_read_b64_tr_b16 a[132:133], v120 offset:0
  v_mfma_f32_16x16x32_bf16 v[4:7], a[136:139], a[24:27], v[4:7]
  ds_read_b64_tr_b16 a[134:135], v120 offset:512
  ds_read_b64_tr_b16 a[136:137], v121 offset:0
  v_mfma_f32_16x16x32_bf16 v[8:11], a[140:143], a[24:27], v[8:11]
  ds_read_b64_tr_b16 a[138:139], v121 offset:512
  v_mfma_f32_16x16x32_bf16 v[56:59], a[140:143], a[28:31], v[56:59]
  ds_read_b64_tr_b16 a[140:141], v122 offset:0
  ds_read_b64_tr_b16 a[142:143], v122 offset:512
  v_mfma_f32_16x16x32_bf16 v[60:63], a[144:147], a[28:31], v[60:63]
  v_mfma_f32_16x16x32_bf16 v[12:15], a[144:147], a[24:27], v[12:15]
  ds_read_b64_tr_b16 a[144:145], v123 offset:0
  ds_read_b64_tr_b16 a[146:147], v123 offset:512
  v_mfma_f32_16x16x32_bf16 v[16:19], a[148:151], a[24:27], v[16:19]
  v_mfma_f32_16x16x32_bf16 v[64:67], a[148:151], a[28:31], v[64:67]
  ds_read_b64_tr_b16 a[148:149], v120 offset:1024
  ds_read_b64_tr_b16 a[150:151], v120 offset:1536
  s_waitcnt lgkmcnt(10)
  v_mfma_f32_16x16x32_bf16 v[68:71], a[152:155], a[28:31], v[68:71]
  v_mfma_f32_16x16x32_bf16 v[20:23], a[152:155], a[24:27], v[20:23]
  ds_read_b64_tr_b16 a[152:153], v121 offset:1024
  ds_read_b64_tr_b16 a[154:155], v121 offset:1536
  v_mfma_f32_16x16x32_bf16 v[24:27], a[156:159], a[24:27], v[24:27]
  v_mfma_f32_16x16x32_bf16 v[72:75], a[156:159], a[28:31], v[72:75]
  ds_read_b64_tr_b16 a[156:157], v122 offset:1024
  ds_read_b64_tr_b16 a[158:159], v122 offset:1536
  v_mfma_f32_16x16x32_bf16 v[76:79], a[160:163], a[28:31], v[76:79]
  v_mfma_f32_16x16x32_bf16 v[28:31], a[160:163], a[24:27], v[28:31]
  ds_read_b64_tr_b16 a[160:161], v123 offset:1024
  ds_read_b64_tr_b16 a[162:163], v123 offset:1536
  v_mfma_f32_16x16x32_bf16 v[32:35], a[24:27], a[164:167], v[32:35]
  v_mfma_f32_16x16x32_bf16 v[80:83], a[28:31], a[164:167], v[80:83]
  ds_read_b64_tr_b16 a[164:165], v120 offset:2048
  ds_read_b64_tr_b16 a[166:167], v120 offset:2560
  v_mfma_f32_16x16x32_bf16 v[84:87], a[28:31], a[168:171], v[84:87]
  v_mfma_f32_16x16x32_bf16 v[36:39], a[24:27], a[168:171], v[36:39]
  ds_read_b64_tr_b16 a[168:169], v121 offset:2048
  ds_read_b64_tr_b16 a[170:171], v121 offset:2560
  v_mfma_f32_16x16x32_bf16 v[40:43], a[24:27], a[172:175], v[40:43]
  v_mfma_f32_16x16x32_bf16 v[88:91], a[28:31], a[172:175], v[88:91]
  ds_read_b64_tr_b16 a[172:173], v122 offset:2048
  ds_read_b64_tr_b16 a[174:175], v122 offset:2560
  v_mfma_f32_16x16x32_bf16 v[92:95], a[28:31], a[176:179], v[92:95]
  v_mfma_f32_16x16x32_bf16 v[44:47], a[24:27], a[176:179], v[44:47]
  s_waitcnt vmcnt(26) lgkmcnt(10)
  s_barrier
  v_mfma_f32_16x16x32_bf16 v[96:99], a[180:183], a[188:191], v[96:99]
  ds_read_b64_tr_b16 a[176:177], v123 offset:2048
  ds_read_b64_tr_b16 a[178:179], v123 offset:2560
  v_mfma_f32_16x16x32_bf16 v[100:103], a[188:191], a[184:187], v[100:103]
  ds_read_b64_tr_b16 a[180:181], v124 offset:14336
  ds_read_b64_tr_b16 a[182:183], v124 offset:14848
  v_mfma_f32_16x16x32_bf16 v[0:3], a[132:135], a[32:35], v[0:3]
  ds_read_b128 a[188:191], v125 offset:25600
  ds_read_b64_tr_b16 a[184:185], v124 offset:15360
  v_mfma_f32_16x16x32_bf16 v[48:51], a[132:135], a[36:39], v[48:51]
  ds_read_b64_tr_b16 a[186:187], v124 offset:15872
  ds_read_b64_tr_b16 a[132:133], v120 offset:13312
  v_mfma_f32_16x16x32_bf16 v[52:55], a[136:139], a[36:39], v[52:55]
  ds_read_b64_tr_b16 a[134:135], v120 offset:13824
  v_mfma_f32_16x16x32_bf16 v[4:7], a[136:139], a[32:35], v[4:7]
  ds_read_b64_tr_b16 a[136:137], v121 offset:13312
  ds_read_b64_tr_b16 a[138:139], v121 offset:13824
  v_mfma_f32_16x16x32_bf16 v[8:11], a[140:143], a[32:35], v[8:11]
  v_mfma_f32_16x16x32_bf16 v[56:59], a[140:143], a[36:39], v[56:59]
  ds_read_b64_tr_b16 a[140:141], v122 offset:13312
  ds_read_b64_tr_b16 a[142:143], v122 offset:13824
  v_mfma_f32_16x16x32_bf16 v[60:63], a[144:147], a[36:39], v[60:63]
  v_mfma_f32_16x16x32_bf16 v[12:15], a[144:147], a[32:35], v[12:15]
  ds_read_b64_tr_b16 a[144:145], v123 offset:13312
  ds_read_b64_tr_b16 a[146:147], v123 offset:13824
  v_mfma_f32_16x16x32_bf16 v[16:19], a[148:151], a[32:35], v[16:19]
  v_mfma_f32_16x16x32_bf16 v[64:67], a[148:151], a[36:39], v[64:67]
  ds_read_b64_tr_b16 a[148:149], v120 offset:14336
  ds_read_b64_tr_b16 a[150:151], v120 offset:14848
  v_mfma_f32_16x16x32_bf16 v[68:71], a[152:155], a[36:39], v[68:71]
  v_mfma_f32_16x16x32_bf16 v[20:23], a[152:155], a[32:35], v[20:23]
  ds_read_b64_tr_b16 a[152:153], v121 offset:14336
  ds_read_b64_tr_b16 a[154:155], v121 offset:14848
  s_waitcnt lgkmcnt(10)
  v_mfma_f32_16x16x32_bf16 v[24:27], a[156:159], a[32:35], v[24:27]
  v_mfma_f32_16x16x32_bf16 v[72:75], a[156:159], a[36:39], v[72:75]
  ds_read_b64_tr_b16 a[156:157], v122 offset:14336
  ds_read_b64_tr_b16 a[158:159], v122 offset:14848
  v_mfma_f32_16x16x32_bf16 v[76:79], a[160:163], a[36:39], v[76:79]
  v_mfma_f32_16x16x32_bf16 v[28:31], a[160:163], a[32:35], v[28:31]
  ds_read_b64_tr_b16 a[160:161], v123 offset:14336
  ds_read_b64_tr_b16 a[162:163], v123 offset:14848
  v_mfma_f32_16x16x32_bf16 v[32:35], a[32:35], a[164:167], v[32:35]
  v_mfma_f32_16x16x32_bf16 v[80:83], a[36:39], a[164:167], v[80:83]
  ds_read_b64_tr_b16 a[164:165], v120 offset:15360
  ds_read_b64_tr_b16 a[166:167], v120 offset:15872
  v_mfma_f32_16x16x32_bf16 v[84:87], a[36:39], a[168:171], v[84:87]
  v_mfma_f32_16x16x32_bf16 v[36:39], a[32:35], a[168:171], v[36:39]
  ds_read_b64_tr_b16 a[168:169], v121 offset:15360
  ds_read_b64_tr_b16 a[170:171], v121 offset:15872
  v_mfma_f32_16x16x32_bf16 v[40:43], a[32:35], a[172:175], v[40:43]
  v_mfma_f32_16x16x32_bf16 v[88:91], a[36:39], a[172:175], v[88:91]
  ds_read_b64_tr_b16 a[172:173], v122 offset:15360
  ds_read_b64_tr_b16 a[174:175], v122 offset:15872
  v_mfma_f32_16x16x32_bf16 v[92:95], a[36:39], a[176:179], v[92:95]
  v_mfma_f32_16x16x32_bf16 v[44:47], a[32:35], a[176:179], v[44:47]
  s_waitcnt vmcnt(20) lgkmcnt(10)
  s_barrier
  v_mfma_f32_16x16x32_bf16 v[96:99], a[180:183], a[188:191], v[96:99]
  ds_read_b64_tr_b16 a[176:177], v123 offset:15360
  s_add_u32 m0, s38, 13312
  v_mfma_f32_16x16x32_bf16 v[100:103], a[188:191], a[184:187], v[100:103]
  buffer_load_dwordx4 v107, s[8:11], s17 offen lds
  v_mfma_f32_16x16x32_bf16 v[0:3], a[132:135], a[40:43], v[0:3]
  ds_read_b64_tr_b16 a[178:179], v123 offset:15872
  buffer_load_dwordx4 v108, s[8:11], s17 offen offset:1024 lds
  v_mfma_f32_16x16x32_bf16 v[48:51], a[132:135], a[44:47], v[48:51]
  ds_read_b64_tr_b16 a[180:181], v124 offset:27648
  ds_read_b64_tr_b16 a[182:183], v124 offset:28160
  buffer_load_dwordx4 v109, s[8:11], s17 offen offset:2048 lds
  v_mfma_f32_16x16x32_bf16 v[52:55], a[136:139], a[44:47], v[52:55]
  ds_read_b128 a[188:191], v125 offset:38912
  ds_read_b64_tr_b16 a[184:185], v124 offset:28672
  ds_read_b64_tr_b16 a[186:187], v124 offset:29184
  v_mfma_f32_16x16x32_bf16 v[4:7], a[136:139], a[40:43], v[4:7]
  ds_read_b64_tr_b16 a[132:133], v120 offset:26624
  s_add_u32 s17, s17, 196608
  v_mfma_f32_16x16x32_bf16 v[8:11], a[140:143], a[40:43], v[8:11]
  ds_read_b64_tr_b16 a[134:135], v120 offset:27136
  s_cmp_eq_u32 s17, s10
  v_mfma_f32_16x16x32_bf16 v[56:59], a[140:143], a[44:47], v[56:59]
  ds_read_b64_tr_b16 a[136:137], v121 offset:26624
  s_cselect_b32 s17, 0, s17
  v_mfma_f32_16x16x32_bf16 v[60:63], a[144:147], a[44:47], v[60:63]
  ds_read_b64_tr_b16 a[138:139], v121 offset:27136
  s_add_u32 m0, s38, 26624
  v_mfma_f32_16x16x32_bf16 v[12:15], a[144:147], a[40:43], v[12:15]
  ds_read_b64_tr_b16 a[140:141], v122 offset:26624
  ds_read_b64_tr_b16 a[142:143], v122 offset:27136
  v_mfma_f32_16x16x32_bf16 v[16:19], a[148:151], a[40:43], v[16:19]
  buffer_load_dwordx4 v107, s[8:11], s17 offen lds
  v_mfma_f32_16x16x32_bf16 v[64:67], a[148:151], a[44:47], v[64:67]
  buffer_load_dwordx4 v108, s[8:11], s17 offen offset:1024 lds
  v_mfma_f32_16x16x32_bf16 v[68:71], a[152:155], a[44:47], v[68:71]
  ds_read_b64_tr_b16 a[144:145], v123 offset:26624
  ds_read_b64_tr_b16 a[146:147], v123 offset:27136
  buffer_load_dwordx4 v109, s[8:11], s17 offen offset:2048 lds
  v_mfma_f32_16x16x32_bf16 v[20:23], a[152:155], a[40:43], v[20:23]
  ds_read_b64_tr_b16 a[148:149], v120 offset:27648
  s_add_u32 s17, s17, 196608
  s_waitcnt lgkmcnt(10)
  v_mfma_f32_16x16x32_bf16 v[24:27], a[156:159], a[40:43], v[24:27]
  ds_read_b64_tr_b16 a[150:151], v120 offset:28160
  ds_read_b64_tr_b16 a[152:153], v121 offset:27648
  v_mfma_f32_16x16x32_bf16 v[72:75], a[156:159], a[44:47], v[72:75]
  ds_read_b64_tr_b16 a[154:155], v121 offset:28160
  s_cmp_eq_u32 s17, s10
  v_mfma_f32_16x16x32_bf16 v[76:79], a[160:163], a[44:47], v[76:79]
  ds_read_b64_tr_b16 a[156:157], v122 offset:27648
  s_cselect_b32 s17, 0, s17
  v_mfma_f32_16x16x32_bf16 v[28:31], a[160:163], a[40:43], v[28:31]
  ds_read_b64_tr_b16 a[158:159], v122 offset:28160
  s_add_u32 m0, s39, 26624
  v_mfma_f32_16x16x32_bf16 v[32:35], a[40:43], a[164:167], v[32:35]
  buffer_load_dword v106, s[4:7], s16 offen sc1 lds
  v_mfma_f32_16x16x32_bf16 v[80:83], a[44:47], a[164:167], v[80:83]
  ds_read_b64_tr_b16 a[160:161], v123 offset:27648
  ds_read_b64_tr_b16 a[162:163], v123 offset:28160
  v_mfma_f32_16x16x32_bf16 v[84:87], a[44:47], a[168:171], v[84:87]
  buffer_load_dwordx4 a[16:19], v105, s[4:7], s16 offen sc1
  v_mfma_f32_16x16x32_bf16 v[36:39], a[40:43], a[168:171], v[36:39]
  buffer_load_dwordx4 a[20:23], v105, s[4:7], s16 offen offset:1024 sc1
  v_mfma_f32_16x16x32_bf16 v[40:43], a[40:43], a[172:175], v[40:43]
  ds_read_b64_tr_b16 a[164:165], v120 offset:28672
  ds_read_b64_tr_b16 a[166:167], v120 offset:29184
  s_add_u32 s16, s16, 131072
  v_mfma_f32_16x16x32_bf16 v[88:91], a[44:47], a[172:175], v[88:91]
  ds_read_b64_tr_b16 a[168:169], v121 offset:28672
  s_bitset0_b32 s16, 20
  v_mfma_f32_16x16x32_bf16 v[92:95], a[44:47], a[176:179], v[92:95]
  ds_read_b64_tr_b16 a[170:171], v121 offset:29184
  ds_read_b64_tr_b16 a[172:173], v122 offset:28672
  v_mfma_f32_16x16x32_bf16 v[44:47], a[40:43], a[176:179], v[44:47]
  s_waitcnt vmcnt(21) lgkmcnt(10)
  s_barrier
  v_mfma_f32_16x16x32_bf16 v[96:99], a[180:183], a[188:191], v[96:99]
  ds_read_b64_tr_b16 a[174:175], v122 offset:29184
  s_add_u32 m0, s38, 39936
  v_mfma_f32_16x16x32_bf16 v[100:103], a[188:191], a[184:187], v[100:103]
  buffer_load_dwordx4 v107, s[8:11], s17 offen lds
  v_mfma_f32_16x16x32_bf16 v[0:3], a[132:135], a[48:51], v[0:3]
  ds_read_b64_tr_b16 a[176:177], v123 offset:28672
  ds_read_b64_tr_b16 a[178:179], v123 offset:29184
  buffer_load_dwordx4 v108, s[8:11], s17 offen offset:1024 lds
  v_mfma_f32_16x16x32_bf16 v[48:51], a[132:135], a[52:55], v[48:51]
  ds_read_b64_tr_b16 a[180:181], v124 offset:40960
  ds_read_b64_tr_b16 a[182:183], v124 offset:41472
  buffer_load_dwordx4 v109, s[8:11], s17 offen offset:2048 lds
  v_mfma_f32_16x16x32_bf16 v[52:55], a[136:139], a[52:55], v[52:55]
  ds_read_b128 a[188:191], v125 offset:52224
  ds_read_b64_tr_b16 a[184:185], v124 offset:41984
  ds_read_b64_tr_b16 a[186:187], v124 offset:42496
  v_mfma_f32_16x16x32_bf16 v[4:7], a[136:139], a[48:51], v[4:7]
  ds_read_b64_tr_b16 a[132:133], v120 offset:39936
  s_add_u32 s17, s17, 196608
  v_mfma_f32_16x16x32_bf16 v[8:11], a[140:143], a[48:51], v[8:11]
  ds_read_b64_tr_b16 a[134:135], v120 offset:40448
  s_cmp_eq_u32 s17, s10
  v_mfma_f32_16x16x32_bf16 v[56:59], a[140:143], a[52:55], v[56:59]
  ds_read_b64_tr_b16 a[136:137], v121 offset:39936
  s_cselect_b32 s17, 0, s17
  v_mfma_f32_16x16x32_bf16 v[60:63], a[144:147], a[52:55], v[60:63]
  ds_read_b64_tr_b16 a[138:139], v121 offset:40448
  s_add_u32 m0, s39, 39936
  v_mfma_f32_16x16x32_bf16 v[12:15], a[144:147], a[48:51], v[12:15]
  ds_read_b64_tr_b16 a[140:141], v122 offset:39936
  ds_read_b64_tr_b16 a[142:143], v122 offset:40448
  v_mfma_f32_16x16x32_bf16 v[16:19], a[148:151], a[48:51], v[16:19]
  buffer_load_dword v106, s[4:7], s16 offen sc1 lds
  v_mfma_f32_16x16x32_bf16 v[64:67], a[148:151], a[52:55], v[64:67]
  buffer_load_dwordx4 a[24:27], v105, s[4:7], s16 offen sc1
  s_waitcnt lgkmcnt(10)
  v_mfma_f32_16x16x32_bf16 v[68:71], a[152:155], a[52:55], v[68:71]
  ds_read_b64_tr_b16 a[144:145], v123 offset:39936
  ds_read_b64_tr_b16 a[146:147], v123 offset:40448
  buffer_load_dwordx4 a[28:31], v105, s[4:7], s16 offen offset:1024 sc1
  v_mfma_f32_16x16x32_bf16 v[20:23], a[152:155], a[48:51], v[20:23]
  ds_read_b64_tr_b16 a[148:149], v120 offset:40960
  s_add_u32 s16, s16, 131072
  v_mfma_f32_16x16x32_bf16 v[24:27], a[156:159], a[48:51], v[24:27]
  ds_read_b64_tr_b16 a[150:151], v120 offset:41472
  ds_read_b64_tr_b16 a[152:153], v121 offset:40960
  v_mfma_f32_16x16x32_bf16 v[72:75], a[156:159], a[52:55], v[72:75]
  ds_read_b64_tr_b16 a[154:155], v121 offset:41472
  s_bitset0_b32 s16, 20
  v_mfma_f32_16x16x32_bf16 v[76:79], a[160:163], a[52:55], v[76:79]
  ds_read_b64_tr_b16 a[156:157], v122 offset:40960
  s_add_u32 m0, s38, 53248
  v_mfma_f32_16x16x32_bf16 v[28:31], a[160:163], a[48:51], v[28:31]
  buffer_load_dwordx4 v107, s[8:11], s17 offen lds
  v_mfma_f32_16x16x32_bf16 v[32:35], a[48:51], a[164:167], v[32:35]
  ds_read_b64_tr_b16 a[158:159], v122 offset:41472
  buffer_load_dwordx4 v108, s[8:11], s17 offen offset:1024 lds
  v_mfma_f32_16x16x32_bf16 v[80:83], a[52:55], a[164:167], v[80:83]
  ds_read_b64_tr_b16 a[160:161], v123 offset:40960
  ds_read_b64_tr_b16 a[162:163], v123 offset:41472
  v_mfma_f32_16x16x32_bf16 v[84:87], a[52:55], a[168:171], v[84:87]
  buffer_load_dwordx4 v109, s[8:11], s17 offen offset:2048 lds
  v_mfma_f32_16x16x32_bf16 v[36:39], a[48:51], a[168:171], v[36:39]
  ds_read_b64_tr_b16 a[164:165], v120 offset:41984
  s_add_u32 s17, s17, 196608
  v_mfma_f32_16x16x32_bf16 v[40:43], a[48:51], a[172:175], v[40:43]
  ds_read_b64_tr_b16 a[166:167], v120 offset:42496
  s_cmp_eq_u32 s17, s10
  v_mfma_f32_16x16x32_bf16 v[88:91], a[52:55], a[172:175], v[88:91]
  ds_read_b64_tr_b16 a[168:169], v121 offset:41984
  s_cselect_b32 s17, 0, s17
  v_mfma_f32_16x16x32_bf16 v[92:95], a[52:55], a[176:179], v[92:95]
  ds_read_b64_tr_b16 a[170:171], v121 offset:42496
  ds_read_b64_tr_b16 a[172:173], v122 offset:41984
  v_mfma_f32_16x16x32_bf16 v[44:47], a[48:51], a[176:179], v[44:47]
  s_waitcnt vmcnt(21) lgkmcnt(10)
  s_barrier
  v_mfma_f32_16x16x32_bf16 v[96:99], a[180:183], a[188:191], v[96:99]
  ds_read_b64_tr_b16 a[174:175], v122 offset:42496
  s_add_u32 m0, s39, 53248
  v_mfma_f32_16x16x32_bf16 v[100:103], a[188:191], a[184:187], v[100:103]
  buffer_load_dword v106, s[4:7], s16 offen sc1 lds
  v_mfma_f32_16x16x32_bf16 v[0:3], a[132:135], a[56:59], v[0:3]
  ds_read_b64_tr_b16 a[176:177], v123 offset:41984
  ds_read_b64_tr_b16 a[178:179], v123 offset:42496
  buffer_load_dwordx4 a[32:35], v105, s[4:7], s16 offen sc1
  v_mfma_f32_16x16x32_bf16 v[48:51], a[132:135], a[60:63], v[48:51]
  ds_read_b64_tr_b16 a[180:181], v118 offset:1024
  ds_read_b64_tr_b16 a[182:183], v118 offset:1536
  buffer_load_dwordx4 a[36:39], v105, s[4:7], s16 offen offset:1024 sc1
  v_mfma_f32_16x16x32_bf16 v[52:55], a[136:139], a[60:63], v[52:55]
  ds_read_b128 a[188:191], v119 offset:12288
  ds_read_b64_tr_b16 a[184:185], v118 offset:2048
  ds_read_b64_tr_b16 a[186:187], v118 offset:2560
  v_mfma_f32_16x16x32_bf16 v[4:7], a[136:139], a[56:59], v[4:7]
  ds_read_b64_tr_b16 a[132:133], v114 offset:0
  s_add_u32 s16, s16, 131072
  v_mfma_f32_16x16x32_bf16 v[8:11], a[140:143], a[56:59], v[8:11]
  ds_read_b64_tr_b16 a[134:135], v114 offset:512
  s_bitset0_b32 s16, 20
  v_mfma_f32_16x16x32_bf16 v[56:59], a[140:143], a[60:63], v[56:59]
  ds_read_b64_tr_b16 a[136:137], v115 offset:0
  s_add_u32 m0, s38, 66560
  v_mfma_f32_16x16x32_bf16 v[60:63], a[144:147], a[60:63], v[60:63]
  ds_read_b64_tr_b16 a[138:139], v115 offset:512
  ds_read_b64_tr_b16 a[140:141], v116 offset:0
  v_mfma_f32_16x16x32_bf16 v[12:15], a[144:147], a[56:59], v[12:15]
  buffer_load_dwordx4 v107, s[8:11], s17 offen lds
  v_mfma_f32_16x16x32_bf16 v[16:19], a[148:151], a[56:59], v[16:19]
  ds_read_b64_tr_b16 a[142:143], v116 offset:512
  buffer_load_dwordx4 v108, s[8:11], s17 offen offset:1024 lds
  v_mfma_f32_16x16x32_bf16 v[64:67], a[148:151], a[60:63], v[64:67]
  buffer_load_dwordx4 v109, s[8:11], s17 offen offset:2048 lds
  s_waitcnt lgkmcnt(10)
  v_mfma_f32_16x16x32_bf16 v[68:71], a[152:155], a[60:63], v[68:71]
  ds_read_b64_tr_b16 a[144:145], v117 offset:0
  ds_read_b64_tr_b16 a[146:147], v117 offset:512
  v_mfma_f32_16x16x32_bf16 v[20:23], a[152:155], a[56:59], v[20:23]
  ds_read_b64_tr_b16 a[148:149], v114 offset:1024
  s_add_u32 s17, s17, 196608
  v_mfma_f32_16x16x32_bf16 v[24:27], a[156:159], a[56:59], v[24:27]
  ds_read_b64_tr_b16 a[150:151], v114 offset:1536
  s_cmp_eq_u32 s17, s10
  v_mfma_f32_16x16x32_bf16 v[72:75], a[156:159], a[60:63], v[72:75]
  ds_read_b64_tr_b16 a[152:153], v115 offset:1024
  s_cselect_b32 s17, 0, s17
  v_mfma_f32_16x16x32_bf16 v[76:79], a[160:163], a[60:63], v[76:79]
  ds_read_b64_tr_b16 a[154:155], v115 offset:1536
  ds_read_b64_tr_b16 a[156:157], v116 offset:1024
  v_mfma_f32_16x16x32_bf16 v[28:31], a[160:163], a[56:59], v[28:31]
  ds_read_b64_tr_b16 a[158:159], v116 offset:1536
  s_add_u32 m0, s39, 66560
  v_mfma_f32_16x16x32_bf16 v[32:35], a[56:59], a[164:167], v[32:35]
  buffer_load_dword v106, s[4:7], s16 offen sc1 lds
  v_mfma_f32_16x16x32_bf16 v[80:83], a[60:63], a[164:167], v[80:83]
  buffer_load_dwordx4 a[40:43], v105, s[4:7], s16 offen sc1
  v_mfma_f32_16x16x32_bf16 v[84:87], a[60:63], a[168:171], v[84:87]
  ds_read_b64_tr_b16 a[160:161], v117 offset:1024
  ds_read_b64_tr_b16 a[162:163], v117 offset:1536
  v_mfma_f32_16x16x32_bf16 v[36:39], a[56:59], a[168:171], v[36:39]
  buffer_load_dwordx4 a[44:47], v105, s[4:7], s16 offen offset:1024 sc1
  v_mfma_f32_16x16x32_bf16 v[40:43], a[56:59], a[172:175], v[40:43]
  ds_read_b64_tr_b16 a[164:165], v114 offset:2048
  ds_read_b64_tr_b16 a[166:167], v114 offset:2560
  s_add_u32 s16, s16, 131072
  v_mfma_f32_16x16x32_bf16 v[88:91], a[60:63], a[172:175], v[88:91]
  ds_read_b64_tr_b16 a[168:169], v115 offset:2048
  s_bitset0_b32 s16, 20
  v_mfma_f32_16x16x32_bf16 v[92:95], a[60:63], a[176:179], v[92:95]
  ds_read_b64_tr_b16 a[170:171], v115 offset:2560
  ds_read_b64_tr_b16 a[172:173], v116 offset:2048
  v_mfma_f32_16x16x32_bf16 v[44:47], a[56:59], a[176:179], v[44:47]
  s_waitcnt vmcnt(24) lgkmcnt(10)
  s_barrier
  v_mfma_f32_16x16x32_bf16 v[96:99], a[180:183], a[188:191], v[96:99]
  ds_read_b64_tr_b16 a[174:175], v116 offset:2560
  s_add_u32 m0, s38, 79872
  v_mfma_f32_16x16x32_bf16 v[100:103], a[188:191], a[184:187], v[100:103]
  buffer_load_dwordx4 v107, s[8:11], s17 offen lds
  v_mfma_f32_16x16x32_bf16 v[0:3], a[132:135], a[0:3], v[0:3]
  ds_read_b64_tr_b16 a[176:177], v117 offset:2048
  ds_read_b64_tr_b16 a[178:179], v117 offset:2560
  buffer_load_dwordx4 v108, s[8:11], s17 offen offset:1024 lds
  v_mfma_f32_16x16x32_bf16 v[48:51], a[132:135], a[4:7], v[48:51]
  ds_read_b64_tr_b16 a[180:181], v118 offset:14336
  ds_read_b64_tr_b16 a[182:183], v118 offset:14848
  buffer_load_dwordx4 v109, s[8:11], s17 offen offset:2048 lds
  v_mfma_f32_16x16x32_bf16 v[52:55], a[136:139], a[4:7], v[52:55]
  ds_read_b128 a[188:191], v119 offset:25600
  ds_read_b64_tr_b16 a[184:185], v118 offset:15360
  ds_read_b64_tr_b16 a[186:187], v118 offset:15872
  v_mfma_f32_16x16x32_bf16 v[4:7], a[136:139], a[0:3], v[4:7]
  ds_read_b64_tr_b16 a[132:133], v114 offset:13312
  s_add_u32 s17, s17, 196608
  v_mfma_f32_16x16x32_bf16 v[8:11], a[140:143], a[0:3], v[8:11]
  ds_read_b64_tr_b16 a[134:135], v114 offset:13824
  s_cmp_eq_u32 s17, s10
  v_mfma_f32_16x16x32_bf16 v[56:59], a[140:143], a[4:7], v[56:59]
  ds_read_b64_tr_b16 a[136:137], v115 offset:13312
  s_cselect_b32 s17, 0, s17
  v_mfma_f32_16x16x32_bf16 v[60:63], a[144:147], a[4:7], v[60:63]
  ds_read_b64_tr_b16 a[138:139], v115 offset:13824
  s_add_u32 m0, s39, 79872
  v_mfma_f32_16x16x32_bf16 v[12:15], a[144:147], a[0:3], v[12:15]
  ds_read_b64_tr_b16 a[140:141], v116 offset:13312
  ds_read_b64_tr_b16 a[142:143], v116 offset:13824
  v_mfma_f32_16x16x32_bf16 v[16:19], a[148:151], a[0:3], v[16:19]
  buffer_load_dword v106, s[4:7], s16 offen sc1 lds
  v_mfma_f32_16x16x32_bf16 v[64:67], a[148:151], a[4:7], v[64:67]
  buffer_load_dwordx4 a[48:51], v105, s[4:7], s16 offen sc1
  s_waitcnt lgkmcnt(10)
  v_mfma_f32_16x16x32_bf16 v[68:71], a[152:155], a[4:7], v[68:71]
  ds_read_b64_tr_b16 a[144:145], v117 offset:13312
  ds_read_b64_tr_b16 a[146:147], v117 offset:13824
  buffer_load_dwordx4 a[52:55], v105, s[4:7], s16 offen offset:1024 sc1
  v_mfma_f32_16x16x32_bf16 v[20:23], a[152:155], a[0:3], v[20:23]
  ds_read_b64_tr_b16 a[148:149], v114 offset:14336
  s_add_u32 s16, s16, 131072
  v_mfma_f32_16x16x32_bf16 v[24:27], a[156:159], a[0:3], v[24:27]
  ds_read_b64_tr_b16 a[150:151], v114 offset:14848
  ds_read_b64_tr_b16 a[152:153], v115 offset:14336
  v_mfma_f32_16x16x32_bf16 v[72:75], a[156:159], a[4:7], v[72:75]
  ds_read_b64_tr_b16 a[154:155], v115 offset:14848
  s_bitset0_b32 s16, 20
  v_mfma_f32_16x16x32_bf16 v[76:79], a[160:163], a[4:7], v[76:79]
  ds_read_b64_tr_b16 a[156:157], v116 offset:14336
  s_add_u32 m0, s38, 93184
  v_mfma_f32_16x16x32_bf16 v[28:31], a[160:163], a[0:3], v[28:31]
  buffer_load_dwordx4 v107, s[8:11], s17 offen lds
  v_mfma_f32_16x16x32_bf16 v[32:35], a[0:3], a[164:167], v[32:35]
  ds_read_b64_tr_b16 a[158:159], v116 offset:14848
  buffer_load_dwordx4 v108, s[8:11], s17 offen offset:1024 lds
  v_mfma_f32_16x16x32_bf16 v[80:83], a[4:7], a[164:167], v[80:83]
  ds_read_b64_tr_b16 a[160:161], v117 offset:14336
  ds_read_b64_tr_b16 a[162:163], v117 offset:14848
  v_mfma_f32_16x16x32_bf16 v[84:87], a[4:7], a[168:171], v[84:87]
  buffer_load_dwordx4 v109, s[8:11], s17 offen offset:2048 lds
  v_mfma_f32_16x16x32_bf16 v[36:39], a[0:3], a[168:171], v[36:39]
  ds_read_b64_tr_b16 a[164:165], v114 offset:15360
  s_add_u32 s17, s17, 196608
  v_mfma_f32_16x16x32_bf16 v[40:43], a[0:3], a[172:175], v[40:43]
  ds_read_b64_tr_b16 a[166:167], v114 offset:15872
  s_cmp_eq_u32 s17, s10
  v_mfma_f32_16x16x32_bf16 v[88:91], a[4:7], a[172:175], v[88:91]
  ds_read_b64_tr_b16 a[168:169], v115 offset:15360
  s_cselect_b32 s17, 0, s17
  v_mfma_f32_16x16x32_bf16 v[92:95], a[4:7], a[176:179], v[92:95]
  ds_read_b64_tr_b16 a[170:171], v115 offset:15872
  ds_read_b64_tr_b16 a[172:173], v116 offset:15360
  v_mfma_f32_16x16x32_bf16 v[44:47], a[0:3], a[176:179], v[44:47]
  s_waitcnt vmcnt(27) lgkmcnt(10)
  s_barrier
  v_mfma_f32_16x16x32_bf16 v[96:99], a[180:183], a[188:191], v[96:99]
  ds_read_b64_tr_b16 a[174:175], v116 offset:15872
  s_add_u32 m0, s39, 93184
  v_mfma_f32_16x16x32_bf16 v[100:103], a[188:191], a[184:187], v[100:103]
  buffer_load_dword v106, s[4:7], s16 offen sc1 lds
  v_mfma_f32_16x16x32_bf16 v[0:3], a[132:135], a[8:11], v[0:3]
  ds_read_b64_tr_b16 a[176:177], v117 offset:15360
  ds_read_b64_tr_b16 a[178:179], v117 offset:15872
  buffer_load_dwordx4 a[56:59], v105, s[4:7], s16 offen sc1
  v_mfma_f32_16x16x32_bf16 v[48:51], a[132:135], a[12:15], v[48:51]
  ds_read_b64_tr_b16 a[180:181], v118 offset:27648
  ds_read_b64_tr_b16 a[182:183], v118 offset:28160
  buffer_load_dwordx4 a[60:63], v105, s[4:7], s16 offen offset:1024 sc1
  v_mfma_f32_16x16x32_bf16 v[52:55], a[136:139], a[12:15], v[52:55]
  ds_read_b128 a[188:191], v119 offset:38912
  ds_read_b64_tr_b16 a[184:185], v118 offset:28672
  ds_read_b64_tr_b16 a[186:187], v118 offset:29184
  s_add_u32 s16, s16, 131072
  v_mfma_f32_16x16x32_bf16 v[4:7], a[136:139], a[8:11], v[4:7]
  ds_read_b64_tr_b16 a[132:133], v114 offset:26624
  s_bitset0_b32 s16, 20
  v_mfma_f32_16x16x32_bf16 v[8:11], a[140:143], a[8:11], v[8:11]
  ds_read_b64_tr_b16 a[134:135], v114 offset:27136
  ds_read_b64_tr_b16 a[136:137], v115 offset:26624
  v_mfma_f32_16x16x32_bf16 v[56:59], a[140:143], a[12:15], v[56:59]
  ds_read_b64_tr_b16 a[138:139], v115 offset:27136
  s_add_u32 m0, s51, 0
  v_mfma_f32_16x16x32_bf16 v[60:63], a[144:147], a[12:15], v[60:63]
  ds_read_b64_tr_b16 a[140:141], v116 offset:26624
  s_add_u32 s50, s98, 0
  v_mfma_f32_16x16x32_bf16 v[12:15], a[144:147], a[8:11], v[12:15]
  ds_read_b64_tr_b16 a[142:143], v116 offset:27136
  s_bitset0_b32 s50, 21
  v_mfma_f32_16x16x32_bf16 v[16:19], a[148:151], a[8:11], v[16:19]
  buffer_load_dwordx4 v248, s[52:55], s50 offen lds
  v_mfma_f32_16x16x32_bf16 v[64:67], a[148:151], a[12:15], v[64:67]
  buffer_load_dwordx4 v249, s[52:55], s50 offen offset:1024 lds
  s_waitcnt lgkmcnt(10)
  v_mfma_f32_16x16x32_bf16 v[68:71], a[152:155], a[12:15], v[68:71]
  ds_read_b64_tr_b16 a[144:145], v117 offset:26624
  ds_read_b64_tr_b16 a[146:147], v117 offset:27136
  v_mfma_f32_16x16x32_bf16 v[20:23], a[152:155], a[8:11], v[20:23]
  ds_read_b64_tr_b16 a[148:149], v114 offset:27648
  s_add_u32 m0, s51, 114688
  v_mfma_f32_16x16x32_bf16 v[24:27], a[156:159], a[8:11], v[24:27]
  ds_read_b64_tr_b16 a[150:151], v114 offset:28160
  s_add_u32 s50, s98, 1835008
  v_mfma_f32_16x16x32_bf16 v[72:75], a[156:159], a[12:15], v[72:75]
  ds_read_b64_tr_b16 a[152:153], v115 offset:27648
  s_bitset0_b32 s50, 21
  v_mfma_f32_16x16x32_bf16 v[76:79], a[160:163], a[12:15], v[76:79]
  ds_read_b64_tr_b16 a[154:155], v115 offset:28160
  buffer_load_dwordx4 v248, s[52:55], s50 offen lds
  v_mfma_f32_16x16x32_bf16 v[28:31], a[160:163], a[8:11], v[28:31]
  buffer_load_dwordx4 v249, s[52:55], s50 offen offset:1024 lds
  v_mfma_f32_16x16x32_bf16 v[32:35], a[8:11], a[164:167], v[32:35]
  ds_read_b64_tr_b16 a[156:157], v116 offset:27648
  ds_read_b64_tr_b16 a[158:159], v116 offset:28160
  v_mfma_f32_16x16x32_bf16 v[80:83], a[12:15], a[164:167], v[80:83]
  ds_read_b64_tr_b16 a[160:161], v117 offset:27648
  s_add_u32 m0, s51, 122880
  v_mfma_f32_16x16x32_bf16 v[84:87], a[12:15], a[168:171], v[84:87]
  ds_read_b64_tr_b16 a[162:163], v117 offset:28160
  s_add_u32 s50, s98, 1966080
  v_mfma_f32_16x16x32_bf16 v[36:39], a[8:11], a[168:171], v[36:39]
  ds_read_b64_tr_b16 a[164:165], v114 offset:28672
  s_bitset0_b32 s50, 21
  v_mfma_f32_16x16x32_bf16 v[40:43], a[8:11], a[172:175], v[40:43]
  ds_read_b64_tr_b16 a[166:167], v114 offset:29184
  buffer_load_dwordx4 v248, s[52:55], s50 offen lds
  v_mfma_f32_16x16x32_bf16 v[88:91], a[12:15], a[172:175], v[88:91]
  buffer_load_dwordx4 v249, s[52:55], s50 offen offset:1024 lds
  v_mfma_f32_16x16x32_bf16 v[92:95], a[12:15], a[176:179], v[92:95]
  ds_read_b64_tr_b16 a[168:169], v115 offset:28672
  ds_read_b64_tr_b16 a[170:171], v115 offset:29184
  v_mfma_f32_16x16x32_bf16 v[44:47], a[8:11], a[176:179], v[44:47]
  s_waitcnt vmcnt(30) lgkmcnt(10)
  s_barrier
  v_mfma_f32_16x16x32_bf16 v[96:99], a[180:183], a[188:191], v[96:99]
  ds_read_b64_tr_b16 a[172:173], v116 offset:28672
  ds_read_b64_tr_b16 a[174:175], v116 offset:29184
  s_add_u32 m0, s51, 8192
  v_mfma_f32_16x16x32_bf16 v[100:103], a[188:191], a[184:187], v[100:103]
  ds_read_b64_tr_b16 a[176:177], v117 offset:28672
  ds_read_b64_tr_b16 a[178:179], v117 offset:29184
  v_mfma_f32_16x16x32_bf16 v[0:3], a[132:135], a[16:19], v[0:3]
  ds_read_b64_tr_b16 a[180:181], v118 offset:40960
  s_add_u32 s50, s98, 131072
  v_mfma_f32_16x16x32_bf16 v[48:51], a[132:135], a[20:23], v[48:51]
  ds_read_b64_tr_b16 a[182:183], v118 offset:41472
  ds_read_b128 a[188:191], v119 offset:52224
  v_mfma_f32_16x16x32_bf16 v[52:55], a[136:139], a[20:23], v[52:55]
  ds_read_b64_tr_b16 a[184:185], v118 offset:41984
  ds_read_b64_tr_b16 a[186:187], v118 offset:42496
  v_mfma_f32_16x16x32_bf16 v[4:7], a[136:139], a[16:19], v[4:7]
  ds_read_b64_tr_b16 a[132:133], v114 offset:39936
  s_bitset0_b32 s50, 21
  v_mfma_f32_16x16x32_bf16 v[8:11], a[140:143], a[16:19], v[8:11]
  ds_read_b64_tr_b16 a[134:135], v114 offset:40448
  ds_read_b64_tr_b16 a[136:137], v115 offset:39936
  v_mfma_f32_16x16x32_bf16 v[56:59], a[140:143], a[20:23], v[56:59]
  buffer_load_dwordx4 v248, s[52:55], s50 offen lds
  v_mfma_f32_16x16x32_bf16 v[60:63], a[144:147], a[20:23], v[60:63]
  ds_read_b64_tr_b16 a[138:139], v115 offset:40448
  ds_read_b64_tr_b16 a[140:141], v116 offset:39936
  v_mfma_f32_16x16x32_bf16 v[12:15], a[144:147], a[16:19], v[12:15]
  ds_read_b64_tr_b16 a[142:143], v116 offset:40448
  ds_read_b64_tr_b16 a[144:145], v117 offset:39936
  v_mfma_f32_16x16x32_bf16 v[16:19], a[148:151], a[16:19], v[16:19]
  buffer_load_dwordx4 v249, s[52:55], s50 offen offset:1024 lds
  v_mfma_f32_16x16x32_bf16 v[64:67], a[148:151], a[20:23], v[64:67]
  ds_read_b64_tr_b16 a[146:147], v117 offset:40448
  ds_read_b64_tr_b16 a[148:149], v114 offset:40960
  s_waitcnt lgkmcnt(10)
  v_mfma_f32_16x16x32_bf16 v[68:71], a[152:155], a[20:23], v[68:71]
  ds_read_b64_tr_b16 a[150:151], v114 offset:41472
  s_add_u32 m0, s51, 16384
  v_mfma_f32_16x16x32_bf16 v[20:23], a[152:155], a[16:19], v[20:23]
  ds_read_b64_tr_b16 a[152:153], v115 offset:40960
  ds_read_b64_tr_b16 a[154:155], v115 offset:41472
  v_mfma_f32_16x16x32_bf16 v[24:27], a[156:159], a[16:19], v[24:27]
  v_mfma_f32_16x16x32_bf16 v[72:75], a[156:159], a[20:23], v[72:75]
  ds_read_b64_tr_b16 a[156:157], v116 offset:40960
  s_add_u32 s50, s98, 262144
  v_mfma_f32_16x16x32_bf16 v[76:79], a[160:163], a[20:23], v[76:79]
  ds_read_b64_tr_b16 a[158:159], v116 offset:41472
  v_mfma_f32_16x16x32_bf16 v[28:31], a[160:163], a[16:19], v[28:31]
  ds_read_b64_tr_b16 a[160:161], v117 offset:40960
  s_bitset0_b32 s50, 21
  v_mfma_f32_16x16x32_bf16 v[32:35], a[16:19], a[164:167], v[32:35]
  ds_read_b64_tr_b16 a[162:163], v117 offset:41472
  v_mfma_f32_16x16x32_bf16 v[80:83], a[20:23], a[164:167], v[80:83]
  ds_read_b64_tr_b16 a[164:165], v114 offset:41984
  ds_read_b64_tr_b16 a[166:167], v114 offset:42496
  v_mfma_f32_16x16x32_bf16 v[84:87], a[20:23], a[168:171], v[84:87]
  buffer_load_dwordx4 v248, s[52:55], s50 offen lds
  v_mfma_f32_16x16x32_bf16 v[36:39], a[16:19], a[168:171], v[36:39]
  ds_read_b64_tr_b16 a[168:169], v115 offset:41984
  ds_read_b64_tr_b16 a[170:171], v115 offset:42496
  v_mfma_f32_16x16x32_bf16 v[40:43], a[16:19], a[172:175], v[40:43]
  buffer_load_dwordx4 v249, s[52:55], s50 offen offset:1024 lds
  v_mfma_f32_16x16x32_bf16 v[88:91], a[20:23], a[172:175], v[88:91]
  ds_read_b64_tr_b16 a[172:173], v116 offset:41984
  ds_read_b64_tr_b16 a[174:175], v116 offset:42496
  v_mfma_f32_16x16x32_bf16 v[92:95], a[20:23], a[176:179], v[92:95]
  v_mfma_f32_16x16x32_bf16 v[44:47], a[16:19], a[176:179], v[44:47]
  s_waitcnt vmcnt(28) lgkmcnt(10)
  s_barrier
  v_mfma_f32_16x16x32_bf16 v[96:99], a[180:183], a[188:191], v[96:99]
  ds_read_b64_tr_b16 a[176:177], v117 offset:41984
  s_add_u32 m0, s51, 24576
  v_mfma_f32_16x16x32_bf16 v[100:103], a[188:191], a[184:187], v[100:103]
  ds_read_b64_tr_b16 a[178:179], v117 offset:42496
  ds_read_b64_tr_b16 a[180:181], v124 offset:1024
  v_mfma_f32_16x16x32_bf16 v[0:3], a[132:135], a[24:27], v[0:3]
  ds_read_b64_tr_b16 a[182:183], v124 offset:1536
  ds_read_b128 a[188:191], v125 offset:12288
  v_mfma_f32_16x16x32_bf16 v[48:51], a[132:135], a[28:31], v[48:51]
  ds_read_b64_tr_b16 a[184:185], v124 offset:2048
  ds_read_b64_tr_b16 a[186:187], v124 offset:2560
  v_mfma_f32_16x16x32_bf16 v[52:55], a[136:139], a[28:31], v[52:55]
  ds_read_b64_tr_b16 a[132:133], v120 offset:0
  ds_read_b64_tr_b16 a[134:135], v120 offset:512
  v_mfma_f32_16x16x32_bf16 v[4:7], a[136:139], a[24:27], v[4:7]
  ds_read_b64_tr_b16 a[136:137], v121 offset:0
  s_add_u32 s50, s98, 393216
  v_mfma_f32_16x16x32_bf16 v[8:11], a[140:143], a[24:27], v[8:11]
  ds_read_b64_tr_b16 a[138:139], v121 offset:512
  v_mfma_f32_16x16x32_bf16 v[56:59], a[140:143], a[28:31], v[56:59]
  ds_read_b64_tr_b16 a[140:141], v122 offset:0
  ds_read_b64_tr_b16 a[142:143], v122 offset:512
  v_mfma_f32_16x16x32_bf16 v[60:63], a[144:147], a[28:31], v[60:63]
  v_mfma_f32_16x16x32_bf16 v[12:15], a[144:147], a[24:27], v[12:15]
  ds_read_b64_tr_b16 a[144:145], v123 offset:0
  ds_read_b64_tr_b16 a[146:147], v123 offset:512
  v_mfma_f32_16x16x32_bf16 v[16:19], a[148:151], a[24:27], v[16:19]
  s_bitset0_b32 s50, 21
  v_mfma_f32_16x16x32_bf16 v[64:67], a[148:151], a[28:31], v[64:67]
  ds_read_b64_tr_b16 a[148:149], v120 offset:1024
  ds_read_b64_tr_b16 a[150:151], v120 offset:1536
  v_mfma_f32_16x16x32_bf16 v[68:71], a[152:155], a[28:31], v[68:71]
  v_mfma_f32_16x16x32_bf16 v[20:23], a[152:155], a[24:27], v[20:23]
  ds_read_b64_tr_b16 a[152:153], v121 offset:1024
  ds_read_b64_tr_b16 a[154:155], v121 offset:1536
  s_waitcnt lgkmcnt(10)
  v_mfma_f32_16x16x32_bf16 v[24:27], a[156:159], a[24:27], v[24:27]
  v_mfma_f32_16x16x32_bf16 v[72:75], a[156:159], a[28:31], v[72:75]
  buffer_load_dwordx4 v248, s[52:55], s50 offen lds
  v_mfma_f32_16x16x32_bf16 v[76:79], a[160:163], a[28:31], v[76:79]
  ds_read_b64_tr_b16 a[156:157], v122 offset:1024
  ds_read_b64_tr_b16 a[158:159], v122 offset:1536
  v_mfma_f32_16x16x32_bf16 v[28:31], a[160:163], a[24:27], v[28:31]
  ds_read_b64_tr_b16 a[160:161], v123 offset:1024
  ds_read_b64_tr_b16 a[162:163], v123 offset:1536
  v_mfma_f32_16x16x32_bf16 v[32:35], a[24:27], a[164:167], v[32:35]
  v_mfma_f32_16x16x32_bf16 v[80:83], a[28:31], a[164:167], v[80:83]
  ds_read_b64_tr_b16 a[164:165], v120 offset:2048
  ds_read_b64_tr_b16 a[166:167], v120 offset:2560
  v_mfma_f32_16x16x32_bf16 v[84:87], a[28:31], a[168:171], v[84:87]
  buffer_load_dwordx4 v249, s[52:55], s50 offen offset:1024 lds
  v_mfma_f32_16x16x32_bf16 v[36:39], a[24:27], a[168:171], v[36:39]
  ds_read_b64_tr_b16 a[168:169], v121 offset:2048
  ds_read_b64_tr_b16 a[170:171], v121 offset:2560
  v_mfma_f32_16x16x32_bf16 v[40:43], a[24:27], a[172:175], v[40:43]
  v_mfma_f32_16x16x32_bf16 v[88:91], a[28:31], a[172:175], v[88:91]
  ds_read_b64_tr_b16 a[172:173], v122 offset:2048
  ds_read_b64_tr_b16 a[174:175], v122 offset:2560
  v_mfma_f32_16x16x32_bf16 v[92:95], a[28:31], a[176:179], v[92:95]
  v_mfma_f32_16x16x32_bf16 v[44:47], a[24:27], a[176:179], v[44:47]
  s_waitcnt vmcnt(24) lgkmcnt(10)
  s_barrier
  v_mfma_f32_16x16x32_bf16 v[96:99], a[180:183], a[188:191], v[96:99]
  ds_read_b64_tr_b16 a[176:177], v123 offset:2048
  s_add_u32 m0, s51, 32768
  v_mfma_f32_16x16x32_bf16 v[100:103], a[188:191], a[184:187], v[100:103]
  ds_read_b64_tr_b16 a[178:179], v123 offset:2560
  s_add_u32 s50, s98, 524288
  v_mfma_f32_16x16x32_bf16 v[0:3], a[132:135], a[32:35], v[0:3]
  ds_read_b64_tr_b16 a[180:181], v124 offset:14336
  ds_read_b64_tr_b16 a[182:183], v124 offset:14848
  v_mfma_f32_16x16x32_bf16 v[48:51], a[132:135], a[36:39], v[48:51]
  ds_read_b128 a[188:191], v125 offset:25600
  s_bitset0_b32 s50, 21
  v_mfma_f32_16x16x32_bf16 v[52:55], a[136:139], a[36:39], v[52:55]
  ds_read_b64_tr_b16 a[184:185], v124 offset:15360
  ds_read_b64_tr_b16 a[186:187], v124 offset:15872
  v_mfma_f32_16x16x32_bf16 v[4:7], a[136:139], a[32:35], v[4:7]
  buffer_load_dwordx4 v248, s[52:55], s50 offen lds
  v_mfma_f32_16x16x32_bf16 v[8:11], a[140:143], a[32:35], v[8:11]
  ds_read_b64_tr_b16 a[132:133], v120 offset:13312
  ds_read_b64_tr_b16 a[134:135], v120 offset:13824
  buffer_load_dwordx4 v249, s[52:55], s50 offen offset:1024 lds
  v_mfma_f32_16x16x32_bf16 v[56:59], a[140:143], a[36:39], v[56:59]
  ds_read_b64_tr_b16 a[136:137], v121 offset:13312
  ds_read_b64_tr_b16 a[138:139], v121 offset:13824
  v_mfma_f32_16x16x32_bf16 v[60:63], a[144:147], a[36:39], v[60:63]
  ds_read_b64_tr_b16 a[140:141], v122 offset:13312
  s_add_u32 m0, s51, 40960
  v_mfma_f32_16x16x32_bf16 v[12:15], a[144:147], a[32:35], v[12:15]
  ds_read_b64_tr_b16 a[142:143], v122 offset:13824
  ds_read_b64_tr_b16 a[144:145], v123 offset:13312
  v_mfma_f32_16x16x32_bf16 v[16:19], a[148:151], a[32:35], v[16:19]
  ds_read_b64_tr_b16 a[146:147], v123 offset:13824
  s_add_u32 s50, s98, 655360
  v_mfma_f32_16x16x32_bf16 v[64:67], a[148:151], a[36:39], v[64:67]
  ds_read_b64_tr_b16 a[148:149], v120 offset:14336
  s_bitset0_b32 s50, 21
  v_mfma_f32_16x16x32_bf16 v[68:71], a[152:155], a[36:39], v[68:71]
  ds_read_b64_tr_b16 a[150:151], v120 offset:14848
  v_mfma_f32_16x16x32_bf16 v[20:23], a[152:155], a[32:35], v[20:23]
  buffer_load_dwordx4 v248, s[52:55], s50 offen lds
  s_waitcnt lgkmcnt(10)
  v_mfma_f32_16x16x32_bf16 v[24:27], a[156:159], a[32:35], v[24:27]
  ds_read_b64_tr_b16 a[152:153], v121 offset:14336
  ds_read_b64_tr_b16 a[154:155], v121 offset:14848
  v_mfma_f32_16x16x32_bf16 v[72:75], a[156:159], a[36:39], v[72:75]
  buffer_load_dwordx4 v249, s[52:55], s50 offen offset:1024 lds
  v_mfma_f32_16x16x32_bf16 v[76:79], a[160:163], a[36:39], v[76:79]
  ds_read_b64_tr_b16 a[156:157], v122 offset:14336
  s_lshl_b32 s34, s37, 8
  v_mfma_f32_16x16x32_bf16 v[28:31], a[160:163], a[32:35], v[28:31]
  ds_read_b64_tr_b16 a[158:159], v122 offset:14848
  ds_read_b64_tr_b16 a[160:161], v123 offset:14336
  v_mfma_f32_16x16x32_bf16 v[32:35], a[32:35], a[164:167], v[32:35]
  ds_read_b64_tr_b16 a[162:163], v123 offset:14848
  s_lshl_b32 s33, s3, 12
  v_mfma_f32_16x16x32_bf16 v[80:83], a[36:39], a[164:167], v[80:83]
  ds_read_b64_tr_b16 a[164:165], v120 offset:15360
  ds_read_b64_tr_b16 a[166:167], v120 offset:15872
  v_mfma_f32_16x16x32_bf16 v[84:87], a[36:39], a[168:171], v[84:87]
  s_add_u32 s34, s34, s33
  v_mfma_f32_16x16x32_bf16 v[36:39], a[32:35], a[168:171], v[36:39]
  ds_read_b64_tr_b16 a[168:169], v121 offset:15360
  s_add_u32 s68, s34, 8192
  v_mfma_f32_16x16x32_bf16 v[40:43], a[32:35], a[172:175], v[40:43]
  ds_read_b64_tr_b16 a[170:171], v121 offset:15872
  v_mfma_f32_16x16x32_bf16 v[88:91], a[36:39], a[172:175], v[88:91]
  buffer_load_dwordx4 v[250:253], v254, s[12:15], s68 offen sc1
  v_mfma_f32_16x16x32_bf16 v[92:95], a[36:39], a[176:179], v[92:95]
  ds_read_b64_tr_b16 a[172:173], v122 offset:15360
  ds_read_b64_tr_b16 a[174:175], v122 offset:15872
  v_mfma_f32_16x16x32_bf16 v[44:47], a[32:35], a[176:179], v[44:47]
  s_waitcnt vmcnt(23) lgkmcnt(10)
  s_barrier
  v_mfma_f32_16x16x32_bf16 v[96:99], a[180:183], a[188:191], v[96:99]
  ds_read_b64_tr_b16 a[176:177], v123 offset:15360
  s_add_u32 m0, s51, 49152
  v_mfma_f32_16x16x32_bf16 v[100:103], a[188:191], a[184:187], v[100:103]
  ds_read_b64_tr_b16 a[178:179], v123 offset:15872
  s_add_u32 s50, s98, 786432
  v_mfma_f32_16x16x32_bf16 v[0:3], a[132:135], a[40:43], v[0:3]
  ds_read_b64_tr_b16 a[180:181], v124 offset:27648
  s_bitset0_b32 s50, 21
  v_mfma_f32_16x16x32_bf16 v[48:51], a[132:135], a[44:47], v[48:51]
  ds_read_b64_tr_b16 a[182:183], v124 offset:28160
  buffer_load_dwordx4 v248, s[52:55], s50 offen lds
  v_mfma_f32_16x16x32_bf16 v[52:55], a[136:139], a[44:47], v[52:55]
  ds_read_b128 a[188:191], v125 offset:38912
  ds_read_b64_tr_b16 a[184:185], v124 offset:28672
  ds_read_b64_tr_b16 a[186:187], v124 offset:29184
  v_mfma_f32_16x16x32_bf16 v[4:7], a[136:139], a[40:43], v[4:7]
  buffer_load_dwordx4 v249, s[52:55], s50 offen offset:1024 lds
  v_mfma_f32_16x16x32_bf16 v[8:11], a[140:143], a[40:43], v[8:11]
  ds_read_b64_tr_b16 a[132:133], v120 offset:26624
  ds_read_b64_tr_b16 a[134:135], v120 offset:27136
  s_add_u32 m0, s51, 57344
  v_mfma_f32_16x16x32_bf16 v[56:59], a[140:143], a[44:47], v[56:59]
  ds_read_b64_tr_b16 a[136:137], v121 offset:26624
  s_add_u32 s50, s98, 917504
  v_mfma_f32_16x16x32_bf16 v[60:63], a[144:147], a[44:47], v[60:63]
  ds_read_b64_tr_b16 a[138:139], v121 offset:27136
  ds_read_b64_tr_b16 a[140:141], v122 offset:26624
  v_mfma_f32_16x16x32_bf16 v[12:15], a[144:147], a[40:43], v[12:15]
  ds_read_b64_tr_b16 a[142:143], v122 offset:27136
  s_bitset0_b32 s50, 21
  v_mfma_f32_16x16x32_bf16 v[16:19], a[148:151], a[40:43], v[16:19]
  buffer_load_dwordx4 v248, s[52:55], s50 offen lds
  v_mfma_f32_16x16x32_bf16 v[64:67], a[148:151], a[44:47], v[64:67]
  buffer_load_dwordx4 v249, s[52:55], s50 offen offset:1024 lds
  v_mfma_f32_16x16x32_bf16 v[68:71], a[152:155], a[44:47], v[68:71]
  ds_read_b64_tr_b16 a[144:145], v123 offset:26624
  ds_read_b64_tr_b16 a[146:147], v123 offset:27136
  v_mfma_f32_16x16x32_bf16 v[20:23], a[152:155], a[40:43], v[20:23]
  ds_read_b64_tr_b16 a[148:149], v120 offset:27648
  s_mov_b32 s56, s26
  s_waitcnt lgkmcnt(10)
  v_mfma_f32_16x16x32_bf16 v[24:27], a[156:159], a[40:43], v[24:27]
  ds_read_b64_tr_b16 a[150:151], v120 offset:28160
  s_mov_b32 s57, s27
  v_mfma_f32_16x16x32_bf16 v[72:75], a[156:159], a[44:47], v[72:75]
  ds_read_b64_tr_b16 a[152:153], v121 offset:27648
  s_mov_b32 s58, 0x400000
  v_mfma_f32_16x16x32_bf16 v[76:79], a[160:163], a[44:47], v[76:79]
  ds_read_b64_tr_b16 a[154:155], v121 offset:28160
  ds_read_b64_tr_b16 a[156:157], v122 offset:27648
  v_mfma_f32_16x16x32_bf16 v[28:31], a[160:163], a[40:43], v[28:31]
  ds_read_b64_tr_b16 a[158:159], v122 offset:28160
  s_mov_b32 s59, 0x20000
  v_mfma_f32_16x16x32_bf16 v[32:35], a[40:43], a[164:167], v[32:35]
  ds_read_b64_tr_b16 a[160:161], v123 offset:27648
  s_mov_b32 s33, 0x8000
  v_mfma_f32_16x16x32_bf16 v[80:83], a[44:47], a[164:167], v[80:83]
  buffer_load_dwordx4 a[240:243], v128, s[56:59], 0 offen offset:0
  v_mfma_f32_16x16x32_bf16 v[84:87], a[44:47], a[168:171], v[84:87]
  ds_read_b64_tr_b16 a[162:163], v123 offset:28160
  ds_read_b64_tr_b16 a[164:165], v120 offset:28672
  v_mfma_f32_16x16x32_bf16 v[36:39], a[40:43], a[168:171], v[36:39]
  buffer_load_dwordx4 a[244:247], v128, s[56:59], 0 offen offset:64
  v_mfma_f32_16x16x32_bf16 v[40:43], a[40:43], a[172:175], v[40:43]
  ds_read_b64_tr_b16 a[166:167], v120 offset:29184
  buffer_load_dwordx4 a[248:251], v128, s[56:59], s33 offen offset:0
  v_mfma_f32_16x16x32_bf16 v[88:91], a[44:47], a[172:175], v[88:91]
  buffer_load_dwordx4 a[252:255], v128, s[56:59], s33 offen offset:64
  v_mfma_f32_16x16x32_bf16 v[92:95], a[44:47], a[176:179], v[92:95]
  ds_read_b64_tr_b16 a[168:169], v121 offset:28672
  ds_read_b64_tr_b16 a[170:171], v121 offset:29184
  v_mfma_f32_16x16x32_bf16 v[44:47], a[40:43], a[176:179], v[44:47]
  s_waitcnt vmcnt(25) lgkmcnt(10)
  s_barrier
  v_mfma_f32_16x16x32_bf16 v[96:99], a[180:183], a[188:191], v[96:99]
  ds_read_b64_tr_b16 a[172:173], v122 offset:28672
  ds_read_b64_tr_b16 a[174:175], v122 offset:29184
  s_add_u32 m0, s51, 65536
  v_mfma_f32_16x16x32_bf16 v[100:103], a[188:191], a[184:187], v[100:103]
  ds_read_b64_tr_b16 a[176:177], v123 offset:28672
  ds_read_b64_tr_b16 a[178:179], v123 offset:29184
  v_mfma_f32_16x16x32_bf16 v[0:3], a[132:135], a[48:51], v[0:3]
  ds_read_b64_tr_b16 a[180:181], v124 offset:40960
  ds_read_b64_tr_b16 a[182:183], v124 offset:41472
  v_mfma_f32_16x16x32_bf16 v[48:51], a[132:135], a[52:55], v[48:51]
  ds_read_b128 a[188:191], v125 offset:52224
  ds_read_b64_tr_b16 a[184:185], v124 offset:41984
  v_mfma_f32_16x16x32_bf16 v[52:55], a[136:139], a[52:55], v[52:55]
  ds_read_b64_tr_b16 a[186:187], v124 offset:42496
  ds_read_b64_tr_b16 a[132:133], v120 offset:39936
  v_mfma_f32_16x16x32_bf16 v[4:7], a[136:139], a[48:51], v[4:7]
  ds_read_b64_tr_b16 a[134:135], v120 offset:40448
  s_add_u32 s50, s98, 1048576
  v_mfma_f32_16x16x32_bf16 v[8:11], a[140:143], a[48:51], v[8:11]
  ds_read_b64_tr_b16 a[136:137], v121 offset:39936
  ds_read_b64_tr_b16 a[138:139], v121 offset:40448
  v_mfma_f32_16x16x32_bf16 v[56:59], a[140:143], a[52:55], v[56:59]
  ds_read_b64_tr_b16 a[140:141], v122 offset:39936
  ds_read_b64_tr_b16 a[142:143], v122 offset:40448
  v_mfma_f32_16x16x32_bf16 v[60:63], a[144:147], a[52:55], v[60:63]
  v_mfma_f32_16x16x32_bf16 v[12:15], a[144:147], a[48:51], v[12:15]
  ds_read_b64_tr_b16 a[144:145], v123 offset:39936
  ds_read_b64_tr_b16 a[146:147], v123 offset:40448
  v_mfma_f32_16x16x32_bf16 v[16:19], a[148:151], a[48:51], v[16:19]
  s_bitset0_b32 s50, 21
  v_mfma_f32_16x16x32_bf16 v[64:67], a[148:151], a[52:55], v[64:67]
  ds_read_b64_tr_b16 a[148:149], v120 offset:40960
  ds_read_b64_tr_b16 a[150:151], v120 offset:41472
  s_waitcnt lgkmcnt(10)
  v_mfma_f32_16x16x32_bf16 v[68:71], a[152:155], a[52:55], v[68:71]
  v_mfma_f32_16x16x32_bf16 v[20:23], a[152:155], a[48:51], v[20:23]
  ds_read_b64_tr_b16 a[152:153], v121 offset:40960
  ds_read_b64_tr_b16 a[154:155], v121 offset:41472
  v_mfma_f32_16x16x32_bf16 v[24:27], a[156:159], a[48:51], v[24:27]
  v_mfma_f32_16x16x32_bf16 v[72:75], a[156:159], a[52:55], v[72:75]
  buffer_load_dwordx4 v248, s[52:55], s50 offen lds
  v_mfma_f32_16x16x32_bf16 v[76:79], a[160:163], a[52:55], v[76:79]
  ds_read_b64_tr_b16 a[156:157], v122 offset:40960
  ds_read_b64_tr_b16 a[158:159], v122 offset:41472
  v_mfma_f32_16x16x32_bf16 v[28:31], a[160:163], a[48:51], v[28:31]
  ds_read_b64_tr_b16 a[160:161], v123 offset:40960
  ds_read_b64_tr_b16 a[162:163], v123 offset:41472
  v_mfma_f32_16x16x32_bf16 v[32:35], a[48:51], a[164:167], v[32:35]
  v_mfma_f32_16x16x32_bf16 v[80:83], a[52:55], a[164:167], v[80:83]
  s_add_u32 s4, s20, 0x600000
  s_addc_u32 s5, s21, 0
  s_mov_b32 s6, 0x400000
  s_mov_b32 s7, 0x20000
  s_lshl_b32 s33, s3, 12
  s_add_u32 s33, s33, 139264
  v_add_u32 v110, s33, v119
  s_lshr_b32 s33, s3, 1
  s_lshl_b32 s33, s33, 10
  s_and_b32 s34, s3, 1
  s_lshl_b32 s34, s34, 3
  s_add_u32 s33, s33, s34
  s_add_u32 s33, s33, 139264
  v_add_u32 v111, s33, v119
  v_mfma_f32_16x16x32_bf16 v[84:87], a[52:55], a[168:171], v[84:87]
  buffer_load_dwordx4 v249, s[52:55], s50 offen offset:1024 lds
  v_mfma_f32_16x16x32_bf16 v[36:39], a[48:51], a[168:171], v[36:39]
  ds_read_b64_tr_b16 a[164:165], v120 offset:41984
  ds_read_b64_tr_b16 a[166:167], v120 offset:42496
  v_mfma_f32_16x16x32_bf16 v[40:43], a[48:51], a[172:175], v[40:43]
  ds_read_b64_tr_b16 a[168:169], v121 offset:41984
  ds_read_b64_tr_b16 a[170:171], v121 offset:42496
  v_mfma_f32_16x16x32_bf16 v[88:91], a[52:55], a[172:175], v[88:91]
  ds_read_b64_tr_b16 a[172:173], v122 offset:41984
  ds_read_b64_tr_b16 a[174:175], v122 offset:42496
  v_mfma_f32_16x16x32_bf16 v[92:95], a[52:55], a[176:179], v[92:95]
  v_mfma_f32_16x16x32_bf16 v[44:47], a[48:51], a[176:179], v[44:47]
  s_waitcnt vmcnt(27) lgkmcnt(10)
  s_barrier
  v_mfma_f32_16x16x32_bf16 v[96:99], a[180:183], a[188:191], v[96:99]
  ds_read_b64_tr_b16 a[176:177], v123 offset:41984
  ds_read_b64_tr_b16 a[178:179], v123 offset:42496
  v_mfma_f32_16x16x32_bf16 v[100:103], a[188:191], a[184:187], v[100:103]
  v_mfma_f32_16x16x32_bf16 v[64:67], a[148:151], a[60:63], v[64:67]
  v_mfma_f32_16x16x32_bf16 v[68:71], a[152:155], a[60:63], v[68:71]
  s_waitcnt lgkmcnt(10)
  v_mfma_f32_16x16x32_bf16 v[72:75], a[156:159], a[60:63], v[72:75]
  s_waitcnt lgkmcnt(8)
  v_mfma_f32_16x16x32_bf16 v[76:79], a[160:163], a[60:63], v[76:79]
  v_mfma_f32_16x16x32_bf16 v[16:19], a[148:151], a[56:59], v[16:19]
  v_mfma_f32_16x16x32_bf16 v[20:23], a[152:155], a[56:59], v[20:23]
  v_mfma_f32_16x16x32_bf16 v[24:27], a[156:159], a[56:59], v[24:27]
  v_mfma_f32_16x16x32_bf16 v[28:31], a[160:163], a[56:59], v[28:31]
  v_cvt_pk_bf16_f32 v196, v96, v97
  v_cvt_pk_bf16_f32 v197, v98, v99
  s_waitcnt lgkmcnt(6)
  v_mfma_f32_16x16x32_bf16 v[80:83], a[60:63], a[164:167], v[80:83]
  v_cvt_pk_bf16_f32 v198, v100, v101
  v_cvt_pk_bf16_f32 v199, v102, v103
  s_waitcnt lgkmcnt(4)
  v_mfma_f32_16x16x32_bf16 v[84:87], a[60:63], a[168:171], v[84:87]
  ds_write_b64 v111, v[196:197]
  ds_write_b64 v111, v[198:199] offset:2048
  s_waitcnt lgkmcnt(4)
  v_mfma_f32_16x16x32_bf16 v[88:91], a[60:63], a[172:175], v[88:91]
  v_cvt_pk_bf16_f32 v164, v64, v65
  v_cvt_pk_bf16_f32 v165, v66, v67
  s_waitcnt lgkmcnt(2)
  v_mfma_f32_16x16x32_bf16 v[92:95], a[60:63], a[176:179], v[92:95]
  v_cvt_pk_bf16_f32 v166, v68, v69
  v_cvt_pk_bf16_f32 v167, v70, v71
  v_mfma_f32_16x16x32_bf16 v[48:51], a[132:135], a[60:63], v[48:51]
  v_cvt_pk_bf16_f32 v168, v72, v73
  v_cvt_pk_bf16_f32 v169, v74, v75
  v_mfma_f32_16x16x32_bf16 v[52:55], a[136:139], a[60:63], v[52:55]
  v_cvt_pk_bf16_f32 v170, v76, v77
  v_cvt_pk_bf16_f32 v171, v78, v79
  v_mfma_f32_16x16x32_bf16 v[56:59], a[140:143], a[60:63], v[56:59]
  ds_write_b128 v110, v[164:167] offset:4096
  ds_write_b128 v110, v[168:171] offset:5120
  v_mfma_f32_16x16x32_bf16 v[60:63], a[144:147], a[60:63], v[60:63]
  v_cvt_pk_bf16_f32 v176, v80, v81
  v_cvt_pk_bf16_f32 v177, v82, v83
  v_mfma_f32_16x16x32_bf16 v[0:3], a[132:135], a[56:59], v[0:3]
  v_cvt_pk_bf16_f32 v182, v84, v85
  v_cvt_pk_bf16_f32 v183, v86, v87
  v_mfma_f32_16x16x32_bf16 v[4:7], a[136:139], a[56:59], v[4:7]
  v_cvt_pk_bf16_f32 v188, v88, v89
  v_cvt_pk_bf16_f32 v189, v90, v91
  v_mfma_f32_16x16x32_bf16 v[8:11], a[140:143], a[56:59], v[8:11]
  v_cvt_pk_bf16_f32 v194, v92, v93
  v_cvt_pk_bf16_f32 v195, v94, v95
  v_mfma_f32_16x16x32_bf16 v[12:15], a[144:147], a[56:59], v[12:15]
  ds_write_b64 v110, v[176:177] offset:6144
  ds_write_b64 v110, v[182:183] offset:6152
  v_mfma_f32_16x16x32_bf16 v[32:35], a[56:59], a[164:167], v[32:35]
  ds_write_b64 v110, v[188:189] offset:7168
  ds_write_b64 v110, v[194:195] offset:7176
  v_mfma_f32_16x16x32_bf16 v[36:39], a[56:59], a[168:171], v[36:39]
  v_cvt_pk_bf16_f32 v156, v16, v17
  v_cvt_pk_bf16_f32 v157, v18, v19
  v_mfma_f32_16x16x32_bf16 v[40:43], a[56:59], a[172:175], v[40:43]
  v_cvt_pk_bf16_f32 v158, v20, v21
  v_cvt_pk_bf16_f32 v159, v22, v23
  v_mfma_f32_16x16x32_bf16 v[44:47], a[56:59], a[176:179], v[44:47]
L_att:
  v_cvt_pk_bf16_f32 v160, v24, v25
  v_cvt_pk_bf16_f32 v161, v26, v27
  v_cvt_pk_bf16_f32 v162, v28, v29
  v_cvt_pk_bf16_f32 v163, v30, v31
  v_cvt_pk_bf16_f32 v140, v48, v49
  v_cvt_pk_bf16_f32 v141, v50, v51
  v_cvt_pk_bf16_f32 v142, v52, v53
  v_cvt_pk_bf16_f32 v143, v54, v55
  v_cvt_pk_bf16_f32 v144, v56, v57
  v_cvt_pk_bf16_f32 v145, v58, v59
  v_cvt_pk_bf16_f32 v146, v60, v61
  v_cvt_pk_bf16_f32 v147, v62, v63
  s_waitcnt lgkmcnt(0)
  s_barrier
  ds_read_b128 v[148:151], v110 offset:0
  ds_read_b64 v[172:173], v110 offset:2048
  ds_read_b64 v[178:179], v110 offset:2056
  ds_read_b128 v[152:155], v110 offset:1024
  ds_read_b64 v[184:185], v110 offset:3072
  ds_read_b64 v[190:191], v110 offset:3080
  v_mfma_f32_16x16x32_bf16 v[200:203], v[156:159], v[140:143], 0
  v_mfma_f32_16x16x32_bf16 v[204:207], v[164:167], v[140:143], 0
  v_mfma_f32_16x16x32_bf16 v[208:211], v[160:163], v[144:147], 0
  v_mfma_f32_16x16x32_bf16 v[212:215], v[168:171], v[144:147], 0
  v_cvt_pk_bf16_f32 v132, v0, v1
  v_cvt_pk_bf16_f32 v133, v2, v3
  v_cvt_pk_bf16_f32 v134, v4, v5
  v_cvt_pk_bf16_f32 v135, v6, v7
  v_cvt_pk_bf16_f32 v136, v8, v9
  v_cvt_pk_bf16_f32 v137, v10, v11
  v_cvt_pk_bf16_f32 v138, v12, v13
  v_cvt_pk_bf16_f32 v139, v14, v15
  s_or_b32 s33, s30, s3
  s_cmp_eq_u32 s33, 0
  s_cselect_b32 s33, 0xf149f2ca, 0
  v_mov_b32 v232, s33
  v_cndmask_b32_e64 v120, v232, 0, s[44:45]
  v_cndmask_b32_e64 v121, v232, 0, s[46:47]
  v_and_b32 v122, 1, v104
  v_lshlrev_b32 v122, 4, v122
  s_waitcnt lgkmcnt(0)
  v_mfma_f32_16x16x32_bf16 v[216:219], v[148:151], v[132:135], 0
  v_mfma_f32_16x16x32_bf16 v[220:223], v[156:159], v[132:135], 0
  v_mfma_f32_16x16x32_bf16 v[224:227], v[152:155], v[136:139], 0
  v_mfma_f32_16x16x32_bf16 v[228:231], v[160:163], v[136:139], 0
  v_cvt_pk_bf16_f32 v174, v32, v33
  v_cvt_pk_bf16_f32 v175, v34, v35
  v_cvt_pk_bf16_f32 v180, v36, v37
  v_cvt_pk_bf16_f32 v181, v38, v39
  v_cvt_pk_bf16_f32 v186, v40, v41
  v_cvt_pk_bf16_f32 v187, v42, v43
  v_cvt_pk_bf16_f32 v192, v44, v45
  v_cvt_pk_bf16_f32 v193, v46, v47
  s_mov_b32 s40, 0x3e8293ee
  v_cndmask_b32_e64 v200, v200, v201, s[48:49]
  v_cndmask_b32_e64 v202, v202, v203, s[48:49]
  v_cndmask_b32_e64 v204, v204, v205, s[48:49]
  v_cndmask_b32_e64 v206, v206, v207, s[48:49]
  v_cndmask_b32_e64 v208, v208, v209, s[48:49]
  v_cndmask_b32_e64 v210, v210, v211, s[48:49]
  v_cndmask_b32_e64 v212, v212, v213, s[48:49]
  v_cndmask_b32_e64 v214, v214, v215, s[48:49]
  v_cndmask_b32_e64 v216, v216, v217, s[48:49]
  v_cndmask_b32_e64 v218, v218, v219, s[48:49]
  v_cndmask_b32_e64 v220, v220, v221, s[48:49]
  v_cndmask_b32_e64 v222, v222, v223, s[48:49]
  v_cndmask_b32_e64 v224, v224, v225, s[48:49]
  v_cndmask_b32_e64 v226, v226, v227, s[48:49]
  v_cndmask_b32_e64 v228, v228, v229, s[48:49]
  v_cndmask_b32_e64 v230, v230, v231, s[48:49]
  v_cndmask_b32_e64 v200, v200, v204, s[44:45]
  v_cndmask_b32_e64 v201, v202, v206, s[46:47]
  v_cndmask_b32_e64 v208, v208, v212, s[44:45]
  v_cndmask_b32_e64 v209, v210, v214, s[46:47]
  v_cndmask_b32_e64 v216, v216, v220, s[44:45]
  v_cndmask_b32_e64 v217, v218, v222, s[46:47]
  v_cndmask_b32_e64 v224, v224, v228, s[44:45]
  v_cndmask_b32_e64 v225, v226, v230, s[46:47]
  v_mul_f32 v200, s40, v200
  v_mul_f32 v201, s40, v201
  v_mul_f32 v208, s40, v208
  v_mul_f32 v209, s40, v209
  v_fma_f32 v216, v216, s40, v120
  v_fma_f32 v217, v217, s40, v121
  v_fma_f32 v224, v224, s40, v120
  v_fma_f32 v225, v225, s40, v121
  v_max_f32 v232, v200, v201
  v_max_f32 v233, v208, v209
  v_max_f32 v234, v216, v217
  v_max_f32 v235, v224, v225
  v_mov_b32 v236, v232
  v_mov_b32 v237, v233
  v_mov_b32 v238, v234
  v_mov_b32 v239, v235
  s_nop 1
  v_permlane16_swap_b32 v236, v232
  v_permlane16_swap_b32 v237, v233
  v_permlane16_swap_b32 v238, v234
  v_permlane16_swap_b32 v239, v235
  s_nop 1
  v_max_f32 v232, v232, v236
  v_max_f32 v233, v233, v237
  v_max_f32 v234, v234, v238
  v_max_f32 v235, v235, v239
  v_mov_b32 v236, v232
  v_mov_b32 v237, v233
  v_mov_b32 v238, v234
  v_mov_b32 v239, v235
  s_nop 1
  v_permlane32_swap_b32 v236, v232
  v_permlane32_swap_b32 v237, v233
  v_permlane32_swap_b32 v238, v234
  v_permlane32_swap_b32 v239, v235
  s_nop 1
  v_max_f32 v232, v232, v236
  v_max_f32 v233, v233, v237
  v_max_f32 v234, v234, v238
  v_max_f32 v235, v235, v239
  v_sub_f32 v200, v200, v232
  v_sub_f32 v201, v201, v232
  v_sub_f32 v208, v208, v233
  v_sub_f32 v209, v209, v233
  v_sub_f32 v216, v216, v234
  v_sub_f32 v217, v217, v234
  v_sub_f32 v224, v224, v235
  v_sub_f32 v225, v225, v235
  v_exp_f32 v200, v200
  v_exp_f32 v201, v201
  v_exp_f32 v208, v208
  v_exp_f32 v209, v209
  v_exp_f32 v216, v216
  v_exp_f32 v217, v217
  v_exp_f32 v224, v224
  v_exp_f32 v225, v225
  s_nop 0
  v_add_f32 v232, v200, v201
  v_add_f32 v233, v208, v209
  v_add_f32 v234, v216, v217
  v_add_f32 v235, v224, v225
  v_mov_b32 v236, v232
  v_mov_b32 v237, v233
  v_mov_b32 v238, v234
  v_mov_b32 v239, v235
  s_nop 1
  v_permlane16_swap_b32 v236, v232
  v_permlane16_swap_b32 v237, v233
  v_permlane16_swap_b32 v238, v234
  v_permlane16_swap_b32 v239, v235
  s_nop 1
  v_add_f32 v232, v232, v236
  v_add_f32 v233, v233, v237
  v_add_f32 v234, v234, v238
  v_add_f32 v235, v235, v239
  v_mov_b32 v236, v232
  v_mov_b32 v237, v233
  v_mov_b32 v238, v234
  v_mov_b32 v239, v235
  s_nop 1
  v_permlane32_swap_b32 v236, v232
  v_permlane32_swap_b32 v237, v233
  v_permlane32_swap_b32 v238, v234
  v_permlane32_swap_b32 v239, v235
  s_nop 1
  v_add_f32 v232, v232, v236
  v_add_f32 v233, v233, v237
  v_add_f32 v234, v234, v238
  v_add_f32 v235, v235, v239
  v_rcp_f32 v232, v232
  v_rcp_f32 v233, v233
  v_rcp_f32 v234, v234
  v_rcp_f32 v235, v235
  s_nop 0
  v_mul_f32 v200, v200, v232
  v_mul_f32 v201, v201, v232
  v_mul_f32 v208, v208, v233
  v_mul_f32 v209, v209, v233
  v_mul_f32 v216, v216, v234
  v_mul_f32 v217, v217, v234
  v_mul_f32 v224, v224, v235
  v_mul_f32 v225, v225, v235
  v_cvt_pk_bf16_f32 v200, v200, 0
  v_cvt_pk_bf16_f32 v201, v201, 0
  v_cvt_pk_bf16_f32 v208, v208, 0
  v_cvt_pk_bf16_f32 v209, v209, 0
  v_cvt_pk_bf16_f32 v216, v216, 0
  v_cvt_pk_bf16_f32 v217, v217, 0
  v_cvt_pk_bf16_f32 v224, v224, 0
  v_cvt_pk_bf16_f32 v225, v225, 0
  v_lshlrev_b32 v200, v122, v200
  v_lshlrev_b32 v201, v122, v201
  v_lshlrev_b32 v208, v122, v208
  v_lshlrev_b32 v209, v122, v209
  v_lshlrev_b32 v216, v122, v216
  v_lshlrev_b32 v217, v122, v217
  v_lshlrev_b32 v224, v122, v224
  v_lshlrev_b32 v225, v122, v225
  v_cndmask_b32_e64 v132, v200, 0, s[44:45]
  v_cndmask_b32_e64 v134, 0, v200, s[44:45]
  v_cndmask_b32_e64 v133, v201, 0, s[46:47]
  v_cndmask_b32_e64 v135, 0, v201, s[46:47]
  v_cndmask_b32_e64 v136, v208, 0, s[44:45]
  v_cndmask_b32_e64 v138, 0, v208, s[44:45]
  v_cndmask_b32_e64 v137, v209, 0, s[46:47]
  v_cndmask_b32_e64 v139, 0, v209, s[46:47]
  v_cndmask_b32_e64 v140, v216, 0, s[44:45]
  v_cndmask_b32_e64 v142, 0, v216, s[44:45]
  v_cndmask_b32_e64 v141, v217, 0, s[46:47]
  v_cndmask_b32_e64 v143, 0, v217, s[46:47]
  v_cndmask_b32_e64 v144, v224, 0, s[44:45]
  v_cndmask_b32_e64 v146, 0, v224, s[44:45]
  v_cndmask_b32_e64 v145, v225, 0, s[46:47]
  v_cndmask_b32_e64 v147, 0, v225, s[46:47]
  s_nop 1
  v_mfma_f32_16x16x32_bf16 v[200:203], v[174:177], v[132:135], 0
  v_mfma_f32_16x16x32_bf16 v[204:207], v[180:183], v[132:135], 0
  v_mfma_f32_16x16x32_bf16 v[208:211], v[186:189], v[136:139], 0
  v_mfma_f32_16x16x32_bf16 v[212:215], v[192:195], v[136:139], 0
  v_mfma_f32_16x16x32_bf16 v[216:219], v[172:175], v[140:143], 0
  v_mfma_f32_16x16x32_bf16 v[220:223], v[178:181], v[140:143], 0
  v_mfma_f32_16x16x32_bf16 v[224:227], v[184:187], v[144:147], 0
  v_mfma_f32_16x16x32_bf16 v[228:231], v[190:193], v[144:147], 0
  s_lshl_b32 s41, s31, 18
  s_add_u32 s42, s41, 131072
  s_nop 1
  v_cvt_pk_bf16_f32 v148, v200, v201
  v_cvt_pk_bf16_f32 v149, v202, v203
  v_cvt_pk_bf16_f32 v150, v204, v205
  v_cvt_pk_bf16_f32 v151, v206, v207
  buffer_store_dwordx4 v[148:151], v105, s[4:7], s41 offen offset:1024 sc1
  v_cvt_pk_bf16_f32 v152, v208, v209
  v_cvt_pk_bf16_f32 v153, v210, v211
  v_cvt_pk_bf16_f32 v154, v212, v213
  v_cvt_pk_bf16_f32 v155, v214, v215
  buffer_store_dwordx4 v[152:155], v105, s[4:7], s42 offen offset:1024 sc1
  v_cvt_pk_bf16_f32 v156, v216, v217
  v_cvt_pk_bf16_f32 v157, v218, v219
  v_cvt_pk_bf16_f32 v158, v220, v221
  v_cvt_pk_bf16_f32 v159, v222, v223
  buffer_store_dwordx4 v[156:159], v105, s[4:7], s41 offen offset:0 sc1
  s_nop 0
  v_cvt_pk_bf16_f32 v160, v224, v225
  v_cvt_pk_bf16_f32 v161, v226, v227
  v_cvt_pk_bf16_f32 v162, v228, v229
  v_cvt_pk_bf16_f32 v163, v230, v231
  buffer_store_dwordx4 v[160:163], v105, s[4:7], s42 offen offset:0 sc1
  s_lshl_b32 s69, s30, 2
  s_add_u32 s69, s69, s3
  s_lshl_b32 s69, s69, 4
  s_add_u32 s69, s69, s31
  s_add_u32 s69, s69, 1024
  s_lshl_b32 s69, s69, 6
  s_mov_b32 s30, s36
  s_mov_b32 s31, s37
  s_mov_b32 s49, s98
  v_mov_b32 v32, v104
  v_mov_b32 v231, v104
  v_mov_b32 v43, v128
  v_and_b32 v44, 15, v32
  s_lshl_b32 s32, s30, 13
  s_lshl_b32 s33, s3, 11
  s_add_u32 s32, s32, s33
  v_lshlrev_b32 v80, 4, v32
  v_add_u32 v33, s32, v80
  v_add_u32 v34, 131072, v33
  s_lshl_b32 s16, s98, 1
  s_lshl_b32 s32, s30, 2
  s_add_u32 s32, s32, s3
  s_lshl_b32 s32, s32, 4
  s_add_u32 s32, s32, 1024
  v_add_u32 v45, s32, v44
  v_lshlrev_b32 v45, 6, v45
  v_mov_b32 v158, s19
  v_mov_b32 v159, s19
  v_lshlrev_b32 v46, 2, v32
  s_bfe_u32 s44, s19, 0x80000
  s_bfe_u32 s45, s19, 0x80008
  s_bfe_u32 s46, s19, 0x80010
  s_bfe_u32 s47, s19, 0x80018
  s_mov_b32 s92, s30
  s_mov_b32 s93, s31
  s_and_b32 s28, s2, 7
  s_lshr_b32 s29, s2, 3
  s_lshr_b32 s30, s28, 2
  s_xor_b32 s30, s30, 1
  s_lshl_b32 s30, s30, 2
  s_and_b32 s31, s29, 3
  s_add_u32 s30, s30, s31
  s_and_b32 s31, s28, 3
  s_lshl_b32 s31, s31, 3
  s_lshr_b32 s29, s29, 2
  s_add_u32 s31, s31, s29
  s_lshl_b32 s32, s30, 14
  s_lshl_b32 s33, s3, 12
  s_add_u32 s32, s32, s33
  v_lshlrev_b32 v224, 4, v231
  v_add_u32 v224, s32, v224
  s_and_b32 s33, s3, 1
  s_mul_i32 s34, s33, 114688
  s_mul_i32 s35, s31, 224
  s_add_u32 s34, s34, s35
  s_movk_i32 s36, 4682
  s_movk_i32 s37, 7168
  s_and_b32 s39, s31, 1
  s_lshl_b32 s39, s39, 1
  v_add_u32 v234, 0, v231
  v_mul_u32_u24 v235, s36, v234
  v_lshrrev_b32 v235, 16, v235
  v_mul_u32_u24 v236, 14, v235
  v_sub_u32 v236, v234, v236
  v_add_u32 v236, s39, v236
  v_subrev_u32 v237, 14, v236
  v_min_u32 v236, v236, v237
  v_mul_u32_u24 v235, s37, v235
  v_lshl_add_u32 v235, v236, 4, v235
  v_add_u32 v235, s34, v235
  v_subrev_u32 v225, 0, v235
  v_add_u32 v234, 64, v231
  v_mul_u32_u24 v235, s36, v234
  v_lshrrev_b32 v235, 16, v235
  v_mul_u32_u24 v236, 14, v235
  v_sub_u32 v236, v234, v236
  v_add_u32 v236, s39, v236
  v_subrev_u32 v237, 14, v236
  v_min_u32 v236, v236, v237
  v_mul_u32_u24 v235, s37, v235
  v_lshl_add_u32 v235, v236, 4, v235
  v_add_u32 v235, s34, v235
  v_subrev_u32 v226, 1024, v235
  v_add_u32 v234, 128, v231
  v_mul_u32_u24 v235, s36, v234
  v_lshrrev_b32 v235, 16, v235
  v_mul_u32_u24 v236, 14, v235
  v_sub_u32 v236, v234, v236
  v_add_u32 v236, s39, v236
  v_subrev_u32 v237, 14, v236
  v_min_u32 v236, v236, v237
  v_mul_u32_u24 v235, s37, v235
  v_lshl_add_u32 v235, v236, 4, v235
  v_add_u32 v235, s34, v235
  v_subrev_u32 v227, 2048, v235
  v_add_u32 v234, 192, v231
  v_mul_u32_u24 v235, s36, v234
  v_lshrrev_b32 v235, 16, v235
  v_mul_u32_u24 v236, 14, v235
  v_sub_u32 v236, v234, v236
  v_add_u32 v236, s39, v236
  v_subrev_u32 v237, 14, v236
  v_min_u32 v236, v236, v237
  v_mul_u32_u24 v235, s37, v235
  v_lshl_add_u32 v235, v236, 4, v235
  v_add_u32 v235, s34, v235
  v_subrev_u32 v228, 3072, v235
  s_mov_b32 s94, s30
  s_mov_b32 s95, s31
  s_mov_b32 s30, s92
  s_mov_b32 s31, s93
  s_mul_i32 s38, s3, 3584
  s_add_u32 s38, s38, 98304
  s_bfe_u32 s33, s2, 0x20003
  s_mul_i32 s17, s33, 229376
  s_cmp_eq_u32 s33, 3
  s_cselect_b32 s96, -3, 1
  s_mul_i32 s96, s96, 229376
  s_cmp_eq_u32 s33, 2
  s_cselect_b32 s97, -3, 1
  s_mul_i32 s97, s97, 229376
  s_cmp_eq_u32 s33, 1
  s_cselect_b32 s98, -3, 1
  s_mul_i32 s98, s98, 229376
  s_cmp_eq_u32 s33, 0
  s_cselect_b32 s99, 1, 5
  s_mul_i32 s99, s99, 229376
  s_cmp_lt_u32 s3, 2
  s_cselect_b32 s8, s60, s62
  s_cselect_b32 s9, s61, s63
  s_mov_b32 s10, 7340032
  s_mov_b32 s11, 0x20000
  s_waitcnt vmcnt(0)
  s_mov_b64 exec, 1
  buffer_store_dword v158, v46, s[64:67], s69 offen sc1
  s_mov_b64 exec, -1
  s_add_u32 m0, s51, 73728
  s_add_u32 s50, s49, 1179648
  s_bitset0_b32 s50, 21
  buffer_load_dwordx4 v248, s[52:55], s50 offen lds
  buffer_load_dwordx4 v249, s[52:55], s50 offen offset:1024 lds
  s_add_u32 m0, s51, 81920
  s_add_u32 s50, s49, 1310720
  s_bitset0_b32 s50, 21
  buffer_load_dwordx4 v248, s[52:55], s50 offen lds
  buffer_load_dwordx4 v249, s[52:55], s50 offen offset:1024 lds
  s_add_u32 m0, s51, 90112
  s_add_u32 s50, s49, 1441792
  s_bitset0_b32 s50, 21
  buffer_load_dwordx4 v248, s[52:55], s50 offen lds
  buffer_load_dwordx4 v249, s[52:55], s50 offen offset:1024 lds
  s_add_u32 m0, s51, 98304
  s_add_u32 s50, s49, 1572864
  s_bitset0_b32 s50, 21
  buffer_load_dwordx4 v248, s[52:55], s50 offen lds
  buffer_load_dwordx4 v249, s[52:55], s50 offen offset:1024 lds
  v_xor_b32 v168, s44, v250
  v_xor_b32 v169, s45, v251
  v_xor_b32 v170, s46, v252
  v_xor_b32 v171, s47, v253
  v_or3_b32 v172, v168, v169, v170
  v_or_b32 v172, v172, v171
  v_and_b32 v172, 0xff, v172
  v_cmp_ne_u32 vcc, 0, v172
  s_nop 1
  s_cmp_lg_u64 vcc, 0
  s_cbranch_scc1 L_vslow_11
L_vback_12:
  v_mov_b32 v172, v168
  v_mov_b32 v173, v169
  v_mov_b32 v174, v170
  v_mov_b32 v175, v171
  s_nop 1
  v_permlane16_swap_b32 v172, v168
  v_permlane16_swap_b32 v173, v169
  v_permlane16_swap_b32 v174, v170
  v_permlane16_swap_b32 v175, v171
  s_nop 1
  v_add_f32 v168, v168, v172
  v_add_f32 v169, v169, v173
  v_add_f32 v170, v170, v174
  v_add_f32 v171, v171, v175
  v_mov_b32 v172, v168
  v_mov_b32 v173, v169
  v_mov_b32 v174, v170
  v_mov_b32 v175, v171
  s_nop 1
  v_permlane32_swap_b32 v172, v168
  v_permlane32_swap_b32 v173, v169
  v_permlane32_swap_b32 v174, v170
  v_permlane32_swap_b32 v175, v171
  s_nop 1
  v_add_f32 v168, v168, v172
  v_add_f32 v169, v169, v173
  v_add_f32 v170, v170, v174
  v_add_f32 v171, v171, v175
  v_cvt_pk_bf16_f32 v172, v168, v169
  v_lshlrev_b32 v168, 16, v172
  v_and_b32 v169, 0xffff0000, v172
  v_cvt_pk_bf16_f32 v173, v170, v171
  v_lshlrev_b32 v170, 16, v173
  v_and_b32 v171, 0xffff0000, v173
  s_cmp_eq_u32 s3, 2
  s_cselect_b32 s33, 1.0, 0
  v_add_f32 v168, s33, v168
  v_add_f32 v169, s33, v169
  v_add_f32 v170, s33, v170
  v_add_f32 v171, s33, v171
  v_cvt_pk_bf16_f32 v172, v168, v169
  v_lshlrev_b32 v168, 16, v172
  v_and_b32 v169, 0xffff0000, v172
  v_cvt_pk_bf16_f32 v173, v170, v171
  v_lshlrev_b32 v170, 16, v173
  v_and_b32 v171, 0xffff0000, v173
  v_lshlrev_b32 v172, 4, v44
  s_lshl_b32 s33, s3, 8
  s_add_u32 s33, s33, 162816
  v_add_u32 v172, s33, v172
  ds_write_b128 v172, v[168:171]
  v_lshrrev_b32 v82, 2, v32
  v_lshlrev_b32 v82, 7, v82
  v_bfe_u32 v81, v32, 3, 2
  v_lshl_add_u32 v82, v81, 5, v82
  v_and_b32 v81, 3, v32
  v_lshl_add_u32 v35, v81, 3, v82
  v_xor_b32 v36, 32, v35
  v_xor_b32 v37, 64, v35
  v_xor_b32 v38, 96, v35
  v_add_u32 v39, 65536, v35
  v_add_u32 v40, 65536, v36
  v_add_u32 v41, 65536, v37
  v_add_u32 v42, 65536, v38
  v_lshrrev_b32 v47, 4, v32
  v_lshlrev_b32 v46, 4, v47
  v_add_u32 v253, 162816, v46
  s_waitcnt vmcnt(0) lgkmcnt(0)
  s_waitcnt vmcnt(63)
  s_barrier
  ds_read_b64_tr_b16 v[88:89], v35 offset:0
  ds_read_b64_tr_b16 v[90:91], v35 offset:2048
  ds_read_b64_tr_b16 v[104:105], v35 offset:4096
  ds_read_b64_tr_b16 v[106:107], v35 offset:6144
  ds_read_b64_tr_b16 v[92:93], v36 offset:0
  ds_read_b64_tr_b16 v[94:95], v36 offset:2048
  ds_read_b64_tr_b16 v[108:109], v36 offset:4096
  ds_read_b64_tr_b16 v[110:111], v36 offset:6144
  ds_read_b64_tr_b16 v[96:97], v37 offset:0
  ds_read_b64_tr_b16 v[98:99], v37 offset:2048
  ds_read_b64_tr_b16 v[112:113], v37 offset:4096
  ds_read_b64_tr_b16 v[114:115], v37 offset:6144
  ds_read_b64_tr_b16 v[100:101], v38 offset:0
  ds_read_b64_tr_b16 v[102:103], v38 offset:2048
  ds_read_b64_tr_b16 v[116:117], v38 offset:4096
  ds_read_b64_tr_b16 v[118:119], v38 offset:6144
  ds_read_b128 v[64:67], v253 offset:0
  ds_read_b128 v[68:71], v253 offset:64
  ds_read_b128 v[72:75], v253 offset:128
  ds_read_b128 v[76:79], v253 offset:192
  ds_read_b128 v[168:171], v253 offset:256
  ds_read_b128 v[172:175], v253 offset:320
  ds_read_b128 v[176:179], v253 offset:384
  ds_read_b128 v[180:183], v253 offset:448
  ds_read_b128 v[184:187], v253 offset:512
  ds_read_b128 v[188:191], v253 offset:576
  ds_read_b128 v[192:195], v253 offset:640
  ds_read_b128 v[196:199], v253 offset:704
  buffer_load_dword v87, v45, s[64:67], 0 offen sc1
  v_mov_b32 v252, v43
  v_accvgpr_read_b32 v48, a240
  v_accvgpr_read_b32 v49, a241
  v_accvgpr_read_b32 v50, a242
  v_accvgpr_read_b32 v51, a243
  v_accvgpr_read_b32 v52, a244
  v_accvgpr_read_b32 v53, a245
  v_accvgpr_read_b32 v54, a246
  v_accvgpr_read_b32 v55, a247
  v_accvgpr_read_b32 v56, a248
  v_accvgpr_read_b32 v57, a249
  v_accvgpr_read_b32 v58, a250
  v_accvgpr_read_b32 v59, a251
  v_accvgpr_read_b32 v60, a252
  v_accvgpr_read_b32 v61, a253
  v_accvgpr_read_b32 v62, a254
  v_accvgpr_read_b32 v63, a255
  s_lshl_b32 s41, s31, 18
  s_add_u32 s42, s41, 131072
  v_permlane16_swap_b32 v48, v50
  v_permlane16_swap_b32 v49, v51
  v_permlane16_swap_b32 v52, v54
  v_permlane16_swap_b32 v53, v55
  v_permlane16_swap_b32 v56, v58
  v_permlane16_swap_b32 v57, v59
  v_permlane16_swap_b32 v60, v62
  v_permlane16_swap_b32 v61, v63
  v_lshlrev_b32 v120, 16, v48
  v_and_b32 v121, 0xffff0000, v48
  v_lshlrev_b32 v122, 16, v49
  v_and_b32 v123, 0xffff0000, v49
  v_lshlrev_b32 v124, 16, v50
  v_and_b32 v125, 0xffff0000, v50
  v_lshlrev_b32 v126, 16, v51
  v_and_b32 v127, 0xffff0000, v51
  v_lshlrev_b32 v128, 16, v52
  v_and_b32 v129, 0xffff0000, v52
  v_lshlrev_b32 v130, 16, v53
  v_and_b32 v131, 0xffff0000, v53
  v_lshlrev_b32 v132, 16, v54
  v_and_b32 v133, 0xffff0000, v54
  v_lshlrev_b32 v134, 16, v55
  v_and_b32 v135, 0xffff0000, v55
  v_lshlrev_b32 v136, 16, v56
  v_and_b32 v137, 0xffff0000, v56
  v_lshlrev_b32 v138, 16, v57
  v_and_b32 v139, 0xffff0000, v57
  v_lshlrev_b32 v140, 16, v58
  v_and_b32 v141, 0xffff0000, v58
  v_lshlrev_b32 v142, 16, v59
  v_and_b32 v143, 0xffff0000, v59
  v_lshlrev_b32 v144, 16, v60
  v_and_b32 v145, 0xffff0000, v60
  v_lshlrev_b32 v146, 16, v61
  v_and_b32 v147, 0xffff0000, v61
  v_lshlrev_b32 v148, 16, v62
  v_and_b32 v149, 0xffff0000, v62
  v_lshlrev_b32 v150, 16, v63
  v_and_b32 v151, 0xffff0000, v63
  s_add_u32 s52, s20, 0x180000
  s_addc_u32 s53, s21, 0
  s_mov_b32 s54, 0x80000
  s_mov_b32 s55, 0x20000
  s_lshl2_add_u32 s56, s30, s3
  s_lshl_b32 s56, s56, 12
  s_lshl_b32 s57, s31, 8
  s_add_u32 s57, s57, s56
  v_mov_b32 v81, 0xffffff00
  v_mov_b32 v216, 0x3e003e00
  v_mov_b32 v217, 0x3e003e00
  v_mov_b32 v218, 0x3e003e00
  v_mov_b32 v219, 0x3e003e00
  v_lshrrev_b32 v83, 2, v44
  v_xor_b32 v83, v83, v47
  v_lshlrev_b32 v83, 24, v83
  v_lshl_add_u32 v83, v44, 4, v83
  v_and_b32 v84, 1, v32
  v_cmp_ne_u32 s[34:35], 0, v84
  v_and_b32 v84, 2, v32
  v_cmp_ne_u32 s[36:37], 0, v84
  s_mov_b32 s33, 262144
L_spin_15:
  s_waitcnt vmcnt(0)
  v_cmp_ne_u32 vcc, s19, v87
  s_nop 1
  s_and_b32 s32, vcc_lo, 0xffff
  s_cbranch_scc0 L_rdy_16
  buffer_load_dword v87, v45, s[64:67], 0 offen sc1
  s_sub_u32 s33, s33, 1
  s_cmp_lg_u32 s33, 0
  s_cbranch_scc1 L_spin_15
L_rdy_16:
  buffer_load_dwordx4 a[0:3], v33, s[4:7], s16 offen offset:0 sc1
  buffer_load_dwordx4 a[4:7], v33, s[4:7], s16 offen offset:1024 sc1
  buffer_load_dwordx4 a[8:11], v34, s[4:7], s16 offen offset:0 sc1
  buffer_load_dwordx4 a[12:15], v34, s[4:7], s16 offen offset:1024 sc1
  s_add_u32 s16, s16, 262144
  s_bitset0_b32 s16, 22
  buffer_load_dwordx4 a[16:19], v33, s[4:7], s16 offen offset:0 sc1
  buffer_load_dwordx4 a[20:23], v33, s[4:7], s16 offen offset:1024 sc1
  buffer_load_dwordx4 a[24:27], v34, s[4:7], s16 offen offset:0 sc1
  buffer_load_dwordx4 a[28:31], v34, s[4:7], s16 offen offset:1024 sc1
  s_add_u32 s16, s16, 262144
  s_bitset0_b32 s16, 22
  buffer_load_dwordx4 a[32:35], v33, s[4:7], s16 offen offset:0 sc1
  buffer_load_dwordx4 a[36:39], v33, s[4:7], s16 offen offset:1024 sc1
  buffer_load_dwordx4 a[40:43], v34, s[4:7], s16 offen offset:0 sc1
  buffer_load_dwordx4 a[44:47], v34, s[4:7], s16 offen offset:1024 sc1
  s_add_u32 s16, s16, 262144
  s_bitset0_b32 s16, 22
  buffer_load_dwordx4 a[48:51], v33, s[4:7], s16 offen offset:0 sc1
  buffer_load_dwordx4 a[52:55], v33, s[4:7], s16 offen offset:1024 sc1
  buffer_load_dwordx4 a[56:59], v34, s[4:7], s16 offen offset:0 sc1
  buffer_load_dwordx4 a[60:63], v34, s[4:7], s16 offen offset:1024 sc1
  s_add_u32 s16, s16, 262144
  s_bitset0_b32 s16, 22
  s_waitcnt vmcnt(12) lgkmcnt(10)
  v_mfma_f32_16x16x32_bf16 v[0:3], v[88:91], a[0:3], 0
  buffer_load_dwordx4 a[64:67], v33, s[4:7], s16 offen offset:0 sc1
  v_mfma_f32_16x16x32_bf16 v[0:3], v[104:107], a[8:11], v[0:3]
  v_mfma_f32_16x16x32_bf16 v[16:19], v[104:107], a[12:15], 0
  buffer_load_dwordx4 a[68:71], v33, s[4:7], s16 offen offset:1024 sc1
  v_mfma_f32_16x16x32_bf16 v[16:19], v[88:91], a[4:7], v[16:19]
  ds_read_b64_tr_b16 v[104:105], v35 offset:12288
  ds_read_b64_tr_b16 v[106:107], v35 offset:14336
  v_mfma_f32_16x16x32_bf16 v[20:23], v[92:95], a[4:7], 0
  ds_read_b64_tr_b16 v[88:89], v35 offset:8192
  ds_read_b64_tr_b16 v[90:91], v35 offset:10240
  v_mfma_f32_16x16x32_bf16 v[20:23], v[108:111], a[12:15], v[20:23]
  buffer_load_dwordx4 a[72:75], v34, s[4:7], s16 offen offset:0 sc1
  v_mfma_f32_16x16x32_bf16 v[4:7], v[108:111], a[8:11], 0
  ds_read_b64_tr_b16 v[108:109], v36 offset:12288
  ds_read_b64_tr_b16 v[110:111], v36 offset:14336
  v_mfma_f32_16x16x32_bf16 v[4:7], v[92:95], a[0:3], v[4:7]
  buffer_load_dwordx4 a[76:79], v34, s[4:7], s16 offen offset:1024 sc1
  v_mfma_f32_16x16x32_bf16 v[8:11], v[96:99], a[0:3], 0
  ds_read_b64_tr_b16 v[92:93], v36 offset:8192
  ds_read_b64_tr_b16 v[94:95], v36 offset:10240
  v_mfma_f32_16x16x32_bf16 v[8:11], v[112:115], a[8:11], v[8:11]
  v_mfma_f32_16x16x32_bf16 v[24:27], v[112:115], a[12:15], 0
  ds_read_b64_tr_b16 v[112:113], v37 offset:12288
  s_add_u32 s16, s16, 262144
  v_mfma_f32_16x16x32_bf16 v[24:27], v[96:99], a[4:7], v[24:27]
  ds_read_b64_tr_b16 v[114:115], v37 offset:14336
  ds_read_b64_tr_b16 v[96:97], v37 offset:8192
  v_mfma_f32_16x16x32_bf16 v[28:31], v[100:103], a[4:7], 0
  ds_read_b64_tr_b16 v[98:99], v37 offset:10240
  s_bitset0_b32 s16, 22
  v_mfma_f32_16x16x32_bf16 v[28:31], v[116:119], a[12:15], v[28:31]
  v_mfma_f32_16x16x32_bf16 v[12:15], v[116:119], a[8:11], 0
  ds_read_b64_tr_b16 v[116:117], v38 offset:12288
  ds_read_b64_tr_b16 v[118:119], v38 offset:14336
  v_mfma_f32_16x16x32_bf16 v[12:15], v[100:103], a[0:3], v[12:15]
  s_waitcnt vmcnt(12) lgkmcnt(10)
  ds_read_b64_tr_b16 v[100:101], v38 offset:8192
  v_mfma_f32_16x16x32_bf16 v[0:3], v[88:91], a[16:19], v[0:3]
  buffer_load_dwordx4 a[80:83], v33, s[4:7], s16 offen offset:0 sc1
  v_mfma_f32_16x16x32_bf16 v[0:3], v[104:107], a[24:27], v[0:3]
  ds_read_b64_tr_b16 v[102:103], v38 offset:10240
  v_mfma_f32_16x16x32_bf16 v[16:19], v[104:107], a[28:31], v[16:19]
  buffer_load_dwordx4 a[84:87], v33, s[4:7], s16 offen offset:1024 sc1
  v_mfma_f32_16x16x32_bf16 v[16:19], v[88:91], a[20:23], v[16:19]
  ds_read_b64_tr_b16 v[104:105], v35 offset:20480
  ds_read_b64_tr_b16 v[106:107], v35 offset:22528
  s_waitcnt lgkmcnt(10)
  v_mfma_f32_16x16x32_bf16 v[20:23], v[92:95], a[20:23], v[20:23]
  ds_read_b64_tr_b16 v[88:89], v35 offset:16384
  ds_read_b64_tr_b16 v[90:91], v35 offset:18432
  v_mfma_f32_16x16x32_bf16 v[20:23], v[108:111], a[28:31], v[20:23]
  buffer_load_dwordx4 a[88:91], v34, s[4:7], s16 offen offset:0 sc1
  v_mfma_f32_16x16x32_bf16 v[4:7], v[108:111], a[24:27], v[4:7]
  ds_read_b64_tr_b16 v[108:109], v36 offset:20480
  ds_read_b64_tr_b16 v[110:111], v36 offset:22528
  v_mfma_f32_16x16x32_bf16 v[4:7], v[92:95], a[16:19], v[4:7]
  buffer_load_dwordx4 a[92:95], v34, s[4:7], s16 offen offset:1024 sc1
  s_waitcnt lgkmcnt(10)
  v_mfma_f32_16x16x32_bf16 v[8:11], v[96:99], a[16:19], v[8:11]
  ds_read_b64_tr_b16 v[92:93], v36 offset:16384
  ds_read_b64_tr_b16 v[94:95], v36 offset:18432
  v_mfma_f32_16x16x32_bf16 v[8:11], v[112:115], a[24:27], v[8:11]
  v_mfma_f32_16x16x32_bf16 v[24:27], v[112:115], a[28:31], v[24:27]
  ds_read_b64_tr_b16 v[112:113], v37 offset:20480
  s_add_u32 s16, s16, 262144
  v_mfma_f32_16x16x32_bf16 v[24:27], v[96:99], a[20:23], v[24:27]
  ds_read_b64_tr_b16 v[114:115], v37 offset:22528
  ds_read_b64_tr_b16 v[96:97], v37 offset:16384
  s_waitcnt lgkmcnt(10)
  v_mfma_f32_16x16x32_bf16 v[28:31], v[100:103], a[20:23], v[28:31]
  ds_read_b64_tr_b16 v[98:99], v37 offset:18432
  s_bitset0_b32 s16, 22
  v_mfma_f32_16x16x32_bf16 v[28:31], v[116:119], a[28:31], v[28:31]
  v_mfma_f32_16x16x32_bf16 v[12:15], v[116:119], a[24:27], v[12:15]
  ds_read_b64_tr_b16 v[116:117], v38 offset:20480
  ds_read_b64_tr_b16 v[118:119], v38 offset:22528
  v_mfma_f32_16x16x32_bf16 v[12:15], v[100:103], a[16:19], v[12:15]
  s_waitcnt vmcnt(12) lgkmcnt(10)
  ds_read_b64_tr_b16 v[100:101], v38 offset:16384
  v_mfma_f32_16x16x32_bf16 v[0:3], v[88:91], a[32:35], v[0:3]
  buffer_load_dwordx4 a[96:99], v33, s[4:7], s16 offen offset:0 sc1
  v_mfma_f32_16x16x32_bf16 v[0:3], v[104:107], a[40:43], v[0:3]
  ds_read_b64_tr_b16 v[102:103], v38 offset:18432
  v_mfma_f32_16x16x32_bf16 v[16:19], v[104:107], a[44:47], v[16:19]
  buffer_load_dwordx4 a[100:103], v33, s[4:7], s16 offen offset:1024 sc1
  v_mfma_f32_16x16x32_bf16 v[16:19], v[88:91], a[36:39], v[16:19]
  ds_read_b64_tr_b16 v[104:105], v35 offset:28672
  ds_read_b64_tr_b16 v[106:107], v35 offset:30720
  s_waitcnt lgkmcnt(10)
  v_mfma_f32_16x16x32_bf16 v[20:23], v[92:95], a[36:39], v[20:23]
  ds_read_b64_tr_b16 v[88:89], v35 offset:24576
  ds_read_b64_tr_b16 v[90:91], v35 offset:26624
  v_mfma_f32_16x16x32_bf16 v[20:23], v[108:111], a[44:47], v[20:23]
  buffer_load_dwordx4 a[104:107], v34, s[4:7], s16 offen offset:0 sc1
  v_mfma_f32_16x16x32_bf16 v[4:7], v[108:111], a[40:43], v[4:7]
  ds_read_b64_tr_b16 v[108:109], v36 offset:28672
  ds_read_b64_tr_b16 v[110:111], v36 offset:30720
  v_mfma_f32_16x16x32_bf16 v[4:7], v[92:95], a[32:35], v[4:7]
  buffer_load_dwordx4 a[108:111], v34, s[4:7], s16 offen offset:1024 sc1
  s_waitcnt lgkmcnt(10)
  v_mfma_f32_16x16x32_bf16 v[8:11], v[96:99], a[32:35], v[8:11]
  ds_read_b64_tr_b16 v[92:93], v36 offset:24576
  ds_read_b64_tr_b16 v[94:95], v36 offset:26624
  v_mfma_f32_16x16x32_bf16 v[8:11], v[112:115], a[40:43], v[8:11]
  v_mfma_f32_16x16x32_bf16 v[24:27], v[112:115], a[44:47], v[24:27]
  ds_read_b64_tr_b16 v[112:113], v37 offset:28672
  s_add_u32 s16, s16, 262144
  v_mfma_f32_16x16x32_bf16 v[24:27], v[96:99], a[36:39], v[24:27]
  ds_read_b64_tr_b16 v[114:115], v37 offset:30720
  ds_read_b64_tr_b16 v[96:97], v37 offset:24576
  s_waitcnt lgkmcnt(10)
  v_mfma_f32_16x16x32_bf16 v[28:31], v[100:103], a[36:39], v[28:31]
  ds_read_b64_tr_b16 v[98:99], v37 offset:26624
  s_bitset0_b32 s16, 22
  v_mfma_f32_16x16x32_bf16 v[28:31], v[116:119], a[44:47], v[28:31]
  v_mfma_f32_16x16x32_bf16 v[12:15], v[116:119], a[40:43], v[12:15]
  ds_read_b64_tr_b16 v[116:117], v38 offset:28672
  ds_read_b64_tr_b16 v[118:119], v38 offset:30720
  v_mfma_f32_16x16x32_bf16 v[12:15], v[100:103], a[32:35], v[12:15]
  s_waitcnt vmcnt(12) lgkmcnt(10)
  ds_read_b64_tr_b16 v[100:101], v38 offset:24576
  v_mfma_f32_16x16x32_bf16 v[0:3], v[88:91], a[48:51], v[0:3]
  buffer_load_dwordx4 a[112:115], v33, s[4:7], s16 offen offset:0 sc1
  v_mfma_f32_16x16x32_bf16 v[0:3], v[104:107], a[56:59], v[0:3]
  ds_read_b64_tr_b16 v[102:103], v38 offset:26624
  v_mfma_f32_16x16x32_bf16 v[16:19], v[104:107], a[60:63], v[16:19]
  buffer_load_dwordx4 a[116:119], v33, s[4:7], s16 offen offset:1024 sc1
  v_mfma_f32_16x16x32_bf16 v[16:19], v[88:91], a[52:55], v[16:19]
  ds_read_b64_tr_b16 v[104:105], v35 offset:36864
  ds_read_b64_tr_b16 v[106:107], v35 offset:38912
  s_waitcnt lgkmcnt(10)
  v_mfma_f32_16x16x32_bf16 v[20:23], v[92:95], a[52:55], v[20:23]
  ds_read_b64_tr_b16 v[88:89], v35 offset:32768
  ds_read_b64_tr_b16 v[90:91], v35 offset:34816
  v_mfma_f32_16x16x32_bf16 v[20:23], v[108:111], a[60:63], v[20:23]
  buffer_load_dwordx4 a[120:123], v34, s[4:7], s16 offen offset:0 sc1
  v_mfma_f32_16x16x32_bf16 v[4:7], v[108:111], a[56:59], v[4:7]
  ds_read_b64_tr_b16 v[108:109], v36 offset:36864
  ds_read_b64_tr_b16 v[110:111], v36 offset:38912
  v_mfma_f32_16x16x32_bf16 v[4:7], v[92:95], a[48:51], v[4:7]
  buffer_load_dwordx4 a[124:127], v34, s[4:7], s16 offen offset:1024 sc1
  s_waitcnt lgkmcnt(10)
  v_mfma_f32_16x16x32_bf16 v[8:11], v[96:99], a[48:51], v[8:11]
  ds_read_b64_tr_b16 v[92:93], v36 offset:32768
  ds_read_b64_tr_b16 v[94:95], v36 offset:34816
  v_mfma_f32_16x16x32_bf16 v[8:11], v[112:115], a[56:59], v[8:11]
  v_mfma_f32_16x16x32_bf16 v[24:27], v[112:115], a[60:63], v[24:27]
  ds_read_b64_tr_b16 v[112:113], v37 offset:36864
  s_add_u32 s16, s16, 262144
  v_mfma_f32_16x16x32_bf16 v[24:27], v[96:99], a[52:55], v[24:27]
  ds_read_b64_tr_b16 v[114:115], v37 offset:38912
  ds_read_b64_tr_b16 v[96:97], v37 offset:32768
  s_waitcnt lgkmcnt(10)
  v_mfma_f32_16x16x32_bf16 v[28:31], v[100:103], a[52:55], v[28:31]
  ds_read_b64_tr_b16 v[98:99], v37 offset:34816
  s_bitset0_b32 s16, 22
  v_mfma_f32_16x16x32_bf16 v[28:31], v[116:119], a[60:63], v[28:31]
  v_mfma_f32_16x16x32_bf16 v[12:15], v[116:119], a[56:59], v[12:15]
  ds_read_b64_tr_b16 v[116:117], v38 offset:36864
  ds_read_b64_tr_b16 v[118:119], v38 offset:38912
  v_mfma_f32_16x16x32_bf16 v[12:15], v[100:103], a[48:51], v[12:15]
  s_waitcnt vmcnt(12) lgkmcnt(10)
  ds_read_b64_tr_b16 v[100:101], v38 offset:32768
  v_mfma_f32_16x16x32_bf16 v[0:3], v[88:91], a[64:67], v[0:3]
  buffer_load_dwordx4 a[0:3], v33, s[4:7], s16 offen offset:0 sc1
  v_mfma_f32_16x16x32_bf16 v[0:3], v[104:107], a[72:75], v[0:3]
  ds_read_b64_tr_b16 v[102:103], v38 offset:34816
  v_mfma_f32_16x16x32_bf16 v[16:19], v[104:107], a[76:79], v[16:19]
  buffer_load_dwordx4 a[4:7], v33, s[4:7], s16 offen offset:1024 sc1
  v_mfma_f32_16x16x32_bf16 v[16:19], v[88:91], a[68:71], v[16:19]
  ds_read_b64_tr_b16 v[104:105], v35 offset:45056
  ds_read_b64_tr_b16 v[106:107], v35 offset:47104
  s_waitcnt lgkmcnt(10)
  v_mfma_f32_16x16x32_bf16 v[20:23], v[92:95], a[68:71], v[20:23]
  ds_read_b64_tr_b16 v[88:89], v35 offset:40960
  ds_read_b64_tr_b16 v[90:91], v35 offset:43008
  v_mfma_f32_16x16x32_bf16 v[20:23], v[108:111], a[76:79], v[20:23]
  buffer_load_dwordx4 a[8:11], v34, s[4:7], s16 offen offset:0 sc1
  v_mfma_f32_16x16x32_bf16 v[4:7], v[108:111], a[72:75], v[4:7]
  ds_read_b64_tr_b16 v[108:109], v36 offset:45056
  ds_read_b64_tr_b16 v[110:111], v36 offset:47104
  v_mfma_f32_16x16x32_bf16 v[4:7], v[92:95], a[64:67], v[4:7]
  buffer_load_dwordx4 a[12:15], v34, s[4:7], s16 offen offset:1024 sc1
  s_waitcnt lgkmcnt(10)
  v_mfma_f32_16x16x32_bf16 v[8:11], v[96:99], a[64:67], v[8:11]
  ds_read_b64_tr_b16 v[92:93], v36 offset:40960
  ds_read_b64_tr_b16 v[94:95], v36 offset:43008
  v_mfma_f32_16x16x32_bf16 v[8:11], v[112:115], a[72:75], v[8:11]
  v_mfma_f32_16x16x32_bf16 v[24:27], v[112:115], a[76:79], v[24:27]
  ds_read_b64_tr_b16 v[112:113], v37 offset:45056
  s_add_u32 s16, s16, 262144
  v_mfma_f32_16x16x32_bf16 v[24:27], v[96:99], a[68:71], v[24:27]
  ds_read_b64_tr_b16 v[114:115], v37 offset:47104
  ds_read_b64_tr_b16 v[96:97], v37 offset:40960
  s_waitcnt lgkmcnt(10)
  v_mfma_f32_16x16x32_bf16 v[28:31], v[100:103], a[68:71], v[28:31]
  ds_read_b64_tr_b16 v[98:99], v37 offset:43008
  s_bitset0_b32 s16, 22
  v_mfma_f32_16x16x32_bf16 v[28:31], v[116:119], a[76:79], v[28:31]
  v_mfma_f32_16x16x32_bf16 v[12:15], v[116:119], a[72:75], v[12:15]
  ds_read_b64_tr_b16 v[116:117], v38 offset:45056
  ds_read_b64_tr_b16 v[118:119], v38 offset:47104
  v_mfma_f32_16x16x32_bf16 v[12:15], v[100:103], a[64:67], v[12:15]
  s_waitcnt vmcnt(12) lgkmcnt(10)
  ds_read_b64_tr_b16 v[100:101], v38 offset:40960
  v_mfma_f32_16x16x32_bf16 v[0:3], v[88:91], a[80:83], v[0:3]
  buffer_load_dwordx4 a[16:19], v33, s[4:7], s16 offen offset:0 sc1
  v_mfma_f32_16x16x32_bf16 v[0:3], v[104:107], a[88:91], v[0:3]
  ds_read_b64_tr_b16 v[102:103], v38 offset:43008
  v_mfma_f32_16x16x32_bf16 v[16:19], v[104:107], a[92:95], v[16:19]
  buffer_load_dwordx4 a[20:23], v33, s[4:7], s16 offen offset:1024 sc1
  v_mfma_f32_16x16x32_bf16 v[16:19], v[88:91], a[84:87], v[16:19]
  ds_read_b64_tr_b16 v[104:105], v35 offset:53248
  ds_read_b64_tr_b16 v[106:107], v35 offset:55296
  s_waitcnt lgkmcnt(10)
  v_mfma_f32_16x16x32_bf16 v[20:23], v[92:95], a[84:87], v[20:23]
  ds_read_b64_tr_b16 v[88:89], v35 offset:49152
  ds_read_b64_tr_b16 v[90:91], v35 offset:51200
  v_mfma_f32_16x16x32_bf16 v[20:23], v[108:111], a[92:95], v[20:23]
  buffer_load_dwordx4 a[24:27], v34, s[4:7], s16 offen offset:0 sc1
  v_mfma_f32_16x16x32_bf16 v[4:7], v[108:111], a[88:91], v[4:7]
  ds_read_b64_tr_b16 v[108:109], v36 offset:53248
  ds_read_b64_tr_b16 v[110:111], v36 offset:55296
  v_mfma_f32_16x16x32_bf16 v[4:7], v[92:95], a[80:83], v[4:7]
  buffer_load_dwordx4 a[28:31], v34, s[4:7], s16 offen offset:1024 sc1
  s_waitcnt lgkmcnt(10)
  v_mfma_f32_16x16x32_bf16 v[8:11], v[96:99], a[80:83], v[8:11]
  ds_read_b64_tr_b16 v[92:93], v36 offset:49152
  ds_read_b64_tr_b16 v[94:95], v36 offset:51200
  v_mfma_f32_16x16x32_bf16 v[8:11], v[112:115], a[88:91], v[8:11]
  v_mfma_f32_16x16x32_bf16 v[24:27], v[112:115], a[92:95], v[24:27]
  ds_read_b64_tr_b16 v[112:113], v37 offset:53248
  s_add_u32 s16, s16, 262144
  v_mfma_f32_16x16x32_bf16 v[24:27], v[96:99], a[84:87], v[24:27]
  ds_read_b64_tr_b16 v[114:115], v37 offset:55296
  ds_read_b64_tr_b16 v[96:97], v37 offset:49152
  s_waitcnt lgkmcnt(10)
  v_mfma_f32_16x16x32_bf16 v[28:31], v[100:103], a[84:87], v[28:31]
  ds_read_b64_tr_b16 v[98:99], v37 offset:51200
  s_bitset0_b32 s16, 22
  v_mfma_f32_16x16x32_bf16 v[28:31], v[116:119], a[92:95], v[28:31]
  v_mfma_f32_16x16x32_bf16 v[12:15], v[116:119], a[88:91], v[12:15]
  ds_read_b64_tr_b16 v[116:117], v38 offset:53248
  ds_read_b64_tr_b16 v[118:119], v38 offset:55296
  v_mfma_f32_16x16x32_bf16 v[12:15], v[100:103], a[80:83], v[12:15]
  s_waitcnt vmcnt(12) lgkmcnt(10)
  ds_read_b64_tr_b16 v[100:101], v38 offset:49152
  v_mfma_f32_16x16x32_bf16 v[0:3], v[88:91], a[96:99], v[0:3]
  buffer_load_dwordx4 a[32:35], v33, s[4:7], s16 offen offset:0 sc1
  v_mfma_f32_16x16x32_bf16 v[0:3], v[104:107], a[104:107], v[0:3]
  ds_read_b64_tr_b16 v[102:103], v38 offset:51200
  v_mfma_f32_16x16x32_bf16 v[16:19], v[104:107], a[108:111], v[16:19]
  buffer_load_dwordx4 a[36:39], v33, s[4:7], s16 offen offset:1024 sc1
  v_mfma_f32_16x16x32_bf16 v[16:19], v[88:91], a[100:103], v[16:19]
  ds_read_b64_tr_b16 v[104:105], v35 offset:61440
  ds_read_b64_tr_b16 v[106:107], v35 offset:63488
  s_waitcnt lgkmcnt(10)
  v_mfma_f32_16x16x32_bf16 v[20:23], v[92:95], a[100:103], v[20:23]
  ds_read_b64_tr_b16 v[88:89], v35 offset:57344
  ds_read_b64_tr_b16 v[90:91], v35 offset:59392
  v_mfma_f32_16x16x32_bf16 v[20:23], v[108:111], a[108:111], v[20:23]
  buffer_load_dwordx4 a[40:43], v34, s[4:7], s16 offen offset:0 sc1
  v_mfma_f32_16x16x32_bf16 v[4:7], v[108:111], a[104:107], v[4:7]
  ds_read_b64_tr_b16 v[108:109], v36 offset:61440
  ds_read_b64_tr_b16 v[110:111], v36 offset:63488
  v_mfma_f32_16x16x32_bf16 v[4:7], v[92:95], a[96:99], v[4:7]
  buffer_load_dwordx4 a[44:47], v34, s[4:7], s16 offen offset:1024 sc1
  s_waitcnt lgkmcnt(10)
  v_mfma_f32_16x16x32_bf16 v[8:11], v[96:99], a[96:99], v[8:11]
  ds_read_b64_tr_b16 v[92:93], v36 offset:57344
  ds_read_b64_tr_b16 v[94:95], v36 offset:59392
  v_mfma_f32_16x16x32_bf16 v[8:11], v[112:115], a[104:107], v[8:11]
  v_mfma_f32_16x16x32_bf16 v[24:27], v[112:115], a[108:111], v[24:27]
  ds_read_b64_tr_b16 v[112:113], v37 offset:61440
  s_add_u32 s16, s16, 262144
  v_mfma_f32_16x16x32_bf16 v[24:27], v[96:99], a[100:103], v[24:27]
  ds_read_b64_tr_b16 v[114:115], v37 offset:63488
  ds_read_b64_tr_b16 v[96:97], v37 offset:57344
  s_waitcnt lgkmcnt(10)
  v_mfma_f32_16x16x32_bf16 v[28:31], v[100:103], a[100:103], v[28:31]
  ds_read_b64_tr_b16 v[98:99], v37 offset:59392
  s_bitset0_b32 s16, 22
  v_mfma_f32_16x16x32_bf16 v[28:31], v[116:119], a[108:111], v[28:31]
  v_mfma_f32_16x16x32_bf16 v[12:15], v[116:119], a[104:107], v[12:15]
  ds_read_b64_tr_b16 v[116:117], v38 offset:61440
  ds_read_b64_tr_b16 v[118:119], v38 offset:63488
  v_mfma_f32_16x16x32_bf16 v[12:15], v[100:103], a[96:99], v[12:15]
  s_waitcnt vmcnt(12) lgkmcnt(10)
  ds_read_b64_tr_b16 v[100:101], v38 offset:57344
  v_mfma_f32_16x16x32_bf16 v[0:3], v[88:91], a[112:115], v[0:3]
  buffer_load_dwordx4 a[48:51], v33, s[4:7], s16 offen offset:0 sc1
  v_mfma_f32_16x16x32_bf16 v[0:3], v[104:107], a[120:123], v[0:3]
  ds_read_b64_tr_b16 v[102:103], v38 offset:59392
  v_mfma_f32_16x16x32_bf16 v[16:19], v[104:107], a[124:127], v[16:19]
  buffer_load_dwordx4 a[52:55], v33, s[4:7], s16 offen offset:1024 sc1
  v_mfma_f32_16x16x32_bf16 v[16:19], v[88:91], a[116:119], v[16:19]
  ds_read_b64_tr_b16 v[104:105], v39 offset:4096
  ds_read_b64_tr_b16 v[106:107], v39 offset:6144
  s_waitcnt lgkmcnt(10)
  v_mfma_f32_16x16x32_bf16 v[20:23], v[92:95], a[116:119], v[20:23]
  ds_read_b64_tr_b16 v[88:89], v39 offset:0
  ds_read_b64_tr_b16 v[90:91], v39 offset:2048
  v_mfma_f32_16x16x32_bf16 v[20:23], v[108:111], a[124:127], v[20:23]
  buffer_load_dwordx4 a[56:59], v34, s[4:7], s16 offen offset:0 sc1
  v_mfma_f32_16x16x32_bf16 v[4:7], v[108:111], a[120:123], v[4:7]
  ds_read_b64_tr_b16 v[108:109], v40 offset:4096
  ds_read_b64_tr_b16 v[110:111], v40 offset:6144
  v_mfma_f32_16x16x32_bf16 v[4:7], v[92:95], a[112:115], v[4:7]
  buffer_load_dwordx4 a[60:63], v34, s[4:7], s16 offen offset:1024 sc1
  s_waitcnt lgkmcnt(10)
  v_mfma_f32_16x16x32_bf16 v[8:11], v[96:99], a[112:115], v[8:11]
  ds_read_b64_tr_b16 v[92:93], v40 offset:0
  ds_read_b64_tr_b16 v[94:95], v40 offset:2048
  v_mfma_f32_16x16x32_bf16 v[8:11], v[112:115], a[120:123], v[8:11]
  v_mfma_f32_16x16x32_bf16 v[24:27], v[112:115], a[124:127], v[24:27]
  ds_read_b64_tr_b16 v[112:113], v41 offset:4096
  s_add_u32 s16, s16, 262144
  v_mfma_f32_16x16x32_bf16 v[24:27], v[96:99], a[116:119], v[24:27]
  ds_read_b64_tr_b16 v[114:115], v41 offset:6144
  ds_read_b64_tr_b16 v[96:97], v41 offset:0
  s_waitcnt lgkmcnt(10)
  v_mfma_f32_16x16x32_bf16 v[28:31], v[100:103], a[116:119], v[28:31]
  ds_read_b64_tr_b16 v[98:99], v41 offset:2048
  s_bitset0_b32 s16, 22
  v_mfma_f32_16x16x32_bf16 v[28:31], v[116:119], a[124:127], v[28:31]
  v_mfma_f32_16x16x32_bf16 v[12:15], v[116:119], a[120:123], v[12:15]
  ds_read_b64_tr_b16 v[116:117], v42 offset:4096
  ds_read_b64_tr_b16 v[118:119], v42 offset:6144
  v_mfma_f32_16x16x32_bf16 v[12:15], v[100:103], a[112:115], v[12:15]
  s_waitcnt vmcnt(12) lgkmcnt(10)
  ds_read_b64_tr_b16 v[100:101], v42 offset:0
  v_mfma_f32_16x16x32_bf16 v[0:3], v[88:91], a[0:3], v[0:3]
  buffer_load_dwordx4 a[64:67], v33, s[4:7], s16 offen offset:0 sc1
  v_mfma_f32_16x16x32_bf16 v[0:3], v[104:107], a[8:11], v[0:3]
  ds_read_b64_tr_b16 v[102:103], v42 offset:2048
  v_mfma_f32_16x16x32_bf16 v[16:19], v[104:107], a[12:15], v[16:19]
  buffer_load_dwordx4 a[68:71], v33, s[4:7], s16 offen offset:1024 sc1
  v_mfma_f32_16x16x32_bf16 v[16:19], v[88:91], a[4:7], v[16:19]
  ds_read_b64_tr_b16 v[104:105], v39 offset:12288
  ds_read_b64_tr_b16 v[106:107], v39 offset:14336
  s_waitcnt lgkmcnt(10)
  v_mfma_f32_16x16x32_bf16 v[20:23], v[92:95], a[4:7], v[20:23]
  ds_read_b64_tr_b16 v[88:89], v39 offset:8192
  ds_read_b64_tr_b16 v[90:91], v39 offset:10240
  v_mfma_f32_16x16x32_bf16 v[20:23], v[108:111], a[12:15], v[20:23]
  buffer_load_dwordx4 a[72:75], v34, s[4:7], s16 offen offset:0 sc1
  v_mfma_f32_16x16x32_bf16 v[4:7], v[108:111], a[8:11], v[4:7]
  ds_read_b64_tr_b16 v[108:109], v40 offset:12288
  ds_read_b64_tr_b16 v[110:111], v40 offset:14336
  v_mfma_f32_16x16x32_bf16 v[4:7], v[92:95], a[0:3], v[4:7]
  buffer_load_dwordx4 a[76:79], v34, s[4:7], s16 offen offset:1024 sc1
  s_waitcnt lgkmcnt(10)
  v_mfma_f32_16x16x32_bf16 v[8:11], v[96:99], a[0:3], v[8:11]
  ds_read_b64_tr_b16 v[92:93], v40 offset:8192
  ds_read_b64_tr_b16 v[94:95], v40 offset:10240
  v_mfma_f32_16x16x32_bf16 v[8:11], v[112:115], a[8:11], v[8:11]
  v_mfma_f32_16x16x32_bf16 v[24:27], v[112:115], a[12:15], v[24:27]
  ds_read_b64_tr_b16 v[112:113], v41 offset:12288
  s_add_u32 s16, s16, 262144
  v_mfma_f32_16x16x32_bf16 v[24:27], v[96:99], a[4:7], v[24:27]
  ds_read_b64_tr_b16 v[114:115], v41 offset:14336
  ds_read_b64_tr_b16 v[96:97], v41 offset:8192
  s_waitcnt lgkmcnt(10)
  v_mfma_f32_16x16x32_bf16 v[28:31], v[100:103], a[4:7], v[28:31]
  ds_read_b64_tr_b16 v[98:99], v41 offset:10240
  s_bitset0_b32 s16, 22
  v_mfma_f32_16x16x32_bf16 v[28:31], v[116:119], a[12:15], v[28:31]
  v_mfma_f32_16x16x32_bf16 v[12:15], v[116:119], a[8:11], v[12:15]
  ds_read_b64_tr_b16 v[116:117], v42 offset:12288
  ds_read_b64_tr_b16 v[118:119], v42 offset:14336
  v_mfma_f32_16x16x32_bf16 v[12:15], v[100:103], a[0:3], v[12:15]
  s_waitcnt vmcnt(12) lgkmcnt(10)
  ds_read_b64_tr_b16 v[100:101], v42 offset:8192
  v_mfma_f32_16x16x32_bf16 v[0:3], v[88:91], a[16:19], v[0:3]
  buffer_load_dwordx4 a[80:83], v33, s[4:7], s16 offen offset:0 sc1
  v_mfma_f32_16x16x32_bf16 v[0:3], v[104:107], a[24:27], v[0:3]
  ds_read_b64_tr_b16 v[102:103], v42 offset:10240
  v_mfma_f32_16x16x32_bf16 v[16:19], v[104:107], a[28:31], v[16:19]
  buffer_load_dwordx4 a[84:87], v33, s[4:7], s16 offen offset:1024 sc1
  v_mfma_f32_16x16x32_bf16 v[16:19], v[88:91], a[20:23], v[16:19]
  ds_read_b64_tr_b16 v[104:105], v39 offset:20480
  ds_read_b64_tr_b16 v[106:107], v39 offset:22528
  s_waitcnt lgkmcnt(10)
  v_mfma_f32_16x16x32_bf16 v[20:23], v[92:95], a[20:23], v[20:23]
  ds_read_b64_tr_b16 v[88:89], v39 offset:16384
  ds_read_b64_tr_b16 v[90:91], v39 offset:18432
  v_mfma_f32_16x16x32_bf16 v[20:23], v[108:111], a[28:31], v[20:23]
  buffer_load_dwordx4 a[88:91], v34, s[4:7], s16 offen offset:0 sc1
  v_mfma_f32_16x16x32_bf16 v[4:7], v[108:111], a[24:27], v[4:7]
  ds_read_b64_tr_b16 v[108:109], v40 offset:20480
  ds_read_b64_tr_b16 v[110:111], v40 offset:22528
  v_mfma_f32_16x16x32_bf16 v[4:7], v[92:95], a[16:19], v[4:7]
  buffer_load_dwordx4 a[92:95], v34, s[4:7], s16 offen offset:1024 sc1
  s_waitcnt lgkmcnt(10)
  v_mfma_f32_16x16x32_bf16 v[8:11], v[96:99], a[16:19], v[8:11]
  ds_read_b64_tr_b16 v[92:93], v40 offset:16384
  ds_read_b64_tr_b16 v[94:95], v40 offset:18432
  v_mfma_f32_16x16x32_bf16 v[8:11], v[112:115], a[24:27], v[8:11]
  v_mfma_f32_16x16x32_bf16 v[24:27], v[112:115], a[28:31], v[24:27]
  ds_read_b64_tr_b16 v[112:113], v41 offset:20480
  s_add_u32 s16, s16, 262144
  v_mfma_f32_16x16x32_bf16 v[24:27], v[96:99], a[20:23], v[24:27]
  ds_read_b64_tr_b16 v[114:115], v41 offset:22528
  ds_read_b64_tr_b16 v[96:97], v41 offset:16384
  s_waitcnt lgkmcnt(10)
  v_mfma_f32_16x16x32_bf16 v[28:31], v[100:103], a[20:23], v[28:31]
  ds_read_b64_tr_b16 v[98:99], v41 offset:18432
  s_bitset0_b32 s16, 22
  v_mfma_f32_16x16x32_bf16 v[28:31], v[116:119], a[28:31], v[28:31]
  v_mfma_f32_16x16x32_bf16 v[12:15], v[116:119], a[24:27], v[12:15]
  ds_read_b64_tr_b16 v[116:117], v42 offset:20480
  ds_read_b64_tr_b16 v[118:119], v42 offset:22528
  v_mfma_f32_16x16x32_bf16 v[12:15], v[100:103], a[16:19], v[12:15]
  s_waitcnt vmcnt(12) lgkmcnt(10)
  ds_read_b64_tr_b16 v[100:101], v42 offset:16384
  v_mfma_f32_16x16x32_bf16 v[0:3], v[88:91], a[32:35], v[0:3]
  buffer_load_dwordx4 a[96:99], v33, s[4:7], s16 offen offset:0 sc1
  v_mfma_f32_16x16x32_bf16 v[0:3], v[104:107], a[40:43], v[0:3]
  ds_read_b64_tr_b16 v[102:103], v42 offset:18432
  v_mfma_f32_16x16x32_bf16 v[16:19], v[104:107], a[44:47], v[16:19]
  buffer_load_dwordx4 a[100:103], v33, s[4:7], s16 offen offset:1024 sc1
  v_mfma_f32_16x16x32_bf16 v[16:19], v[88:91], a[36:39], v[16:19]
  ds_read_b64_tr_b16 v[104:105], v39 offset:28672
  ds_read_b64_tr_b16 v[106:107], v39 offset:30720
  s_waitcnt lgkmcnt(10)
  v_mfma_f32_16x16x32_bf16 v[20:23], v[92:95], a[36:39], v[20:23]
  ds_read_b64_tr_b16 v[88:89], v39 offset:24576
  ds_read_b64_tr_b16 v[90:91], v39 offset:26624
  v_mfma_f32_16x16x32_bf16 v[20:23], v[108:111], a[44:47], v[20:23]
  buffer_load_dwordx4 a[104:107], v34, s[4:7], s16 offen offset:0 sc1
  v_mfma_f32_16x16x32_bf16 v[4:7], v[108:111], a[40:43], v[4:7]
  ds_read_b64_tr_b16 v[108:109], v40 offset:28672
  ds_read_b64_tr_b16 v[110:111], v40 offset:30720
  v_mfma_f32_16x16x32_bf16 v[4:7], v[92:95], a[32:35], v[4:7]
  buffer_load_dwordx4 a[108:111], v34, s[4:7], s16 offen offset:1024 sc1
  s_waitcnt lgkmcnt(10)
  v_mfma_f32_16x16x32_bf16 v[8:11], v[96:99], a[32:35], v[8:11]
  ds_read_b64_tr_b16 v[92:93], v40 offset:24576
  ds_read_b64_tr_b16 v[94:95], v40 offset:26624
  v_mfma_f32_16x16x32_bf16 v[8:11], v[112:115], a[40:43], v[8:11]
  v_mfma_f32_16x16x32_bf16 v[24:27], v[112:115], a[44:47], v[24:27]
  ds_read_b64_tr_b16 v[112:113], v41 offset:28672
  s_add_u32 s16, s16, 262144
  v_mfma_f32_16x16x32_bf16 v[24:27], v[96:99], a[36:39], v[24:27]
  ds_read_b64_tr_b16 v[114:115], v41 offset:30720
  ds_read_b64_tr_b16 v[96:97], v41 offset:24576
  s_waitcnt lgkmcnt(10)
  v_mfma_f32_16x16x32_bf16 v[28:31], v[100:103], a[36:39], v[28:31]
  ds_read_b64_tr_b16 v[98:99], v41 offset:26624
  s_bitset0_b32 s16, 22
  v_mfma_f32_16x16x32_bf16 v[28:31], v[116:119], a[44:47], v[28:31]
  v_mfma_f32_16x16x32_bf16 v[12:15], v[116:119], a[40:43], v[12:15]
  ds_read_b64_tr_b16 v[116:117], v42 offset:28672
  ds_read_b64_tr_b16 v[118:119], v42 offset:30720
  v_mfma_f32_16x16x32_bf16 v[12:15], v[100:103], a[32:35], v[12:15]
  s_waitcnt vmcnt(12) lgkmcnt(10)
  ds_read_b64_tr_b16 v[100:101], v42 offset:24576
  v_mfma_f32_16x16x32_bf16 v[0:3], v[88:91], a[48:51], v[0:3]
  buffer_load_dwordx4 a[112:115], v33, s[4:7], s16 offen offset:0 sc1
  v_mfma_f32_16x16x32_bf16 v[0:3], v[104:107], a[56:59], v[0:3]
  ds_read_b64_tr_b16 v[102:103], v42 offset:26624
  v_mfma_f32_16x16x32_bf16 v[16:19], v[104:107], a[60:63], v[16:19]
  buffer_load_dwordx4 a[116:119], v33, s[4:7], s16 offen offset:1024 sc1
  v_mfma_f32_16x16x32_bf16 v[16:19], v[88:91], a[52:55], v[16:19]
  ds_read_b64_tr_b16 v[104:105], v39 offset:36864
  ds_read_b64_tr_b16 v[106:107], v39 offset:38912
  s_waitcnt lgkmcnt(10)
  v_mfma_f32_16x16x32_bf16 v[20:23], v[92:95], a[52:55], v[20:23]
  ds_read_b64_tr_b16 v[88:89], v39 offset:32768
  ds_read_b64_tr_b16 v[90:91], v39 offset:34816
  v_mfma_f32_16x16x32_bf16 v[20:23], v[108:111], a[60:63], v[20:23]
  buffer_load_dwordx4 a[120:123], v34, s[4:7], s16 offen offset:0 sc1
  v_mfma_f32_16x16x32_bf16 v[4:7], v[108:111], a[56:59], v[4:7]
  ds_read_b64_tr_b16 v[108:109], v40 offset:36864
  ds_read_b64_tr_b16 v[110:111], v40 offset:38912
  v_mfma_f32_16x16x32_bf16 v[4:7], v[92:95], a[48:51], v[4:7]
  buffer_load_dwordx4 a[124:127], v34, s[4:7], s16 offen offset:1024 sc1
  s_waitcnt lgkmcnt(10)
  v_mfma_f32_16x16x32_bf16 v[8:11], v[96:99], a[48:51], v[8:11]
  ds_read_b64_tr_b16 v[92:93], v40 offset:32768
  ds_read_b64_tr_b16 v[94:95], v40 offset:34816
  v_mfma_f32_16x16x32_bf16 v[8:11], v[112:115], a[56:59], v[8:11]
  v_mfma_f32_16x16x32_bf16 v[24:27], v[112:115], a[60:63], v[24:27]
  ds_read_b64_tr_b16 v[112:113], v41 offset:36864
  s_add_u32 s16, s16, 262144
  v_mfma_f32_16x16x32_bf16 v[24:27], v[96:99], a[52:55], v[24:27]
  ds_read_b64_tr_b16 v[114:115], v41 offset:38912
  ds_read_b64_tr_b16 v[96:97], v41 offset:32768
  s_waitcnt lgkmcnt(10)
  v_mfma_f32_16x16x32_bf16 v[28:31], v[100:103], a[52:55], v[28:31]
  ds_read_b64_tr_b16 v[98:99], v41 offset:34816
  s_bitset0_b32 s16, 22
  v_mfma_f32_16x16x32_bf16 v[28:31], v[116:119], a[60:63], v[28:31]
  v_mfma_f32_16x16x32_bf16 v[12:15], v[116:119], a[56:59], v[12:15]
  ds_read_b64_tr_b16 v[116:117], v42 offset:36864
  ds_read_b64_tr_b16 v[118:119], v42 offset:38912
  v_mfma_f32_16x16x32_bf16 v[12:15], v[100:103], a[48:51], v[12:15]
  s_waitcnt vmcnt(12) lgkmcnt(10)
  ds_read_b64_tr_b16 v[100:101], v42 offset:32768
  v_mfma_f32_16x16x32_bf16 v[0:3], v[88:91], a[64:67], v[0:3]
  ds_read_b64_tr_b16 v[102:103], v42 offset:34816
  s_add_u32 m0, s38, 43008
  v_mfma_f32_16x16x32_bf16 v[0:3], v[104:107], a[72:75], v[0:3]
  v_mfma_f32_16x16x32_bf16 v[16:19], v[104:107], a[76:79], v[16:19]
  ds_read_b64_tr_b16 v[104:105], v39 offset:45056
  ds_read_b64_tr_b16 v[106:107], v39 offset:47104
  v_mfma_f32_16x16x32_bf16 v[16:19], v[88:91], a[68:71], v[16:19]
  ds_read_b64_tr_b16 v[88:89], v39 offset:40960
  ds_read_b64_tr_b16 v[90:91], v39 offset:43008
  s_waitcnt lgkmcnt(10)
  v_mfma_f32_16x16x32_bf16 v[20:23], v[92:95], a[68:71], v[20:23]
  v_mfma_f32_16x16x32_bf16 v[20:23], v[108:111], a[76:79], v[20:23]
  buffer_load_dwordx4 v225, s[8:11], s17 offen lds
  v_mfma_f32_16x16x32_bf16 v[4:7], v[108:111], a[72:75], v[4:7]
  ds_read_b64_tr_b16 v[108:109], v40 offset:45056
  ds_read_b64_tr_b16 v[110:111], v40 offset:47104
  v_mfma_f32_16x16x32_bf16 v[4:7], v[92:95], a[64:67], v[4:7]
  ds_read_b64_tr_b16 v[92:93], v40 offset:40960
  ds_read_b64_tr_b16 v[94:95], v40 offset:43008
  s_waitcnt lgkmcnt(10)
  v_mfma_f32_16x16x32_bf16 v[8:11], v[96:99], a[64:67], v[8:11]
  v_mfma_f32_16x16x32_bf16 v[8:11], v[112:115], a[72:75], v[8:11]
  v_mfma_f32_16x16x32_bf16 v[24:27], v[112:115], a[76:79], v[24:27]
  buffer_load_dwordx4 v226, s[8:11], s17 offen offset:1024 lds
  v_mfma_f32_16x16x32_bf16 v[24:27], v[96:99], a[68:71], v[24:27]
  ds_read_b64_tr_b16 v[112:113], v41 offset:45056
  ds_read_b64_tr_b16 v[114:115], v41 offset:47104
  s_waitcnt lgkmcnt(10)
  v_mfma_f32_16x16x32_bf16 v[28:31], v[100:103], a[68:71], v[28:31]
  ds_read_b64_tr_b16 v[96:97], v41 offset:40960
  ds_read_b64_tr_b16 v[98:99], v41 offset:43008
  v_mfma_f32_16x16x32_bf16 v[28:31], v[116:119], a[76:79], v[28:31]
  v_mfma_f32_16x16x32_bf16 v[12:15], v[116:119], a[72:75], v[12:15]
  ds_read_b64_tr_b16 v[116:117], v42 offset:45056
  ds_read_b64_tr_b16 v[118:119], v42 offset:47104
  v_mfma_f32_16x16x32_bf16 v[12:15], v[100:103], a[64:67], v[12:15]
  s_waitcnt vmcnt(10) lgkmcnt(10)
  ds_read_b64_tr_b16 v[100:101], v42 offset:40960
  v_mfma_f32_16x16x32_bf16 v[0:3], v[88:91], a[80:83], v[0:3]
  buffer_load_dwordx4 v227, s[8:11], s17 offen offset:2048 lds
  v_mfma_f32_16x16x32_bf16 v[0:3], v[104:107], a[88:91], v[0:3]
  ds_read_b64_tr_b16 v[102:103], v42 offset:43008
  v_mfma_f32_16x16x32_bf16 v[16:19], v[104:107], a[92:95], v[16:19]
  ds_read_b64_tr_b16 v[104:105], v39 offset:53248
  ds_read_b64_tr_b16 v[106:107], v39 offset:55296
  v_mfma_f32_16x16x32_bf16 v[16:19], v[88:91], a[84:87], v[16:19]
  ds_read_b64_tr_b16 v[88:89], v39 offset:49152
  ds_read_b64_tr_b16 v[90:91], v39 offset:51200
  s_waitcnt lgkmcnt(10)
  v_mfma_f32_16x16x32_bf16 v[20:23], v[92:95], a[84:87], v[20:23]
  v_mfma_f32_16x16x32_bf16 v[20:23], v[108:111], a[92:95], v[20:23]
  s_mov_b32 exec_hi, 0
  buffer_load_dwordx4 v228, s[8:11], s17 offen offset:3072 lds
  s_mov_b32 exec_hi, -1
  v_mfma_f32_16x16x32_bf16 v[4:7], v[108:111], a[88:91], v[4:7]
  ds_read_b64_tr_b16 v[108:109], v40 offset:53248
  ds_read_b64_tr_b16 v[110:111], v40 offset:55296
  v_mfma_f32_16x16x32_bf16 v[4:7], v[92:95], a[80:83], v[4:7]
  ds_read_b64_tr_b16 v[92:93], v40 offset:49152
  ds_read_b64_tr_b16 v[94:95], v40 offset:51200
  s_waitcnt lgkmcnt(10)
  v_mfma_f32_16x16x32_bf16 v[8:11], v[96:99], a[80:83], v[8:11]
  v_mfma_f32_16x16x32_bf16 v[8:11], v[112:115], a[88:91], v[8:11]
  v_mfma_f32_16x16x32_bf16 v[24:27], v[112:115], a[92:95], v[24:27]
  ds_read_b64_tr_b16 v[112:113], v41 offset:53248
  s_add_u32 s17, s17, s96
  v_mfma_f32_16x16x32_bf16 v[24:27], v[96:99], a[84:87], v[24:27]
  ds_read_b64_tr_b16 v[114:115], v41 offset:55296
  ds_read_b64_tr_b16 v[96:97], v41 offset:49152
  s_waitcnt lgkmcnt(10)
  v_mfma_f32_16x16x32_bf16 v[28:31], v[100:103], a[84:87], v[28:31]
  ds_read_b64_tr_b16 v[98:99], v41 offset:51200
  v_mfma_f32_16x16x32_bf16 v[28:31], v[116:119], a[92:95], v[28:31]
  v_mfma_f32_16x16x32_bf16 v[12:15], v[116:119], a[88:91], v[12:15]
  ds_read_b64_tr_b16 v[116:117], v42 offset:53248
  ds_read_b64_tr_b16 v[118:119], v42 offset:55296
  v_mfma_f32_16x16x32_bf16 v[12:15], v[100:103], a[80:83], v[12:15]
  s_waitcnt vmcnt(8) lgkmcnt(10)
  ds_read_b64_tr_b16 v[100:101], v42 offset:49152
  v_mfma_f32_16x16x32_bf16 v[0:3], v[88:91], a[96:99], v[0:3]
  ds_read_b64_tr_b16 v[102:103], v42 offset:51200
  v_mfma_f32_16x16x32_bf16 v[0:3], v[104:107], a[104:107], v[0:3]
  v_mfma_f32_16x16x32_bf16 v[16:19], v[104:107], a[108:111], v[16:19]
  ds_read_b64_tr_b16 v[104:105], v39 offset:61440
  ds_read_b64_tr_b16 v[106:107], v39 offset:63488
  v_mfma_f32_16x16x32_bf16 v[16:19], v[88:91], a[100:103], v[16:19]
  ds_read_b64_tr_b16 v[88:89], v39 offset:57344
  ds_read_b64_tr_b16 v[90:91], v39 offset:59392
  s_waitcnt lgkmcnt(10)
  v_mfma_f32_16x16x32_bf16 v[20:23], v[92:95], a[100:103], v[20:23]
  v_mfma_f32_16x16x32_bf16 v[20:23], v[108:111], a[108:111], v[20:23]
  v_mfma_f32_16x16x32_bf16 v[4:7], v[108:111], a[104:107], v[4:7]
  ds_read_b64_tr_b16 v[108:109], v40 offset:61440
  ds_read_b64_tr_b16 v[110:111], v40 offset:63488
  v_mfma_f32_16x16x32_bf16 v[4:7], v[92:95], a[96:99], v[4:7]
  ds_read_b64_tr_b16 v[92:93], v40 offset:57344
  ds_read_b64_tr_b16 v[94:95], v40 offset:59392
  s_waitcnt lgkmcnt(10)
  v_mfma_f32_16x16x32_bf16 v[8:11], v[96:99], a[96:99], v[8:11]
  v_mfma_f32_16x16x32_bf16 v[8:11], v[112:115], a[104:107], v[8:11]
  v_mfma_f32_16x16x32_bf16 v[24:27], v[112:115], a[108:111], v[24:27]
  ds_read_b64_tr_b16 v[112:113], v41 offset:61440
  ds_read_b64_tr_b16 v[114:115], v41 offset:63488
  v_mfma_f32_16x16x32_bf16 v[24:27], v[96:99], a[100:103], v[24:27]
  ds_read_b64_tr_b16 v[96:97], v41 offset:57344
  ds_read_b64_tr_b16 v[98:99], v41 offset:59392
  s_waitcnt lgkmcnt(10)
  v_mfma_f32_16x16x32_bf16 v[28:31], v[100:103], a[100:103], v[28:31]
  v_mfma_f32_16x16x32_bf16 v[28:31], v[116:119], a[108:111], v[28:31]
  v_mfma_f32_16x16x32_bf16 v[12:15], v[116:119], a[104:107], v[12:15]
  ds_read_b64_tr_b16 v[116:117], v42 offset:61440
  ds_read_b64_tr_b16 v[118:119], v42 offset:63488
  v_mfma_f32_16x16x32_bf16 v[12:15], v[100:103], a[96:99], v[12:15]
  s_waitcnt vmcnt(4) lgkmcnt(10)
  ds_read_b64_tr_b16 v[100:101], v42 offset:57344
  v_mfma_f32_16x16x32_bf16 v[0:3], v[88:91], a[112:115], v[0:3]
  ds_read_b64_tr_b16 v[102:103], v42 offset:59392
  v_mfma_f32_16x16x32_bf16 v[16:19], v[88:91], a[116:119], v[16:19]
  s_waitcnt lgkmcnt(8)
  v_mfma_f32_16x16x32_bf16 v[20:23], v[92:95], a[116:119], v[20:23]
  v_mfma_f32_16x16x32_bf16 v[4:7], v[92:95], a[112:115], v[4:7]
  s_waitcnt lgkmcnt(4)
  v_mfma_f32_16x16x32_bf16 v[8:11], v[96:99], a[112:115], v[8:11]
  v_mfma_f32_16x16x32_bf16 v[24:27], v[96:99], a[116:119], v[24:27]
  s_waitcnt lgkmcnt(0)
  v_mfma_f32_16x16x32_bf16 v[28:31], v[100:103], a[116:119], v[28:31]
  v_mfma_f32_16x16x32_bf16 v[12:15], v[100:103], a[112:115], v[12:15]
  v_mfma_f32_16x16x32_bf16 v[0:3], v[104:107], a[120:123], v[0:3]
  v_mfma_f32_16x16x32_bf16 v[4:7], v[108:111], a[120:123], v[4:7]
  v_mfma_f32_16x16x32_bf16 v[8:11], v[112:115], a[120:123], v[8:11]
  v_mfma_f32_16x16x32_bf16 v[12:15], v[116:119], a[120:123], v[12:15]
  v_mfma_f32_16x16x32_bf16 v[16:19], v[104:107], a[124:127], v[16:19]
  v_mfma_f32_16x16x32_bf16 v[20:23], v[108:111], a[124:127], v[20:23]
  v_mfma_f32_16x16x32_bf16 v[24:27], v[112:115], a[124:127], v[24:27]
  v_mfma_f32_16x16x32_bf16 v[28:31], v[116:119], a[124:127], v[28:31]
  s_nop 1
  v_pk_fma_f32 v[120:121], v[0:1], v[64:65], v[120:121]
  v_pk_fma_f32 v[122:123], v[2:3], v[66:67], v[122:123]
  v_pk_fma_f32 v[124:125], v[4:5], v[68:69], v[124:125]
  v_pk_fma_f32 v[126:127], v[6:7], v[70:71], v[126:127]
  v_cvt_pk_bf16_f32 v48, v120, v121
  v_cvt_pk_bf16_f32 v49, v122, v123
  v_cvt_pk_bf16_f32 v50, v124, v125
  v_cvt_pk_bf16_f32 v51, v126, v127
  v_pk_fma_f32 v[128:129], v[8:9], v[72:73], v[128:129]
  v_pk_fma_f32 v[130:131], v[10:11], v[74:75], v[130:131]
  v_pk_fma_f32 v[132:133], v[12:13], v[76:77], v[132:133]
  v_pk_fma_f32 v[134:135], v[14:15], v[78:79], v[134:135]
  v_mfma_f32_16x16x32_bf16 v[200:203], v[216:219], v[48:51], 0
  v_mfma_f32_16x16x32_bf16 v[204:207], v[48:51], v[48:51], 0
  v_cvt_pk_bf16_f32 v52, v128, v129
  v_cvt_pk_bf16_f32 v53, v130, v131
  v_cvt_pk_bf16_f32 v54, v132, v133
  v_cvt_pk_bf16_f32 v55, v134, v135
  v_pk_fma_f32 v[136:137], v[16:17], v[64:65], v[136:137]
  v_pk_fma_f32 v[138:139], v[18:19], v[66:67], v[138:139]
  v_pk_fma_f32 v[140:141], v[20:21], v[68:69], v[140:141]
  v_pk_fma_f32 v[142:143], v[22:23], v[70:71], v[142:143]
  v_mfma_f32_16x16x32_bf16 v[200:203], v[216:219], v[52:55], v[200:203]
  v_mfma_f32_16x16x32_bf16 v[204:207], v[52:55], v[52:55], v[204:207]
  v_cvt_pk_bf16_f32 v56, v136, v137
  v_cvt_pk_bf16_f32 v57, v138, v139
  v_cvt_pk_bf16_f32 v58, v140, v141
  v_cvt_pk_bf16_f32 v59, v142, v143
  v_pk_fma_f32 v[144:145], v[24:25], v[72:73], v[144:145]
  v_pk_fma_f32 v[146:147], v[26:27], v[74:75], v[146:147]
  v_pk_fma_f32 v[148:149], v[28:29], v[76:77], v[148:149]
  v_pk_fma_f32 v[150:151], v[30:31], v[78:79], v[150:151]
  v_mfma_f32_16x16x32_bf16 v[208:211], v[216:219], v[56:59], 0
  v_mfma_f32_16x16x32_bf16 v[212:215], v[56:59], v[56:59], 0
  v_cvt_pk_bf16_f32 v60, v144, v145
  v_cvt_pk_bf16_f32 v61, v146, v147
  v_cvt_pk_bf16_f32 v62, v148, v149
  v_cvt_pk_bf16_f32 v63, v150, v151
  s_nop 1
  v_mfma_f32_16x16x32_bf16 v[212:215], v[60:63], v[60:63], v[212:215]
  v_mfma_f32_16x16x32_bf16 v[208:211], v[216:219], v[60:63], v[208:211]
  v_cndmask_b32_e64 v204, v204, v205, s[34:35]
  v_cndmask_b32_e64 v206, v206, v207, s[34:35]
  v_cndmask_b32_e64 v204, v204, v206, s[36:37]
  v_fma_f32 v204, -v200, v200, v204
  v_and_or_b32 v156, v200, v81, s44
  v_and_or_b32 v157, v204, v81, s45
  s_nop 1
  v_cndmask_b32_e64 v212, v212, v213, s[34:35]
  v_cndmask_b32_e64 v214, v214, v215, s[34:35]
  v_cndmask_b32_e64 v212, v212, v214, s[36:37]
  v_fma_f32 v212, -v208, v208, v212
  v_and_or_b32 v158, v208, v81, s46
  v_and_or_b32 v159, v212, v81, s47
  buffer_store_dwordx4 v[156:159], v83, s[52:55], s57 offen sc1
  s_barrier
  s_add_u32 m0, s38, 0
  s_nop 0
  buffer_load_dwordx4 v225, s[8:11], s17 offen lds
  buffer_load_dwordx4 v226, s[8:11], s17 offen offset:1024 lds
  buffer_load_dwordx4 v227, s[8:11], s17 offen offset:2048 lds
  s_mov_b32 exec_hi, 0
  buffer_load_dwordx4 v228, s[8:11], s17 offen offset:3072 lds
  s_mov_b32 exec_hi, -1
  s_add_u32 s17, s17, s97
  s_add_u32 m0, s38, 14336
  s_nop 0
  buffer_load_dwordx4 v225, s[8:11], s17 offen lds
  buffer_load_dwordx4 v226, s[8:11], s17 offen offset:1024 lds
  buffer_load_dwordx4 v227, s[8:11], s17 offen offset:2048 lds
  s_mov_b32 exec_hi, 0
  buffer_load_dwordx4 v228, s[8:11], s17 offen offset:3072 lds
  s_mov_b32 exec_hi, -1
  s_add_u32 s17, s17, s98
  v_accvgpr_write_b32 a128, v48
  v_lshlrev_b32 v0, 16, v48
  v_and_b32 v1, 0xffff0000, v48
  v_accvgpr_write_b32 a129, v49
  v_lshlrev_b32 v2, 16, v49
  v_and_b32 v3, 0xffff0000, v49
  v_accvgpr_write_b32 a130, v50
  v_lshlrev_b32 v4, 16, v50
  v_and_b32 v5, 0xffff0000, v50
  v_accvgpr_write_b32 a131, v51
  v_lshlrev_b32 v6, 16, v51
  v_and_b32 v7, 0xffff0000, v51
  v_accvgpr_write_b32 a132, v52
  v_lshlrev_b32 v8, 16, v52
  v_and_b32 v9, 0xffff0000, v52
  v_accvgpr_write_b32 a133, v53
  v_lshlrev_b32 v10, 16, v53
  v_and_b32 v11, 0xffff0000, v53
  v_accvgpr_write_b32 a134, v54
  v_lshlrev_b32 v12, 16, v54
  v_and_b32 v13, 0xffff0000, v54
  v_accvgpr_write_b32 a135, v55
  v_lshlrev_b32 v14, 16, v55
  v_and_b32 v15, 0xffff0000, v55
  v_accvgpr_write_b32 a136, v56
  v_lshlrev_b32 v16, 16, v56
  v_and_b32 v17, 0xffff0000, v56
  v_accvgpr_write_b32 a137, v57
  v_lshlrev_b32 v18, 16, v57
  v_and_b32 v19, 0xffff0000, v57
  v_accvgpr_write_b32 a138, v58
  v_lshlrev_b32 v20, 16, v58
  v_and_b32 v21, 0xffff0000, v58
  v_accvgpr_write_b32 a139, v59
  v_lshlrev_b32 v22, 16, v59
  v_and_b32 v23, 0xffff0000, v59
  v_accvgpr_write_b32 a140, v60
  v_lshlrev_b32 v24, 16, v60
  v_and_b32 v25, 0xffff0000, v60
  v_accvgpr_write_b32 a141, v61
  v_lshlrev_b32 v26, 16, v61
  v_and_b32 v27, 0xffff0000, v61
  v_accvgpr_write_b32 a142, v62
  v_lshlrev_b32 v28, 16, v62
  v_and_b32 v29, 0xffff0000, v62
  v_accvgpr_write_b32 a143, v63
  v_lshlrev_b32 v30, 16, v63
  v_and_b32 v31, 0xffff0000, v63
  s_add_u32 s48, s20, 0xa00000
  s_addc_u32 s49, s21, 0
  s_mov_b32 s50, 0x400000
  s_mov_b32 s51, 0x20000
  s_mov_b32 s59, 262144
L_poll_17:
  buffer_load_dwordx4 v[88:91], v80, s[52:55], s56 offen offset:0 sc1
  buffer_load_dwordx4 v[92:95], v80, s[52:55], s56 offen offset:1024 sc1
  buffer_load_dwordx4 v[96:99], v80, s[52:55], s56 offen offset:2048 sc1
  buffer_load_dwordx4 v[100:103], v80, s[52:55], s56 offen offset:3072 sc1
  s_waitcnt vmcnt(3)
  v_xor_b32 v88, s44, v88
  v_xor_b32 v89, s45, v89
  v_xor_b32 v90, s46, v90
  v_xor_b32 v91, s47, v91
  v_or3_b32 v160, v88, v89, v90
  v_or_b32 v160, v160, v91
  s_waitcnt vmcnt(2)
  v_xor_b32 v92, s44, v92
  v_xor_b32 v93, s45, v93
  v_xor_b32 v94, s46, v94
  v_xor_b32 v95, s47, v95
  v_or3_b32 v160, v160, v92, v93
  v_or3_b32 v160, v160, v94, v95
  s_waitcnt vmcnt(1)
  v_xor_b32 v96, s44, v96
  v_xor_b32 v97, s45, v97
  v_xor_b32 v98, s46, v98
  v_xor_b32 v99, s47, v99
  v_or3_b32 v160, v160, v96, v97
  v_or3_b32 v160, v160, v98, v99
  s_waitcnt vmcnt(0)
  v_xor_b32 v100, s44, v100
  v_xor_b32 v101, s45, v101
  v_xor_b32 v102, s46, v102
  v_xor_b32 v103, s47, v103
  v_or3_b32 v160, v160, v100, v101
  v_or3_b32 v160, v160, v102, v103
  v_and_b32 v160, 0xff, v160
  v_cmp_ne_u32 vcc, 0, v160
  s_nop 1
  s_cmp_eq_u64 vcc, 0
  s_cbranch_scc1 L_ready_18
  s_sub_u32 s59, s59, 1
  s_cmp_lg_u32 s59, 0
  s_cbranch_scc1 L_poll_17
L_ready_18:
  v_fmac_f32 v89, v88, v88
  v_fmac_f32 v91, v90, v90
  v_fmac_f32 v93, v92, v92
  v_fmac_f32 v95, v94, v94
  v_fmac_f32 v97, v96, v96
  v_fmac_f32 v99, v98, v98
  v_fmac_f32 v101, v100, v100
  v_fmac_f32 v103, v102, v102
  v_pk_add_f32 v[152:153], v[88:89], v[92:93]
  v_pk_add_f32 v[160:161], v[96:97], v[100:101]
  v_pk_add_f32 v[154:155], v[90:91], v[94:95]
  v_pk_add_f32 v[162:163], v[98:99], v[102:103]
  v_pk_add_f32 v[152:153], v[152:153], v[160:161]
  v_pk_add_f32 v[154:155], v[154:155], v[162:163]
  v_mov_b32 v160, v152
  v_mov_b32 v161, v153
  v_mov_b32 v162, v154
  v_mov_b32 v163, v155
  s_nop 1
  v_permlane16_swap_b32 v160, v152
  v_permlane16_swap_b32 v161, v153
  v_permlane16_swap_b32 v162, v154
  v_permlane16_swap_b32 v163, v155
  s_nop 1
  v_add_f32 v152, v152, v160
  v_add_f32 v153, v153, v161
  v_add_f32 v154, v154, v162
  v_add_f32 v155, v155, v163
  v_mov_b32 v160, v152
  v_mov_b32 v161, v153
  v_mov_b32 v162, v154
  v_mov_b32 v163, v155
  s_nop 1
  v_permlane32_swap_b32 v160, v152
  v_permlane32_swap_b32 v161, v153
  v_permlane32_swap_b32 v162, v154
  v_permlane32_swap_b32 v163, v155
  s_nop 1
  v_add_f32 v152, v152, v160
  v_add_f32 v153, v153, v161
  v_add_f32 v154, v154, v162
  v_add_f32 v155, v155, v163
  v_mul_f32 v120, 0x3c000000, v152
  v_mul_f32 v122, 0x3a800000, v153
  v_mul_f32 v121, 0x3c000000, v154
  v_mul_f32 v123, 0x3a800000, v155
  v_fma_f32 v122, -v120, v120, v122
  v_fma_f32 v123, -v121, v121, v123
  v_max_f32 v122, 0, v122
  v_max_f32 v123, 0, v123
  v_cvt_pk_bf16_f32 v124, v122, v123
  v_lshlrev_b32 v122, 16, v124
  v_and_b32 v123, 0xffff0000, v124
  v_add_f32 v122, 0x3727c5ac, v122
  v_add_f32 v123, 0x3727c5ac, v123
  v_cvt_pk_bf16_f32 v124, v122, v123
  v_lshlrev_b32 v122, 16, v124
  v_and_b32 v123, 0xffff0000, v124
  v_sqrt_f32 v122, v122
  v_sqrt_f32 v123, v123
  v_cvt_pk_bf16_f32 v124, v120, v121
  v_lshlrev_b32 v120, 16, v124
  v_and_b32 v121, 0xffff0000, v124
  v_cvt_pk_bf16_f32 v124, v122, v123
  v_lshlrev_b32 v122, 16, v124
  v_and_b32 v123, 0xffff0000, v124
  v_rcp_f32 v126, v122
  v_rcp_f32 v130, v123
  s_nop 0
  v_mov_b32 v127, v126
  v_mul_f32_e64 v128, -v120, v126
  v_mul_f32_e64 v129, -v120, v126
  v_mov_b32 v131, v130
  v_mul_f32_e64 v132, -v121, v130
  v_mul_f32_e64 v133, -v121, v130
  v_pk_fma_f32 v[0:1], v[0:1], v[126:127], v[128:129]
  v_pk_fma_f32 v[2:3], v[2:3], v[126:127], v[128:129]
  v_pk_fma_f32 v[4:5], v[4:5], v[126:127], v[128:129]
  v_pk_fma_f32 v[6:7], v[6:7], v[126:127], v[128:129]
  v_pk_fma_f32 v[0:1], v[0:1], v[184:185], v[168:169]
  v_pk_fma_f32 v[2:3], v[2:3], v[186:187], v[170:171]
  v_pk_fma_f32 v[4:5], v[4:5], v[188:189], v[172:173]
  v_pk_fma_f32 v[6:7], v[6:7], v[190:191], v[174:175]
  v_cvt_pk_bf16_f32 v88, v0, v1
  v_cvt_pk_bf16_f32 v89, v2, v3
  v_cvt_pk_bf16_f32 v90, v4, v5
  v_cvt_pk_bf16_f32 v91, v6, v7
  buffer_store_dwordx4 v[88:91], v33, s[48:51], s41 offen offset:0 sc1
  v_pk_fma_f32 v[8:9], v[8:9], v[126:127], v[128:129]
  v_pk_fma_f32 v[10:11], v[10:11], v[126:127], v[128:129]
  v_pk_fma_f32 v[12:13], v[12:13], v[126:127], v[128:129]
  v_pk_fma_f32 v[14:15], v[14:15], v[126:127], v[128:129]
  v_pk_fma_f32 v[8:9], v[8:9], v[192:193], v[176:177]
  v_pk_fma_f32 v[10:11], v[10:11], v[194:195], v[178:179]
  v_pk_fma_f32 v[12:13], v[12:13], v[196:197], v[180:181]
  v_pk_fma_f32 v[14:15], v[14:15], v[198:199], v[182:183]
  v_cvt_pk_bf16_f32 v92, v8, v9
  v_cvt_pk_bf16_f32 v93, v10, v11
  v_cvt_pk_bf16_f32 v94, v12, v13
  v_cvt_pk_bf16_f32 v95, v14, v15
  buffer_store_dwordx4 v[92:95], v33, s[48:51], s42 offen offset:0 sc1
  v_pk_fma_f32 v[16:17], v[16:17], v[130:131], v[132:133]
  v_pk_fma_f32 v[18:19], v[18:19], v[130:131], v[132:133]
  v_pk_fma_f32 v[20:21], v[20:21], v[130:131], v[132:133]
  v_pk_fma_f32 v[22:23], v[22:23], v[130:131], v[132:133]
  v_pk_fma_f32 v[16:17], v[16:17], v[184:185], v[168:169]
  v_pk_fma_f32 v[18:19], v[18:19], v[186:187], v[170:171]
  v_pk_fma_f32 v[20:21], v[20:21], v[188:189], v[172:173]
  v_pk_fma_f32 v[22:23], v[22:23], v[190:191], v[174:175]
  v_cvt_pk_bf16_f32 v96, v16, v17
  v_cvt_pk_bf16_f32 v97, v18, v19
  v_cvt_pk_bf16_f32 v98, v20, v21
  v_cvt_pk_bf16_f32 v99, v22, v23
  buffer_store_dwordx4 v[96:99], v33, s[48:51], s41 offen offset:1024 sc1
  v_pk_fma_f32 v[24:25], v[24:25], v[130:131], v[132:133]
  v_pk_fma_f32 v[26:27], v[26:27], v[130:131], v[132:133]
  v_pk_fma_f32 v[28:29], v[28:29], v[130:131], v[132:133]
  v_pk_fma_f32 v[30:31], v[30:31], v[130:131], v[132:133]
  v_pk_fma_f32 v[24:25], v[24:25], v[192:193], v[176:177]
  v_pk_fma_f32 v[26:27], v[26:27], v[194:195], v[178:179]
  v_pk_fma_f32 v[28:29], v[28:29], v[196:197], v[180:181]
  v_pk_fma_f32 v[30:31], v[30:31], v[198:199], v[182:183]
  v_cvt_pk_bf16_f32 v100, v24, v25
  v_cvt_pk_bf16_f32 v101, v26, v27
  v_cvt_pk_bf16_f32 v102, v28, v29
  v_cvt_pk_bf16_f32 v103, v30, v31
  buffer_store_dwordx4 v[100:103], v33, s[48:51], s42 offen offset:1024 sc1
  s_add_u32 s64, s20, 0xb0000
  s_addc_u32 s65, s21, 0
  s_mov_b32 s66, 0x10000
  s_mov_b32 s67, 0x20000
  s_lshl_b32 s32, s30, 2
  s_add_u32 s32, s32, s3
  s_lshl_b32 s32, s32, 4
  s_add_u32 s32, s32, s31
  s_lshl_b32 s32, s32, 6
  s_mov_b32 s30, s94
  s_mov_b32 s31, s95
  s_lshl_b32 s33, s30, 2
  s_add_u32 s33, s33, s3
  s_lshl_b32 s68, s33, 11
  v_lshlrev_b32 v250, 2, v231
  v_mov_b32 v248, s19
  v_and_b32 v246, 31, v231
  v_and_b32 v245, 17, v246
  v_lshlrev_b32 v245, 6, v245
  v_lshlrev_b32 v246, 6, v246
  s_mov_b64 s[24:25], s[60:61]
  s_mov_b64 s[26:27], s[62:63]
  s_add_u32 s4, s20, 0xa00000
  s_addc_u32 s5, s21, 0
  s_mov_b32 s6, 0x400000
  s_mov_b32 s7, 0x20000
  s_bfe_u32 s33, s2, 0x20003
  s_mul_i32 s16, s33, 131072
  s_cmp_eq_u32 s33, 3
  s_cselect_b32 s44, -3, 1
  s_mul_i32 s44, s44, 131072
  s_cmp_eq_u32 s33, 2
  s_cselect_b32 s45, -3, 1
  s_mul_i32 s45, s45, 131072
  s_cmp_eq_u32 s33, 1
  s_cselect_b32 s46, -3, 1
  s_mul_i32 s46, s46, 131072
  s_cmp_eq_u32 s33, 0
  s_cselect_b32 s47, 1, 5
  s_mul_i32 s47, s47, 131072
  s_bitcmp1_b32 s3, 0
  s_cselect_b32 s52, s26, s24
  s_cselect_b32 s53, s27, s25
  s_cselect_b32 s60, 3670016, 0
  s_mov_b32 s54, 7340032
  s_mov_b32 s55, 0x20000
  s_lshl_b32 s56, s2, 1
  s_lshr_b32 s59, s3, 1
  s_add_u32 s56, s56, s59
  s_lshl_b32 s56, s56, 10
  s_add_u32 s60, s60, s56
  s_add_u32 s56, s56, 1048576
  s_mov_b32 s59, 0
  v_lshrrev_b32 v249, 3, v231
  v_lshlrev_b32 v249, 7, v249
  v_and_b32 v251, 0, v231
  v_lshl_add_u32 v249, v251, 19, v249
  s_mov_b32 s52, s22
  s_mov_b32 s53, s23
  s_mov_b32 s56, s60
  s_add_u32 s12, s20, 0x1600000
  s_addc_u32 s13, s21, 0
  s_mov_b32 s14, 0xe00000
  s_mov_b32 s15, 0x20000
  v_lshrrev_b32 v234, 2, v231
  v_mul_u32_u24 v234, 224, v234
  v_and_b32 v235, 3, v231
  v_lshl_add_u32 v229, v235, 3, v234
  v_add_u32 v229, 98304, v229
  v_add_u32 v230, 57344, v229
  s_waitcnt vmcnt(0)
  s_mov_b64 exec, 1
  buffer_store_dword v248, v250, s[64:67], s32 offen sc1
  s_mov_b64 exec, -1
  s_waitcnt vmcnt(8)
  s_barrier
  ds_read_b64_tr_b16 a[64:65], v229 offset:43008
  ds_read_b64_tr_b16 a[66:67], v229 offset:46592
  ds_read_b64_tr_b16 a[68:69], v229 offset:43040
  ds_read_b64_tr_b16 a[70:71], v229 offset:46624
  ds_read_b64_tr_b16 a[72:73], v229 offset:43072
  ds_read_b64_tr_b16 a[74:75], v229 offset:46656
  ds_read_b64_tr_b16 a[76:77], v229 offset:43104
  ds_read_b64_tr_b16 a[78:79], v229 offset:46688
  ds_read_b64_tr_b16 a[80:81], v229 offset:43136
  ds_read_b64_tr_b16 a[82:83], v229 offset:46720
  ds_read_b64_tr_b16 a[84:85], v229 offset:43168
  ds_read_b64_tr_b16 a[86:87], v229 offset:46752
  ds_read_b64_tr_b16 a[88:89], v229 offset:43200
  ds_read_b64_tr_b16 a[90:91], v229 offset:46784
  ds_read_b64_tr_b16 a[92:93], v229 offset:50176
  ds_read_b64_tr_b16 a[94:95], v229 offset:53760
  ds_read_b64_tr_b16 a[96:97], v229 offset:50208
  ds_read_b64_tr_b16 a[98:99], v229 offset:53792
  ds_read_b64_tr_b16 a[100:101], v229 offset:50240
  ds_read_b64_tr_b16 a[102:103], v229 offset:53824
  ds_read_b64_tr_b16 a[104:105], v229 offset:50272
  ds_read_b64_tr_b16 a[106:107], v229 offset:53856
  ds_read_b64_tr_b16 a[108:109], v229 offset:50304
  ds_read_b64_tr_b16 a[110:111], v229 offset:53888
  ds_read_b64_tr_b16 a[112:113], v229 offset:50336
  ds_read_b64_tr_b16 a[114:115], v229 offset:53920
  ds_read_b64_tr_b16 a[116:117], v229 offset:50368
  ds_read_b64_tr_b16 a[118:119], v229 offset:53952
  s_mov_b32 s34, 262144
L_spin_21:
  buffer_load_dword v247, v245, s[64:67], s68 offen sc1
  s_waitcnt vmcnt(0)
  v_cmp_ne_u32 vcc, s19, v247
  s_nop 1
  s_cmp_eq_u64 vcc, 0
  s_cbranch_scc1 L_rdy_22
  s_sub_u32 s34, s34, 1
  s_cmp_lg_u32 s34, 0
  s_cbranch_scc1 L_spin_21
L_rdy_22:
  buffer_load_dwordx4 a[0:3], v224, s[4:7], s16 offen offset:0 sc1
  buffer_load_dwordx4 a[4:7], v224, s[4:7], s16 offen offset:1024 sc1
  buffer_load_dwordx4 a[8:11], v224, s[4:7], s16 offen offset:2048 sc1
  buffer_load_dwordx4 a[12:15], v224, s[4:7], s16 offen offset:3072 sc1
  s_add_u32 s16, s16, s44
  buffer_load_dwordx4 a[16:19], v224, s[4:7], s16 offen offset:0 sc1
  buffer_load_dwordx4 a[20:23], v224, s[4:7], s16 offen offset:1024 sc1
  buffer_load_dwordx4 a[24:27], v224, s[4:7], s16 offen offset:2048 sc1
  buffer_load_dwordx4 a[28:31], v224, s[4:7], s16 offen offset:3072 sc1
  s_add_u32 s16, s16, s45
  s_waitcnt vmcnt(4) lgkmcnt(10)
  s_barrier
  buffer_load_dword v247, v246, s[64:67], s68 offen sc1
  v_mfma_f32_16x16x32_bf16 v[0:3], a[64:67], a[0:3], 0
  s_add_u32 m0, s38, 28672
  v_mfma_f32_16x16x32_bf16 v[56:59], a[64:67], a[4:7], 0
  buffer_load_dwordx4 v225, s[8:11], s17 offen lds
  v_mfma_f32_16x16x32_bf16 v[112:115], a[64:67], a[8:11], 0
  v_mfma_f32_16x16x32_bf16 v[168:171], a[64:67], a[12:15], 0
  ds_read_b64_tr_b16 a[64:65], v229 offset:0
  ds_read_b64_tr_b16 a[66:67], v229 offset:3584
  v_mfma_f32_16x16x32_bf16 v[172:175], a[68:71], a[12:15], 0
  v_mfma_f32_16x16x32_bf16 v[116:119], a[68:71], a[8:11], 0
  buffer_load_dwordx4 a[32:35], v224, s[4:7], s16 offen offset:0 sc1
  v_mfma_f32_16x16x32_bf16 v[60:63], a[68:71], a[4:7], 0
  v_mfma_f32_16x16x32_bf16 v[4:7], a[68:71], a[0:3], 0
  ds_read_b64_tr_b16 a[68:69], v229 offset:32
  ds_read_b64_tr_b16 a[70:71], v229 offset:3616
  v_mfma_f32_16x16x32_bf16 v[8:11], a[72:75], a[0:3], 0
  v_mfma_f32_16x16x32_bf16 v[64:67], a[72:75], a[4:7], 0
  v_mfma_f32_16x16x32_bf16 v[120:123], a[72:75], a[8:11], 0
  buffer_load_dwordx4 v226, s[8:11], s17 offen offset:1024 lds
  v_mfma_f32_16x16x32_bf16 v[176:179], a[72:75], a[12:15], 0
  ds_read_b64_tr_b16 a[72:73], v229 offset:64
  ds_read_b64_tr_b16 a[74:75], v229 offset:3648
  v_mfma_f32_16x16x32_bf16 v[180:183], a[76:79], a[12:15], 0
  v_mfma_f32_16x16x32_bf16 v[124:127], a[76:79], a[8:11], 0
  v_mfma_f32_16x16x32_bf16 v[68:71], a[76:79], a[4:7], 0
  buffer_load_dwordx4 a[36:39], v224, s[4:7], s16 offen offset:1024 sc1
  v_mfma_f32_16x16x32_bf16 v[12:15], a[76:79], a[0:3], 0
  ds_read_b64_tr_b16 a[76:77], v229 offset:96
  ds_read_b64_tr_b16 a[78:79], v229 offset:3680
  v_mfma_f32_16x16x32_bf16 v[16:19], a[80:83], a[0:3], 0
  v_mfma_f32_16x16x32_bf16 v[72:75], a[80:83], a[4:7], 0
  v_mfma_f32_16x16x32_bf16 v[128:131], a[80:83], a[8:11], 0
  v_mfma_f32_16x16x32_bf16 v[184:187], a[80:83], a[12:15], 0
  buffer_load_dwordx4 v227, s[8:11], s17 offen offset:2048 lds
  v_mfma_f32_16x16x32_bf16 v[188:191], a[84:87], a[12:15], 0
  ds_read_b64_tr_b16 a[80:81], v229 offset:128
  ds_read_b64_tr_b16 a[82:83], v229 offset:3712
  v_mfma_f32_16x16x32_bf16 v[132:135], a[84:87], a[8:11], 0
  v_mfma_f32_16x16x32_bf16 v[76:79], a[84:87], a[4:7], 0
  v_mfma_f32_16x16x32_bf16 v[20:23], a[84:87], a[0:3], 0
  buffer_load_dwordx4 a[40:43], v224, s[4:7], s16 offen offset:2048 sc1
  v_mfma_f32_16x16x32_bf16 v[24:27], a[88:91], a[0:3], 0
  ds_read_b64_tr_b16 a[84:85], v229 offset:160
  ds_read_b64_tr_b16 a[86:87], v229 offset:3744
  v_mfma_f32_16x16x32_bf16 v[80:83], a[88:91], a[4:7], 0
  v_mfma_f32_16x16x32_bf16 v[136:139], a[88:91], a[8:11], 0
  v_mfma_f32_16x16x32_bf16 v[192:195], a[88:91], a[12:15], 0
  ds_read_b64_tr_b16 a[88:89], v229 offset:192
  ds_read_b64_tr_b16 a[90:91], v229 offset:3776
  v_mfma_f32_16x16x32_bf16 v[196:199], a[92:95], a[12:15], 0
  s_mov_b32 exec_hi, 0
  buffer_load_dwordx4 v228, s[8:11], s17 offen offset:3072 lds
  s_mov_b32 exec_hi, -1
  v_mfma_f32_16x16x32_bf16 v[140:143], a[92:95], a[8:11], 0
  s_add_u32 s17, s17, s99
  v_mfma_f32_16x16x32_bf16 v[84:87], a[92:95], a[4:7], 0
  v_mfma_f32_16x16x32_bf16 v[28:31], a[92:95], a[0:3], 0
  ds_read_b64_tr_b16 a[92:93], v229 offset:7168
  ds_read_b64_tr_b16 a[94:95], v229 offset:10752
  v_mfma_f32_16x16x32_bf16 v[32:35], a[96:99], a[0:3], 0
  v_mfma_f32_16x16x32_bf16 v[88:91], a[96:99], a[4:7], 0
  buffer_load_dwordx4 a[44:47], v224, s[4:7], s16 offen offset:3072 sc1
  v_mfma_f32_16x16x32_bf16 v[144:147], a[96:99], a[8:11], 0
  s_add_u32 s16, s16, s46
  v_mfma_f32_16x16x32_bf16 v[200:203], a[96:99], a[12:15], 0
  ds_read_b64_tr_b16 a[96:97], v229 offset:7200
  ds_read_b64_tr_b16 a[98:99], v229 offset:10784
  s_waitcnt lgkmcnt(10)
  v_mfma_f32_16x16x32_bf16 v[204:207], a[100:103], a[12:15], 0
  v_mfma_f32_16x16x32_bf16 v[148:151], a[100:103], a[8:11], 0
  buffer_load_dwordx4 a[48:51], v224, s[4:7], s16 offen offset:0 sc1
  v_mfma_f32_16x16x32_bf16 v[92:95], a[100:103], a[4:7], 0
  v_mfma_f32_16x16x32_bf16 v[36:39], a[100:103], a[0:3], 0
  ds_read_b64_tr_b16 a[100:101], v229 offset:7232
  ds_read_b64_tr_b16 a[102:103], v229 offset:10816
  v_mfma_f32_16x16x32_bf16 v[40:43], a[104:107], a[0:3], 0
  v_mfma_f32_16x16x32_bf16 v[96:99], a[104:107], a[4:7], 0
  v_mfma_f32_16x16x32_bf16 v[152:155], a[104:107], a[8:11], 0
  buffer_load_dwordx4 a[52:55], v224, s[4:7], s16 offen offset:1024 sc1
  v_mfma_f32_16x16x32_bf16 v[208:211], a[104:107], a[12:15], 0
  ds_read_b64_tr_b16 a[104:105], v229 offset:7264
  ds_read_b64_tr_b16 a[106:107], v229 offset:10848
  v_mfma_f32_16x16x32_bf16 v[212:215], a[108:111], a[12:15], 0
  v_mfma_f32_16x16x32_bf16 v[156:159], a[108:111], a[8:11], 0
  v_mfma_f32_16x16x32_bf16 v[100:103], a[108:111], a[4:7], 0
  buffer_load_dwordx4 a[56:59], v224, s[4:7], s16 offen offset:2048 sc1
  v_mfma_f32_16x16x32_bf16 v[44:47], a[108:111], a[0:3], 0
  ds_read_b64_tr_b16 a[108:109], v229 offset:7296
  ds_read_b64_tr_b16 a[110:111], v229 offset:10880
  v_mfma_f32_16x16x32_bf16 v[48:51], a[112:115], a[0:3], 0
  v_mfma_f32_16x16x32_bf16 v[104:107], a[112:115], a[4:7], 0
  v_mfma_f32_16x16x32_bf16 v[160:163], a[112:115], a[8:11], 0
  v_mfma_f32_16x16x32_bf16 v[216:219], a[112:115], a[12:15], 0
  buffer_load_dwordx4 a[60:63], v224, s[4:7], s16 offen offset:3072 sc1
  v_mfma_f32_16x16x32_bf16 v[220:223], a[116:119], a[12:15], 0
  ds_read_b64_tr_b16 a[112:113], v229 offset:7328
  s_add_u32 s16, s16, s47
  v_mfma_f32_16x16x32_bf16 v[164:167], a[116:119], a[8:11], 0
  ds_read_b64_tr_b16 a[114:115], v229 offset:10912
  v_mfma_f32_16x16x32_bf16 v[108:111], a[116:119], a[4:7], 0
  v_mfma_f32_16x16x32_bf16 v[52:55], a[116:119], a[0:3], 0
  s_waitcnt vmcnt(12) lgkmcnt(10)
  s_barrier
  v_cmp_ne_u32 vcc, s19, v247
  s_nop 1
  s_cmp_lg_u64 vcc, 0
  s_cbranch_scc1 L_slow_19
  L_back_20:
  v_mfma_f32_16x16x32_bf16 v[0:3], a[64:67], a[16:19], v[0:3]
  ds_read_b64_tr_b16 a[116:117], v229 offset:7360
  s_add_u32 m0, s38, 43008
  v_mfma_f32_16x16x32_bf16 v[56:59], a[64:67], a[20:23], v[56:59]
  buffer_load_dwordx4 v225, s[8:11], s17 offen lds
  v_mfma_f32_16x16x32_bf16 v[112:115], a[64:67], a[24:27], v[112:115]
  ds_read_b64_tr_b16 a[118:119], v229 offset:10944
  v_mfma_f32_16x16x32_bf16 v[168:171], a[64:67], a[28:31], v[168:171]
  ds_read_b64_tr_b16 a[64:65], v229 offset:14336
  ds_read_b64_tr_b16 a[66:67], v229 offset:17920
  v_mfma_f32_16x16x32_bf16 v[172:175], a[68:71], a[28:31], v[172:175]
  v_mfma_f32_16x16x32_bf16 v[116:119], a[68:71], a[24:27], v[116:119]
  v_mfma_f32_16x16x32_bf16 v[60:63], a[68:71], a[20:23], v[60:63]
  v_mfma_f32_16x16x32_bf16 v[4:7], a[68:71], a[16:19], v[4:7]
  buffer_load_dwordx4 a[0:3], v224, s[4:7], s16 offen offset:0 sc1
  v_mfma_f32_16x16x32_bf16 v[8:11], a[72:75], a[16:19], v[8:11]
  ds_read_b64_tr_b16 a[68:69], v229 offset:14368
  ds_read_b64_tr_b16 a[70:71], v229 offset:17952
  v_mfma_f32_16x16x32_bf16 v[64:67], a[72:75], a[20:23], v[64:67]
  v_mfma_f32_16x16x32_bf16 v[120:123], a[72:75], a[24:27], v[120:123]
  v_mfma_f32_16x16x32_bf16 v[176:179], a[72:75], a[28:31], v[176:179]
  ds_read_b64_tr_b16 a[72:73], v229 offset:14400
  ds_read_b64_tr_b16 a[74:75], v229 offset:17984
  v_mfma_f32_16x16x32_bf16 v[180:183], a[76:79], a[28:31], v[180:183]
  v_mfma_f32_16x16x32_bf16 v[124:127], a[76:79], a[24:27], v[124:127]
  buffer_load_dwordx4 v226, s[8:11], s17 offen offset:1024 lds
  v_mfma_f32_16x16x32_bf16 v[68:71], a[76:79], a[20:23], v[68:71]
  v_mfma_f32_16x16x32_bf16 v[12:15], a[76:79], a[16:19], v[12:15]
  ds_read_b64_tr_b16 a[76:77], v229 offset:14432
  ds_read_b64_tr_b16 a[78:79], v229 offset:18016
  v_mfma_f32_16x16x32_bf16 v[16:19], a[80:83], a[16:19], v[16:19]
  v_mfma_f32_16x16x32_bf16 v[72:75], a[80:83], a[20:23], v[72:75]
  v_mfma_f32_16x16x32_bf16 v[128:131], a[80:83], a[24:27], v[128:131]
  v_mfma_f32_16x16x32_bf16 v[184:187], a[80:83], a[28:31], v[184:187]
  buffer_load_dwordx4 a[4:7], v224, s[4:7], s16 offen offset:1024 sc1
  v_mfma_f32_16x16x32_bf16 v[188:191], a[84:87], a[28:31], v[188:191]
  ds_read_b64_tr_b16 a[80:81], v229 offset:14464
  ds_read_b64_tr_b16 a[82:83], v229 offset:18048
  v_mfma_f32_16x16x32_bf16 v[132:135], a[84:87], a[24:27], v[132:135]
  v_mfma_f32_16x16x32_bf16 v[76:79], a[84:87], a[20:23], v[76:79]
  v_mfma_f32_16x16x32_bf16 v[20:23], a[84:87], a[16:19], v[20:23]
  ds_read_b64_tr_b16 a[84:85], v229 offset:14496
  ds_read_b64_tr_b16 a[86:87], v229 offset:18080
  v_mfma_f32_16x16x32_bf16 v[24:27], a[88:91], a[16:19], v[24:27]
  v_mfma_f32_16x16x32_bf16 v[80:83], a[88:91], a[20:23], v[80:83]
  buffer_load_dwordx4 v227, s[8:11], s17 offen offset:2048 lds
  v_mfma_f32_16x16x32_bf16 v[136:139], a[88:91], a[24:27], v[136:139]
  v_mfma_f32_16x16x32_bf16 v[192:195], a[88:91], a[28:31], v[192:195]
  ds_read_b64_tr_b16 a[88:89], v229 offset:14528
  ds_read_b64_tr_b16 a[90:91], v229 offset:18112
  v_mfma_f32_16x16x32_bf16 v[196:199], a[92:95], a[28:31], v[196:199]
  v_mfma_f32_16x16x32_bf16 v[140:143], a[92:95], a[24:27], v[140:143]
  v_mfma_f32_16x16x32_bf16 v[84:87], a[92:95], a[20:23], v[84:87]
  v_mfma_f32_16x16x32_bf16 v[28:31], a[92:95], a[16:19], v[28:31]
  buffer_load_dwordx4 a[8:11], v224, s[4:7], s16 offen offset:2048 sc1
  s_waitcnt lgkmcnt(10)
  v_mfma_f32_16x16x32_bf16 v[32:35], a[96:99], a[16:19], v[32:35]
  ds_read_b64_tr_b16 a[92:93], v229 offset:21504
  ds_read_b64_tr_b16 a[94:95], v229 offset:25088
  v_mfma_f32_16x16x32_bf16 v[88:91], a[96:99], a[20:23], v[88:91]
  v_mfma_f32_16x16x32_bf16 v[144:147], a[96:99], a[24:27], v[144:147]
  v_mfma_f32_16x16x32_bf16 v[200:203], a[96:99], a[28:31], v[200:203]
  ds_read_b64_tr_b16 a[96:97], v229 offset:21536
  ds_read_b64_tr_b16 a[98:99], v229 offset:25120
  v_mfma_f32_16x16x32_bf16 v[204:207], a[100:103], a[28:31], v[204:207]
  v_mfma_f32_16x16x32_bf16 v[148:151], a[100:103], a[24:27], v[148:151]
  s_mov_b32 exec_hi, 0
  buffer_load_dwordx4 v228, s[8:11], s17 offen offset:3072 lds
  s_mov_b32 exec_hi, -1
  v_mfma_f32_16x16x32_bf16 v[92:95], a[100:103], a[20:23], v[92:95]
  s_add_u32 s17, s17, s96
  v_mfma_f32_16x16x32_bf16 v[36:39], a[100:103], a[16:19], v[36:39]
  ds_read_b64_tr_b16 a[100:101], v229 offset:21568
  ds_read_b64_tr_b16 a[102:103], v229 offset:25152
  v_mfma_f32_16x16x32_bf16 v[40:43], a[104:107], a[16:19], v[40:43]
  v_mfma_f32_16x16x32_bf16 v[96:99], a[104:107], a[20:23], v[96:99]
  v_mfma_f32_16x16x32_bf16 v[152:155], a[104:107], a[24:27], v[152:155]
  v_mfma_f32_16x16x32_bf16 v[208:211], a[104:107], a[28:31], v[208:211]
  buffer_load_dwordx4 a[12:15], v224, s[4:7], s16 offen offset:3072 sc1
  v_mfma_f32_16x16x32_bf16 v[212:215], a[108:111], a[28:31], v[212:215]
  ds_read_b64_tr_b16 a[104:105], v229 offset:21600
  s_add_u32 s16, s16, s44
  v_mfma_f32_16x16x32_bf16 v[156:159], a[108:111], a[24:27], v[156:159]
  ds_read_b64_tr_b16 a[106:107], v229 offset:25184
  v_mfma_f32_16x16x32_bf16 v[100:103], a[108:111], a[20:23], v[100:103]
  v_mfma_f32_16x16x32_bf16 v[44:47], a[108:111], a[16:19], v[44:47]
  ds_read_b64_tr_b16 a[108:109], v229 offset:21632
  ds_read_b64_tr_b16 a[110:111], v229 offset:25216
  v_mfma_f32_16x16x32_bf16 v[48:51], a[112:115], a[16:19], v[48:51]
  v_mfma_f32_16x16x32_bf16 v[104:107], a[112:115], a[20:23], v[104:107]
  buffer_load_dword v251, v249, s[52:55], s56 offen
  v_mfma_f32_16x16x32_bf16 v[160:163], a[112:115], a[24:27], v[160:163]
  s_add_u32 s56, s56, 524288
  v_mfma_f32_16x16x32_bf16 v[216:219], a[112:115], a[28:31], v[216:219]
  ds_read_b64_tr_b16 a[112:113], v229 offset:21664
  ds_read_b64_tr_b16 a[114:115], v229 offset:25248
  v_mfma_f32_16x16x32_bf16 v[220:223], a[116:119], a[28:31], v[220:223]
  v_mfma_f32_16x16x32_bf16 v[164:167], a[116:119], a[24:27], v[164:167]
  v_mfma_f32_16x16x32_bf16 v[108:111], a[116:119], a[20:23], v[108:111]
  v_mfma_f32_16x16x32_bf16 v[52:55], a[116:119], a[16:19], v[52:55]
  s_waitcnt vmcnt(13) lgkmcnt(10)
  s_barrier
  v_mfma_f32_16x16x32_bf16 v[0:3], a[64:67], a[32:35], v[0:3]
  ds_read_b64_tr_b16 a[116:117], v229 offset:21696
  s_add_u32 m0, s38, 0
  v_mfma_f32_16x16x32_bf16 v[56:59], a[64:67], a[36:39], v[56:59]
  buffer_load_dwordx4 v225, s[8:11], s17 offen lds
  v_mfma_f32_16x16x32_bf16 v[112:115], a[64:67], a[40:43], v[112:115]
  ds_read_b64_tr_b16 a[118:119], v229 offset:25280
  v_mfma_f32_16x16x32_bf16 v[168:171], a[64:67], a[44:47], v[168:171]
  ds_read_b64_tr_b16 a[64:65], v229 offset:28672
  ds_read_b64_tr_b16 a[66:67], v229 offset:32256
  v_mfma_f32_16x16x32_bf16 v[172:175], a[68:71], a[44:47], v[172:175]
  v_mfma_f32_16x16x32_bf16 v[116:119], a[68:71], a[40:43], v[116:119]
  v_mfma_f32_16x16x32_bf16 v[60:63], a[68:71], a[36:39], v[60:63]
  v_mfma_f32_16x16x32_bf16 v[4:7], a[68:71], a[32:35], v[4:7]
  buffer_load_dwordx4 a[16:19], v224, s[4:7], s16 offen offset:0 sc1
  v_mfma_f32_16x16x32_bf16 v[8:11], a[72:75], a[32:35], v[8:11]
  ds_read_b64_tr_b16 a[68:69], v229 offset:28704
  ds_read_b64_tr_b16 a[70:71], v229 offset:32288
  v_mfma_f32_16x16x32_bf16 v[64:67], a[72:75], a[36:39], v[64:67]
  v_mfma_f32_16x16x32_bf16 v[120:123], a[72:75], a[40:43], v[120:123]
  v_mfma_f32_16x16x32_bf16 v[176:179], a[72:75], a[44:47], v[176:179]
  ds_read_b64_tr_b16 a[72:73], v229 offset:28736
  ds_read_b64_tr_b16 a[74:75], v229 offset:32320
  v_mfma_f32_16x16x32_bf16 v[180:183], a[76:79], a[44:47], v[180:183]
  v_mfma_f32_16x16x32_bf16 v[124:127], a[76:79], a[40:43], v[124:127]
  v_mfma_f32_16x16x32_bf16 v[68:71], a[76:79], a[36:39], v[68:71]
  buffer_load_dwordx4 v226, s[8:11], s17 offen offset:1024 lds
  v_mfma_f32_16x16x32_bf16 v[12:15], a[76:79], a[32:35], v[12:15]
  ds_read_b64_tr_b16 a[76:77], v229 offset:28768
  ds_read_b64_tr_b16 a[78:79], v229 offset:32352
  v_mfma_f32_16x16x32_bf16 v[16:19], a[80:83], a[32:35], v[16:19]
  v_mfma_f32_16x16x32_bf16 v[72:75], a[80:83], a[36:39], v[72:75]
  v_mfma_f32_16x16x32_bf16 v[128:131], a[80:83], a[40:43], v[128:131]
  v_mfma_f32_16x16x32_bf16 v[184:187], a[80:83], a[44:47], v[184:187]
  ds_read_b64_tr_b16 a[80:81], v229 offset:28800
  ds_read_b64_tr_b16 a[82:83], v229 offset:32384
  v_mfma_f32_16x16x32_bf16 v[188:191], a[84:87], a[44:47], v[188:191]
  v_mfma_f32_16x16x32_bf16 v[132:135], a[84:87], a[40:43], v[132:135]
  buffer_load_dwordx4 a[20:23], v224, s[4:7], s16 offen offset:1024 sc1
  v_mfma_f32_16x16x32_bf16 v[76:79], a[84:87], a[36:39], v[76:79]
  v_mfma_f32_16x16x32_bf16 v[20:23], a[84:87], a[32:35], v[20:23]
  ds_read_b64_tr_b16 a[84:85], v229 offset:28832
  ds_read_b64_tr_b16 a[86:87], v229 offset:32416
  v_mfma_f32_16x16x32_bf16 v[24:27], a[88:91], a[32:35], v[24:27]
  v_mfma_f32_16x16x32_bf16 v[80:83], a[88:91], a[36:39], v[80:83]
  v_mfma_f32_16x16x32_bf16 v[136:139], a[88:91], a[40:43], v[136:139]
  v_mfma_f32_16x16x32_bf16 v[192:195], a[88:91], a[44:47], v[192:195]
  ds_read_b64_tr_b16 a[88:89], v229 offset:28864
  ds_read_b64_tr_b16 a[90:91], v229 offset:32448
  v_mfma_f32_16x16x32_bf16 v[196:199], a[92:95], a[44:47], v[196:199]
  buffer_load_dwordx4 v227, s[8:11], s17 offen offset:2048 lds
  v_mfma_f32_16x16x32_bf16 v[140:143], a[92:95], a[40:43], v[140:143]
  v_mfma_f32_16x16x32_bf16 v[84:87], a[92:95], a[36:39], v[84:87]
  v_mfma_f32_16x16x32_bf16 v[28:31], a[92:95], a[32:35], v[28:31]
  ds_read_b64_tr_b16 a[92:93], v229 offset:35840
  ds_read_b64_tr_b16 a[94:95], v229 offset:39424
  s_waitcnt lgkmcnt(10)
  v_mfma_f32_16x16x32_bf16 v[32:35], a[96:99], a[32:35], v[32:35]
  v_mfma_f32_16x16x32_bf16 v[88:91], a[96:99], a[36:39], v[88:91]
  v_mfma_f32_16x16x32_bf16 v[144:147], a[96:99], a[40:43], v[144:147]
  v_mfma_f32_16x16x32_bf16 v[200:203], a[96:99], a[44:47], v[200:203]
  buffer_load_dwordx4 a[24:27], v224, s[4:7], s16 offen offset:2048 sc1
  v_mfma_f32_16x16x32_bf16 v[204:207], a[100:103], a[44:47], v[204:207]
  ds_read_b64_tr_b16 a[96:97], v229 offset:35872
  ds_read_b64_tr_b16 a[98:99], v229 offset:39456
  v_mfma_f32_16x16x32_bf16 v[148:151], a[100:103], a[40:43], v[148:151]
  v_mfma_f32_16x16x32_bf16 v[92:95], a[100:103], a[36:39], v[92:95]
  v_mfma_f32_16x16x32_bf16 v[36:39], a[100:103], a[32:35], v[36:39]
  ds_read_b64_tr_b16 a[100:101], v229 offset:35904
  ds_read_b64_tr_b16 a[102:103], v229 offset:39488
  v_mfma_f32_16x16x32_bf16 v[40:43], a[104:107], a[32:35], v[40:43]
  v_mfma_f32_16x16x32_bf16 v[96:99], a[104:107], a[36:39], v[96:99]
  v_mfma_f32_16x16x32_bf16 v[152:155], a[104:107], a[40:43], v[152:155]
  s_mov_b32 exec_hi, 0
  buffer_load_dwordx4 v228, s[8:11], s17 offen offset:3072 lds
  s_mov_b32 exec_hi, -1
  v_mfma_f32_16x16x32_bf16 v[208:211], a[104:107], a[44:47], v[208:211]
  ds_read_b64_tr_b16 a[104:105], v229 offset:35936
  s_add_u32 s17, s17, s97
  v_mfma_f32_16x16x32_bf16 v[212:215], a[108:111], a[44:47], v[212:215]
  ds_read_b64_tr_b16 a[106:107], v229 offset:39520
  v_mfma_f32_16x16x32_bf16 v[156:159], a[108:111], a[40:43], v[156:159]
  v_mfma_f32_16x16x32_bf16 v[100:103], a[108:111], a[36:39], v[100:103]
  v_mfma_f32_16x16x32_bf16 v[44:47], a[108:111], a[32:35], v[44:47]
  ds_read_b64_tr_b16 a[108:109], v229 offset:35968
  ds_read_b64_tr_b16 a[110:111], v229 offset:39552
  v_mfma_f32_16x16x32_bf16 v[48:51], a[112:115], a[32:35], v[48:51]
  v_mfma_f32_16x16x32_bf16 v[104:107], a[112:115], a[36:39], v[104:107]
  buffer_load_dwordx4 a[28:31], v224, s[4:7], s16 offen offset:3072 sc1
  v_mfma_f32_16x16x32_bf16 v[160:163], a[112:115], a[40:43], v[160:163]
  s_add_u32 s16, s16, s45
  v_mfma_f32_16x16x32_bf16 v[216:219], a[112:115], a[44:47], v[216:219]
  ds_read_b64_tr_b16 a[112:113], v229 offset:36000
  ds_read_b64_tr_b16 a[114:115], v229 offset:39584
  v_mfma_f32_16x16x32_bf16 v[220:223], a[116:119], a[44:47], v[220:223]
  v_mfma_f32_16x16x32_bf16 v[164:167], a[116:119], a[40:43], v[164:167]
  v_mfma_f32_16x16x32_bf16 v[108:111], a[116:119], a[36:39], v[108:111]
  v_mfma_f32_16x16x32_bf16 v[52:55], a[116:119], a[32:35], v[52:55]
  s_mov_b32 s18, 6
  .p2align 6
L_loop_24:
  s_waitcnt vmcnt(10) lgkmcnt(10)
  s_barrier
  v_mfma_f32_16x16x32_bf16 v[0:3], a[64:67], a[48:51], v[0:3]
  ds_read_b64_tr_b16 a[116:117], v229 offset:36032
  s_add_u32 m0, s38, 14336
  v_mfma_f32_16x16x32_bf16 v[56:59], a[64:67], a[52:55], v[56:59]
  buffer_load_dwordx4 v225, s[8:11], s17 offen lds
  v_mfma_f32_16x16x32_bf16 v[112:115], a[64:67], a[56:59], v[112:115]
  ds_read_b64_tr_b16 a[118:119], v229 offset:39616
  v_mfma_f32_16x16x32_bf16 v[168:171], a[64:67], a[60:63], v[168:171]
  ds_read_b64_tr_b16 a[64:65], v229 offset:43008
  ds_read_b64_tr_b16 a[66:67], v229 offset:46592
  v_mfma_f32_16x16x32_bf16 v[172:175], a[68:71], a[60:63], v[172:175]
  v_mfma_f32_16x16x32_bf16 v[116:119], a[68:71], a[56:59], v[116:119]
  v_mfma_f32_16x16x32_bf16 v[60:63], a[68:71], a[52:55], v[60:63]
  v_mfma_f32_16x16x32_bf16 v[4:7], a[68:71], a[48:51], v[4:7]
  buffer_load_dwordx4 a[32:35], v224, s[4:7], s16 offen offset:0 sc1
  v_mfma_f32_16x16x32_bf16 v[8:11], a[72:75], a[48:51], v[8:11]
  ds_read_b64_tr_b16 a[68:69], v229 offset:43040
  ds_read_b64_tr_b16 a[70:71], v229 offset:46624
  v_mfma_f32_16x16x32_bf16 v[64:67], a[72:75], a[52:55], v[64:67]
  v_mfma_f32_16x16x32_bf16 v[120:123], a[72:75], a[56:59], v[120:123]
  v_mfma_f32_16x16x32_bf16 v[176:179], a[72:75], a[60:63], v[176:179]
  ds_read_b64_tr_b16 a[72:73], v229 offset:43072
  ds_read_b64_tr_b16 a[74:75], v229 offset:46656
  v_mfma_f32_16x16x32_bf16 v[180:183], a[76:79], a[60:63], v[180:183]
  v_mfma_f32_16x16x32_bf16 v[124:127], a[76:79], a[56:59], v[124:127]
  v_mfma_f32_16x16x32_bf16 v[68:71], a[76:79], a[52:55], v[68:71]
  buffer_load_dwordx4 v226, s[8:11], s17 offen offset:1024 lds
  v_mfma_f32_16x16x32_bf16 v[12:15], a[76:79], a[48:51], v[12:15]
  ds_read_b64_tr_b16 a[76:77], v229 offset:43104
  ds_read_b64_tr_b16 a[78:79], v229 offset:46688
  v_mfma_f32_16x16x32_bf16 v[16:19], a[80:83], a[48:51], v[16:19]
  v_mfma_f32_16x16x32_bf16 v[72:75], a[80:83], a[52:55], v[72:75]
  v_mfma_f32_16x16x32_bf16 v[128:131], a[80:83], a[56:59], v[128:131]
  v_mfma_f32_16x16x32_bf16 v[184:187], a[80:83], a[60:63], v[184:187]
  ds_read_b64_tr_b16 a[80:81], v229 offset:43136
  ds_read_b64_tr_b16 a[82:83], v229 offset:46720
  v_mfma_f32_16x16x32_bf16 v[188:191], a[84:87], a[60:63], v[188:191]
  v_mfma_f32_16x16x32_bf16 v[132:135], a[84:87], a[56:59], v[132:135]
  buffer_load_dwordx4 a[36:39], v224, s[4:7], s16 offen offset:1024 sc1
  v_mfma_f32_16x16x32_bf16 v[76:79], a[84:87], a[52:55], v[76:79]
  v_mfma_f32_16x16x32_bf16 v[20:23], a[84:87], a[48:51], v[20:23]
  ds_read_b64_tr_b16 a[84:85], v229 offset:43168
  ds_read_b64_tr_b16 a[86:87], v229 offset:46752
  v_mfma_f32_16x16x32_bf16 v[24:27], a[88:91], a[48:51], v[24:27]
  v_mfma_f32_16x16x32_bf16 v[80:83], a[88:91], a[52:55], v[80:83]
  v_mfma_f32_16x16x32_bf16 v[136:139], a[88:91], a[56:59], v[136:139]
  v_mfma_f32_16x16x32_bf16 v[192:195], a[88:91], a[60:63], v[192:195]
  ds_read_b64_tr_b16 a[88:89], v229 offset:43200
  ds_read_b64_tr_b16 a[90:91], v229 offset:46784
  v_mfma_f32_16x16x32_bf16 v[196:199], a[92:95], a[60:63], v[196:199]
  buffer_load_dwordx4 v227, s[8:11], s17 offen offset:2048 lds
  v_mfma_f32_16x16x32_bf16 v[140:143], a[92:95], a[56:59], v[140:143]
  v_mfma_f32_16x16x32_bf16 v[84:87], a[92:95], a[52:55], v[84:87]
  v_mfma_f32_16x16x32_bf16 v[28:31], a[92:95], a[48:51], v[28:31]
  ds_read_b64_tr_b16 a[92:93], v229 offset:50176
  ds_read_b64_tr_b16 a[94:95], v229 offset:53760
  s_waitcnt lgkmcnt(10)
  v_mfma_f32_16x16x32_bf16 v[32:35], a[96:99], a[48:51], v[32:35]
  v_mfma_f32_16x16x32_bf16 v[88:91], a[96:99], a[52:55], v[88:91]
  v_mfma_f32_16x16x32_bf16 v[144:147], a[96:99], a[56:59], v[144:147]
  v_mfma_f32_16x16x32_bf16 v[200:203], a[96:99], a[60:63], v[200:203]
  buffer_load_dwordx4 a[40:43], v224, s[4:7], s16 offen offset:2048 sc1
  v_mfma_f32_16x16x32_bf16 v[204:207], a[100:103], a[60:63], v[204:207]
  ds_read_b64_tr_b16 a[96:97], v229 offset:50208
  ds_read_b64_tr_b16 a[98:99], v229 offset:53792
  v_mfma_f32_16x16x32_bf16 v[148:151], a[100:103], a[56:59], v[148:151]
  v_mfma_f32_16x16x32_bf16 v[92:95], a[100:103], a[52:55], v[92:95]
  v_mfma_f32_16x16x32_bf16 v[36:39], a[100:103], a[48:51], v[36:39]
  ds_read_b64_tr_b16 a[100:101], v229 offset:50240
  ds_read_b64_tr_b16 a[102:103], v229 offset:53824
  v_mfma_f32_16x16x32_bf16 v[40:43], a[104:107], a[48:51], v[40:43]
  v_mfma_f32_16x16x32_bf16 v[96:99], a[104:107], a[52:55], v[96:99]
  v_mfma_f32_16x16x32_bf16 v[152:155], a[104:107], a[56:59], v[152:155]
  s_mov_b32 exec_hi, 0
  buffer_load_dwordx4 v228, s[8:11], s17 offen offset:3072 lds
  s_mov_b32 exec_hi, -1
  v_mfma_f32_16x16x32_bf16 v[208:211], a[104:107], a[60:63], v[208:211]
  ds_read_b64_tr_b16 a[104:105], v229 offset:50272
  s_add_u32 s17, s17, s98
  v_mfma_f32_16x16x32_bf16 v[212:215], a[108:111], a[60:63], v[212:215]
  ds_read_b64_tr_b16 a[106:107], v229 offset:53856
  v_mfma_f32_16x16x32_bf16 v[156:159], a[108:111], a[56:59], v[156:159]
  v_mfma_f32_16x16x32_bf16 v[100:103], a[108:111], a[52:55], v[100:103]
  v_mfma_f32_16x16x32_bf16 v[44:47], a[108:111], a[48:51], v[44:47]
  ds_read_b64_tr_b16 a[108:109], v229 offset:50304
  ds_read_b64_tr_b16 a[110:111], v229 offset:53888
  v_mfma_f32_16x16x32_bf16 v[48:51], a[112:115], a[48:51], v[48:51]
  v_mfma_f32_16x16x32_bf16 v[104:107], a[112:115], a[52:55], v[104:107]
  buffer_load_dwordx4 a[44:47], v224, s[4:7], s16 offen offset:3072 sc1
  v_mfma_f32_16x16x32_bf16 v[160:163], a[112:115], a[56:59], v[160:163]
  s_add_u32 s16, s16, s46
  v_mfma_f32_16x16x32_bf16 v[216:219], a[112:115], a[60:63], v[216:219]
  ds_read_b64_tr_b16 a[112:113], v229 offset:50336
  ds_read_b64_tr_b16 a[114:115], v229 offset:53920
  v_mfma_f32_16x16x32_bf16 v[220:223], a[116:119], a[60:63], v[220:223]
  v_mfma_f32_16x16x32_bf16 v[164:167], a[116:119], a[56:59], v[164:167]
  v_mfma_f32_16x16x32_bf16 v[108:111], a[116:119], a[52:55], v[108:111]
  v_mfma_f32_16x16x32_bf16 v[52:55], a[116:119], a[48:51], v[52:55]
  s_waitcnt vmcnt(9) lgkmcnt(10)
  s_barrier
  v_mfma_f32_16x16x32_bf16 v[0:3], a[64:67], a[0:3], v[0:3]
  ds_read_b64_tr_b16 a[116:117], v229 offset:50368
  s_add_u32 m0, s38, 28672
  v_mfma_f32_16x16x32_bf16 v[56:59], a[64:67], a[4:7], v[56:59]
  buffer_load_dwordx4 v225, s[8:11], s17 offen lds
  v_mfma_f32_16x16x32_bf16 v[112:115], a[64:67], a[8:11], v[112:115]
  ds_read_b64_tr_b16 a[118:119], v229 offset:53952
  v_mfma_f32_16x16x32_bf16 v[168:171], a[64:67], a[12:15], v[168:171]
  ds_read_b64_tr_b16 a[64:65], v229 offset:0
  ds_read_b64_tr_b16 a[66:67], v229 offset:3584
  v_mfma_f32_16x16x32_bf16 v[172:175], a[68:71], a[12:15], v[172:175]
  v_mfma_f32_16x16x32_bf16 v[116:119], a[68:71], a[8:11], v[116:119]
  v_mfma_f32_16x16x32_bf16 v[60:63], a[68:71], a[4:7], v[60:63]
  v_mfma_f32_16x16x32_bf16 v[4:7], a[68:71], a[0:3], v[4:7]
  buffer_load_dwordx4 a[48:51], v224, s[4:7], s16 offen offset:0 sc1
  v_mfma_f32_16x16x32_bf16 v[8:11], a[72:75], a[0:3], v[8:11]
  ds_read_b64_tr_b16 a[68:69], v229 offset:32
  ds_read_b64_tr_b16 a[70:71], v229 offset:3616
  v_mfma_f32_16x16x32_bf16 v[64:67], a[72:75], a[4:7], v[64:67]
  v_mfma_f32_16x16x32_bf16 v[120:123], a[72:75], a[8:11], v[120:123]
  v_mfma_f32_16x16x32_bf16 v[176:179], a[72:75], a[12:15], v[176:179]
  ds_read_b64_tr_b16 a[72:73], v229 offset:64
  ds_read_b64_tr_b16 a[74:75], v229 offset:3648
  v_mfma_f32_16x16x32_bf16 v[180:183], a[76:79], a[12:15], v[180:183]
  v_mfma_f32_16x16x32_bf16 v[124:127], a[76:79], a[8:11], v[124:127]
  v_mfma_f32_16x16x32_bf16 v[68:71], a[76:79], a[4:7], v[68:71]
  buffer_load_dwordx4 v226, s[8:11], s17 offen offset:1024 lds
  v_mfma_f32_16x16x32_bf16 v[12:15], a[76:79], a[0:3], v[12:15]
  ds_read_b64_tr_b16 a[76:77], v229 offset:96
  ds_read_b64_tr_b16 a[78:79], v229 offset:3680
  v_mfma_f32_16x16x32_bf16 v[16:19], a[80:83], a[0:3], v[16:19]
  v_mfma_f32_16x16x32_bf16 v[72:75], a[80:83], a[4:7], v[72:75]
  v_mfma_f32_16x16x32_bf16 v[128:131], a[80:83], a[8:11], v[128:131]
  v_mfma_f32_16x16x32_bf16 v[184:187], a[80:83], a[12:15], v[184:187]
  ds_read_b64_tr_b16 a[80:81], v229 offset:128
  ds_read_b64_tr_b16 a[82:83], v229 offset:3712
  v_mfma_f32_16x16x32_bf16 v[188:191], a[84:87], a[12:15], v[188:191]
  v_mfma_f32_16x16x32_bf16 v[132:135], a[84:87], a[8:11], v[132:135]
  buffer_load_dwordx4 a[52:55], v224, s[4:7], s16 offen offset:1024 sc1
  v_mfma_f32_16x16x32_bf16 v[76:79], a[84:87], a[4:7], v[76:79]
  v_mfma_f32_16x16x32_bf16 v[20:23], a[84:87], a[0:3], v[20:23]
  ds_read_b64_tr_b16 a[84:85], v229 offset:160
  ds_read_b64_tr_b16 a[86:87], v229 offset:3744
  v_mfma_f32_16x16x32_bf16 v[24:27], a[88:91], a[0:3], v[24:27]
  v_mfma_f32_16x16x32_bf16 v[80:83], a[88:91], a[4:7], v[80:83]
  v_mfma_f32_16x16x32_bf16 v[136:139], a[88:91], a[8:11], v[136:139]
  v_mfma_f32_16x16x32_bf16 v[192:195], a[88:91], a[12:15], v[192:195]
  ds_read_b64_tr_b16 a[88:89], v229 offset:192
  ds_read_b64_tr_b16 a[90:91], v229 offset:3776
  v_mfma_f32_16x16x32_bf16 v[196:199], a[92:95], a[12:15], v[196:199]
  buffer_load_dwordx4 v227, s[8:11], s17 offen offset:2048 lds
  v_mfma_f32_16x16x32_bf16 v[140:143], a[92:95], a[8:11], v[140:143]
  v_mfma_f32_16x16x32_bf16 v[84:87], a[92:95], a[4:7], v[84:87]
  v_mfma_f32_16x16x32_bf16 v[28:31], a[92:95], a[0:3], v[28:31]
  ds_read_b64_tr_b16 a[92:93], v229 offset:7168
  ds_read_b64_tr_b16 a[94:95], v229 offset:10752
  s_waitcnt lgkmcnt(10)
  v_mfma_f32_16x16x32_bf16 v[32:35], a[96:99], a[0:3], v[32:35]
  v_mfma_f32_16x16x32_bf16 v[88:91], a[96:99], a[4:7], v[88:91]
  v_mfma_f32_16x16x32_bf16 v[144:147], a[96:99], a[8:11], v[144:147]
  v_mfma_f32_16x16x32_bf16 v[200:203], a[96:99], a[12:15], v[200:203]
  buffer_load_dwordx4 a[56:59], v224, s[4:7], s16 offen offset:2048 sc1
  v_mfma_f32_16x16x32_bf16 v[204:207], a[100:103], a[12:15], v[204:207]
  ds_read_b64_tr_b16 a[96:97], v229 offset:7200
  ds_read_b64_tr_b16 a[98:99], v229 offset:10784
  v_mfma_f32_16x16x32_bf16 v[148:151], a[100:103], a[8:11], v[148:151]
  v_mfma_f32_16x16x32_bf16 v[92:95], a[100:103], a[4:7], v[92:95]
  v_mfma_f32_16x16x32_bf16 v[36:39], a[100:103], a[0:3], v[36:39]
  ds_read_b64_tr_b16 a[100:101], v229 offset:7232
  ds_read_b64_tr_b16 a[102:103], v229 offset:10816
  v_mfma_f32_16x16x32_bf16 v[40:43], a[104:107], a[0:3], v[40:43]
  v_mfma_f32_16x16x32_bf16 v[96:99], a[104:107], a[4:7], v[96:99]
  v_mfma_f32_16x16x32_bf16 v[152:155], a[104:107], a[8:11], v[152:155]
  s_mov_b32 exec_hi, 0
  buffer_load_dwordx4 v228, s[8:11], s17 offen offset:3072 lds
  s_mov_b32 exec_hi, -1
  v_mfma_f32_16x16x32_bf16 v[208:211], a[104:107], a[12:15], v[208:211]
  ds_read_b64_tr_b16 a[104:105], v229 offset:7264
  s_add_u32 s17, s17, s99
  v_mfma_f32_16x16x32_bf16 v[212:215], a[108:111], a[12:15], v[212:215]
  ds_read_b64_tr_b16 a[106:107], v229 offset:10848
  v_mfma_f32_16x16x32_bf16 v[156:159], a[108:111], a[8:11], v[156:159]
  v_mfma_f32_16x16x32_bf16 v[100:103], a[108:111], a[4:7], v[100:103]
  v_mfma_f32_16x16x32_bf16 v[44:47], a[108:111], a[0:3], v[44:47]
  ds_read_b64_tr_b16 a[108:109], v229 offset:7296
  ds_read_b64_tr_b16 a[110:111], v229 offset:10880
  v_mfma_f32_16x16x32_bf16 v[48:51], a[112:115], a[0:3], v[48:51]
  v_mfma_f32_16x16x32_bf16 v[104:107], a[112:115], a[4:7], v[104:107]
  buffer_load_dwordx4 a[60:63], v224, s[4:7], s16 offen offset:3072 sc1
  v_mfma_f32_16x16x32_bf16 v[160:163], a[112:115], a[8:11], v[160:163]
  s_add_u32 s16, s16, s47
  v_mfma_f32_16x16x32_bf16 v[216:219], a[112:115], a[12:15], v[216:219]
  ds_read_b64_tr_b16 a[112:113], v229 offset:7328
  ds_read_b64_tr_b16 a[114:115], v229 offset:10912
  v_mfma_f32_16x16x32_bf16 v[220:223], a[116:119], a[12:15], v[220:223]
  v_mfma_f32_16x16x32_bf16 v[164:167], a[116:119], a[8:11], v[164:167]
  v_mfma_f32_16x16x32_bf16 v[108:111], a[116:119], a[4:7], v[108:111]
  v_mfma_f32_16x16x32_bf16 v[52:55], a[116:119], a[0:3], v[52:55]
  s_waitcnt vmcnt(9) lgkmcnt(10)
  s_barrier
  v_mfma_f32_16x16x32_bf16 v[0:3], a[64:67], a[16:19], v[0:3]
  ds_read_b64_tr_b16 a[116:117], v229 offset:7360
  s_add_u32 m0, s38, 43008
  v_mfma_f32_16x16x32_bf16 v[56:59], a[64:67], a[20:23], v[56:59]
  buffer_load_dwordx4 v225, s[8:11], s17 offen lds
  v_mfma_f32_16x16x32_bf16 v[112:115], a[64:67], a[24:27], v[112:115]
  ds_read_b64_tr_b16 a[118:119], v229 offset:10944
  v_mfma_f32_16x16x32_bf16 v[168:171], a[64:67], a[28:31], v[168:171]
  ds_read_b64_tr_b16 a[64:65], v229 offset:14336
  ds_read_b64_tr_b16 a[66:67], v229 offset:17920
  v_mfma_f32_16x16x32_bf16 v[172:175], a[68:71], a[28:31], v[172:175]
  v_mfma_f32_16x16x32_bf16 v[116:119], a[68:71], a[24:27], v[116:119]
  v_mfma_f32_16x16x32_bf16 v[60:63], a[68:71], a[20:23], v[60:63]
  v_mfma_f32_16x16x32_bf16 v[4:7], a[68:71], a[16:19], v[4:7]
  buffer_load_dwordx4 a[0:3], v224, s[4:7], s16 offen offset:0 sc1
  v_mfma_f32_16x16x32_bf16 v[8:11], a[72:75], a[16:19], v[8:11]
  ds_read_b64_tr_b16 a[68:69], v229 offset:14368
  ds_read_b64_tr_b16 a[70:71], v229 offset:17952
  v_mfma_f32_16x16x32_bf16 v[64:67], a[72:75], a[20:23], v[64:67]
  v_mfma_f32_16x16x32_bf16 v[120:123], a[72:75], a[24:27], v[120:123]
  v_mfma_f32_16x16x32_bf16 v[176:179], a[72:75], a[28:31], v[176:179]
  ds_read_b64_tr_b16 a[72:73], v229 offset:14400
  ds_read_b64_tr_b16 a[74:75], v229 offset:17984
  v_mfma_f32_16x16x32_bf16 v[180:183], a[76:79], a[28:31], v[180:183]
  v_mfma_f32_16x16x32_bf16 v[124:127], a[76:79], a[24:27], v[124:127]
  buffer_load_dwordx4 v226, s[8:11], s17 offen offset:1024 lds
  v_mfma_f32_16x16x32_bf16 v[68:71], a[76:79], a[20:23], v[68:71]
  v_mfma_f32_16x16x32_bf16 v[12:15], a[76:79], a[16:19], v[12:15]
  ds_read_b64_tr_b16 a[76:77], v229 offset:14432
  ds_read_b64_tr_b16 a[78:79], v229 offset:18016
  v_mfma_f32_16x16x32_bf16 v[16:19], a[80:83], a[16:19], v[16:19]
  v_mfma_f32_16x16x32_bf16 v[72:75], a[80:83], a[20:23], v[72:75]
  v_mfma_f32_16x16x32_bf16 v[128:131], a[80:83], a[24:27], v[128:131]
  v_mfma_f32_16x16x32_bf16 v[184:187], a[80:83], a[28:31], v[184:187]
  buffer_load_dwordx4 a[4:7], v224, s[4:7], s16 offen offset:1024 sc1
  v_mfma_f32_16x16x32_bf16 v[188:191], a[84:87], a[28:31], v[188:191]
  ds_read_b64_tr_b16 a[80:81], v229 offset:14464
  ds_read_b64_tr_b16 a[82:83], v229 offset:18048
  v_mfma_f32_16x16x32_bf16 v[132:135], a[84:87], a[24:27], v[132:135]
  v_mfma_f32_16x16x32_bf16 v[76:79], a[84:87], a[20:23], v[76:79]
  v_mfma_f32_16x16x32_bf16 v[20:23], a[84:87], a[16:19], v[20:23]
  ds_read_b64_tr_b16 a[84:85], v229 offset:14496
  ds_read_b64_tr_b16 a[86:87], v229 offset:18080
  v_mfma_f32_16x16x32_bf16 v[24:27], a[88:91], a[16:19], v[24:27]
  v_mfma_f32_16x16x32_bf16 v[80:83], a[88:91], a[20:23], v[80:83]
  buffer_load_dwordx4 v227, s[8:11], s17 offen offset:2048 lds
  v_mfma_f32_16x16x32_bf16 v[136:139], a[88:91], a[24:27], v[136:139]
  v_mfma_f32_16x16x32_bf16 v[192:195], a[88:91], a[28:31], v[192:195]
  ds_read_b64_tr_b16 a[88:89], v229 offset:14528
  ds_read_b64_tr_b16 a[90:91], v229 offset:18112
  v_mfma_f32_16x16x32_bf16 v[196:199], a[92:95], a[28:31], v[196:199]
  v_mfma_f32_16x16x32_bf16 v[140:143], a[92:95], a[24:27], v[140:143]
  v_mfma_f32_16x16x32_bf16 v[84:87], a[92:95], a[20:23], v[84:87]
  v_mfma_f32_16x16x32_bf16 v[28:31], a[92:95], a[16:19], v[28:31]
  buffer_load_dwordx4 a[8:11], v224, s[4:7], s16 offen offset:2048 sc1
  s_waitcnt lgkmcnt(10)
  v_mfma_f32_16x16x32_bf16 v[32:35], a[96:99], a[16:19], v[32:35]
  ds_read_b64_tr_b16 a[92:93], v229 offset:21504
  ds_read_b64_tr_b16 a[94:95], v229 offset:25088
  v_mfma_f32_16x16x32_bf16 v[88:91], a[96:99], a[20:23], v[88:91]
  v_mfma_f32_16x16x32_bf16 v[144:147], a[96:99], a[24:27], v[144:147]
  v_mfma_f32_16x16x32_bf16 v[200:203], a[96:99], a[28:31], v[200:203]
  ds_read_b64_tr_b16 a[96:97], v229 offset:21536
  ds_read_b64_tr_b16 a[98:99], v229 offset:25120
  v_mfma_f32_16x16x32_bf16 v[204:207], a[100:103], a[28:31], v[204:207]
  v_mfma_f32_16x16x32_bf16 v[148:151], a[100:103], a[24:27], v[148:151]
  s_mov_b32 exec_hi, 0
  buffer_load_dwordx4 v228, s[8:11], s17 offen offset:3072 lds
  s_mov_b32 exec_hi, -1
  v_mfma_f32_16x16x32_bf16 v[92:95], a[100:103], a[20:23], v[92:95]
  s_add_u32 s17, s17, s96
  v_mfma_f32_16x16x32_bf16 v[36:39], a[100:103], a[16:19], v[36:39]
  ds_read_b64_tr_b16 a[100:101], v229 offset:21568
  ds_read_b64_tr_b16 a[102:103], v229 offset:25152
  v_mfma_f32_16x16x32_bf16 v[40:43], a[104:107], a[16:19], v[40:43]
  v_mfma_f32_16x16x32_bf16 v[96:99], a[104:107], a[20:23], v[96:99]
  v_mfma_f32_16x16x32_bf16 v[152:155], a[104:107], a[24:27], v[152:155]
  v_mfma_f32_16x16x32_bf16 v[208:211], a[104:107], a[28:31], v[208:211]
  buffer_load_dwordx4 a[12:15], v224, s[4:7], s16 offen offset:3072 sc1
  v_mfma_f32_16x16x32_bf16 v[212:215], a[108:111], a[28:31], v[212:215]
  ds_read_b64_tr_b16 a[104:105], v229 offset:21600
  s_add_u32 s16, s16, s44
  v_mfma_f32_16x16x32_bf16 v[156:159], a[108:111], a[24:27], v[156:159]
  ds_read_b64_tr_b16 a[106:107], v229 offset:25184
  v_mfma_f32_16x16x32_bf16 v[100:103], a[108:111], a[20:23], v[100:103]
  v_mfma_f32_16x16x32_bf16 v[44:47], a[108:111], a[16:19], v[44:47]
  ds_read_b64_tr_b16 a[108:109], v229 offset:21632
  ds_read_b64_tr_b16 a[110:111], v229 offset:25216
  v_mfma_f32_16x16x32_bf16 v[48:51], a[112:115], a[16:19], v[48:51]
  v_mfma_f32_16x16x32_bf16 v[104:107], a[112:115], a[20:23], v[104:107]
  buffer_load_dword v251, v249, s[52:55], s56 offen
  v_mfma_f32_16x16x32_bf16 v[160:163], a[112:115], a[24:27], v[160:163]
  s_add_u32 s56, s56, 524288
  v_mfma_f32_16x16x32_bf16 v[216:219], a[112:115], a[28:31], v[216:219]
  ds_read_b64_tr_b16 a[112:113], v229 offset:21664
  ds_read_b64_tr_b16 a[114:115], v229 offset:25248
  v_mfma_f32_16x16x32_bf16 v[220:223], a[116:119], a[28:31], v[220:223]
  v_mfma_f32_16x16x32_bf16 v[164:167], a[116:119], a[24:27], v[164:167]
  v_mfma_f32_16x16x32_bf16 v[108:111], a[116:119], a[20:23], v[108:111]
  v_mfma_f32_16x16x32_bf16 v[52:55], a[116:119], a[16:19], v[52:55]
  s_waitcnt vmcnt(10) lgkmcnt(10)
  s_barrier
  v_mfma_f32_16x16x32_bf16 v[0:3], a[64:67], a[32:35], v[0:3]
  ds_read_b64_tr_b16 a[116:117], v229 offset:21696
  s_add_u32 m0, s38, 0
  v_mfma_f32_16x16x32_bf16 v[56:59], a[64:67], a[36:39], v[56:59]
  buffer_load_dwordx4 v225, s[8:11], s17 offen lds
  v_mfma_f32_16x16x32_bf16 v[112:115], a[64:67], a[40:43], v[112:115]
  ds_read_b64_tr_b16 a[118:119], v229 offset:25280
  v_mfma_f32_16x16x32_bf16 v[168:171], a[64:67], a[44:47], v[168:171]
  ds_read_b64_tr_b16 a[64:65], v229 offset:28672
  ds_read_b64_tr_b16 a[66:67], v229 offset:32256
  v_mfma_f32_16x16x32_bf16 v[172:175], a[68:71], a[44:47], v[172:175]
  v_mfma_f32_16x16x32_bf16 v[116:119], a[68:71], a[40:43], v[116:119]
  v_mfma_f32_16x16x32_bf16 v[60:63], a[68:71], a[36:39], v[60:63]
  v_mfma_f32_16x16x32_bf16 v[4:7], a[68:71], a[32:35], v[4:7]
  buffer_load_dwordx4 a[16:19], v224, s[4:7], s16 offen offset:0 sc1
  v_mfma_f32_16x16x32_bf16 v[8:11], a[72:75], a[32:35], v[8:11]
  ds_read_b64_tr_b16 a[68:69], v229 offset:28704
  ds_read_b64_tr_b16 a[70:71], v229 offset:32288
  v_mfma_f32_16x16x32_bf16 v[64:67], a[72:75], a[36:39], v[64:67]
  v_mfma_f32_16x16x32_bf16 v[120:123], a[72:75], a[40:43], v[120:123]
  v_mfma_f32_16x16x32_bf16 v[176:179], a[72:75], a[44:47], v[176:179]
  ds_read_b64_tr_b16 a[72:73], v229 offset:28736
  ds_read_b64_tr_b16 a[74:75], v229 offset:32320
  v_mfma_f32_16x16x32_bf16 v[180:183], a[76:79], a[44:47], v[180:183]
  v_mfma_f32_16x16x32_bf16 v[124:127], a[76:79], a[40:43], v[124:127]
  v_mfma_f32_16x16x32_bf16 v[68:71], a[76:79], a[36:39], v[68:71]
  buffer_load_dwordx4 v226, s[8:11], s17 offen offset:1024 lds
  v_mfma_f32_16x16x32_bf16 v[12:15], a[76:79], a[32:35], v[12:15]
  ds_read_b64_tr_b16 a[76:77], v229 offset:28768
  ds_read_b64_tr_b16 a[78:79], v229 offset:32352
  v_mfma_f32_16x16x32_bf16 v[16:19], a[80:83], a[32:35], v[16:19]
  v_mfma_f32_16x16x32_bf16 v[72:75], a[80:83], a[36:39], v[72:75]
  v_mfma_f32_16x16x32_bf16 v[128:131], a[80:83], a[40:43], v[128:131]
  v_mfma_f32_16x16x32_bf16 v[184:187], a[80:83], a[44:47], v[184:187]
  ds_read_b64_tr_b16 a[80:81], v229 offset:28800
  ds_read_b64_tr_b16 a[82:83], v229 offset:32384
  v_mfma_f32_16x16x32_bf16 v[188:191], a[84:87], a[44:47], v[188:191]
  v_mfma_f32_16x16x32_bf16 v[132:135], a[84:87], a[40:43], v[132:135]
  buffer_load_dwordx4 a[20:23], v224, s[4:7], s16 offen offset:1024 sc1
  v_mfma_f32_16x16x32_bf16 v[76:79], a[84:87], a[36:39], v[76:79]
  v_mfma_f32_16x16x32_bf16 v[20:23], a[84:87], a[32:35], v[20:23]
  ds_read_b64_tr_b16 a[84:85], v229 offset:28832
  ds_read_b64_tr_b16 a[86:87], v229 offset:32416
  v_mfma_f32_16x16x32_bf16 v[24:27], a[88:91], a[32:35], v[24:27]
  v_mfma_f32_16x16x32_bf16 v[80:83], a[88:91], a[36:39], v[80:83]
  v_mfma_f32_16x16x32_bf16 v[136:139], a[88:91], a[40:43], v[136:139]
  v_mfma_f32_16x16x32_bf16 v[192:195], a[88:91], a[44:47], v[192:195]
  ds_read_b64_tr_b16 a[88:89], v229 offset:28864
  ds_read_b64_tr_b16 a[90:91], v229 offset:32448
  v_mfma_f32_16x16x32_bf16 v[196:199], a[92:95], a[44:47], v[196:199]
  buffer_load_dwordx4 v227, s[8:11], s17 offen offset:2048 lds
  v_mfma_f32_16x16x32_bf16 v[140:143], a[92:95], a[40:43], v[140:143]
  v_mfma_f32_16x16x32_bf16 v[84:87], a[92:95], a[36:39], v[84:87]
  v_mfma_f32_16x16x32_bf16 v[28:31], a[92:95], a[32:35], v[28:31]
  ds_read_b64_tr_b16 a[92:93], v229 offset:35840
  ds_read_b64_tr_b16 a[94:95], v229 offset:39424
  s_waitcnt lgkmcnt(10)
  v_mfma_f32_16x16x32_bf16 v[32:35], a[96:99], a[32:35], v[32:35]
  v_mfma_f32_16x16x32_bf16 v[88:91], a[96:99], a[36:39], v[88:91]
  v_mfma_f32_16x16x32_bf16 v[144:147], a[96:99], a[40:43], v[144:147]
  v_mfma_f32_16x16x32_bf16 v[200:203], a[96:99], a[44:47], v[200:203]
  buffer_load_dwordx4 a[24:27], v224, s[4:7], s16 offen offset:2048 sc1
  v_mfma_f32_16x16x32_bf16 v[204:207], a[100:103], a[44:47], v[204:207]
  ds_read_b64_tr_b16 a[96:97], v229 offset:35872
  ds_read_b64_tr_b16 a[98:99], v229 offset:39456
  v_mfma_f32_16x16x32_bf16 v[148:151], a[100:103], a[40:43], v[148:151]
  v_mfma_f32_16x16x32_bf16 v[92:95], a[100:103], a[36:39], v[92:95]
  v_mfma_f32_16x16x32_bf16 v[36:39], a[100:103], a[32:35], v[36:39]
  ds_read_b64_tr_b16 a[100:101], v229 offset:35904
  ds_read_b64_tr_b16 a[102:103], v229 offset:39488
  v_mfma_f32_16x16x32_bf16 v[40:43], a[104:107], a[32:35], v[40:43]
  v_mfma_f32_16x16x32_bf16 v[96:99], a[104:107], a[36:39], v[96:99]
  v_mfma_f32_16x16x32_bf16 v[152:155], a[104:107], a[40:43], v[152:155]
  s_mov_b32 exec_hi, 0
  buffer_load_dwordx4 v228, s[8:11], s17 offen offset:3072 lds
  s_mov_b32 exec_hi, -1
  v_mfma_f32_16x16x32_bf16 v[208:211], a[104:107], a[44:47], v[208:211]
  ds_read_b64_tr_b16 a[104:105], v229 offset:35936
  s_add_u32 s17, s17, s97
  v_mfma_f32_16x16x32_bf16 v[212:215], a[108:111], a[44:47], v[212:215]
  ds_read_b64_tr_b16 a[106:107], v229 offset:39520
  v_mfma_f32_16x16x32_bf16 v[156:159], a[108:111], a[40:43], v[156:159]
  v_mfma_f32_16x16x32_bf16 v[100:103], a[108:111], a[36:39], v[100:103]
  v_mfma_f32_16x16x32_bf16 v[44:47], a[108:111], a[32:35], v[44:47]
  ds_read_b64_tr_b16 a[108:109], v229 offset:35968
  ds_read_b64_tr_b16 a[110:111], v229 offset:39552
  v_mfma_f32_16x16x32_bf16 v[48:51], a[112:115], a[32:35], v[48:51]
  v_mfma_f32_16x16x32_bf16 v[104:107], a[112:115], a[36:39], v[104:107]
  buffer_load_dwordx4 a[28:31], v224, s[4:7], s16 offen offset:3072 sc1
  v_mfma_f32_16x16x32_bf16 v[160:163], a[112:115], a[40:43], v[160:163]
  s_add_u32 s16, s16, s45
  v_mfma_f32_16x16x32_bf16 v[216:219], a[112:115], a[44:47], v[216:219]
  ds_read_b64_tr_b16 a[112:113], v229 offset:36000
  ds_read_b64_tr_b16 a[114:115], v229 offset:39584
  v_mfma_f32_16x16x32_bf16 v[220:223], a[116:119], a[44:47], v[220:223]
  v_mfma_f32_16x16x32_bf16 v[164:167], a[116:119], a[40:43], v[164:167]
  v_mfma_f32_16x16x32_bf16 v[108:111], a[116:119], a[36:39], v[108:111]
  v_mfma_f32_16x16x32_bf16 v[52:55], a[116:119], a[32:35], v[52:55]
  s_sub_u32 s18, s18, 1
  s_cmp_lg_u32 s18, 0
  s_cbranch_scc1 L_loop_24
  s_waitcnt vmcnt(10) lgkmcnt(10)
  s_barrier
  v_mfma_f32_16x16x32_bf16 v[0:3], a[64:67], a[48:51], v[0:3]
  ds_read_b64_tr_b16 a[116:117], v229 offset:36032
  s_add_u32 m0, s38, 14336
  v_mfma_f32_16x16x32_bf16 v[56:59], a[64:67], a[52:55], v[56:59]
  buffer_load_dwordx4 v225, s[8:11], s17 offen lds
  v_mfma_f32_16x16x32_bf16 v[112:115], a[64:67], a[56:59], v[112:115]
  ds_read_b64_tr_b16 a[118:119], v229 offset:39616
  v_mfma_f32_16x16x32_bf16 v[168:171], a[64:67], a[60:63], v[168:171]
  ds_read_b64_tr_b16 a[64:65], v229 offset:43008
  ds_read_b64_tr_b16 a[66:67], v229 offset:46592
  v_mfma_f32_16x16x32_bf16 v[172:175], a[68:71], a[60:63], v[172:175]
  v_mfma_f32_16x16x32_bf16 v[116:119], a[68:71], a[56:59], v[116:119]
  v_mfma_f32_16x16x32_bf16 v[60:63], a[68:71], a[52:55], v[60:63]
  v_mfma_f32_16x16x32_bf16 v[4:7], a[68:71], a[48:51], v[4:7]
  buffer_load_dwordx4 a[32:35], v224, s[4:7], s16 offen offset:0 sc1
  v_mfma_f32_16x16x32_bf16 v[8:11], a[72:75], a[48:51], v[8:11]
  ds_read_b64_tr_b16 a[68:69], v229 offset:43040
  ds_read_b64_tr_b16 a[70:71], v229 offset:46624
  v_mfma_f32_16x16x32_bf16 v[64:67], a[72:75], a[52:55], v[64:67]
  v_mfma_f32_16x16x32_bf16 v[120:123], a[72:75], a[56:59], v[120:123]
  v_mfma_f32_16x16x32_bf16 v[176:179], a[72:75], a[60:63], v[176:179]
  ds_read_b64_tr_b16 a[72:73], v229 offset:43072
  ds_read_b64_tr_b16 a[74:75], v229 offset:46656
  v_mfma_f32_16x16x32_bf16 v[180:183], a[76:79], a[60:63], v[180:183]
  v_mfma_f32_16x16x32_bf16 v[124:127], a[76:79], a[56:59], v[124:127]
  v_mfma_f32_16x16x32_bf16 v[68:71], a[76:79], a[52:55], v[68:71]
  buffer_load_dwordx4 v226, s[8:11], s17 offen offset:1024 lds
  v_mfma_f32_16x16x32_bf16 v[12:15], a[76:79], a[48:51], v[12:15]
  ds_read_b64_tr_b16 a[76:77], v229 offset:43104
  ds_read_b64_tr_b16 a[78:79], v229 offset:46688
  v_mfma_f32_16x16x32_bf16 v[16:19], a[80:83], a[48:51], v[16:19]
  v_mfma_f32_16x16x32_bf16 v[72:75], a[80:83], a[52:55], v[72:75]
  v_mfma_f32_16x16x32_bf16 v[128:131], a[80:83], a[56:59], v[128:131]
  v_mfma_f32_16x16x32_bf16 v[184:187], a[80:83], a[60:63], v[184:187]
  ds_read_b64_tr_b16 a[80:81], v229 offset:43136
  ds_read_b64_tr_b16 a[82:83], v229 offset:46720
  v_mfma_f32_16x16x32_bf16 v[188:191], a[84:87], a[60:63], v[188:191]
  v_mfma_f32_16x16x32_bf16 v[132:135], a[84:87], a[56:59], v[132:135]
  buffer_load_dwordx4 a[36:39], v224, s[4:7], s16 offen offset:1024 sc1
  v_mfma_f32_16x16x32_bf16 v[76:79], a[84:87], a[52:55], v[76:79]
  v_mfma_f32_16x16x32_bf16 v[20:23], a[84:87], a[48:51], v[20:23]
  ds_read_b64_tr_b16 a[84:85], v229 offset:43168
  ds_read_b64_tr_b16 a[86:87], v229 offset:46752
  v_mfma_f32_16x16x32_bf16 v[24:27], a[88:91], a[48:51], v[24:27]
  v_mfma_f32_16x16x32_bf16 v[80:83], a[88:91], a[52:55], v[80:83]
  v_mfma_f32_16x16x32_bf16 v[136:139], a[88:91], a[56:59], v[136:139]
  v_mfma_f32_16x16x32_bf16 v[192:195], a[88:91], a[60:63], v[192:195]
  ds_read_b64_tr_b16 a[88:89], v229 offset:43200
  ds_read_b64_tr_b16 a[90:91], v229 offset:46784
  v_mfma_f32_16x16x32_bf16 v[196:199], a[92:95], a[60:63], v[196:199]
  buffer_load_dwordx4 v227, s[8:11], s17 offen offset:2048 lds
  v_mfma_f32_16x16x32_bf16 v[140:143], a[92:95], a[56:59], v[140:143]
  v_mfma_f32_16x16x32_bf16 v[84:87], a[92:95], a[52:55], v[84:87]
  v_mfma_f32_16x16x32_bf16 v[28:31], a[92:95], a[48:51], v[28:31]
  ds_read_b64_tr_b16 a[92:93], v229 offset:50176
  ds_read_b64_tr_b16 a[94:95], v229 offset:53760
  s_waitcnt lgkmcnt(10)
  v_mfma_f32_16x16x32_bf16 v[32:35], a[96:99], a[48:51], v[32:35]
  v_mfma_f32_16x16x32_bf16 v[88:91], a[96:99], a[52:55], v[88:91]
  v_mfma_f32_16x16x32_bf16 v[144:147], a[96:99], a[56:59], v[144:147]
  v_mfma_f32_16x16x32_bf16 v[200:203], a[96:99], a[60:63], v[200:203]
  buffer_load_dwordx4 a[40:43], v224, s[4:7], s16 offen offset:2048 sc1
  v_mfma_f32_16x16x32_bf16 v[204:207], a[100:103], a[60:63], v[204:207]
  ds_read_b64_tr_b16 a[96:97], v229 offset:50208
  ds_read_b64_tr_b16 a[98:99], v229 offset:53792
  v_mfma_f32_16x16x32_bf16 v[148:151], a[100:103], a[56:59], v[148:151]
  v_mfma_f32_16x16x32_bf16 v[92:95], a[100:103], a[52:55], v[92:95]
  v_mfma_f32_16x16x32_bf16 v[36:39], a[100:103], a[48:51], v[36:39]
  ds_read_b64_tr_b16 a[100:101], v229 offset:50240
  ds_read_b64_tr_b16 a[102:103], v229 offset:53824
  v_mfma_f32_16x16x32_bf16 v[40:43], a[104:107], a[48:51], v[40:43]
  v_mfma_f32_16x16x32_bf16 v[96:99], a[104:107], a[52:55], v[96:99]
  v_mfma_f32_16x16x32_bf16 v[152:155], a[104:107], a[56:59], v[152:155]
  s_mov_b32 exec_hi, 0
  buffer_load_dwordx4 v228, s[8:11], s17 offen offset:3072 lds
  s_mov_b32 exec_hi, -1
  v_mfma_f32_16x16x32_bf16 v[208:211], a[104:107], a[60:63], v[208:211]
  ds_read_b64_tr_b16 a[104:105], v229 offset:50272
  s_add_u32 s17, s17, s98
  v_mfma_f32_16x16x32_bf16 v[212:215], a[108:111], a[60:63], v[212:215]
  ds_read_b64_tr_b16 a[106:107], v229 offset:53856
  v_mfma_f32_16x16x32_bf16 v[156:159], a[108:111], a[56:59], v[156:159]
  v_mfma_f32_16x16x32_bf16 v[100:103], a[108:111], a[52:55], v[100:103]
  v_mfma_f32_16x16x32_bf16 v[44:47], a[108:111], a[48:51], v[44:47]
  ds_read_b64_tr_b16 a[108:109], v229 offset:50304
  ds_read_b64_tr_b16 a[110:111], v229 offset:53888
  v_mfma_f32_16x16x32_bf16 v[48:51], a[112:115], a[48:51], v[48:51]
  v_mfma_f32_16x16x32_bf16 v[104:107], a[112:115], a[52:55], v[104:107]
  buffer_load_dwordx4 a[44:47], v224, s[4:7], s16 offen offset:3072 sc1
  v_mfma_f32_16x16x32_bf16 v[160:163], a[112:115], a[56:59], v[160:163]
  s_add_u32 s16, s16, s46
  v_mfma_f32_16x16x32_bf16 v[216:219], a[112:115], a[60:63], v[216:219]
  ds_read_b64_tr_b16 a[112:113], v229 offset:50336
  ds_read_b64_tr_b16 a[114:115], v229 offset:53920
  v_mfma_f32_16x16x32_bf16 v[220:223], a[116:119], a[60:63], v[220:223]
  v_mfma_f32_16x16x32_bf16 v[164:167], a[116:119], a[56:59], v[164:167]
  v_mfma_f32_16x16x32_bf16 v[108:111], a[116:119], a[52:55], v[108:111]
  v_mfma_f32_16x16x32_bf16 v[52:55], a[116:119], a[48:51], v[52:55]
  s_waitcnt vmcnt(9) lgkmcnt(10)
  s_barrier
  v_mfma_f32_16x16x32_bf16 v[0:3], a[64:67], a[0:3], v[0:3]
  ds_read_b64_tr_b16 a[116:117], v229 offset:50368
  s_add_u32 m0, s38, 28672
  v_mfma_f32_16x16x32_bf16 v[56:59], a[64:67], a[4:7], v[56:59]
  buffer_load_dwordx4 v225, s[8:11], s17 offen lds
  v_mfma_f32_16x16x32_bf16 v[112:115], a[64:67], a[8:11], v[112:115]
  ds_read_b64_tr_b16 a[118:119], v229 offset:53952
  v_mfma_f32_16x16x32_bf16 v[168:171], a[64:67], a[12:15], v[168:171]
  ds_read_b64_tr_b16 a[64:65], v229 offset:0
  ds_read_b64_tr_b16 a[66:67], v229 offset:3584
  v_mfma_f32_16x16x32_bf16 v[172:175], a[68:71], a[12:15], v[172:175]
  v_mfma_f32_16x16x32_bf16 v[116:119], a[68:71], a[8:11], v[116:119]
  v_mfma_f32_16x16x32_bf16 v[60:63], a[68:71], a[4:7], v[60:63]
  v_mfma_f32_16x16x32_bf16 v[4:7], a[68:71], a[0:3], v[4:7]
  buffer_load_dwordx4 a[48:51], v224, s[4:7], s16 offen offset:0 sc1
  v_mfma_f32_16x16x32_bf16 v[8:11], a[72:75], a[0:3], v[8:11]
  ds_read_b64_tr_b16 a[68:69], v229 offset:32
  ds_read_b64_tr_b16 a[70:71], v229 offset:3616
  v_mfma_f32_16x16x32_bf16 v[64:67], a[72:75], a[4:7], v[64:67]
  v_mfma_f32_16x16x32_bf16 v[120:123], a[72:75], a[8:11], v[120:123]
  v_mfma_f32_16x16x32_bf16 v[176:179], a[72:75], a[12:15], v[176:179]
  ds_read_b64_tr_b16 a[72:73], v229 offset:64
  ds_read_b64_tr_b16 a[74:75], v229 offset:3648
  v_mfma_f32_16x16x32_bf16 v[180:183], a[76:79], a[12:15], v[180:183]
  v_mfma_f32_16x16x32_bf16 v[124:127], a[76:79], a[8:11], v[124:127]
  buffer_load_dwordx4 v226, s[8:11], s17 offen offset:1024 lds
  v_mfma_f32_16x16x32_bf16 v[68:71], a[76:79], a[4:7], v[68:71]
  v_mfma_f32_16x16x32_bf16 v[12:15], a[76:79], a[0:3], v[12:15]
  ds_read_b64_tr_b16 a[76:77], v229 offset:96
  ds_read_b64_tr_b16 a[78:79], v229 offset:3680
  v_mfma_f32_16x16x32_bf16 v[16:19], a[80:83], a[0:3], v[16:19]
  v_mfma_f32_16x16x32_bf16 v[72:75], a[80:83], a[4:7], v[72:75]
  v_mfma_f32_16x16x32_bf16 v[128:131], a[80:83], a[8:11], v[128:131]
  v_mfma_f32_16x16x32_bf16 v[184:187], a[80:83], a[12:15], v[184:187]
  buffer_load_dwordx4 a[52:55], v224, s[4:7], s16 offen offset:1024 sc1
  v_mfma_f32_16x16x32_bf16 v[188:191], a[84:87], a[12:15], v[188:191]
  ds_read_b64_tr_b16 a[80:81], v229 offset:128
  ds_read_b64_tr_b16 a[82:83], v229 offset:3712
  v_mfma_f32_16x16x32_bf16 v[132:135], a[84:87], a[8:11], v[132:135]
  v_mfma_f32_16x16x32_bf16 v[76:79], a[84:87], a[4:7], v[76:79]
  v_mfma_f32_16x16x32_bf16 v[20:23], a[84:87], a[0:3], v[20:23]
  ds_read_b64_tr_b16 a[84:85], v229 offset:160
  ds_read_b64_tr_b16 a[86:87], v229 offset:3744
  v_mfma_f32_16x16x32_bf16 v[24:27], a[88:91], a[0:3], v[24:27]
  v_mfma_f32_16x16x32_bf16 v[80:83], a[88:91], a[4:7], v[80:83]
  buffer_load_dwordx4 v227, s[8:11], s17 offen offset:2048 lds
  v_mfma_f32_16x16x32_bf16 v[136:139], a[88:91], a[8:11], v[136:139]
  v_mfma_f32_16x16x32_bf16 v[192:195], a[88:91], a[12:15], v[192:195]
  ds_read_b64_tr_b16 a[88:89], v229 offset:192
  ds_read_b64_tr_b16 a[90:91], v229 offset:3776
  v_mfma_f32_16x16x32_bf16 v[196:199], a[92:95], a[12:15], v[196:199]
  v_mfma_f32_16x16x32_bf16 v[140:143], a[92:95], a[8:11], v[140:143]
  v_mfma_f32_16x16x32_bf16 v[84:87], a[92:95], a[4:7], v[84:87]
  v_mfma_f32_16x16x32_bf16 v[28:31], a[92:95], a[0:3], v[28:31]
  buffer_load_dwordx4 a[56:59], v224, s[4:7], s16 offen offset:2048 sc1
  s_waitcnt lgkmcnt(10)
  v_mfma_f32_16x16x32_bf16 v[32:35], a[96:99], a[0:3], v[32:35]
  ds_read_b64_tr_b16 a[92:93], v229 offset:7168
  ds_read_b64_tr_b16 a[94:95], v229 offset:10752
  v_mfma_f32_16x16x32_bf16 v[88:91], a[96:99], a[4:7], v[88:91]
  v_mfma_f32_16x16x32_bf16 v[144:147], a[96:99], a[8:11], v[144:147]
  v_mfma_f32_16x16x32_bf16 v[200:203], a[96:99], a[12:15], v[200:203]
  ds_read_b64_tr_b16 a[96:97], v229 offset:7200
  ds_read_b64_tr_b16 a[98:99], v229 offset:10784
  v_mfma_f32_16x16x32_bf16 v[204:207], a[100:103], a[12:15], v[204:207]
  v_mfma_f32_16x16x32_bf16 v[148:151], a[100:103], a[8:11], v[148:151]
  s_mov_b32 exec_hi, 0
  buffer_load_dwordx4 v228, s[8:11], s17 offen offset:3072 lds
  s_mov_b32 exec_hi, -1
  v_mfma_f32_16x16x32_bf16 v[92:95], a[100:103], a[4:7], v[92:95]
  s_add_u32 s17, s17, s99
  v_mfma_f32_16x16x32_bf16 v[36:39], a[100:103], a[0:3], v[36:39]
  ds_read_b64_tr_b16 a[100:101], v229 offset:7232
  ds_read_b64_tr_b16 a[102:103], v229 offset:10816
  v_mfma_f32_16x16x32_bf16 v[40:43], a[104:107], a[0:3], v[40:43]
  v_mfma_f32_16x16x32_bf16 v[96:99], a[104:107], a[4:7], v[96:99]
  v_mfma_f32_16x16x32_bf16 v[152:155], a[104:107], a[8:11], v[152:155]
  v_mfma_f32_16x16x32_bf16 v[208:211], a[104:107], a[12:15], v[208:211]
  buffer_load_dwordx4 a[60:63], v224, s[4:7], s16 offen offset:3072 sc1
  v_mfma_f32_16x16x32_bf16 v[212:215], a[108:111], a[12:15], v[212:215]
  ds_read_b64_tr_b16 a[104:105], v229 offset:7264
  s_add_u32 s16, s16, s47
  v_mfma_f32_16x16x32_bf16 v[156:159], a[108:111], a[8:11], v[156:159]
  ds_read_b64_tr_b16 a[106:107], v229 offset:10848
  v_mfma_f32_16x16x32_bf16 v[100:103], a[108:111], a[4:7], v[100:103]
  v_mfma_f32_16x16x32_bf16 v[44:47], a[108:111], a[0:3], v[44:47]
  ds_read_b64_tr_b16 a[108:109], v229 offset:7296
  ds_read_b64_tr_b16 a[110:111], v229 offset:10880
  v_mfma_f32_16x16x32_bf16 v[48:51], a[112:115], a[0:3], v[48:51]
  v_mfma_f32_16x16x32_bf16 v[104:107], a[112:115], a[4:7], v[104:107]
  s_getpc_b64 s[52:53]
  L_pc_23:
  s_add_u32 s52, s52, L_k56_seam-L_pc_23
  s_addc_u32 s53, s53, 0
  s_lshr_b32 s56, s2, 3
  s_lshl_b32 s56, s56, 2
  s_add_u32 s56, s56, s3
  s_lshl_b32 s56, s56, 13
  v_lshlrev_b32 v254, 7, v231
  v_add_u32 v254, s56, v254
  v_min_u32 v254, L_code_end-L_k56_seam-4, v254
  v_mov_b32 v255, s53
  v_add_co_u32 v254, vcc, s52, v254
  s_nop 1
  v_addc_co_u32 v255, vcc, 0, v255, vcc
  global_load_dword v251, v[254:255], off
  v_mfma_f32_16x16x32_bf16 v[160:163], a[112:115], a[8:11], v[160:163]
  v_mfma_f32_16x16x32_bf16 v[216:219], a[112:115], a[12:15], v[216:219]
  ds_read_b64_tr_b16 a[112:113], v229 offset:7328
  ds_read_b64_tr_b16 a[114:115], v229 offset:10912
  v_mfma_f32_16x16x32_bf16 v[220:223], a[116:119], a[12:15], v[220:223]
  v_mfma_f32_16x16x32_bf16 v[164:167], a[116:119], a[8:11], v[164:167]
  v_mfma_f32_16x16x32_bf16 v[108:111], a[116:119], a[4:7], v[108:111]
  v_mfma_f32_16x16x32_bf16 v[52:55], a[116:119], a[0:3], v[52:55]
  s_waitcnt vmcnt(10) lgkmcnt(10)
  s_barrier
  s_lshr_b32 s32, s31, 4
  s_mul_i32 s32, s32, 56
  v_mfma_f32_16x16x32_bf16 v[0:3], a[64:67], a[16:19], v[0:3]
  s_and_b32 s33, s31, 15
  s_add_u32 s34, s33, s32
  v_mfma_f32_16x16x32_bf16 v[56:59], a[64:67], a[20:23], v[56:59]
  s_lshl_b32 s98, s34, 17
  s_add_u32 s99, s98, 2097152
  v_mfma_f32_16x16x32_bf16 v[112:115], a[64:67], a[24:27], v[112:115]
  ds_read_b64_tr_b16 a[116:117], v229 offset:7360
  ds_read_b64_tr_b16 a[118:119], v229 offset:10944
  s_add_u32 s100, s98, 4194304
  s_lshr_b32 s34, s33, 1
  v_mfma_f32_16x16x32_bf16 v[168:171], a[64:67], a[28:31], v[168:171]
  s_add_u32 s34, s34, s32
  s_add_u32 s34, s34, 48
  v_mfma_f32_16x16x32_bf16 v[172:175], a[68:71], a[28:31], v[172:175]
  s_lshl_b32 s101, s34, 17
  s_and_b32 s35, s31, 1
  v_mfma_f32_16x16x32_bf16 v[116:119], a[68:71], a[24:27], v[116:119]
  s_lshl_b32 s35, s35, 10
  s_add_u32 s101, s101, s35
  v_mfma_f32_16x16x32_bf16 v[60:63], a[68:71], a[20:23], v[60:63]
  ds_read_b64_tr_b16 a[64:65], v229 offset:14336
  ds_read_b64_tr_b16 a[66:67], v229 offset:17920
  s_lshl_b32 s92, s30, 2
  s_add_u32 s92, s92, s3
  v_mfma_f32_16x16x32_bf16 v[4:7], a[68:71], a[16:19], v[4:7]
  s_lshl_b32 s92, s92, 5
  s_add_u32 s92, s92, s31
  v_mfma_f32_16x16x32_bf16 v[8:11], a[72:75], a[16:19], v[8:11]
  s_lshl_b32 s92, s92, 6
  s_add_u32 s56, s20, 0x80000
  v_mfma_f32_16x16x32_bf16 v[64:67], a[72:75], a[20:23], v[64:67]
  s_addc_u32 s57, s21, 0
  s_mov_b32 s58, 0x30000
  v_mfma_f32_16x16x32_bf16 v[120:123], a[72:75], a[24:27], v[120:123]
  ds_read_b64_tr_b16 a[68:69], v229 offset:14368
  ds_read_b64_tr_b16 a[70:71], v229 offset:17952
  s_mov_b32 s59, 0x20000
  s_and_b32 s28, s2, 1
  v_mfma_f32_16x16x32_bf16 v[176:179], a[72:75], a[28:31], v[176:179]
  s_lshr_b32 s29, s2, 3
  s_bfe_u32 s30, s2, 0x20001
  v_mfma_f32_16x16x32_bf16 v[180:183], a[76:79], a[28:31], v[180:183]
  s_lshl_b32 s30, s30, 2
  s_and_b32 s31, s29, 3
  v_mfma_f32_16x16x32_bf16 v[124:127], a[76:79], a[24:27], v[124:127]
  s_add_u32 s30, s30, s31
  s_lshr_b32 s29, s29, 2
  v_mfma_f32_16x16x32_bf16 v[68:71], a[76:79], a[20:23], v[68:71]
  ds_read_b64_tr_b16 a[72:73], v229 offset:14400
  ds_read_b64_tr_b16 a[74:75], v229 offset:17984
  s_lshl_b32 s31, s29, 1
  s_add_u32 s31, s31, s28
  v_mfma_f32_16x16x32_bf16 v[12:15], a[76:79], a[16:19], v[12:15]
  s_lshl_b32 s94, s30, 1
  s_lshr_b32 s33, s3, 1
  v_mfma_f32_16x16x32_bf16 v[16:19], a[80:83], a[16:19], v[16:19]
  s_add_u32 s94, s94, s33
  s_lshl_b32 s94, s94, 11
  v_mfma_f32_16x16x32_bf16 v[72:75], a[80:83], a[20:23], v[72:75]
  s_lshl_b32 s33, s28, 10
  s_add_u32 s94, s94, s33
  v_mfma_f32_16x16x32_bf16 v[128:131], a[80:83], a[24:27], v[128:131]
  ds_read_b64_tr_b16 a[76:77], v229 offset:14432
  ds_read_b64_tr_b16 a[78:79], v229 offset:18016
  v_and_b32 v246, 15, v231
  v_lshlrev_b32 v246, 6, v246
  v_mfma_f32_16x16x32_bf16 v[184:187], a[80:83], a[28:31], v[184:187]
  s_lshl_b32 s32, s30, 13
  s_lshl_b32 s33, s3, 11
  v_mfma_f32_16x16x32_bf16 v[188:191], a[84:87], a[28:31], v[188:191]
  s_add_u32 s32, s32, s33
  v_lshlrev_b32 v240, 4, v231
  v_mfma_f32_16x16x32_bf16 v[132:135], a[84:87], a[24:27], v[132:135]
  v_add_u32 v240, s32, v240
  v_add_u32 v241, 131072, v240
  v_mfma_f32_16x16x32_bf16 v[76:79], a[84:87], a[20:23], v[76:79]
  ds_read_b64_tr_b16 a[80:81], v229 offset:14464
  ds_read_b64_tr_b16 a[82:83], v229 offset:18048
  v_lshrrev_b32 v232, 3, v231
  v_and_b32 v233, 6, v232
  v_mfma_f32_16x16x32_bf16 v[20:23], a[84:87], a[16:19], v[20:23]
  v_and_b32 v234, 7, v231
  v_xor_b32 v233, v233, v234
  v_mfma_f32_16x16x32_bf16 v[24:27], a[88:91], a[16:19], v[24:27]
  v_lshlrev_b32 v232, 11, v232
  v_lshl_add_u32 v232, v233, 4, v232
  v_mfma_f32_16x16x32_bf16 v[80:83], a[88:91], a[20:23], v[80:83]
  s_lshl_b32 s32, s3, 15
  s_add_u32 s32, s32, 4096
  v_mfma_f32_16x16x32_bf16 v[136:139], a[88:91], a[24:27], v[136:139]
  ds_read_b64_tr_b16 a[84:85], v229 offset:14496
  ds_read_b64_tr_b16 a[86:87], v229 offset:18080
  s_lshl_b32 s33, s31, 7
  s_add_u32 s34, s32, s33
  v_mfma_f32_16x16x32_bf16 v[192:195], a[88:91], a[28:31], v[192:195]
  s_xor_b32 s33, s33, 128
  s_add_u32 s35, s32, s33
  v_mfma_f32_16x16x32_bf16 v[196:199], a[92:95], a[28:31], v[196:199]
  v_add_u32 v225, s34, v232
  v_add_u32 v226, 15360, v225
  v_mfma_f32_16x16x32_bf16 v[140:143], a[92:95], a[24:27], v[140:143]
  v_add_u32 v227, s35, v232
  v_add_u32 v228, 13312, v227
  v_mfma_f32_16x16x32_bf16 v[84:87], a[92:95], a[20:23], v[84:87]
  ds_read_b64_tr_b16 a[88:89], v229 offset:14528
  ds_read_b64_tr_b16 a[90:91], v229 offset:18112
  v_subrev_u32 v227, 2048, v227
  s_lshl_b32 s38, s3, 12
  v_mfma_f32_16x16x32_bf16 v[28:31], a[92:95], a[16:19], v[28:31]
  s_add_u32 s38, s38, 0
  s_mul_i32 s16, s28, 7340032
  s_waitcnt lgkmcnt(10)
  v_mfma_f32_16x16x32_bf16 v[32:35], a[96:99], a[16:19], v[32:35]
  s_mul_i32 s17, s28, 3670016
  s_lshr_b32 s33, s3, 1
  v_mfma_f32_16x16x32_bf16 v[88:91], a[96:99], a[20:23], v[88:91]
  s_mul_i32 s33, s33, 196608
  s_add_u32 s17, s17, s33
  v_mfma_f32_16x16x32_bf16 v[144:147], a[96:99], a[24:27], v[144:147]
  ds_read_b64_tr_b16 a[92:93], v229 offset:21504
  ds_read_b64_tr_b16 a[94:95], v229 offset:25088
  s_add_u32 s97, s17, s33
  s_add_u32 s97, s97, 196608
  v_mfma_f32_16x16x32_bf16 v[200:203], a[96:99], a[28:31], v[200:203]
  s_lshr_b32 s33, s2, 5
  s_mul_i32 s33, s33, 2
  v_mfma_f32_16x16x32_bf16 v[204:207], a[100:103], a[28:31], v[204:207]
  s_bfe_u32 s34, s2, 0x20003
  s_mul_i32 s34, s34, 1
  v_mfma_f32_16x16x32_bf16 v[148:151], a[100:103], a[24:27], v[148:151]
  s_add_u32 s33, s33, s34
  s_and_b32 s33, s33, 7
  v_mfma_f32_16x16x32_bf16 v[92:95], a[100:103], a[20:23], v[92:95]
  ds_read_b64_tr_b16 a[96:97], v229 offset:21536
  ds_read_b64_tr_b16 a[98:99], v229 offset:25120
  s_mov_b32 s95, s17
  s_add_u32 s93, s17, 3670016
  v_mfma_f32_16x16x32_bf16 v[36:39], a[100:103], a[16:19], v[36:39]
  s_mul_i32 s34, s33, 458752
  s_add_u32 s17, s17, s34
  v_mfma_f32_16x16x32_bf16 v[40:43], a[104:107], a[16:19], v[40:43]
  s_mov_b32 s40, s16
  s_lshl_b32 s41, s33, 18
  v_mfma_f32_16x16x32_bf16 v[96:99], a[104:107], a[20:23], v[96:99]
  s_add_u32 s16, s40, s41
  s_sub_u32 s8, s22, 4096
  v_mfma_f32_16x16x32_bf16 v[152:155], a[104:107], a[24:27], v[152:155]
  ds_read_b64_tr_b16 a[100:101], v229 offset:21568
  ds_read_b64_tr_b16 a[102:103], v229 offset:25152
  s_subb_u32 s9, s23, 0
  s_mov_b32 s10, 7344128
  v_mfma_f32_16x16x32_bf16 v[208:211], a[104:107], a[28:31], v[208:211]
  s_add_u32 s4, s20, 0x1600000
  s_addc_u32 s5, s21, 0
  v_mfma_f32_16x16x32_bf16 v[212:215], a[108:111], a[28:31], v[212:215]
  s_mov_b32 s6, 0xe00000
  s_mov_b32 s7, 0x20000
  v_mfma_f32_16x16x32_bf16 v[156:159], a[108:111], a[24:27], v[156:159]
  v_lshrrev_b32 v232, 2, v231
  v_lshlrev_b32 v232, 7, v232
  v_mfma_f32_16x16x32_bf16 v[100:103], a[108:111], a[20:23], v[100:103]
  ds_read_b64_tr_b16 a[104:105], v229 offset:21600
  ds_read_b64_tr_b16 a[106:107], v229 offset:25184
  v_bfe_u32 v233, v231, 3, 2
  v_lshl_add_u32 v232, v233, 5, v232
  v_mfma_f32_16x16x32_bf16 v[44:47], a[108:111], a[16:19], v[44:47]
  v_and_b32 v233, 3, v231
  v_lshl_add_u32 v232, v233, 3, v232
  v_mfma_f32_16x16x32_bf16 v[48:51], a[112:115], a[16:19], v[48:51]
  v_xor_b32 v242, 0, v232
  v_add_u32 v242, 0, v242
  v_mfma_f32_16x16x32_bf16 v[104:107], a[112:115], a[20:23], v[104:107]
  v_xor_b32 v243, 32, v232
  v_add_u32 v243, 0, v243
  v_mfma_f32_16x16x32_bf16 v[160:163], a[112:115], a[24:27], v[160:163]
  ds_read_b64_tr_b16 a[108:109], v229 offset:21632
  ds_read_b64_tr_b16 a[110:111], v229 offset:25216
  v_xor_b32 v244, 64, v232
  v_add_u32 v244, 0, v244
  v_mfma_f32_16x16x32_bf16 v[216:219], a[112:115], a[28:31], v[216:219]
  v_xor_b32 v245, 96, v232
  v_add_u32 v245, 0, v245
  v_mfma_f32_16x16x32_bf16 v[220:223], a[116:119], a[28:31], v[220:223]
  s_mov_b32 s42, 0xbfb8aa3b
  s_mov_b32 s43, 0xbfb8aa3b
  v_mfma_f32_16x16x32_bf16 v[164:167], a[116:119], a[24:27], v[164:167]
  s_mov_b32 s62, 1.0
  s_mov_b32 s63, 1.0
  v_mfma_f32_16x16x32_bf16 v[108:111], a[116:119], a[20:23], v[108:111]
  ds_read_b64_tr_b16 a[112:113], v229 offset:21664
  ds_read_b64_tr_b16 a[114:115], v229 offset:25248
  v_mfma_f32_16x16x32_bf16 v[52:55], a[116:119], a[16:19], v[52:55]
  s_waitcnt vmcnt(2) lgkmcnt(10)
  s_barrier
  v_mfma_f32_16x16x32_bf16 v[0:3], a[64:67], a[32:35], v[0:3]
  ds_read_b64_tr_b16 a[116:117], v229 offset:21696
  ds_read_b64_tr_b16 a[118:119], v229 offset:25280
  v_mfma_f32_16x16x32_bf16 v[56:59], a[64:67], a[36:39], v[56:59]
  s_add_u32 m0, s38, 0
  s_nop 0
  buffer_load_dwordx4 v225, s[8:11], s17 offen lds
  v_mfma_f32_16x16x32_bf16 v[112:115], a[64:67], a[40:43], v[112:115]
  v_mfma_f32_16x16x32_bf16 v[168:171], a[64:67], a[44:47], v[168:171]
  ds_read_b64_tr_b16 a[64:65], v229 offset:28672
  ds_read_b64_tr_b16 a[66:67], v229 offset:32256
  v_mfma_f32_16x16x32_bf16 v[172:175], a[68:71], a[44:47], v[172:175]
  v_mfma_f32_16x16x32_bf16 v[116:119], a[68:71], a[40:43], v[116:119]
  buffer_load_dwordx4 v226, s[8:11], s17 offen offset:1024 lds
  v_mfma_f32_16x16x32_bf16 v[60:63], a[68:71], a[36:39], v[60:63]
  v_mfma_f32_16x16x32_bf16 v[4:7], a[68:71], a[32:35], v[4:7]
  ds_read_b64_tr_b16 a[68:69], v229 offset:28704
  ds_read_b64_tr_b16 a[70:71], v229 offset:32288
  v_mfma_f32_16x16x32_bf16 v[8:11], a[72:75], a[32:35], v[8:11]
  v_mfma_f32_16x16x32_bf16 v[64:67], a[72:75], a[36:39], v[64:67]
  buffer_load_dwordx4 v227, s[8:11], s17 offen offset:2048 lds
  v_mfma_f32_16x16x32_bf16 v[120:123], a[72:75], a[40:43], v[120:123]
  v_mfma_f32_16x16x32_bf16 v[176:179], a[72:75], a[44:47], v[176:179]
  ds_read_b64_tr_b16 a[72:73], v229 offset:35840
  ds_read_b64_tr_b16 a[74:75], v229 offset:39424
  v_mfma_f32_16x16x32_bf16 v[180:183], a[76:79], a[44:47], v[180:183]
  v_mfma_f32_16x16x32_bf16 v[124:127], a[76:79], a[40:43], v[124:127]
  buffer_load_dwordx4 v228, s[8:11], s17 offen offset:3072 lds
  s_add_u32 s17, s17, 458752
  s_cmp_eq_u32 s17, s93
  s_cselect_b32 s17, s95, s17
  v_mfma_f32_16x16x32_bf16 v[68:71], a[76:79], a[36:39], v[68:71]
  v_mfma_f32_16x16x32_bf16 v[12:15], a[76:79], a[32:35], v[12:15]
  ds_read_b64_tr_b16 a[76:77], v229 offset:35872
  ds_read_b64_tr_b16 a[78:79], v229 offset:39456
  v_mfma_f32_16x16x32_bf16 v[16:19], a[80:83], a[32:35], v[16:19]
  v_mfma_f32_16x16x32_bf16 v[72:75], a[80:83], a[36:39], v[72:75]
  s_add_u32 m0, s38, 16384
  s_nop 0
  buffer_load_dwordx4 v225, s[8:11], s17 offen lds
  v_mfma_f32_16x16x32_bf16 v[128:131], a[80:83], a[40:43], v[128:131]
  v_mfma_f32_16x16x32_bf16 v[184:187], a[80:83], a[44:47], v[184:187]
  ds_read_b64_tr_b16 a[80:81], v229 offset:28736
  ds_read_b64_tr_b16 a[82:83], v229 offset:32320
  v_mfma_f32_16x16x32_bf16 v[188:191], a[84:87], a[44:47], v[188:191]
  v_mfma_f32_16x16x32_bf16 v[132:135], a[84:87], a[40:43], v[132:135]
  buffer_load_dwordx4 v226, s[8:11], s17 offen offset:1024 lds
  v_mfma_f32_16x16x32_bf16 v[76:79], a[84:87], a[36:39], v[76:79]
  v_mfma_f32_16x16x32_bf16 v[20:23], a[84:87], a[32:35], v[20:23]
  ds_read_b64_tr_b16 a[84:85], v229 offset:28768
  ds_read_b64_tr_b16 a[86:87], v229 offset:32352
  v_mfma_f32_16x16x32_bf16 v[24:27], a[88:91], a[32:35], v[24:27]
  v_mfma_f32_16x16x32_bf16 v[80:83], a[88:91], a[36:39], v[80:83]
  buffer_load_dwordx4 v227, s[8:11], s17 offen offset:2048 lds
  v_mfma_f32_16x16x32_bf16 v[136:139], a[88:91], a[40:43], v[136:139]
  v_mfma_f32_16x16x32_bf16 v[192:195], a[88:91], a[44:47], v[192:195]
  ds_read_b64_tr_b16 a[88:89], v229 offset:35904
  ds_read_b64_tr_b16 a[90:91], v229 offset:39488
  v_mfma_f32_16x16x32_bf16 v[196:199], a[92:95], a[44:47], v[196:199]
  v_mfma_f32_16x16x32_bf16 v[140:143], a[92:95], a[40:43], v[140:143]
  buffer_load_dwordx4 v228, s[8:11], s17 offen offset:3072 lds
  s_add_u32 s17, s17, 458752
  s_cmp_eq_u32 s17, s93
  s_cselect_b32 s17, s95, s17
  v_mfma_f32_16x16x32_bf16 v[84:87], a[92:95], a[36:39], v[84:87]
  v_mfma_f32_16x16x32_bf16 v[28:31], a[92:95], a[32:35], v[28:31]
  ds_read_b64_tr_b16 a[92:93], v229 offset:35936
  ds_read_b64_tr_b16 a[94:95], v229 offset:39520
  s_waitcnt lgkmcnt(10)
  v_mfma_f32_16x16x32_bf16 v[32:35], a[96:99], a[32:35], v[32:35]
  v_mfma_f32_16x16x32_bf16 v[88:91], a[96:99], a[36:39], v[88:91]
  s_add_u32 m0, s38, 32768
  s_nop 0
  buffer_load_dwordx4 v225, s[8:11], s17 offen lds
  v_mfma_f32_16x16x32_bf16 v[144:147], a[96:99], a[40:43], v[144:147]
  v_mfma_f32_16x16x32_bf16 v[200:203], a[96:99], a[44:47], v[200:203]
  ds_read_b64_tr_b16 a[96:97], v229 offset:28800
  ds_read_b64_tr_b16 a[98:99], v229 offset:32384
  v_mfma_f32_16x16x32_bf16 v[204:207], a[100:103], a[44:47], v[204:207]
  v_mfma_f32_16x16x32_bf16 v[148:151], a[100:103], a[40:43], v[148:151]
  buffer_load_dwordx4 v226, s[8:11], s17 offen offset:1024 lds
  v_mfma_f32_16x16x32_bf16 v[92:95], a[100:103], a[36:39], v[92:95]
  v_mfma_f32_16x16x32_bf16 v[36:39], a[100:103], a[32:35], v[36:39]
  ds_read_b64_tr_b16 a[100:101], v229 offset:28832
  ds_read_b64_tr_b16 a[102:103], v229 offset:32416
  v_mfma_f32_16x16x32_bf16 v[40:43], a[104:107], a[32:35], v[40:43]
  v_mfma_f32_16x16x32_bf16 v[96:99], a[104:107], a[36:39], v[96:99]
  buffer_load_dwordx4 v227, s[8:11], s17 offen offset:2048 lds
  v_mfma_f32_16x16x32_bf16 v[152:155], a[104:107], a[40:43], v[152:155]
  v_mfma_f32_16x16x32_bf16 v[208:211], a[104:107], a[44:47], v[208:211]
  ds_read_b64_tr_b16 a[104:105], v229 offset:28864
  ds_read_b64_tr_b16 a[106:107], v229 offset:32448
  v_mfma_f32_16x16x32_bf16 v[212:215], a[108:111], a[44:47], v[212:215]
  v_mfma_f32_16x16x32_bf16 v[156:159], a[108:111], a[40:43], v[156:159]
  buffer_load_dwordx4 v228, s[8:11], s17 offen offset:3072 lds
  s_add_u32 s17, s17, 458752
  s_cmp_eq_u32 s17, s93
  s_cselect_b32 s17, s95, s17
  v_mfma_f32_16x16x32_bf16 v[100:103], a[108:111], a[36:39], v[100:103]
  v_mfma_f32_16x16x32_bf16 v[44:47], a[108:111], a[32:35], v[44:47]
  ds_read_b64_tr_b16 a[108:109], v229 offset:35968
  ds_read_b64_tr_b16 a[110:111], v229 offset:39552
  v_mfma_f32_16x16x32_bf16 v[48:51], a[112:115], a[32:35], v[48:51]
  v_mfma_f32_16x16x32_bf16 v[104:107], a[112:115], a[36:39], v[104:107]
  v_mfma_f32_16x16x32_bf16 v[160:163], a[112:115], a[40:43], v[160:163]
  v_mfma_f32_16x16x32_bf16 v[216:219], a[112:115], a[44:47], v[216:219]
  ds_read_b64_tr_b16 a[112:113], v229 offset:36000
  ds_read_b64_tr_b16 a[114:115], v229 offset:39584
  v_mfma_f32_16x16x32_bf16 v[220:223], a[116:119], a[44:47], v[220:223]
  v_mfma_f32_16x16x32_bf16 v[164:167], a[116:119], a[40:43], v[164:167]
  v_mfma_f32_16x16x32_bf16 v[108:111], a[116:119], a[36:39], v[108:111]
  v_mfma_f32_16x16x32_bf16 v[52:55], a[116:119], a[32:35], v[52:55]
  s_waitcnt vmcnt(13) lgkmcnt(10)
  s_barrier
  v_mfma_f32_16x16x32_bf16 v[0:3], a[64:67], a[48:51], v[0:3]
  ds_read_b64_tr_b16 a[116:117], v229 offset:36032
  ds_read_b64_tr_b16 a[118:119], v229 offset:39616
  v_mfma_f32_16x16x32_bf16 v[56:59], a[64:67], a[52:55], v[56:59]
  s_add_u32 m0, s38, 49152
  s_nop 0
  buffer_load_dwordx4 v225, s[8:11], s17 offen lds
  v_mfma_f32_16x16x32_bf16 v[112:115], a[64:67], a[56:59], v[112:115]
  v_mfma_f32_16x16x32_bf16 v[168:171], a[64:67], a[60:63], v[168:171]
  v_mfma_f32_16x16x32_bf16 v[172:175], a[68:71], a[60:63], v[172:175]
  v_mfma_f32_16x16x32_bf16 v[116:119], a[68:71], a[56:59], v[116:119]
  buffer_load_dwordx4 v226, s[8:11], s17 offen offset:1024 lds
  v_mfma_f32_16x16x32_bf16 v[60:63], a[68:71], a[52:55], v[60:63]
  v_mfma_f32_16x16x32_bf16 v[4:7], a[68:71], a[48:51], v[4:7]
  v_mfma_f32_16x16x32_bf16 v[28:31], a[72:75], a[48:51], v[28:31]
  v_mfma_f32_16x16x32_bf16 v[84:87], a[72:75], a[52:55], v[84:87]
  buffer_load_dwordx4 v227, s[8:11], s17 offen offset:2048 lds
  v_mfma_f32_16x16x32_bf16 v[140:143], a[72:75], a[56:59], v[140:143]
  v_mfma_f32_16x16x32_bf16 v[196:199], a[72:75], a[60:63], v[196:199]
  v_mfma_f32_16x16x32_bf16 v[200:203], a[76:79], a[60:63], v[200:203]
  v_mfma_f32_16x16x32_bf16 v[144:147], a[76:79], a[56:59], v[144:147]
  buffer_load_dwordx4 v228, s[8:11], s17 offen offset:3072 lds
  s_add_u32 s17, s17, 458752
  s_cmp_eq_u32 s17, s93
  s_cselect_b32 s17, s95, s17
  v_mfma_f32_16x16x32_bf16 v[88:91], a[76:79], a[52:55], v[88:91]
  v_mfma_f32_16x16x32_bf16 v[32:35], a[76:79], a[48:51], v[32:35]
  v_mfma_f32_16x16x32_bf16 v[8:11], a[80:83], a[48:51], v[8:11]
  v_mfma_f32_16x16x32_bf16 v[64:67], a[80:83], a[52:55], v[64:67]
  s_add_u32 m0, s38, 65536
  s_nop 0
  buffer_load_dwordx4 v225, s[8:11], s17 offen lds
  v_mfma_f32_16x16x32_bf16 v[120:123], a[80:83], a[56:59], v[120:123]
  v_mfma_f32_16x16x32_bf16 v[176:179], a[80:83], a[60:63], v[176:179]
  v_mfma_f32_16x16x32_bf16 v[180:183], a[84:87], a[60:63], v[180:183]
  v_mfma_f32_16x16x32_bf16 v[124:127], a[84:87], a[56:59], v[124:127]
  buffer_load_dwordx4 v226, s[8:11], s17 offen offset:1024 lds
  v_mfma_f32_16x16x32_bf16 v[68:71], a[84:87], a[52:55], v[68:71]
  v_mfma_f32_16x16x32_bf16 v[12:15], a[84:87], a[48:51], v[12:15]
  v_mfma_f32_16x16x32_bf16 v[36:39], a[88:91], a[48:51], v[36:39]
  v_mfma_f32_16x16x32_bf16 v[92:95], a[88:91], a[52:55], v[92:95]
  buffer_load_dwordx4 v227, s[8:11], s17 offen offset:2048 lds
  v_mfma_f32_16x16x32_bf16 v[148:151], a[88:91], a[56:59], v[148:151]
  v_mfma_f32_16x16x32_bf16 v[204:207], a[88:91], a[60:63], v[204:207]
  v_mfma_f32_16x16x32_bf16 v[208:211], a[92:95], a[60:63], v[208:211]
  v_mfma_f32_16x16x32_bf16 v[152:155], a[92:95], a[56:59], v[152:155]
  buffer_load_dwordx4 v228, s[8:11], s17 offen offset:3072 lds
  s_add_u32 s17, s17, 458752
  s_cmp_eq_u32 s17, s93
  s_cselect_b32 s17, s95, s17
  v_mfma_f32_16x16x32_bf16 v[96:99], a[92:95], a[52:55], v[96:99]
  v_mfma_f32_16x16x32_bf16 v[40:43], a[92:95], a[48:51], v[40:43]
  s_waitcnt lgkmcnt(10)
  v_mfma_f32_16x16x32_bf16 v[16:19], a[96:99], a[48:51], v[16:19]
  v_mfma_f32_16x16x32_bf16 v[72:75], a[96:99], a[52:55], v[72:75]
  s_add_u32 m0, s38, 81920
  s_nop 0
  buffer_load_dwordx4 v225, s[8:11], s17 offen lds
  v_mfma_f32_16x16x32_bf16 v[128:131], a[96:99], a[56:59], v[128:131]
  v_mfma_f32_16x16x32_bf16 v[184:187], a[96:99], a[60:63], v[184:187]
  s_waitcnt lgkmcnt(8)
  v_mfma_f32_16x16x32_bf16 v[188:191], a[100:103], a[60:63], v[188:191]
  v_mfma_f32_16x16x32_bf16 v[132:135], a[100:103], a[56:59], v[132:135]
  buffer_load_dwordx4 v226, s[8:11], s17 offen offset:1024 lds
  v_mfma_f32_16x16x32_bf16 v[76:79], a[100:103], a[52:55], v[76:79]
  v_mfma_f32_16x16x32_bf16 v[20:23], a[100:103], a[48:51], v[20:23]
  s_waitcnt lgkmcnt(6)
  v_mfma_f32_16x16x32_bf16 v[24:27], a[104:107], a[48:51], v[24:27]
  v_mfma_f32_16x16x32_bf16 v[80:83], a[104:107], a[52:55], v[80:83]
  buffer_load_dwordx4 v227, s[8:11], s17 offen offset:2048 lds
  v_mfma_f32_16x16x32_bf16 v[136:139], a[104:107], a[56:59], v[136:139]
  v_mfma_f32_16x16x32_bf16 v[192:195], a[104:107], a[60:63], v[192:195]
  s_waitcnt lgkmcnt(4)
  v_mfma_f32_16x16x32_bf16 v[212:215], a[108:111], a[60:63], v[212:215]
  v_mfma_f32_16x16x32_bf16 v[156:159], a[108:111], a[56:59], v[156:159]
  buffer_load_dwordx4 v228, s[8:11], s17 offen offset:3072 lds
  s_add_u32 s17, s17, 458752
  s_cmp_eq_u32 s17, s93
  s_cselect_b32 s17, s95, s17
  v_mfma_f32_16x16x32_bf16 v[100:103], a[108:111], a[52:55], v[100:103]
  v_mfma_f32_16x16x32_bf16 v[44:47], a[108:111], a[48:51], v[44:47]
  s_waitcnt lgkmcnt(2)
  v_mfma_f32_16x16x32_bf16 v[48:51], a[112:115], a[48:51], v[48:51]
  v_mfma_f32_16x16x32_bf16 v[104:107], a[112:115], a[52:55], v[104:107]
  v_mfma_f32_16x16x32_bf16 v[160:163], a[112:115], a[56:59], v[160:163]
  v_mfma_f32_16x16x32_bf16 v[216:219], a[112:115], a[60:63], v[216:219]
  s_waitcnt lgkmcnt(0)
  v_mfma_f32_16x16x32_bf16 v[220:223], a[116:119], a[60:63], v[220:223]
  v_mfma_f32_16x16x32_bf16 v[164:167], a[116:119], a[56:59], v[164:167]
  v_mfma_f32_16x16x32_bf16 v[108:111], a[116:119], a[52:55], v[108:111]
  v_mfma_f32_16x16x32_bf16 v[52:55], a[116:119], a[48:51], v[52:55]
  s_nop 7
  s_nop 1
L_k56_seam:
  v_pk_mul_f32 v[232:233], v[0:1], s[42:43]
  v_pk_mul_f32 v[234:235], v[2:3], s[42:43]
  v_exp_f32 v232, v232
  v_exp_f32 v233, v233
  v_exp_f32 v234, v234
  v_exp_f32 v235, v235
  v_pk_add_f32 v[232:233], v[232:233], s[62:63]
  v_pk_add_f32 v[234:235], v[234:235], s[62:63]
  v_rcp_f32 v232, v232
  v_rcp_f32 v233, v233
  v_rcp_f32 v234, v234
  v_rcp_f32 v235, v235
  v_pk_mul_f32 v[232:233], v[232:233], v[28:29]
  v_pk_mul_f32 v[234:235], v[234:235], v[30:31]
  v_cvt_pk_bf16_f32 v0, v232, v233
  v_cvt_pk_bf16_f32 v1, v234, v235
  v_pk_mul_f32 v[236:237], v[4:5], s[42:43]
  v_pk_mul_f32 v[238:239], v[6:7], s[42:43]
  v_exp_f32 v236, v236
  v_exp_f32 v237, v237
  v_exp_f32 v238, v238
  v_exp_f32 v239, v239
  v_pk_add_f32 v[236:237], v[236:237], s[62:63]
  v_pk_add_f32 v[238:239], v[238:239], s[62:63]
  v_rcp_f32 v236, v236
  v_rcp_f32 v237, v237
  v_rcp_f32 v238, v238
  v_rcp_f32 v239, v239
  v_pk_mul_f32 v[236:237], v[236:237], v[32:33]
  v_pk_mul_f32 v[238:239], v[238:239], v[34:35]
  v_cvt_pk_bf16_f32 v2, v236, v237
  v_cvt_pk_bf16_f32 v3, v238, v239
  buffer_store_dwordx4 v[0:3], v224, s[12:15], s98 offen offset:0 sc1
  v_pk_mul_f32 v[232:233], v[56:57], s[42:43]
  v_pk_mul_f32 v[234:235], v[58:59], s[42:43]
  v_exp_f32 v232, v232
  v_exp_f32 v233, v233
  v_exp_f32 v234, v234
  v_exp_f32 v235, v235
  v_pk_add_f32 v[232:233], v[232:233], s[62:63]
  v_pk_add_f32 v[234:235], v[234:235], s[62:63]
  v_rcp_f32 v232, v232
  v_rcp_f32 v233, v233
  v_rcp_f32 v234, v234
  v_rcp_f32 v235, v235
  v_pk_mul_f32 v[232:233], v[232:233], v[84:85]
  v_pk_mul_f32 v[234:235], v[234:235], v[86:87]
  v_cvt_pk_bf16_f32 v56, v232, v233
  v_cvt_pk_bf16_f32 v57, v234, v235
  v_pk_mul_f32 v[236:237], v[60:61], s[42:43]
  v_pk_mul_f32 v[238:239], v[62:63], s[42:43]
  v_exp_f32 v236, v236
  v_exp_f32 v237, v237
  v_exp_f32 v238, v238
  v_exp_f32 v239, v239
  v_pk_add_f32 v[236:237], v[236:237], s[62:63]
  v_pk_add_f32 v[238:239], v[238:239], s[62:63]
  v_rcp_f32 v236, v236
  v_rcp_f32 v237, v237
  v_rcp_f32 v238, v238
  v_rcp_f32 v239, v239
  v_pk_mul_f32 v[236:237], v[236:237], v[88:89]
  v_pk_mul_f32 v[238:239], v[238:239], v[90:91]
  v_cvt_pk_bf16_f32 v58, v236, v237
  v_cvt_pk_bf16_f32 v59, v238, v239
  buffer_store_dwordx4 v[56:59], v224, s[12:15], s98 offen offset:1024 sc1
  v_pk_mul_f32 v[232:233], v[112:113], s[42:43]
  v_pk_mul_f32 v[234:235], v[114:115], s[42:43]
  v_exp_f32 v232, v232
  v_exp_f32 v233, v233
  v_exp_f32 v234, v234
  v_exp_f32 v235, v235
  v_pk_add_f32 v[232:233], v[232:233], s[62:63]
  v_pk_add_f32 v[234:235], v[234:235], s[62:63]
  v_rcp_f32 v232, v232
  v_rcp_f32 v233, v233
  v_rcp_f32 v234, v234
  v_rcp_f32 v235, v235
  v_pk_mul_f32 v[232:233], v[232:233], v[140:141]
  v_pk_mul_f32 v[234:235], v[234:235], v[142:143]
  v_cvt_pk_bf16_f32 v112, v232, v233
  v_cvt_pk_bf16_f32 v113, v234, v235
  v_pk_mul_f32 v[236:237], v[116:117], s[42:43]
  v_pk_mul_f32 v[238:239], v[118:119], s[42:43]
  v_exp_f32 v236, v236
  v_exp_f32 v237, v237
  v_exp_f32 v238, v238
  v_exp_f32 v239, v239
  v_pk_add_f32 v[236:237], v[236:237], s[62:63]
  v_pk_add_f32 v[238:239], v[238:239], s[62:63]
  v_rcp_f32 v236, v236
  v_rcp_f32 v237, v237
  v_rcp_f32 v238, v238
  v_rcp_f32 v239, v239
  v_pk_mul_f32 v[236:237], v[236:237], v[144:145]
  v_pk_mul_f32 v[238:239], v[238:239], v[146:147]
  v_cvt_pk_bf16_f32 v114, v236, v237
  v_cvt_pk_bf16_f32 v115, v238, v239
  buffer_store_dwordx4 v[112:115], v224, s[12:15], s98 offen offset:2048 sc1
  v_pk_mul_f32 v[232:233], v[168:169], s[42:43]
  v_pk_mul_f32 v[234:235], v[170:171], s[42:43]
  v_exp_f32 v232, v232
  v_exp_f32 v233, v233
  v_exp_f32 v234, v234
  v_exp_f32 v235, v235
  v_pk_add_f32 v[232:233], v[232:233], s[62:63]
  v_pk_add_f32 v[234:235], v[234:235], s[62:63]
  v_rcp_f32 v232, v232
  v_rcp_f32 v233, v233
  v_rcp_f32 v234, v234
  v_rcp_f32 v235, v235
  v_pk_mul_f32 v[232:233], v[232:233], v[196:197]
  v_pk_mul_f32 v[234:235], v[234:235], v[198:199]
  v_cvt_pk_bf16_f32 v168, v232, v233
  v_cvt_pk_bf16_f32 v169, v234, v235
  v_pk_mul_f32 v[236:237], v[172:173], s[42:43]
  v_pk_mul_f32 v[238:239], v[174:175], s[42:43]
  v_exp_f32 v236, v236
  v_exp_f32 v237, v237
  v_exp_f32 v238, v238
  v_exp_f32 v239, v239
  v_pk_add_f32 v[236:237], v[236:237], s[62:63]
  v_pk_add_f32 v[238:239], v[238:239], s[62:63]
  v_rcp_f32 v236, v236
  v_rcp_f32 v237, v237
  v_rcp_f32 v238, v238
  v_rcp_f32 v239, v239
  v_pk_mul_f32 v[236:237], v[236:237], v[200:201]
  v_pk_mul_f32 v[238:239], v[238:239], v[202:203]
  v_cvt_pk_bf16_f32 v170, v236, v237
  v_cvt_pk_bf16_f32 v171, v238, v239
  buffer_store_dwordx4 v[168:171], v224, s[12:15], s98 offen offset:3072 sc1
  v_pk_mul_f32 v[232:233], v[8:9], s[42:43]
  v_pk_mul_f32 v[234:235], v[10:11], s[42:43]
  v_exp_f32 v232, v232
  v_exp_f32 v233, v233
  v_exp_f32 v234, v234
  v_exp_f32 v235, v235
  v_pk_add_f32 v[232:233], v[232:233], s[62:63]
  v_pk_add_f32 v[234:235], v[234:235], s[62:63]
  v_rcp_f32 v232, v232
  v_rcp_f32 v233, v233
  v_rcp_f32 v234, v234
  v_rcp_f32 v235, v235
  v_pk_mul_f32 v[232:233], v[232:233], v[36:37]
  v_pk_mul_f32 v[234:235], v[234:235], v[38:39]
  v_cvt_pk_bf16_f32 v4, v232, v233
  v_cvt_pk_bf16_f32 v5, v234, v235
  v_pk_mul_f32 v[236:237], v[12:13], s[42:43]
  v_pk_mul_f32 v[238:239], v[14:15], s[42:43]
  v_exp_f32 v236, v236
  v_exp_f32 v237, v237
  v_exp_f32 v238, v238
  v_exp_f32 v239, v239
  v_pk_add_f32 v[236:237], v[236:237], s[62:63]
  v_pk_add_f32 v[238:239], v[238:239], s[62:63]
  v_rcp_f32 v236, v236
  v_rcp_f32 v237, v237
  v_rcp_f32 v238, v238
  v_rcp_f32 v239, v239
  v_pk_mul_f32 v[236:237], v[236:237], v[40:41]
  v_pk_mul_f32 v[238:239], v[238:239], v[42:43]
  v_cvt_pk_bf16_f32 v6, v236, v237
  v_cvt_pk_bf16_f32 v7, v238, v239
  v_pk_mul_f32 v[232:233], v[64:65], s[42:43]
  v_pk_mul_f32 v[234:235], v[66:67], s[42:43]
  v_exp_f32 v232, v232
  v_exp_f32 v233, v233
  v_exp_f32 v234, v234
  v_exp_f32 v235, v235
  v_pk_add_f32 v[232:233], v[232:233], s[62:63]
  v_pk_add_f32 v[234:235], v[234:235], s[62:63]
  v_rcp_f32 v232, v232
  v_rcp_f32 v233, v233
  v_rcp_f32 v234, v234
  v_rcp_f32 v235, v235
  v_pk_mul_f32 v[232:233], v[232:233], v[92:93]
  v_pk_mul_f32 v[234:235], v[234:235], v[94:95]
  v_cvt_pk_bf16_f32 v60, v232, v233
  v_cvt_pk_bf16_f32 v61, v234, v235
  v_pk_mul_f32 v[236:237], v[68:69], s[42:43]
  v_pk_mul_f32 v[238:239], v[70:71], s[42:43]
  v_exp_f32 v236, v236
  v_exp_f32 v237, v237
  v_exp_f32 v238, v238
  v_exp_f32 v239, v239
  v_pk_add_f32 v[236:237], v[236:237], s[62:63]
  v_pk_add_f32 v[238:239], v[238:239], s[62:63]
  v_rcp_f32 v236, v236
  v_rcp_f32 v237, v237
  v_rcp_f32 v238, v238
  v_rcp_f32 v239, v239
  v_pk_mul_f32 v[236:237], v[236:237], v[96:97]
  v_pk_mul_f32 v[238:239], v[238:239], v[98:99]
  v_cvt_pk_bf16_f32 v62, v236, v237
  v_cvt_pk_bf16_f32 v63, v238, v239
  v_pk_mul_f32 v[232:233], v[120:121], s[42:43]
  v_pk_mul_f32 v[234:235], v[122:123], s[42:43]
  v_exp_f32 v232, v232
  v_exp_f32 v233, v233
  v_exp_f32 v234, v234
  v_exp_f32 v235, v235
  v_pk_add_f32 v[232:233], v[232:233], s[62:63]
  v_pk_add_f32 v[234:235], v[234:235], s[62:63]
  v_rcp_f32 v232, v232
  v_rcp_f32 v233, v233
  v_rcp_f32 v234, v234
  v_rcp_f32 v235, v235
  v_pk_mul_f32 v[232:233], v[232:233], v[148:149]
  v_pk_mul_f32 v[234:235], v[234:235], v[150:151]
  v_cvt_pk_bf16_f32 v116, v232, v233
  v_cvt_pk_bf16_f32 v117, v234, v235
  v_pk_mul_f32 v[236:237], v[124:125], s[42:43]
  v_pk_mul_f32 v[238:239], v[126:127], s[42:43]
  v_exp_f32 v236, v236
  v_exp_f32 v237, v237
  v_exp_f32 v238, v238
  v_exp_f32 v239, v239
  v_pk_add_f32 v[236:237], v[236:237], s[62:63]
  v_pk_add_f32 v[238:239], v[238:239], s[62:63]
  v_rcp_f32 v236, v236
  v_rcp_f32 v237, v237
  v_rcp_f32 v238, v238
  v_rcp_f32 v239, v239
  v_pk_mul_f32 v[236:237], v[236:237], v[152:153]
  v_pk_mul_f32 v[238:239], v[238:239], v[154:155]
  v_cvt_pk_bf16_f32 v118, v236, v237
  v_cvt_pk_bf16_f32 v119, v238, v239
  s_waitcnt vmcnt(0)
  s_mov_b64 exec, 1
  buffer_store_dword v248, v250, s[56:59], s92 offen sc1
  s_mov_b64 exec, -1
  s_add_u32 s92, s92, 65536
  s_barrier
  v_pk_mul_f32 v[232:233], v[176:177], s[42:43]
  v_pk_mul_f32 v[234:235], v[178:179], s[42:43]
  v_exp_f32 v232, v232
  v_exp_f32 v233, v233
  v_exp_f32 v234, v234
  v_exp_f32 v235, v235
  v_pk_add_f32 v[232:233], v[232:233], s[62:63]
  v_pk_add_f32 v[234:235], v[234:235], s[62:63]
  s_add_u32 m0, s38, 98304
  s_nop 0
  buffer_load_dwordx4 v225, s[8:11], s17 offen lds
  v_rcp_f32 v232, v232
  v_rcp_f32 v233, v233
  v_rcp_f32 v234, v234
  v_rcp_f32 v235, v235
  v_pk_mul_f32 v[232:233], v[232:233], v[204:205]
  v_pk_mul_f32 v[234:235], v[234:235], v[206:207]
  v_cvt_pk_bf16_f32 v172, v232, v233
  v_cvt_pk_bf16_f32 v173, v234, v235
  buffer_load_dwordx4 v226, s[8:11], s17 offen offset:1024 lds
  v_pk_mul_f32 v[236:237], v[180:181], s[42:43]
  v_pk_mul_f32 v[238:239], v[182:183], s[42:43]
  v_exp_f32 v236, v236
  v_exp_f32 v237, v237
  v_exp_f32 v238, v238
  v_exp_f32 v239, v239
  v_pk_add_f32 v[236:237], v[236:237], s[62:63]
  v_pk_add_f32 v[238:239], v[238:239], s[62:63]
  buffer_load_dwordx4 v227, s[8:11], s17 offen offset:2048 lds
  v_rcp_f32 v236, v236
  v_rcp_f32 v237, v237
  v_rcp_f32 v238, v238
  v_rcp_f32 v239, v239
  v_pk_mul_f32 v[236:237], v[236:237], v[208:209]
  v_pk_mul_f32 v[238:239], v[238:239], v[210:211]
  v_cvt_pk_bf16_f32 v174, v236, v237
  v_cvt_pk_bf16_f32 v175, v238, v239
  buffer_load_dwordx4 v228, s[8:11], s17 offen offset:3072 lds
  s_add_u32 s17, s17, 458752
  s_cmp_eq_u32 s17, s93
  s_cselect_b32 s17, s95, s17
  v_pk_mul_f32 v[232:233], v[16:17], s[42:43]
  v_pk_mul_f32 v[234:235], v[18:19], s[42:43]
  v_exp_f32 v232, v232
  v_exp_f32 v233, v233
  v_exp_f32 v234, v234
  v_exp_f32 v235, v235
  v_pk_add_f32 v[232:233], v[232:233], s[62:63]
  v_pk_add_f32 v[234:235], v[234:235], s[62:63]
  s_add_u32 m0, s38, 114688
  s_nop 0
  buffer_load_dwordx4 v225, s[8:11], s17 offen lds
  v_rcp_f32 v232, v232
  v_rcp_f32 v233, v233
  v_rcp_f32 v234, v234
  v_rcp_f32 v235, v235
  v_pk_mul_f32 v[232:233], v[232:233], v[44:45]
  v_pk_mul_f32 v[234:235], v[234:235], v[46:47]
  v_cvt_pk_bf16_f32 v8, v232, v233
  v_cvt_pk_bf16_f32 v9, v234, v235
  buffer_load_dwordx4 v226, s[8:11], s17 offen offset:1024 lds
  v_pk_mul_f32 v[236:237], v[20:21], s[42:43]
  v_pk_mul_f32 v[238:239], v[22:23], s[42:43]
  v_exp_f32 v236, v236
  v_exp_f32 v237, v237
  v_exp_f32 v238, v238
  v_exp_f32 v239, v239
  v_pk_add_f32 v[236:237], v[236:237], s[62:63]
  v_pk_add_f32 v[238:239], v[238:239], s[62:63]
  buffer_load_dwordx4 v227, s[8:11], s17 offen offset:2048 lds
  v_rcp_f32 v236, v236
  v_rcp_f32 v237, v237
  v_rcp_f32 v238, v238
  v_rcp_f32 v239, v239
  v_pk_mul_f32 v[236:237], v[236:237], v[48:49]
  v_pk_mul_f32 v[238:239], v[238:239], v[50:51]
  v_cvt_pk_bf16_f32 v10, v236, v237
  v_cvt_pk_bf16_f32 v11, v238, v239
  buffer_load_dwordx4 v228, s[8:11], s17 offen offset:3072 lds
  s_add_u32 s17, s17, 458752
  s_cmp_eq_u32 s17, s93
  s_cselect_b32 s17, s95, s17
  s_add_u32 s17, s17, 65536
  s_add_u32 s93, s93, 65536
  s_add_u32 s95, s95, 65536
  v_pk_mul_f32 v[232:233], v[72:73], s[42:43]
  v_pk_mul_f32 v[234:235], v[74:75], s[42:43]
  v_exp_f32 v232, v232
  v_exp_f32 v233, v233
  v_exp_f32 v234, v234
  v_exp_f32 v235, v235
  v_pk_add_f32 v[232:233], v[232:233], s[62:63]
  v_pk_add_f32 v[234:235], v[234:235], s[62:63]
  s_add_u32 m0, s38, 131072
  s_nop 0
  buffer_load_dwordx4 v225, s[8:11], s17 offen lds
  v_rcp_f32 v232, v232
  v_rcp_f32 v233, v233
  v_rcp_f32 v234, v234
  v_rcp_f32 v235, v235
  v_pk_mul_f32 v[232:233], v[232:233], v[100:101]
  v_pk_mul_f32 v[234:235], v[234:235], v[102:103]
  v_cvt_pk_bf16_f32 v64, v232, v233
  v_cvt_pk_bf16_f32 v65, v234, v235
  buffer_load_dwordx4 v226, s[8:11], s17 offen offset:1024 lds
  v_pk_mul_f32 v[236:237], v[76:77], s[42:43]
  v_pk_mul_f32 v[238:239], v[78:79], s[42:43]
  v_exp_f32 v236, v236
  v_exp_f32 v237, v237
  v_exp_f32 v238, v238
  v_exp_f32 v239, v239
  v_pk_add_f32 v[236:237], v[236:237], s[62:63]
  v_pk_add_f32 v[238:239], v[238:239], s[62:63]
  buffer_load_dwordx4 v227, s[8:11], s17 offen offset:2048 lds
  v_rcp_f32 v236, v236
  v_rcp_f32 v237, v237
  v_rcp_f32 v238, v238
  v_rcp_f32 v239, v239
  v_pk_mul_f32 v[236:237], v[236:237], v[104:105]
  v_pk_mul_f32 v[238:239], v[238:239], v[106:107]
  v_cvt_pk_bf16_f32 v66, v236, v237
  v_cvt_pk_bf16_f32 v67, v238, v239
  buffer_load_dwordx4 v228, s[8:11], s17 offen offset:3072 lds
  s_add_u32 s17, s17, 458752
  s_cmp_eq_u32 s17, s93
  s_cselect_b32 s17, s95, s17
  v_pk_mul_f32 v[232:233], v[128:129], s[42:43]
  v_pk_mul_f32 v[234:235], v[130:131], s[42:43]
  v_exp_f32 v232, v232
  v_exp_f32 v233, v233
  v_exp_f32 v234, v234
  v_exp_f32 v235, v235
  v_pk_add_f32 v[232:233], v[232:233], s[62:63]
  v_pk_add_f32 v[234:235], v[234:235], s[62:63]
  v_rcp_f32 v232, v232
  v_rcp_f32 v233, v233
  v_rcp_f32 v234, v234
  v_rcp_f32 v235, v235
  v_pk_mul_f32 v[232:233], v[232:233], v[156:157]
  v_pk_mul_f32 v[234:235], v[234:235], v[158:159]
  v_cvt_pk_bf16_f32 v120, v232, v233
  v_cvt_pk_bf16_f32 v121, v234, v235
  v_pk_mul_f32 v[236:237], v[132:133], s[42:43]
  v_pk_mul_f32 v[238:239], v[134:135], s[42:43]
  v_exp_f32 v236, v236
  v_exp_f32 v237, v237
  v_exp_f32 v238, v238
  v_exp_f32 v239, v239
  v_pk_add_f32 v[236:237], v[236:237], s[62:63]
  v_pk_add_f32 v[238:239], v[238:239], s[62:63]
  v_rcp_f32 v236, v236
  v_rcp_f32 v237, v237
  v_rcp_f32 v238, v238
  v_rcp_f32 v239, v239
  v_pk_mul_f32 v[236:237], v[236:237], v[160:161]
  v_pk_mul_f32 v[238:239], v[238:239], v[162:163]
  v_cvt_pk_bf16_f32 v122, v236, v237
  v_cvt_pk_bf16_f32 v123, v238, v239
  v_pk_mul_f32 v[232:233], v[184:185], s[42:43]
  v_pk_mul_f32 v[234:235], v[186:187], s[42:43]
  v_exp_f32 v232, v232
  v_exp_f32 v233, v233
  v_exp_f32 v234, v234
  v_exp_f32 v235, v235
  v_pk_add_f32 v[232:233], v[232:233], s[62:63]
  v_pk_add_f32 v[234:235], v[234:235], s[62:63]
  v_rcp_f32 v232, v232
  v_rcp_f32 v233, v233
  v_rcp_f32 v234, v234
  v_rcp_f32 v235, v235
  v_pk_mul_f32 v[232:233], v[232:233], v[212:213]
  v_pk_mul_f32 v[234:235], v[234:235], v[214:215]
  v_cvt_pk_bf16_f32 v176, v232, v233
  v_cvt_pk_bf16_f32 v177, v234, v235
  v_pk_mul_f32 v[236:237], v[188:189], s[42:43]
  v_pk_mul_f32 v[238:239], v[190:191], s[42:43]
  v_exp_f32 v236, v236
  v_exp_f32 v237, v237
  v_exp_f32 v238, v238
  v_exp_f32 v239, v239
  v_pk_add_f32 v[236:237], v[236:237], s[62:63]
  v_pk_add_f32 v[238:239], v[238:239], s[62:63]
  v_rcp_f32 v236, v236
  v_rcp_f32 v237, v237
  v_rcp_f32 v238, v238
  v_rcp_f32 v239, v239
  v_pk_mul_f32 v[236:237], v[236:237], v[216:217]
  v_pk_mul_f32 v[238:239], v[238:239], v[218:219]
  v_cvt_pk_bf16_f32 v178, v236, v237
  v_cvt_pk_bf16_f32 v179, v238, v239
  buffer_load_dword v247, v246, s[56:59], s94 offen sc1
  buffer_store_dwordx4 v[4:7], v224, s[12:15], s99 offen offset:0 sc1
  buffer_store_dwordx4 v[60:63], v224, s[12:15], s99 offen offset:1024 sc1
  buffer_store_dwordx4 v[116:119], v224, s[12:15], s99 offen offset:2048 sc1
  buffer_store_dwordx4 v[172:175], v224, s[12:15], s99 offen offset:3072 sc1
  v_pk_mul_f32 v[232:233], v[24:25], s[42:43]
  v_pk_mul_f32 v[234:235], v[26:27], s[42:43]
  v_exp_f32 v232, v232
  v_exp_f32 v233, v233
  v_exp_f32 v234, v234
  v_exp_f32 v235, v235
  v_pk_add_f32 v[232:233], v[232:233], s[62:63]
  v_pk_add_f32 v[234:235], v[234:235], s[62:63]
  v_rcp_f32 v232, v232
  v_rcp_f32 v233, v233
  v_rcp_f32 v234, v234
  v_rcp_f32 v235, v235
  v_pk_mul_f32 v[232:233], v[232:233], v[52:53]
  v_pk_mul_f32 v[234:235], v[234:235], v[54:55]
  v_cvt_pk_bf16_f32 v12, v232, v233
  v_cvt_pk_bf16_f32 v13, v234, v235
  v_pk_mul_f32 v[236:237], v[80:81], s[42:43]
  v_pk_mul_f32 v[238:239], v[82:83], s[42:43]
  v_exp_f32 v236, v236
  v_exp_f32 v237, v237
  v_exp_f32 v238, v238
  v_exp_f32 v239, v239
  v_pk_add_f32 v[236:237], v[236:237], s[62:63]
  v_pk_add_f32 v[238:239], v[238:239], s[62:63]
  v_rcp_f32 v236, v236
  v_rcp_f32 v237, v237
  v_rcp_f32 v238, v238
  v_rcp_f32 v239, v239
  v_pk_mul_f32 v[236:237], v[236:237], v[108:109]
  v_pk_mul_f32 v[238:239], v[238:239], v[110:111]
  v_cvt_pk_bf16_f32 v14, v236, v237
  v_cvt_pk_bf16_f32 v15, v238, v239
  v_pk_mul_f32 v[232:233], v[136:137], s[42:43]
  v_pk_mul_f32 v[234:235], v[138:139], s[42:43]
  v_exp_f32 v232, v232
  v_exp_f32 v233, v233
  v_exp_f32 v234, v234
  v_exp_f32 v235, v235
  v_pk_add_f32 v[232:233], v[232:233], s[62:63]
  v_pk_add_f32 v[234:235], v[234:235], s[62:63]
  v_rcp_f32 v232, v232
  v_rcp_f32 v233, v233
  v_rcp_f32 v234, v234
  v_rcp_f32 v235, v235
  v_pk_mul_f32 v[232:233], v[232:233], v[164:165]
  v_pk_mul_f32 v[234:235], v[234:235], v[166:167]
  v_cvt_pk_bf16_f32 v124, v232, v233
  v_cvt_pk_bf16_f32 v125, v234, v235
  v_pk_mul_f32 v[236:237], v[192:193], s[42:43]
  v_pk_mul_f32 v[238:239], v[194:195], s[42:43]
  v_exp_f32 v236, v236
  v_exp_f32 v237, v237
  v_exp_f32 v238, v238
  v_exp_f32 v239, v239
  v_pk_add_f32 v[236:237], v[236:237], s[62:63]
  v_pk_add_f32 v[238:239], v[238:239], s[62:63]
  v_rcp_f32 v236, v236
  v_rcp_f32 v237, v237
  v_rcp_f32 v238, v238
  v_rcp_f32 v239, v239
  v_pk_mul_f32 v[236:237], v[236:237], v[220:221]
  v_pk_mul_f32 v[238:239], v[238:239], v[222:223]
  v_cvt_pk_bf16_f32 v126, v236, v237
  v_cvt_pk_bf16_f32 v127, v238, v239
  s_waitcnt vmcnt(4)
  v_cmp_ne_u32 vcc, s19, v247
  s_nop 1
  s_cmp_lg_u64 vcc, 0
  s_cbranch_scc1 L_slow_25
  L_back_26:
  s_add_u32 s94, s94, 65536
  buffer_load_dwordx4 a[0:3], v240, s[4:7], s16 offen offset:0 sc1
  buffer_load_dwordx4 a[4:7], v240, s[4:7], s16 offen offset:1024 sc1
  buffer_load_dwordx4 a[8:11], v241, s[4:7], s16 offen offset:0 sc1
  buffer_load_dwordx4 a[12:15], v241, s[4:7], s16 offen offset:1024 sc1
  s_add_u32 s41, s41, 262144
  s_bitset0_b32 s41, 21
  s_add_u32 s16, s40, s41
  buffer_load_dwordx4 a[16:19], v240, s[4:7], s16 offen offset:0 sc1
  buffer_load_dwordx4 a[20:23], v240, s[4:7], s16 offen offset:1024 sc1
  buffer_load_dwordx4 a[24:27], v241, s[4:7], s16 offen offset:0 sc1
  buffer_load_dwordx4 a[28:31], v241, s[4:7], s16 offen offset:1024 sc1
  s_add_u32 s41, s41, 262144
  s_bitset0_b32 s41, 21
  s_add_u32 s16, s40, s41
  buffer_load_dwordx4 a[32:35], v240, s[4:7], s16 offen offset:0 sc1
  buffer_load_dwordx4 a[36:39], v240, s[4:7], s16 offen offset:1024 sc1
  buffer_load_dwordx4 a[40:43], v241, s[4:7], s16 offen offset:0 sc1
  buffer_load_dwordx4 a[44:47], v241, s[4:7], s16 offen offset:1024 sc1
  s_add_u32 s41, s41, 262144
  s_bitset0_b32 s41, 21
  s_add_u32 s16, s40, s41
  v_add_u32 v104, 65536, v242
  v_add_u32 v105, 65536, v243
  v_add_u32 v106, 65536, v244
  v_add_u32 v107, 65536, v245
  s_waitcnt vmcnt(54)
  s_barrier
  ds_read_b64_tr_b16 a[80:81], v242 offset:2048
  ds_read_b64_tr_b16 a[82:83], v242 offset:6144
  ds_read_b64_tr_b16 a[112:113], v242 offset:10240
  ds_read_b64_tr_b16 a[114:115], v242 offset:14336
  ds_read_b64_tr_b16 a[84:85], v243 offset:2048
  ds_read_b64_tr_b16 a[86:87], v243 offset:6144
  ds_read_b64_tr_b16 a[116:117], v243 offset:10240
  ds_read_b64_tr_b16 a[118:119], v243 offset:14336
  ds_read_b64_tr_b16 a[88:89], v244 offset:2048
  ds_read_b64_tr_b16 a[90:91], v244 offset:6144
  ds_read_b64_tr_b16 a[120:121], v244 offset:10240
  ds_read_b64_tr_b16 a[122:123], v244 offset:14336
  ds_read_b64_tr_b16 a[92:93], v245 offset:2048
  ds_read_b64_tr_b16 a[94:95], v245 offset:6144
  ds_read_b64_tr_b16 a[124:125], v245 offset:10240
  ds_read_b64_tr_b16 a[126:127], v245 offset:14336
  ds_read_b64_tr_b16 a[64:65], v242 offset:0
  ds_read_b64_tr_b16 a[66:67], v242 offset:4096
  ds_read_b64_tr_b16 a[96:97], v242 offset:8192
  ds_read_b64_tr_b16 a[98:99], v242 offset:12288
  ds_read_b64_tr_b16 a[68:69], v243 offset:0
  ds_read_b64_tr_b16 a[70:71], v243 offset:4096
  ds_read_b64_tr_b16 a[100:101], v243 offset:8192
  ds_read_b64_tr_b16 a[102:103], v243 offset:12288
  ds_read_b64_tr_b16 a[72:73], v244 offset:0
  ds_read_b64_tr_b16 a[74:75], v244 offset:4096
  ds_read_b64_tr_b16 a[104:105], v244 offset:8192
  ds_read_b64_tr_b16 a[106:107], v244 offset:12288
  ds_read_b64_tr_b16 a[76:77], v245 offset:0
  ds_read_b64_tr_b16 a[78:79], v245 offset:4096
  ds_read_b64_tr_b16 a[108:109], v245 offset:8192
  ds_read_b64_tr_b16 a[110:111], v245 offset:12288
  s_waitcnt vmcnt(8) lgkmcnt(10)
  s_barrier
  s_mov_b64 exec, 1
  buffer_store_dword v248, v250, s[56:59], s92 offen sc1
  s_mov_b64 exec, -1
  s_add_u32 s92, s92, 65536
  v_mfma_f32_16x16x32_bf16 v[72:75], a[80:83], a[0:3], 0
  buffer_load_dwordx4 a[48:51], v240, s[4:7], s16 offen offset:0 sc1
  v_mfma_f32_16x16x32_bf16 v[72:75], a[112:115], a[8:11], v[72:75]
  v_mfma_f32_16x16x32_bf16 v[88:91], a[112:115], a[12:15], 0
  ds_read_b64_tr_b16 a[112:113], v242 offset:26624
  ds_read_b64_tr_b16 a[114:115], v242 offset:30720
  v_mfma_f32_16x16x32_bf16 v[88:91], a[80:83], a[4:7], v[88:91]
  ds_read_b64_tr_b16 a[80:81], v242 offset:18432
  ds_read_b64_tr_b16 a[82:83], v242 offset:22528
  v_mfma_f32_16x16x32_bf16 v[92:95], a[84:87], a[4:7], 0
  v_mfma_f32_16x16x32_bf16 v[92:95], a[116:119], a[12:15], v[92:95]
  buffer_load_dwordx4 a[52:55], v240, s[4:7], s16 offen offset:1024 sc1
  v_mfma_f32_16x16x32_bf16 v[76:79], a[116:119], a[8:11], 0
  ds_read_b64_tr_b16 a[116:117], v243 offset:26624
  ds_read_b64_tr_b16 a[118:119], v243 offset:30720
  v_mfma_f32_16x16x32_bf16 v[76:79], a[84:87], a[0:3], v[76:79]
  ds_read_b64_tr_b16 a[84:85], v243 offset:18432
  ds_read_b64_tr_b16 a[86:87], v243 offset:22528
  v_mfma_f32_16x16x32_bf16 v[80:83], a[88:91], a[0:3], 0
  v_mfma_f32_16x16x32_bf16 v[80:83], a[120:123], a[8:11], v[80:83]
  v_mfma_f32_16x16x32_bf16 v[96:99], a[120:123], a[12:15], 0
  buffer_load_dwordx4 a[56:59], v241, s[4:7], s16 offen offset:0 sc1
  v_mfma_f32_16x16x32_bf16 v[96:99], a[88:91], a[4:7], v[96:99]
  ds_read_b64_tr_b16 a[120:121], v244 offset:26624
  ds_read_b64_tr_b16 a[122:123], v244 offset:30720
  v_mfma_f32_16x16x32_bf16 v[100:103], a[92:95], a[4:7], 0
  ds_read_b64_tr_b16 a[88:89], v244 offset:18432
  ds_read_b64_tr_b16 a[90:91], v244 offset:22528
  v_mfma_f32_16x16x32_bf16 v[100:103], a[124:127], a[12:15], v[100:103]
  v_mfma_f32_16x16x32_bf16 v[84:87], a[124:127], a[8:11], 0
  ds_read_b64_tr_b16 a[124:125], v245 offset:26624
  ds_read_b64_tr_b16 a[126:127], v245 offset:30720
  v_mfma_f32_16x16x32_bf16 v[84:87], a[92:95], a[0:3], v[84:87]
  buffer_load_dwordx4 a[60:63], v241, s[4:7], s16 offen offset:1024 sc1
  v_mfma_f32_16x16x32_bf16 v[16:19], a[64:67], a[0:3], 0
  ds_read_b64_tr_b16 a[92:93], v245 offset:18432
  s_add_u32 s41, s41, 262144
  v_mfma_f32_16x16x32_bf16 v[16:19], a[96:99], a[8:11], v[16:19]
  ds_read_b64_tr_b16 a[94:95], v245 offset:22528
  s_bitset0_b32 s41, 21
  v_mfma_f32_16x16x32_bf16 v[32:35], a[96:99], a[12:15], 0
  ds_read_b64_tr_b16 a[96:97], v242 offset:24576
  s_add_u32 s16, s40, s41
  v_mfma_f32_16x16x32_bf16 v[32:35], a[64:67], a[4:7], v[32:35]
  ds_read_b64_tr_b16 a[98:99], v242 offset:28672
  ds_read_b64_tr_b16 a[64:65], v242 offset:16384
  v_mfma_f32_16x16x32_bf16 v[36:39], a[68:71], a[4:7], 0
  buffer_store_dwordx4 v[8:11], v224, s[12:15], s100 offen offset:0 sc1
  s_waitcnt lgkmcnt(10)
  v_mfma_f32_16x16x32_bf16 v[36:39], a[100:103], a[12:15], v[36:39]
  ds_read_b64_tr_b16 a[66:67], v242 offset:20480
  v_mfma_f32_16x16x32_bf16 v[20:23], a[100:103], a[8:11], 0
  ds_read_b64_tr_b16 a[100:101], v243 offset:24576
  ds_read_b64_tr_b16 a[102:103], v243 offset:28672
  v_mfma_f32_16x16x32_bf16 v[20:23], a[68:71], a[0:3], v[20:23]
  ds_read_b64_tr_b16 a[68:69], v243 offset:16384
  ds_read_b64_tr_b16 a[70:71], v243 offset:20480
  v_mfma_f32_16x16x32_bf16 v[24:27], a[72:75], a[0:3], 0
  v_mfma_f32_16x16x32_bf16 v[24:27], a[104:107], a[8:11], v[24:27]
  buffer_store_dwordx4 v[64:67], v224, s[12:15], s100 offen offset:1024 sc1
  v_mfma_f32_16x16x32_bf16 v[40:43], a[104:107], a[12:15], 0
  ds_read_b64_tr_b16 a[104:105], v244 offset:24576
  ds_read_b64_tr_b16 a[106:107], v244 offset:28672
  v_mfma_f32_16x16x32_bf16 v[40:43], a[72:75], a[4:7], v[40:43]
  ds_read_b64_tr_b16 a[72:73], v244 offset:16384
  ds_read_b64_tr_b16 a[74:75], v244 offset:20480
  v_mfma_f32_16x16x32_bf16 v[44:47], a[76:79], a[4:7], 0
  v_mfma_f32_16x16x32_bf16 v[44:47], a[108:111], a[12:15], v[44:47]
  v_mfma_f32_16x16x32_bf16 v[28:31], a[108:111], a[8:11], 0
  ds_read_b64_tr_b16 a[108:109], v245 offset:24576
  ds_read_b64_tr_b16 a[110:111], v245 offset:28672
  v_mfma_f32_16x16x32_bf16 v[28:31], a[76:79], a[0:3], v[28:31]
  s_waitcnt vmcnt(11) lgkmcnt(10)
  s_barrier
  v_mfma_f32_16x16x32_bf16 v[72:75], a[80:83], a[16:19], v[72:75]
  buffer_load_dwordx4 a[0:3], v240, s[4:7], s16 offen offset:0 sc1
  v_mfma_f32_16x16x32_bf16 v[72:75], a[112:115], a[24:27], v[72:75]
  ds_read_b64_tr_b16 a[76:77], v245 offset:16384
  ds_read_b64_tr_b16 a[78:79], v245 offset:20480
  v_mfma_f32_16x16x32_bf16 v[88:91], a[112:115], a[28:31], v[88:91]
  ds_read_b64_tr_b16 a[112:113], v242 offset:43008
  ds_read_b64_tr_b16 a[114:115], v242 offset:47104
  v_mfma_f32_16x16x32_bf16 v[88:91], a[80:83], a[20:23], v[88:91]
  ds_read_b64_tr_b16 a[80:81], v242 offset:34816
  ds_read_b64_tr_b16 a[82:83], v242 offset:38912
  v_mfma_f32_16x16x32_bf16 v[92:95], a[84:87], a[20:23], v[92:95]
  v_mfma_f32_16x16x32_bf16 v[92:95], a[116:119], a[28:31], v[92:95]
  buffer_load_dwordx4 a[4:7], v240, s[4:7], s16 offen offset:1024 sc1
  v_mfma_f32_16x16x32_bf16 v[76:79], a[116:119], a[24:27], v[76:79]
  ds_read_b64_tr_b16 a[116:117], v243 offset:43008
  ds_read_b64_tr_b16 a[118:119], v243 offset:47104
  v_mfma_f32_16x16x32_bf16 v[76:79], a[84:87], a[16:19], v[76:79]
  ds_read_b64_tr_b16 a[84:85], v243 offset:34816
  ds_read_b64_tr_b16 a[86:87], v243 offset:38912
  v_mfma_f32_16x16x32_bf16 v[80:83], a[88:91], a[16:19], v[80:83]
  v_mfma_f32_16x16x32_bf16 v[80:83], a[120:123], a[24:27], v[80:83]
  v_mfma_f32_16x16x32_bf16 v[96:99], a[120:123], a[28:31], v[96:99]
  buffer_load_dwordx4 a[8:11], v241, s[4:7], s16 offen offset:0 sc1
  v_mfma_f32_16x16x32_bf16 v[96:99], a[88:91], a[20:23], v[96:99]
  ds_read_b64_tr_b16 a[120:121], v244 offset:43008
  ds_read_b64_tr_b16 a[122:123], v244 offset:47104
  v_mfma_f32_16x16x32_bf16 v[100:103], a[92:95], a[20:23], v[100:103]
  ds_read_b64_tr_b16 a[88:89], v244 offset:34816
  ds_read_b64_tr_b16 a[90:91], v244 offset:38912
  v_mfma_f32_16x16x32_bf16 v[100:103], a[124:127], a[28:31], v[100:103]
  v_mfma_f32_16x16x32_bf16 v[84:87], a[124:127], a[24:27], v[84:87]
  ds_read_b64_tr_b16 a[124:125], v245 offset:43008
  ds_read_b64_tr_b16 a[126:127], v245 offset:47104
  v_mfma_f32_16x16x32_bf16 v[84:87], a[92:95], a[16:19], v[84:87]
  buffer_load_dwordx4 a[12:15], v241, s[4:7], s16 offen offset:1024 sc1
  v_mfma_f32_16x16x32_bf16 v[16:19], a[64:67], a[16:19], v[16:19]
  ds_read_b64_tr_b16 a[92:93], v245 offset:34816
  s_add_u32 s41, s41, 262144
  v_mfma_f32_16x16x32_bf16 v[16:19], a[96:99], a[24:27], v[16:19]
  ds_read_b64_tr_b16 a[94:95], v245 offset:38912
  s_bitset0_b32 s41, 21
  v_mfma_f32_16x16x32_bf16 v[32:35], a[96:99], a[28:31], v[32:35]
  ds_read_b64_tr_b16 a[96:97], v242 offset:40960
  s_add_u32 s16, s40, s41
  v_mfma_f32_16x16x32_bf16 v[32:35], a[64:67], a[20:23], v[32:35]
  ds_read_b64_tr_b16 a[98:99], v242 offset:45056
  ds_read_b64_tr_b16 a[64:65], v242 offset:32768
  s_waitcnt lgkmcnt(10)
  v_mfma_f32_16x16x32_bf16 v[36:39], a[68:71], a[20:23], v[36:39]
  buffer_store_dwordx4 v[120:123], v224, s[12:15], s100 offen offset:2048 sc1
  v_mfma_f32_16x16x32_bf16 v[36:39], a[100:103], a[28:31], v[36:39]
  ds_read_b64_tr_b16 a[66:67], v242 offset:36864
  v_mfma_f32_16x16x32_bf16 v[20:23], a[100:103], a[24:27], v[20:23]
  ds_read_b64_tr_b16 a[100:101], v243 offset:40960
  ds_read_b64_tr_b16 a[102:103], v243 offset:45056
  v_mfma_f32_16x16x32_bf16 v[20:23], a[68:71], a[16:19], v[20:23]
  ds_read_b64_tr_b16 a[68:69], v243 offset:32768
  ds_read_b64_tr_b16 a[70:71], v243 offset:36864
  v_mfma_f32_16x16x32_bf16 v[24:27], a[72:75], a[16:19], v[24:27]
  v_mfma_f32_16x16x32_bf16 v[24:27], a[104:107], a[24:27], v[24:27]
  buffer_store_dwordx4 v[176:179], v224, s[12:15], s100 offen offset:3072 sc1
  v_mfma_f32_16x16x32_bf16 v[40:43], a[104:107], a[28:31], v[40:43]
  ds_read_b64_tr_b16 a[104:105], v244 offset:40960
  ds_read_b64_tr_b16 a[106:107], v244 offset:45056
  v_mfma_f32_16x16x32_bf16 v[40:43], a[72:75], a[20:23], v[40:43]
  ds_read_b64_tr_b16 a[72:73], v244 offset:32768
  ds_read_b64_tr_b16 a[74:75], v244 offset:36864
  v_mfma_f32_16x16x32_bf16 v[44:47], a[76:79], a[20:23], v[44:47]
  v_mfma_f32_16x16x32_bf16 v[44:47], a[108:111], a[28:31], v[44:47]
  v_mfma_f32_16x16x32_bf16 v[28:31], a[108:111], a[24:27], v[28:31]
  ds_read_b64_tr_b16 a[108:109], v245 offset:40960
  ds_read_b64_tr_b16 a[110:111], v245 offset:45056
  v_mfma_f32_16x16x32_bf16 v[28:31], a[76:79], a[16:19], v[28:31]
  s_waitcnt vmcnt(13) lgkmcnt(10)
  s_barrier
  v_mfma_f32_16x16x32_bf16 v[72:75], a[80:83], a[32:35], v[72:75]
  buffer_load_dwordx4 a[16:19], v240, s[4:7], s16 offen offset:0 sc1
  v_mfma_f32_16x16x32_bf16 v[72:75], a[112:115], a[40:43], v[72:75]
  ds_read_b64_tr_b16 a[76:77], v245 offset:32768
  ds_read_b64_tr_b16 a[78:79], v245 offset:36864
  v_mfma_f32_16x16x32_bf16 v[88:91], a[112:115], a[44:47], v[88:91]
  ds_read_b64_tr_b16 a[112:113], v242 offset:59392
  ds_read_b64_tr_b16 a[114:115], v242 offset:63488
  v_mfma_f32_16x16x32_bf16 v[88:91], a[80:83], a[36:39], v[88:91]
  ds_read_b64_tr_b16 a[80:81], v242 offset:51200
  ds_read_b64_tr_b16 a[82:83], v242 offset:55296
  v_mfma_f32_16x16x32_bf16 v[92:95], a[84:87], a[36:39], v[92:95]
  v_mfma_f32_16x16x32_bf16 v[92:95], a[116:119], a[44:47], v[92:95]
  buffer_load_dwordx4 a[20:23], v240, s[4:7], s16 offen offset:1024 sc1
  v_mfma_f32_16x16x32_bf16 v[76:79], a[116:119], a[40:43], v[76:79]
  ds_read_b64_tr_b16 a[116:117], v243 offset:59392
  ds_read_b64_tr_b16 a[118:119], v243 offset:63488
  v_mfma_f32_16x16x32_bf16 v[76:79], a[84:87], a[32:35], v[76:79]
  ds_read_b64_tr_b16 a[84:85], v243 offset:51200
  ds_read_b64_tr_b16 a[86:87], v243 offset:55296
  v_mfma_f32_16x16x32_bf16 v[80:83], a[88:91], a[32:35], v[80:83]
  v_mfma_f32_16x16x32_bf16 v[80:83], a[120:123], a[40:43], v[80:83]
  v_mfma_f32_16x16x32_bf16 v[96:99], a[120:123], a[44:47], v[96:99]
  buffer_load_dwordx4 a[24:27], v241, s[4:7], s16 offen offset:0 sc1
  v_mfma_f32_16x16x32_bf16 v[96:99], a[88:91], a[36:39], v[96:99]
  ds_read_b64_tr_b16 a[120:121], v244 offset:59392
  ds_read_b64_tr_b16 a[122:123], v244 offset:63488
  v_mfma_f32_16x16x32_bf16 v[100:103], a[92:95], a[36:39], v[100:103]
  ds_read_b64_tr_b16 a[88:89], v244 offset:51200
  ds_read_b64_tr_b16 a[90:91], v244 offset:55296
  v_mfma_f32_16x16x32_bf16 v[100:103], a[124:127], a[44:47], v[100:103]
  v_mfma_f32_16x16x32_bf16 v[84:87], a[124:127], a[40:43], v[84:87]
  ds_read_b64_tr_b16 a[124:125], v245 offset:59392
  ds_read_b64_tr_b16 a[126:127], v245 offset:63488
  v_mfma_f32_16x16x32_bf16 v[84:87], a[92:95], a[32:35], v[84:87]
  buffer_load_dwordx4 a[28:31], v241, s[4:7], s16 offen offset:1024 sc1
  v_mfma_f32_16x16x32_bf16 v[16:19], a[64:67], a[32:35], v[16:19]
  ds_read_b64_tr_b16 a[92:93], v245 offset:51200
  s_add_u32 s41, s41, 262144
  v_mfma_f32_16x16x32_bf16 v[16:19], a[96:99], a[40:43], v[16:19]
  ds_read_b64_tr_b16 a[94:95], v245 offset:55296
  s_bitset0_b32 s41, 21
  v_mfma_f32_16x16x32_bf16 v[32:35], a[96:99], a[44:47], v[32:35]
  ds_read_b64_tr_b16 a[96:97], v242 offset:57344
  s_add_u32 s16, s40, s41
  v_mfma_f32_16x16x32_bf16 v[32:35], a[64:67], a[36:39], v[32:35]
  ds_read_b64_tr_b16 a[98:99], v242 offset:61440
  ds_read_b64_tr_b16 a[64:65], v242 offset:49152
  s_waitcnt lgkmcnt(10)
  v_mfma_f32_16x16x32_bf16 v[36:39], a[68:71], a[36:39], v[36:39]
  buffer_store_dwordx4 v[12:15], v224, s[12:15], s101 offen offset:0 sc1
  v_mfma_f32_16x16x32_bf16 v[36:39], a[100:103], a[44:47], v[36:39]
  ds_read_b64_tr_b16 a[66:67], v242 offset:53248
  v_mfma_f32_16x16x32_bf16 v[20:23], a[100:103], a[40:43], v[20:23]
  ds_read_b64_tr_b16 a[100:101], v243 offset:57344
  ds_read_b64_tr_b16 a[102:103], v243 offset:61440
  v_mfma_f32_16x16x32_bf16 v[20:23], a[68:71], a[32:35], v[20:23]
  ds_read_b64_tr_b16 a[68:69], v243 offset:49152
  ds_read_b64_tr_b16 a[70:71], v243 offset:53248
  v_mfma_f32_16x16x32_bf16 v[24:27], a[72:75], a[32:35], v[24:27]
  v_mfma_f32_16x16x32_bf16 v[24:27], a[104:107], a[40:43], v[24:27]
  buffer_store_dwordx4 v[124:127], v224, s[12:15], s101 offen offset:2048 sc1
  v_mfma_f32_16x16x32_bf16 v[40:43], a[104:107], a[44:47], v[40:43]
  ds_read_b64_tr_b16 a[104:105], v244 offset:57344
  ds_read_b64_tr_b16 a[106:107], v244 offset:61440
  v_mfma_f32_16x16x32_bf16 v[40:43], a[72:75], a[36:39], v[40:43]
  ds_read_b64_tr_b16 a[72:73], v244 offset:49152
  ds_read_b64_tr_b16 a[74:75], v244 offset:53248
  v_mfma_f32_16x16x32_bf16 v[44:47], a[76:79], a[36:39], v[44:47]
  v_mfma_f32_16x16x32_bf16 v[44:47], a[108:111], a[44:47], v[44:47]
  v_mfma_f32_16x16x32_bf16 v[28:31], a[108:111], a[40:43], v[28:31]
  ds_read_b64_tr_b16 a[108:109], v245 offset:57344
  ds_read_b64_tr_b16 a[110:111], v245 offset:61440
  v_mfma_f32_16x16x32_bf16 v[28:31], a[76:79], a[32:35], v[28:31]
  s_waitcnt vmcnt(14) lgkmcnt(10)
  s_barrier
  v_mfma_f32_16x16x32_bf16 v[72:75], a[80:83], a[48:51], v[72:75]
  ds_read_b64_tr_b16 a[76:77], v245 offset:49152
  s_add_u32 m0, s38, 0
  v_mfma_f32_16x16x32_bf16 v[72:75], a[112:115], a[56:59], v[72:75]
  buffer_load_dwordx4 v225, s[8:11], s17 offen lds
  v_mfma_f32_16x16x32_bf16 v[88:91], a[112:115], a[60:63], v[88:91]
  ds_read_b64_tr_b16 a[78:79], v245 offset:53248
  ds_read_b64_tr_b16 a[112:113], v104 offset:10240
  v_mfma_f32_16x16x32_bf16 v[88:91], a[80:83], a[52:55], v[88:91]
  ds_read_b64_tr_b16 a[114:115], v104 offset:14336
  ds_read_b64_tr_b16 a[80:81], v104 offset:2048
  v_mfma_f32_16x16x32_bf16 v[92:95], a[84:87], a[52:55], v[92:95]
  buffer_load_dwordx4 a[32:35], v240, s[4:7], s16 offen offset:0 sc1
  v_mfma_f32_16x16x32_bf16 v[92:95], a[116:119], a[60:63], v[92:95]
  ds_read_b64_tr_b16 a[82:83], v104 offset:6144
  v_mfma_f32_16x16x32_bf16 v[76:79], a[116:119], a[56:59], v[76:79]
  ds_read_b64_tr_b16 a[116:117], v105 offset:10240
  ds_read_b64_tr_b16 a[118:119], v105 offset:14336
  v_mfma_f32_16x16x32_bf16 v[76:79], a[84:87], a[48:51], v[76:79]
  ds_read_b64_tr_b16 a[84:85], v105 offset:2048
  ds_read_b64_tr_b16 a[86:87], v105 offset:6144
  v_mfma_f32_16x16x32_bf16 v[80:83], a[88:91], a[48:51], v[80:83]
  buffer_load_dwordx4 v226, s[8:11], s17 offen offset:1024 lds
  v_mfma_f32_16x16x32_bf16 v[80:83], a[120:123], a[56:59], v[80:83]
  v_mfma_f32_16x16x32_bf16 v[96:99], a[120:123], a[60:63], v[96:99]
  ds_read_b64_tr_b16 a[120:121], v106 offset:10240
  ds_read_b64_tr_b16 a[122:123], v106 offset:14336
  v_mfma_f32_16x16x32_bf16 v[96:99], a[88:91], a[52:55], v[96:99]
  ds_read_b64_tr_b16 a[88:89], v106 offset:2048
  ds_read_b64_tr_b16 a[90:91], v106 offset:6144
  v_mfma_f32_16x16x32_bf16 v[100:103], a[92:95], a[52:55], v[100:103]
  buffer_load_dwordx4 a[36:39], v240, s[4:7], s16 offen offset:1024 sc1
  v_mfma_f32_16x16x32_bf16 v[100:103], a[124:127], a[60:63], v[100:103]
  v_mfma_f32_16x16x32_bf16 v[84:87], a[124:127], a[56:59], v[84:87]
  ds_read_b64_tr_b16 a[124:125], v107 offset:10240
  ds_read_b64_tr_b16 a[126:127], v107 offset:14336
  v_mfma_f32_16x16x32_bf16 v[84:87], a[92:95], a[48:51], v[84:87]
  buffer_load_dword v247, v246, s[56:59], s94 offen sc1
  v_mfma_f32_16x16x32_bf16 v[16:19], a[64:67], a[48:51], v[16:19]
  buffer_load_dwordx4 v227, s[8:11], s17 offen offset:2048 lds
  v_mfma_f32_16x16x32_bf16 v[16:19], a[96:99], a[56:59], v[16:19]
  ds_read_b64_tr_b16 a[92:93], v107 offset:2048
  ds_read_b64_tr_b16 a[94:95], v107 offset:6144
  v_mfma_f32_16x16x32_bf16 v[32:35], a[96:99], a[60:63], v[32:35]
  ds_read_b64_tr_b16 a[96:97], v104 offset:8192
  ds_read_b64_tr_b16 a[98:99], v104 offset:12288
  v_mfma_f32_16x16x32_bf16 v[32:35], a[64:67], a[52:55], v[32:35]
  ds_read_b64_tr_b16 a[64:65], v104 offset:0
  ds_read_b64_tr_b16 a[66:67], v104 offset:4096
  s_waitcnt lgkmcnt(10)
  v_mfma_f32_16x16x32_bf16 v[36:39], a[68:71], a[52:55], v[36:39]
  buffer_load_dwordx4 a[40:43], v241, s[4:7], s16 offen offset:0 sc1
  v_mfma_f32_16x16x32_bf16 v[36:39], a[100:103], a[60:63], v[36:39]
  v_mfma_f32_16x16x32_bf16 v[20:23], a[100:103], a[56:59], v[20:23]
  ds_read_b64_tr_b16 a[100:101], v105 offset:8192
  ds_read_b64_tr_b16 a[102:103], v105 offset:12288
  v_mfma_f32_16x16x32_bf16 v[20:23], a[68:71], a[48:51], v[20:23]
  buffer_load_dwordx4 v228, s[8:11], s17 offen offset:3072 lds
  v_mfma_f32_16x16x32_bf16 v[24:27], a[72:75], a[48:51], v[24:27]
  ds_read_b64_tr_b16 a[68:69], v105 offset:0
  s_add_u32 s17, s17, 458752
  v_mfma_f32_16x16x32_bf16 v[24:27], a[104:107], a[56:59], v[24:27]
  ds_read_b64_tr_b16 a[70:71], v105 offset:4096
  s_cmp_eq_u32 s17, s93
  v_mfma_f32_16x16x32_bf16 v[40:43], a[104:107], a[60:63], v[40:43]
  ds_read_b64_tr_b16 a[104:105], v106 offset:8192
  s_cselect_b32 s17, s95, s17
  v_mfma_f32_16x16x32_bf16 v[40:43], a[72:75], a[52:55], v[40:43]
  buffer_load_dwordx4 a[44:47], v241, s[4:7], s16 offen offset:1024 sc1
  v_mfma_f32_16x16x32_bf16 v[44:47], a[76:79], a[52:55], v[44:47]
  ds_read_b64_tr_b16 a[106:107], v106 offset:12288
  s_add_u32 s41, s41, 262144
  v_mfma_f32_16x16x32_bf16 v[44:47], a[108:111], a[60:63], v[44:47]
  ds_read_b64_tr_b16 a[72:73], v106 offset:0
  s_bitset0_b32 s41, 21
  v_mfma_f32_16x16x32_bf16 v[28:31], a[108:111], a[56:59], v[28:31]
  ds_read_b64_tr_b16 a[74:75], v106 offset:4096
  s_add_u32 s16, s40, s41
  v_mfma_f32_16x16x32_bf16 v[28:31], a[76:79], a[48:51], v[28:31]
  s_waitcnt vmcnt(17) lgkmcnt(10)
  s_barrier
  v_mfma_f32_16x16x32_bf16 v[72:75], a[80:83], a[0:3], v[72:75]
  ds_read_b64_tr_b16 a[108:109], v107 offset:8192
  s_add_u32 m0, s38, 16384
  v_mfma_f32_16x16x32_bf16 v[72:75], a[112:115], a[8:11], v[72:75]
  ds_read_b64_tr_b16 a[110:111], v107 offset:12288
  buffer_load_dwordx4 v225, s[8:11], s17 offen lds
  v_mfma_f32_16x16x32_bf16 v[88:91], a[112:115], a[12:15], v[88:91]
  ds_read_b64_tr_b16 a[76:77], v107 offset:0
  ds_read_b64_tr_b16 a[78:79], v107 offset:4096
  v_add_u32 v124, 131072, v242
  v_mfma_f32_16x16x32_bf16 v[88:91], a[80:83], a[4:7], v[88:91]
  ds_read_b64_tr_b16 a[112:113], v104 offset:26624
  ds_read_b64_tr_b16 a[114:115], v104 offset:30720
  v_mfma_f32_16x16x32_bf16 v[92:95], a[84:87], a[4:7], v[92:95]
  buffer_load_dwordx4 a[48:51], v240, s[4:7], s16 offen offset:0 sc1
  v_mfma_f32_16x16x32_bf16 v[92:95], a[116:119], a[12:15], v[92:95]
  ds_read_b64_tr_b16 a[80:81], v104 offset:18432
  ds_read_b64_tr_b16 a[82:83], v104 offset:22528
  v_mfma_f32_16x16x32_bf16 v[76:79], a[116:119], a[8:11], v[76:79]
  ds_read_b64_tr_b16 a[116:117], v105 offset:26624
  v_add_u32 v125, 131072, v243
  v_mfma_f32_16x16x32_bf16 v[76:79], a[84:87], a[0:3], v[76:79]
  ds_read_b64_tr_b16 a[118:119], v105 offset:30720
  ds_read_b64_tr_b16 a[84:85], v105 offset:18432
  v_mfma_f32_16x16x32_bf16 v[80:83], a[88:91], a[0:3], v[80:83]
  buffer_load_dwordx4 v226, s[8:11], s17 offen offset:1024 lds
  v_mfma_f32_16x16x32_bf16 v[80:83], a[120:123], a[8:11], v[80:83]
  ds_read_b64_tr_b16 a[86:87], v105 offset:22528
  v_mfma_f32_16x16x32_bf16 v[96:99], a[120:123], a[12:15], v[96:99]
  ds_read_b64_tr_b16 a[120:121], v106 offset:26624
  v_add_u32 v126, 131072, v244
  v_mfma_f32_16x16x32_bf16 v[96:99], a[88:91], a[4:7], v[96:99]
  ds_read_b64_tr_b16 a[122:123], v106 offset:30720
  ds_read_b64_tr_b16 a[88:89], v106 offset:18432
  v_mfma_f32_16x16x32_bf16 v[100:103], a[92:95], a[4:7], v[100:103]
  buffer_load_dwordx4 a[52:55], v240, s[4:7], s16 offen offset:1024 sc1
  v_mfma_f32_16x16x32_bf16 v[100:103], a[124:127], a[12:15], v[100:103]
  ds_read_b64_tr_b16 a[90:91], v106 offset:22528
  v_mfma_f32_16x16x32_bf16 v[84:87], a[124:127], a[8:11], v[84:87]
  ds_read_b64_tr_b16 a[124:125], v107 offset:26624
  v_add_u32 v127, 131072, v245
  v_mfma_f32_16x16x32_bf16 v[84:87], a[92:95], a[0:3], v[84:87]
  ds_read_b64_tr_b16 a[126:127], v107 offset:30720
  ds_read_b64_tr_b16 a[92:93], v107 offset:18432
  s_waitcnt lgkmcnt(10)
  v_mfma_f32_16x16x32_bf16 v[16:19], a[64:67], a[0:3], v[16:19]
  buffer_load_dwordx4 v227, s[8:11], s17 offen offset:2048 lds
  v_mfma_f32_16x16x32_bf16 v[16:19], a[96:99], a[8:11], v[16:19]
  ds_read_b64_tr_b16 a[94:95], v107 offset:22528
  v_mfma_f32_16x16x32_bf16 v[32:35], a[96:99], a[12:15], v[32:35]
  ds_read_b64_tr_b16 a[96:97], v104 offset:24576
  ds_read_b64_tr_b16 a[98:99], v104 offset:28672
  v_mfma_f32_16x16x32_bf16 v[32:35], a[64:67], a[4:7], v[32:35]
  ds_read_b64_tr_b16 a[64:65], v104 offset:16384
  ds_read_b64_tr_b16 a[66:67], v104 offset:20480
  v_mfma_f32_16x16x32_bf16 v[36:39], a[68:71], a[4:7], v[36:39]
  buffer_load_dwordx4 a[56:59], v241, s[4:7], s16 offen offset:0 sc1
  v_mfma_f32_16x16x32_bf16 v[36:39], a[100:103], a[12:15], v[36:39]
  v_mfma_f32_16x16x32_bf16 v[20:23], a[100:103], a[8:11], v[20:23]
  buffer_load_dwordx4 v228, s[8:11], s17 offen offset:3072 lds
  v_mfma_f32_16x16x32_bf16 v[20:23], a[68:71], a[0:3], v[20:23]
  ds_read_b64_tr_b16 a[100:101], v105 offset:24576
  s_add_u32 s17, s17, 458752
  v_mfma_f32_16x16x32_bf16 v[24:27], a[72:75], a[0:3], v[24:27]
  ds_read_b64_tr_b16 a[102:103], v105 offset:28672
  s_cmp_eq_u32 s17, s93
  v_mfma_f32_16x16x32_bf16 v[24:27], a[104:107], a[8:11], v[24:27]
  ds_read_b64_tr_b16 a[68:69], v105 offset:16384
  s_cselect_b32 s17, s95, s17
  v_mfma_f32_16x16x32_bf16 v[40:43], a[104:107], a[12:15], v[40:43]
  ds_read_b64_tr_b16 a[70:71], v105 offset:20480
  buffer_load_dwordx4 a[60:63], v241, s[4:7], s16 offen offset:1024 sc1
  v_mfma_f32_16x16x32_bf16 v[40:43], a[72:75], a[4:7], v[40:43]
  ds_read_b64_tr_b16 a[104:105], v106 offset:24576
  s_add_u32 s41, s41, 262144
  v_mfma_f32_16x16x32_bf16 v[44:47], a[76:79], a[4:7], v[44:47]
  ds_read_b64_tr_b16 a[106:107], v106 offset:28672
  s_bitset0_b32 s41, 21
  v_mfma_f32_16x16x32_bf16 v[44:47], a[108:111], a[12:15], v[44:47]
  ds_read_b64_tr_b16 a[72:73], v106 offset:16384
  s_add_u32 s40, s40, 2097152
  v_mfma_f32_16x16x32_bf16 v[28:31], a[108:111], a[8:11], v[28:31]
  ds_read_b64_tr_b16 a[74:75], v106 offset:20480
  s_add_u32 s16, s40, s41
  v_mfma_f32_16x16x32_bf16 v[28:31], a[76:79], a[0:3], v[28:31]
  s_waitcnt vmcnt(12) lgkmcnt(10)
  s_barrier
  v_cmp_ne_u32 vcc, s19, v247
  s_nop 1
  s_cmp_lg_u64 vcc, 0
  s_cbranch_scc1 L_slow_27
  L_back_28:
  s_add_u32 s94, s94, 65536
  v_mfma_f32_16x16x32_bf16 v[72:75], a[80:83], a[16:19], v[72:75]
  buffer_load_dwordx4 a[0:3], v240, s[4:7], s16 offen offset:0 sc1
  v_mfma_f32_16x16x32_bf16 v[72:75], a[112:115], a[24:27], v[72:75]
  ds_read_b64_tr_b16 a[108:109], v107 offset:24576
  ds_read_b64_tr_b16 a[110:111], v107 offset:28672
  v_mfma_f32_16x16x32_bf16 v[88:91], a[112:115], a[28:31], v[88:91]
  ds_read_b64_tr_b16 a[76:77], v107 offset:16384
  ds_read_b64_tr_b16 a[78:79], v107 offset:20480
  v_mfma_f32_16x16x32_bf16 v[88:91], a[80:83], a[20:23], v[88:91]
  ds_read_b64_tr_b16 a[112:113], v104 offset:43008
  ds_read_b64_tr_b16 a[114:115], v104 offset:47104
  v_mfma_f32_16x16x32_bf16 v[92:95], a[84:87], a[20:23], v[92:95]
  ds_read_b64_tr_b16 a[80:81], v104 offset:34816
  ds_read_b64_tr_b16 a[82:83], v104 offset:38912
  v_mfma_f32_16x16x32_bf16 v[92:95], a[116:119], a[28:31], v[92:95]
  v_mfma_f32_16x16x32_bf16 v[76:79], a[116:119], a[24:27], v[76:79]
  ds_read_b64_tr_b16 a[116:117], v105 offset:43008
  ds_read_b64_tr_b16 a[118:119], v105 offset:47104
  v_mfma_f32_16x16x32_bf16 v[76:79], a[84:87], a[16:19], v[76:79]
  buffer_load_dwordx4 a[4:7], v240, s[4:7], s16 offen offset:1024 sc1
  v_mfma_f32_16x16x32_bf16 v[80:83], a[88:91], a[16:19], v[80:83]
  ds_read_b64_tr_b16 a[84:85], v105 offset:34816
  ds_read_b64_tr_b16 a[86:87], v105 offset:38912
  v_mfma_f32_16x16x32_bf16 v[80:83], a[120:123], a[24:27], v[80:83]
  v_mfma_f32_16x16x32_bf16 v[96:99], a[120:123], a[28:31], v[96:99]
  ds_read_b64_tr_b16 a[120:121], v106 offset:43008
  ds_read_b64_tr_b16 a[122:123], v106 offset:47104
  v_mfma_f32_16x16x32_bf16 v[96:99], a[88:91], a[20:23], v[96:99]
  ds_read_b64_tr_b16 a[88:89], v106 offset:34816
  ds_read_b64_tr_b16 a[90:91], v106 offset:38912
  v_mfma_f32_16x16x32_bf16 v[100:103], a[92:95], a[20:23], v[100:103]
  v_mfma_f32_16x16x32_bf16 v[100:103], a[124:127], a[28:31], v[100:103]
  v_mfma_f32_16x16x32_bf16 v[84:87], a[124:127], a[24:27], v[84:87]
  ds_read_b64_tr_b16 a[124:125], v107 offset:43008
  ds_read_b64_tr_b16 a[126:127], v107 offset:47104
  v_mfma_f32_16x16x32_bf16 v[84:87], a[92:95], a[16:19], v[84:87]
  buffer_load_dwordx4 a[8:11], v241, s[4:7], s16 offen offset:0 sc1
  s_waitcnt lgkmcnt(10)
  v_mfma_f32_16x16x32_bf16 v[16:19], a[64:67], a[16:19], v[16:19]
  ds_read_b64_tr_b16 a[92:93], v107 offset:34816
  ds_read_b64_tr_b16 a[94:95], v107 offset:38912
  v_mfma_f32_16x16x32_bf16 v[16:19], a[96:99], a[24:27], v[16:19]
  v_mfma_f32_16x16x32_bf16 v[32:35], a[96:99], a[28:31], v[32:35]
  ds_read_b64_tr_b16 a[96:97], v104 offset:40960
  ds_read_b64_tr_b16 a[98:99], v104 offset:45056
  v_mfma_f32_16x16x32_bf16 v[32:35], a[64:67], a[20:23], v[32:35]
  ds_read_b64_tr_b16 a[64:65], v104 offset:32768
  ds_read_b64_tr_b16 a[66:67], v104 offset:36864
  v_mfma_f32_16x16x32_bf16 v[36:39], a[68:71], a[20:23], v[36:39]
  v_mfma_f32_16x16x32_bf16 v[36:39], a[100:103], a[28:31], v[36:39]
  v_mfma_f32_16x16x32_bf16 v[20:23], a[100:103], a[24:27], v[20:23]
  ds_read_b64_tr_b16 a[100:101], v105 offset:40960
  ds_read_b64_tr_b16 a[102:103], v105 offset:45056
  v_mfma_f32_16x16x32_bf16 v[20:23], a[68:71], a[16:19], v[20:23]
  buffer_load_dwordx4 a[12:15], v241, s[4:7], s16 offen offset:1024 sc1
  v_mfma_f32_16x16x32_bf16 v[24:27], a[72:75], a[16:19], v[24:27]
  ds_read_b64_tr_b16 a[68:69], v105 offset:32768
  s_add_u32 s41, s41, 262144
  v_mfma_f32_16x16x32_bf16 v[24:27], a[104:107], a[24:27], v[24:27]
  ds_read_b64_tr_b16 a[70:71], v105 offset:36864
  s_bitset0_b32 s41, 21
  v_mfma_f32_16x16x32_bf16 v[40:43], a[104:107], a[28:31], v[40:43]
  ds_read_b64_tr_b16 a[104:105], v106 offset:40960
  s_add_u32 s16, s40, s41
  v_mfma_f32_16x16x32_bf16 v[40:43], a[72:75], a[20:23], v[40:43]
  ds_read_b64_tr_b16 a[106:107], v106 offset:45056
  ds_read_b64_tr_b16 a[72:73], v106 offset:32768
  v_mfma_f32_16x16x32_bf16 v[44:47], a[76:79], a[20:23], v[44:47]
  ds_read_b64_tr_b16 a[74:75], v106 offset:36864
  v_mfma_f32_16x16x32_bf16 v[44:47], a[108:111], a[28:31], v[44:47]
  v_mfma_f32_16x16x32_bf16 v[28:31], a[108:111], a[24:27], v[28:31]
  ds_read_b64_tr_b16 a[108:109], v107 offset:40960
  ds_read_b64_tr_b16 a[110:111], v107 offset:45056
  v_mfma_f32_16x16x32_bf16 v[28:31], a[76:79], a[16:19], v[28:31]
  s_waitcnt vmcnt(12) lgkmcnt(10)
  s_barrier
  s_mov_b64 exec, 1
  buffer_store_dword v248, v250, s[56:59], s92 offen sc1
  s_mov_b64 exec, -1
  s_add_u32 s92, s92, 65536
  v_mfma_f32_16x16x32_bf16 v[72:75], a[80:83], a[32:35], v[72:75]
  ds_read_b64_tr_b16 a[76:77], v107 offset:32768
  s_add_u32 m0, s38, 32768
  v_mfma_f32_16x16x32_bf16 v[72:75], a[112:115], a[40:43], v[72:75]
  buffer_load_dwordx4 v225, s[8:11], s17 offen lds
  v_mfma_f32_16x16x32_bf16 v[88:91], a[112:115], a[44:47], v[88:91]
  ds_read_b64_tr_b16 a[78:79], v107 offset:36864
  ds_read_b64_tr_b16 a[112:113], v104 offset:59392
  v_mfma_f32_16x16x32_bf16 v[88:91], a[80:83], a[36:39], v[88:91]
  ds_read_b64_tr_b16 a[114:115], v104 offset:63488
  ds_read_b64_tr_b16 a[80:81], v104 offset:51200
  v_mfma_f32_16x16x32_bf16 v[92:95], a[84:87], a[36:39], v[92:95]
  buffer_load_dwordx4 a[16:19], v240, s[4:7], s16 offen offset:0 sc1
  v_mfma_f32_16x16x32_bf16 v[92:95], a[116:119], a[44:47], v[92:95]
  ds_read_b64_tr_b16 a[82:83], v104 offset:55296
  v_mfma_f32_16x16x32_bf16 v[76:79], a[116:119], a[40:43], v[76:79]
  ds_read_b64_tr_b16 a[116:117], v105 offset:59392
  ds_read_b64_tr_b16 a[118:119], v105 offset:63488
  v_mfma_f32_16x16x32_bf16 v[76:79], a[84:87], a[32:35], v[76:79]
  ds_read_b64_tr_b16 a[84:85], v105 offset:51200
  ds_read_b64_tr_b16 a[86:87], v105 offset:55296
  v_mfma_f32_16x16x32_bf16 v[80:83], a[88:91], a[32:35], v[80:83]
  buffer_load_dwordx4 v226, s[8:11], s17 offen offset:1024 lds
  v_mfma_f32_16x16x32_bf16 v[80:83], a[120:123], a[40:43], v[80:83]
  v_mfma_f32_16x16x32_bf16 v[96:99], a[120:123], a[44:47], v[96:99]
  ds_read_b64_tr_b16 a[120:121], v106 offset:59392
  ds_read_b64_tr_b16 a[122:123], v106 offset:63488
  v_mfma_f32_16x16x32_bf16 v[96:99], a[88:91], a[36:39], v[96:99]
  ds_read_b64_tr_b16 a[88:89], v106 offset:51200
  ds_read_b64_tr_b16 a[90:91], v106 offset:55296
  v_mfma_f32_16x16x32_bf16 v[100:103], a[92:95], a[36:39], v[100:103]
  buffer_load_dwordx4 a[20:23], v240, s[4:7], s16 offen offset:1024 sc1
  v_mfma_f32_16x16x32_bf16 v[100:103], a[124:127], a[44:47], v[100:103]
  v_mfma_f32_16x16x32_bf16 v[84:87], a[124:127], a[40:43], v[84:87]
  ds_read_b64_tr_b16 a[124:125], v107 offset:59392
  ds_read_b64_tr_b16 a[126:127], v107 offset:63488
  v_mfma_f32_16x16x32_bf16 v[84:87], a[92:95], a[32:35], v[84:87]
  ds_read_b64_tr_b16 a[92:93], v107 offset:51200
  ds_read_b64_tr_b16 a[94:95], v107 offset:55296
  v_mfma_f32_16x16x32_bf16 v[16:19], a[64:67], a[32:35], v[16:19]
  buffer_load_dwordx4 v227, s[8:11], s17 offen offset:2048 lds
  v_mfma_f32_16x16x32_bf16 v[16:19], a[96:99], a[40:43], v[16:19]
  v_mfma_f32_16x16x32_bf16 v[32:35], a[96:99], a[44:47], v[32:35]
  ds_read_b64_tr_b16 a[96:97], v104 offset:57344
  ds_read_b64_tr_b16 a[98:99], v104 offset:61440
  v_mfma_f32_16x16x32_bf16 v[32:35], a[64:67], a[36:39], v[32:35]
  ds_read_b64_tr_b16 a[64:65], v104 offset:49152
  ds_read_b64_tr_b16 a[66:67], v104 offset:53248
  s_waitcnt lgkmcnt(10)
  v_mfma_f32_16x16x32_bf16 v[36:39], a[68:71], a[36:39], v[36:39]
  buffer_load_dwordx4 a[24:27], v241, s[4:7], s16 offen offset:0 sc1
  v_mfma_f32_16x16x32_bf16 v[36:39], a[100:103], a[44:47], v[36:39]
  v_mfma_f32_16x16x32_bf16 v[20:23], a[100:103], a[40:43], v[20:23]
  ds_read_b64_tr_b16 a[100:101], v105 offset:57344
  ds_read_b64_tr_b16 a[102:103], v105 offset:61440
  v_mfma_f32_16x16x32_bf16 v[20:23], a[68:71], a[32:35], v[20:23]
  buffer_load_dwordx4 v228, s[8:11], s17 offen offset:3072 lds
  v_mfma_f32_16x16x32_bf16 v[24:27], a[72:75], a[32:35], v[24:27]
  ds_read_b64_tr_b16 a[68:69], v105 offset:49152
  s_add_u32 s17, s17, 458752
  v_mfma_f32_16x16x32_bf16 v[24:27], a[104:107], a[40:43], v[24:27]
  ds_read_b64_tr_b16 a[70:71], v105 offset:53248
  s_cmp_eq_u32 s17, s93
  v_mfma_f32_16x16x32_bf16 v[40:43], a[104:107], a[44:47], v[40:43]
  ds_read_b64_tr_b16 a[104:105], v106 offset:57344
  s_cselect_b32 s17, s95, s17
  v_mfma_f32_16x16x32_bf16 v[40:43], a[72:75], a[36:39], v[40:43]
  buffer_load_dwordx4 a[28:31], v241, s[4:7], s16 offen offset:1024 sc1
  v_mfma_f32_16x16x32_bf16 v[44:47], a[76:79], a[36:39], v[44:47]
  ds_read_b64_tr_b16 a[106:107], v106 offset:61440
  s_add_u32 s41, s41, 262144
  v_mfma_f32_16x16x32_bf16 v[44:47], a[108:111], a[44:47], v[44:47]
  ds_read_b64_tr_b16 a[72:73], v106 offset:49152
  s_bitset0_b32 s41, 21
  v_mfma_f32_16x16x32_bf16 v[28:31], a[108:111], a[40:43], v[28:31]
  ds_read_b64_tr_b16 a[74:75], v106 offset:53248
  s_add_u32 s16, s40, s41
  v_mfma_f32_16x16x32_bf16 v[28:31], a[76:79], a[32:35], v[28:31]
  s_waitcnt vmcnt(13) lgkmcnt(10)
  s_barrier
  v_mfma_f32_16x16x32_bf16 v[72:75], a[80:83], a[48:51], v[72:75]
  ds_read_b64_tr_b16 a[108:109], v107 offset:57344
  s_add_u32 m0, s38, 49152
  v_mfma_f32_16x16x32_bf16 v[72:75], a[112:115], a[56:59], v[72:75]
  ds_read_b64_tr_b16 a[110:111], v107 offset:61440
  buffer_load_dwordx4 v225, s[8:11], s17 offen lds
  v_mfma_f32_16x16x32_bf16 v[88:91], a[112:115], a[60:63], v[88:91]
  ds_read_b64_tr_b16 a[76:77], v107 offset:49152
  ds_read_b64_tr_b16 a[78:79], v107 offset:53248
  v_mfma_f32_16x16x32_bf16 v[88:91], a[80:83], a[52:55], v[88:91]
  ds_read_b64_tr_b16 a[112:113], v124 offset:10240
  ds_read_b64_tr_b16 a[114:115], v124 offset:14336
  v_mfma_f32_16x16x32_bf16 v[92:95], a[84:87], a[52:55], v[92:95]
  buffer_load_dwordx4 a[32:35], v240, s[4:7], s16 offen offset:0 sc1
  v_mfma_f32_16x16x32_bf16 v[92:95], a[116:119], a[60:63], v[92:95]
  ds_read_b64_tr_b16 a[80:81], v124 offset:2048
  ds_read_b64_tr_b16 a[82:83], v124 offset:6144
  v_mfma_f32_16x16x32_bf16 v[76:79], a[116:119], a[56:59], v[76:79]
  ds_read_b64_tr_b16 a[116:117], v125 offset:10240
  ds_read_b64_tr_b16 a[118:119], v125 offset:14336
  v_mfma_f32_16x16x32_bf16 v[76:79], a[84:87], a[48:51], v[76:79]
  ds_read_b64_tr_b16 a[84:85], v125 offset:2048
  ds_read_b64_tr_b16 a[86:87], v125 offset:6144
  v_mfma_f32_16x16x32_bf16 v[80:83], a[88:91], a[48:51], v[80:83]
  buffer_load_dwordx4 v226, s[8:11], s17 offen offset:1024 lds
  v_mfma_f32_16x16x32_bf16 v[80:83], a[120:123], a[56:59], v[80:83]
  v_mfma_f32_16x16x32_bf16 v[96:99], a[120:123], a[60:63], v[96:99]
  ds_read_b64_tr_b16 a[120:121], v126 offset:10240
  ds_read_b64_tr_b16 a[122:123], v126 offset:14336
  v_mfma_f32_16x16x32_bf16 v[96:99], a[88:91], a[52:55], v[96:99]
  ds_read_b64_tr_b16 a[88:89], v126 offset:2048
  ds_read_b64_tr_b16 a[90:91], v126 offset:6144
  v_mfma_f32_16x16x32_bf16 v[100:103], a[92:95], a[52:55], v[100:103]
  buffer_load_dwordx4 a[36:39], v240, s[4:7], s16 offen offset:1024 sc1
  v_mfma_f32_16x16x32_bf16 v[100:103], a[124:127], a[60:63], v[100:103]
  v_mfma_f32_16x16x32_bf16 v[84:87], a[124:127], a[56:59], v[84:87]
  ds_read_b64_tr_b16 a[124:125], v127 offset:10240
  ds_read_b64_tr_b16 a[126:127], v127 offset:14336
  v_mfma_f32_16x16x32_bf16 v[84:87], a[92:95], a[48:51], v[84:87]
  ds_read_b64_tr_b16 a[92:93], v127 offset:2048
  ds_read_b64_tr_b16 a[94:95], v127 offset:6144
  s_waitcnt lgkmcnt(10)
  v_mfma_f32_16x16x32_bf16 v[16:19], a[64:67], a[48:51], v[16:19]
  buffer_load_dwordx4 v227, s[8:11], s17 offen offset:2048 lds
  v_mfma_f32_16x16x32_bf16 v[16:19], a[96:99], a[56:59], v[16:19]
  v_mfma_f32_16x16x32_bf16 v[32:35], a[96:99], a[60:63], v[32:35]
  ds_read_b64_tr_b16 a[96:97], v124 offset:8192
  ds_read_b64_tr_b16 a[98:99], v124 offset:12288
  v_mfma_f32_16x16x32_bf16 v[32:35], a[64:67], a[52:55], v[32:35]
  ds_read_b64_tr_b16 a[64:65], v124 offset:0
  ds_read_b64_tr_b16 a[66:67], v124 offset:4096
  v_mfma_f32_16x16x32_bf16 v[36:39], a[68:71], a[52:55], v[36:39]
  buffer_load_dwordx4 a[40:43], v241, s[4:7], s16 offen offset:0 sc1
  v_mfma_f32_16x16x32_bf16 v[36:39], a[100:103], a[60:63], v[36:39]
  v_mfma_f32_16x16x32_bf16 v[20:23], a[100:103], a[56:59], v[20:23]
  ds_read_b64_tr_b16 a[100:101], v125 offset:8192
  ds_read_b64_tr_b16 a[102:103], v125 offset:12288
  v_mfma_f32_16x16x32_bf16 v[20:23], a[68:71], a[48:51], v[20:23]
  buffer_load_dwordx4 v228, s[8:11], s17 offen offset:3072 lds
  v_mfma_f32_16x16x32_bf16 v[24:27], a[72:75], a[48:51], v[24:27]
  ds_read_b64_tr_b16 a[68:69], v125 offset:0
  s_add_u32 s17, s17, 458752
  v_mfma_f32_16x16x32_bf16 v[24:27], a[104:107], a[56:59], v[24:27]
  ds_read_b64_tr_b16 a[70:71], v125 offset:4096
  s_cmp_eq_u32 s17, s93
  v_mfma_f32_16x16x32_bf16 v[40:43], a[104:107], a[60:63], v[40:43]
  ds_read_b64_tr_b16 a[104:105], v126 offset:8192
  s_cselect_b32 s17, s95, s17
  v_mfma_f32_16x16x32_bf16 v[40:43], a[72:75], a[52:55], v[40:43]
  buffer_load_dwordx4 a[44:47], v241, s[4:7], s16 offen offset:1024 sc1
  v_mfma_f32_16x16x32_bf16 v[44:47], a[76:79], a[52:55], v[44:47]
  ds_read_b64_tr_b16 a[106:107], v126 offset:12288
  s_add_u32 s41, s41, 262144
  v_mfma_f32_16x16x32_bf16 v[44:47], a[108:111], a[60:63], v[44:47]
  ds_read_b64_tr_b16 a[72:73], v126 offset:0
  s_bitset0_b32 s41, 21
  v_mfma_f32_16x16x32_bf16 v[28:31], a[108:111], a[56:59], v[28:31]
  ds_read_b64_tr_b16 a[74:75], v126 offset:4096
  s_add_u32 s16, s40, s41
  v_mfma_f32_16x16x32_bf16 v[28:31], a[76:79], a[48:51], v[28:31]
  s_waitcnt vmcnt(17) lgkmcnt(10)
  s_barrier
  v_mfma_f32_16x16x32_bf16 v[72:75], a[80:83], a[0:3], v[72:75]
  ds_read_b64_tr_b16 a[108:109], v127 offset:8192
  s_add_u32 m0, s38, 65536
  v_mfma_f32_16x16x32_bf16 v[72:75], a[112:115], a[8:11], v[72:75]
  ds_read_b64_tr_b16 a[110:111], v127 offset:12288
  buffer_load_dwordx4 v225, s[8:11], s17 offen lds
  v_mfma_f32_16x16x32_bf16 v[88:91], a[112:115], a[12:15], v[88:91]
  ds_read_b64_tr_b16 a[76:77], v127 offset:0
  ds_read_b64_tr_b16 a[78:79], v127 offset:4096
  v_mfma_f32_16x16x32_bf16 v[88:91], a[80:83], a[4:7], v[88:91]
  ds_read_b64_tr_b16 a[112:113], v242 offset:10240
  ds_read_b64_tr_b16 a[114:115], v242 offset:14336
  v_mfma_f32_16x16x32_bf16 v[92:95], a[84:87], a[4:7], v[92:95]
  buffer_load_dwordx4 a[48:51], v240, s[4:7], s16 offen offset:0 sc1
  v_mfma_f32_16x16x32_bf16 v[92:95], a[116:119], a[12:15], v[92:95]
  ds_read_b64_tr_b16 a[80:81], v242 offset:2048
  ds_read_b64_tr_b16 a[82:83], v242 offset:6144
  v_mfma_f32_16x16x32_bf16 v[76:79], a[116:119], a[8:11], v[76:79]
  ds_read_b64_tr_b16 a[116:117], v243 offset:10240
  ds_read_b64_tr_b16 a[118:119], v243 offset:14336
  v_mfma_f32_16x16x32_bf16 v[76:79], a[84:87], a[0:3], v[76:79]
  ds_read_b64_tr_b16 a[84:85], v243 offset:2048
  ds_read_b64_tr_b16 a[86:87], v243 offset:6144
  v_mfma_f32_16x16x32_bf16 v[80:83], a[88:91], a[0:3], v[80:83]
  buffer_load_dwordx4 v226, s[8:11], s17 offen offset:1024 lds
  v_mfma_f32_16x16x32_bf16 v[80:83], a[120:123], a[8:11], v[80:83]
  v_mfma_f32_16x16x32_bf16 v[96:99], a[120:123], a[12:15], v[96:99]
  ds_read_b64_tr_b16 a[120:121], v244 offset:10240
  ds_read_b64_tr_b16 a[122:123], v244 offset:14336
  v_mfma_f32_16x16x32_bf16 v[96:99], a[88:91], a[4:7], v[96:99]
  ds_read_b64_tr_b16 a[88:89], v244 offset:2048
  ds_read_b64_tr_b16 a[90:91], v244 offset:6144
  v_mfma_f32_16x16x32_bf16 v[100:103], a[92:95], a[4:7], v[100:103]
  buffer_load_dwordx4 a[52:55], v240, s[4:7], s16 offen offset:1024 sc1
  v_mfma_f32_16x16x32_bf16 v[100:103], a[124:127], a[12:15], v[100:103]
  v_mfma_f32_16x16x32_bf16 v[84:87], a[124:127], a[8:11], v[84:87]
  ds_read_b64_tr_b16 a[124:125], v245 offset:10240
  ds_read_b64_tr_b16 a[126:127], v245 offset:14336
  v_mfma_f32_16x16x32_bf16 v[84:87], a[92:95], a[0:3], v[84:87]
  ds_read_b64_tr_b16 a[92:93], v245 offset:2048
  ds_read_b64_tr_b16 a[94:95], v245 offset:6144
  s_waitcnt lgkmcnt(10)
  v_mfma_f32_16x16x32_bf16 v[16:19], a[64:67], a[0:3], v[16:19]
  buffer_load_dwordx4 v227, s[8:11], s17 offen offset:2048 lds
  v_mfma_f32_16x16x32_bf16 v[16:19], a[96:99], a[8:11], v[16:19]
  v_mfma_f32_16x16x32_bf16 v[32:35], a[96:99], a[12:15], v[32:35]
  ds_read_b64_tr_b16 a[96:97], v242 offset:8192
  ds_read_b64_tr_b16 a[98:99], v242 offset:12288
  v_mfma_f32_16x16x32_bf16 v[32:35], a[64:67], a[4:7], v[32:35]
  ds_read_b64_tr_b16 a[64:65], v242 offset:0
  ds_read_b64_tr_b16 a[66:67], v242 offset:4096
  v_mfma_f32_16x16x32_bf16 v[36:39], a[68:71], a[4:7], v[36:39]
  buffer_load_dwordx4 a[56:59], v241, s[4:7], s16 offen offset:0 sc1
  v_mfma_f32_16x16x32_bf16 v[36:39], a[100:103], a[12:15], v[36:39]
  v_mfma_f32_16x16x32_bf16 v[20:23], a[100:103], a[8:11], v[20:23]
  ds_read_b64_tr_b16 a[100:101], v243 offset:8192
  ds_read_b64_tr_b16 a[102:103], v243 offset:12288
  v_mfma_f32_16x16x32_bf16 v[20:23], a[68:71], a[0:3], v[20:23]
  buffer_load_dwordx4 v228, s[8:11], s17 offen offset:3072 lds
  v_mfma_f32_16x16x32_bf16 v[24:27], a[72:75], a[0:3], v[24:27]
  ds_read_b64_tr_b16 a[68:69], v243 offset:0
  s_add_u32 s17, s17, 458752
  v_mfma_f32_16x16x32_bf16 v[24:27], a[104:107], a[8:11], v[24:27]
  ds_read_b64_tr_b16 a[70:71], v243 offset:4096
  s_cmp_eq_u32 s17, s93
  v_mfma_f32_16x16x32_bf16 v[40:43], a[104:107], a[12:15], v[40:43]
  ds_read_b64_tr_b16 a[104:105], v244 offset:8192
  s_cselect_b32 s17, s95, s17
  v_mfma_f32_16x16x32_bf16 v[40:43], a[72:75], a[4:7], v[40:43]
  buffer_load_dwordx4 a[60:63], v241, s[4:7], s16 offen offset:1024 sc1
  v_mfma_f32_16x16x32_bf16 v[44:47], a[76:79], a[4:7], v[44:47]
  ds_read_b64_tr_b16 a[106:107], v244 offset:12288
  s_add_u32 s41, s41, 262144
  v_mfma_f32_16x16x32_bf16 v[44:47], a[108:111], a[12:15], v[44:47]
  ds_read_b64_tr_b16 a[72:73], v244 offset:0
  s_bitset0_b32 s41, 21
  v_mfma_f32_16x16x32_bf16 v[28:31], a[108:111], a[8:11], v[28:31]
  ds_read_b64_tr_b16 a[74:75], v244 offset:4096
  s_add_u32 s16, s40, s41
  v_mfma_f32_16x16x32_bf16 v[28:31], a[76:79], a[0:3], v[28:31]
  s_waitcnt vmcnt(16) lgkmcnt(10)
  s_barrier
  v_mfma_f32_16x16x32_bf16 v[72:75], a[80:83], a[16:19], v[72:75]
  ds_read_b64_tr_b16 a[108:109], v245 offset:8192
  s_add_u32 m0, s38, 81920
  v_mfma_f32_16x16x32_bf16 v[72:75], a[112:115], a[24:27], v[72:75]
  ds_read_b64_tr_b16 a[110:111], v245 offset:12288
  buffer_load_dwordx4 v225, s[8:11], s17 offen lds
  v_mfma_f32_16x16x32_bf16 v[88:91], a[112:115], a[28:31], v[88:91]
  ds_read_b64_tr_b16 a[76:77], v245 offset:0
  ds_read_b64_tr_b16 a[78:79], v245 offset:4096
  v_mfma_f32_16x16x32_bf16 v[88:91], a[80:83], a[20:23], v[88:91]
  ds_read_b64_tr_b16 a[112:113], v242 offset:26624
  ds_read_b64_tr_b16 a[114:115], v242 offset:30720
  v_mfma_f32_16x16x32_bf16 v[92:95], a[84:87], a[20:23], v[92:95]
  buffer_load_dwordx4 a[0:3], v240, s[4:7], s16 offen offset:0 sc1
  v_mfma_f32_16x16x32_bf16 v[92:95], a[116:119], a[28:31], v[92:95]
  ds_read_b64_tr_b16 a[80:81], v242 offset:18432
  ds_read_b64_tr_b16 a[82:83], v242 offset:22528
  v_mfma_f32_16x16x32_bf16 v[76:79], a[116:119], a[24:27], v[76:79]
  ds_read_b64_tr_b16 a[116:117], v243 offset:26624
  ds_read_b64_tr_b16 a[118:119], v243 offset:30720
  v_mfma_f32_16x16x32_bf16 v[76:79], a[84:87], a[16:19], v[76:79]
  ds_read_b64_tr_b16 a[84:85], v243 offset:18432
  ds_read_b64_tr_b16 a[86:87], v243 offset:22528
  v_mfma_f32_16x16x32_bf16 v[80:83], a[88:91], a[16:19], v[80:83]
  buffer_load_dwordx4 v226, s[8:11], s17 offen offset:1024 lds
  v_mfma_f32_16x16x32_bf16 v[80:83], a[120:123], a[24:27], v[80:83]
  v_mfma_f32_16x16x32_bf16 v[96:99], a[120:123], a[28:31], v[96:99]
  ds_read_b64_tr_b16 a[120:121], v244 offset:26624
  ds_read_b64_tr_b16 a[122:123], v244 offset:30720
  v_mfma_f32_16x16x32_bf16 v[96:99], a[88:91], a[20:23], v[96:99]
  ds_read_b64_tr_b16 a[88:89], v244 offset:18432
  ds_read_b64_tr_b16 a[90:91], v244 offset:22528
  v_mfma_f32_16x16x32_bf16 v[100:103], a[92:95], a[20:23], v[100:103]
  buffer_load_dwordx4 a[4:7], v240, s[4:7], s16 offen offset:1024 sc1
  v_mfma_f32_16x16x32_bf16 v[100:103], a[124:127], a[28:31], v[100:103]
  v_mfma_f32_16x16x32_bf16 v[84:87], a[124:127], a[24:27], v[84:87]
  ds_read_b64_tr_b16 a[124:125], v245 offset:26624
  ds_read_b64_tr_b16 a[126:127], v245 offset:30720
  v_mfma_f32_16x16x32_bf16 v[84:87], a[92:95], a[16:19], v[84:87]
  ds_read_b64_tr_b16 a[92:93], v245 offset:18432
  ds_read_b64_tr_b16 a[94:95], v245 offset:22528
  s_waitcnt lgkmcnt(10)
  v_mfma_f32_16x16x32_bf16 v[16:19], a[64:67], a[16:19], v[16:19]
  buffer_load_dwordx4 v227, s[8:11], s17 offen offset:2048 lds
  v_mfma_f32_16x16x32_bf16 v[16:19], a[96:99], a[24:27], v[16:19]
  v_mfma_f32_16x16x32_bf16 v[32:35], a[96:99], a[28:31], v[32:35]
  ds_read_b64_tr_b16 a[96:97], v242 offset:24576
  ds_read_b64_tr_b16 a[98:99], v242 offset:28672
  v_mfma_f32_16x16x32_bf16 v[32:35], a[64:67], a[20:23], v[32:35]
  ds_read_b64_tr_b16 a[64:65], v242 offset:16384
  ds_read_b64_tr_b16 a[66:67], v242 offset:20480
  v_mfma_f32_16x16x32_bf16 v[36:39], a[68:71], a[20:23], v[36:39]
  buffer_load_dwordx4 a[8:11], v241, s[4:7], s16 offen offset:0 sc1
  v_mfma_f32_16x16x32_bf16 v[36:39], a[100:103], a[28:31], v[36:39]
  v_mfma_f32_16x16x32_bf16 v[20:23], a[100:103], a[24:27], v[20:23]
  ds_read_b64_tr_b16 a[100:101], v243 offset:24576
  ds_read_b64_tr_b16 a[102:103], v243 offset:28672
  v_mfma_f32_16x16x32_bf16 v[20:23], a[68:71], a[16:19], v[20:23]
  buffer_load_dwordx4 v228, s[8:11], s17 offen offset:3072 lds
  v_mfma_f32_16x16x32_bf16 v[24:27], a[72:75], a[16:19], v[24:27]
  ds_read_b64_tr_b16 a[68:69], v243 offset:16384
  s_add_u32 s17, s17, 458752
  v_mfma_f32_16x16x32_bf16 v[24:27], a[104:107], a[24:27], v[24:27]
  ds_read_b64_tr_b16 a[70:71], v243 offset:20480
  s_cmp_eq_u32 s17, s93
  v_mfma_f32_16x16x32_bf16 v[40:43], a[104:107], a[28:31], v[40:43]
  ds_read_b64_tr_b16 a[104:105], v244 offset:24576
  s_cselect_b32 s17, s95, s17
  v_mfma_f32_16x16x32_bf16 v[40:43], a[72:75], a[20:23], v[40:43]
  buffer_load_dwordx4 a[12:15], v241, s[4:7], s16 offen offset:1024 sc1
  v_mfma_f32_16x16x32_bf16 v[44:47], a[76:79], a[20:23], v[44:47]
  ds_read_b64_tr_b16 a[106:107], v244 offset:28672
  s_add_u32 s41, s41, 262144
  v_mfma_f32_16x16x32_bf16 v[44:47], a[108:111], a[28:31], v[44:47]
  ds_read_b64_tr_b16 a[72:73], v244 offset:16384
  s_bitset0_b32 s41, 21
  v_mfma_f32_16x16x32_bf16 v[28:31], a[108:111], a[24:27], v[28:31]
  ds_read_b64_tr_b16 a[74:75], v244 offset:20480
  s_add_u32 s16, s40, s41
  v_mfma_f32_16x16x32_bf16 v[28:31], a[76:79], a[16:19], v[28:31]
  s_waitcnt vmcnt(16) lgkmcnt(10)
  s_barrier
  v_mfma_f32_16x16x32_bf16 v[72:75], a[80:83], a[32:35], v[72:75]
  ds_read_b64_tr_b16 a[108:109], v245 offset:24576
  s_add_u32 m0, s38, 98304
  v_mfma_f32_16x16x32_bf16 v[72:75], a[112:115], a[40:43], v[72:75]
  ds_read_b64_tr_b16 a[110:111], v245 offset:28672
  v_accvgpr_read_b32 v0, a128
  buffer_load_dwordx4 v225, s[8:11], s17 offen lds
  v_mfma_f32_16x16x32_bf16 v[88:91], a[112:115], a[44:47], v[88:91]
  ds_read_b64_tr_b16 a[76:77], v245 offset:16384
  ds_read_b64_tr_b16 a[78:79], v245 offset:20480
  v_mfma_f32_16x16x32_bf16 v[88:91], a[80:83], a[36:39], v[88:91]
  ds_read_b64_tr_b16 a[112:113], v242 offset:43008
  v_accvgpr_read_b32 v1, a129
  v_mfma_f32_16x16x32_bf16 v[92:95], a[84:87], a[36:39], v[92:95]
  buffer_load_dwordx4 a[16:19], v240, s[4:7], s16 offen offset:0 sc1
  v_mfma_f32_16x16x32_bf16 v[92:95], a[116:119], a[44:47], v[92:95]
  ds_read_b64_tr_b16 a[114:115], v242 offset:47104
  v_accvgpr_read_b32 v2, a130
  v_mfma_f32_16x16x32_bf16 v[76:79], a[116:119], a[40:43], v[76:79]
  ds_read_b64_tr_b16 a[80:81], v242 offset:34816
  ds_read_b64_tr_b16 a[82:83], v242 offset:38912
  v_mfma_f32_16x16x32_bf16 v[76:79], a[84:87], a[32:35], v[76:79]
  ds_read_b64_tr_b16 a[116:117], v243 offset:43008
  ds_read_b64_tr_b16 a[118:119], v243 offset:47104
  v_mfma_f32_16x16x32_bf16 v[80:83], a[88:91], a[32:35], v[80:83]
  v_accvgpr_read_b32 v3, a131
  buffer_load_dwordx4 v226, s[8:11], s17 offen offset:1024 lds
  v_mfma_f32_16x16x32_bf16 v[80:83], a[120:123], a[40:43], v[80:83]
  ds_read_b64_tr_b16 a[84:85], v243 offset:34816
  ds_read_b64_tr_b16 a[86:87], v243 offset:38912
  v_mfma_f32_16x16x32_bf16 v[96:99], a[120:123], a[44:47], v[96:99]
  ds_read_b64_tr_b16 a[120:121], v244 offset:43008
  v_lshlrev_b32 v192, 16, v0
  v_mfma_f32_16x16x32_bf16 v[96:99], a[88:91], a[36:39], v[96:99]
  ds_read_b64_tr_b16 a[122:123], v244 offset:47104
  ds_read_b64_tr_b16 a[88:89], v244 offset:34816
  v_mfma_f32_16x16x32_bf16 v[100:103], a[92:95], a[36:39], v[100:103]
  v_and_b32 v193, 0xffff0000, v0
  buffer_load_dwordx4 a[20:23], v240, s[4:7], s16 offen offset:1024 sc1
  v_mfma_f32_16x16x32_bf16 v[100:103], a[124:127], a[44:47], v[100:103]
  ds_read_b64_tr_b16 a[90:91], v244 offset:38912
  v_mfma_f32_16x16x32_bf16 v[84:87], a[124:127], a[40:43], v[84:87]
  ds_read_b64_tr_b16 a[124:125], v245 offset:43008
  ds_read_b64_tr_b16 a[126:127], v245 offset:47104
  v_mfma_f32_16x16x32_bf16 v[84:87], a[92:95], a[32:35], v[84:87]
  ds_read_b64_tr_b16 a[92:93], v245 offset:34816
  v_lshlrev_b32 v194, 16, v1
  s_waitcnt lgkmcnt(10)
  v_mfma_f32_16x16x32_bf16 v[16:19], a[64:67], a[32:35], v[16:19]
  buffer_load_dwordx4 v227, s[8:11], s17 offen offset:2048 lds
  v_mfma_f32_16x16x32_bf16 v[16:19], a[96:99], a[40:43], v[16:19]
  ds_read_b64_tr_b16 a[94:95], v245 offset:38912
  v_and_b32 v195, 0xffff0000, v1
  v_mfma_f32_16x16x32_bf16 v[32:35], a[96:99], a[44:47], v[32:35]
  ds_read_b64_tr_b16 a[96:97], v242 offset:40960
  ds_read_b64_tr_b16 a[98:99], v242 offset:45056
  v_mfma_f32_16x16x32_bf16 v[32:35], a[64:67], a[36:39], v[32:35]
  v_lshlrev_b32 v196, 16, v2
  buffer_load_dwordx4 a[24:27], v241, s[4:7], s16 offen offset:0 sc1
  v_mfma_f32_16x16x32_bf16 v[36:39], a[68:71], a[36:39], v[36:39]
  buffer_load_dwordx4 v228, s[8:11], s17 offen offset:3072 lds
  v_mfma_f32_16x16x32_bf16 v[36:39], a[100:103], a[44:47], v[36:39]
  ds_read_b64_tr_b16 a[64:65], v242 offset:32768
  s_add_u32 s17, s17, 458752
  v_mfma_f32_16x16x32_bf16 v[20:23], a[100:103], a[40:43], v[20:23]
  ds_read_b64_tr_b16 a[66:67], v242 offset:36864
  v_and_b32 v197, 0xffff0000, v2
  s_cmp_eq_u32 s17, s93
  v_mfma_f32_16x16x32_bf16 v[20:23], a[68:71], a[32:35], v[20:23]
  ds_read_b64_tr_b16 a[100:101], v243 offset:40960
  s_cselect_b32 s17, s95, s17
  v_mfma_f32_16x16x32_bf16 v[24:27], a[72:75], a[32:35], v[24:27]
  v_lshlrev_b32 v198, 16, v3
  s_add_u32 s17, s17, 65536
  v_mfma_f32_16x16x32_bf16 v[24:27], a[104:107], a[40:43], v[24:27]
  ds_read_b64_tr_b16 a[102:103], v243 offset:45056
  s_add_u32 s93, s93, 65536
  v_mfma_f32_16x16x32_bf16 v[40:43], a[104:107], a[44:47], v[40:43]
  ds_read_b64_tr_b16 a[68:69], v243 offset:32768
  ds_read_b64_tr_b16 a[70:71], v243 offset:36864
  v_and_b32 v199, 0xffff0000, v3
  s_add_u32 s95, s95, 65536
  v_mfma_f32_16x16x32_bf16 v[40:43], a[72:75], a[36:39], v[40:43]
  buffer_load_dwordx4 a[28:31], v241, s[4:7], s16 offen offset:1024 sc1
  v_mfma_f32_16x16x32_bf16 v[44:47], a[76:79], a[36:39], v[44:47]
  ds_read_b64_tr_b16 a[104:105], v244 offset:40960
  s_add_u32 s41, s41, 262144
  v_mfma_f32_16x16x32_bf16 v[44:47], a[108:111], a[44:47], v[44:47]
  ds_read_b64_tr_b16 a[106:107], v244 offset:45056
  s_bitset0_b32 s41, 21
  v_mfma_f32_16x16x32_bf16 v[28:31], a[108:111], a[40:43], v[28:31]
  ds_read_b64_tr_b16 a[72:73], v244 offset:32768
  ds_read_b64_tr_b16 a[74:75], v244 offset:36864
  ds_read_b128 v[56:59], v253 offset:768
  s_add_u32 s16, s40, s41
  v_mfma_f32_16x16x32_bf16 v[28:31], a[76:79], a[32:35], v[28:31]
  s_waitcnt vmcnt(16) lgkmcnt(10)
  s_barrier
  v_mfma_f32_16x16x32_bf16 v[72:75], a[80:83], a[48:51], v[72:75]
  ds_read_b64_tr_b16 a[108:109], v245 offset:40960
  s_add_u32 m0, s38, 114688
  v_mfma_f32_16x16x32_bf16 v[72:75], a[112:115], a[56:59], v[72:75]
  ds_read_b64_tr_b16 a[110:111], v245 offset:45056
  v_accvgpr_read_b32 v4, a132
  buffer_load_dwordx4 v225, s[8:11], s17 offen lds
  v_mfma_f32_16x16x32_bf16 v[88:91], a[112:115], a[60:63], v[88:91]
  ds_read_b64_tr_b16 a[76:77], v245 offset:32768
  ds_read_b64_tr_b16 a[78:79], v245 offset:36864
  v_mfma_f32_16x16x32_bf16 v[88:91], a[80:83], a[52:55], v[88:91]
  ds_read_b64_tr_b16 a[112:113], v242 offset:59392
  v_accvgpr_read_b32 v5, a133
  v_mfma_f32_16x16x32_bf16 v[92:95], a[84:87], a[52:55], v[92:95]
  buffer_load_dwordx4 a[32:35], v240, s[4:7], s16 offen offset:0 sc1
  v_mfma_f32_16x16x32_bf16 v[92:95], a[116:119], a[60:63], v[92:95]
  ds_read_b64_tr_b16 a[114:115], v242 offset:63488
  v_accvgpr_read_b32 v6, a134
  v_mfma_f32_16x16x32_bf16 v[76:79], a[116:119], a[56:59], v[76:79]
  ds_read_b64_tr_b16 a[80:81], v242 offset:51200
  ds_read_b64_tr_b16 a[82:83], v242 offset:55296
  v_mfma_f32_16x16x32_bf16 v[76:79], a[84:87], a[48:51], v[76:79]
  ds_read_b64_tr_b16 a[116:117], v243 offset:59392
  ds_read_b64_tr_b16 a[118:119], v243 offset:63488
  v_mfma_f32_16x16x32_bf16 v[80:83], a[88:91], a[48:51], v[80:83]
  v_accvgpr_read_b32 v7, a135
  buffer_load_dwordx4 v226, s[8:11], s17 offen offset:1024 lds
  v_mfma_f32_16x16x32_bf16 v[80:83], a[120:123], a[56:59], v[80:83]
  ds_read_b64_tr_b16 a[84:85], v243 offset:51200
  ds_read_b64_tr_b16 a[86:87], v243 offset:55296
  v_mfma_f32_16x16x32_bf16 v[96:99], a[120:123], a[60:63], v[96:99]
  ds_read_b64_tr_b16 a[120:121], v244 offset:59392
  v_lshlrev_b32 v200, 16, v4
  v_mfma_f32_16x16x32_bf16 v[96:99], a[88:91], a[52:55], v[96:99]
  ds_read_b64_tr_b16 a[122:123], v244 offset:63488
  ds_read_b64_tr_b16 a[88:89], v244 offset:51200
  v_mfma_f32_16x16x32_bf16 v[100:103], a[92:95], a[52:55], v[100:103]
  v_and_b32 v201, 0xffff0000, v4
  buffer_load_dwordx4 a[36:39], v240, s[4:7], s16 offen offset:1024 sc1
  v_mfma_f32_16x16x32_bf16 v[100:103], a[124:127], a[60:63], v[100:103]
  ds_read_b64_tr_b16 a[90:91], v244 offset:55296
  v_mfma_f32_16x16x32_bf16 v[84:87], a[124:127], a[56:59], v[84:87]
  ds_read_b64_tr_b16 a[124:125], v245 offset:59392
  ds_read_b64_tr_b16 a[126:127], v245 offset:63488
  v_mfma_f32_16x16x32_bf16 v[84:87], a[92:95], a[48:51], v[84:87]
  v_lshlrev_b32 v202, 16, v5
  buffer_load_dword v247, v246, s[56:59], s94 offen sc1
  s_waitcnt lgkmcnt(10)
  v_mfma_f32_16x16x32_bf16 v[16:19], a[64:67], a[48:51], v[16:19]
  buffer_load_dwordx4 v227, s[8:11], s17 offen offset:2048 lds
  v_mfma_f32_16x16x32_bf16 v[16:19], a[96:99], a[56:59], v[16:19]
  ds_read_b64_tr_b16 a[92:93], v245 offset:51200
  v_and_b32 v203, 0xffff0000, v5
  v_mfma_f32_16x16x32_bf16 v[32:35], a[96:99], a[60:63], v[32:35]
  ds_read_b64_tr_b16 a[94:95], v245 offset:55296
  ds_read_b64_tr_b16 a[96:97], v242 offset:57344
  v_mfma_f32_16x16x32_bf16 v[32:35], a[64:67], a[52:55], v[32:35]
  ds_read_b64_tr_b16 a[98:99], v242 offset:61440
  v_lshlrev_b32 v204, 16, v6
  v_mfma_f32_16x16x32_bf16 v[36:39], a[68:71], a[52:55], v[36:39]
  buffer_load_dwordx4 a[40:43], v241, s[4:7], s16 offen offset:0 sc1
  v_mfma_f32_16x16x32_bf16 v[36:39], a[100:103], a[60:63], v[36:39]
  ds_read_b64_tr_b16 a[64:65], v242 offset:49152
  ds_read_b64_tr_b16 a[66:67], v242 offset:53248
  v_mfma_f32_16x16x32_bf16 v[20:23], a[100:103], a[56:59], v[20:23]
  ds_read_b64_tr_b16 a[100:101], v243 offset:57344
  v_and_b32 v205, 0xffff0000, v6
  v_mfma_f32_16x16x32_bf16 v[20:23], a[68:71], a[48:51], v[20:23]
  buffer_load_dwordx4 v228, s[8:11], s17 offen offset:3072 lds
  v_mfma_f32_16x16x32_bf16 v[24:27], a[72:75], a[48:51], v[24:27]
  v_lshlrev_b32 v206, 16, v7
  s_add_u32 s17, s17, 458752
  v_mfma_f32_16x16x32_bf16 v[24:27], a[104:107], a[56:59], v[24:27]
  ds_read_b64_tr_b16 a[102:103], v243 offset:61440
  s_cmp_eq_u32 s17, s93
  v_mfma_f32_16x16x32_bf16 v[40:43], a[104:107], a[60:63], v[40:43]
  ds_read_b64_tr_b16 a[68:69], v243 offset:49152
  ds_read_b64_tr_b16 a[70:71], v243 offset:53248
  v_and_b32 v207, 0xffff0000, v7
  s_cselect_b32 s17, s95, s17
  v_mfma_f32_16x16x32_bf16 v[40:43], a[72:75], a[52:55], v[40:43]
  buffer_load_dwordx4 a[44:47], v241, s[4:7], s16 offen offset:1024 sc1
  v_mfma_f32_16x16x32_bf16 v[44:47], a[76:79], a[52:55], v[44:47]
  ds_read_b64_tr_b16 a[104:105], v244 offset:57344
  s_add_u32 s41, s41, 262144
  v_mfma_f32_16x16x32_bf16 v[44:47], a[108:111], a[60:63], v[44:47]
  ds_read_b64_tr_b16 a[106:107], v244 offset:61440
  s_bitset0_b32 s41, 21
  v_mfma_f32_16x16x32_bf16 v[28:31], a[108:111], a[56:59], v[28:31]
  ds_read_b64_tr_b16 a[72:73], v244 offset:49152
  ds_read_b64_tr_b16 a[74:75], v244 offset:53248
  ds_read_b128 v[60:63], v253 offset:832
  s_add_u32 s16, s40, s41
  v_mfma_f32_16x16x32_bf16 v[28:31], a[76:79], a[48:51], v[28:31]
  s_waitcnt vmcnt(17) lgkmcnt(10)
  s_barrier
  v_mfma_f32_16x16x32_bf16 v[72:75], a[80:83], a[0:3], v[72:75]
  ds_read_b64_tr_b16 a[108:109], v245 offset:57344
  s_add_u32 m0, s38, 131072
  v_mfma_f32_16x16x32_bf16 v[72:75], a[112:115], a[8:11], v[72:75]
  ds_read_b64_tr_b16 a[110:111], v245 offset:61440
  v_accvgpr_read_b32 v8, a136
  buffer_load_dwordx4 v225, s[8:11], s17 offen lds
  v_mfma_f32_16x16x32_bf16 v[88:91], a[112:115], a[12:15], v[88:91]
  ds_read_b64_tr_b16 a[76:77], v245 offset:49152
  ds_read_b64_tr_b16 a[78:79], v245 offset:53248
  v_mfma_f32_16x16x32_bf16 v[88:91], a[80:83], a[4:7], v[88:91]
  ds_read_b64_tr_b16 a[112:113], v104 offset:10240
  v_accvgpr_read_b32 v9, a137
  v_mfma_f32_16x16x32_bf16 v[92:95], a[84:87], a[4:7], v[92:95]
  buffer_load_dwordx4 a[48:51], v240, s[4:7], s16 offen offset:0 sc1
  v_mfma_f32_16x16x32_bf16 v[92:95], a[116:119], a[12:15], v[92:95]
  ds_read_b64_tr_b16 a[114:115], v104 offset:14336
  v_accvgpr_read_b32 v10, a138
  v_mfma_f32_16x16x32_bf16 v[76:79], a[116:119], a[8:11], v[76:79]
  ds_read_b64_tr_b16 a[80:81], v104 offset:2048
  ds_read_b64_tr_b16 a[82:83], v104 offset:6144
  v_mfma_f32_16x16x32_bf16 v[76:79], a[84:87], a[0:3], v[76:79]
  ds_read_b64_tr_b16 a[116:117], v105 offset:10240
  ds_read_b64_tr_b16 a[118:119], v105 offset:14336
  v_mfma_f32_16x16x32_bf16 v[80:83], a[88:91], a[0:3], v[80:83]
  v_accvgpr_read_b32 v11, a139
  buffer_load_dwordx4 v226, s[8:11], s17 offen offset:1024 lds
  v_mfma_f32_16x16x32_bf16 v[80:83], a[120:123], a[8:11], v[80:83]
  ds_read_b64_tr_b16 a[84:85], v105 offset:2048
  ds_read_b64_tr_b16 a[86:87], v105 offset:6144
  v_mfma_f32_16x16x32_bf16 v[96:99], a[120:123], a[12:15], v[96:99]
  ds_read_b64_tr_b16 a[120:121], v106 offset:10240
  v_lshlrev_b32 v208, 16, v8
  v_mfma_f32_16x16x32_bf16 v[96:99], a[88:91], a[4:7], v[96:99]
  ds_read_b64_tr_b16 a[122:123], v106 offset:14336
  ds_read_b64_tr_b16 a[88:89], v106 offset:2048
  v_mfma_f32_16x16x32_bf16 v[100:103], a[92:95], a[4:7], v[100:103]
  v_and_b32 v209, 0xffff0000, v8
  buffer_load_dwordx4 a[52:55], v240, s[4:7], s16 offen offset:1024 sc1
  v_mfma_f32_16x16x32_bf16 v[100:103], a[124:127], a[12:15], v[100:103]
  ds_read_b64_tr_b16 a[90:91], v106 offset:6144
  v_mfma_f32_16x16x32_bf16 v[84:87], a[124:127], a[8:11], v[84:87]
  ds_read_b64_tr_b16 a[124:125], v107 offset:10240
  ds_read_b64_tr_b16 a[126:127], v107 offset:14336
  v_mfma_f32_16x16x32_bf16 v[84:87], a[92:95], a[0:3], v[84:87]
  ds_read_b64_tr_b16 a[92:93], v107 offset:2048
  v_lshlrev_b32 v210, 16, v9
  s_waitcnt lgkmcnt(10)
  v_mfma_f32_16x16x32_bf16 v[16:19], a[64:67], a[0:3], v[16:19]
  buffer_load_dwordx4 v227, s[8:11], s17 offen offset:2048 lds
  v_mfma_f32_16x16x32_bf16 v[16:19], a[96:99], a[8:11], v[16:19]
  ds_read_b64_tr_b16 a[94:95], v107 offset:6144
  v_and_b32 v211, 0xffff0000, v9
  v_mfma_f32_16x16x32_bf16 v[32:35], a[96:99], a[12:15], v[32:35]
  ds_read_b64_tr_b16 a[96:97], v104 offset:8192
  ds_read_b64_tr_b16 a[98:99], v104 offset:12288
  v_mfma_f32_16x16x32_bf16 v[32:35], a[64:67], a[4:7], v[32:35]
  ds_read_b64_tr_b16 a[64:65], v104 offset:0
  v_lshlrev_b32 v212, 16, v10
  v_mfma_f32_16x16x32_bf16 v[36:39], a[68:71], a[4:7], v[36:39]
  buffer_load_dwordx4 a[56:59], v241, s[4:7], s16 offen offset:0 sc1
  v_mfma_f32_16x16x32_bf16 v[36:39], a[100:103], a[12:15], v[36:39]
  ds_read_b64_tr_b16 a[66:67], v104 offset:4096
  v_mfma_f32_16x16x32_bf16 v[20:23], a[100:103], a[8:11], v[20:23]
  v_and_b32 v213, 0xffff0000, v10
  buffer_load_dwordx4 v228, s[8:11], s17 offen offset:3072 lds
  v_mfma_f32_16x16x32_bf16 v[20:23], a[68:71], a[0:3], v[20:23]
  ds_read_b64_tr_b16 a[100:101], v105 offset:8192
  s_add_u32 s17, s17, 458752
  v_mfma_f32_16x16x32_bf16 v[24:27], a[72:75], a[0:3], v[24:27]
  v_lshlrev_b32 v214, 16, v11
  s_cmp_eq_u32 s17, s93
  v_mfma_f32_16x16x32_bf16 v[24:27], a[104:107], a[8:11], v[24:27]
  ds_read_b64_tr_b16 a[102:103], v105 offset:12288
  s_cselect_b32 s17, s95, s17
  v_mfma_f32_16x16x32_bf16 v[40:43], a[104:107], a[12:15], v[40:43]
  ds_read_b64_tr_b16 a[68:69], v105 offset:0
  ds_read_b64_tr_b16 a[70:71], v105 offset:4096
  v_and_b32 v215, 0xffff0000, v11
  buffer_load_dwordx4 a[60:63], v241, s[4:7], s16 offen offset:1024 sc1
  v_mfma_f32_16x16x32_bf16 v[40:43], a[72:75], a[4:7], v[40:43]
  ds_read_b64_tr_b16 a[104:105], v106 offset:8192
  s_add_u32 s41, s41, 262144
  v_mfma_f32_16x16x32_bf16 v[44:47], a[76:79], a[4:7], v[44:47]
  ds_read_b64_tr_b16 a[106:107], v106 offset:12288
  s_bitset0_b32 s41, 21
  v_mfma_f32_16x16x32_bf16 v[44:47], a[108:111], a[12:15], v[44:47]
  ds_read_b64_tr_b16 a[72:73], v106 offset:0
  s_add_u32 s40, s40, 2097152
  v_mfma_f32_16x16x32_bf16 v[28:31], a[108:111], a[8:11], v[28:31]
  ds_read_b64_tr_b16 a[74:75], v106 offset:4096
  ds_read_b128 v[64:67], v253 offset:896
  s_add_u32 s16, s40, s41
  v_mfma_f32_16x16x32_bf16 v[28:31], a[76:79], a[0:3], v[28:31]
  s_waitcnt vmcnt(12) lgkmcnt(10)
  s_barrier
  v_cmp_ne_u32 vcc, s19, v247
  s_nop 1
  s_cmp_lg_u64 vcc, 0
  s_cbranch_scc1 L_slow_29
  L_back_30:
  s_add_u32 s94, s94, 65536
  v_mfma_f32_16x16x32_bf16 v[72:75], a[80:83], a[16:19], v[72:75]
  buffer_load_dwordx4 a[0:3], v240, s[4:7], s16 offen offset:0 sc1
  v_mfma_f32_16x16x32_bf16 v[72:75], a[112:115], a[24:27], v[72:75]
  ds_read_b64_tr_b16 a[108:109], v107 offset:8192
  ds_read_b64_tr_b16 a[110:111], v107 offset:12288
  v_accvgpr_read_b32 v12, a140
  v_mfma_f32_16x16x32_bf16 v[88:91], a[112:115], a[28:31], v[88:91]
  ds_read_b64_tr_b16 a[76:77], v107 offset:0
  ds_read_b64_tr_b16 a[78:79], v107 offset:4096
  v_mfma_f32_16x16x32_bf16 v[88:91], a[80:83], a[20:23], v[88:91]
  ds_read_b64_tr_b16 a[112:113], v104 offset:26624
  v_accvgpr_read_b32 v13, a141
  v_mfma_f32_16x16x32_bf16 v[92:95], a[84:87], a[20:23], v[92:95]
  ds_read_b64_tr_b16 a[114:115], v104 offset:30720
  ds_read_b64_tr_b16 a[80:81], v104 offset:18432
  v_mfma_f32_16x16x32_bf16 v[92:95], a[116:119], a[28:31], v[92:95]
  ds_read_b64_tr_b16 a[82:83], v104 offset:22528
  v_accvgpr_read_b32 v14, a142
  v_mfma_f32_16x16x32_bf16 v[76:79], a[116:119], a[24:27], v[76:79]
  ds_read_b64_tr_b16 a[116:117], v105 offset:26624
  ds_read_b64_tr_b16 a[118:119], v105 offset:30720
  v_mfma_f32_16x16x32_bf16 v[76:79], a[84:87], a[16:19], v[76:79]
  buffer_load_dwordx4 a[4:7], v240, s[4:7], s16 offen offset:1024 sc1
  v_mfma_f32_16x16x32_bf16 v[80:83], a[88:91], a[16:19], v[80:83]
  ds_read_b64_tr_b16 a[84:85], v105 offset:18432
  v_accvgpr_read_b32 v15, a143
  v_mfma_f32_16x16x32_bf16 v[80:83], a[120:123], a[24:27], v[80:83]
  ds_read_b64_tr_b16 a[86:87], v105 offset:22528
  v_mfma_f32_16x16x32_bf16 v[96:99], a[120:123], a[28:31], v[96:99]
  ds_read_b64_tr_b16 a[120:121], v106 offset:26624
  v_lshlrev_b32 v216, 16, v12
  v_mfma_f32_16x16x32_bf16 v[96:99], a[88:91], a[20:23], v[96:99]
  ds_read_b64_tr_b16 a[122:123], v106 offset:30720
  ds_read_b64_tr_b16 a[88:89], v106 offset:18432
  v_mfma_f32_16x16x32_bf16 v[100:103], a[92:95], a[20:23], v[100:103]
  ds_read_b64_tr_b16 a[90:91], v106 offset:22528
  v_and_b32 v217, 0xffff0000, v12
  v_mfma_f32_16x16x32_bf16 v[100:103], a[124:127], a[28:31], v[100:103]
  v_mfma_f32_16x16x32_bf16 v[84:87], a[124:127], a[24:27], v[84:87]
  ds_read_b64_tr_b16 a[124:125], v107 offset:26624
  ds_read_b64_tr_b16 a[126:127], v107 offset:30720
  v_mfma_f32_16x16x32_bf16 v[84:87], a[92:95], a[16:19], v[84:87]
  v_lshlrev_b32 v218, 16, v13
  buffer_load_dwordx4 a[8:11], v241, s[4:7], s16 offen offset:0 sc1
  s_waitcnt lgkmcnt(10)
  v_mfma_f32_16x16x32_bf16 v[16:19], a[64:67], a[16:19], v[16:19]
  ds_read_b64_tr_b16 a[92:93], v107 offset:18432
  ds_read_b64_tr_b16 a[94:95], v107 offset:22528
  v_mfma_f32_16x16x32_bf16 v[16:19], a[96:99], a[24:27], v[16:19]
  v_and_b32 v219, 0xffff0000, v13
  v_mfma_f32_16x16x32_bf16 v[32:35], a[96:99], a[28:31], v[32:35]
  ds_read_b64_tr_b16 a[96:97], v104 offset:24576
  ds_read_b64_tr_b16 a[98:99], v104 offset:28672
  v_mfma_f32_16x16x32_bf16 v[32:35], a[64:67], a[20:23], v[32:35]
  ds_read_b64_tr_b16 a[64:65], v104 offset:16384
  v_lshlrev_b32 v220, 16, v14
  v_mfma_f32_16x16x32_bf16 v[36:39], a[68:71], a[20:23], v[36:39]
  ds_read_b64_tr_b16 a[66:67], v104 offset:20480
  v_mfma_f32_16x16x32_bf16 v[36:39], a[100:103], a[28:31], v[36:39]
  v_mfma_f32_16x16x32_bf16 v[20:23], a[100:103], a[24:27], v[20:23]
  ds_read_b64_tr_b16 a[100:101], v105 offset:24576
  v_and_b32 v221, 0xffff0000, v14
  v_mfma_f32_16x16x32_bf16 v[20:23], a[68:71], a[16:19], v[20:23]
  buffer_load_dwordx4 a[12:15], v241, s[4:7], s16 offen offset:1024 sc1
  v_mfma_f32_16x16x32_bf16 v[24:27], a[72:75], a[16:19], v[24:27]
  v_lshlrev_b32 v222, 16, v15
  s_add_u32 s41, s41, 262144
  v_mfma_f32_16x16x32_bf16 v[24:27], a[104:107], a[24:27], v[24:27]
  ds_read_b64_tr_b16 a[102:103], v105 offset:28672
  s_bitset0_b32 s41, 21
  v_mfma_f32_16x16x32_bf16 v[40:43], a[104:107], a[28:31], v[40:43]
  ds_read_b64_tr_b16 a[68:69], v105 offset:16384
  ds_read_b64_tr_b16 a[70:71], v105 offset:20480
  v_and_b32 v223, 0xffff0000, v15
  s_add_u32 s16, s40, s41
  v_mfma_f32_16x16x32_bf16 v[40:43], a[72:75], a[20:23], v[40:43]
  ds_read_b64_tr_b16 a[104:105], v106 offset:24576
  ds_read_b64_tr_b16 a[106:107], v106 offset:28672
  v_mfma_f32_16x16x32_bf16 v[44:47], a[76:79], a[20:23], v[44:47]
  ds_read_b64_tr_b16 a[72:73], v106 offset:16384
  ds_read_b64_tr_b16 a[74:75], v106 offset:20480
  v_mfma_f32_16x16x32_bf16 v[44:47], a[108:111], a[28:31], v[44:47]
  v_mfma_f32_16x16x32_bf16 v[28:31], a[108:111], a[24:27], v[28:31]
  ds_read_b64_tr_b16 a[108:109], v107 offset:24576
  ds_read_b128 v[68:71], v253 offset:960
  v_mfma_f32_16x16x32_bf16 v[28:31], a[76:79], a[16:19], v[28:31]
  s_waitcnt vmcnt(12) lgkmcnt(10)
  s_barrier
  v_mfma_f32_16x16x32_bf16 v[72:75], a[80:83], a[32:35], v[72:75]
  ds_read_b64_tr_b16 a[110:111], v107 offset:28672
  s_add_u32 m0, s38, 0
  v_mfma_f32_16x16x32_bf16 v[72:75], a[112:115], a[40:43], v[72:75]
  buffer_load_dwordx4 v225, s[8:11], s17 offen lds
  v_mfma_f32_16x16x32_bf16 v[88:91], a[112:115], a[44:47], v[88:91]
  ds_read_b64_tr_b16 a[76:77], v107 offset:16384
  ds_read_b64_tr_b16 a[78:79], v107 offset:20480
  v_mfma_f32_16x16x32_bf16 v[88:91], a[80:83], a[36:39], v[88:91]
  ds_read_b64_tr_b16 a[112:113], v104 offset:43008
  ds_read_b64_tr_b16 a[114:115], v104 offset:47104
  v_mfma_f32_16x16x32_bf16 v[92:95], a[84:87], a[36:39], v[92:95]
  buffer_load_dwordx4 a[16:19], v240, s[4:7], s16 offen offset:0 sc1
  v_mfma_f32_16x16x32_bf16 v[92:95], a[116:119], a[44:47], v[92:95]
  ds_read_b64_tr_b16 a[80:81], v104 offset:34816
  ds_read_b64_tr_b16 a[82:83], v104 offset:38912
  v_mfma_f32_16x16x32_bf16 v[76:79], a[116:119], a[40:43], v[76:79]
  ds_read_b64_tr_b16 a[116:117], v105 offset:43008
  ds_read_b64_tr_b16 a[118:119], v105 offset:47104
  v_mfma_f32_16x16x32_bf16 v[76:79], a[84:87], a[32:35], v[76:79]
  ds_read_b64_tr_b16 a[84:85], v105 offset:34816
  ds_read_b64_tr_b16 a[86:87], v105 offset:38912
  v_mfma_f32_16x16x32_bf16 v[80:83], a[88:91], a[32:35], v[80:83]
  buffer_load_dwordx4 v226, s[8:11], s17 offen offset:1024 lds
  v_mfma_f32_16x16x32_bf16 v[80:83], a[120:123], a[40:43], v[80:83]
  v_mfma_f32_16x16x32_bf16 v[96:99], a[120:123], a[44:47], v[96:99]
  ds_read_b64_tr_b16 a[120:121], v106 offset:43008
  ds_read_b64_tr_b16 a[122:123], v106 offset:47104
  v_mfma_f32_16x16x32_bf16 v[96:99], a[88:91], a[36:39], v[96:99]
  ds_read_b64_tr_b16 a[88:89], v106 offset:34816
  ds_read_b64_tr_b16 a[90:91], v106 offset:38912
  v_mfma_f32_16x16x32_bf16 v[100:103], a[92:95], a[36:39], v[100:103]
  buffer_load_dwordx4 a[20:23], v240, s[4:7], s16 offen offset:1024 sc1
  v_mfma_f32_16x16x32_bf16 v[100:103], a[124:127], a[44:47], v[100:103]
  v_mfma_f32_16x16x32_bf16 v[84:87], a[124:127], a[40:43], v[84:87]
  ds_read_b64_tr_b16 a[124:125], v107 offset:43008
  ds_read_b64_tr_b16 a[126:127], v107 offset:47104
  v_mfma_f32_16x16x32_bf16 v[84:87], a[92:95], a[32:35], v[84:87]
  ds_read_b64_tr_b16 a[92:93], v107 offset:34816
  ds_read_b64_tr_b16 a[94:95], v107 offset:38912
  v_mfma_f32_16x16x32_bf16 v[16:19], a[64:67], a[32:35], v[16:19]
  buffer_load_dwordx4 v227, s[8:11], s17 offen offset:2048 lds
  v_mfma_f32_16x16x32_bf16 v[16:19], a[96:99], a[40:43], v[16:19]
  v_mfma_f32_16x16x32_bf16 v[32:35], a[96:99], a[44:47], v[32:35]
  ds_read_b64_tr_b16 a[96:97], v104 offset:40960
  ds_read_b64_tr_b16 a[98:99], v104 offset:45056
  v_mfma_f32_16x16x32_bf16 v[32:35], a[64:67], a[36:39], v[32:35]
  ds_read_b64_tr_b16 a[64:65], v104 offset:32768
  ds_read_b64_tr_b16 a[66:67], v104 offset:36864
  s_waitcnt lgkmcnt(10)
  v_mfma_f32_16x16x32_bf16 v[36:39], a[68:71], a[36:39], v[36:39]
  buffer_load_dwordx4 a[24:27], v241, s[4:7], s16 offen offset:0 sc1
  v_mfma_f32_16x16x32_bf16 v[36:39], a[100:103], a[44:47], v[36:39]
  v_mfma_f32_16x16x32_bf16 v[20:23], a[100:103], a[40:43], v[20:23]
  ds_read_b64_tr_b16 a[100:101], v105 offset:40960
  ds_read_b64_tr_b16 a[102:103], v105 offset:45056
  v_mfma_f32_16x16x32_bf16 v[20:23], a[68:71], a[32:35], v[20:23]
  buffer_load_dwordx4 v228, s[8:11], s17 offen offset:3072 lds
  v_mfma_f32_16x16x32_bf16 v[24:27], a[72:75], a[32:35], v[24:27]
  ds_read_b64_tr_b16 a[68:69], v105 offset:32768
  s_add_u32 s17, s17, 458752
  v_mfma_f32_16x16x32_bf16 v[24:27], a[104:107], a[40:43], v[24:27]
  ds_read_b64_tr_b16 a[70:71], v105 offset:36864
  s_cmp_eq_u32 s17, s93
  v_mfma_f32_16x16x32_bf16 v[40:43], a[104:107], a[44:47], v[40:43]
  ds_read_b64_tr_b16 a[104:105], v106 offset:40960
  s_cselect_b32 s17, s95, s17
  v_mfma_f32_16x16x32_bf16 v[40:43], a[72:75], a[36:39], v[40:43]
  buffer_load_dwordx4 a[28:31], v241, s[4:7], s16 offen offset:1024 sc1
  v_mfma_f32_16x16x32_bf16 v[44:47], a[76:79], a[36:39], v[44:47]
  ds_read_b64_tr_b16 a[106:107], v106 offset:45056
  s_add_u32 s41, s41, 262144
  v_mfma_f32_16x16x32_bf16 v[44:47], a[108:111], a[44:47], v[44:47]
  ds_read_b64_tr_b16 a[72:73], v106 offset:32768
  s_bitset0_b32 s41, 21
  v_mfma_f32_16x16x32_bf16 v[28:31], a[108:111], a[40:43], v[28:31]
  ds_read_b64_tr_b16 a[74:75], v106 offset:36864
  s_add_u32 s16, s40, s41
  v_mfma_f32_16x16x32_bf16 v[28:31], a[76:79], a[32:35], v[28:31]
  s_waitcnt vmcnt(12) lgkmcnt(10)
  s_barrier
  v_mfma_f32_16x16x32_bf16 v[72:75], a[80:83], a[48:51], v[72:75]
  ds_read_b64_tr_b16 a[108:109], v107 offset:40960
  s_add_u32 m0, s38, 16384
  v_mfma_f32_16x16x32_bf16 v[72:75], a[112:115], a[56:59], v[72:75]
  ds_read_b64_tr_b16 a[110:111], v107 offset:45056
  buffer_load_dwordx4 v225, s[8:11], s17 offen lds
  v_mfma_f32_16x16x32_bf16 v[88:91], a[112:115], a[60:63], v[88:91]
  ds_read_b64_tr_b16 a[76:77], v107 offset:32768
  ds_read_b64_tr_b16 a[78:79], v107 offset:36864
  v_mfma_f32_16x16x32_bf16 v[88:91], a[80:83], a[52:55], v[88:91]
  ds_read_b64_tr_b16 a[112:113], v104 offset:59392
  ds_read_b64_tr_b16 a[114:115], v104 offset:63488
  v_mfma_f32_16x16x32_bf16 v[92:95], a[84:87], a[52:55], v[92:95]
  buffer_load_dwordx4 a[32:35], v240, s[4:7], s16 offen offset:0 sc1
  v_mfma_f32_16x16x32_bf16 v[92:95], a[116:119], a[60:63], v[92:95]
  ds_read_b64_tr_b16 a[80:81], v104 offset:51200
  ds_read_b64_tr_b16 a[82:83], v104 offset:55296
  v_mfma_f32_16x16x32_bf16 v[76:79], a[116:119], a[56:59], v[76:79]
  ds_read_b64_tr_b16 a[116:117], v105 offset:59392
  ds_read_b64_tr_b16 a[118:119], v105 offset:63488
  v_mfma_f32_16x16x32_bf16 v[76:79], a[84:87], a[48:51], v[76:79]
  ds_read_b64_tr_b16 a[84:85], v105 offset:51200
  ds_read_b64_tr_b16 a[86:87], v105 offset:55296
  v_mfma_f32_16x16x32_bf16 v[80:83], a[88:91], a[48:51], v[80:83]
  buffer_load_dwordx4 v226, s[8:11], s17 offen offset:1024 lds
  v_mfma_f32_16x16x32_bf16 v[80:83], a[120:123], a[56:59], v[80:83]
  v_mfma_f32_16x16x32_bf16 v[96:99], a[120:123], a[60:63], v[96:99]
  ds_read_b64_tr_b16 a[120:121], v106 offset:59392
  ds_read_b64_tr_b16 a[122:123], v106 offset:63488
  v_mfma_f32_16x16x32_bf16 v[96:99], a[88:91], a[52:55], v[96:99]
  ds_read_b64_tr_b16 a[88:89], v106 offset:51200
  ds_read_b64_tr_b16 a[90:91], v106 offset:55296
  v_mfma_f32_16x16x32_bf16 v[100:103], a[92:95], a[52:55], v[100:103]
  buffer_load_dwordx4 a[36:39], v240, s[4:7], s16 offen offset:1024 sc1
  v_mfma_f32_16x16x32_bf16 v[100:103], a[124:127], a[60:63], v[100:103]
  v_mfma_f32_16x16x32_bf16 v[84:87], a[124:127], a[56:59], v[84:87]
  ds_read_b64_tr_b16 a[124:125], v107 offset:59392
  ds_read_b64_tr_b16 a[126:127], v107 offset:63488
  v_mfma_f32_16x16x32_bf16 v[84:87], a[92:95], a[48:51], v[84:87]
  ds_read_b64_tr_b16 a[92:93], v107 offset:51200
  ds_read_b64_tr_b16 a[94:95], v107 offset:55296
  s_waitcnt lgkmcnt(10)
  v_mfma_f32_16x16x32_bf16 v[16:19], a[64:67], a[48:51], v[16:19]
  buffer_load_dwordx4 v227, s[8:11], s17 offen offset:2048 lds
  v_mfma_f32_16x16x32_bf16 v[16:19], a[96:99], a[56:59], v[16:19]
  v_mfma_f32_16x16x32_bf16 v[32:35], a[96:99], a[60:63], v[32:35]
  ds_read_b64_tr_b16 a[96:97], v104 offset:57344
  ds_read_b64_tr_b16 a[98:99], v104 offset:61440
  v_mfma_f32_16x16x32_bf16 v[32:35], a[64:67], a[52:55], v[32:35]
  ds_read_b64_tr_b16 a[64:65], v104 offset:49152
  ds_read_b64_tr_b16 a[66:67], v104 offset:53248
  v_mfma_f32_16x16x32_bf16 v[36:39], a[68:71], a[52:55], v[36:39]
  buffer_load_dwordx4 a[40:43], v241, s[4:7], s16 offen offset:0 sc1
  v_mfma_f32_16x16x32_bf16 v[36:39], a[100:103], a[60:63], v[36:39]
  v_mfma_f32_16x16x32_bf16 v[20:23], a[100:103], a[56:59], v[20:23]
  ds_read_b64_tr_b16 a[100:101], v105 offset:57344
  ds_read_b64_tr_b16 a[102:103], v105 offset:61440
  v_mfma_f32_16x16x32_bf16 v[20:23], a[68:71], a[48:51], v[20:23]
  buffer_load_dwordx4 v228, s[8:11], s17 offen offset:3072 lds
  v_mfma_f32_16x16x32_bf16 v[24:27], a[72:75], a[48:51], v[24:27]
  ds_read_b64_tr_b16 a[68:69], v105 offset:49152
  s_add_u32 s17, s17, 458752
  v_mfma_f32_16x16x32_bf16 v[24:27], a[104:107], a[56:59], v[24:27]
  ds_read_b64_tr_b16 a[70:71], v105 offset:53248
  s_cmp_eq_u32 s17, s93
  v_mfma_f32_16x16x32_bf16 v[40:43], a[104:107], a[60:63], v[40:43]
  ds_read_b64_tr_b16 a[104:105], v106 offset:57344
  s_cselect_b32 s17, s95, s17
  v_mfma_f32_16x16x32_bf16 v[40:43], a[72:75], a[52:55], v[40:43]
  buffer_load_dwordx4 a[44:47], v241, s[4:7], s16 offen offset:1024 sc1
  v_mfma_f32_16x16x32_bf16 v[44:47], a[76:79], a[52:55], v[44:47]
  ds_read_b64_tr_b16 a[106:107], v106 offset:61440
  s_add_u32 s41, s41, 262144
  v_mfma_f32_16x16x32_bf16 v[44:47], a[108:111], a[60:63], v[44:47]
  ds_read_b64_tr_b16 a[72:73], v106 offset:49152
  s_bitset0_b32 s41, 21
  v_mfma_f32_16x16x32_bf16 v[28:31], a[108:111], a[56:59], v[28:31]
  ds_read_b64_tr_b16 a[74:75], v106 offset:53248
  s_add_u32 s16, s40, s41
  v_mfma_f32_16x16x32_bf16 v[28:31], a[76:79], a[48:51], v[28:31]
  s_waitcnt vmcnt(16) lgkmcnt(10)
  s_barrier
  v_mfma_f32_16x16x32_bf16 v[72:75], a[80:83], a[0:3], v[72:75]
  ds_read_b64_tr_b16 a[108:109], v107 offset:57344
  s_add_u32 m0, s38, 32768
  v_mfma_f32_16x16x32_bf16 v[72:75], a[112:115], a[8:11], v[72:75]
  ds_read_b64_tr_b16 a[110:111], v107 offset:61440
  buffer_load_dwordx4 v225, s[8:11], s17 offen lds
  v_mfma_f32_16x16x32_bf16 v[88:91], a[112:115], a[12:15], v[88:91]
  ds_read_b64_tr_b16 a[76:77], v107 offset:49152
  ds_read_b64_tr_b16 a[78:79], v107 offset:53248
  v_mfma_f32_16x16x32_bf16 v[88:91], a[80:83], a[4:7], v[88:91]
  ds_read_b64_tr_b16 a[112:113], v124 offset:10240
  ds_read_b64_tr_b16 a[114:115], v124 offset:14336
  v_mfma_f32_16x16x32_bf16 v[92:95], a[84:87], a[4:7], v[92:95]
  buffer_load_dwordx4 a[48:51], v240, s[4:7], s16 offen offset:0 sc1
  v_mfma_f32_16x16x32_bf16 v[92:95], a[116:119], a[12:15], v[92:95]
  ds_read_b64_tr_b16 a[80:81], v124 offset:2048
  ds_read_b64_tr_b16 a[82:83], v124 offset:6144
  v_mfma_f32_16x16x32_bf16 v[76:79], a[116:119], a[8:11], v[76:79]
  ds_read_b64_tr_b16 a[116:117], v125 offset:10240
  ds_read_b64_tr_b16 a[118:119], v125 offset:14336
  v_mfma_f32_16x16x32_bf16 v[76:79], a[84:87], a[0:3], v[76:79]
  ds_read_b64_tr_b16 a[84:85], v125 offset:2048
  ds_read_b64_tr_b16 a[86:87], v125 offset:6144
  v_mfma_f32_16x16x32_bf16 v[80:83], a[88:91], a[0:3], v[80:83]
  buffer_load_dwordx4 v226, s[8:11], s17 offen offset:1024 lds
  v_mfma_f32_16x16x32_bf16 v[80:83], a[120:123], a[8:11], v[80:83]
  v_mfma_f32_16x16x32_bf16 v[96:99], a[120:123], a[12:15], v[96:99]
  ds_read_b64_tr_b16 a[120:121], v126 offset:10240
  ds_read_b64_tr_b16 a[122:123], v126 offset:14336
  v_mfma_f32_16x16x32_bf16 v[96:99], a[88:91], a[4:7], v[96:99]
  ds_read_b64_tr_b16 a[88:89], v126 offset:2048
  ds_read_b64_tr_b16 a[90:91], v126 offset:6144
  v_mfma_f32_16x16x32_bf16 v[100:103], a[92:95], a[4:7], v[100:103]
  buffer_load_dwordx4 a[52:55], v240, s[4:7], s16 offen offset:1024 sc1
  v_mfma_f32_16x16x32_bf16 v[100:103], a[124:127], a[12:15], v[100:103]
  v_mfma_f32_16x16x32_bf16 v[84:87], a[124:127], a[8:11], v[84:87]
  ds_read_b64_tr_b16 a[124:125], v127 offset:10240
  ds_read_b64_tr_b16 a[126:127], v127 offset:14336
  v_mfma_f32_16x16x32_bf16 v[84:87], a[92:95], a[0:3], v[84:87]
  ds_read_b64_tr_b16 a[92:93], v127 offset:2048
  ds_read_b64_tr_b16 a[94:95], v127 offset:6144
  s_waitcnt lgkmcnt(10)
  v_mfma_f32_16x16x32_bf16 v[16:19], a[64:67], a[0:3], v[16:19]
  buffer_load_dwordx4 v227, s[8:11], s17 offen offset:2048 lds
  v_mfma_f32_16x16x32_bf16 v[16:19], a[96:99], a[8:11], v[16:19]
  v_mfma_f32_16x16x32_bf16 v[32:35], a[96:99], a[12:15], v[32:35]
  ds_read_b64_tr_b16 a[96:97], v124 offset:8192
  ds_read_b64_tr_b16 a[98:99], v124 offset:12288
  v_mfma_f32_16x16x32_bf16 v[32:35], a[64:67], a[4:7], v[32:35]
  ds_read_b64_tr_b16 a[64:65], v124 offset:0
  ds_read_b64_tr_b16 a[66:67], v124 offset:4096
  v_mfma_f32_16x16x32_bf16 v[36:39], a[68:71], a[4:7], v[36:39]
  buffer_load_dwordx4 a[56:59], v241, s[4:7], s16 offen offset:0 sc1
  v_mfma_f32_16x16x32_bf16 v[36:39], a[100:103], a[12:15], v[36:39]
  v_mfma_f32_16x16x32_bf16 v[20:23], a[100:103], a[8:11], v[20:23]
  ds_read_b64_tr_b16 a[100:101], v125 offset:8192
  ds_read_b64_tr_b16 a[102:103], v125 offset:12288
  v_mfma_f32_16x16x32_bf16 v[20:23], a[68:71], a[0:3], v[20:23]
  buffer_load_dwordx4 v228, s[8:11], s17 offen offset:3072 lds
  v_mfma_f32_16x16x32_bf16 v[24:27], a[72:75], a[0:3], v[24:27]
  ds_read_b64_tr_b16 a[68:69], v125 offset:0
  s_add_u32 s17, s17, 458752
  v_mfma_f32_16x16x32_bf16 v[24:27], a[104:107], a[8:11], v[24:27]
  ds_read_b64_tr_b16 a[70:71], v125 offset:4096
  s_cmp_eq_u32 s17, s93
  v_mfma_f32_16x16x32_bf16 v[40:43], a[104:107], a[12:15], v[40:43]
  ds_read_b64_tr_b16 a[104:105], v126 offset:8192
  s_cselect_b32 s17, s95, s17
  v_mfma_f32_16x16x32_bf16 v[40:43], a[72:75], a[4:7], v[40:43]
  buffer_load_dwordx4 a[60:63], v241, s[4:7], s16 offen offset:1024 sc1
  v_mfma_f32_16x16x32_bf16 v[44:47], a[76:79], a[4:7], v[44:47]
  ds_read_b64_tr_b16 a[106:107], v126 offset:12288
  s_add_u32 s41, s41, 262144
  v_mfma_f32_16x16x32_bf16 v[44:47], a[108:111], a[12:15], v[44:47]
  ds_read_b64_tr_b16 a[72:73], v126 offset:0
  s_bitset0_b32 s41, 21
  v_mfma_f32_16x16x32_bf16 v[28:31], a[108:111], a[8:11], v[28:31]
  ds_read_b64_tr_b16 a[74:75], v126 offset:4096
  s_add_u32 s16, s40, s41
  v_mfma_f32_16x16x32_bf16 v[28:31], a[76:79], a[0:3], v[28:31]
  s_waitcnt vmcnt(16) lgkmcnt(10)
  s_barrier
  v_mfma_f32_16x16x32_bf16 v[72:75], a[80:83], a[16:19], v[72:75]
  ds_read_b64_tr_b16 a[108:109], v127 offset:8192
  s_add_u32 m0, s38, 49152
  v_mfma_f32_16x16x32_bf16 v[72:75], a[112:115], a[24:27], v[72:75]
  ds_read_b64_tr_b16 a[110:111], v127 offset:12288
  buffer_load_dwordx4 v225, s[8:11], s17 offen lds
  v_mfma_f32_16x16x32_bf16 v[88:91], a[112:115], a[28:31], v[88:91]
  ds_read_b64_tr_b16 a[76:77], v127 offset:0
  ds_read_b64_tr_b16 a[78:79], v127 offset:4096
  v_mfma_f32_16x16x32_bf16 v[88:91], a[80:83], a[20:23], v[88:91]
  ds_read_b64_tr_b16 a[112:113], v242 offset:10240
  ds_read_b64_tr_b16 a[114:115], v242 offset:14336
  v_mfma_f32_16x16x32_bf16 v[92:95], a[84:87], a[20:23], v[92:95]
  buffer_load_dwordx4 a[0:3], v240, s[4:7], s16 offen offset:0 sc1
  v_mfma_f32_16x16x32_bf16 v[92:95], a[116:119], a[28:31], v[92:95]
  ds_read_b64_tr_b16 a[80:81], v242 offset:2048
  ds_read_b64_tr_b16 a[82:83], v242 offset:6144
  v_mfma_f32_16x16x32_bf16 v[76:79], a[116:119], a[24:27], v[76:79]
  ds_read_b64_tr_b16 a[116:117], v243 offset:10240
  ds_read_b64_tr_b16 a[118:119], v243 offset:14336
  v_mfma_f32_16x16x32_bf16 v[76:79], a[84:87], a[16:19], v[76:79]
  ds_read_b64_tr_b16 a[84:85], v243 offset:2048
  ds_read_b64_tr_b16 a[86:87], v243 offset:6144
  v_mfma_f32_16x16x32_bf16 v[80:83], a[88:91], a[16:19], v[80:83]
  buffer_load_dwordx4 v226, s[8:11], s17 offen offset:1024 lds
  v_mfma_f32_16x16x32_bf16 v[80:83], a[120:123], a[24:27], v[80:83]
  v_mfma_f32_16x16x32_bf16 v[96:99], a[120:123], a[28:31], v[96:99]
  ds_read_b64_tr_b16 a[120:121], v244 offset:10240
  ds_read_b64_tr_b16 a[122:123], v244 offset:14336
  v_mfma_f32_16x16x32_bf16 v[96:99], a[88:91], a[20:23], v[96:99]
  ds_read_b64_tr_b16 a[88:89], v244 offset:2048
  ds_read_b64_tr_b16 a[90:91], v244 offset:6144
  v_mfma_f32_16x16x32_bf16 v[100:103], a[92:95], a[20:23], v[100:103]
  buffer_load_dwordx4 a[4:7], v240, s[4:7], s16 offen offset:1024 sc1
  v_mfma_f32_16x16x32_bf16 v[100:103], a[124:127], a[28:31], v[100:103]
  v_mfma_f32_16x16x32_bf16 v[84:87], a[124:127], a[24:27], v[84:87]
  ds_read_b64_tr_b16 a[124:125], v245 offset:10240
  ds_read_b64_tr_b16 a[126:127], v245 offset:14336
  v_mfma_f32_16x16x32_bf16 v[84:87], a[92:95], a[16:19], v[84:87]
  ds_read_b64_tr_b16 a[92:93], v245 offset:2048
  ds_read_b64_tr_b16 a[94:95], v245 offset:6144
  s_waitcnt lgkmcnt(10)
  v_mfma_f32_16x16x32_bf16 v[16:19], a[64:67], a[16:19], v[16:19]
  buffer_load_dwordx4 v227, s[8:11], s17 offen offset:2048 lds
  v_mfma_f32_16x16x32_bf16 v[16:19], a[96:99], a[24:27], v[16:19]
  v_mfma_f32_16x16x32_bf16 v[32:35], a[96:99], a[28:31], v[32:35]
  ds_read_b64_tr_b16 a[96:97], v242 offset:8192
  ds_read_b64_tr_b16 a[98:99], v242 offset:12288
  v_mfma_f32_16x16x32_bf16 v[32:35], a[64:67], a[20:23], v[32:35]
  ds_read_b64_tr_b16 a[64:65], v242 offset:0
  ds_read_b64_tr_b16 a[66:67], v242 offset:4096
  v_mfma_f32_16x16x32_bf16 v[36:39], a[68:71], a[20:23], v[36:39]
  buffer_load_dwordx4 a[8:11], v241, s[4:7], s16 offen offset:0 sc1
  v_mfma_f32_16x16x32_bf16 v[36:39], a[100:103], a[28:31], v[36:39]
  v_mfma_f32_16x16x32_bf16 v[20:23], a[100:103], a[24:27], v[20:23]
  ds_read_b64_tr_b16 a[100:101], v243 offset:8192
  ds_read_b64_tr_b16 a[102:103], v243 offset:12288
  v_mfma_f32_16x16x32_bf16 v[20:23], a[68:71], a[16:19], v[20:23]
  buffer_load_dwordx4 v228, s[8:11], s17 offen offset:3072 lds
  v_mfma_f32_16x16x32_bf16 v[24:27], a[72:75], a[16:19], v[24:27]
  ds_read_b64_tr_b16 a[68:69], v243 offset:0
  s_add_u32 s17, s17, 458752
  v_mfma_f32_16x16x32_bf16 v[24:27], a[104:107], a[24:27], v[24:27]
  ds_read_b64_tr_b16 a[70:71], v243 offset:4096
  s_cmp_eq_u32 s17, s93
  v_mfma_f32_16x16x32_bf16 v[40:43], a[104:107], a[28:31], v[40:43]
  ds_read_b64_tr_b16 a[104:105], v244 offset:8192
  s_cselect_b32 s17, s95, s17
  v_mfma_f32_16x16x32_bf16 v[40:43], a[72:75], a[20:23], v[40:43]
  buffer_load_dwordx4 a[12:15], v241, s[4:7], s16 offen offset:1024 sc1
  v_mfma_f32_16x16x32_bf16 v[44:47], a[76:79], a[20:23], v[44:47]
  ds_read_b64_tr_b16 a[106:107], v244 offset:12288
  s_add_u32 s41, s41, 262144
  v_mfma_f32_16x16x32_bf16 v[44:47], a[108:111], a[28:31], v[44:47]
  ds_read_b64_tr_b16 a[72:73], v244 offset:0
  s_bitset0_b32 s41, 21
  v_mfma_f32_16x16x32_bf16 v[28:31], a[108:111], a[24:27], v[28:31]
  ds_read_b64_tr_b16 a[74:75], v244 offset:4096
  s_add_u32 s16, s40, s41
  v_mfma_f32_16x16x32_bf16 v[28:31], a[76:79], a[16:19], v[28:31]
  s_waitcnt vmcnt(16) lgkmcnt(10)
  s_barrier
  v_mfma_f32_16x16x32_bf16 v[72:75], a[80:83], a[32:35], v[72:75]
  ds_read_b64_tr_b16 a[108:109], v245 offset:8192
  s_add_u32 m0, s38, 65536
  v_mfma_f32_16x16x32_bf16 v[72:75], a[112:115], a[40:43], v[72:75]
  ds_read_b64_tr_b16 a[110:111], v245 offset:12288
  buffer_load_dwordx4 v225, s[8:11], s17 offen lds
  v_mfma_f32_16x16x32_bf16 v[88:91], a[112:115], a[44:47], v[88:91]
  ds_read_b64_tr_b16 a[76:77], v245 offset:0
  ds_read_b64_tr_b16 a[78:79], v245 offset:4096
  v_mfma_f32_16x16x32_bf16 v[88:91], a[80:83], a[36:39], v[88:91]
  ds_read_b64_tr_b16 a[112:113], v242 offset:26624
  ds_read_b64_tr_b16 a[114:115], v242 offset:30720
  v_mfma_f32_16x16x32_bf16 v[92:95], a[84:87], a[36:39], v[92:95]
  buffer_load_dwordx4 a[16:19], v240, s[4:7], s16 offen offset:0 sc1
  v_mfma_f32_16x16x32_bf16 v[92:95], a[116:119], a[44:47], v[92:95]
  ds_read_b64_tr_b16 a[80:81], v242 offset:18432
  ds_read_b64_tr_b16 a[82:83], v242 offset:22528
  v_mfma_f32_16x16x32_bf16 v[76:79], a[116:119], a[40:43], v[76:79]
  ds_read_b64_tr_b16 a[116:117], v243 offset:26624
  ds_read_b64_tr_b16 a[118:119], v243 offset:30720
  v_mfma_f32_16x16x32_bf16 v[76:79], a[84:87], a[32:35], v[76:79]
  ds_read_b64_tr_b16 a[84:85], v243 offset:18432
  ds_read_b64_tr_b16 a[86:87], v243 offset:22528
  v_mfma_f32_16x16x32_bf16 v[80:83], a[88:91], a[32:35], v[80:83]
  buffer_load_dwordx4 v226, s[8:11], s17 offen offset:1024 lds
  v_mfma_f32_16x16x32_bf16 v[80:83], a[120:123], a[40:43], v[80:83]
  v_mfma_f32_16x16x32_bf16 v[96:99], a[120:123], a[44:47], v[96:99]
  ds_read_b64_tr_b16 a[120:121], v244 offset:26624
  ds_read_b64_tr_b16 a[122:123], v244 offset:30720
  v_mfma_f32_16x16x32_bf16 v[96:99], a[88:91], a[36:39], v[96:99]
  ds_read_b64_tr_b16 a[88:89], v244 offset:18432
  ds_read_b64_tr_b16 a[90:91], v244 offset:22528
  v_mfma_f32_16x16x32_bf16 v[100:103], a[92:95], a[36:39], v[100:103]
  buffer_load_dwordx4 a[20:23], v240, s[4:7], s16 offen offset:1024 sc1
  v_mfma_f32_16x16x32_bf16 v[100:103], a[124:127], a[44:47], v[100:103]
  v_mfma_f32_16x16x32_bf16 v[84:87], a[124:127], a[40:43], v[84:87]
  ds_read_b64_tr_b16 a[124:125], v245 offset:26624
  ds_read_b64_tr_b16 a[126:127], v245 offset:30720
  v_mfma_f32_16x16x32_bf16 v[84:87], a[92:95], a[32:35], v[84:87]
  ds_read_b64_tr_b16 a[92:93], v245 offset:18432
  ds_read_b64_tr_b16 a[94:95], v245 offset:22528
  s_waitcnt lgkmcnt(10)
  v_mfma_f32_16x16x32_bf16 v[16:19], a[64:67], a[32:35], v[16:19]
  buffer_load_dwordx4 v227, s[8:11], s17 offen offset:2048 lds
  v_mfma_f32_16x16x32_bf16 v[16:19], a[96:99], a[40:43], v[16:19]
  v_mfma_f32_16x16x32_bf16 v[32:35], a[96:99], a[44:47], v[32:35]
  ds_read_b64_tr_b16 a[96:97], v242 offset:24576
  ds_read_b64_tr_b16 a[98:99], v242 offset:28672
  v_mfma_f32_16x16x32_bf16 v[32:35], a[64:67], a[36:39], v[32:35]
  ds_read_b64_tr_b16 a[64:65], v242 offset:16384
  ds_read_b64_tr_b16 a[66:67], v242 offset:20480
  v_mfma_f32_16x16x32_bf16 v[36:39], a[68:71], a[36:39], v[36:39]
  buffer_load_dwordx4 a[24:27], v241, s[4:7], s16 offen offset:0 sc1
  v_mfma_f32_16x16x32_bf16 v[36:39], a[100:103], a[44:47], v[36:39]
  v_mfma_f32_16x16x32_bf16 v[20:23], a[100:103], a[40:43], v[20:23]
  ds_read_b64_tr_b16 a[100:101], v243 offset:24576
  ds_read_b64_tr_b16 a[102:103], v243 offset:28672
  v_mfma_f32_16x16x32_bf16 v[20:23], a[68:71], a[32:35], v[20:23]
  buffer_load_dwordx4 v228, s[8:11], s17 offen offset:3072 lds
  v_mfma_f32_16x16x32_bf16 v[24:27], a[72:75], a[32:35], v[24:27]
  ds_read_b64_tr_b16 a[68:69], v243 offset:16384
  s_add_u32 s17, s17, 458752
  v_mfma_f32_16x16x32_bf16 v[24:27], a[104:107], a[40:43], v[24:27]
  ds_read_b64_tr_b16 a[70:71], v243 offset:20480
  s_cmp_eq_u32 s17, s93
  v_mfma_f32_16x16x32_bf16 v[40:43], a[104:107], a[44:47], v[40:43]
  ds_read_b64_tr_b16 a[104:105], v244 offset:24576
  s_cselect_b32 s17, s95, s17
  v_mfma_f32_16x16x32_bf16 v[40:43], a[72:75], a[36:39], v[40:43]
  buffer_load_dwordx4 a[28:31], v241, s[4:7], s16 offen offset:1024 sc1
  v_mfma_f32_16x16x32_bf16 v[44:47], a[76:79], a[36:39], v[44:47]
  ds_read_b64_tr_b16 a[106:107], v244 offset:28672
  s_add_u32 s41, s41, 262144
  v_mfma_f32_16x16x32_bf16 v[44:47], a[108:111], a[44:47], v[44:47]
  ds_read_b64_tr_b16 a[72:73], v244 offset:16384
  s_bitset0_b32 s41, 21
  v_mfma_f32_16x16x32_bf16 v[28:31], a[108:111], a[40:43], v[28:31]
  ds_read_b64_tr_b16 a[74:75], v244 offset:20480
  s_add_u32 s16, s40, s41
  v_mfma_f32_16x16x32_bf16 v[28:31], a[76:79], a[32:35], v[28:31]
  s_waitcnt vmcnt(16) lgkmcnt(10)
  s_barrier
  v_mfma_f32_16x16x32_bf16 v[72:75], a[80:83], a[48:51], v[72:75]
  ds_read_b64_tr_b16 a[108:109], v245 offset:24576
  s_add_u32 m0, s38, 81920
  v_mfma_f32_16x16x32_bf16 v[72:75], a[112:115], a[56:59], v[72:75]
  ds_read_b64_tr_b16 a[110:111], v245 offset:28672
  buffer_load_dwordx4 v225, s[8:11], s17 offen lds
  v_mfma_f32_16x16x32_bf16 v[88:91], a[112:115], a[60:63], v[88:91]
  ds_read_b64_tr_b16 a[76:77], v245 offset:16384
  ds_read_b64_tr_b16 a[78:79], v245 offset:20480
  v_mfma_f32_16x16x32_bf16 v[88:91], a[80:83], a[52:55], v[88:91]
  ds_read_b64_tr_b16 a[112:113], v242 offset:43008
  ds_read_b64_tr_b16 a[114:115], v242 offset:47104
  v_mfma_f32_16x16x32_bf16 v[92:95], a[84:87], a[52:55], v[92:95]
  buffer_load_dwordx4 a[32:35], v240, s[4:7], s16 offen offset:0 sc1
  v_mfma_f32_16x16x32_bf16 v[92:95], a[116:119], a[60:63], v[92:95]
  ds_read_b64_tr_b16 a[80:81], v242 offset:34816
  ds_read_b64_tr_b16 a[82:83], v242 offset:38912
  v_mfma_f32_16x16x32_bf16 v[76:79], a[116:119], a[56:59], v[76:79]
  ds_read_b64_tr_b16 a[116:117], v243 offset:43008
  ds_read_b64_tr_b16 a[118:119], v243 offset:47104
  v_mfma_f32_16x16x32_bf16 v[76:79], a[84:87], a[48:51], v[76:79]
  ds_read_b64_tr_b16 a[84:85], v243 offset:34816
  ds_read_b64_tr_b16 a[86:87], v243 offset:38912
  v_mfma_f32_16x16x32_bf16 v[80:83], a[88:91], a[48:51], v[80:83]
  buffer_load_dwordx4 v226, s[8:11], s17 offen offset:1024 lds
  v_mfma_f32_16x16x32_bf16 v[80:83], a[120:123], a[56:59], v[80:83]
  v_mfma_f32_16x16x32_bf16 v[96:99], a[120:123], a[60:63], v[96:99]
  ds_read_b64_tr_b16 a[120:121], v244 offset:43008
  ds_read_b64_tr_b16 a[122:123], v244 offset:47104
  v_mfma_f32_16x16x32_bf16 v[96:99], a[88:91], a[52:55], v[96:99]
  ds_read_b64_tr_b16 a[88:89], v244 offset:34816
  ds_read_b64_tr_b16 a[90:91], v244 offset:38912
  v_mfma_f32_16x16x32_bf16 v[100:103], a[92:95], a[52:55], v[100:103]
  buffer_load_dwordx4 a[36:39], v240, s[4:7], s16 offen offset:1024 sc1
  v_mfma_f32_16x16x32_bf16 v[100:103], a[124:127], a[60:63], v[100:103]
  v_mfma_f32_16x16x32_bf16 v[84:87], a[124:127], a[56:59], v[84:87]
  ds_read_b64_tr_b16 a[124:125], v245 offset:43008
  ds_read_b64_tr_b16 a[126:127], v245 offset:47104
  v_mfma_f32_16x16x32_bf16 v[84:87], a[92:95], a[48:51], v[84:87]
  ds_read_b64_tr_b16 a[92:93], v245 offset:34816
  ds_read_b64_tr_b16 a[94:95], v245 offset:38912
  s_waitcnt lgkmcnt(10)
  v_mfma_f32_16x16x32_bf16 v[16:19], a[64:67], a[48:51], v[16:19]
  buffer_load_dwordx4 v227, s[8:11], s17 offen offset:2048 lds
  v_mfma_f32_16x16x32_bf16 v[16:19], a[96:99], a[56:59], v[16:19]
  v_mfma_f32_16x16x32_bf16 v[32:35], a[96:99], a[60:63], v[32:35]
  ds_read_b64_tr_b16 a[96:97], v242 offset:40960
  ds_read_b64_tr_b16 a[98:99], v242 offset:45056
  v_mfma_f32_16x16x32_bf16 v[32:35], a[64:67], a[52:55], v[32:35]
  ds_read_b64_tr_b16 a[64:65], v242 offset:32768
  ds_read_b64_tr_b16 a[66:67], v242 offset:36864
  v_mfma_f32_16x16x32_bf16 v[36:39], a[68:71], a[52:55], v[36:39]
  buffer_load_dwordx4 a[40:43], v241, s[4:7], s16 offen offset:0 sc1
  v_mfma_f32_16x16x32_bf16 v[36:39], a[100:103], a[60:63], v[36:39]
  v_mfma_f32_16x16x32_bf16 v[20:23], a[100:103], a[56:59], v[20:23]
  ds_read_b64_tr_b16 a[100:101], v243 offset:40960
  ds_read_b64_tr_b16 a[102:103], v243 offset:45056
  v_mfma_f32_16x16x32_bf16 v[20:23], a[68:71], a[48:51], v[20:23]
  ds_read_b64_tr_b16 a[68:69], v243 offset:32768
  ds_read_b64_tr_b16 a[70:71], v243 offset:36864
  v_mfma_f32_16x16x32_bf16 v[24:27], a[72:75], a[48:51], v[24:27]
  buffer_load_dwordx4 v228, s[8:11], s17 offen offset:3072 lds
  v_mfma_f32_16x16x32_bf16 v[24:27], a[104:107], a[56:59], v[24:27]
  s_mov_b32 s17, s97
  v_mfma_f32_16x16x32_bf16 v[40:43], a[104:107], a[60:63], v[40:43]
  ds_read_b64_tr_b16 a[104:105], v244 offset:40960
  ds_read_b64_tr_b16 a[106:107], v244 offset:45056
  v_mfma_f32_16x16x32_bf16 v[40:43], a[72:75], a[52:55], v[40:43]
  buffer_load_dwordx4 a[44:47], v241, s[4:7], s16 offen offset:1024 sc1
  v_mfma_f32_16x16x32_bf16 v[44:47], a[76:79], a[52:55], v[44:47]
  ds_read_b64_tr_b16 a[72:73], v244 offset:32768
  s_add_u32 s41, s41, 262144
  v_mfma_f32_16x16x32_bf16 v[44:47], a[108:111], a[60:63], v[44:47]
  ds_read_b64_tr_b16 a[74:75], v244 offset:36864
  s_bitset0_b32 s41, 21
  v_mfma_f32_16x16x32_bf16 v[28:31], a[108:111], a[56:59], v[28:31]
  ds_read_b64_tr_b16 a[108:109], v245 offset:40960
  s_add_u32 s16, s40, s41
  v_mfma_f32_16x16x32_bf16 v[28:31], a[76:79], a[48:51], v[28:31]
  s_waitcnt vmcnt(16) lgkmcnt(10)
  s_barrier
  v_mfma_f32_16x16x32_bf16 v[72:75], a[80:83], a[0:3], v[72:75]
  ds_read_b64_tr_b16 a[110:111], v245 offset:45056
  s_add_u32 m0, s38, 98304
  v_mfma_f32_16x16x32_bf16 v[72:75], a[112:115], a[8:11], v[72:75]
  buffer_load_dwordx4 v227, s[8:11], s17 offen offset:2048 lds
  v_mfma_f32_16x16x32_bf16 v[88:91], a[112:115], a[12:15], v[88:91]
  ds_read_b64_tr_b16 a[76:77], v245 offset:32768
  ds_read_b64_tr_b16 a[78:79], v245 offset:36864
  v_mfma_f32_16x16x32_bf16 v[88:91], a[80:83], a[4:7], v[88:91]
  ds_read_b64_tr_b16 a[112:113], v242 offset:59392
  ds_read_b64_tr_b16 a[114:115], v242 offset:63488
  v_mfma_f32_16x16x32_bf16 v[92:95], a[84:87], a[4:7], v[92:95]
  buffer_load_dwordx4 a[48:51], v240, s[4:7], s16 offen offset:0 sc1
  v_mfma_f32_16x16x32_bf16 v[92:95], a[116:119], a[12:15], v[92:95]
  ds_read_b64_tr_b16 a[80:81], v242 offset:51200
  ds_read_b64_tr_b16 a[82:83], v242 offset:55296
  v_mfma_f32_16x16x32_bf16 v[76:79], a[116:119], a[8:11], v[76:79]
  ds_read_b64_tr_b16 a[116:117], v243 offset:59392
  ds_read_b64_tr_b16 a[118:119], v243 offset:63488
  v_mfma_f32_16x16x32_bf16 v[76:79], a[84:87], a[0:3], v[76:79]
  ds_read_b64_tr_b16 a[84:85], v243 offset:51200
  ds_read_b64_tr_b16 a[86:87], v243 offset:55296
  v_mfma_f32_16x16x32_bf16 v[80:83], a[88:91], a[0:3], v[80:83]
  buffer_load_dwordx4 v228, s[8:11], s17 offen offset:3072 lds
  v_mfma_f32_16x16x32_bf16 v[80:83], a[120:123], a[8:11], v[80:83]
  s_add_u32 s17, s17, 917504
  v_mfma_f32_16x16x32_bf16 v[96:99], a[120:123], a[12:15], v[96:99]
  ds_read_b64_tr_b16 a[120:121], v244 offset:59392
  ds_read_b64_tr_b16 a[122:123], v244 offset:63488
  v_mfma_f32_16x16x32_bf16 v[96:99], a[88:91], a[4:7], v[96:99]
  ds_read_b64_tr_b16 a[88:89], v244 offset:51200
  ds_read_b64_tr_b16 a[90:91], v244 offset:55296
  v_mfma_f32_16x16x32_bf16 v[100:103], a[92:95], a[4:7], v[100:103]
  buffer_load_dwordx4 a[52:55], v240, s[4:7], s16 offen offset:1024 sc1
  v_mfma_f32_16x16x32_bf16 v[100:103], a[124:127], a[12:15], v[100:103]
  s_add_u32 m0, s38, 96256
  v_mfma_f32_16x16x32_bf16 v[84:87], a[124:127], a[8:11], v[84:87]
  ds_read_b64_tr_b16 a[124:125], v245 offset:59392
  ds_read_b64_tr_b16 a[126:127], v245 offset:63488
  v_mfma_f32_16x16x32_bf16 v[84:87], a[92:95], a[0:3], v[84:87]
  ds_read_b64_tr_b16 a[92:93], v245 offset:51200
  ds_read_b64_tr_b16 a[94:95], v245 offset:55296
  s_waitcnt lgkmcnt(10)
  v_mfma_f32_16x16x32_bf16 v[16:19], a[64:67], a[0:3], v[16:19]
  buffer_load_dwordx4 v227, s[8:11], s17 offen offset:2048 lds
  v_mfma_f32_16x16x32_bf16 v[16:19], a[96:99], a[8:11], v[16:19]
  v_mfma_f32_16x16x32_bf16 v[32:35], a[96:99], a[12:15], v[32:35]
  ds_read_b64_tr_b16 a[96:97], v242 offset:57344
  ds_read_b64_tr_b16 a[98:99], v242 offset:61440
  v_mfma_f32_16x16x32_bf16 v[32:35], a[64:67], a[4:7], v[32:35]
  ds_read_b64_tr_b16 a[64:65], v242 offset:49152
  ds_read_b64_tr_b16 a[66:67], v242 offset:53248
  v_mfma_f32_16x16x32_bf16 v[36:39], a[68:71], a[4:7], v[36:39]
  buffer_load_dwordx4 a[56:59], v241, s[4:7], s16 offen offset:0 sc1
  v_mfma_f32_16x16x32_bf16 v[36:39], a[100:103], a[12:15], v[36:39]
  v_mfma_f32_16x16x32_bf16 v[20:23], a[100:103], a[8:11], v[20:23]
  ds_read_b64_tr_b16 a[100:101], v243 offset:57344
  ds_read_b64_tr_b16 a[102:103], v243 offset:61440
  v_mfma_f32_16x16x32_bf16 v[20:23], a[68:71], a[0:3], v[20:23]
  ds_read_b64_tr_b16 a[68:69], v243 offset:49152
  ds_read_b64_tr_b16 a[70:71], v243 offset:53248
  v_mfma_f32_16x16x32_bf16 v[24:27], a[72:75], a[0:3], v[24:27]
  buffer_load_dwordx4 v228, s[8:11], s17 offen offset:3072 lds
  v_mfma_f32_16x16x32_bf16 v[24:27], a[104:107], a[8:11], v[24:27]
  s_add_u32 s17, s17, 917504
  v_mfma_f32_16x16x32_bf16 v[40:43], a[104:107], a[12:15], v[40:43]
  ds_read_b64_tr_b16 a[104:105], v244 offset:57344
  ds_read_b64_tr_b16 a[106:107], v244 offset:61440
  v_mfma_f32_16x16x32_bf16 v[40:43], a[72:75], a[4:7], v[40:43]
  ds_read_b64_tr_b16 a[72:73], v244 offset:49152
  ds_read_b64_tr_b16 a[74:75], v244 offset:53248
  v_mfma_f32_16x16x32_bf16 v[44:47], a[76:79], a[4:7], v[44:47]
  buffer_load_dwordx4 a[60:63], v241, s[4:7], s16 offen offset:1024 sc1
  v_mfma_f32_16x16x32_bf16 v[44:47], a[108:111], a[12:15], v[44:47]
  s_add_u32 s16, s40, 2097152
  v_mfma_f32_16x16x32_bf16 v[28:31], a[108:111], a[8:11], v[28:31]
  ds_read_b64_tr_b16 a[108:109], v245 offset:57344
  ds_read_b64_tr_b16 a[110:111], v245 offset:61440
  v_mfma_f32_16x16x32_bf16 v[28:31], a[76:79], a[0:3], v[28:31]
  s_waitcnt vmcnt(16) lgkmcnt(10)
  s_barrier
  v_mfma_f32_16x16x32_bf16 v[72:75], a[80:83], a[16:19], v[72:75]
  buffer_load_dwordx4 v[128:131], v240, s[4:7], s16 offen offset:0 sc1
  v_mfma_f32_16x16x32_bf16 v[72:75], a[112:115], a[24:27], v[72:75]
  ds_read_b64_tr_b16 a[76:77], v245 offset:49152
  ds_read_b64_tr_b16 a[78:79], v245 offset:53248
  v_mfma_f32_16x16x32_bf16 v[88:91], a[112:115], a[28:31], v[88:91]
  ds_read_b64_tr_b16 a[112:113], v104 offset:10240
  ds_read_b64_tr_b16 a[114:115], v104 offset:14336
  v_mfma_f32_16x16x32_bf16 v[88:91], a[80:83], a[20:23], v[88:91]
  buffer_load_dwordx4 v[132:135], v240, s[4:7], s16 offen offset:1024 sc1
  v_mfma_f32_16x16x32_bf16 v[92:95], a[84:87], a[20:23], v[92:95]
  ds_read_b64_tr_b16 a[80:81], v104 offset:2048
  ds_read_b64_tr_b16 a[82:83], v104 offset:6144
  v_mfma_f32_16x16x32_bf16 v[92:95], a[116:119], a[28:31], v[92:95]
  v_mfma_f32_16x16x32_bf16 v[76:79], a[116:119], a[24:27], v[76:79]
  ds_read_b64_tr_b16 a[116:117], v105 offset:10240
  ds_read_b64_tr_b16 a[118:119], v105 offset:14336
  v_mfma_f32_16x16x32_bf16 v[76:79], a[84:87], a[16:19], v[76:79]
  buffer_load_dwordx4 v[136:139], v241, s[4:7], s16 offen offset:0 sc1
  v_mfma_f32_16x16x32_bf16 v[80:83], a[88:91], a[16:19], v[80:83]
  ds_read_b64_tr_b16 a[84:85], v105 offset:2048
  ds_read_b64_tr_b16 a[86:87], v105 offset:6144
  v_mfma_f32_16x16x32_bf16 v[80:83], a[120:123], a[24:27], v[80:83]
  v_mfma_f32_16x16x32_bf16 v[96:99], a[120:123], a[28:31], v[96:99]
  ds_read_b64_tr_b16 a[120:121], v106 offset:10240
  ds_read_b64_tr_b16 a[122:123], v106 offset:14336
  v_mfma_f32_16x16x32_bf16 v[96:99], a[88:91], a[20:23], v[96:99]
  buffer_load_dwordx4 v[140:143], v241, s[4:7], s16 offen offset:1024 sc1
  v_mfma_f32_16x16x32_bf16 v[100:103], a[92:95], a[20:23], v[100:103]
  ds_read_b64_tr_b16 a[88:89], v106 offset:2048
  s_add_u32 s16, s16, 262144
  v_mfma_f32_16x16x32_bf16 v[100:103], a[124:127], a[28:31], v[100:103]
  ds_read_b64_tr_b16 a[90:91], v106 offset:6144
  v_mfma_f32_16x16x32_bf16 v[84:87], a[124:127], a[24:27], v[84:87]
  ds_read_b64_tr_b16 a[124:125], v107 offset:10240
  ds_read_b64_tr_b16 a[126:127], v107 offset:14336
  v_mfma_f32_16x16x32_bf16 v[84:87], a[92:95], a[16:19], v[84:87]
  buffer_load_dwordx4 v[144:147], v240, s[4:7], s16 offen offset:0 sc1
  v_mfma_f32_16x16x32_bf16 v[16:19], a[64:67], a[16:19], v[16:19]
  ds_read_b64_tr_b16 a[92:93], v107 offset:2048
  ds_read_b64_tr_b16 a[94:95], v107 offset:6144
  v_mfma_f32_16x16x32_bf16 v[16:19], a[96:99], a[24:27], v[16:19]
  v_mfma_f32_16x16x32_bf16 v[32:35], a[96:99], a[28:31], v[32:35]
  ds_read_b64_tr_b16 a[96:97], v104 offset:8192
  ds_read_b64_tr_b16 a[98:99], v104 offset:12288
  v_mfma_f32_16x16x32_bf16 v[32:35], a[64:67], a[20:23], v[32:35]
  buffer_load_dwordx4 v[148:151], v240, s[4:7], s16 offen offset:1024 sc1
  s_waitcnt lgkmcnt(10)
  v_mfma_f32_16x16x32_bf16 v[36:39], a[68:71], a[20:23], v[36:39]
  ds_read_b64_tr_b16 a[64:65], v104 offset:0
  ds_read_b64_tr_b16 a[66:67], v104 offset:4096
  v_mfma_f32_16x16x32_bf16 v[36:39], a[100:103], a[28:31], v[36:39]
  v_mfma_f32_16x16x32_bf16 v[20:23], a[100:103], a[24:27], v[20:23]
  ds_read_b64_tr_b16 a[100:101], v105 offset:8192
  ds_read_b64_tr_b16 a[102:103], v105 offset:12288
  v_mfma_f32_16x16x32_bf16 v[20:23], a[68:71], a[16:19], v[20:23]
  buffer_load_dwordx4 v[152:155], v241, s[4:7], s16 offen offset:0 sc1
  v_mfma_f32_16x16x32_bf16 v[24:27], a[72:75], a[16:19], v[24:27]
  ds_read_b64_tr_b16 a[68:69], v105 offset:0
  ds_read_b64_tr_b16 a[70:71], v105 offset:4096
  v_mfma_f32_16x16x32_bf16 v[24:27], a[104:107], a[24:27], v[24:27]
  v_mfma_f32_16x16x32_bf16 v[40:43], a[104:107], a[28:31], v[40:43]
  ds_read_b64_tr_b16 a[104:105], v106 offset:8192
  ds_read_b64_tr_b16 a[106:107], v106 offset:12288
  v_mfma_f32_16x16x32_bf16 v[40:43], a[72:75], a[20:23], v[40:43]
  buffer_load_dwordx4 v[156:159], v241, s[4:7], s16 offen offset:1024 sc1
  v_mfma_f32_16x16x32_bf16 v[44:47], a[76:79], a[20:23], v[44:47]
  ds_read_b64_tr_b16 a[72:73], v106 offset:0
  s_add_u32 s16, s16, 262144
  v_mfma_f32_16x16x32_bf16 v[44:47], a[108:111], a[28:31], v[44:47]
  ds_read_b64_tr_b16 a[74:75], v106 offset:4096
  v_mfma_f32_16x16x32_bf16 v[28:31], a[108:111], a[24:27], v[28:31]
  ds_read_b64_tr_b16 a[108:109], v107 offset:8192
  ds_read_b64_tr_b16 a[110:111], v107 offset:12288
  v_mfma_f32_16x16x32_bf16 v[28:31], a[76:79], a[16:19], v[28:31]
  s_waitcnt vmcnt(16) lgkmcnt(10)
  s_barrier
  v_mfma_f32_16x16x32_bf16 v[72:75], a[80:83], a[32:35], v[72:75]
  ds_read_b64_tr_b16 a[76:77], v107 offset:0
  s_add_u32 m0, s38, 114688
  v_mfma_f32_16x16x32_bf16 v[72:75], a[112:115], a[40:43], v[72:75]
  buffer_load_dwordx4 v227, s[8:11], s17 offen offset:2048 lds
  v_mfma_f32_16x16x32_bf16 v[88:91], a[112:115], a[44:47], v[88:91]
  ds_read_b64_tr_b16 a[78:79], v107 offset:4096
  ds_read_b64_tr_b16 a[112:113], v104 offset:26624
  v_mfma_f32_16x16x32_bf16 v[88:91], a[80:83], a[36:39], v[88:91]
  buffer_load_dwordx4 v[160:163], v240, s[4:7], s16 offen offset:0 sc1
  v_mfma_f32_16x16x32_bf16 v[92:95], a[84:87], a[36:39], v[92:95]
  ds_read_b64_tr_b16 a[114:115], v104 offset:30720
  ds_read_b64_tr_b16 a[80:81], v104 offset:18432
  v_mfma_f32_16x16x32_bf16 v[92:95], a[116:119], a[44:47], v[92:95]
  ds_read_b64_tr_b16 a[82:83], v104 offset:22528
  v_mfma_f32_16x16x32_bf16 v[76:79], a[116:119], a[40:43], v[76:79]
  buffer_load_dwordx4 v228, s[8:11], s17 offen offset:3072 lds
  v_mfma_f32_16x16x32_bf16 v[76:79], a[84:87], a[32:35], v[76:79]
  ds_read_b64_tr_b16 a[116:117], v105 offset:26624
  s_add_u32 s17, s17, 917504
  v_mfma_f32_16x16x32_bf16 v[80:83], a[88:91], a[32:35], v[80:83]
  buffer_load_dwordx4 v[164:167], v240, s[4:7], s16 offen offset:1024 sc1
  v_mfma_f32_16x16x32_bf16 v[80:83], a[120:123], a[40:43], v[80:83]
  ds_read_b64_tr_b16 a[118:119], v105 offset:30720
  s_add_u32 m0, s38, 112640
  v_mfma_f32_16x16x32_bf16 v[96:99], a[120:123], a[44:47], v[96:99]
  ds_read_b64_tr_b16 a[84:85], v105 offset:18432
  ds_read_b64_tr_b16 a[86:87], v105 offset:22528
  v_mfma_f32_16x16x32_bf16 v[96:99], a[88:91], a[36:39], v[96:99]
  buffer_load_dwordx4 v227, s[8:11], s17 offen offset:2048 lds
  v_mfma_f32_16x16x32_bf16 v[100:103], a[92:95], a[36:39], v[100:103]
  ds_read_b64_tr_b16 a[120:121], v106 offset:26624
  ds_read_b64_tr_b16 a[122:123], v106 offset:30720
  v_mfma_f32_16x16x32_bf16 v[100:103], a[124:127], a[44:47], v[100:103]
  buffer_load_dwordx4 v[168:171], v241, s[4:7], s16 offen offset:0 sc1
  v_mfma_f32_16x16x32_bf16 v[84:87], a[124:127], a[40:43], v[84:87]
  ds_read_b64_tr_b16 a[88:89], v106 offset:18432
  ds_read_b64_tr_b16 a[90:91], v106 offset:22528
  v_mfma_f32_16x16x32_bf16 v[84:87], a[92:95], a[32:35], v[84:87]
  ds_read_b64_tr_b16 a[124:125], v107 offset:26624
  ds_read_b64_tr_b16 a[126:127], v107 offset:30720
  v_mfma_f32_16x16x32_bf16 v[16:19], a[64:67], a[32:35], v[16:19]
  buffer_load_dwordx4 v228, s[8:11], s17 offen offset:3072 lds
  v_mfma_f32_16x16x32_bf16 v[16:19], a[96:99], a[40:43], v[16:19]
  ds_read_b64_tr_b16 a[92:93], v107 offset:18432
  s_mov_b32 s17, s97
  v_mfma_f32_16x16x32_bf16 v[32:35], a[96:99], a[44:47], v[32:35]
  ds_read_b64_tr_b16 a[94:95], v107 offset:22528
  ds_read_b64_tr_b16 a[96:97], v104 offset:24576
  v_mfma_f32_16x16x32_bf16 v[32:35], a[64:67], a[36:39], v[32:35]
  buffer_load_dwordx4 v[172:175], v241, s[4:7], s16 offen offset:1024 sc1
  s_waitcnt lgkmcnt(10)
  v_mfma_f32_16x16x32_bf16 v[36:39], a[68:71], a[36:39], v[36:39]
  ds_read_b64_tr_b16 a[98:99], v104 offset:28672
  s_add_u32 s16, s16, 262144
  v_mfma_f32_16x16x32_bf16 v[36:39], a[100:103], a[44:47], v[36:39]
  buffer_load_dwordx4 v[176:179], v240, s[4:7], s16 offen offset:0 sc1
  v_mfma_f32_16x16x32_bf16 v[20:23], a[100:103], a[40:43], v[20:23]
  ds_read_b64_tr_b16 a[64:65], v104 offset:16384
  ds_read_b64_tr_b16 a[66:67], v104 offset:20480
  v_mfma_f32_16x16x32_bf16 v[20:23], a[68:71], a[32:35], v[20:23]
  ds_read_b64_tr_b16 a[100:101], v105 offset:24576
  ds_read_b64_tr_b16 a[102:103], v105 offset:28672
  v_mfma_f32_16x16x32_bf16 v[24:27], a[72:75], a[32:35], v[24:27]
  buffer_load_dwordx4 v[180:183], v240, s[4:7], s16 offen offset:1024 sc1
  v_mfma_f32_16x16x32_bf16 v[24:27], a[104:107], a[40:43], v[24:27]
  ds_read_b64_tr_b16 a[68:69], v105 offset:16384
  ds_read_b64_tr_b16 a[70:71], v105 offset:20480
  v_mfma_f32_16x16x32_bf16 v[40:43], a[104:107], a[44:47], v[40:43]
  buffer_load_dwordx4 v[184:187], v241, s[4:7], s16 offen offset:0 sc1
  v_mfma_f32_16x16x32_bf16 v[40:43], a[72:75], a[36:39], v[40:43]
  ds_read_b64_tr_b16 a[104:105], v106 offset:24576
  ds_read_b64_tr_b16 a[106:107], v106 offset:28672
  v_mfma_f32_16x16x32_bf16 v[44:47], a[76:79], a[36:39], v[44:47]
  ds_read_b64_tr_b16 a[72:73], v106 offset:16384
  ds_read_b64_tr_b16 a[74:75], v106 offset:20480
  v_mfma_f32_16x16x32_bf16 v[44:47], a[108:111], a[44:47], v[44:47]
  buffer_load_dwordx4 v[188:191], v241, s[4:7], s16 offen offset:1024 sc1
  v_mfma_f32_16x16x32_bf16 v[28:31], a[108:111], a[40:43], v[28:31]
  ds_read_b64_tr_b16 a[108:109], v107 offset:24576
  s_add_u32 s16, s16, 262144
  v_mfma_f32_16x16x32_bf16 v[28:31], a[76:79], a[32:35], v[28:31]
  s_waitcnt vmcnt(20) lgkmcnt(10)
  s_barrier
  v_mfma_f32_16x16x32_bf16 v[72:75], a[80:83], a[48:51], v[72:75]
  ds_read_b64_tr_b16 a[110:111], v107 offset:28672
  s_add_u32 m0, s38, 133120
  v_mfma_f32_16x16x32_bf16 v[72:75], a[112:115], a[56:59], v[72:75]
  buffer_load_dwordx4 v225, s[8:11], s17 offen offset:0 lds
  v_mfma_f32_16x16x32_bf16 v[88:91], a[112:115], a[60:63], v[88:91]
  ds_read_b64_tr_b16 a[76:77], v107 offset:16384
  ds_read_b64_tr_b16 a[78:79], v107 offset:20480
  v_mfma_f32_16x16x32_bf16 v[88:91], a[80:83], a[52:55], v[88:91]
  ds_read_b64_tr_b16 a[112:113], v104 offset:43008
  ds_read_b64_tr_b16 a[114:115], v104 offset:47104
  v_mfma_f32_16x16x32_bf16 v[92:95], a[84:87], a[52:55], v[92:95]
  ds_read_b64_tr_b16 a[80:81], v104 offset:34816
  ds_read_b64_tr_b16 a[82:83], v104 offset:38912
  v_mfma_f32_16x16x32_bf16 v[92:95], a[116:119], a[60:63], v[92:95]
  v_mfma_f32_16x16x32_bf16 v[76:79], a[116:119], a[56:59], v[76:79]
  ds_read_b64_tr_b16 a[116:117], v105 offset:43008
  ds_read_b64_tr_b16 a[118:119], v105 offset:47104
  v_mfma_f32_16x16x32_bf16 v[76:79], a[84:87], a[48:51], v[76:79]
  ds_read_b64_tr_b16 a[84:85], v105 offset:34816
  ds_read_b64_tr_b16 a[86:87], v105 offset:38912
  v_mfma_f32_16x16x32_bf16 v[80:83], a[88:91], a[48:51], v[80:83]
  buffer_load_dwordx4 v226, s[8:11], s17 offen offset:1024 lds
  v_mfma_f32_16x16x32_bf16 v[80:83], a[120:123], a[56:59], v[80:83]
  s_add_u32 s17, s17, 917504
  v_mfma_f32_16x16x32_bf16 v[96:99], a[120:123], a[60:63], v[96:99]
  ds_read_b64_tr_b16 a[120:121], v106 offset:43008
  s_add_u32 m0, s38, 131072
  v_mfma_f32_16x16x32_bf16 v[96:99], a[88:91], a[52:55], v[96:99]
  ds_read_b64_tr_b16 a[122:123], v106 offset:47104
  ds_read_b64_tr_b16 a[88:89], v106 offset:34816
  v_mfma_f32_16x16x32_bf16 v[100:103], a[92:95], a[52:55], v[100:103]
  ds_read_b64_tr_b16 a[90:91], v106 offset:38912
  v_mfma_f32_16x16x32_bf16 v[100:103], a[124:127], a[60:63], v[100:103]
  v_mfma_f32_16x16x32_bf16 v[84:87], a[124:127], a[56:59], v[84:87]
  ds_read_b64_tr_b16 a[124:125], v107 offset:43008
  ds_read_b64_tr_b16 a[126:127], v107 offset:47104
  v_mfma_f32_16x16x32_bf16 v[84:87], a[92:95], a[48:51], v[84:87]
  ds_read_b64_tr_b16 a[92:93], v107 offset:34816
  ds_read_b64_tr_b16 a[94:95], v107 offset:38912
  s_waitcnt lgkmcnt(10)
  v_mfma_f32_16x16x32_bf16 v[16:19], a[64:67], a[48:51], v[16:19]
  buffer_load_dwordx4 v225, s[8:11], s17 offen offset:0 lds
  v_mfma_f32_16x16x32_bf16 v[16:19], a[96:99], a[56:59], v[16:19]
  v_mfma_f32_16x16x32_bf16 v[32:35], a[96:99], a[60:63], v[32:35]
  ds_read_b64_tr_b16 a[96:97], v104 offset:40960
  ds_read_b64_tr_b16 a[98:99], v104 offset:45056
  v_mfma_f32_16x16x32_bf16 v[32:35], a[64:67], a[52:55], v[32:35]
  ds_read_b64_tr_b16 a[64:65], v104 offset:32768
  ds_read_b64_tr_b16 a[66:67], v104 offset:36864
  v_mfma_f32_16x16x32_bf16 v[36:39], a[68:71], a[52:55], v[36:39]
  v_mfma_f32_16x16x32_bf16 v[36:39], a[100:103], a[60:63], v[36:39]
  v_mfma_f32_16x16x32_bf16 v[20:23], a[100:103], a[56:59], v[20:23]
  ds_read_b64_tr_b16 a[100:101], v105 offset:40960
  ds_read_b64_tr_b16 a[102:103], v105 offset:45056
  v_mfma_f32_16x16x32_bf16 v[20:23], a[68:71], a[48:51], v[20:23]
  ds_read_b64_tr_b16 a[68:69], v105 offset:32768
  ds_read_b64_tr_b16 a[70:71], v105 offset:36864
  v_mfma_f32_16x16x32_bf16 v[24:27], a[72:75], a[48:51], v[24:27]
  buffer_load_dwordx4 v226, s[8:11], s17 offen offset:1024 lds
  v_mfma_f32_16x16x32_bf16 v[24:27], a[104:107], a[56:59], v[24:27]
  s_add_u32 s17, s17, 917504
  v_mfma_f32_16x16x32_bf16 v[40:43], a[104:107], a[60:63], v[40:43]
  ds_read_b64_tr_b16 a[104:105], v106 offset:40960
  ds_read_b64_tr_b16 a[106:107], v106 offset:45056
  v_mfma_f32_16x16x32_bf16 v[40:43], a[72:75], a[52:55], v[40:43]
  ds_read_b64_tr_b16 a[72:73], v106 offset:32768
  ds_read_b64_tr_b16 a[74:75], v106 offset:36864
  v_mfma_f32_16x16x32_bf16 v[44:47], a[76:79], a[52:55], v[44:47]
  v_mfma_f32_16x16x32_bf16 v[44:47], a[108:111], a[60:63], v[44:47]
  v_mfma_f32_16x16x32_bf16 v[28:31], a[108:111], a[56:59], v[28:31]
  ds_read_b64_tr_b16 a[108:109], v107 offset:40960
  ds_read_b64_tr_b16 a[110:111], v107 offset:45056
  v_mfma_f32_16x16x32_bf16 v[28:31], a[76:79], a[48:51], v[28:31]
  s_waitcnt vmcnt(9) lgkmcnt(10)
  s_barrier
  v_swap_b32 v130, v132
  v_swap_b32 v131, v133
  v_swap_b32 v138, v140
  v_swap_b32 v139, v141
  v_swap_b32 v146, v148
  v_swap_b32 v147, v149
  v_swap_b32 v154, v156
  v_swap_b32 v155, v157
  s_nop 1
  v_mfma_f32_16x16x32_bf16 v[72:75], a[80:83], v[128:131], v[72:75]
  ds_read_b64_tr_b16 a[76:77], v107 offset:32768
  s_add_u32 m0, s38, 2048
  v_mfma_f32_16x16x32_bf16 v[72:75], a[112:115], v[136:139], v[72:75]
  buffer_load_dwordx4 v225, s[8:11], s17 offen offset:0 lds
  v_mfma_f32_16x16x32_bf16 v[88:91], a[112:115], v[140:143], v[88:91]
  ds_read_b64_tr_b16 a[78:79], v107 offset:36864
  ds_read_b64_tr_b16 a[112:113], v104 offset:59392
  v_mfma_f32_16x16x32_bf16 v[88:91], a[80:83], v[132:135], v[88:91]
  ds_read_b64_tr_b16 a[114:115], v104 offset:63488
  ds_read_b64_tr_b16 a[80:81], v104 offset:51200
  v_mfma_f32_16x16x32_bf16 v[92:95], a[84:87], v[132:135], v[92:95]
  ds_read_b64_tr_b16 a[82:83], v104 offset:55296
  v_mfma_f32_16x16x32_bf16 v[92:95], a[116:119], v[140:143], v[92:95]
  v_mfma_f32_16x16x32_bf16 v[76:79], a[116:119], v[136:139], v[76:79]
  ds_read_b64_tr_b16 a[116:117], v105 offset:59392
  ds_read_b64_tr_b16 a[118:119], v105 offset:63488
  v_mfma_f32_16x16x32_bf16 v[76:79], a[84:87], v[128:131], v[76:79]
  ds_read_b64_tr_b16 a[84:85], v105 offset:51200
  ds_read_b64_tr_b16 a[86:87], v105 offset:55296
  v_mfma_f32_16x16x32_bf16 v[80:83], a[88:91], v[128:131], v[80:83]
  buffer_load_dwordx4 v226, s[8:11], s17 offen offset:1024 lds
  v_mfma_f32_16x16x32_bf16 v[80:83], a[120:123], v[136:139], v[80:83]
  s_add_u32 s17, s17, 917504
  v_mfma_f32_16x16x32_bf16 v[96:99], a[120:123], v[140:143], v[96:99]
  ds_read_b64_tr_b16 a[120:121], v106 offset:59392
  s_add_u32 m0, s38, 0
  v_mfma_f32_16x16x32_bf16 v[96:99], a[88:91], v[132:135], v[96:99]
  ds_read_b64_tr_b16 a[122:123], v106 offset:63488
  ds_read_b64_tr_b16 a[88:89], v106 offset:51200
  v_mfma_f32_16x16x32_bf16 v[100:103], a[92:95], v[132:135], v[100:103]
  ds_read_b64_tr_b16 a[90:91], v106 offset:55296
  v_mfma_f32_16x16x32_bf16 v[100:103], a[124:127], v[140:143], v[100:103]
  v_mfma_f32_16x16x32_bf16 v[84:87], a[124:127], v[136:139], v[84:87]
  ds_read_b64_tr_b16 a[124:125], v107 offset:59392
  ds_read_b64_tr_b16 a[126:127], v107 offset:63488
  v_mfma_f32_16x16x32_bf16 v[84:87], a[92:95], v[128:131], v[84:87]
  ds_read_b64_tr_b16 a[92:93], v107 offset:51200
  ds_read_b64_tr_b16 a[94:95], v107 offset:55296
  v_mfma_f32_16x16x32_bf16 v[72:75], a[64:67], v[144:147], v[72:75]
  buffer_load_dwordx4 v225, s[8:11], s17 offen offset:0 lds
  v_mfma_f32_16x16x32_bf16 v[72:75], a[96:99], v[152:155], v[72:75]
  v_mfma_f32_16x16x32_bf16 v[88:91], a[96:99], v[156:159], v[88:91]
  ds_read_b64_tr_b16 a[96:97], v104 offset:57344
  ds_read_b64_tr_b16 a[98:99], v104 offset:61440
  v_mfma_f32_16x16x32_bf16 v[88:91], a[64:67], v[148:151], v[88:91]
  ds_read_b64_tr_b16 a[64:65], v104 offset:49152
  ds_read_b64_tr_b16 a[66:67], v104 offset:53248
  s_waitcnt lgkmcnt(10)
  v_mfma_f32_16x16x32_bf16 v[92:95], a[68:71], v[148:151], v[92:95]
  v_mfma_f32_16x16x32_bf16 v[92:95], a[100:103], v[156:159], v[92:95]
  v_mfma_f32_16x16x32_bf16 v[76:79], a[100:103], v[152:155], v[76:79]
  ds_read_b64_tr_b16 a[100:101], v105 offset:57344
  ds_read_b64_tr_b16 a[102:103], v105 offset:61440
  v_mfma_f32_16x16x32_bf16 v[76:79], a[68:71], v[144:147], v[76:79]
  ds_read_b64_tr_b16 a[68:69], v105 offset:49152
  ds_read_b64_tr_b16 a[70:71], v105 offset:53248
  v_mfma_f32_16x16x32_bf16 v[80:83], a[72:75], v[144:147], v[80:83]
  buffer_load_dwordx4 v226, s[8:11], s17 offen offset:1024 lds
  v_mfma_f32_16x16x32_bf16 v[80:83], a[104:107], v[152:155], v[80:83]
  s_add_u32 s17, s17, 917504
  v_mfma_f32_16x16x32_bf16 v[96:99], a[104:107], v[156:159], v[96:99]
  s_add_u32 s52, s20, 0xe00000
  s_addc_u32 s53, s21, 0
  s_mov_b32 s54, 0x800000
  s_mov_b32 s55, 0x20000
  v_lshlrev_b32 v50, 4, v231
  s_lshl_b32 s36, s2, 2
  s_add_u32 s36, s36, s3
  s_xor_b32 s37, s36, 4
  s_lshl_b32 s39, s37, 12
  s_lshl_b32 s36, s36, 12
  s_mov_b32 s43, 0x8000
  s_mov_b32 s44, s90
  s_mov_b32 s45, s91
  s_mov_b32 s46, 0x400000
  s_mov_b32 s47, 0x20000
  v_mfma_f32_16x16x32_bf16 v[96:99], a[72:75], v[148:151], v[96:99]
  ds_read_b64_tr_b16 a[104:105], v106 offset:57344
  ds_read_b64_tr_b16 a[106:107], v106 offset:61440
  v_mfma_f32_16x16x32_bf16 v[100:103], a[76:79], v[148:151], v[100:103]
  ds_read_b64_tr_b16 a[72:73], v106 offset:49152
  ds_read_b64_tr_b16 a[74:75], v106 offset:53248
  v_mfma_f32_16x16x32_bf16 v[100:103], a[108:111], v[156:159], v[100:103]
  v_mfma_f32_16x16x32_bf16 v[84:87], a[108:111], v[152:155], v[84:87]
  ds_read_b64_tr_b16 a[108:109], v107 offset:57344
  ds_read_b64_tr_b16 a[110:111], v107 offset:61440
  v_mfma_f32_16x16x32_bf16 v[84:87], a[76:79], v[144:147], v[84:87]
  s_waitcnt vmcnt(4) lgkmcnt(10)
  s_barrier
  v_swap_b32 v162, v164
  v_swap_b32 v163, v165
  v_swap_b32 v170, v172
  v_swap_b32 v171, v173
  v_swap_b32 v178, v180
  v_swap_b32 v179, v181
  v_swap_b32 v186, v188
  v_swap_b32 v187, v189
  s_nop 1
  v_mfma_f32_16x16x32_bf16 v[72:75], a[80:83], v[160:163], v[72:75]
  ds_read_b64_tr_b16 a[76:77], v107 offset:49152
  ds_read_b64_tr_b16 a[78:79], v107 offset:53248
  v_mfma_f32_16x16x32_bf16 v[72:75], a[112:115], v[168:171], v[72:75]
  v_mfma_f32_16x16x32_bf16 v[88:91], a[112:115], v[172:175], v[88:91]
  ds_read_b64_tr_b16 a[112:113], v124 offset:10240
  ds_read_b64_tr_b16 a[114:115], v124 offset:14336
  v_mfma_f32_16x16x32_bf16 v[88:91], a[80:83], v[164:167], v[88:91]
  ds_read_b64_tr_b16 a[80:81], v124 offset:2048
  ds_read_b64_tr_b16 a[82:83], v124 offset:6144
  v_mfma_f32_16x16x32_bf16 v[92:95], a[84:87], v[164:167], v[92:95]
  v_mfma_f32_16x16x32_bf16 v[92:95], a[116:119], v[172:175], v[92:95]
  v_mfma_f32_16x16x32_bf16 v[76:79], a[116:119], v[168:171], v[76:79]
  ds_read_b64_tr_b16 a[116:117], v125 offset:10240
  ds_read_b64_tr_b16 a[118:119], v125 offset:14336
  v_mfma_f32_16x16x32_bf16 v[76:79], a[84:87], v[160:163], v[76:79]
  ds_read_b64_tr_b16 a[84:85], v125 offset:2048
  ds_read_b64_tr_b16 a[86:87], v125 offset:6144
  v_mfma_f32_16x16x32_bf16 v[80:83], a[88:91], v[160:163], v[80:83]
  v_mfma_f32_16x16x32_bf16 v[80:83], a[120:123], v[168:171], v[80:83]
  v_mfma_f32_16x16x32_bf16 v[96:99], a[120:123], v[172:175], v[96:99]
  ds_read_b64_tr_b16 a[120:121], v126 offset:10240
  ds_read_b64_tr_b16 a[122:123], v126 offset:14336
  v_mfma_f32_16x16x32_bf16 v[96:99], a[88:91], v[164:167], v[96:99]
  ds_read_b64_tr_b16 a[88:89], v126 offset:2048
  ds_read_b64_tr_b16 a[90:91], v126 offset:6144
  v_mfma_f32_16x16x32_bf16 v[100:103], a[92:95], v[164:167], v[100:103]
  v_mfma_f32_16x16x32_bf16 v[100:103], a[124:127], v[172:175], v[100:103]
  v_mfma_f32_16x16x32_bf16 v[84:87], a[124:127], v[168:171], v[84:87]
  ds_read_b64_tr_b16 a[124:125], v127 offset:10240
  ds_read_b64_tr_b16 a[126:127], v127 offset:14336
  v_mfma_f32_16x16x32_bf16 v[84:87], a[92:95], v[160:163], v[84:87]
  ds_read_b64_tr_b16 a[92:93], v127 offset:2048
  ds_read_b64_tr_b16 a[94:95], v127 offset:6144
  v_mfma_f32_16x16x32_bf16 v[72:75], a[64:67], v[176:179], v[72:75]
  v_mfma_f32_16x16x32_bf16 v[72:75], a[96:99], v[184:187], v[72:75]
  v_mfma_f32_16x16x32_bf16 v[88:91], a[96:99], v[188:191], v[88:91]
  ds_read_b64_tr_b16 a[96:97], v124 offset:8192
  ds_read_b64_tr_b16 a[98:99], v124 offset:12288
  v_mfma_f32_16x16x32_bf16 v[88:91], a[64:67], v[180:183], v[88:91]
  ds_read_b64_tr_b16 a[64:65], v124 offset:0
  ds_read_b64_tr_b16 a[66:67], v124 offset:4096
  s_waitcnt lgkmcnt(10)
  v_mfma_f32_16x16x32_bf16 v[92:95], a[68:71], v[180:183], v[92:95]
  v_mfma_f32_16x16x32_bf16 v[92:95], a[100:103], v[188:191], v[92:95]
  v_mfma_f32_16x16x32_bf16 v[76:79], a[100:103], v[184:187], v[76:79]
  ds_read_b64_tr_b16 a[100:101], v125 offset:8192
  ds_read_b64_tr_b16 a[102:103], v125 offset:12288
  v_mfma_f32_16x16x32_bf16 v[76:79], a[68:71], v[176:179], v[76:79]
  ds_read_b64_tr_b16 a[68:69], v125 offset:0
  ds_read_b64_tr_b16 a[70:71], v125 offset:4096
  v_mfma_f32_16x16x32_bf16 v[80:83], a[72:75], v[176:179], v[80:83]
  v_mfma_f32_16x16x32_bf16 v[80:83], a[104:107], v[184:187], v[80:83]
  v_mfma_f32_16x16x32_bf16 v[96:99], a[104:107], v[188:191], v[96:99]
  ds_read_b64_tr_b16 a[104:105], v126 offset:8192
  ds_read_b64_tr_b16 a[106:107], v126 offset:12288
  v_mfma_f32_16x16x32_bf16 v[96:99], a[72:75], v[180:183], v[96:99]
  ds_read_b64_tr_b16 a[72:73], v126 offset:0
  ds_read_b64_tr_b16 a[74:75], v126 offset:4096
  v_mfma_f32_16x16x32_bf16 v[100:103], a[76:79], v[180:183], v[100:103]
  v_mfma_f32_16x16x32_bf16 v[100:103], a[108:111], v[188:191], v[100:103]
  v_mfma_f32_16x16x32_bf16 v[84:87], a[108:111], v[184:187], v[84:87]
  ds_read_b64_tr_b16 a[108:109], v127 offset:8192
  ds_read_b64_tr_b16 a[110:111], v127 offset:12288
  v_mfma_f32_16x16x32_bf16 v[84:87], a[76:79], v[176:179], v[84:87]
  s_waitcnt vmcnt(0) lgkmcnt(10)
  s_barrier
  v_mfma_f32_16x16x32_bf16 v[16:19], a[80:83], v[128:131], v[16:19]
  v_cvt_pk_bf16_f32 v108, v72, v73
  v_cvt_pk_bf16_f32 v109, v74, v75
  v_cvt_pk_bf16_f32 v110, v76, v77
  v_cvt_pk_bf16_f32 v111, v78, v79
  buffer_store_dwordx4 v[108:111], v50, s[52:55], s39 offen offset:0 sc1
  v_mfma_f32_16x16x32_bf16 v[16:19], a[112:115], v[136:139], v[16:19]
  ds_read_b64_tr_b16 a[76:77], v127 offset:0
  ds_read_b64_tr_b16 a[78:79], v127 offset:4096
  v_mfma_f32_16x16x32_bf16 v[32:35], a[112:115], v[140:143], v[32:35]
  v_cvt_pk_bf16_f32 v116, v88, v89
  v_cvt_pk_bf16_f32 v117, v90, v91
  v_cvt_pk_bf16_f32 v118, v92, v93
  v_cvt_pk_bf16_f32 v119, v94, v95
  buffer_store_dwordx4 v[116:119], v50, s[52:55], s39 offen offset:2048 sc1
  v_mfma_f32_16x16x32_bf16 v[32:35], a[80:83], v[132:135], v[32:35]
  ds_read_b64_tr_b16 a[112:113], v242 offset:10240
  ds_read_b64_tr_b16 a[114:115], v242 offset:14336
  v_mfma_f32_16x16x32_bf16 v[36:39], a[84:87], v[132:135], v[36:39]
  ds_read_b64_tr_b16 a[80:81], v242 offset:2048
  ds_read_b64_tr_b16 a[82:83], v242 offset:6144
  v_mfma_f32_16x16x32_bf16 v[36:39], a[116:119], v[140:143], v[36:39]
  v_mfma_f32_16x16x32_bf16 v[20:23], a[116:119], v[136:139], v[20:23]
  v_cvt_pk_bf16_f32 v120, v96, v97
  v_cvt_pk_bf16_f32 v121, v98, v99
  v_cvt_pk_bf16_f32 v122, v100, v101
  v_cvt_pk_bf16_f32 v123, v102, v103
  buffer_store_dwordx4 v[120:123], v50, s[52:55], s39 offen offset:3072 sc1
  v_mfma_f32_16x16x32_bf16 v[20:23], a[84:87], v[128:131], v[20:23]
  ds_read_b64_tr_b16 a[116:117], v243 offset:10240
  ds_read_b64_tr_b16 a[118:119], v243 offset:14336
  v_mfma_f32_16x16x32_bf16 v[24:27], a[88:91], v[128:131], v[24:27]
  v_cvt_pk_bf16_f32 v112, v80, v81
  v_cvt_pk_bf16_f32 v113, v82, v83
  v_cvt_pk_bf16_f32 v114, v84, v85
  v_cvt_pk_bf16_f32 v115, v86, v87
  buffer_store_dwordx4 v[112:115], v50, s[52:55], s39 offen offset:1024 sc1
  v_mfma_f32_16x16x32_bf16 v[24:27], a[120:123], v[136:139], v[24:27]
  ds_read_b64_tr_b16 a[84:85], v243 offset:2048
  ds_read_b64_tr_b16 a[86:87], v243 offset:6144
  v_mfma_f32_16x16x32_bf16 v[40:43], a[120:123], v[140:143], v[40:43]
  ds_read_b64_tr_b16 a[120:121], v244 offset:10240
  ds_read_b64_tr_b16 a[122:123], v244 offset:14336
  v_mfma_f32_16x16x32_bf16 v[40:43], a[88:91], v[132:135], v[40:43]
  ds_read_b64_tr_b16 a[88:89], v244 offset:2048
  ds_read_b64_tr_b16 a[90:91], v244 offset:6144
  v_mfma_f32_16x16x32_bf16 v[44:47], a[92:95], v[132:135], v[44:47]
  v_mfma_f32_16x16x32_bf16 v[44:47], a[124:127], v[140:143], v[44:47]
  v_mfma_f32_16x16x32_bf16 v[28:31], a[124:127], v[136:139], v[28:31]
  ds_read_b64_tr_b16 a[124:125], v245 offset:10240
  ds_read_b64_tr_b16 a[126:127], v245 offset:14336
  v_mfma_f32_16x16x32_bf16 v[28:31], a[92:95], v[128:131], v[28:31]
  ds_read_b64_tr_b16 a[92:93], v245 offset:2048
  ds_read_b64_tr_b16 a[94:95], v245 offset:6144
  v_mfma_f32_16x16x32_bf16 v[16:19], a[64:67], v[144:147], v[16:19]
  v_mfma_f32_16x16x32_bf16 v[16:19], a[96:99], v[152:155], v[16:19]
  v_mfma_f32_16x16x32_bf16 v[32:35], a[96:99], v[156:159], v[32:35]
  ds_read_b64_tr_b16 a[96:97], v242 offset:8192
  ds_read_b64_tr_b16 a[98:99], v242 offset:12288
  v_mfma_f32_16x16x32_bf16 v[32:35], a[64:67], v[148:151], v[32:35]
  ds_read_b64_tr_b16 a[64:65], v242 offset:0
  ds_read_b64_tr_b16 a[66:67], v242 offset:4096
  s_waitcnt lgkmcnt(10)
  v_mfma_f32_16x16x32_bf16 v[36:39], a[68:71], v[148:151], v[36:39]
  v_mfma_f32_16x16x32_bf16 v[36:39], a[100:103], v[156:159], v[36:39]
  v_mfma_f32_16x16x32_bf16 v[20:23], a[100:103], v[152:155], v[20:23]
  ds_read_b64_tr_b16 a[100:101], v243 offset:8192
  ds_read_b64_tr_b16 a[102:103], v243 offset:12288
  v_mfma_f32_16x16x32_bf16 v[20:23], a[68:71], v[144:147], v[20:23]
  ds_read_b64_tr_b16 a[68:69], v243 offset:0
  ds_read_b64_tr_b16 a[70:71], v243 offset:4096
  v_mfma_f32_16x16x32_bf16 v[24:27], a[72:75], v[144:147], v[24:27]
  v_mfma_f32_16x16x32_bf16 v[24:27], a[104:107], v[152:155], v[24:27]
  v_mfma_f32_16x16x32_bf16 v[40:43], a[104:107], v[156:159], v[40:43]
  ds_read_b64_tr_b16 a[104:105], v244 offset:8192
  ds_read_b64_tr_b16 a[106:107], v244 offset:12288
  v_mfma_f32_16x16x32_bf16 v[40:43], a[72:75], v[148:151], v[40:43]
  ds_read_b64_tr_b16 a[72:73], v244 offset:0
  ds_read_b64_tr_b16 a[74:75], v244 offset:4096
  v_mfma_f32_16x16x32_bf16 v[44:47], a[76:79], v[148:151], v[44:47]
  v_mfma_f32_16x16x32_bf16 v[44:47], a[108:111], v[156:159], v[44:47]
  v_mfma_f32_16x16x32_bf16 v[28:31], a[108:111], v[152:155], v[28:31]
  ds_read_b64_tr_b16 a[108:109], v245 offset:8192
  ds_read_b64_tr_b16 a[110:111], v245 offset:12288
  v_mfma_f32_16x16x32_bf16 v[28:31], a[76:79], v[144:147], v[28:31]
  s_waitcnt vmcnt(63) lgkmcnt(10)
  s_barrier
  v_mfma_f32_16x16x32_bf16 v[16:19], a[80:83], v[160:163], v[16:19]
  ds_read_b64_tr_b16 a[76:77], v245 offset:0
  ds_read_b64_tr_b16 a[78:79], v245 offset:4096
  v_mfma_f32_16x16x32_bf16 v[16:19], a[112:115], v[168:171], v[16:19]
  v_mfma_f32_16x16x32_bf16 v[32:35], a[112:115], v[172:175], v[32:35]
  v_mfma_f32_16x16x32_bf16 v[32:35], a[80:83], v[164:167], v[32:35]
  v_mfma_f32_16x16x32_bf16 v[36:39], a[84:87], v[164:167], v[36:39]
  v_mfma_f32_16x16x32_bf16 v[36:39], a[116:119], v[172:175], v[36:39]
  v_mfma_f32_16x16x32_bf16 v[20:23], a[116:119], v[168:171], v[20:23]
  v_mfma_f32_16x16x32_bf16 v[20:23], a[84:87], v[160:163], v[20:23]
  v_mfma_f32_16x16x32_bf16 v[24:27], a[88:91], v[160:163], v[24:27]
  v_mfma_f32_16x16x32_bf16 v[24:27], a[120:123], v[168:171], v[24:27]
  v_mfma_f32_16x16x32_bf16 v[40:43], a[120:123], v[172:175], v[40:43]
  v_mfma_f32_16x16x32_bf16 v[40:43], a[88:91], v[164:167], v[40:43]
  v_mfma_f32_16x16x32_bf16 v[44:47], a[92:95], v[164:167], v[44:47]
  v_mfma_f32_16x16x32_bf16 v[44:47], a[124:127], v[172:175], v[44:47]
  v_mfma_f32_16x16x32_bf16 v[28:31], a[124:127], v[168:171], v[28:31]
  v_mfma_f32_16x16x32_bf16 v[28:31], a[92:95], v[160:163], v[28:31]
  v_mfma_f32_16x16x32_bf16 v[16:19], a[64:67], v[176:179], v[16:19]
  v_mfma_f32_16x16x32_bf16 v[16:19], a[96:99], v[184:187], v[16:19]
  v_mfma_f32_16x16x32_bf16 v[32:35], a[96:99], v[188:191], v[32:35]
  v_mfma_f32_16x16x32_bf16 v[32:35], a[64:67], v[180:183], v[32:35]
  buffer_load_dwordx4 v[108:111], v50, s[52:55], s36 offen offset:0 sc1
  s_waitcnt lgkmcnt(8)
  v_mfma_f32_16x16x32_bf16 v[36:39], a[68:71], v[180:183], v[36:39]
  buffer_load_dwordx4 v[112:115], v50, s[52:55], s36 offen offset:1024 sc1
  v_mfma_f32_16x16x32_bf16 v[36:39], a[100:103], v[188:191], v[36:39]
  buffer_load_dwordx4 v[116:119], v50, s[52:55], s36 offen offset:2048 sc1
  v_mfma_f32_16x16x32_bf16 v[20:23], a[100:103], v[184:187], v[20:23]
  buffer_load_dwordx4 v[120:123], v50, s[52:55], s36 offen offset:3072 sc1
  v_mfma_f32_16x16x32_bf16 v[20:23], a[68:71], v[176:179], v[20:23]
  s_waitcnt lgkmcnt(4)
  v_mfma_f32_16x16x32_bf16 v[24:27], a[72:75], v[176:179], v[24:27]
  v_mfma_f32_16x16x32_bf16 v[24:27], a[104:107], v[184:187], v[24:27]
  v_mfma_f32_16x16x32_bf16 v[40:43], a[104:107], v[188:191], v[40:43]
  v_mfma_f32_16x16x32_bf16 v[40:43], a[72:75], v[180:183], v[40:43]
  s_waitcnt lgkmcnt(0)
  v_mfma_f32_16x16x32_bf16 v[44:47], a[76:79], v[180:183], v[44:47]
  v_mfma_f32_16x16x32_bf16 v[44:47], a[108:111], v[188:191], v[44:47]
  v_mfma_f32_16x16x32_bf16 v[28:31], a[108:111], v[184:187], v[28:31]
  v_mfma_f32_16x16x32_bf16 v[28:31], a[76:79], v[176:179], v[28:31]
  s_nop 7
  s_nop 1
  s_waitcnt lgkmcnt(0)
  v_pk_fma_f32 v[192:193], v[16:17], v[56:57], v[192:193]
  v_pk_fma_f32 v[194:195], v[18:19], v[58:59], v[194:195]
  v_pk_fma_f32 v[196:197], v[20:21], v[60:61], v[196:197]
  v_pk_fma_f32 v[198:199], v[22:23], v[62:63], v[198:199]
  v_pk_fma_f32 v[200:201], v[24:25], v[64:65], v[200:201]
  v_pk_fma_f32 v[202:203], v[26:27], v[66:67], v[202:203]
  v_pk_fma_f32 v[204:205], v[28:29], v[68:69], v[204:205]
  v_pk_fma_f32 v[206:207], v[30:31], v[70:71], v[206:207]
  v_pk_fma_f32 v[208:209], v[32:33], v[56:57], v[208:209]
  v_pk_fma_f32 v[210:211], v[34:35], v[58:59], v[210:211]
  v_pk_fma_f32 v[212:213], v[36:37], v[60:61], v[212:213]
  v_pk_fma_f32 v[214:215], v[38:39], v[62:63], v[214:215]
  v_pk_fma_f32 v[216:217], v[40:41], v[64:65], v[216:217]
  v_pk_fma_f32 v[218:219], v[42:43], v[66:67], v[218:219]
  v_pk_fma_f32 v[220:221], v[44:45], v[68:69], v[220:221]
  v_pk_fma_f32 v[222:223], v[46:47], v[70:71], v[222:223]
  s_mov_b32 s60, 262144
  s_branch L_chk_33
L_poll_31:
  buffer_load_dwordx4 v[108:111], v50, s[52:55], s36 offen offset:0 sc1
  buffer_load_dwordx4 v[112:115], v50, s[52:55], s36 offen offset:1024 sc1
  buffer_load_dwordx4 v[116:119], v50, s[52:55], s36 offen offset:2048 sc1
  buffer_load_dwordx4 v[120:123], v50, s[52:55], s36 offen offset:3072 sc1
L_chk_33:
  s_waitcnt vmcnt(3)
  v_max3_u32 v51, v108, v109, v110
  v_max_u32 v51, v51, v111
  s_waitcnt vmcnt(2)
  v_max3_u32 v51, v51, v112, v113
  v_max3_u32 v51, v51, v114, v115
  s_waitcnt vmcnt(1)
  v_max3_u32 v51, v51, v116, v117
  v_max3_u32 v51, v51, v118, v119
  s_waitcnt vmcnt(0)
  v_max3_u32 v51, v51, v120, v121
  v_max3_u32 v51, v51, v122, v123
  v_cmp_eq_u32 vcc, -1, v51
  s_nop 1
  s_cmp_eq_u64 vcc, 0
  s_cbranch_scc1 L_ready_32
  s_sub_u32 s60, s60, 1
  s_cmp_lg_u32 s60, 0
  s_cbranch_scc1 L_poll_31
L_ready_32:
  v_lshlrev_b32 v72, 16, v108
  v_and_b32 v73, 0xffff0000, v108
  v_lshlrev_b32 v74, 16, v109
  v_and_b32 v75, 0xffff0000, v109
  v_pk_fma_f32 v[192:193], v[72:73], v[56:57], v[192:193]
  v_pk_fma_f32 v[194:195], v[74:75], v[58:59], v[194:195]
  v_cvt_pk_bf16_f32 v0, v192, v193
  v_cvt_pk_bf16_f32 v1, v194, v195
  v_lshlrev_b32 v76, 16, v110
  v_and_b32 v77, 0xffff0000, v110
  v_lshlrev_b32 v78, 16, v111
  v_and_b32 v79, 0xffff0000, v111
  v_pk_fma_f32 v[196:197], v[76:77], v[60:61], v[196:197]
  v_pk_fma_f32 v[198:199], v[78:79], v[62:63], v[198:199]
  v_cvt_pk_bf16_f32 v2, v196, v197
  v_cvt_pk_bf16_f32 v3, v198, v199
  s_nop 1
  v_permlane16_swap_b32 v0, v2
  v_permlane16_swap_b32 v1, v3
  s_nop 1
  buffer_store_dwordx4 v[0:3], v252, s[44:47], 0 offen offset:0 sc1
  v_lshlrev_b32 v80, 16, v112
  v_and_b32 v81, 0xffff0000, v112
  v_lshlrev_b32 v82, 16, v113
  v_and_b32 v83, 0xffff0000, v113
  v_pk_fma_f32 v[200:201], v[80:81], v[64:65], v[200:201]
  v_pk_fma_f32 v[202:203], v[82:83], v[66:67], v[202:203]
  v_cvt_pk_bf16_f32 v4, v200, v201
  v_cvt_pk_bf16_f32 v5, v202, v203
  v_lshlrev_b32 v84, 16, v114
  v_and_b32 v85, 0xffff0000, v114
  v_lshlrev_b32 v86, 16, v115
  v_and_b32 v87, 0xffff0000, v115
  v_pk_fma_f32 v[204:205], v[84:85], v[68:69], v[204:205]
  v_pk_fma_f32 v[206:207], v[86:87], v[70:71], v[206:207]
  v_cvt_pk_bf16_f32 v6, v204, v205
  v_cvt_pk_bf16_f32 v7, v206, v207
  s_nop 1
  v_permlane16_swap_b32 v4, v6
  v_permlane16_swap_b32 v5, v7
  s_nop 1
  buffer_store_dwordx4 v[4:7], v252, s[44:47], 0 offen offset:64 sc1
  v_lshlrev_b32 v88, 16, v116
  v_and_b32 v89, 0xffff0000, v116
  v_lshlrev_b32 v90, 16, v117
  v_and_b32 v91, 0xffff0000, v117
  v_pk_fma_f32 v[208:209], v[88:89], v[56:57], v[208:209]
  v_pk_fma_f32 v[210:211], v[90:91], v[58:59], v[210:211]
  v_cvt_pk_bf16_f32 v8, v208, v209
  v_cvt_pk_bf16_f32 v9, v210, v211
  v_lshlrev_b32 v92, 16, v118
  v_and_b32 v93, 0xffff0000, v118
  v_lshlrev_b32 v94, 16, v119
  v_and_b32 v95, 0xffff0000, v119
  v_pk_fma_f32 v[212:213], v[92:93], v[60:61], v[212:213]
  v_pk_fma_f32 v[214:215], v[94:95], v[62:63], v[214:215]
  v_cvt_pk_bf16_f32 v10, v212, v213
  v_cvt_pk_bf16_f32 v11, v214, v215
  s_nop 1
  v_permlane16_swap_b32 v8, v10
  v_permlane16_swap_b32 v9, v11
  s_nop 1
  buffer_store_dwordx4 v[8:11], v252, s[44:47], s43 offen offset:0 sc1
  v_lshlrev_b32 v96, 16, v120
  v_and_b32 v97, 0xffff0000, v120
  v_lshlrev_b32 v98, 16, v121
  v_and_b32 v99, 0xffff0000, v121
  v_pk_fma_f32 v[216:217], v[96:97], v[64:65], v[216:217]
  v_pk_fma_f32 v[218:219], v[98:99], v[66:67], v[218:219]
  v_cvt_pk_bf16_f32 v12, v216, v217
  v_cvt_pk_bf16_f32 v13, v218, v219
  v_lshlrev_b32 v100, 16, v122
  v_and_b32 v101, 0xffff0000, v122
  v_lshlrev_b32 v102, 16, v123
  v_and_b32 v103, 0xffff0000, v123
  v_pk_fma_f32 v[220:221], v[100:101], v[68:69], v[220:221]
  v_pk_fma_f32 v[222:223], v[102:103], v[70:71], v[222:223]
  v_cvt_pk_bf16_f32 v14, v220, v221
  v_cvt_pk_bf16_f32 v15, v222, v223
  s_nop 1
  v_permlane16_swap_b32 v12, v14
  v_permlane16_swap_b32 v13, v15
  s_nop 1
  buffer_store_dwordx4 v[12:15], v252, s[44:47], s43 offen offset:64 sc1
  s_endpgm
L_slow_9:
  s_mov_b32 s33, 262144
L_spin_34:
  buffer_load_dword v127, v126, s[64:67], 0 offen sc1
  s_waitcnt vmcnt(0)
  v_cmp_ne_u32 vcc, s19, v127
  s_nop 1
  s_cmp_eq_u64 vcc, 0
  s_cbranch_scc1 L_back_10
  s_sub_u32 s33, s33, 1
  s_cmp_lg_u32 s33, 0
  s_cbranch_scc1 L_spin_34
  s_branch L_back_10
L_vslow_11:
  s_mov_b32 s33, 262144
L_spin_35:
  buffer_load_dwordx4 v[250:253], v254, s[12:15], s68 offen sc1
  s_waitcnt vmcnt(0)
  v_xor_b32 v168, s44, v250
  v_xor_b32 v169, s45, v251
  v_xor_b32 v170, s46, v252
  v_xor_b32 v171, s47, v253
  v_or3_b32 v172, v168, v169, v170
  v_or_b32 v172, v172, v171
  v_and_b32 v172, 0xff, v172
  v_cmp_ne_u32 vcc, 0, v172
  s_nop 1
  s_cmp_eq_u64 vcc, 0
  s_cbranch_scc1 L_vback_12
  s_sub_u32 s33, s33, 1
  s_cmp_lg_u32 s33, 0
  s_cbranch_scc1 L_spin_35
  s_branch L_vback_12
L_slow_19:
  s_mov_b32 s69, 262144
L_spin_36:
  buffer_load_dword v247, v246, s[64:67], s68 offen sc1
  s_waitcnt vmcnt(0)
  v_cmp_ne_u32 vcc, s19, v247
  s_nop 1
  s_cmp_eq_u64 vcc, 0
  s_cbranch_scc1 L_back_20
  s_sub_u32 s69, s69, 1
  s_cmp_lg_u32 s69, 0
  s_cbranch_scc1 L_spin_36
  s_branch L_back_20
L_slow_25:
  s_mov_b32 s60, 262144
L_spin_37:
  buffer_load_dword v247, v246, s[56:59], s94 offen sc1
  s_waitcnt vmcnt(0)
  v_cmp_ne_u32 vcc, s19, v247
  s_nop 1
  s_cmp_eq_u64 vcc, 0
  s_cbranch_scc1 L_back_26
  s_sub_u32 s60, s60, 1
  s_cmp_lg_u32 s60, 0
  s_cbranch_scc1 L_spin_37
  s_branch L_back_26
L_slow_27:
  s_mov_b32 s60, 262144
L_spin_38:
  buffer_load_dword v247, v246, s[56:59], s94 offen sc1
  s_waitcnt vmcnt(0)
  v_cmp_ne_u32 vcc, s19, v247
  s_nop 1
  s_cmp_eq_u64 vcc, 0
  s_cbranch_scc1 L_back_28
  s_sub_u32 s60, s60, 1
  s_cmp_lg_u32 s60, 0
  s_cbranch_scc1 L_spin_38
  s_branch L_back_28
L_slow_29:
  s_mov_b32 s60, 262144
L_spin_39:
  buffer_load_dword v247, v246, s[56:59], s94 offen sc1
  s_waitcnt vmcnt(0)
  v_cmp_ne_u32 vcc, s19, v247
  s_nop 1
  s_cmp_eq_u64 vcc, 0
  s_cbranch_scc1 L_back_30
  s_sub_u32 s60, s60, 1
  s_cmp_lg_u32 s60, 0
  s_cbranch_scc1 L_spin_39
  s_branch L_back_30
L_end_1:
  s_endpgm
L_code_end:
  s_endpgm
.section .rodata,"a"
.p2align 6
.amdhsa_kernel adaLN_cond__sliding_local_dilated__glu_gated_glu__prompt_kernel
  .amdhsa_next_free_vgpr 512
  .amdhsa_next_free_sgpr 102
  .amdhsa_accum_offset 256
  .amdhsa_group_segment_fixed_size 0
  .amdhsa_kernarg_size 96
  .amdhsa_user_sgpr_count 2
  .amdhsa_user_sgpr_kernarg_segment_ptr 1
  .amdhsa_system_sgpr_workgroup_id_x 1
  .amdhsa_float_denorm_mode_32 3
.end_amdhsa_kernel
```
